```python
import torch

def _softmax(x, axis=-1):
    return torch.softmax(x, dim=axis)

def _gelu(x):
    return torch.nn.functional.gelu(x, approximate='tanh')

def _silu(x):
    return torch.nn.functional.silu(x)

def _sigmoid(x):
    return torch.sigmoid(x)

def _layernorm(x, axis=-1, eps=1e-05):
    m = x.mean(dim=axis, keepdim=True)
    v = x.var(dim=axis, keepdim=True, unbiased=False)
    return (x - m) / torch.sqrt(v + eps)

def _scatter_add(tgt, idx, src, axis=0):
    return tgt.clone().index_add_(axis, idx, src)

def _segment_sum(src, seg, n):
    out = torch.zeros((n,) + src.shape[1:], dtype=src.dtype)
    return out.index_add_(0, seg, src)

def _pad(x, pw):
    flat = tuple((v for pair in reversed(pw) for v in pair))
    return torch.nn.functional.pad(x, flat)
kernel_name = 'gated_mix__ssm_conv_h3__memory_aug_recurrent_mem_tr__prompt'

def setup_inputs():

    _w = lambda a: (lambda t: t.to(torch.bfloat16) if t.is_floating_point() else t)(torch.as_tensor(a))

    def _A_setup():
        B, S, D = (1, 2048, 1024)
        ks = 4
        return {'q': _w((lambda *s: torch.randn(*s, dtype=torch.bfloat16) * 0.05)(B, S, D)), 'k': _w((lambda *s: torch.randn(*s, dtype=torch.bfloat16) * 0.4)(B, S, D)), 'v': _w((lambda *s: torch.randn(*s, dtype=torch.bfloat16) * 0.4)(B, S, D)), 'shift_k': _w((lambda *s: torch.randn(*s, dtype=torch.bfloat16) * 0.4)(D, ks) * 0.5), 'ssm_k': _w((lambda *s: torch.randn(*s, dtype=torch.bfloat16) * 0.4)(D, S) * (1.0 / S ** 0.5)), 'ssm_D': _w((lambda *s: torch.randn(*s, dtype=torch.bfloat16) * 0.4)(D))}
    _A_in = _A_setup()

    def _B_setup():
        B, S, Dm = (1, 2048, 1024)
        H, Dh = (32, 128)
        M, seg = (8, 32)
        seg = min(seg, S)
        S = S // seg * seg
        return {'x': _w((lambda *s: torch.randn(*s, dtype=torch.bfloat16) * 0.05)(B, S, Dm)), 'mem0': _w((lambda *s: torch.randn(*s, dtype=torch.bfloat16) * 0.4)(B, M, Dm)), 'Wq': _w((lambda *s: torch.randn(*s, dtype=torch.bfloat16) * 6.4)(Dm, H, Dh) * Dm ** (-0.5)), 'Wk': _w((lambda *s: torch.randn(*s, dtype=torch.bfloat16) * 6.4)(Dm, H, Dh) * Dm ** (-0.5)), 'Wv': _w((lambda *s: torch.randn(*s, dtype=torch.bfloat16) * 0.4)(Dm, H, Dh) * Dm ** (-0.5)), 'Wo': _w((lambda *s: torch.randn(*s, dtype=torch.bfloat16) * 0.4)(H, Dh, Dm) * (H * Dh) ** (-0.5)), 'seg_len': seg}
    _B_in = _B_setup()
    return {'A_q': _A_in['q'], 'A_k': _A_in['k'], 'A_v': _A_in['v'], 'A_shift_k': _A_in['shift_k'], 'A_ssm_k': _A_in['ssm_k'], 'A_ssm_D': _A_in['ssm_D'], 'B_x': _B_in['x'], 'B_mem0': _B_in['mem0'], 'B_Wq': _B_in['Wq'], 'B_Wk': _B_in['Wk'], 'B_Wv': _B_in['Wv'], 'B_Wo': _B_in['Wo'], 'B_seg_len': _B_in['seg_len'], 'gate_w': _w((lambda *s: torch.randn(*s, dtype=torch.bfloat16) * 0.05)(1024) * 16.0)}

def reference(A_q, A_k, A_v, A_shift_k, A_ssm_k, A_ssm_D, B_x, B_mem0, B_Wq, B_Wk, B_Wv, B_Wo, B_seg_len, gate_w):

    def _A_ref(q, k, v, shift_k, ssm_k, ssm_D):
        B, S, D = q.shape
        ks = shift_k.shape[-1]
        k_pad = _pad(k, ((0, 0), (ks - 1, 0), (0, 0)))
        k_shift = torch.zeros_like(k)
        for t in range(ks):
            k_shift = k_shift + k_pad[:, t:t + S, :] * shift_k[:, ks - 1 - t][None, None, :]
        kv = k_shift * v
        L = 2 * S
        kv_pad = _pad(kv, ((0, 0), (0, S), (0, 0)))
        kf_pad = _pad(ssm_k, ((0, 0), (0, S)))
        kv_f = (lambda x, axes=(-2, -1): torch.fft.rfft2(x.float(), dim=axes))(kv_pad[:, None, :, :], axes=(1, 2))
        kf_f = (lambda x, axes=(-2, -1): torch.fft.rfft2(x.float(), dim=axes))(kf_pad[:, None, :], axes=(1, 2))
        kf_f = (lambda x, *d: x.permute(*d))(kf_f, 1, 2, 0)
        y_f = kv_f * kf_f[None, :, :, :]
        y = (lambda x, s, axes=(-2, -1): torch.fft.irfft2(x, s=s, dim=axes).to(torch.bfloat16))(y_f, (1, L), axes=(1, 2))[:, 0, :S, :]
        y = y + kv * ssm_D[None, None, :]
        return q * y

    def _B_ref(x, mem0, Wq, Wk, Wv, Wo, seg_len):
        B, S, Dm = x.shape
        H, Dh = (Wq.shape[1], Wq.shape[2])
        M = mem0.shape[1]
        scale = Dh ** (-0.5)
        n_seg = S // seg_len
        L = M + seg_len
        idx = torch.arange(L)
        mask = (idx[:, None] < M) | (idx[:, None] >= idx[None, :])
        mem = mem0
        outs = []
        for s in range(n_seg):
            xs = x[:, s * seg_len:(s + 1) * seg_len, :].clone()
            h = torch.concatenate([mem, xs], axis=1)
            q = torch.einsum('btd,dhe->bhte', h, Wq)
            k = torch.einsum('btd,dhe->bhte', h, Wk)
            v = torch.einsum('btd,dhe->bhte', h, Wv)
            scores = torch.einsum('bhqe,bhke->bhqk', q, k) * scale
            scores = torch.where(mask[None, None], scores, -1000000000.0)
            p = _softmax(scores, axis=-1)
            o = torch.einsum('bhqk,bhke->bhqe', p, v)
            o = torch.einsum('bhte,hed->btd', o, Wo)
            mem = o[:, :M, :].clone()
            outs.append(o[:, M:, :])
        return torch.concatenate(outs, axis=1)
    x = A_q
    g = _sigmoid((x * gate_w).sum(-1, keepdims=True))
    a = _A_ref(x, A_k, A_v, A_shift_k, A_ssm_k, A_ssm_D)
    b = _B_ref(x, B_mem0, B_Wq, B_Wk, B_Wv, B_Wo, B_seg_len)
    return g * a + (1 - g) * b
```

```asm
; @launch kernel=mega_kernel grid=(256,1,1) block=(256,1,1) lds=163840
.amdgcn_target "amdgcn-amd-amdhsa--gfx950"
.text
.globl mega_kernel
.p2align 8
.type mega_kernel,@function
mega_kernel:
    s_cmp_ge_u32 s2, 256
    s_cbranch_scc1 .mg_end_1
    s_load_dwordx4 s[52:55], s[0:1], 120
    s_getreg_b32 s3, hwreg(HW_REG_XCC_ID)
    v_and_b32 v1, 63, v0
    v_lshrrev_b32 v4, 6, v0
    s_and_b32 s3, s3, 7
    v_readfirstlane_b32 s24, v4
    s_waitcnt lgkmcnt(0)
    s_mov_b32 s8, s54
    s_and_b32 s9, s55, 0xffff
    s_mov_b32 s10, 0x10000000
    s_mov_b32 s11, 0x00020000
    s_mov_b32 s20, s52
    s_and_b32 s21, s53, 0xffff
    s_mov_b32 s22, 0x100
    s_mov_b32 s23, 0x00020000
    s_mov_b32 s100, s54
    v_mov_b32 v7, 163832
    s_cmp_lg_u32 s24, 0
    s_cbranch_scc1 .noat_4
    s_mov_b64 exec, 1
    v_mov_b32 v5, 1
    s_lshl_b32 s4, s3, 2
    v_mov_b32 v6, s4
    buffer_atomic_add v5, v6, s[20:23], 0 offen sc0 sc1
    s_waitcnt vmcnt(0)
    ds_write_b32 v7, v5
    s_waitcnt lgkmcnt(0)
    s_mov_b64 exec, -1
.noat_4:
    s_barrier
    ds_read_b32 v5, v7
    s_waitcnt lgkmcnt(0)
    v_readfirstlane_b32 s26, v5
    s_mov_b32 s25, s3
    s_mov_b32 s27, 0
    s_and_b32 s26, s26, 31
.mg_role_3:
    s_cmp_ge_u32 s25, 4
    s_cbranch_scc1 .mg_bg_2
    s_load_dwordx2 s[40:41], s[0:1], 56
    s_load_dwordx8 s[84:91], s[0:1], 64
    v_and_b32 v1, 63, v0
    s_sub_u32 s101, 0, s100
    s_and_b32 s101, s101, 0x1fffff
    s_add_u32 s101, s101, 100663296
    s_cmp_lg_u32 s24, 3
    s_cbranch_scc1 .nocal_5
    s_lshl_b32 s4, s25, 5
    s_add_u32 s4, s4, s26
    s_cmp_ge_u32 s4, 16
    s_cbranch_scc1 .nocal_5
    s_lshl_b32 s5, s26, 11
    s_add_u32 s5, s5, s101
    s_mov_b64 exec, 1
    v_mov_b32 v4, -1
    v_mov_b32 v5, 0
    s_mov_b32 s7, 0xffff
    s_memtime s[72:73]
    s_waitcnt lgkmcnt(0)
    buffer_store_dword v4, v5, s[8:11], s5 offen sc1
    s_waitcnt vmcnt(0)
    s_memtime s[74:75]
    s_waitcnt lgkmcnt(0)
    s_sub_u32 s74, s74, s72
    s_min_u32 s7, s7, s74
    s_memtime s[72:73]
    s_waitcnt lgkmcnt(0)
    buffer_store_dword v4, v5, s[8:11], s5 offen sc1
    s_waitcnt vmcnt(0)
    s_memtime s[74:75]
    s_waitcnt lgkmcnt(0)
    s_sub_u32 s74, s74, s72
    s_min_u32 s7, s7, s74
    s_memtime s[72:73]
    s_waitcnt lgkmcnt(0)
    buffer_store_dword v4, v5, s[8:11], s5 offen sc1
    s_waitcnt vmcnt(0)
    s_memtime s[74:75]
    s_waitcnt lgkmcnt(0)
    s_sub_u32 s74, s74, s72
    s_min_u32 s7, s7, s74
    s_memtime s[72:73]
    s_waitcnt lgkmcnt(0)
    buffer_store_dword v4, v5, s[8:11], s5 offen sc1
    s_waitcnt vmcnt(0)
    s_memtime s[74:75]
    s_waitcnt lgkmcnt(0)
    s_sub_u32 s74, s74, s72
    s_min_u32 s7, s7, s74
    s_lshl_b32 s5, s26, 1
    s_add_u32 s5, s5, 64
    v_mov_b32 v4, s7
    buffer_store_short v4, v5, s[20:23], s5 offen sc1
    s_mov_b64 exec, -1
.nocal_5:
    s_lshl_b32 s4, s25, 11
    s_lshl_b32 s5, s26, 6
    s_add_u32 s4, s4, s5
    s_lshl_b32 s6, s24, 21
    s_add_u32 s4, s4, s6
    s_lshl_b32 s7, s25, 21
    s_lshl_b32 s6, s24, 19
    s_add_u32 s7, s7, s6
    s_add_u32 s7, s7, s5
    s_lshl_b32 s6, s24, 15
    v_bfe_u32 v4, v1, 4, 1
    v_lshlrev_b32 v4, 1, v4
    v_and_b32 v5, 3, v1
    v_xor_b32 v4, v4, v5
    v_lshlrev_b32 v4, 4, v4
    v_bfe_u32 v254, v1, 2, 1
    v_mul_u32_u24 v5, 1, v254
    v_bfe_u32 v254, v1, 3, 1
    v_mul_u32_u24 v254, 8, v254
    v_add_u32 v5, v5, v254
    v_bfe_u32 v254, v1, 4, 1
    v_mul_u32_u24 v254, 4, v254
    v_add_u32 v5, v5, v254
    v_bfe_u32 v254, v1, 5, 1
    v_mul_u32_u24 v254, 2, v254
    v_add_u32 v5, v5, v254
    v_lshlrev_b32 v6, 13, v5
    v_add_u32 v6, v6, v4
    v_add_u32 v240, s4, v6
    v_lshlrev_b32 v6, 11, v5
    v_add_u32 v6, v6, v4
    v_add_u32 v241, s7, v6
    v_bfe_u32 v254, v1, 2, 2
    v_mul_u32_u24 v242, 64, v254
    v_bfe_u32 v254, v1, 4, 1
    v_mul_u32_u24 v254, 288, v254
    v_add_u32 v242, v242, v254
    v_bfe_u32 v254, v1, 5, 1
    v_mul_u32_u24 v254, 1024, v254
    v_add_u32 v242, v242, v254
    v_bfe_u32 v254, v1, 0, 2
    v_mul_u32_u24 v254, 8, v254
    v_add_u32 v242, v242, v254
    v_add_u32 v242, s6, v242
    v_xor_b32 v243, 32, v242
    s_waitcnt lgkmcnt(0)
    s_mov_b32 s12, s40
    s_and_b32 s13, s41, 0xffff
    s_mov_b32 s14, 0x4000
    s_mov_b32 s15, 0x00020000
    s_mov_b32 s16, s84
    s_and_b32 s17, s85, 0xffff
    s_mov_b32 s18, 0x800000
    s_mov_b32 s19, 0x00020000
    s_add_u32 m0, s6, 0
    s_mov_b32 s5, 0
    buffer_load_dwordx4 v240, s[16:19], s5 offen lds
    s_add_u32 m0, s6, 1024
    s_mov_b32 s5, 131072
    buffer_load_dwordx4 v240, s[16:19], s5 offen lds
    s_add_u32 m0, s6, 2048
    s_mov_b32 s5, 262144
    buffer_load_dwordx4 v240, s[16:19], s5 offen lds
    s_add_u32 m0, s6, 3072
    s_mov_b32 s5, 393216
    buffer_load_dwordx4 v240, s[16:19], s5 offen lds
    s_add_u32 m0, s6, 4096
    s_mov_b32 s5, 524288
    buffer_load_dwordx4 v240, s[16:19], s5 offen lds
    s_add_u32 m0, s6, 5120
    s_mov_b32 s5, 655360
    buffer_load_dwordx4 v240, s[16:19], s5 offen lds
    s_add_u32 m0, s6, 6144
    s_mov_b32 s5, 786432
    buffer_load_dwordx4 v240, s[16:19], s5 offen lds
    s_add_u32 m0, s6, 7168
    s_mov_b32 s5, 917504
    buffer_load_dwordx4 v240, s[16:19], s5 offen lds
    s_add_u32 m0, s6, 8192
    s_mov_b32 s5, 1048576
    buffer_load_dwordx4 v240, s[16:19], s5 offen lds
    s_add_u32 m0, s6, 9216
    s_mov_b32 s5, 1179648
    buffer_load_dwordx4 v240, s[16:19], s5 offen lds
    s_add_u32 m0, s6, 10240
    s_mov_b32 s5, 1310720
    buffer_load_dwordx4 v240, s[16:19], s5 offen lds
    s_add_u32 m0, s6, 11264
    s_mov_b32 s5, 1441792
    buffer_load_dwordx4 v240, s[16:19], s5 offen lds
    s_add_u32 m0, s6, 12288
    s_mov_b32 s5, 1572864
    buffer_load_dwordx4 v240, s[16:19], s5 offen lds
    s_add_u32 m0, s6, 13312
    s_mov_b32 s5, 1703936
    buffer_load_dwordx4 v240, s[16:19], s5 offen lds
    s_add_u32 m0, s6, 14336
    s_mov_b32 s5, 1835008
    buffer_load_dwordx4 v240, s[16:19], s5 offen lds
    s_add_u32 m0, s6, 15360
    s_mov_b32 s5, 1966080
    buffer_load_dwordx4 v240, s[16:19], s5 offen lds
    s_mov_b32 s16, s86
    s_and_b32 s17, s87, 0xffff
    s_mov_b32 s18, 0x800000
    s_mov_b32 s19, 0x00020000
    s_add_u32 m0, s6, 16384
    s_mov_b32 s5, 0
    buffer_load_dwordx4 v240, s[16:19], s5 offen lds
    s_add_u32 m0, s6, 17408
    s_mov_b32 s5, 131072
    buffer_load_dwordx4 v240, s[16:19], s5 offen lds
    s_add_u32 m0, s6, 18432
    s_mov_b32 s5, 262144
    buffer_load_dwordx4 v240, s[16:19], s5 offen lds
    s_add_u32 m0, s6, 19456
    s_mov_b32 s5, 393216
    buffer_load_dwordx4 v240, s[16:19], s5 offen lds
    s_add_u32 m0, s6, 20480
    s_mov_b32 s5, 524288
    buffer_load_dwordx4 v240, s[16:19], s5 offen lds
    s_add_u32 m0, s6, 21504
    s_mov_b32 s5, 655360
    buffer_load_dwordx4 v240, s[16:19], s5 offen lds
    s_add_u32 m0, s6, 22528
    s_mov_b32 s5, 786432
    buffer_load_dwordx4 v240, s[16:19], s5 offen lds
    s_add_u32 m0, s6, 23552
    s_mov_b32 s5, 917504
    buffer_load_dwordx4 v240, s[16:19], s5 offen lds
    s_add_u32 m0, s6, 24576
    s_mov_b32 s5, 1048576
    buffer_load_dwordx4 v240, s[16:19], s5 offen lds
    s_add_u32 m0, s6, 25600
    s_mov_b32 s5, 1179648
    buffer_load_dwordx4 v240, s[16:19], s5 offen lds
    s_add_u32 m0, s6, 26624
    s_mov_b32 s5, 1310720
    buffer_load_dwordx4 v240, s[16:19], s5 offen lds
    s_add_u32 m0, s6, 27648
    s_mov_b32 s5, 1441792
    buffer_load_dwordx4 v240, s[16:19], s5 offen lds
    s_add_u32 m0, s6, 28672
    s_mov_b32 s5, 1572864
    buffer_load_dwordx4 v240, s[16:19], s5 offen lds
    s_add_u32 m0, s6, 29696
    s_mov_b32 s5, 1703936
    buffer_load_dwordx4 v240, s[16:19], s5 offen lds
    s_add_u32 m0, s6, 30720
    s_mov_b32 s5, 1835008
    buffer_load_dwordx4 v240, s[16:19], s5 offen lds
    s_add_u32 m0, s6, 31744
    s_mov_b32 s5, 1966080
    buffer_load_dwordx4 v240, s[16:19], s5 offen lds
    s_lshr_b32 s52, s26, 2
    s_and_b32 s53, s26, 3
    s_lshl_b32 s54, s25, 14
    s_lshl_b32 s55, s26, 9
    s_add_u32 s55, s55, s54
    s_lshl_b32 s56, s25, 3
    s_add_u32 s56, s56, s52
    s_lshl_b32 s57, s56, 12
    s_lshl_b32 s58, s53, 9
    s_add_u32 s58, s58, s57
    s_mov_b32 s48, 0x00ff00ff
    s_mov_b32 s49, 0x00ff00ff
    s_mov_b32 s50, 0xff00ff00
    s_mov_b32 s51, 0xff00ff00
    v_mov_b32 v2, 0x4444
    v_mov_b32 v4, 0xeeee
    s_lshl_b32 s4, s24, 12
    s_add_u32 s4, s4, s54
    v_cndmask_b32 v2, v4, v2, s[48:49]
    v_bfe_u32 v254, v1, 0, 6
    v_mul_u32_u24 v3, 16, v254
    v_add_u32 v3, s4, v3
    v_add_u32 v4, 0x10000, v3
    s_mul_i32 s4, s24, 1152
    v_bfe_u32 v254, v1, 4, 1
    v_mul_u32_u24 v5, 576, v254
    v_bfe_u32 v254, v1, 5, 1
    v_mul_u32_u24 v254, 64, v254
    v_add_u32 v5, v5, v254
    v_bfe_u32 v254, v1, 0, 4
    v_mul_u32_u24 v254, 4, v254
    v_add_u32 v5, v5, v254
    v_add_u32 v5, s4, v5
    v_add_u32 v6, 4608, v5
    v_add_u32 v7, 9216, v5
    s_lshl_b32 s4, s24, 10
    v_bfe_u32 v254, v1, 0, 6
    v_mul_u32_u24 v8, 16, v254
    v_add_u32 v8, 13824, v8
    v_add_u32 v8, s4, v8
    s_and_b32 s4, s24, 1
    s_lshr_b32 s5, s24, 1
    s_lshl_b32 s59, s4, 6
    s_mul_i32 s60, s5, 4608
    s_add_u32 s59, s59, s60
    s_lshl_b32 s4, s4, 8
    s_add_u32 s60, s58, s4
    s_lshl_b32 s5, s5, 11
    s_add_u32 s61, s60, s5
    v_bfe_u32 v254, v1, 2, 3
    v_mul_u32_u24 v9, 144, v254
    v_bfe_u32 v254, v1, 5, 1
    v_mul_u32_u24 v254, 32, v254
    v_add_u32 v9, v9, v254
    v_bfe_u32 v254, v1, 0, 2
    v_mul_u32_u24 v254, 8, v254
    v_add_u32 v9, v9, v254
    v_add_u32 v9, s59, v9
    v_bfe_u32 v254, v1, 0, 6
    v_mul_u32_u24 v10, 4, v254
    v_add_u32 v10, 131072, v10
    v_add_u32 v10, s61, v10
    v_bfe_u32 v254, v1, 0, 6
    v_mul_u32_u24 v11, 4, v254
    v_add_u32 v11, 17920, v11
    v_add_u32 v11, s4, v11
    v_mov_b32 v20, -1
    v_mov_b32 v21, -1
    v_mov_b32 v22, -1
    v_mov_b32 v23, -1
    v_mov_b32 v40, 0
    v_mov_b32 v41, 0
    v_mov_b32 v42, 0
    v_mov_b32 v43, 0
    v_mov_b32 v44, 0
    v_mov_b32 v45, 0
    v_mov_b32 v46, 0
    v_mov_b32 v47, 0
    v_mov_b32 v48, 0
    v_mov_b32 v49, 0
    v_mov_b32 v50, 0
    v_mov_b32 v51, 0
    v_mov_b32 v52, 0
    v_mov_b32 v53, 0
    v_mov_b32 v54, 0
    v_mov_b32 v55, 0
    v_mov_b32 v56, 0
    v_mov_b32 v57, 0
    v_mov_b32 v58, 0
    v_mov_b32 v59, 0
    v_mov_b32 v60, 0
    v_mov_b32 v61, 0
    v_mov_b32 v62, 0
    v_mov_b32 v63, 0
    v_mov_b32 v64, 0
    v_mov_b32 v65, 0
    v_mov_b32 v66, 0
    v_mov_b32 v67, 0
    v_mov_b32 v68, 0
    v_mov_b32 v69, 0
    v_mov_b32 v70, 0
    v_mov_b32 v71, 0
    v_bfe_u32 v254, v1, 0, 5
    v_mul_u32_u24 v244, 16, v254
    v_bfe_u32 v254, v1, 5, 1
    v_mul_u32_u24 v254, 2048, v254
    v_add_u32 v244, v244, v254
    v_add_u32 v244, 131072, v244
    v_add_u32 v244, s58, v244
    v_bfe_u32 v254, v1, 0, 5
    v_mul_u32_u24 v245, 16, v254
    v_bfe_u32 v254, v1, 5, 1
    v_mul_u32_u24 v254, 65536, v254
    v_add_u32 v245, v245, v254
    v_add_u32 v245, s55, v245
    s_lshl_b32 s4, s25, 5
    s_add_u32 s4, s4, s26
    s_lshl_b32 s4, s4, 14
    s_lshl_b32 s5, s24, 12
    s_add_u32 s4, s4, s5
    s_add_u32 s4, s4, s101
    v_bfe_u32 v254, v1, 0, 6
    v_mul_u32_u24 v246, 16, v254
    v_add_u32 v246, s4, v246
    s_lshl_b32 s4, s26, 6
    v_bfe_u32 v254, v1, 1, 3
    v_mul_u32_u24 v247, 2048, v254
    v_bfe_u32 v254, v1, 4, 2
    v_mul_u32_u24 v254, 16, v254
    v_add_u32 v247, v247, v254
    v_bfe_u32 v254, v1, 0, 1
    v_mul_u32_u24 v254, 8, v254
    v_add_u32 v247, v247, v254
    v_add_u32 v247, s4, v247
    s_waitcnt vmcnt(16)
    ds_read_b64_tr_b16 a[0:1], v242 offset:0
    ds_read_b64_tr_b16 a[2:3], v242 offset:512
    ds_read_b64_tr_b16 a[4:5], v242 offset:2048
    ds_read_b64_tr_b16 a[6:7], v242 offset:2560
    ds_read_b64_tr_b16 a[8:9], v242 offset:4096
    ds_read_b64_tr_b16 a[10:11], v242 offset:4608
    ds_read_b64_tr_b16 a[12:13], v242 offset:6144
    ds_read_b64_tr_b16 a[14:15], v242 offset:6656
    ds_read_b64_tr_b16 a[16:17], v242 offset:8192
    ds_read_b64_tr_b16 a[18:19], v242 offset:8704
    ds_read_b64_tr_b16 a[20:21], v242 offset:10240
    ds_read_b64_tr_b16 a[22:23], v242 offset:10752
    ds_read_b64_tr_b16 a[24:25], v242 offset:12288
    ds_read_b64_tr_b16 a[26:27], v242 offset:12800
    ds_read_b64_tr_b16 a[28:29], v242 offset:14336
    ds_read_b64_tr_b16 a[30:31], v242 offset:14848
    ds_read_b64_tr_b16 a[32:33], v243 offset:0
    ds_read_b64_tr_b16 a[34:35], v243 offset:512
    ds_read_b64_tr_b16 a[36:37], v243 offset:2048
    ds_read_b64_tr_b16 a[38:39], v243 offset:2560
    ds_read_b64_tr_b16 a[40:41], v243 offset:4096
    ds_read_b64_tr_b16 a[42:43], v243 offset:4608
    ds_read_b64_tr_b16 a[44:45], v243 offset:6144
    ds_read_b64_tr_b16 a[46:47], v243 offset:6656
    ds_read_b64_tr_b16 a[48:49], v243 offset:8192
    ds_read_b64_tr_b16 a[50:51], v243 offset:8704
    ds_read_b64_tr_b16 a[52:53], v243 offset:10240
    ds_read_b64_tr_b16 a[54:55], v243 offset:10752
    ds_read_b64_tr_b16 a[56:57], v243 offset:12288
    ds_read_b64_tr_b16 a[58:59], v243 offset:12800
    ds_read_b64_tr_b16 a[60:61], v243 offset:14336
    ds_read_b64_tr_b16 a[62:63], v243 offset:14848
    s_waitcnt lgkmcnt(0)
    v_and_b32 v239, 7, v0
    v_lshlrev_b32 v239, 2, v239
    buffer_load_dword v238, v239, s[20:23], 0 offen sc1
    buffer_load_dwordx2 v[248:249], v247, s[12:15], 0 offen
    s_mov_b32 s16, s88
    s_and_b32 s17, s89, 0xffff
    s_mov_b32 s18, 0x800000
    s_mov_b32 s19, 0x00020000
    s_add_u32 m0, s6, 0
    s_mov_b32 s5, 0
    buffer_load_dwordx4 v240, s[16:19], s5 offen lds
    s_add_u32 m0, s6, 1024
    s_mov_b32 s5, 131072
    buffer_load_dwordx4 v240, s[16:19], s5 offen lds
    s_add_u32 m0, s6, 2048
    s_mov_b32 s5, 262144
    buffer_load_dwordx4 v240, s[16:19], s5 offen lds
    s_add_u32 m0, s6, 3072
    s_mov_b32 s5, 393216
    buffer_load_dwordx4 v240, s[16:19], s5 offen lds
    s_add_u32 m0, s6, 4096
    s_mov_b32 s5, 524288
    buffer_load_dwordx4 v240, s[16:19], s5 offen lds
    s_add_u32 m0, s6, 5120
    s_mov_b32 s5, 655360
    buffer_load_dwordx4 v240, s[16:19], s5 offen lds
    s_add_u32 m0, s6, 6144
    s_mov_b32 s5, 786432
    buffer_load_dwordx4 v240, s[16:19], s5 offen lds
    s_add_u32 m0, s6, 7168
    s_mov_b32 s5, 917504
    buffer_load_dwordx4 v240, s[16:19], s5 offen lds
    s_add_u32 m0, s6, 8192
    s_mov_b32 s5, 1048576
    buffer_load_dwordx4 v240, s[16:19], s5 offen lds
    s_add_u32 m0, s6, 9216
    s_mov_b32 s5, 1179648
    buffer_load_dwordx4 v240, s[16:19], s5 offen lds
    s_add_u32 m0, s6, 10240
    s_mov_b32 s5, 1310720
    buffer_load_dwordx4 v240, s[16:19], s5 offen lds
    s_add_u32 m0, s6, 11264
    s_mov_b32 s5, 1441792
    buffer_load_dwordx4 v240, s[16:19], s5 offen lds
    s_add_u32 m0, s6, 12288
    s_mov_b32 s5, 1572864
    buffer_load_dwordx4 v240, s[16:19], s5 offen lds
    s_add_u32 m0, s6, 13312
    s_mov_b32 s5, 1703936
    buffer_load_dwordx4 v240, s[16:19], s5 offen lds
    s_add_u32 m0, s6, 14336
    s_mov_b32 s5, 1835008
    buffer_load_dwordx4 v240, s[16:19], s5 offen lds
    s_add_u32 m0, s6, 15360
    s_mov_b32 s5, 1966080
    buffer_load_dwordx4 v240, s[16:19], s5 offen lds
    s_waitcnt vmcnt(16)
    s_cmp_lg_u32 s27, 0
    s_cbranch_scc1 .vd_7
    s_mov_b32 s62, 0
.vp_6:
    v_cmp_ne_u32 vcc, 32, v238
    s_cbranch_vccz .vd_7
    v_readlane_b32 s64, v238, 0
    v_readlane_b32 s65, v238, 1
    v_readlane_b32 s66, v238, 2
    v_readlane_b32 s67, v238, 3
    v_readlane_b32 s68, v238, 4
    v_readlane_b32 s69, v238, 5
    v_readlane_b32 s70, v238, 6
    v_readlane_b32 s71, v238, 7
    s_nop 3
    s_add_u32 s4, s64, s65
    s_add_u32 s5, s66, s67
    s_add_u32 s72, s68, s69
    s_add_u32 s73, s70, s71
    s_add_u32 s4, s4, s5
    s_add_u32 s72, s72, s73
    s_add_u32 s4, s4, s72
    s_cmp_ge_u32 s4, 256
    s_cbranch_scc1 .vs_8
    s_add_u32 s62, s62, 1
    s_cmp_gt_u32 s62, 0x100000
    s_cbranch_scc1 .mg_end_1
    buffer_load_dword v238, v239, s[20:23], 0 offen sc1
    s_waitcnt vmcnt(0)
    s_branch .vp_6
.vs_8:
    s_lshr_b32 s25, s2, 5
    s_and_b32 s26, s2, 31
    s_mov_b32 s27, 1
    s_waitcnt vmcnt(0) lgkmcnt(0)
    s_barrier
    s_branch .mg_role_3
.vd_7:
    s_cmp_lg_u32 s27, 0
    s_cbranch_scc1 .slowv_9
    s_lshl_b32 s4, s24, 18
    s_add_u32 s4, s4, 83886080
    buffer_store_dwordx4 v[20:23], v244, s[8:11], s4 offen
    s_cmp_lg_u32 s24, 0
    s_cbranch_scc1 .arm0_10
    s_mov_b32 exec_lo, 0
.arm0_10:
    buffer_store_dwordx4 v[20:23], v245, s[8:11], s4 offen
    s_mov_b64 exec, -1
    buffer_store_dwordx4 v[20:23], v246, s[8:11], 0 offen offset:0 sc1
    buffer_store_dwordx4 v[20:23], v246, s[8:11], 0 offen offset:1024 sc1
    buffer_store_dwordx4 v[20:23], v246, s[8:11], 0 offen offset:2048 sc1
    buffer_store_dwordx4 v[20:23], v246, s[8:11], 0 offen offset:3072 sc1
    s_cmp_lg_u32 s24, 1
    s_cbranch_scc1 .arm1_11
    v_min_u32 v248, 0xfffffffe, v248
    v_min_u32 v249, 0xfffffffe, v249
    v_lshlrev_b32 v247, 3, v1
    s_add_u32 s4, s55, 83886080
    buffer_store_dwordx2 v[248:249], v247, s[8:11], s4 offen
    s_lshl_b32 s4, s56, 6
    s_lshl_b32 s5, s53, 2
    s_add_u32 s4, s4, s5
    s_add_u32 s4, s4, 92274736
    s_mov_b64 exec, 1
    buffer_store_dword v40, v40, s[8:11], s4 offen sc1
    s_mov_b64 exec, -1
.arm1_11:
    ds_read_b64_tr_b16 a[64:65], v242 offset:16384
    ds_read_b64_tr_b16 a[66:67], v242 offset:16896
    ds_read_b64_tr_b16 a[68:69], v242 offset:18432
    ds_read_b64_tr_b16 a[70:71], v242 offset:18944
    ds_read_b64_tr_b16 a[72:73], v242 offset:20480
    ds_read_b64_tr_b16 a[74:75], v242 offset:20992
    ds_read_b64_tr_b16 a[76:77], v242 offset:22528
    ds_read_b64_tr_b16 a[78:79], v242 offset:23040
    ds_read_b64_tr_b16 a[80:81], v242 offset:24576
    ds_read_b64_tr_b16 a[82:83], v242 offset:25088
    ds_read_b64_tr_b16 a[84:85], v242 offset:26624
    ds_read_b64_tr_b16 a[86:87], v242 offset:27136
    ds_read_b64_tr_b16 a[88:89], v242 offset:28672
    ds_read_b64_tr_b16 a[90:91], v242 offset:29184
    ds_read_b64_tr_b16 a[92:93], v242 offset:30720
    ds_read_b64_tr_b16 a[94:95], v242 offset:31232
    ds_read_b64_tr_b16 a[96:97], v243 offset:16384
    ds_read_b64_tr_b16 a[98:99], v243 offset:16896
    ds_read_b64_tr_b16 a[100:101], v243 offset:18432
    ds_read_b64_tr_b16 a[102:103], v243 offset:18944
    ds_read_b64_tr_b16 a[104:105], v243 offset:20480
    ds_read_b64_tr_b16 a[106:107], v243 offset:20992
    ds_read_b64_tr_b16 a[108:109], v243 offset:22528
    ds_read_b64_tr_b16 a[110:111], v243 offset:23040
    ds_read_b64_tr_b16 a[112:113], v243 offset:24576
    ds_read_b64_tr_b16 a[114:115], v243 offset:25088
    ds_read_b64_tr_b16 a[116:117], v243 offset:26624
    ds_read_b64_tr_b16 a[118:119], v243 offset:27136
    ds_read_b64_tr_b16 a[120:121], v243 offset:28672
    ds_read_b64_tr_b16 a[122:123], v243 offset:29184
    ds_read_b64_tr_b16 a[124:125], v243 offset:30720
    ds_read_b64_tr_b16 a[126:127], v243 offset:31232
    s_waitcnt lgkmcnt(0)
    s_mov_b32 s16, s90
    s_and_b32 s17, s91, 0xffff
    s_mov_b32 s18, 0x800000
    s_mov_b32 s19, 0x00020000
    s_add_u32 m0, s6, 16384
    s_mov_b32 s5, 0
    buffer_load_dwordx4 v241, s[16:19], s5 offen lds
    s_add_u32 m0, s6, 17408
    s_mov_b32 s5, 32768
    buffer_load_dwordx4 v241, s[16:19], s5 offen lds
    s_add_u32 m0, s6, 18432
    s_mov_b32 s5, 65536
    buffer_load_dwordx4 v241, s[16:19], s5 offen lds
    s_add_u32 m0, s6, 19456
    s_mov_b32 s5, 98304
    buffer_load_dwordx4 v241, s[16:19], s5 offen lds
    s_add_u32 m0, s6, 20480
    s_mov_b32 s5, 131072
    buffer_load_dwordx4 v241, s[16:19], s5 offen lds
    s_add_u32 m0, s6, 21504
    s_mov_b32 s5, 163840
    buffer_load_dwordx4 v241, s[16:19], s5 offen lds
    s_add_u32 m0, s6, 22528
    s_mov_b32 s5, 196608
    buffer_load_dwordx4 v241, s[16:19], s5 offen lds
    s_add_u32 m0, s6, 23552
    s_mov_b32 s5, 229376
    buffer_load_dwordx4 v241, s[16:19], s5 offen lds
    s_add_u32 m0, s6, 24576
    s_mov_b32 s5, 262144
    buffer_load_dwordx4 v241, s[16:19], s5 offen lds
    s_add_u32 m0, s6, 25600
    s_mov_b32 s5, 294912
    buffer_load_dwordx4 v241, s[16:19], s5 offen lds
    s_add_u32 m0, s6, 26624
    s_mov_b32 s5, 327680
    buffer_load_dwordx4 v241, s[16:19], s5 offen lds
    s_add_u32 m0, s6, 27648
    s_mov_b32 s5, 360448
    buffer_load_dwordx4 v241, s[16:19], s5 offen lds
    s_add_u32 m0, s6, 28672
    s_mov_b32 s5, 393216
    buffer_load_dwordx4 v241, s[16:19], s5 offen lds
    s_add_u32 m0, s6, 29696
    s_mov_b32 s5, 425984
    buffer_load_dwordx4 v241, s[16:19], s5 offen lds
    s_add_u32 m0, s6, 30720
    s_mov_b32 s5, 458752
    buffer_load_dwordx4 v241, s[16:19], s5 offen lds
    s_add_u32 m0, s6, 31744
    s_mov_b32 s5, 491520
    buffer_load_dwordx4 v241, s[16:19], s5 offen lds
    s_waitcnt vmcnt(16)
    s_barrier
    s_cmp_lg_u32 s24, 0
    s_cbranch_scc1 .sg_12
    s_mov_b64 exec, 1
    v_mov_b32 v18, 1
    buffer_atomic_add v18, v40, s[20:23], 0 offen offset:32 sc1
    s_mov_b64 exec, -1
.sg_12:
    ds_read_b64_tr_b16 a[128:129], v242 offset:0
    ds_read_b64_tr_b16 a[130:131], v242 offset:512
    ds_read_b64_tr_b16 a[132:133], v242 offset:2048
    ds_read_b64_tr_b16 a[134:135], v242 offset:2560
    ds_read_b64_tr_b16 a[136:137], v242 offset:4096
    ds_read_b64_tr_b16 a[138:139], v242 offset:4608
    ds_read_b64_tr_b16 a[140:141], v242 offset:6144
    ds_read_b64_tr_b16 a[142:143], v242 offset:6656
    ds_read_b64_tr_b16 a[144:145], v242 offset:8192
    ds_read_b64_tr_b16 a[146:147], v242 offset:8704
    ds_read_b64_tr_b16 a[148:149], v242 offset:10240
    ds_read_b64_tr_b16 a[150:151], v242 offset:10752
    ds_read_b64_tr_b16 a[152:153], v242 offset:12288
    ds_read_b64_tr_b16 a[154:155], v242 offset:12800
    ds_read_b64_tr_b16 a[156:157], v242 offset:14336
    ds_read_b64_tr_b16 a[158:159], v242 offset:14848
    ds_read_b64_tr_b16 a[160:161], v243 offset:0
    ds_read_b64_tr_b16 a[162:163], v243 offset:512
    ds_read_b64_tr_b16 a[164:165], v243 offset:2048
    ds_read_b64_tr_b16 a[166:167], v243 offset:2560
    ds_read_b64_tr_b16 a[168:169], v243 offset:4096
    ds_read_b64_tr_b16 a[170:171], v243 offset:4608
    ds_read_b64_tr_b16 a[172:173], v243 offset:6144
    ds_read_b64_tr_b16 a[174:175], v243 offset:6656
    ds_read_b64_tr_b16 a[176:177], v243 offset:8192
    ds_read_b64_tr_b16 a[178:179], v243 offset:8704
    ds_read_b64_tr_b16 a[180:181], v243 offset:10240
    ds_read_b64_tr_b16 a[182:183], v243 offset:10752
    ds_read_b64_tr_b16 a[184:185], v243 offset:12288
    ds_read_b64_tr_b16 a[186:187], v243 offset:12800
    ds_read_b64_tr_b16 a[188:189], v243 offset:14336
    ds_read_b64_tr_b16 a[190:191], v243 offset:14848
    s_waitcnt lgkmcnt(0)
    s_mov_b32 s47, 0
    s_cmp_lg_u32 s27, 0
    s_cbranch_scc1 .cd_14
    v_and_b32 v18, 15, v1
    v_lshlrev_b32 v18, 1, v18
    s_mov_b32 s62, 0
.cp_13:
    buffer_load_ushort v19, v18, s[20:23], 0 offen offset:64 sc1
    s_add_u32 s62, s62, 1
    s_cmp_gt_u32 s62, 0x100000
    s_cbranch_scc1 .mg_end_1
    s_waitcnt vmcnt(0)
    v_cmp_eq_u32 vcc, 0, v19
    s_cbranch_vccnz .cp_13
    v_readlane_b32 s66, v19, 0
    v_readlane_b32 s67, v19, 1
    v_readlane_b32 s68, v19, 2
    v_readlane_b32 s69, v19, 3
    v_readlane_b32 s70, v19, 4
    v_readlane_b32 s71, v19, 5
    v_readlane_b32 s72, v19, 6
    v_readlane_b32 s73, v19, 7
    v_readlane_b32 s74, v19, 8
    v_readlane_b32 s75, v19, 9
    v_readlane_b32 s76, v19, 10
    v_readlane_b32 s77, v19, 11
    v_readlane_b32 s78, v19, 12
    v_readlane_b32 s79, v19, 13
    v_readlane_b32 s80, v19, 14
    v_readlane_b32 s81, v19, 15
    s_nop 3
    s_add_u32 s4, s66, s67
    s_add_u32 s4, s4, s68
    s_add_u32 s4, s4, s69
    s_add_u32 s4, s4, s74
    s_add_u32 s4, s4, s75
    s_add_u32 s4, s4, s76
    s_add_u32 s4, s4, s77
    s_add_u32 s5, s70, s71
    s_add_u32 s5, s5, s72
    s_add_u32 s5, s5, s73
    s_add_u32 s5, s5, s78
    s_add_u32 s5, s5, s79
    s_add_u32 s5, s5, s80
    s_add_u32 s5, s5, s81
    s_cmp_lt_u32 s5, s4
    s_cselect_b32 s47, 0x2000, 0
    s_cselect_b32 s66, s70, s66
    s_cselect_b32 s67, s71, s67
    s_cselect_b32 s68, s72, s68
    s_cselect_b32 s69, s73, s69
    s_cselect_b32 s74, s78, s74
    s_cselect_b32 s75, s79, s75
    s_cselect_b32 s76, s80, s76
    s_cselect_b32 s77, s81, s77
    s_add_u32 s4, s66, s68
    s_add_u32 s4, s4, s74
    s_add_u32 s4, s4, s76
    s_add_u32 s5, s67, s69
    s_add_u32 s5, s5, s75
    s_add_u32 s5, s5, s77
    s_cmp_lt_u32 s5, s4
    s_cselect_b32 s4, 2048, 0
    s_or_b32 s47, s47, s4
    s_add_u32 s4, s66, s67
    s_add_u32 s4, s4, s74
    s_add_u32 s4, s4, s75
    s_add_u32 s5, s68, s69
    s_add_u32 s5, s5, s76
    s_add_u32 s5, s5, s77
    s_cmp_lt_u32 s5, s4
    s_cselect_b32 s4, 4096, 0
    s_or_b32 s47, s47, s4
    s_add_u32 s4, s66, s67
    s_add_u32 s4, s4, s68
    s_add_u32 s4, s4, s69
    s_add_u32 s5, s74, s75
    s_add_u32 s5, s5, s76
    s_add_u32 s5, s5, s77
    s_cmp_lt_u32 s5, s4
    s_cselect_b32 s4, 16384, 0
    s_or_b32 s47, s47, s4
.cd_14:
    s_waitcnt vmcnt(0)
    ds_read_b64_tr_b16 a[192:193], v242 offset:16384
    ds_read_b64_tr_b16 a[194:195], v242 offset:16896
    ds_read_b64_tr_b16 a[196:197], v242 offset:18432
    ds_read_b64_tr_b16 a[198:199], v242 offset:18944
    ds_read_b64_tr_b16 a[200:201], v242 offset:20480
    ds_read_b64_tr_b16 a[202:203], v242 offset:20992
    ds_read_b64_tr_b16 a[204:205], v242 offset:22528
    ds_read_b64_tr_b16 a[206:207], v242 offset:23040
    ds_read_b64_tr_b16 a[208:209], v242 offset:24576
    ds_read_b64_tr_b16 a[210:211], v242 offset:25088
    ds_read_b64_tr_b16 a[212:213], v242 offset:26624
    ds_read_b64_tr_b16 a[214:215], v242 offset:27136
    ds_read_b64_tr_b16 a[216:217], v242 offset:28672
    ds_read_b64_tr_b16 a[218:219], v242 offset:29184
    ds_read_b64_tr_b16 a[220:221], v242 offset:30720
    ds_read_b64_tr_b16 a[222:223], v242 offset:31232
    ds_read_b64_tr_b16 a[224:225], v243 offset:16384
    ds_read_b64_tr_b16 a[226:227], v243 offset:16896
    ds_read_b64_tr_b16 a[228:229], v243 offset:18432
    ds_read_b64_tr_b16 a[230:231], v243 offset:18944
    ds_read_b64_tr_b16 a[232:233], v243 offset:20480
    ds_read_b64_tr_b16 a[234:235], v243 offset:20992
    ds_read_b64_tr_b16 a[236:237], v243 offset:22528
    ds_read_b64_tr_b16 a[238:239], v243 offset:23040
    ds_read_b64_tr_b16 a[240:241], v243 offset:24576
    ds_read_b64_tr_b16 a[242:243], v243 offset:25088
    ds_read_b64_tr_b16 a[244:245], v243 offset:26624
    ds_read_b64_tr_b16 a[246:247], v243 offset:27136
    ds_read_b64_tr_b16 a[248:249], v243 offset:28672
    ds_read_b64_tr_b16 a[250:251], v243 offset:29184
    ds_read_b64_tr_b16 a[252:253], v243 offset:30720
    ds_read_b64_tr_b16 a[254:255], v243 offset:31232
    s_waitcnt lgkmcnt(0)
    s_mov_b32 s28, 0
    s_mov_b32 s30, 83886080
    s_mov_b32 s31, 84148224
    s_mov_b32 s32, 84410368
    s_mov_b32 s33, 84672512
    s_mov_b32 s41, 66977792
    s_lshl_b32 s42, s56, 13
    s_lshl_b32 s4, s53, 11
    s_add_u32 s44, s42, s4
    s_add_u32 s44, s44, 33554432
    s_add_u32 s42, s42, 16777216
    s_add_u32 s43, s42, 4096
    s_add_u32 s96, s44, 524288
    s_sub_u32 s95, s96, 16777216
    s_mov_b32 s62, 0
    s_mov_b32 s45, 0x3e0293ee
    s_mov_b32 s46, 0
    s_and_b32 s4, s25, 1
    s_lshl_b32 s4, s4, 14
    s_lshr_b32 s5, s25, 1
    s_lshl_b32 s5, s5, 12
    s_or_b32 s4, s4, s5
    s_xor_b32 s47, s47, s4
    s_and_b32 s5, s26, 1
    s_lshl_b32 s5, s5, 10
    s_lshr_b32 s4, s26, 1
    s_lshl_b32 s4, s4, 15
    s_or_b32 s5, s5, s4
    s_bfe_u32 s4, s26, 0x10004
    s_lshl_b32 s4, s4, 11
    s_xor_b32 s5, s5, s4
    s_xor_b32 s34, s5, s47
    s_xor_b32 s35, s34, 0x84000
    s_xor_b32 s36, s34, 0x101000
    s_xor_b32 s37, s34, 0x185000
    s_cmp_eq_u32 s24, 1
    s_cbranch_scc1 .w1_16
    s_cmp_eq_u32 s24, 2
    s_cbranch_scc1 .w2_17
    s_cmp_eq_u32 s24, 3
    s_cbranch_scc1 .w3_18
.w0_15:
    v_bfe_u32 v254, v1, 4, 2
    v_mul_u32_u24 v12, 128, v254
    v_bfe_u32 v254, v1, 0, 3
    v_mul_u32_u24 v254, 16, v254
    v_add_u32 v12, v12, v254
    v_add_u32 v12, 131072, v12
    v_add_u32 v12, s57, v12
    v_bfe_u32 v254, v1, 4, 2
    v_mul_u32_u24 v13, 128, v254
    v_bfe_u32 v254, v1, 2, 2
    v_mul_u32_u24 v254, 32, v254
    v_add_u32 v13, v13, v254
    v_bfe_u32 v254, v1, 0, 1
    v_mul_u32_u24 v254, 16, v254
    v_add_u32 v13, v13, v254
    v_add_u32 v13, 133120, v13
    v_add_u32 v13, s57, v13
    v_bfe_u32 v254, v1, 4, 2
    v_mul_u32_u24 v14, 128, v254
    v_bfe_u32 v254, v1, 0, 4
    v_mul_u32_u24 v254, 16, v254
    v_add_u32 v14, v14, v254
    v_add_u32 v14, 65536, v14
    v_add_u32 v14, s55, v14
    v_bfe_u32 v254, v1, 0, 6
    v_mul_u32_u24 v15, 16, v254
    v_bfe_u32 v254, v1, 2, 2
    v_mul_u32_u24 v16, 128, v254
    v_bfe_u32 v254, v1, 0, 2
    v_mul_u32_u24 v254, 16, v254
    v_add_u32 v16, v16, v254
    v_bfe_u32 v254, v1, 4, 2
    v_mul_u32_u24 v254, 4, v254
    v_add_u32 v16, v16, v254
    v_add_u32 v16, 18432, v16
    v_mov_b32 v144, 0
    v_mov_b32 v145, 0
    v_mov_b32 v146, 0
    v_mov_b32 v147, 0
    v_mov_b32 v148, 0
    v_mov_b32 v149, 0
    v_mov_b32 v150, 0
    v_mov_b32 v151, 0
    v_mov_b32 v152, 0
    v_mov_b32 v153, 0
    v_mov_b32 v154, 0
    v_mov_b32 v155, 0
    v_mov_b32 v156, 0
    v_mov_b32 v157, 0
    v_mov_b32 v158, 0
    v_mov_b32 v159, 0
    v_mov_b32 v160, 0
    v_mov_b32 v161, 0
    v_mov_b32 v162, 0
    v_mov_b32 v163, 0
    v_mov_b32 v164, 0
    v_mov_b32 v165, 0
    v_mov_b32 v166, 0
    v_mov_b32 v167, 0
    v_mov_b32 v168, 0
    v_mov_b32 v169, 0
    v_mov_b32 v170, 0
    v_mov_b32 v171, 0
    v_mov_b32 v172, 0
    v_mov_b32 v173, 0
    v_mov_b32 v174, 0
    v_mov_b32 v175, 0
    v_mov_b32 v208, 0
    v_mov_b32 v209, 0
    v_mov_b32 v210, 0
    v_mov_b32 v211, 0
    v_mov_b32 v212, 0
    v_mov_b32 v213, 0
    v_mov_b32 v214, 0
    v_mov_b32 v215, 0
    v_mov_b32 v216, 0
    v_mov_b32 v217, 0
    v_mov_b32 v218, 0
    v_mov_b32 v219, 0
    v_mov_b32 v18, 0xff800000
    v_cndmask_b32 v200, v18, 0, s[48:49]
    v_mov_b32 v220, 0x3f803f80
    v_cndmask_b32 v201, v18, 0, s[48:49]
    v_mov_b32 v221, 0x3f803f80
    v_cndmask_b32 v202, v18, 0, s[48:49]
    v_mov_b32 v222, 0x3f803f80
    v_cndmask_b32 v203, v18, 0, s[48:49]
    v_mov_b32 v223, 0x3f803f80
    s_barrier
    buffer_load_dwordx4 v[104:107], v15, s[8:11], s42 offen offset:0
    buffer_load_dwordx4 v[108:111], v15, s[8:11], s42 offen offset:1024
    buffer_load_dwordx4 v[112:115], v15, s[8:11], s42 offen offset:2048
    buffer_load_dwordx4 v[116:119], v15, s[8:11], s42 offen offset:3072
    buffer_load_dwordx4 v[120:123], v15, s[8:11], s43 offen offset:0
    buffer_load_dwordx4 v[124:127], v15, s[8:11], s43 offen offset:1024
    buffer_load_dwordx4 v[128:131], v15, s[8:11], s43 offen offset:2048
    buffer_load_dwordx4 v[132:135], v15, s[8:11], s43 offen offset:3072
    buffer_load_dwordx4 v[136:139], v15, s[8:11], s44 offen offset:0
    buffer_load_dwordx4 v[140:143], v15, s[8:11], s44 offen offset:1024
    s_add_u32 s42, s42, 262144
    s_add_u32 s43, s43, 262144
    s_add_u32 s44, s44, 262144
.p2align 6
.step_19:
    s_barrier
    s_setprio 3
    buffer_load_dwordx4 v[24:27], v3, s[8:11], s30 offen offset:0 sc1
    s_setprio 2
    buffer_load_dwordx4 v[28:31], v3, s[8:11], s30 offen offset:1024 sc1
    s_setprio 1
    buffer_load_dwordx4 v[32:35], v3, s[8:11], s30 offen offset:2048 sc1
    s_setprio 0
    buffer_load_dwordx4 v[36:39], v3, s[8:11], s30 offen offset:3072 sc1
    s_waitcnt vmcnt(3)
    v_max_u32 v18, v25, v27
    v_cmp_eq_u32 vcc, -1, v18
    s_cbranch_vccnz .gs_21
.gr_22:
    v_smfmac_f32_16x16x64_bf16 v[40:43], v[24:27], a[0:7], v2
    v_smfmac_f32_16x16x64_bf16 v[44:47], v[24:27], a[32:39], v2
    s_waitcnt vmcnt(2)
    v_max_u32 v18, v29, v31
    v_cmp_eq_u32 vcc, -1, v18
    v_smfmac_f32_16x16x64_bf16 v[48:51], v[24:27], a[64:71], v2
    s_cbranch_vccnz .gs_23
.gr_24:
    v_smfmac_f32_16x16x64_bf16 v[40:43], v[28:31], a[8:15], v2
    v_smfmac_f32_16x16x64_bf16 v[44:47], v[28:31], a[40:47], v2
    v_smfmac_f32_16x16x64_bf16 v[52:55], v[24:27], a[96:103], v2
    s_waitcnt vmcnt(1)
    v_max_u32 v18, v33, v35
    v_cmp_eq_u32 vcc, -1, v18
    v_smfmac_f32_16x16x64_bf16 v[48:51], v[28:31], a[72:79], v2
    s_cbranch_vccnz .gs_25
.gr_26:
    v_smfmac_f32_16x16x64_bf16 v[40:43], v[32:35], a[16:23], v2
    v_smfmac_f32_16x16x64_bf16 v[44:47], v[32:35], a[48:55], v2
    v_smfmac_f32_16x16x64_bf16 v[52:55], v[28:31], a[104:111], v2
    s_waitcnt vmcnt(0)
    v_max_u32 v18, v37, v39
    v_cmp_eq_u32 vcc, -1, v18
    v_smfmac_f32_16x16x64_bf16 v[48:51], v[32:35], a[80:87], v2
    s_cbranch_vccnz .gs_27
.gr_28:
    v_smfmac_f32_16x16x64_bf16 v[40:43], v[36:39], a[24:31], v2
    v_smfmac_f32_16x16x64_bf16 v[44:47], v[36:39], a[56:63], v2
    v_smfmac_f32_16x16x64_bf16 v[52:55], v[32:35], a[112:119], v2
    v_smfmac_f32_16x16x64_bf16 v[48:51], v[36:39], a[88:95], v2
    v_permlane32_swap_b32 v40, v44
    v_permlane32_swap_b32 v41, v45
    v_smfmac_f32_16x16x64_bf16 v[52:55], v[36:39], a[120:127], v2
    v_permlane32_swap_b32 v42, v46
    v_permlane32_swap_b32 v43, v47
    v_add_f32 v40, v40, v44
    v_add_f32 v41, v41, v45
    v_add_f32 v42, v42, v46
    v_add_f32 v43, v43, v47
    ds_write2_b32 v5, v40, v41 offset0:0 offset1:36
    ds_write2_b32 v5, v42, v43 offset0:72 offset1:108
    v_permlane32_swap_b32 v48, v52
    v_permlane32_swap_b32 v49, v53
    v_permlane32_swap_b32 v50, v54
    v_permlane32_swap_b32 v51, v55
    v_add_f32 v48, v48, v52
    v_add_f32 v49, v49, v53
    v_add_f32 v50, v50, v54
    v_add_f32 v51, v51, v55
    ds_write2_b32 v6, v48, v49 offset0:0 offset1:36
    ds_write2_b32 v6, v50, v51 offset0:72 offset1:108
    s_waitcnt lgkmcnt(2)
    s_barrier
    ds_read_b64 v[72:73], v9 offset:0
    ds_read_b64 v[74:75], v9 offset:1152
    ds_read_b64 v[76:77], v9 offset:2304
    ds_read_b64 v[78:79], v9 offset:3456
    s_waitcnt lgkmcnt(4)
    s_barrier
    s_waitcnt lgkmcnt(2)
    v_add_f32 v72, v72, v74
    v_add_f32 v73, v73, v75
    s_waitcnt lgkmcnt(0)
    v_add_f32 v76, v76, v78
    v_add_f32 v77, v77, v79
    v_add_f32 v72, v72, v76
    v_add_f32 v73, v73, v77
    v_cvt_pk_bf16_f32 v72, v72, v73
    v_min_u32 v72, 0xfffffffe, v72
    buffer_store_dword v72, v10, s[8:11], s30 offen
    v_smfmac_f32_16x16x64_bf16 v[56:59], v[24:27], a[128:135], v2
    v_smfmac_f32_16x16x64_bf16 v[60:63], v[24:27], a[160:167], v2
    v_smfmac_f32_16x16x64_bf16 v[56:59], v[28:31], a[136:143], v2
    v_smfmac_f32_16x16x64_bf16 v[60:63], v[28:31], a[168:175], v2
    v_smfmac_f32_16x16x64_bf16 v[56:59], v[32:35], a[144:151], v2
    v_smfmac_f32_16x16x64_bf16 v[60:63], v[32:35], a[176:183], v2
    v_smfmac_f32_16x16x64_bf16 v[56:59], v[36:39], a[152:159], v2
    v_smfmac_f32_16x16x64_bf16 v[60:63], v[36:39], a[184:191], v2
    v_mov_b32 v40, 0
    v_mov_b32 v41, 0
    v_mov_b32 v42, 0
    v_mov_b32 v43, 0
    v_mov_b32 v44, 0
    v_mov_b32 v45, 0
    v_mov_b32 v46, 0
    v_mov_b32 v47, 0
    v_permlane32_swap_b32 v56, v60
    v_permlane32_swap_b32 v57, v61
    v_permlane32_swap_b32 v58, v62
    v_permlane32_swap_b32 v59, v63
    v_add_f32 v56, v56, v60
    v_add_f32 v57, v57, v61
    v_add_f32 v58, v58, v62
    v_add_f32 v59, v59, v63
    ds_write_b128 v8, v[56:59]
    s_cmp_eq_u32 s28, 63
    s_cbranch_scc1 .fin_20
    s_waitcnt vmcnt(0)
    s_mov_b64 exec, s[48:49]
    buffer_load_dwordx4 v[144:147], v12, s[8:11], s30 offen offset:0 sc1
    buffer_load_dwordx4 v[148:151], v12, s[8:11], s30 offen offset:512 sc1
    buffer_load_dwordx4 v[152:155], v12, s[8:11], s30 offen offset:1024 sc1
    buffer_load_dwordx4 v[156:159], v12, s[8:11], s30 offen offset:1536 sc1
    s_mov_b64 exec, s[50:51]
    buffer_load_dwordx4 v[160:163], v12, s[8:11], s30 offen offset:0 sc1
    buffer_load_dwordx4 v[164:167], v12, s[8:11], s30 offen offset:512 sc1
    buffer_load_dwordx4 v[168:171], v12, s[8:11], s30 offen offset:1024 sc1
    buffer_load_dwordx4 v[172:175], v12, s[8:11], s30 offen offset:1536 sc1
    s_mov_b64 exec, -1
    buffer_load_dwordx4 v[176:179], v13, s[8:11], s30 offen offset:0 sc1
    buffer_load_dwordx4 v[180:183], v13, s[8:11], s30 offen offset:512 sc1
    buffer_load_dwordx4 v[184:187], v13, s[8:11], s30 offen offset:1024 sc1
    buffer_load_dwordx4 v[188:191], v13, s[8:11], s30 offen offset:1536 sc1
    s_waitcnt lgkmcnt(0)
    s_barrier
.mf_29:
    s_waitcnt vmcnt(11)
    v_mfma_f32_16x16x32_bf16 v[192:195], v[104:107], v[144:147], 0
    v_max3_u32 v18, v144, v145, v146
    v_max_u32 v18, v18, v147
    s_waitcnt vmcnt(10)
    v_mfma_f32_16x16x32_bf16 v[192:195], v[108:111], v[148:151], v[192:195]
    v_max3_u32 v18, v18, v148, v149
    v_max3_u32 v18, v18, v150, v151
    s_waitcnt vmcnt(9)
    v_mfma_f32_16x16x32_bf16 v[192:195], v[112:115], v[152:155], v[192:195]
    v_max3_u32 v18, v18, v152, v153
    v_max3_u32 v18, v18, v154, v155
    s_waitcnt vmcnt(8)
    v_mfma_f32_16x16x32_bf16 v[192:195], v[116:119], v[156:159], v[192:195]
    v_max3_u32 v18, v18, v156, v157
    v_max3_u32 v18, v18, v158, v159
    s_waitcnt vmcnt(7)
    v_mfma_f32_16x16x32_bf16 v[192:195], v[120:123], v[160:163], v[192:195]
    v_cmp_eq_u32 vcc, -1, v18
    s_waitcnt vmcnt(6)
    v_mfma_f32_16x16x32_bf16 v[192:195], v[124:127], v[164:167], v[192:195]
    s_cbranch_vccnz .re_30
    s_waitcnt vmcnt(5)
    v_mfma_f32_16x16x32_bf16 v[192:195], v[128:131], v[168:171], v[192:195]
    s_waitcnt vmcnt(4)
    v_mfma_f32_16x16x32_bf16 v[192:195], v[132:135], v[172:175], v[192:195]
.mk_31:
    s_waitcnt vmcnt(3)
    v_mfma_f32_16x16x32_bf16 v[196:199], v[176:179], v[144:147], v[200:203]
    v_max3_u32 v18, v176, v177, v178
    v_max_u32 v18, v18, v179
    s_waitcnt vmcnt(2)
    v_mfma_f32_16x16x32_bf16 v[196:199], v[180:183], v[148:151], v[196:199]
    v_max3_u32 v18, v18, v180, v181
    v_max3_u32 v18, v18, v182, v183
    s_waitcnt vmcnt(1)
    v_mfma_f32_16x16x32_bf16 v[196:199], v[184:187], v[152:155], v[196:199]
    v_max3_u32 v18, v18, v184, v185
    v_max3_u32 v18, v18, v186, v187
    s_waitcnt vmcnt(0)
    v_mfma_f32_16x16x32_bf16 v[196:199], v[188:191], v[156:159], v[196:199]
    v_max3_u32 v18, v18, v188, v189
    v_max3_u32 v18, v18, v190, v191
    v_cmp_eq_u32 vcc, -1, v18
    v_max3_f32 v19, v192, v193, v194
    s_cbranch_vccnz .rk_32
    s_barrier
    ds_read_b32 v212, v16
    ds_read_b32 v216, v16 offset:64
    v_max3_f32 v18, v195, v196, v197
    v_max_f32 v18, v18, v19
    s_nop 1
    v_max_f32_dpp v19, v18, v18 row_ror:8 row_mask:0xf bank_mask:0xf
    v_max_f32_dpp v17, v18, v18 row_ror:8 row_mask:0xf bank_mask:0xf
    s_nop 1
    v_permlane16_swap_b32 v19, v17
    v_max_f32 v18, v19, v17
    v_max_f32 v19, v19, v17
    s_nop 1
    v_permlane32_swap_b32 v18, v19
    v_max_f32 v18, v18, v19
    v_mul_f32 v18, s45, v18
    v_fma_f32 v240, v192, s45, -v18
    v_fma_f32 v241, v193, s45, -v18
    v_fma_f32 v242, v194, s45, -v18
    v_fma_f32 v243, v195, s45, -v18
    v_fma_f32 v244, v196, s45, -v18
    v_fma_f32 v245, v197, s45, -v18
    v_exp_f32 v240, v240
    v_exp_f32 v241, v241
    v_exp_f32 v242, v242
    v_exp_f32 v243, v243
    v_exp_f32 v244, v244
    v_exp_f32 v245, v245
    v_cvt_pk_bf16_f32 v204, v240, v241
    v_cvt_pk_bf16_f32 v205, v242, v243
    v_cvt_pk_bf16_f32 v208, v244, v245
    s_waitcnt lgkmcnt(0)
    v_mov_b32_dpp v206, v204 row_ror:8 row_mask:0xf bank_mask:0xf
    v_mov_b32_dpp v207, v205 row_ror:8 row_mask:0xf bank_mask:0xf
    v_mfma_f32_16x16x32_bf16 v[224:227], v[220:223], v[208:211], 0
    v_mfma_f32_16x16x32_bf16 v[224:227], v[220:223], v[204:207], v[224:227]
    v_mfma_f32_16x16x32_bf16 v[228:231], v[212:215], v[208:211], 0
    v_mfma_f32_16x16x32_bf16 v[228:231], v[136:139], v[204:207], v[228:231]
    v_mfma_f32_16x16x32_bf16 v[232:235], v[216:219], v[208:211], 0
    v_rcp_f32 v18, v224
    v_mfma_f32_16x16x32_bf16 v[232:235], v[140:143], v[204:207], v[232:235]
    s_mov_b64 exec, s[48:49]
    v_mul_f32 v228, v18, v228
    v_mul_f32 v229, v18, v229
    v_mul_f32 v230, v18, v230
    v_mul_f32 v231, v18, v231
    v_cvt_pk_bf16_f32 v236, v228, v229
    v_cvt_pk_bf16_f32 v237, v230, v231
    s_nop 1
    v_mul_f32 v232, v18, v232
    v_mul_f32 v233, v18, v233
    v_mul_f32 v234, v18, v234
    v_mul_f32 v235, v18, v235
    v_cvt_pk_bf16_f32 v238, v232, v233
    v_cvt_pk_bf16_f32 v239, v234, v235
    v_min_u32 v239, 0xfffffffe, v239
    buffer_store_dwordx4 v[236:239], v14, s[8:11], s30 offen
    s_mov_b64 exec, -1
    v_mov_b32 v48, 0
    v_mov_b32 v49, 0
    v_mov_b32 v50, 0
    v_mov_b32 v51, 0
    v_mov_b32 v52, 0
    v_mov_b32 v53, 0
    v_mov_b32 v54, 0
    v_mov_b32 v55, 0
    v_mov_b32 v56, 0
    v_mov_b32 v57, 0
    v_mov_b32 v58, 0
    v_mov_b32 v59, 0
    v_mov_b32 v60, 0
    v_mov_b32 v61, 0
    v_mov_b32 v62, 0
    v_mov_b32 v63, 0
    s_waitcnt vmcnt(0)
    s_barrier
    s_setprio 3
    buffer_load_dwordx4 v[24:27], v4, s[8:11], s30 offen offset:0 sc1
    s_setprio 2
    buffer_load_dwordx4 v[28:31], v4, s[8:11], s30 offen offset:1024 sc1
    s_setprio 1
    buffer_load_dwordx4 v[32:35], v4, s[8:11], s30 offen offset:2048 sc1
    s_setprio 0
    buffer_load_dwordx4 v[36:39], v4, s[8:11], s30 offen offset:3072 sc1
    s_waitcnt vmcnt(3)
    v_cmp_eq_u32 vcc, -1, v27
    s_cbranch_vccnz .gs_33
.gr_34:
    v_smfmac_f32_16x16x64_bf16 v[64:67], v[24:27], a[192:199], v2
    v_smfmac_f32_16x16x64_bf16 v[68:71], v[24:27], a[224:231], v2
    s_waitcnt vmcnt(2)
    v_cmp_eq_u32 vcc, -1, v31
    s_cbranch_vccnz .gs_35
.gr_36:
    v_smfmac_f32_16x16x64_bf16 v[64:67], v[28:31], a[200:207], v2
    v_smfmac_f32_16x16x64_bf16 v[68:71], v[28:31], a[232:239], v2
    s_waitcnt vmcnt(1)
    v_cmp_eq_u32 vcc, -1, v35
    s_cbranch_vccnz .gs_37
.gr_38:
    v_smfmac_f32_16x16x64_bf16 v[64:67], v[32:35], a[208:215], v2
    v_smfmac_f32_16x16x64_bf16 v[68:71], v[32:35], a[240:247], v2
    s_waitcnt vmcnt(0)
    v_cmp_eq_u32 vcc, -1, v39
    s_cbranch_vccnz .gs_39
.gr_40:
    v_smfmac_f32_16x16x64_bf16 v[64:67], v[36:39], a[216:223], v2
    v_smfmac_f32_16x16x64_bf16 v[68:71], v[36:39], a[248:255], v2
    s_nop 7
    v_permlane32_swap_b32 v64, v68
    v_permlane32_swap_b32 v65, v69
    v_permlane32_swap_b32 v66, v70
    v_permlane32_swap_b32 v67, v71
    v_add_f32 v64, v64, v68
    v_add_f32 v65, v65, v69
    v_add_f32 v66, v66, v70
    v_add_f32 v67, v67, v71
    ds_write2_b32 v7, v64, v65 offset0:0 offset1:36
    ds_write2_b32 v7, v66, v67 offset0:72 offset1:108
    s_waitcnt lgkmcnt(0)
    s_barrier
    buffer_load_dwordx4 v[104:107], v15, s[8:11], s42 offen offset:0
    buffer_load_dwordx4 v[108:111], v15, s[8:11], s42 offen offset:1024
    buffer_load_dwordx4 v[112:115], v15, s[8:11], s42 offen offset:2048
    buffer_load_dwordx4 v[116:119], v15, s[8:11], s42 offen offset:3072
    buffer_load_dwordx4 v[120:123], v15, s[8:11], s43 offen offset:0
    buffer_load_dwordx4 v[124:127], v15, s[8:11], s43 offen offset:1024
    buffer_load_dwordx4 v[128:131], v15, s[8:11], s43 offen offset:2048
    buffer_load_dwordx4 v[132:135], v15, s[8:11], s43 offen offset:3072
    buffer_load_dwordx4 v[136:139], v15, s[8:11], s44 offen offset:0
    buffer_load_dwordx4 v[140:143], v15, s[8:11], s44 offen offset:1024
    s_add_u32 s42, s42, 262144
    s_add_u32 s43, s43, 262144
    s_add_u32 s44, s44, 262144
    v_mov_b32 v64, 0
    v_mov_b32 v65, 0
    v_mov_b32 v66, 0
    v_mov_b32 v67, 0
    v_mov_b32 v68, 0
    v_mov_b32 v69, 0
    v_mov_b32 v70, 0
    v_mov_b32 v71, 0
    s_mov_b32 s4, s30
    s_mov_b32 s30, s31
    s_mov_b32 s31, s32
    s_mov_b32 s32, s33
    s_mov_b32 s33, s4
    s_add_u32 s28, s28, 1
    s_mov_b32 s62, 0
    s_branch .step_19
.fin_20:
    s_waitcnt lgkmcnt(0)
    s_barrier
    s_barrier
    s_endpgm
.gs_21:
    buffer_load_dwordx4 v[24:27], v3, s[8:11], s30 offen offset:0 sc1
    buffer_load_dwordx4 v[28:31], v3, s[8:11], s30 offen offset:1024 sc1
    buffer_load_dwordx4 v[32:35], v3, s[8:11], s30 offen offset:2048 sc1
    buffer_load_dwordx4 v[36:39], v3, s[8:11], s30 offen offset:3072 sc1
    s_add_u32 s62, s62, 1
    s_cmp_gt_u32 s62, 0x100000
    s_cbranch_scc1 .mg_end_1
    s_waitcnt vmcnt(3)
    v_max_u32 v18, v25, v27
    v_cmp_eq_u32 vcc, -1, v18
    s_cbranch_vccz .gr_22
    s_branch .gs_21
.gs_23:
    buffer_load_dwordx4 v[28:31], v3, s[8:11], s30 offen offset:1024 sc1
    buffer_load_dwordx4 v[32:35], v3, s[8:11], s30 offen offset:2048 sc1
    buffer_load_dwordx4 v[36:39], v3, s[8:11], s30 offen offset:3072 sc1
    s_add_u32 s62, s62, 1
    s_cmp_gt_u32 s62, 0x100000
    s_cbranch_scc1 .mg_end_1
    s_waitcnt vmcnt(2)
    v_max_u32 v18, v29, v31
    v_cmp_eq_u32 vcc, -1, v18
    s_cbranch_vccz .gr_24
    s_branch .gs_23
.gs_25:
    buffer_load_dwordx4 v[32:35], v3, s[8:11], s30 offen offset:2048 sc1
    buffer_load_dwordx4 v[36:39], v3, s[8:11], s30 offen offset:3072 sc1
    s_add_u32 s62, s62, 1
    s_cmp_gt_u32 s62, 0x100000
    s_cbranch_scc1 .mg_end_1
    s_waitcnt vmcnt(1)
    v_max_u32 v18, v33, v35
    v_cmp_eq_u32 vcc, -1, v18
    s_cbranch_vccz .gr_26
    s_branch .gs_25
.gs_27:
    buffer_load_dwordx4 v[36:39], v3, s[8:11], s30 offen offset:3072 sc1
    s_add_u32 s62, s62, 1
    s_cmp_gt_u32 s62, 0x100000
    s_cbranch_scc1 .mg_end_1
    s_waitcnt vmcnt(0)
    v_max_u32 v18, v37, v39
    v_cmp_eq_u32 vcc, -1, v18
    s_cbranch_vccz .gr_28
    s_branch .gs_27
.re_30:
    s_mov_b64 exec, s[48:49]
    buffer_load_dwordx4 v[144:147], v12, s[8:11], s30 offen offset:0 sc1
    buffer_load_dwordx4 v[148:151], v12, s[8:11], s30 offen offset:512 sc1
    buffer_load_dwordx4 v[152:155], v12, s[8:11], s30 offen offset:1024 sc1
    buffer_load_dwordx4 v[156:159], v12, s[8:11], s30 offen offset:1536 sc1
    s_mov_b64 exec, s[50:51]
    buffer_load_dwordx4 v[160:163], v12, s[8:11], s30 offen offset:0 sc1
    buffer_load_dwordx4 v[164:167], v12, s[8:11], s30 offen offset:512 sc1
    buffer_load_dwordx4 v[168:171], v12, s[8:11], s30 offen offset:1024 sc1
    buffer_load_dwordx4 v[172:175], v12, s[8:11], s30 offen offset:1536 sc1
    s_mov_b64 exec, -1
    buffer_load_dwordx4 v[176:179], v13, s[8:11], s30 offen offset:0 sc1
    buffer_load_dwordx4 v[180:183], v13, s[8:11], s30 offen offset:512 sc1
    buffer_load_dwordx4 v[184:187], v13, s[8:11], s30 offen offset:1024 sc1
    buffer_load_dwordx4 v[188:191], v13, s[8:11], s30 offen offset:1536 sc1
    s_add_u32 s62, s62, 1
    s_cmp_gt_u32 s62, 0x100000
    s_cbranch_scc1 .mg_end_1
    s_branch .mf_29
.rk_32:
    buffer_load_dwordx4 v[176:179], v13, s[8:11], s30 offen offset:0 sc1
    buffer_load_dwordx4 v[180:183], v13, s[8:11], s30 offen offset:512 sc1
    buffer_load_dwordx4 v[184:187], v13, s[8:11], s30 offen offset:1024 sc1
    buffer_load_dwordx4 v[188:191], v13, s[8:11], s30 offen offset:1536 sc1
    s_add_u32 s62, s62, 1
    s_cmp_gt_u32 s62, 0x100000
    s_cbranch_scc1 .mg_end_1
    s_branch .mk_31
.gs_33:
    buffer_load_dwordx4 v[24:27], v4, s[8:11], s30 offen offset:0 sc1
    buffer_load_dwordx4 v[28:31], v4, s[8:11], s30 offen offset:1024 sc1
    buffer_load_dwordx4 v[32:35], v4, s[8:11], s30 offen offset:2048 sc1
    buffer_load_dwordx4 v[36:39], v4, s[8:11], s30 offen offset:3072 sc1
    s_add_u32 s62, s62, 1
    s_cmp_gt_u32 s62, 0x100000
    s_cbranch_scc1 .mg_end_1
    s_waitcnt vmcnt(3)
    v_cmp_eq_u32 vcc, -1, v27
    s_cbranch_vccz .gr_34
    s_branch .gs_33
.gs_35:
    buffer_load_dwordx4 v[28:31], v4, s[8:11], s30 offen offset:1024 sc1
    buffer_load_dwordx4 v[32:35], v4, s[8:11], s30 offen offset:2048 sc1
    buffer_load_dwordx4 v[36:39], v4, s[8:11], s30 offen offset:3072 sc1
    s_add_u32 s62, s62, 1
    s_cmp_gt_u32 s62, 0x100000
    s_cbranch_scc1 .mg_end_1
    s_waitcnt vmcnt(2)
    v_cmp_eq_u32 vcc, -1, v31
    s_cbranch_vccz .gr_36
    s_branch .gs_35
.gs_37:
    buffer_load_dwordx4 v[32:35], v4, s[8:11], s30 offen offset:2048 sc1
    buffer_load_dwordx4 v[36:39], v4, s[8:11], s30 offen offset:3072 sc1
    s_add_u32 s62, s62, 1
    s_cmp_gt_u32 s62, 0x100000
    s_cbranch_scc1 .mg_end_1
    s_waitcnt vmcnt(1)
    v_cmp_eq_u32 vcc, -1, v35
    s_cbranch_vccz .gr_38
    s_branch .gs_37
.gs_39:
    buffer_load_dwordx4 v[36:39], v4, s[8:11], s30 offen offset:3072 sc1
    s_add_u32 s62, s62, 1
    s_cmp_gt_u32 s62, 0x100000
    s_cbranch_scc1 .mg_end_1
    s_waitcnt vmcnt(0)
    v_cmp_eq_u32 vcc, -1, v39
    s_cbranch_vccz .gr_40
    s_branch .gs_39
.w1_16:
    v_bfe_u32 v254, v1, 1, 3
    v_mul_u32_u24 v12, 144, v254
    v_bfe_u32 v254, v1, 4, 2
    v_mul_u32_u24 v254, 32, v254
    v_add_u32 v12, v12, v254
    v_bfe_u32 v254, v1, 0, 1
    v_mul_u32_u24 v254, 16, v254
    v_add_u32 v12, v12, v254
    v_add_u32 v12, 9216, v12
    v_bfe_u32 v254, v1, 0, 6
    v_mul_u32_u24 v13, 16, v254
    v_add_u32 v13, s101, v13
    v_bfe_u32 v254, v1, 0, 6
    v_mul_u32_u24 v14, 8, v254
    v_add_u32 v14, s55, v14
    s_barrier
.p2align 6
.step_41:
    s_waitcnt vmcnt(0)
    s_barrier
    s_setprio 3
    buffer_load_dwordx4 v[24:27], v3, s[8:11], s30 offen offset:0 sc1
    s_setprio 2
    buffer_load_dwordx4 v[28:31], v3, s[8:11], s30 offen offset:1024 sc1
    s_setprio 1
    buffer_load_dwordx4 v[32:35], v3, s[8:11], s30 offen offset:2048 sc1
    s_setprio 0
    buffer_load_dwordx4 v[36:39], v3, s[8:11], s30 offen offset:3072 sc1
    s_waitcnt vmcnt(3)
    v_max_u32 v18, v25, v27
    v_cmp_eq_u32 vcc, -1, v18
    s_cbranch_vccnz .gs_43
.gr_44:
    v_smfmac_f32_16x16x64_bf16 v[40:43], v[24:27], a[0:7], v2
    v_smfmac_f32_16x16x64_bf16 v[44:47], v[24:27], a[32:39], v2
    s_waitcnt vmcnt(2)
    v_max_u32 v18, v29, v31
    v_cmp_eq_u32 vcc, -1, v18
    v_smfmac_f32_16x16x64_bf16 v[48:51], v[24:27], a[64:71], v2
    s_cbranch_vccnz .gs_45
.gr_46:
    v_smfmac_f32_16x16x64_bf16 v[40:43], v[28:31], a[8:15], v2
    v_smfmac_f32_16x16x64_bf16 v[44:47], v[28:31], a[40:47], v2
    v_smfmac_f32_16x16x64_bf16 v[52:55], v[24:27], a[96:103], v2
    s_waitcnt vmcnt(1)
    v_max_u32 v18, v33, v35
    v_cmp_eq_u32 vcc, -1, v18
    v_smfmac_f32_16x16x64_bf16 v[48:51], v[28:31], a[72:79], v2
    s_cbranch_vccnz .gs_47
.gr_48:
    v_smfmac_f32_16x16x64_bf16 v[40:43], v[32:35], a[16:23], v2
    v_smfmac_f32_16x16x64_bf16 v[44:47], v[32:35], a[48:55], v2
    v_smfmac_f32_16x16x64_bf16 v[52:55], v[28:31], a[104:111], v2
    s_waitcnt vmcnt(0)
    v_max_u32 v18, v37, v39
    v_cmp_eq_u32 vcc, -1, v18
    v_smfmac_f32_16x16x64_bf16 v[48:51], v[32:35], a[80:87], v2
    s_cbranch_vccnz .gs_49
.gr_50:
    v_smfmac_f32_16x16x64_bf16 v[40:43], v[36:39], a[24:31], v2
    v_smfmac_f32_16x16x64_bf16 v[44:47], v[36:39], a[56:63], v2
    v_smfmac_f32_16x16x64_bf16 v[52:55], v[32:35], a[112:119], v2
    v_smfmac_f32_16x16x64_bf16 v[48:51], v[36:39], a[88:95], v2
    v_permlane32_swap_b32 v40, v44
    v_permlane32_swap_b32 v41, v45
    v_smfmac_f32_16x16x64_bf16 v[52:55], v[36:39], a[120:127], v2
    v_permlane32_swap_b32 v42, v46
    v_permlane32_swap_b32 v43, v47
    v_add_f32 v40, v40, v44
    v_add_f32 v41, v41, v45
    v_add_f32 v42, v42, v46
    v_add_f32 v43, v43, v47
    ds_write2_b32 v5, v40, v41 offset0:0 offset1:36
    ds_write2_b32 v5, v42, v43 offset0:72 offset1:108
    v_permlane32_swap_b32 v48, v52
    v_permlane32_swap_b32 v49, v53
    v_permlane32_swap_b32 v50, v54
    v_permlane32_swap_b32 v51, v55
    v_add_f32 v48, v48, v52
    v_add_f32 v49, v49, v53
    v_add_f32 v50, v50, v54
    v_add_f32 v51, v51, v55
    ds_write2_b32 v6, v48, v49 offset0:0 offset1:36
    ds_write2_b32 v6, v50, v51 offset0:72 offset1:108
    s_waitcnt lgkmcnt(2)
    s_barrier
    ds_read_b64 v[72:73], v9 offset:0
    ds_read_b64 v[74:75], v9 offset:1152
    ds_read_b64 v[76:77], v9 offset:2304
    ds_read_b64 v[78:79], v9 offset:3456
    s_waitcnt lgkmcnt(4)
    s_barrier
    s_waitcnt lgkmcnt(2)
    v_add_f32 v72, v72, v74
    v_add_f32 v73, v73, v75
    s_waitcnt lgkmcnt(0)
    v_add_f32 v76, v76, v78
    v_add_f32 v77, v77, v79
    v_add_f32 v72, v72, v76
    v_add_f32 v73, v73, v77
    v_cvt_pk_bf16_f32 v72, v72, v73
    v_min_u32 v72, 0xfffffffe, v72
    buffer_store_dword v72, v10, s[8:11], s30 offen
    v_smfmac_f32_16x16x64_bf16 v[56:59], v[24:27], a[128:135], v2
    v_smfmac_f32_16x16x64_bf16 v[60:63], v[24:27], a[160:167], v2
    v_smfmac_f32_16x16x64_bf16 v[56:59], v[28:31], a[136:143], v2
    v_smfmac_f32_16x16x64_bf16 v[60:63], v[28:31], a[168:175], v2
    v_smfmac_f32_16x16x64_bf16 v[56:59], v[32:35], a[144:151], v2
    v_smfmac_f32_16x16x64_bf16 v[60:63], v[32:35], a[176:183], v2
    v_smfmac_f32_16x16x64_bf16 v[56:59], v[36:39], a[152:159], v2
    v_smfmac_f32_16x16x64_bf16 v[60:63], v[36:39], a[184:191], v2
    v_mov_b32 v40, 0
    v_mov_b32 v41, 0
    v_mov_b32 v42, 0
    v_mov_b32 v43, 0
    v_mov_b32 v44, 0
    v_mov_b32 v45, 0
    v_mov_b32 v46, 0
    v_mov_b32 v47, 0
    v_permlane32_swap_b32 v56, v60
    v_permlane32_swap_b32 v57, v61
    v_permlane32_swap_b32 v58, v62
    v_permlane32_swap_b32 v59, v63
    v_add_f32 v56, v56, v60
    v_add_f32 v57, v57, v61
    v_add_f32 v58, v58, v62
    v_add_f32 v59, v59, v63
    ds_write_b128 v8, v[56:59]
    s_waitcnt lgkmcnt(0)
    s_barrier
    s_barrier
    s_cmp_eq_u32 s28, 63
    s_cbranch_scc1 .fin_42
    s_xor_b32 s38, s34, 0x4000
    s_xor_b32 s39, s34, 0x1000
    s_xor_b32 s40, s34, 0x5000
    v_mov_b32 v48, 0
    v_mov_b32 v49, 0
    v_mov_b32 v50, 0
    v_mov_b32 v51, 0
    v_mov_b32 v52, 0
    v_mov_b32 v53, 0
    v_mov_b32 v54, 0
    v_mov_b32 v55, 0
    v_mov_b32 v56, 0
    v_mov_b32 v57, 0
    v_mov_b32 v58, 0
    v_mov_b32 v59, 0
    v_mov_b32 v60, 0
    v_mov_b32 v61, 0
    v_mov_b32 v62, 0
    v_mov_b32 v63, 0
    s_barrier
    s_setprio 3
    buffer_load_dwordx4 v[24:27], v4, s[8:11], s30 offen offset:0 sc1
    s_setprio 2
    buffer_load_dwordx4 v[28:31], v4, s[8:11], s30 offen offset:1024 sc1
    s_setprio 1
    buffer_load_dwordx4 v[32:35], v4, s[8:11], s30 offen offset:2048 sc1
    s_setprio 0
    buffer_load_dwordx4 v[36:39], v4, s[8:11], s30 offen offset:3072 sc1
    s_waitcnt vmcnt(3)
    v_cmp_eq_u32 vcc, -1, v27
    s_cbranch_vccnz .gs_51
.gr_52:
    v_smfmac_f32_16x16x64_bf16 v[64:67], v[24:27], a[192:199], v2
    v_smfmac_f32_16x16x64_bf16 v[68:71], v[24:27], a[224:231], v2
    s_waitcnt vmcnt(2)
    v_cmp_eq_u32 vcc, -1, v31
    s_cbranch_vccnz .gs_53
.gr_54:
    v_smfmac_f32_16x16x64_bf16 v[64:67], v[28:31], a[200:207], v2
    v_smfmac_f32_16x16x64_bf16 v[68:71], v[28:31], a[232:239], v2
    s_waitcnt vmcnt(1)
    v_cmp_eq_u32 vcc, -1, v35
    s_cbranch_vccnz .gs_55
.gr_56:
    v_smfmac_f32_16x16x64_bf16 v[64:67], v[32:35], a[208:215], v2
    v_smfmac_f32_16x16x64_bf16 v[68:71], v[32:35], a[240:247], v2
    s_waitcnt vmcnt(0)
    v_cmp_eq_u32 vcc, -1, v39
    s_cbranch_vccnz .gs_57
.gr_58:
    v_smfmac_f32_16x16x64_bf16 v[64:67], v[36:39], a[216:223], v2
    v_smfmac_f32_16x16x64_bf16 v[68:71], v[36:39], a[248:255], v2
    s_nop 7
    v_permlane32_swap_b32 v64, v68
    v_permlane32_swap_b32 v65, v69
    v_permlane32_swap_b32 v66, v70
    v_permlane32_swap_b32 v67, v71
    v_add_f32 v64, v64, v68
    v_add_f32 v65, v65, v69
    v_add_f32 v66, v66, v70
    v_add_f32 v67, v67, v71
    ds_write2_b32 v7, v64, v65 offset0:0 offset1:36
    ds_write2_b32 v7, v66, v67 offset0:72 offset1:108
    s_waitcnt lgkmcnt(0)
    s_barrier
    ds_read_b128 v[72:75], v12 offset:0
    ds_read_b128 v[76:79], v12 offset:1152
    ds_read_b128 v[80:83], v12 offset:2304
    ds_read_b128 v[84:87], v12 offset:3456
    s_waitcnt lgkmcnt(2)
    v_add_f32 v72, v72, v76
    v_add_f32 v73, v73, v77
    v_add_f32 v74, v74, v78
    v_add_f32 v75, v75, v79
    s_waitcnt lgkmcnt(0)
    v_add_f32 v80, v80, v84
    v_add_f32 v81, v81, v85
    v_add_f32 v82, v82, v86
    v_add_f32 v83, v83, v87
    v_add_f32 v72, v72, v80
    v_add_f32 v73, v73, v81
    v_add_f32 v74, v74, v82
    v_add_f32 v75, v75, v83
    v_min_u32 v75, 0xfffffffe, v75
    buffer_store_dwordx4 v[72:75], v13, s[8:11], s34 offen sc1
    v_mov_b32 v64, 0
    v_mov_b32 v65, 0
    v_mov_b32 v66, 0
    v_mov_b32 v67, 0
    v_mov_b32 v68, 0
    v_mov_b32 v69, 0
    v_mov_b32 v70, 0
    v_mov_b32 v71, 0
    s_waitcnt vmcnt(0)
.pl_59:
    buffer_load_dwordx4 v[76:79], v13, s[8:11], s38 offen sc1
    buffer_load_dwordx4 v[80:83], v13, s[8:11], s39 offen sc1
    buffer_load_dwordx4 v[84:87], v13, s[8:11], s40 offen sc1
    s_waitcnt vmcnt(2)
    v_add_f32 v88, v72, v76
    v_add_f32 v89, v73, v77
    v_add_f32 v90, v74, v78
    v_add_f32 v91, v75, v79
    s_waitcnt vmcnt(0)
    v_max3_u32 v18, v79, v83, v87
    v_cmp_eq_u32 vcc, -1, v18
    v_add_f32 v80, v80, v84
    v_add_f32 v81, v81, v85
    v_add_f32 v82, v82, v86
    v_add_f32 v83, v83, v87
    v_add_f32 v88, v88, v80
    v_add_f32 v89, v89, v81
    v_add_f32 v90, v90, v82
    v_add_f32 v91, v91, v83
    v_cvt_pk_bf16_f32 v92, v88, v89
    v_cvt_pk_bf16_f32 v93, v90, v91
    v_min_u32 v93, 0xfffffffe, v93
    s_cbranch_vccnz .pr_60
    buffer_store_dwordx2 v[92:93], v14, s[8:11], s31 offen
    s_mov_b32 s4, s30
    s_mov_b32 s30, s31
    s_mov_b32 s31, s32
    s_mov_b32 s32, s33
    s_mov_b32 s33, s4
    s_add_u32 s28, s28, 1
    s_mov_b32 s62, 0
    s_mov_b32 s4, s34
    s_mov_b32 s34, s35
    s_mov_b32 s35, s36
    s_mov_b32 s36, s37
    s_mov_b32 s37, s4
    s_branch .step_41
.fin_42:
    s_endpgm
.gs_43:
    buffer_load_dwordx4 v[24:27], v3, s[8:11], s30 offen offset:0 sc1
    buffer_load_dwordx4 v[28:31], v3, s[8:11], s30 offen offset:1024 sc1
    buffer_load_dwordx4 v[32:35], v3, s[8:11], s30 offen offset:2048 sc1
    buffer_load_dwordx4 v[36:39], v3, s[8:11], s30 offen offset:3072 sc1
    s_add_u32 s62, s62, 1
    s_cmp_gt_u32 s62, 0x100000
    s_cbranch_scc1 .mg_end_1
    s_waitcnt vmcnt(3)
    v_max_u32 v18, v25, v27
    v_cmp_eq_u32 vcc, -1, v18
    s_cbranch_vccz .gr_44
    s_branch .gs_43
.gs_45:
    buffer_load_dwordx4 v[28:31], v3, s[8:11], s30 offen offset:1024 sc1
    buffer_load_dwordx4 v[32:35], v3, s[8:11], s30 offen offset:2048 sc1
    buffer_load_dwordx4 v[36:39], v3, s[8:11], s30 offen offset:3072 sc1
    s_add_u32 s62, s62, 1
    s_cmp_gt_u32 s62, 0x100000
    s_cbranch_scc1 .mg_end_1
    s_waitcnt vmcnt(2)
    v_max_u32 v18, v29, v31
    v_cmp_eq_u32 vcc, -1, v18
    s_cbranch_vccz .gr_46
    s_branch .gs_45
.gs_47:
    buffer_load_dwordx4 v[32:35], v3, s[8:11], s30 offen offset:2048 sc1
    buffer_load_dwordx4 v[36:39], v3, s[8:11], s30 offen offset:3072 sc1
    s_add_u32 s62, s62, 1
    s_cmp_gt_u32 s62, 0x100000
    s_cbranch_scc1 .mg_end_1
    s_waitcnt vmcnt(1)
    v_max_u32 v18, v33, v35
    v_cmp_eq_u32 vcc, -1, v18
    s_cbranch_vccz .gr_48
    s_branch .gs_47
.gs_49:
    buffer_load_dwordx4 v[36:39], v3, s[8:11], s30 offen offset:3072 sc1
    s_add_u32 s62, s62, 1
    s_cmp_gt_u32 s62, 0x100000
    s_cbranch_scc1 .mg_end_1
    s_waitcnt vmcnt(0)
    v_max_u32 v18, v37, v39
    v_cmp_eq_u32 vcc, -1, v18
    s_cbranch_vccz .gr_50
    s_branch .gs_49
.gs_51:
    buffer_load_dwordx4 v[24:27], v4, s[8:11], s30 offen offset:0 sc1
    buffer_load_dwordx4 v[28:31], v4, s[8:11], s30 offen offset:1024 sc1
    buffer_load_dwordx4 v[32:35], v4, s[8:11], s30 offen offset:2048 sc1
    buffer_load_dwordx4 v[36:39], v4, s[8:11], s30 offen offset:3072 sc1
    s_add_u32 s62, s62, 1
    s_cmp_gt_u32 s62, 0x100000
    s_cbranch_scc1 .mg_end_1
    s_waitcnt vmcnt(3)
    v_cmp_eq_u32 vcc, -1, v27
    s_cbranch_vccz .gr_52
    s_branch .gs_51
.gs_53:
    buffer_load_dwordx4 v[28:31], v4, s[8:11], s30 offen offset:1024 sc1
    buffer_load_dwordx4 v[32:35], v4, s[8:11], s30 offen offset:2048 sc1
    buffer_load_dwordx4 v[36:39], v4, s[8:11], s30 offen offset:3072 sc1
    s_add_u32 s62, s62, 1
    s_cmp_gt_u32 s62, 0x100000
    s_cbranch_scc1 .mg_end_1
    s_waitcnt vmcnt(2)
    v_cmp_eq_u32 vcc, -1, v31
    s_cbranch_vccz .gr_54
    s_branch .gs_53
.gs_55:
    buffer_load_dwordx4 v[32:35], v4, s[8:11], s30 offen offset:2048 sc1
    buffer_load_dwordx4 v[36:39], v4, s[8:11], s30 offen offset:3072 sc1
    s_add_u32 s62, s62, 1
    s_cmp_gt_u32 s62, 0x100000
    s_cbranch_scc1 .mg_end_1
    s_waitcnt vmcnt(1)
    v_cmp_eq_u32 vcc, -1, v35
    s_cbranch_vccz .gr_56
    s_branch .gs_55
.gs_57:
    buffer_load_dwordx4 v[36:39], v4, s[8:11], s30 offen offset:3072 sc1
    s_add_u32 s62, s62, 1
    s_cmp_gt_u32 s62, 0x100000
    s_cbranch_scc1 .mg_end_1
    s_waitcnt vmcnt(0)
    v_cmp_eq_u32 vcc, -1, v39
    s_cbranch_vccz .gr_58
    s_branch .gs_57
.pr_60:
    s_add_u32 s62, s62, 1
    s_cmp_gt_u32 s62, 0x100000
    s_cbranch_scc1 .mg_end_1
    s_branch .pl_59
.w2_17:
    s_lshl_b32 s4, s56, 6
    s_lshl_b32 s5, s53, 2
    s_add_u32 s4, s4, s5
    s_add_u32 s4, s4, 92274736
    v_mov_b32 v14, s4
    v_bfe_u32 v254, v1, 0, 6
    v_mul_u32_u24 v12, 16, v254
    v_add_u32 v12, 17920, v12
    s_mov_b32 s62, 0
.wc_61:
    buffer_load_dword v18, v40, s[20:23], 0 offen offset:32 sc1
    s_add_u32 s62, s62, 1
    s_cmp_gt_u32 s62, 0x100000
    s_cbranch_scc1 .mg_end_1
    s_waitcnt vmcnt(0)
    v_readfirstlane_b32 s4, v18
    s_cmp_lt_u32 s4, 128
    s_cbranch_scc1 .wc_61
    s_barrier
.p2align 6
.step_62:
    s_barrier
    s_setprio 3
    buffer_load_dwordx4 v[24:27], v3, s[8:11], s30 offen offset:0 sc1
    s_setprio 2
    buffer_load_dwordx4 v[28:31], v3, s[8:11], s30 offen offset:1024 sc1
    s_setprio 1
    buffer_load_dwordx4 v[32:35], v3, s[8:11], s30 offen offset:2048 sc1
    s_setprio 0
    buffer_load_dwordx4 v[36:39], v3, s[8:11], s30 offen offset:3072 sc1
    s_waitcnt vmcnt(3)
    v_max_u32 v18, v25, v27
    v_cmp_eq_u32 vcc, -1, v18
    s_cbranch_vccnz .gs_64
.gr_65:
    v_smfmac_f32_16x16x64_bf16 v[40:43], v[24:27], a[0:7], v2
    v_smfmac_f32_16x16x64_bf16 v[44:47], v[24:27], a[32:39], v2
    s_waitcnt vmcnt(2)
    v_max_u32 v18, v29, v31
    v_cmp_eq_u32 vcc, -1, v18
    v_smfmac_f32_16x16x64_bf16 v[48:51], v[24:27], a[64:71], v2
    s_cbranch_vccnz .gs_66
.gr_67:
    v_smfmac_f32_16x16x64_bf16 v[40:43], v[28:31], a[8:15], v2
    v_smfmac_f32_16x16x64_bf16 v[44:47], v[28:31], a[40:47], v2
    v_smfmac_f32_16x16x64_bf16 v[52:55], v[24:27], a[96:103], v2
    s_waitcnt vmcnt(1)
    v_max_u32 v18, v33, v35
    v_cmp_eq_u32 vcc, -1, v18
    v_smfmac_f32_16x16x64_bf16 v[48:51], v[28:31], a[72:79], v2
    s_cbranch_vccnz .gs_68
.gr_69:
    v_smfmac_f32_16x16x64_bf16 v[40:43], v[32:35], a[16:23], v2
    v_smfmac_f32_16x16x64_bf16 v[44:47], v[32:35], a[48:55], v2
    v_smfmac_f32_16x16x64_bf16 v[52:55], v[28:31], a[104:111], v2
    s_waitcnt vmcnt(0)
    v_max_u32 v18, v37, v39
    v_cmp_eq_u32 vcc, -1, v18
    v_smfmac_f32_16x16x64_bf16 v[48:51], v[32:35], a[80:87], v2
    s_cbranch_vccnz .gs_70
.gr_71:
    v_smfmac_f32_16x16x64_bf16 v[40:43], v[36:39], a[24:31], v2
    v_smfmac_f32_16x16x64_bf16 v[44:47], v[36:39], a[56:63], v2
    v_smfmac_f32_16x16x64_bf16 v[52:55], v[32:35], a[112:119], v2
    v_smfmac_f32_16x16x64_bf16 v[48:51], v[36:39], a[88:95], v2
    v_permlane32_swap_b32 v40, v44
    v_permlane32_swap_b32 v41, v45
    v_smfmac_f32_16x16x64_bf16 v[52:55], v[36:39], a[120:127], v2
    v_permlane32_swap_b32 v42, v46
    v_permlane32_swap_b32 v43, v47
    v_add_f32 v40, v40, v44
    v_add_f32 v41, v41, v45
    v_add_f32 v42, v42, v46
    v_add_f32 v43, v43, v47
    ds_write2_b32 v5, v40, v41 offset0:0 offset1:36
    ds_write2_b32 v5, v42, v43 offset0:72 offset1:108
    v_permlane32_swap_b32 v48, v52
    v_permlane32_swap_b32 v49, v53
    v_permlane32_swap_b32 v50, v54
    v_permlane32_swap_b32 v51, v55
    v_add_f32 v48, v48, v52
    v_add_f32 v49, v49, v53
    v_add_f32 v50, v50, v54
    v_add_f32 v51, v51, v55
    ds_write2_b32 v6, v48, v49 offset0:0 offset1:36
    ds_write2_b32 v6, v50, v51 offset0:72 offset1:108
    s_waitcnt lgkmcnt(2)
    s_barrier
    s_waitcnt lgkmcnt(0)
    s_barrier
    ds_read_b64 v[72:73], v9 offset:0
    ds_read_b64 v[74:75], v9 offset:1152
    ds_read_b64 v[76:77], v9 offset:2304
    ds_read_b64 v[78:79], v9 offset:3456
    s_waitcnt lgkmcnt(2)
    v_add_f32 v72, v72, v74
    v_add_f32 v73, v73, v75
    s_waitcnt lgkmcnt(0)
    v_add_f32 v76, v76, v78
    v_add_f32 v77, v77, v79
    v_add_f32 v72, v72, v76
    v_add_f32 v73, v73, v77
    v_cvt_pk_bf16_f32 v72, v72, v73
    v_min_u32 v72, 0xfffffffe, v72
    buffer_store_dword v72, v10, s[8:11], s30 offen
    v_smfmac_f32_16x16x64_bf16 v[56:59], v[24:27], a[128:135], v2
    v_smfmac_f32_16x16x64_bf16 v[60:63], v[24:27], a[160:167], v2
    v_smfmac_f32_16x16x64_bf16 v[56:59], v[28:31], a[136:143], v2
    v_smfmac_f32_16x16x64_bf16 v[60:63], v[28:31], a[168:175], v2
    v_smfmac_f32_16x16x64_bf16 v[56:59], v[32:35], a[144:151], v2
    v_smfmac_f32_16x16x64_bf16 v[60:63], v[32:35], a[176:183], v2
    v_smfmac_f32_16x16x64_bf16 v[56:59], v[36:39], a[152:159], v2
    v_smfmac_f32_16x16x64_bf16 v[60:63], v[36:39], a[184:191], v2
    ds_write_b32 v11, v72
    v_mov_b32 v40, 0
    v_mov_b32 v41, 0
    v_mov_b32 v42, 0
    v_mov_b32 v43, 0
    v_mov_b32 v44, 0
    v_mov_b32 v45, 0
    v_mov_b32 v46, 0
    v_mov_b32 v47, 0
    v_permlane32_swap_b32 v56, v60
    v_permlane32_swap_b32 v57, v61
    v_permlane32_swap_b32 v58, v62
    v_permlane32_swap_b32 v59, v63
    v_add_f32 v56, v56, v60
    v_add_f32 v57, v57, v61
    v_add_f32 v58, v58, v62
    v_add_f32 v59, v59, v63
    ds_write_b128 v8, v[56:59]
    s_waitcnt lgkmcnt(0)
    s_barrier
    s_barrier
    ds_read_b128 v[72:75], v12
    s_cmp_eq_u32 s28, 63
    s_cbranch_scc1 .fin_63
    v_mov_b32 v48, 0
    v_mov_b32 v49, 0
    v_mov_b32 v50, 0
    v_mov_b32 v51, 0
    v_mov_b32 v52, 0
    v_mov_b32 v53, 0
    v_mov_b32 v54, 0
    v_mov_b32 v55, 0
    v_mov_b32 v56, 0
    v_mov_b32 v57, 0
    v_mov_b32 v58, 0
    v_mov_b32 v59, 0
    v_mov_b32 v60, 0
    v_mov_b32 v61, 0
    v_mov_b32 v62, 0
    v_mov_b32 v63, 0
    s_barrier
    s_setprio 3
    buffer_load_dwordx4 v[24:27], v4, s[8:11], s30 offen offset:0 sc1
    s_setprio 2
    buffer_load_dwordx4 v[28:31], v4, s[8:11], s30 offen offset:1024 sc1
    s_setprio 1
    buffer_load_dwordx4 v[32:35], v4, s[8:11], s30 offen offset:2048 sc1
    s_setprio 0
    buffer_load_dwordx4 v[36:39], v4, s[8:11], s30 offen offset:3072 sc1
    s_waitcnt vmcnt(3)
    v_cmp_eq_u32 vcc, -1, v27
    s_cbranch_vccnz .gs_72
.gr_73:
    v_smfmac_f32_16x16x64_bf16 v[64:67], v[24:27], a[192:199], v2
    v_smfmac_f32_16x16x64_bf16 v[68:71], v[24:27], a[224:231], v2
    s_waitcnt vmcnt(2)
    v_cmp_eq_u32 vcc, -1, v31
    s_cbranch_vccnz .gs_74
.gr_75:
    v_smfmac_f32_16x16x64_bf16 v[64:67], v[28:31], a[200:207], v2
    v_smfmac_f32_16x16x64_bf16 v[68:71], v[28:31], a[232:239], v2
    s_waitcnt vmcnt(1)
    v_cmp_eq_u32 vcc, -1, v35
    s_cbranch_vccnz .gs_76
.gr_77:
    v_smfmac_f32_16x16x64_bf16 v[64:67], v[32:35], a[208:215], v2
    v_smfmac_f32_16x16x64_bf16 v[68:71], v[32:35], a[240:247], v2
    s_waitcnt vmcnt(0)
    v_cmp_eq_u32 vcc, -1, v39
    s_cbranch_vccnz .gs_78
.gr_79:
    v_smfmac_f32_16x16x64_bf16 v[64:67], v[36:39], a[216:223], v2
    v_smfmac_f32_16x16x64_bf16 v[68:71], v[36:39], a[248:255], v2
    s_nop 7
    v_permlane32_swap_b32 v64, v68
    v_permlane32_swap_b32 v65, v69
    v_permlane32_swap_b32 v66, v70
    v_permlane32_swap_b32 v67, v71
    v_add_f32 v64, v64, v68
    v_add_f32 v65, v65, v69
    v_add_f32 v66, v66, v70
    v_add_f32 v67, v67, v71
    ds_write2_b32 v7, v64, v65 offset0:0 offset1:36
    ds_write2_b32 v7, v66, v67 offset0:72 offset1:108
    s_waitcnt lgkmcnt(0)
    s_barrier
    buffer_store_dwordx4 v[72:75], v244, s[8:11], s41 offen sc1
    v_mov_b32 v18, s28
    s_mov_b64 exec, 1
    buffer_store_dword v18, v14, s[8:11], 0 offen sc1
    s_mov_b64 exec, -1
    v_mov_b32 v64, 0
    v_mov_b32 v65, 0
    v_mov_b32 v66, 0
    v_mov_b32 v67, 0
    v_mov_b32 v68, 0
    v_mov_b32 v69, 0
    v_mov_b32 v70, 0
    v_mov_b32 v71, 0
    s_mov_b32 s4, s30
    s_mov_b32 s30, s31
    s_mov_b32 s31, s32
    s_mov_b32 s32, s33
    s_mov_b32 s33, s4
    s_add_u32 s28, s28, 1
    s_mov_b32 s62, 0
    s_add_u32 s41, s41, 0x20000
    s_branch .step_62
.fin_63:
    s_waitcnt lgkmcnt(0)
    buffer_store_dwordx4 v[72:75], v244, s[8:11], s41 offen sc1
    s_waitcnt vmcnt(0)
    v_mov_b32 v18, 64
    s_mov_b64 exec, 1
    buffer_store_dword v18, v14, s[8:11], 0 offen sc1
    s_mov_b64 exec, -1
    s_endpgm
.gs_64:
    buffer_load_dwordx4 v[24:27], v3, s[8:11], s30 offen offset:0 sc1
    buffer_load_dwordx4 v[28:31], v3, s[8:11], s30 offen offset:1024 sc1
    buffer_load_dwordx4 v[32:35], v3, s[8:11], s30 offen offset:2048 sc1
    buffer_load_dwordx4 v[36:39], v3, s[8:11], s30 offen offset:3072 sc1
    s_add_u32 s62, s62, 1
    s_cmp_gt_u32 s62, 0x100000
    s_cbranch_scc1 .mg_end_1
    s_waitcnt vmcnt(3)
    v_max_u32 v18, v25, v27
    v_cmp_eq_u32 vcc, -1, v18
    s_cbranch_vccz .gr_65
    s_branch .gs_64
.gs_66:
    buffer_load_dwordx4 v[28:31], v3, s[8:11], s30 offen offset:1024 sc1
    buffer_load_dwordx4 v[32:35], v3, s[8:11], s30 offen offset:2048 sc1
    buffer_load_dwordx4 v[36:39], v3, s[8:11], s30 offen offset:3072 sc1
    s_add_u32 s62, s62, 1
    s_cmp_gt_u32 s62, 0x100000
    s_cbranch_scc1 .mg_end_1
    s_waitcnt vmcnt(2)
    v_max_u32 v18, v29, v31
    v_cmp_eq_u32 vcc, -1, v18
    s_cbranch_vccz .gr_67
    s_branch .gs_66
.gs_68:
    buffer_load_dwordx4 v[32:35], v3, s[8:11], s30 offen offset:2048 sc1
    buffer_load_dwordx4 v[36:39], v3, s[8:11], s30 offen offset:3072 sc1
    s_add_u32 s62, s62, 1
    s_cmp_gt_u32 s62, 0x100000
    s_cbranch_scc1 .mg_end_1
    s_waitcnt vmcnt(1)
    v_max_u32 v18, v33, v35
    v_cmp_eq_u32 vcc, -1, v18
    s_cbranch_vccz .gr_69
    s_branch .gs_68
.gs_70:
    buffer_load_dwordx4 v[36:39], v3, s[8:11], s30 offen offset:3072 sc1
    s_add_u32 s62, s62, 1
    s_cmp_gt_u32 s62, 0x100000
    s_cbranch_scc1 .mg_end_1
    s_waitcnt vmcnt(0)
    v_max_u32 v18, v37, v39
    v_cmp_eq_u32 vcc, -1, v18
    s_cbranch_vccz .gr_71
    s_branch .gs_70
.gs_72:
    buffer_load_dwordx4 v[24:27], v4, s[8:11], s30 offen offset:0 sc1
    buffer_load_dwordx4 v[28:31], v4, s[8:11], s30 offen offset:1024 sc1
    buffer_load_dwordx4 v[32:35], v4, s[8:11], s30 offen offset:2048 sc1
    buffer_load_dwordx4 v[36:39], v4, s[8:11], s30 offen offset:3072 sc1
    s_add_u32 s62, s62, 1
    s_cmp_gt_u32 s62, 0x100000
    s_cbranch_scc1 .mg_end_1
    s_waitcnt vmcnt(3)
    v_cmp_eq_u32 vcc, -1, v27
    s_cbranch_vccz .gr_73
    s_branch .gs_72
.gs_74:
    buffer_load_dwordx4 v[28:31], v4, s[8:11], s30 offen offset:1024 sc1
    buffer_load_dwordx4 v[32:35], v4, s[8:11], s30 offen offset:2048 sc1
    buffer_load_dwordx4 v[36:39], v4, s[8:11], s30 offen offset:3072 sc1
    s_add_u32 s62, s62, 1
    s_cmp_gt_u32 s62, 0x100000
    s_cbranch_scc1 .mg_end_1
    s_waitcnt vmcnt(2)
    v_cmp_eq_u32 vcc, -1, v31
    s_cbranch_vccz .gr_75
    s_branch .gs_74
.gs_76:
    buffer_load_dwordx4 v[32:35], v4, s[8:11], s30 offen offset:2048 sc1
    buffer_load_dwordx4 v[36:39], v4, s[8:11], s30 offen offset:3072 sc1
    s_add_u32 s62, s62, 1
    s_cmp_gt_u32 s62, 0x100000
    s_cbranch_scc1 .mg_end_1
    s_waitcnt vmcnt(1)
    v_cmp_eq_u32 vcc, -1, v35
    s_cbranch_vccz .gr_77
    s_branch .gs_76
.gs_78:
    buffer_load_dwordx4 v[36:39], v4, s[8:11], s30 offen offset:3072 sc1
    s_add_u32 s62, s62, 1
    s_cmp_gt_u32 s62, 0x100000
    s_cbranch_scc1 .mg_end_1
    s_waitcnt vmcnt(0)
    v_cmp_eq_u32 vcc, -1, v39
    s_cbranch_vccz .gr_79
    s_branch .gs_78
.w3_18:
    v_bfe_u32 v254, v1, 3, 1
    v_mul_u32_u24 v12, 512, v254
    v_bfe_u32 v254, v1, 5, 1
    v_mul_u32_u24 v254, 256, v254
    v_add_u32 v12, v12, v254
    v_bfe_u32 v254, v1, 2, 1
    v_mul_u32_u24 v254, 128, v254
    v_add_u32 v12, v12, v254
    v_bfe_u32 v254, v1, 0, 2
    v_mul_u32_u24 v254, 16, v254
    v_add_u32 v12, v12, v254
    v_bfe_u32 v254, v1, 4, 1
    v_mul_u32_u24 v254, 8, v254
    v_add_u32 v12, v12, v254
    v_add_u32 v12, 13824, v12
    v_bfe_u32 v254, v1, 2, 2
    v_mul_u32_u24 v14, 128, v254
    v_bfe_u32 v254, v1, 0, 2
    v_mul_u32_u24 v254, 16, v254
    v_add_u32 v14, v14, v254
    v_bfe_u32 v254, v1, 4, 2
    v_mul_u32_u24 v254, 4, v254
    v_add_u32 v14, v14, v254
    v_add_u32 v14, 18432, v14
    v_bfe_u32 v254, v1, 0, 6
    v_mul_u32_u24 v15, 16, v254
    v_add_u32 v15, s101, v15
    s_lshl_b32 s4, s56, 6
    s_add_u32 s4, s4, 92274704
    v_bfe_u32 v254, v1, 0, 3
    v_mul_u32_u24 v13, 4, v254
    v_add_u32 v13, s4, v13
    s_mov_b32 s62, 0
.wc_80:
    buffer_load_dword v18, v40, s[20:23], 0 offen offset:36 sc1
    s_add_u32 s62, s62, 1
    s_cmp_gt_u32 s62, 0x100000
    s_cbranch_scc1 .mg_end_1
    s_waitcnt vmcnt(0)
    v_readfirstlane_b32 s4, v18
    s_cmp_lt_u32 s4, 128
    s_cbranch_scc1 .wc_80
    s_cmp_ge_u32 s46, 2
    s_cbranch_scc1 .kvd_82
    s_mov_b32 s62, 0
.kv_81:
    buffer_load_dword v18, v13, s[8:11], 0 offen sc1
    s_add_u32 s62, s62, 1
    s_cmp_gt_u32 s62, 0x100000
    s_cbranch_scc1 .mg_end_1
    s_waitcnt vmcnt(0)
    v_min_u32_dpp v18, v18, v18 quad_perm:[1,0,3,2] row_mask:0xf bank_mask:0xf
    s_nop 1
    v_min_u32_dpp v18, v18, v18 quad_perm:[2,3,0,1] row_mask:0xf bank_mask:0xf
    s_nop 1
    v_min_u32_dpp v18, v18, v18 row_half_mirror row_mask:0xf bank_mask:0xf
    s_nop 0
    v_readfirstlane_b32 s46, v18
    s_cmp_lt_u32 s46, 2
    s_cbranch_scc1 .kv_81
.kvd_82:
    s_barrier
.p2align 6
.step_83:
    s_barrier
    s_setprio 3
    buffer_load_dwordx4 v[24:27], v3, s[8:11], s30 offen offset:0 sc1
    s_setprio 2
    buffer_load_dwordx4 v[28:31], v3, s[8:11], s30 offen offset:1024 sc1
    s_setprio 1
    buffer_load_dwordx4 v[32:35], v3, s[8:11], s30 offen offset:2048 sc1
    s_setprio 0
    buffer_load_dwordx4 v[36:39], v3, s[8:11], s30 offen offset:3072 sc1
    s_waitcnt vmcnt(3)
    v_max_u32 v18, v25, v27
    v_cmp_eq_u32 vcc, -1, v18
    s_cbranch_vccnz .gs_85
.gr_86:
    v_smfmac_f32_16x16x64_bf16 v[40:43], v[24:27], a[0:7], v2
    v_smfmac_f32_16x16x64_bf16 v[44:47], v[24:27], a[32:39], v2
    s_waitcnt vmcnt(2)
    v_max_u32 v18, v29, v31
    v_cmp_eq_u32 vcc, -1, v18
    v_smfmac_f32_16x16x64_bf16 v[48:51], v[24:27], a[64:71], v2
    s_cbranch_vccnz .gs_87
.gr_88:
    v_smfmac_f32_16x16x64_bf16 v[40:43], v[28:31], a[8:15], v2
    v_smfmac_f32_16x16x64_bf16 v[44:47], v[28:31], a[40:47], v2
    v_smfmac_f32_16x16x64_bf16 v[52:55], v[24:27], a[96:103], v2
    s_waitcnt vmcnt(1)
    v_max_u32 v18, v33, v35
    v_cmp_eq_u32 vcc, -1, v18
    v_smfmac_f32_16x16x64_bf16 v[48:51], v[28:31], a[72:79], v2
    s_cbranch_vccnz .gs_89
.gr_90:
    v_smfmac_f32_16x16x64_bf16 v[40:43], v[32:35], a[16:23], v2
    v_smfmac_f32_16x16x64_bf16 v[44:47], v[32:35], a[48:55], v2
    v_smfmac_f32_16x16x64_bf16 v[52:55], v[28:31], a[104:111], v2
    s_waitcnt vmcnt(0)
    v_max_u32 v18, v37, v39
    v_cmp_eq_u32 vcc, -1, v18
    v_smfmac_f32_16x16x64_bf16 v[48:51], v[32:35], a[80:87], v2
    s_cbranch_vccnz .gs_91
.gr_92:
    v_smfmac_f32_16x16x64_bf16 v[40:43], v[36:39], a[24:31], v2
    v_smfmac_f32_16x16x64_bf16 v[44:47], v[36:39], a[56:63], v2
    v_smfmac_f32_16x16x64_bf16 v[52:55], v[32:35], a[112:119], v2
    v_smfmac_f32_16x16x64_bf16 v[48:51], v[36:39], a[88:95], v2
    v_permlane32_swap_b32 v40, v44
    v_permlane32_swap_b32 v41, v45
    v_smfmac_f32_16x16x64_bf16 v[52:55], v[36:39], a[120:127], v2
    v_permlane32_swap_b32 v42, v46
    v_permlane32_swap_b32 v43, v47
    v_add_f32 v40, v40, v44
    v_add_f32 v41, v41, v45
    v_add_f32 v42, v42, v46
    v_add_f32 v43, v43, v47
    ds_write2_b32 v5, v40, v41 offset0:0 offset1:36
    ds_write2_b32 v5, v42, v43 offset0:72 offset1:108
    v_permlane32_swap_b32 v48, v52
    v_permlane32_swap_b32 v49, v53
    v_permlane32_swap_b32 v50, v54
    v_permlane32_swap_b32 v51, v55
    v_add_f32 v48, v48, v52
    v_add_f32 v49, v49, v53
    v_add_f32 v50, v50, v54
    v_add_f32 v51, v51, v55
    ds_write2_b32 v6, v48, v49 offset0:0 offset1:36
    ds_write2_b32 v6, v50, v51 offset0:72 offset1:108
    s_waitcnt lgkmcnt(2)
    s_barrier
    s_waitcnt lgkmcnt(0)
    s_barrier
    ds_read_b64 v[72:73], v9 offset:0
    ds_read_b64 v[74:75], v9 offset:1152
    ds_read_b64 v[76:77], v9 offset:2304
    ds_read_b64 v[78:79], v9 offset:3456
    s_waitcnt lgkmcnt(2)
    v_add_f32 v72, v72, v74
    v_add_f32 v73, v73, v75
    s_waitcnt lgkmcnt(0)
    v_add_f32 v76, v76, v78
    v_add_f32 v77, v77, v79
    v_add_f32 v72, v72, v76
    v_add_f32 v73, v73, v77
    v_cvt_pk_bf16_f32 v72, v72, v73
    v_min_u32 v72, 0xfffffffe, v72
    buffer_store_dword v72, v10, s[8:11], s30 offen
    v_smfmac_f32_16x16x64_bf16 v[56:59], v[24:27], a[128:135], v2
    v_smfmac_f32_16x16x64_bf16 v[60:63], v[24:27], a[160:167], v2
    v_smfmac_f32_16x16x64_bf16 v[56:59], v[28:31], a[136:143], v2
    v_smfmac_f32_16x16x64_bf16 v[60:63], v[28:31], a[168:175], v2
    v_smfmac_f32_16x16x64_bf16 v[56:59], v[32:35], a[144:151], v2
    v_smfmac_f32_16x16x64_bf16 v[60:63], v[32:35], a[176:183], v2
    v_smfmac_f32_16x16x64_bf16 v[56:59], v[36:39], a[152:159], v2
    v_smfmac_f32_16x16x64_bf16 v[60:63], v[36:39], a[184:191], v2
    ds_write_b32 v11, v72
    v_mov_b32 v40, 0
    v_mov_b32 v41, 0
    v_mov_b32 v42, 0
    v_mov_b32 v43, 0
    v_mov_b32 v44, 0
    v_mov_b32 v45, 0
    v_mov_b32 v46, 0
    v_mov_b32 v47, 0
    v_permlane32_swap_b32 v56, v60
    v_permlane32_swap_b32 v57, v61
    v_permlane32_swap_b32 v58, v62
    v_permlane32_swap_b32 v59, v63
    v_add_f32 v56, v56, v60
    v_add_f32 v57, v57, v61
    v_add_f32 v58, v58, v62
    v_add_f32 v59, v59, v63
    ds_write_b128 v8, v[56:59]
    s_waitcnt lgkmcnt(0)
    s_barrier
    ds_read_b64 v[72:73], v12 offset:0
    ds_read_b64 v[74:75], v12 offset:1024
    ds_read_b64 v[76:77], v12 offset:2048
    ds_read_b64 v[78:79], v12 offset:3072
    ds_read_b64 v[80:81], v12 offset:64
    ds_read_b64 v[82:83], v12 offset:1088
    ds_read_b64 v[84:85], v12 offset:2112
    ds_read_b64 v[86:87], v12 offset:3136
    s_waitcnt lgkmcnt(4)
    v_add_f32 v72, v72, v74
    v_add_f32 v73, v73, v75
    v_add_f32 v76, v76, v78
    v_add_f32 v77, v77, v79
    v_add_f32 v72, v72, v76
    v_add_f32 v73, v73, v77
    v_cvt_pk_bf16_f32 v72, v72, v73
    s_waitcnt lgkmcnt(0)
    v_add_f32 v80, v80, v82
    v_add_f32 v81, v81, v83
    v_add_f32 v84, v84, v86
    v_add_f32 v85, v85, v87
    v_add_f32 v80, v80, v84
    v_add_f32 v81, v81, v85
    v_cvt_pk_bf16_f32 v80, v80, v81
    ds_write_b32 v14, v72
    ds_write_b32 v14, v80 offset:64
    s_waitcnt lgkmcnt(0)
    s_barrier
    s_cmp_eq_u32 s28, 63
    s_cbranch_scc1 .fin_84
    v_mov_b32 v48, 0
    v_mov_b32 v49, 0
    v_mov_b32 v50, 0
    v_mov_b32 v51, 0
    v_mov_b32 v52, 0
    v_mov_b32 v53, 0
    v_mov_b32 v54, 0
    v_mov_b32 v55, 0
    v_mov_b32 v56, 0
    v_mov_b32 v57, 0
    v_mov_b32 v58, 0
    v_mov_b32 v59, 0
    v_mov_b32 v60, 0
    v_mov_b32 v61, 0
    v_mov_b32 v62, 0
    v_mov_b32 v63, 0
    s_barrier
    s_setprio 3
    buffer_load_dwordx4 v[24:27], v4, s[8:11], s30 offen offset:0 sc1
    s_setprio 2
    buffer_load_dwordx4 v[28:31], v4, s[8:11], s30 offen offset:1024 sc1
    s_setprio 1
    buffer_load_dwordx4 v[32:35], v4, s[8:11], s30 offen offset:2048 sc1
    s_setprio 0
    buffer_load_dwordx4 v[36:39], v4, s[8:11], s30 offen offset:3072 sc1
    s_waitcnt vmcnt(3)
    v_cmp_eq_u32 vcc, -1, v27
    s_cbranch_vccnz .gs_93
.gr_94:
    v_smfmac_f32_16x16x64_bf16 v[64:67], v[24:27], a[192:199], v2
    v_smfmac_f32_16x16x64_bf16 v[68:71], v[24:27], a[224:231], v2
    s_waitcnt vmcnt(2)
    v_cmp_eq_u32 vcc, -1, v31
    s_cbranch_vccnz .gs_95
.gr_96:
    v_smfmac_f32_16x16x64_bf16 v[64:67], v[28:31], a[200:207], v2
    v_smfmac_f32_16x16x64_bf16 v[68:71], v[28:31], a[232:239], v2
    s_waitcnt vmcnt(1)
    v_cmp_eq_u32 vcc, -1, v35
    s_cbranch_vccnz .gs_97
.gr_98:
    v_smfmac_f32_16x16x64_bf16 v[64:67], v[32:35], a[208:215], v2
    v_smfmac_f32_16x16x64_bf16 v[68:71], v[32:35], a[240:247], v2
    s_waitcnt vmcnt(0)
    v_cmp_eq_u32 vcc, -1, v39
    s_cbranch_vccnz .gs_99
.gr_100:
    v_smfmac_f32_16x16x64_bf16 v[64:67], v[36:39], a[216:223], v2
    v_smfmac_f32_16x16x64_bf16 v[68:71], v[36:39], a[248:255], v2
    s_nop 7
    v_permlane32_swap_b32 v64, v68
    v_permlane32_swap_b32 v65, v69
    v_permlane32_swap_b32 v66, v70
    v_permlane32_swap_b32 v67, v71
    v_add_f32 v64, v64, v68
    v_add_f32 v65, v65, v69
    v_add_f32 v66, v66, v70
    v_add_f32 v67, v67, v71
    ds_write2_b32 v7, v64, v65 offset0:0 offset1:36
    ds_write2_b32 v7, v66, v67 offset0:72 offset1:108
    s_waitcnt lgkmcnt(0)
    s_barrier
    buffer_store_dwordx4 v[20:23], v15, s[8:11], s36 offen sc1
    buffer_store_dwordx4 v[20:23], v244, s[8:11], s32 offen
    buffer_store_dwordx4 v[20:23], v245, s[8:11], s32 offen
    s_add_u32 s5, s28, 3
    s_min_u32 s5, s5, 64
    s_cmp_ge_u32 s46, s5
    s_cbranch_scc1 .kvd_102
    s_mov_b32 s62, 0
.kv_101:
    buffer_load_dword v18, v13, s[8:11], 0 offen sc1
    s_add_u32 s62, s62, 1
    s_cmp_gt_u32 s62, 0x100000
    s_cbranch_scc1 .mg_end_1
    s_waitcnt vmcnt(0)
    v_min_u32_dpp v18, v18, v18 quad_perm:[1,0,3,2] row_mask:0xf bank_mask:0xf
    s_nop 1
    v_min_u32_dpp v18, v18, v18 quad_perm:[2,3,0,1] row_mask:0xf bank_mask:0xf
    s_nop 1
    v_min_u32_dpp v18, v18, v18 row_half_mirror row_mask:0xf bank_mask:0xf
    s_nop 0
    v_readfirstlane_b32 s46, v18
    s_cmp_lt_u32 s46, s5
    s_cbranch_scc1 .kv_101
.kvd_102:
    v_mov_b32 v64, 0
    v_mov_b32 v65, 0
    v_mov_b32 v66, 0
    v_mov_b32 v67, 0
    v_mov_b32 v68, 0
    v_mov_b32 v69, 0
    v_mov_b32 v70, 0
    v_mov_b32 v71, 0
    s_mov_b32 s4, s30
    s_mov_b32 s30, s31
    s_mov_b32 s31, s32
    s_mov_b32 s32, s33
    s_mov_b32 s33, s4
    s_add_u32 s28, s28, 1
    s_mov_b32 s62, 0
    s_mov_b32 s4, s34
    s_mov_b32 s34, s35
    s_mov_b32 s35, s36
    s_mov_b32 s36, s37
    s_mov_b32 s37, s4
    s_add_u32 s41, s41, 0x20000
    s_branch .step_83
.fin_84:
    s_endpgm
.gs_85:
    buffer_load_dwordx4 v[24:27], v3, s[8:11], s30 offen offset:0 sc1
    buffer_load_dwordx4 v[28:31], v3, s[8:11], s30 offen offset:1024 sc1
    buffer_load_dwordx4 v[32:35], v3, s[8:11], s30 offen offset:2048 sc1
    buffer_load_dwordx4 v[36:39], v3, s[8:11], s30 offen offset:3072 sc1
    s_add_u32 s62, s62, 1
    s_cmp_gt_u32 s62, 0x100000
    s_cbranch_scc1 .mg_end_1
    s_waitcnt vmcnt(3)
    v_max_u32 v18, v25, v27
    v_cmp_eq_u32 vcc, -1, v18
    s_cbranch_vccz .gr_86
    s_branch .gs_85
.gs_87:
    buffer_load_dwordx4 v[28:31], v3, s[8:11], s30 offen offset:1024 sc1
    buffer_load_dwordx4 v[32:35], v3, s[8:11], s30 offen offset:2048 sc1
    buffer_load_dwordx4 v[36:39], v3, s[8:11], s30 offen offset:3072 sc1
    s_add_u32 s62, s62, 1
    s_cmp_gt_u32 s62, 0x100000
    s_cbranch_scc1 .mg_end_1
    s_waitcnt vmcnt(2)
    v_max_u32 v18, v29, v31
    v_cmp_eq_u32 vcc, -1, v18
    s_cbranch_vccz .gr_88
    s_branch .gs_87
.gs_89:
    buffer_load_dwordx4 v[32:35], v3, s[8:11], s30 offen offset:2048 sc1
    buffer_load_dwordx4 v[36:39], v3, s[8:11], s30 offen offset:3072 sc1
    s_add_u32 s62, s62, 1
    s_cmp_gt_u32 s62, 0x100000
    s_cbranch_scc1 .mg_end_1
    s_waitcnt vmcnt(1)
    v_max_u32 v18, v33, v35
    v_cmp_eq_u32 vcc, -1, v18
    s_cbranch_vccz .gr_90
    s_branch .gs_89
.gs_91:
    buffer_load_dwordx4 v[36:39], v3, s[8:11], s30 offen offset:3072 sc1
    s_add_u32 s62, s62, 1
    s_cmp_gt_u32 s62, 0x100000
    s_cbranch_scc1 .mg_end_1
    s_waitcnt vmcnt(0)
    v_max_u32 v18, v37, v39
    v_cmp_eq_u32 vcc, -1, v18
    s_cbranch_vccz .gr_92
    s_branch .gs_91
.gs_93:
    buffer_load_dwordx4 v[24:27], v4, s[8:11], s30 offen offset:0 sc1
    buffer_load_dwordx4 v[28:31], v4, s[8:11], s30 offen offset:1024 sc1
    buffer_load_dwordx4 v[32:35], v4, s[8:11], s30 offen offset:2048 sc1
    buffer_load_dwordx4 v[36:39], v4, s[8:11], s30 offen offset:3072 sc1
    s_add_u32 s62, s62, 1
    s_cmp_gt_u32 s62, 0x100000
    s_cbranch_scc1 .mg_end_1
    s_waitcnt vmcnt(3)
    v_cmp_eq_u32 vcc, -1, v27
    s_cbranch_vccz .gr_94
    s_branch .gs_93
.gs_95:
    buffer_load_dwordx4 v[28:31], v4, s[8:11], s30 offen offset:1024 sc1
    buffer_load_dwordx4 v[32:35], v4, s[8:11], s30 offen offset:2048 sc1
    buffer_load_dwordx4 v[36:39], v4, s[8:11], s30 offen offset:3072 sc1
    s_add_u32 s62, s62, 1
    s_cmp_gt_u32 s62, 0x100000
    s_cbranch_scc1 .mg_end_1
    s_waitcnt vmcnt(2)
    v_cmp_eq_u32 vcc, -1, v31
    s_cbranch_vccz .gr_96
    s_branch .gs_95
.gs_97:
    buffer_load_dwordx4 v[32:35], v4, s[8:11], s30 offen offset:2048 sc1
    buffer_load_dwordx4 v[36:39], v4, s[8:11], s30 offen offset:3072 sc1
    s_add_u32 s62, s62, 1
    s_cmp_gt_u32 s62, 0x100000
    s_cbranch_scc1 .mg_end_1
    s_waitcnt vmcnt(1)
    v_cmp_eq_u32 vcc, -1, v35
    s_cbranch_vccz .gr_98
    s_branch .gs_97
.gs_99:
    buffer_load_dwordx4 v[36:39], v4, s[8:11], s30 offen offset:3072 sc1
    s_add_u32 s62, s62, 1
    s_cmp_gt_u32 s62, 0x100000
    s_cbranch_scc1 .mg_end_1
    s_waitcnt vmcnt(0)
    v_cmp_eq_u32 vcc, -1, v39
    s_cbranch_vccz .gr_100
    s_branch .gs_99
.slowv_9:
    s_lshl_b32 s4, s24, 18
    s_add_u32 s4, s4, 83886080
    buffer_store_dwordx4 v[20:23], v244, s[8:11], s4 offen sc1
    s_cmp_lg_u32 s24, 0
    s_cbranch_scc1 .arm0_103
    s_mov_b32 exec_lo, 0
.arm0_103:
    buffer_store_dwordx4 v[20:23], v245, s[8:11], s4 offen sc1
    s_mov_b64 exec, -1
    buffer_store_dwordx4 v[20:23], v246, s[8:11], 0 offen offset:0 sc1
    buffer_store_dwordx4 v[20:23], v246, s[8:11], 0 offen offset:1024 sc1
    buffer_store_dwordx4 v[20:23], v246, s[8:11], 0 offen offset:2048 sc1
    buffer_store_dwordx4 v[20:23], v246, s[8:11], 0 offen offset:3072 sc1
    s_cmp_lg_u32 s24, 1
    s_cbranch_scc1 .arm1_104
    v_min_u32 v248, 0xfffffffe, v248
    v_min_u32 v249, 0xfffffffe, v249
    v_lshlrev_b32 v247, 3, v1
    s_add_u32 s4, s55, 83886080
    buffer_store_dwordx2 v[248:249], v247, s[8:11], s4 offen sc1
    s_lshl_b32 s4, s56, 6
    s_lshl_b32 s5, s53, 2
    s_add_u32 s4, s4, s5
    s_add_u32 s4, s4, 92274736
    s_mov_b64 exec, 1
    buffer_store_dword v40, v40, s[8:11], s4 offen sc1
    s_mov_b64 exec, -1
.arm1_104:
    ds_read_b64_tr_b16 a[64:65], v242 offset:16384
    ds_read_b64_tr_b16 a[66:67], v242 offset:16896
    ds_read_b64_tr_b16 a[68:69], v242 offset:18432
    ds_read_b64_tr_b16 a[70:71], v242 offset:18944
    ds_read_b64_tr_b16 a[72:73], v242 offset:20480
    ds_read_b64_tr_b16 a[74:75], v242 offset:20992
    ds_read_b64_tr_b16 a[76:77], v242 offset:22528
    ds_read_b64_tr_b16 a[78:79], v242 offset:23040
    ds_read_b64_tr_b16 a[80:81], v242 offset:24576
    ds_read_b64_tr_b16 a[82:83], v242 offset:25088
    ds_read_b64_tr_b16 a[84:85], v242 offset:26624
    ds_read_b64_tr_b16 a[86:87], v242 offset:27136
    ds_read_b64_tr_b16 a[88:89], v242 offset:28672
    ds_read_b64_tr_b16 a[90:91], v242 offset:29184
    ds_read_b64_tr_b16 a[92:93], v242 offset:30720
    ds_read_b64_tr_b16 a[94:95], v242 offset:31232
    ds_read_b64_tr_b16 a[96:97], v243 offset:16384
    ds_read_b64_tr_b16 a[98:99], v243 offset:16896
    ds_read_b64_tr_b16 a[100:101], v243 offset:18432
    ds_read_b64_tr_b16 a[102:103], v243 offset:18944
    ds_read_b64_tr_b16 a[104:105], v243 offset:20480
    ds_read_b64_tr_b16 a[106:107], v243 offset:20992
    ds_read_b64_tr_b16 a[108:109], v243 offset:22528
    ds_read_b64_tr_b16 a[110:111], v243 offset:23040
    ds_read_b64_tr_b16 a[112:113], v243 offset:24576
    ds_read_b64_tr_b16 a[114:115], v243 offset:25088
    ds_read_b64_tr_b16 a[116:117], v243 offset:26624
    ds_read_b64_tr_b16 a[118:119], v243 offset:27136
    ds_read_b64_tr_b16 a[120:121], v243 offset:28672
    ds_read_b64_tr_b16 a[122:123], v243 offset:29184
    ds_read_b64_tr_b16 a[124:125], v243 offset:30720
    ds_read_b64_tr_b16 a[126:127], v243 offset:31232
    s_waitcnt lgkmcnt(0)
    s_mov_b32 s16, s90
    s_and_b32 s17, s91, 0xffff
    s_mov_b32 s18, 0x800000
    s_mov_b32 s19, 0x00020000
    s_add_u32 m0, s6, 16384
    s_mov_b32 s5, 0
    buffer_load_dwordx4 v241, s[16:19], s5 offen lds
    s_add_u32 m0, s6, 17408
    s_mov_b32 s5, 32768
    buffer_load_dwordx4 v241, s[16:19], s5 offen lds
    s_add_u32 m0, s6, 18432
    s_mov_b32 s5, 65536
    buffer_load_dwordx4 v241, s[16:19], s5 offen lds
    s_add_u32 m0, s6, 19456
    s_mov_b32 s5, 98304
    buffer_load_dwordx4 v241, s[16:19], s5 offen lds
    s_add_u32 m0, s6, 20480
    s_mov_b32 s5, 131072
    buffer_load_dwordx4 v241, s[16:19], s5 offen lds
    s_add_u32 m0, s6, 21504
    s_mov_b32 s5, 163840
    buffer_load_dwordx4 v241, s[16:19], s5 offen lds
    s_add_u32 m0, s6, 22528
    s_mov_b32 s5, 196608
    buffer_load_dwordx4 v241, s[16:19], s5 offen lds
    s_add_u32 m0, s6, 23552
    s_mov_b32 s5, 229376
    buffer_load_dwordx4 v241, s[16:19], s5 offen lds
    s_add_u32 m0, s6, 24576
    s_mov_b32 s5, 262144
    buffer_load_dwordx4 v241, s[16:19], s5 offen lds
    s_add_u32 m0, s6, 25600
    s_mov_b32 s5, 294912
    buffer_load_dwordx4 v241, s[16:19], s5 offen lds
    s_add_u32 m0, s6, 26624
    s_mov_b32 s5, 327680
    buffer_load_dwordx4 v241, s[16:19], s5 offen lds
    s_add_u32 m0, s6, 27648
    s_mov_b32 s5, 360448
    buffer_load_dwordx4 v241, s[16:19], s5 offen lds
    s_add_u32 m0, s6, 28672
    s_mov_b32 s5, 393216
    buffer_load_dwordx4 v241, s[16:19], s5 offen lds
    s_add_u32 m0, s6, 29696
    s_mov_b32 s5, 425984
    buffer_load_dwordx4 v241, s[16:19], s5 offen lds
    s_add_u32 m0, s6, 30720
    s_mov_b32 s5, 458752
    buffer_load_dwordx4 v241, s[16:19], s5 offen lds
    s_add_u32 m0, s6, 31744
    s_mov_b32 s5, 491520
    buffer_load_dwordx4 v241, s[16:19], s5 offen lds
    s_waitcnt vmcnt(16)
    s_barrier
    s_cmp_lg_u32 s24, 0
    s_cbranch_scc1 .sg_105
    s_mov_b64 exec, 1
    v_mov_b32 v18, 1
    buffer_atomic_add v18, v40, s[20:23], 0 offen offset:32 sc1
    s_mov_b64 exec, -1
.sg_105:
    ds_read_b64_tr_b16 a[128:129], v242 offset:0
    ds_read_b64_tr_b16 a[130:131], v242 offset:512
    ds_read_b64_tr_b16 a[132:133], v242 offset:2048
    ds_read_b64_tr_b16 a[134:135], v242 offset:2560
    ds_read_b64_tr_b16 a[136:137], v242 offset:4096
    ds_read_b64_tr_b16 a[138:139], v242 offset:4608
    ds_read_b64_tr_b16 a[140:141], v242 offset:6144
    ds_read_b64_tr_b16 a[142:143], v242 offset:6656
    ds_read_b64_tr_b16 a[144:145], v242 offset:8192
    ds_read_b64_tr_b16 a[146:147], v242 offset:8704
    ds_read_b64_tr_b16 a[148:149], v242 offset:10240
    ds_read_b64_tr_b16 a[150:151], v242 offset:10752
    ds_read_b64_tr_b16 a[152:153], v242 offset:12288
    ds_read_b64_tr_b16 a[154:155], v242 offset:12800
    ds_read_b64_tr_b16 a[156:157], v242 offset:14336
    ds_read_b64_tr_b16 a[158:159], v242 offset:14848
    ds_read_b64_tr_b16 a[160:161], v243 offset:0
    ds_read_b64_tr_b16 a[162:163], v243 offset:512
    ds_read_b64_tr_b16 a[164:165], v243 offset:2048
    ds_read_b64_tr_b16 a[166:167], v243 offset:2560
    ds_read_b64_tr_b16 a[168:169], v243 offset:4096
    ds_read_b64_tr_b16 a[170:171], v243 offset:4608
    ds_read_b64_tr_b16 a[172:173], v243 offset:6144
    ds_read_b64_tr_b16 a[174:175], v243 offset:6656
    ds_read_b64_tr_b16 a[176:177], v243 offset:8192
    ds_read_b64_tr_b16 a[178:179], v243 offset:8704
    ds_read_b64_tr_b16 a[180:181], v243 offset:10240
    ds_read_b64_tr_b16 a[182:183], v243 offset:10752
    ds_read_b64_tr_b16 a[184:185], v243 offset:12288
    ds_read_b64_tr_b16 a[186:187], v243 offset:12800
    ds_read_b64_tr_b16 a[188:189], v243 offset:14336
    ds_read_b64_tr_b16 a[190:191], v243 offset:14848
    s_waitcnt lgkmcnt(0)
    s_mov_b32 s47, 0
    s_cmp_lg_u32 s27, 0
    s_cbranch_scc1 .cd_107
    v_and_b32 v18, 15, v1
    v_lshlrev_b32 v18, 1, v18
    s_mov_b32 s62, 0
.cp_106:
    buffer_load_ushort v19, v18, s[20:23], 0 offen offset:64 sc1
    s_add_u32 s62, s62, 1
    s_cmp_gt_u32 s62, 0x100000
    s_cbranch_scc1 .mg_end_1
    s_waitcnt vmcnt(0)
    v_cmp_eq_u32 vcc, 0, v19
    s_cbranch_vccnz .cp_106
    v_readlane_b32 s66, v19, 0
    v_readlane_b32 s67, v19, 1
    v_readlane_b32 s68, v19, 2
    v_readlane_b32 s69, v19, 3
    v_readlane_b32 s70, v19, 4
    v_readlane_b32 s71, v19, 5
    v_readlane_b32 s72, v19, 6
    v_readlane_b32 s73, v19, 7
    v_readlane_b32 s74, v19, 8
    v_readlane_b32 s75, v19, 9
    v_readlane_b32 s76, v19, 10
    v_readlane_b32 s77, v19, 11
    v_readlane_b32 s78, v19, 12
    v_readlane_b32 s79, v19, 13
    v_readlane_b32 s80, v19, 14
    v_readlane_b32 s81, v19, 15
    s_nop 3
    s_add_u32 s4, s66, s67
    s_add_u32 s4, s4, s68
    s_add_u32 s4, s4, s69
    s_add_u32 s4, s4, s74
    s_add_u32 s4, s4, s75
    s_add_u32 s4, s4, s76
    s_add_u32 s4, s4, s77
    s_add_u32 s5, s70, s71
    s_add_u32 s5, s5, s72
    s_add_u32 s5, s5, s73
    s_add_u32 s5, s5, s78
    s_add_u32 s5, s5, s79
    s_add_u32 s5, s5, s80
    s_add_u32 s5, s5, s81
    s_cmp_lt_u32 s5, s4
    s_cselect_b32 s47, 0x2000, 0
    s_cselect_b32 s66, s70, s66
    s_cselect_b32 s67, s71, s67
    s_cselect_b32 s68, s72, s68
    s_cselect_b32 s69, s73, s69
    s_cselect_b32 s74, s78, s74
    s_cselect_b32 s75, s79, s75
    s_cselect_b32 s76, s80, s76
    s_cselect_b32 s77, s81, s77
    s_add_u32 s4, s66, s68
    s_add_u32 s4, s4, s74
    s_add_u32 s4, s4, s76
    s_add_u32 s5, s67, s69
    s_add_u32 s5, s5, s75
    s_add_u32 s5, s5, s77
    s_cmp_lt_u32 s5, s4
    s_cselect_b32 s4, 2048, 0
    s_or_b32 s47, s47, s4
    s_add_u32 s4, s66, s67
    s_add_u32 s4, s4, s74
    s_add_u32 s4, s4, s75
    s_add_u32 s5, s68, s69
    s_add_u32 s5, s5, s76
    s_add_u32 s5, s5, s77
    s_cmp_lt_u32 s5, s4
    s_cselect_b32 s4, 4096, 0
    s_or_b32 s47, s47, s4
    s_add_u32 s4, s66, s67
    s_add_u32 s4, s4, s68
    s_add_u32 s4, s4, s69
    s_add_u32 s5, s74, s75
    s_add_u32 s5, s5, s76
    s_add_u32 s5, s5, s77
    s_cmp_lt_u32 s5, s4
    s_cselect_b32 s4, 16384, 0
    s_or_b32 s47, s47, s4
.cd_107:
    s_waitcnt vmcnt(0)
    ds_read_b64_tr_b16 a[192:193], v242 offset:16384
    ds_read_b64_tr_b16 a[194:195], v242 offset:16896
    ds_read_b64_tr_b16 a[196:197], v242 offset:18432
    ds_read_b64_tr_b16 a[198:199], v242 offset:18944
    ds_read_b64_tr_b16 a[200:201], v242 offset:20480
    ds_read_b64_tr_b16 a[202:203], v242 offset:20992
    ds_read_b64_tr_b16 a[204:205], v242 offset:22528
    ds_read_b64_tr_b16 a[206:207], v242 offset:23040
    ds_read_b64_tr_b16 a[208:209], v242 offset:24576
    ds_read_b64_tr_b16 a[210:211], v242 offset:25088
    ds_read_b64_tr_b16 a[212:213], v242 offset:26624
    ds_read_b64_tr_b16 a[214:215], v242 offset:27136
    ds_read_b64_tr_b16 a[216:217], v242 offset:28672
    ds_read_b64_tr_b16 a[218:219], v242 offset:29184
    ds_read_b64_tr_b16 a[220:221], v242 offset:30720
    ds_read_b64_tr_b16 a[222:223], v242 offset:31232
    ds_read_b64_tr_b16 a[224:225], v243 offset:16384
    ds_read_b64_tr_b16 a[226:227], v243 offset:16896
    ds_read_b64_tr_b16 a[228:229], v243 offset:18432
    ds_read_b64_tr_b16 a[230:231], v243 offset:18944
    ds_read_b64_tr_b16 a[232:233], v243 offset:20480
    ds_read_b64_tr_b16 a[234:235], v243 offset:20992
    ds_read_b64_tr_b16 a[236:237], v243 offset:22528
    ds_read_b64_tr_b16 a[238:239], v243 offset:23040
    ds_read_b64_tr_b16 a[240:241], v243 offset:24576
    ds_read_b64_tr_b16 a[242:243], v243 offset:25088
    ds_read_b64_tr_b16 a[244:245], v243 offset:26624
    ds_read_b64_tr_b16 a[246:247], v243 offset:27136
    ds_read_b64_tr_b16 a[248:249], v243 offset:28672
    ds_read_b64_tr_b16 a[250:251], v243 offset:29184
    ds_read_b64_tr_b16 a[252:253], v243 offset:30720
    ds_read_b64_tr_b16 a[254:255], v243 offset:31232
    s_waitcnt lgkmcnt(0)
    s_mov_b32 s28, 0
    s_mov_b32 s30, 83886080
    s_mov_b32 s31, 84148224
    s_mov_b32 s32, 84410368
    s_mov_b32 s33, 84672512
    s_mov_b32 s41, 66977792
    s_lshl_b32 s42, s56, 13
    s_lshl_b32 s4, s53, 11
    s_add_u32 s44, s42, s4
    s_add_u32 s44, s44, 33554432
    s_add_u32 s42, s42, 16777216
    s_add_u32 s43, s42, 4096
    s_add_u32 s96, s44, 524288
    s_sub_u32 s95, s96, 16777216
    s_mov_b32 s62, 0
    s_mov_b32 s45, 0x3e0293ee
    s_mov_b32 s46, 0
    s_and_b32 s4, s25, 1
    s_lshl_b32 s4, s4, 14
    s_lshr_b32 s5, s25, 1
    s_lshl_b32 s5, s5, 12
    s_or_b32 s4, s4, s5
    s_xor_b32 s47, s47, s4
    s_and_b32 s5, s26, 1
    s_lshl_b32 s5, s5, 10
    s_lshr_b32 s4, s26, 1
    s_lshl_b32 s4, s4, 15
    s_or_b32 s5, s5, s4
    s_bfe_u32 s4, s26, 0x10004
    s_lshl_b32 s4, s4, 11
    s_xor_b32 s5, s5, s4
    s_xor_b32 s34, s5, s47
    s_xor_b32 s35, s34, 0x84000
    s_xor_b32 s36, s34, 0x101000
    s_xor_b32 s37, s34, 0x185000
    s_cmp_eq_u32 s24, 1
    s_cbranch_scc1 .w1_109
    s_cmp_eq_u32 s24, 2
    s_cbranch_scc1 .w2_110
    s_cmp_eq_u32 s24, 3
    s_cbranch_scc1 .w3_111
.w0_108:
    v_bfe_u32 v254, v1, 4, 2
    v_mul_u32_u24 v12, 128, v254
    v_bfe_u32 v254, v1, 0, 3
    v_mul_u32_u24 v254, 16, v254
    v_add_u32 v12, v12, v254
    v_add_u32 v12, 131072, v12
    v_add_u32 v12, s57, v12
    v_bfe_u32 v254, v1, 4, 2
    v_mul_u32_u24 v13, 128, v254
    v_bfe_u32 v254, v1, 2, 2
    v_mul_u32_u24 v254, 32, v254
    v_add_u32 v13, v13, v254
    v_bfe_u32 v254, v1, 0, 1
    v_mul_u32_u24 v254, 16, v254
    v_add_u32 v13, v13, v254
    v_add_u32 v13, 133120, v13
    v_add_u32 v13, s57, v13
    v_bfe_u32 v254, v1, 4, 2
    v_mul_u32_u24 v14, 128, v254
    v_bfe_u32 v254, v1, 0, 4
    v_mul_u32_u24 v254, 16, v254
    v_add_u32 v14, v14, v254
    v_add_u32 v14, 65536, v14
    v_add_u32 v14, s55, v14
    v_bfe_u32 v254, v1, 0, 6
    v_mul_u32_u24 v15, 16, v254
    v_bfe_u32 v254, v1, 2, 2
    v_mul_u32_u24 v16, 128, v254
    v_bfe_u32 v254, v1, 0, 2
    v_mul_u32_u24 v254, 16, v254
    v_add_u32 v16, v16, v254
    v_bfe_u32 v254, v1, 4, 2
    v_mul_u32_u24 v254, 4, v254
    v_add_u32 v16, v16, v254
    v_add_u32 v16, 18432, v16
    v_mov_b32 v144, 0
    v_mov_b32 v145, 0
    v_mov_b32 v146, 0
    v_mov_b32 v147, 0
    v_mov_b32 v148, 0
    v_mov_b32 v149, 0
    v_mov_b32 v150, 0
    v_mov_b32 v151, 0
    v_mov_b32 v152, 0
    v_mov_b32 v153, 0
    v_mov_b32 v154, 0
    v_mov_b32 v155, 0
    v_mov_b32 v156, 0
    v_mov_b32 v157, 0
    v_mov_b32 v158, 0
    v_mov_b32 v159, 0
    v_mov_b32 v160, 0
    v_mov_b32 v161, 0
    v_mov_b32 v162, 0
    v_mov_b32 v163, 0
    v_mov_b32 v164, 0
    v_mov_b32 v165, 0
    v_mov_b32 v166, 0
    v_mov_b32 v167, 0
    v_mov_b32 v168, 0
    v_mov_b32 v169, 0
    v_mov_b32 v170, 0
    v_mov_b32 v171, 0
    v_mov_b32 v172, 0
    v_mov_b32 v173, 0
    v_mov_b32 v174, 0
    v_mov_b32 v175, 0
    v_mov_b32 v208, 0
    v_mov_b32 v209, 0
    v_mov_b32 v210, 0
    v_mov_b32 v211, 0
    v_mov_b32 v212, 0
    v_mov_b32 v213, 0
    v_mov_b32 v214, 0
    v_mov_b32 v215, 0
    v_mov_b32 v216, 0
    v_mov_b32 v217, 0
    v_mov_b32 v218, 0
    v_mov_b32 v219, 0
    v_mov_b32 v18, 0xff800000
    v_cndmask_b32 v200, v18, 0, s[48:49]
    v_mov_b32 v220, 0x3f803f80
    v_cndmask_b32 v201, v18, 0, s[48:49]
    v_mov_b32 v221, 0x3f803f80
    v_cndmask_b32 v202, v18, 0, s[48:49]
    v_mov_b32 v222, 0x3f803f80
    v_cndmask_b32 v203, v18, 0, s[48:49]
    v_mov_b32 v223, 0x3f803f80
    s_barrier
    buffer_load_dwordx4 v[104:107], v15, s[8:11], s42 offen offset:0
    buffer_load_dwordx4 v[108:111], v15, s[8:11], s42 offen offset:1024
    buffer_load_dwordx4 v[112:115], v15, s[8:11], s42 offen offset:2048
    buffer_load_dwordx4 v[116:119], v15, s[8:11], s42 offen offset:3072
    buffer_load_dwordx4 v[120:123], v15, s[8:11], s43 offen offset:0
    buffer_load_dwordx4 v[124:127], v15, s[8:11], s43 offen offset:1024
    buffer_load_dwordx4 v[128:131], v15, s[8:11], s43 offen offset:2048
    buffer_load_dwordx4 v[132:135], v15, s[8:11], s43 offen offset:3072
    buffer_load_dwordx4 v[136:139], v15, s[8:11], s44 offen offset:0
    buffer_load_dwordx4 v[140:143], v15, s[8:11], s44 offen offset:1024
    s_add_u32 s42, s42, 262144
    s_add_u32 s43, s43, 262144
    s_add_u32 s44, s44, 262144
.p2align 6
.step_112:
    s_barrier
    s_setprio 3
    buffer_load_dwordx4 v[24:27], v3, s[8:11], s30 offen offset:0 sc1
    s_setprio 2
    buffer_load_dwordx4 v[28:31], v3, s[8:11], s30 offen offset:1024 sc1
    s_setprio 1
    buffer_load_dwordx4 v[32:35], v3, s[8:11], s30 offen offset:2048 sc1
    s_setprio 0
    buffer_load_dwordx4 v[36:39], v3, s[8:11], s30 offen offset:3072 sc1
    s_waitcnt vmcnt(3)
    v_max_u32 v18, v25, v27
    v_cmp_eq_u32 vcc, -1, v18
    s_cbranch_vccnz .gs_114
.gr_115:
    v_smfmac_f32_16x16x64_bf16 v[40:43], v[24:27], a[0:7], v2
    v_smfmac_f32_16x16x64_bf16 v[44:47], v[24:27], a[32:39], v2
    s_waitcnt vmcnt(2)
    v_max_u32 v18, v29, v31
    v_cmp_eq_u32 vcc, -1, v18
    v_smfmac_f32_16x16x64_bf16 v[48:51], v[24:27], a[64:71], v2
    s_cbranch_vccnz .gs_116
.gr_117:
    v_smfmac_f32_16x16x64_bf16 v[40:43], v[28:31], a[8:15], v2
    v_smfmac_f32_16x16x64_bf16 v[44:47], v[28:31], a[40:47], v2
    v_smfmac_f32_16x16x64_bf16 v[52:55], v[24:27], a[96:103], v2
    s_waitcnt vmcnt(1)
    v_max_u32 v18, v33, v35
    v_cmp_eq_u32 vcc, -1, v18
    v_smfmac_f32_16x16x64_bf16 v[48:51], v[28:31], a[72:79], v2
    s_cbranch_vccnz .gs_118
.gr_119:
    v_smfmac_f32_16x16x64_bf16 v[40:43], v[32:35], a[16:23], v2
    v_smfmac_f32_16x16x64_bf16 v[44:47], v[32:35], a[48:55], v2
    v_smfmac_f32_16x16x64_bf16 v[52:55], v[28:31], a[104:111], v2
    s_waitcnt vmcnt(0)
    v_max_u32 v18, v37, v39
    v_cmp_eq_u32 vcc, -1, v18
    v_smfmac_f32_16x16x64_bf16 v[48:51], v[32:35], a[80:87], v2
    s_cbranch_vccnz .gs_120
.gr_121:
    v_smfmac_f32_16x16x64_bf16 v[40:43], v[36:39], a[24:31], v2
    v_smfmac_f32_16x16x64_bf16 v[44:47], v[36:39], a[56:63], v2
    v_smfmac_f32_16x16x64_bf16 v[52:55], v[32:35], a[112:119], v2
    v_smfmac_f32_16x16x64_bf16 v[48:51], v[36:39], a[88:95], v2
    v_permlane32_swap_b32 v40, v44
    v_permlane32_swap_b32 v41, v45
    v_smfmac_f32_16x16x64_bf16 v[52:55], v[36:39], a[120:127], v2
    v_permlane32_swap_b32 v42, v46
    v_permlane32_swap_b32 v43, v47
    v_add_f32 v40, v40, v44
    v_add_f32 v41, v41, v45
    v_add_f32 v42, v42, v46
    v_add_f32 v43, v43, v47
    ds_write2_b32 v5, v40, v41 offset0:0 offset1:36
    ds_write2_b32 v5, v42, v43 offset0:72 offset1:108
    v_permlane32_swap_b32 v48, v52
    v_permlane32_swap_b32 v49, v53
    v_permlane32_swap_b32 v50, v54
    v_permlane32_swap_b32 v51, v55
    v_add_f32 v48, v48, v52
    v_add_f32 v49, v49, v53
    v_add_f32 v50, v50, v54
    v_add_f32 v51, v51, v55
    ds_write2_b32 v6, v48, v49 offset0:0 offset1:36
    ds_write2_b32 v6, v50, v51 offset0:72 offset1:108
    s_waitcnt lgkmcnt(2)
    s_barrier
    ds_read_b64 v[72:73], v9 offset:0
    ds_read_b64 v[74:75], v9 offset:1152
    ds_read_b64 v[76:77], v9 offset:2304
    ds_read_b64 v[78:79], v9 offset:3456
    s_waitcnt lgkmcnt(4)
    s_barrier
    s_waitcnt lgkmcnt(2)
    v_add_f32 v72, v72, v74
    v_add_f32 v73, v73, v75
    s_waitcnt lgkmcnt(0)
    v_add_f32 v76, v76, v78
    v_add_f32 v77, v77, v79
    v_add_f32 v72, v72, v76
    v_add_f32 v73, v73, v77
    v_cvt_pk_bf16_f32 v72, v72, v73
    v_min_u32 v72, 0xfffffffe, v72
    buffer_store_dword v72, v10, s[8:11], s30 offen sc1
    v_smfmac_f32_16x16x64_bf16 v[56:59], v[24:27], a[128:135], v2
    v_smfmac_f32_16x16x64_bf16 v[60:63], v[24:27], a[160:167], v2
    v_smfmac_f32_16x16x64_bf16 v[56:59], v[28:31], a[136:143], v2
    v_smfmac_f32_16x16x64_bf16 v[60:63], v[28:31], a[168:175], v2
    v_smfmac_f32_16x16x64_bf16 v[56:59], v[32:35], a[144:151], v2
    v_smfmac_f32_16x16x64_bf16 v[60:63], v[32:35], a[176:183], v2
    v_smfmac_f32_16x16x64_bf16 v[56:59], v[36:39], a[152:159], v2
    v_smfmac_f32_16x16x64_bf16 v[60:63], v[36:39], a[184:191], v2
    v_mov_b32 v40, 0
    v_mov_b32 v41, 0
    v_mov_b32 v42, 0
    v_mov_b32 v43, 0
    v_mov_b32 v44, 0
    v_mov_b32 v45, 0
    v_mov_b32 v46, 0
    v_mov_b32 v47, 0
    v_permlane32_swap_b32 v56, v60
    v_permlane32_swap_b32 v57, v61
    v_permlane32_swap_b32 v58, v62
    v_permlane32_swap_b32 v59, v63
    v_add_f32 v56, v56, v60
    v_add_f32 v57, v57, v61
    v_add_f32 v58, v58, v62
    v_add_f32 v59, v59, v63
    ds_write_b128 v8, v[56:59]
    s_cmp_eq_u32 s28, 63
    s_cbranch_scc1 .fin_113
    s_waitcnt vmcnt(0)
    s_mov_b64 exec, s[48:49]
    buffer_load_dwordx4 v[144:147], v12, s[8:11], s30 offen offset:0 sc1
    buffer_load_dwordx4 v[148:151], v12, s[8:11], s30 offen offset:512 sc1
    buffer_load_dwordx4 v[152:155], v12, s[8:11], s30 offen offset:1024 sc1
    buffer_load_dwordx4 v[156:159], v12, s[8:11], s30 offen offset:1536 sc1
    s_mov_b64 exec, s[50:51]
    buffer_load_dwordx4 v[160:163], v12, s[8:11], s30 offen offset:0 sc1
    buffer_load_dwordx4 v[164:167], v12, s[8:11], s30 offen offset:512 sc1
    buffer_load_dwordx4 v[168:171], v12, s[8:11], s30 offen offset:1024 sc1
    buffer_load_dwordx4 v[172:175], v12, s[8:11], s30 offen offset:1536 sc1
    s_mov_b64 exec, -1
    buffer_load_dwordx4 v[176:179], v13, s[8:11], s30 offen offset:0 sc1
    buffer_load_dwordx4 v[180:183], v13, s[8:11], s30 offen offset:512 sc1
    buffer_load_dwordx4 v[184:187], v13, s[8:11], s30 offen offset:1024 sc1
    buffer_load_dwordx4 v[188:191], v13, s[8:11], s30 offen offset:1536 sc1
    s_waitcnt lgkmcnt(0)
    s_barrier
.mf_122:
    s_waitcnt vmcnt(11)
    v_mfma_f32_16x16x32_bf16 v[192:195], v[104:107], v[144:147], 0
    v_max3_u32 v18, v144, v145, v146
    v_max_u32 v18, v18, v147
    s_waitcnt vmcnt(10)
    v_mfma_f32_16x16x32_bf16 v[192:195], v[108:111], v[148:151], v[192:195]
    v_max3_u32 v18, v18, v148, v149
    v_max3_u32 v18, v18, v150, v151
    s_waitcnt vmcnt(9)
    v_mfma_f32_16x16x32_bf16 v[192:195], v[112:115], v[152:155], v[192:195]
    v_max3_u32 v18, v18, v152, v153
    v_max3_u32 v18, v18, v154, v155
    s_waitcnt vmcnt(8)
    v_mfma_f32_16x16x32_bf16 v[192:195], v[116:119], v[156:159], v[192:195]
    v_max3_u32 v18, v18, v156, v157
    v_max3_u32 v18, v18, v158, v159
    s_waitcnt vmcnt(7)
    v_mfma_f32_16x16x32_bf16 v[192:195], v[120:123], v[160:163], v[192:195]
    v_cmp_eq_u32 vcc, -1, v18
    s_waitcnt vmcnt(6)
    v_mfma_f32_16x16x32_bf16 v[192:195], v[124:127], v[164:167], v[192:195]
    s_cbranch_vccnz .re_123
    s_waitcnt vmcnt(5)
    v_mfma_f32_16x16x32_bf16 v[192:195], v[128:131], v[168:171], v[192:195]
    s_waitcnt vmcnt(4)
    v_mfma_f32_16x16x32_bf16 v[192:195], v[132:135], v[172:175], v[192:195]
.mk_124:
    s_waitcnt vmcnt(3)
    v_mfma_f32_16x16x32_bf16 v[196:199], v[176:179], v[144:147], v[200:203]
    v_max3_u32 v18, v176, v177, v178
    v_max_u32 v18, v18, v179
    s_waitcnt vmcnt(2)
    v_mfma_f32_16x16x32_bf16 v[196:199], v[180:183], v[148:151], v[196:199]
    v_max3_u32 v18, v18, v180, v181
    v_max3_u32 v18, v18, v182, v183
    s_waitcnt vmcnt(1)
    v_mfma_f32_16x16x32_bf16 v[196:199], v[184:187], v[152:155], v[196:199]
    v_max3_u32 v18, v18, v184, v185
    v_max3_u32 v18, v18, v186, v187
    s_waitcnt vmcnt(0)
    v_mfma_f32_16x16x32_bf16 v[196:199], v[188:191], v[156:159], v[196:199]
    v_max3_u32 v18, v18, v188, v189
    v_max3_u32 v18, v18, v190, v191
    v_cmp_eq_u32 vcc, -1, v18
    v_max3_f32 v19, v192, v193, v194
    s_cbranch_vccnz .rk_125
    s_barrier
    ds_read_b32 v212, v16
    ds_read_b32 v216, v16 offset:64
    v_max3_f32 v18, v195, v196, v197
    v_max_f32 v18, v18, v19
    s_nop 1
    v_max_f32_dpp v19, v18, v18 row_ror:8 row_mask:0xf bank_mask:0xf
    v_max_f32_dpp v17, v18, v18 row_ror:8 row_mask:0xf bank_mask:0xf
    s_nop 1
    v_permlane16_swap_b32 v19, v17
    v_max_f32 v18, v19, v17
    v_max_f32 v19, v19, v17
    s_nop 1
    v_permlane32_swap_b32 v18, v19
    v_max_f32 v18, v18, v19
    v_mul_f32 v18, s45, v18
    v_fma_f32 v240, v192, s45, -v18
    v_fma_f32 v241, v193, s45, -v18
    v_fma_f32 v242, v194, s45, -v18
    v_fma_f32 v243, v195, s45, -v18
    v_fma_f32 v244, v196, s45, -v18
    v_fma_f32 v245, v197, s45, -v18
    v_exp_f32 v240, v240
    v_exp_f32 v241, v241
    v_exp_f32 v242, v242
    v_exp_f32 v243, v243
    v_exp_f32 v244, v244
    v_exp_f32 v245, v245
    v_cvt_pk_bf16_f32 v204, v240, v241
    v_cvt_pk_bf16_f32 v205, v242, v243
    v_cvt_pk_bf16_f32 v208, v244, v245
    s_waitcnt lgkmcnt(0)
    v_mov_b32_dpp v206, v204 row_ror:8 row_mask:0xf bank_mask:0xf
    v_mov_b32_dpp v207, v205 row_ror:8 row_mask:0xf bank_mask:0xf
    v_mfma_f32_16x16x32_bf16 v[224:227], v[220:223], v[208:211], 0
    v_mfma_f32_16x16x32_bf16 v[224:227], v[220:223], v[204:207], v[224:227]
    v_mfma_f32_16x16x32_bf16 v[228:231], v[212:215], v[208:211], 0
    v_mfma_f32_16x16x32_bf16 v[228:231], v[136:139], v[204:207], v[228:231]
    v_mfma_f32_16x16x32_bf16 v[232:235], v[216:219], v[208:211], 0
    v_rcp_f32 v18, v224
    v_mfma_f32_16x16x32_bf16 v[232:235], v[140:143], v[204:207], v[232:235]
    s_mov_b64 exec, s[48:49]
    v_mul_f32 v228, v18, v228
    v_mul_f32 v229, v18, v229
    v_mul_f32 v230, v18, v230
    v_mul_f32 v231, v18, v231
    v_cvt_pk_bf16_f32 v236, v228, v229
    v_cvt_pk_bf16_f32 v237, v230, v231
    s_nop 1
    v_mul_f32 v232, v18, v232
    v_mul_f32 v233, v18, v233
    v_mul_f32 v234, v18, v234
    v_mul_f32 v235, v18, v235
    v_cvt_pk_bf16_f32 v238, v232, v233
    v_cvt_pk_bf16_f32 v239, v234, v235
    v_min_u32 v239, 0xfffffffe, v239
    buffer_store_dwordx4 v[236:239], v14, s[8:11], s30 offen sc1
    s_mov_b64 exec, -1
    v_mov_b32 v48, 0
    v_mov_b32 v49, 0
    v_mov_b32 v50, 0
    v_mov_b32 v51, 0
    v_mov_b32 v52, 0
    v_mov_b32 v53, 0
    v_mov_b32 v54, 0
    v_mov_b32 v55, 0
    v_mov_b32 v56, 0
    v_mov_b32 v57, 0
    v_mov_b32 v58, 0
    v_mov_b32 v59, 0
    v_mov_b32 v60, 0
    v_mov_b32 v61, 0
    v_mov_b32 v62, 0
    v_mov_b32 v63, 0
    s_waitcnt vmcnt(0)
    s_barrier
    s_setprio 3
    buffer_load_dwordx4 v[24:27], v4, s[8:11], s30 offen offset:0 sc1
    s_setprio 2
    buffer_load_dwordx4 v[28:31], v4, s[8:11], s30 offen offset:1024 sc1
    s_setprio 1
    buffer_load_dwordx4 v[32:35], v4, s[8:11], s30 offen offset:2048 sc1
    s_setprio 0
    buffer_load_dwordx4 v[36:39], v4, s[8:11], s30 offen offset:3072 sc1
    s_waitcnt vmcnt(3)
    v_cmp_eq_u32 vcc, -1, v27
    s_cbranch_vccnz .gs_126
.gr_127:
    v_smfmac_f32_16x16x64_bf16 v[64:67], v[24:27], a[192:199], v2
    v_smfmac_f32_16x16x64_bf16 v[68:71], v[24:27], a[224:231], v2
    s_waitcnt vmcnt(2)
    v_cmp_eq_u32 vcc, -1, v31
    s_cbranch_vccnz .gs_128
.gr_129:
    v_smfmac_f32_16x16x64_bf16 v[64:67], v[28:31], a[200:207], v2
    v_smfmac_f32_16x16x64_bf16 v[68:71], v[28:31], a[232:239], v2
    s_waitcnt vmcnt(1)
    v_cmp_eq_u32 vcc, -1, v35
    s_cbranch_vccnz .gs_130
.gr_131:
    v_smfmac_f32_16x16x64_bf16 v[64:67], v[32:35], a[208:215], v2
    v_smfmac_f32_16x16x64_bf16 v[68:71], v[32:35], a[240:247], v2
    s_waitcnt vmcnt(0)
    v_cmp_eq_u32 vcc, -1, v39
    s_cbranch_vccnz .gs_132
.gr_133:
    v_smfmac_f32_16x16x64_bf16 v[64:67], v[36:39], a[216:223], v2
    v_smfmac_f32_16x16x64_bf16 v[68:71], v[36:39], a[248:255], v2
    s_nop 7
    v_permlane32_swap_b32 v64, v68
    v_permlane32_swap_b32 v65, v69
    v_permlane32_swap_b32 v66, v70
    v_permlane32_swap_b32 v67, v71
    v_add_f32 v64, v64, v68
    v_add_f32 v65, v65, v69
    v_add_f32 v66, v66, v70
    v_add_f32 v67, v67, v71
    ds_write2_b32 v7, v64, v65 offset0:0 offset1:36
    ds_write2_b32 v7, v66, v67 offset0:72 offset1:108
    s_waitcnt lgkmcnt(0)
    s_barrier
    buffer_load_dwordx4 v[104:107], v15, s[8:11], s42 offen offset:0
    buffer_load_dwordx4 v[108:111], v15, s[8:11], s42 offen offset:1024
    buffer_load_dwordx4 v[112:115], v15, s[8:11], s42 offen offset:2048
    buffer_load_dwordx4 v[116:119], v15, s[8:11], s42 offen offset:3072
    buffer_load_dwordx4 v[120:123], v15, s[8:11], s43 offen offset:0
    buffer_load_dwordx4 v[124:127], v15, s[8:11], s43 offen offset:1024
    buffer_load_dwordx4 v[128:131], v15, s[8:11], s43 offen offset:2048
    buffer_load_dwordx4 v[132:135], v15, s[8:11], s43 offen offset:3072
    buffer_load_dwordx4 v[136:139], v15, s[8:11], s44 offen offset:0
    buffer_load_dwordx4 v[140:143], v15, s[8:11], s44 offen offset:1024
    s_add_u32 s42, s42, 262144
    s_add_u32 s43, s43, 262144
    s_add_u32 s44, s44, 262144
    v_mov_b32 v64, 0
    v_mov_b32 v65, 0
    v_mov_b32 v66, 0
    v_mov_b32 v67, 0
    v_mov_b32 v68, 0
    v_mov_b32 v69, 0
    v_mov_b32 v70, 0
    v_mov_b32 v71, 0
    s_mov_b32 s4, s30
    s_mov_b32 s30, s31
    s_mov_b32 s31, s32
    s_mov_b32 s32, s33
    s_mov_b32 s33, s4
    s_add_u32 s28, s28, 1
    s_mov_b32 s62, 0
    s_branch .step_112
.fin_113:
    s_waitcnt lgkmcnt(0)
    s_barrier
    s_barrier
    s_endpgm
.gs_114:
    buffer_load_dwordx4 v[24:27], v3, s[8:11], s30 offen offset:0 sc1
    buffer_load_dwordx4 v[28:31], v3, s[8:11], s30 offen offset:1024 sc1
    buffer_load_dwordx4 v[32:35], v3, s[8:11], s30 offen offset:2048 sc1
    buffer_load_dwordx4 v[36:39], v3, s[8:11], s30 offen offset:3072 sc1
    s_add_u32 s62, s62, 1
    s_cmp_gt_u32 s62, 0x100000
    s_cbranch_scc1 .mg_end_1
    s_waitcnt vmcnt(3)
    v_max_u32 v18, v25, v27
    v_cmp_eq_u32 vcc, -1, v18
    s_cbranch_vccz .gr_115
    s_branch .gs_114
.gs_116:
    buffer_load_dwordx4 v[28:31], v3, s[8:11], s30 offen offset:1024 sc1
    buffer_load_dwordx4 v[32:35], v3, s[8:11], s30 offen offset:2048 sc1
    buffer_load_dwordx4 v[36:39], v3, s[8:11], s30 offen offset:3072 sc1
    s_add_u32 s62, s62, 1
    s_cmp_gt_u32 s62, 0x100000
    s_cbranch_scc1 .mg_end_1
    s_waitcnt vmcnt(2)
    v_max_u32 v18, v29, v31
    v_cmp_eq_u32 vcc, -1, v18
    s_cbranch_vccz .gr_117
    s_branch .gs_116
.gs_118:
    buffer_load_dwordx4 v[32:35], v3, s[8:11], s30 offen offset:2048 sc1
    buffer_load_dwordx4 v[36:39], v3, s[8:11], s30 offen offset:3072 sc1
    s_add_u32 s62, s62, 1
    s_cmp_gt_u32 s62, 0x100000
    s_cbranch_scc1 .mg_end_1
    s_waitcnt vmcnt(1)
    v_max_u32 v18, v33, v35
    v_cmp_eq_u32 vcc, -1, v18
    s_cbranch_vccz .gr_119
    s_branch .gs_118
.gs_120:
    buffer_load_dwordx4 v[36:39], v3, s[8:11], s30 offen offset:3072 sc1
    s_add_u32 s62, s62, 1
    s_cmp_gt_u32 s62, 0x100000
    s_cbranch_scc1 .mg_end_1
    s_waitcnt vmcnt(0)
    v_max_u32 v18, v37, v39
    v_cmp_eq_u32 vcc, -1, v18
    s_cbranch_vccz .gr_121
    s_branch .gs_120
.re_123:
    s_mov_b64 exec, s[48:49]
    buffer_load_dwordx4 v[144:147], v12, s[8:11], s30 offen offset:0 sc1
    buffer_load_dwordx4 v[148:151], v12, s[8:11], s30 offen offset:512 sc1
    buffer_load_dwordx4 v[152:155], v12, s[8:11], s30 offen offset:1024 sc1
    buffer_load_dwordx4 v[156:159], v12, s[8:11], s30 offen offset:1536 sc1
    s_mov_b64 exec, s[50:51]
    buffer_load_dwordx4 v[160:163], v12, s[8:11], s30 offen offset:0 sc1
    buffer_load_dwordx4 v[164:167], v12, s[8:11], s30 offen offset:512 sc1
    buffer_load_dwordx4 v[168:171], v12, s[8:11], s30 offen offset:1024 sc1
    buffer_load_dwordx4 v[172:175], v12, s[8:11], s30 offen offset:1536 sc1
    s_mov_b64 exec, -1
    buffer_load_dwordx4 v[176:179], v13, s[8:11], s30 offen offset:0 sc1
    buffer_load_dwordx4 v[180:183], v13, s[8:11], s30 offen offset:512 sc1
    buffer_load_dwordx4 v[184:187], v13, s[8:11], s30 offen offset:1024 sc1
    buffer_load_dwordx4 v[188:191], v13, s[8:11], s30 offen offset:1536 sc1
    s_add_u32 s62, s62, 1
    s_cmp_gt_u32 s62, 0x100000
    s_cbranch_scc1 .mg_end_1
    s_branch .mf_122
.rk_125:
    buffer_load_dwordx4 v[176:179], v13, s[8:11], s30 offen offset:0 sc1
    buffer_load_dwordx4 v[180:183], v13, s[8:11], s30 offen offset:512 sc1
    buffer_load_dwordx4 v[184:187], v13, s[8:11], s30 offen offset:1024 sc1
    buffer_load_dwordx4 v[188:191], v13, s[8:11], s30 offen offset:1536 sc1
    s_add_u32 s62, s62, 1
    s_cmp_gt_u32 s62, 0x100000
    s_cbranch_scc1 .mg_end_1
    s_branch .mk_124
.gs_126:
    buffer_load_dwordx4 v[24:27], v4, s[8:11], s30 offen offset:0 sc1
    buffer_load_dwordx4 v[28:31], v4, s[8:11], s30 offen offset:1024 sc1
    buffer_load_dwordx4 v[32:35], v4, s[8:11], s30 offen offset:2048 sc1
    buffer_load_dwordx4 v[36:39], v4, s[8:11], s30 offen offset:3072 sc1
    s_add_u32 s62, s62, 1
    s_cmp_gt_u32 s62, 0x100000
    s_cbranch_scc1 .mg_end_1
    s_waitcnt vmcnt(3)
    v_cmp_eq_u32 vcc, -1, v27
    s_cbranch_vccz .gr_127
    s_branch .gs_126
.gs_128:
    buffer_load_dwordx4 v[28:31], v4, s[8:11], s30 offen offset:1024 sc1
    buffer_load_dwordx4 v[32:35], v4, s[8:11], s30 offen offset:2048 sc1
    buffer_load_dwordx4 v[36:39], v4, s[8:11], s30 offen offset:3072 sc1
    s_add_u32 s62, s62, 1
    s_cmp_gt_u32 s62, 0x100000
    s_cbranch_scc1 .mg_end_1
    s_waitcnt vmcnt(2)
    v_cmp_eq_u32 vcc, -1, v31
    s_cbranch_vccz .gr_129
    s_branch .gs_128
.gs_130:
    buffer_load_dwordx4 v[32:35], v4, s[8:11], s30 offen offset:2048 sc1
    buffer_load_dwordx4 v[36:39], v4, s[8:11], s30 offen offset:3072 sc1
    s_add_u32 s62, s62, 1
    s_cmp_gt_u32 s62, 0x100000
    s_cbranch_scc1 .mg_end_1
    s_waitcnt vmcnt(1)
    v_cmp_eq_u32 vcc, -1, v35
    s_cbranch_vccz .gr_131
    s_branch .gs_130
.gs_132:
    buffer_load_dwordx4 v[36:39], v4, s[8:11], s30 offen offset:3072 sc1
    s_add_u32 s62, s62, 1
    s_cmp_gt_u32 s62, 0x100000
    s_cbranch_scc1 .mg_end_1
    s_waitcnt vmcnt(0)
    v_cmp_eq_u32 vcc, -1, v39
    s_cbranch_vccz .gr_133
    s_branch .gs_132
.w1_109:
    v_bfe_u32 v254, v1, 1, 3
    v_mul_u32_u24 v12, 144, v254
    v_bfe_u32 v254, v1, 4, 2
    v_mul_u32_u24 v254, 32, v254
    v_add_u32 v12, v12, v254
    v_bfe_u32 v254, v1, 0, 1
    v_mul_u32_u24 v254, 16, v254
    v_add_u32 v12, v12, v254
    v_add_u32 v12, 9216, v12
    v_bfe_u32 v254, v1, 0, 6
    v_mul_u32_u24 v13, 16, v254
    v_add_u32 v13, s101, v13
    v_bfe_u32 v254, v1, 0, 6
    v_mul_u32_u24 v14, 8, v254
    v_add_u32 v14, s55, v14
    s_barrier
.p2align 6
.step_134:
    s_waitcnt vmcnt(0)
    s_barrier
    s_setprio 3
    buffer_load_dwordx4 v[24:27], v3, s[8:11], s30 offen offset:0 sc1
    s_setprio 2
    buffer_load_dwordx4 v[28:31], v3, s[8:11], s30 offen offset:1024 sc1
    s_setprio 1
    buffer_load_dwordx4 v[32:35], v3, s[8:11], s30 offen offset:2048 sc1
    s_setprio 0
    buffer_load_dwordx4 v[36:39], v3, s[8:11], s30 offen offset:3072 sc1
    s_waitcnt vmcnt(3)
    v_max_u32 v18, v25, v27
    v_cmp_eq_u32 vcc, -1, v18
    s_cbranch_vccnz .gs_136
.gr_137:
    v_smfmac_f32_16x16x64_bf16 v[40:43], v[24:27], a[0:7], v2
    v_smfmac_f32_16x16x64_bf16 v[44:47], v[24:27], a[32:39], v2
    s_waitcnt vmcnt(2)
    v_max_u32 v18, v29, v31
    v_cmp_eq_u32 vcc, -1, v18
    v_smfmac_f32_16x16x64_bf16 v[48:51], v[24:27], a[64:71], v2
    s_cbranch_vccnz .gs_138
.gr_139:
    v_smfmac_f32_16x16x64_bf16 v[40:43], v[28:31], a[8:15], v2
    v_smfmac_f32_16x16x64_bf16 v[44:47], v[28:31], a[40:47], v2
    v_smfmac_f32_16x16x64_bf16 v[52:55], v[24:27], a[96:103], v2
    s_waitcnt vmcnt(1)
    v_max_u32 v18, v33, v35
    v_cmp_eq_u32 vcc, -1, v18
    v_smfmac_f32_16x16x64_bf16 v[48:51], v[28:31], a[72:79], v2
    s_cbranch_vccnz .gs_140
.gr_141:
    v_smfmac_f32_16x16x64_bf16 v[40:43], v[32:35], a[16:23], v2
    v_smfmac_f32_16x16x64_bf16 v[44:47], v[32:35], a[48:55], v2
    v_smfmac_f32_16x16x64_bf16 v[52:55], v[28:31], a[104:111], v2
    s_waitcnt vmcnt(0)
    v_max_u32 v18, v37, v39
    v_cmp_eq_u32 vcc, -1, v18
    v_smfmac_f32_16x16x64_bf16 v[48:51], v[32:35], a[80:87], v2
    s_cbranch_vccnz .gs_142
.gr_143:
    v_smfmac_f32_16x16x64_bf16 v[40:43], v[36:39], a[24:31], v2
    v_smfmac_f32_16x16x64_bf16 v[44:47], v[36:39], a[56:63], v2
    v_smfmac_f32_16x16x64_bf16 v[52:55], v[32:35], a[112:119], v2
    v_smfmac_f32_16x16x64_bf16 v[48:51], v[36:39], a[88:95], v2
    v_permlane32_swap_b32 v40, v44
    v_permlane32_swap_b32 v41, v45
    v_smfmac_f32_16x16x64_bf16 v[52:55], v[36:39], a[120:127], v2
    v_permlane32_swap_b32 v42, v46
    v_permlane32_swap_b32 v43, v47
    v_add_f32 v40, v40, v44
    v_add_f32 v41, v41, v45
    v_add_f32 v42, v42, v46
    v_add_f32 v43, v43, v47
    ds_write2_b32 v5, v40, v41 offset0:0 offset1:36
    ds_write2_b32 v5, v42, v43 offset0:72 offset1:108
    v_permlane32_swap_b32 v48, v52
    v_permlane32_swap_b32 v49, v53
    v_permlane32_swap_b32 v50, v54
    v_permlane32_swap_b32 v51, v55
    v_add_f32 v48, v48, v52
    v_add_f32 v49, v49, v53
    v_add_f32 v50, v50, v54
    v_add_f32 v51, v51, v55
    ds_write2_b32 v6, v48, v49 offset0:0 offset1:36
    ds_write2_b32 v6, v50, v51 offset0:72 offset1:108
    s_waitcnt lgkmcnt(2)
    s_barrier
    ds_read_b64 v[72:73], v9 offset:0
    ds_read_b64 v[74:75], v9 offset:1152
    ds_read_b64 v[76:77], v9 offset:2304
    ds_read_b64 v[78:79], v9 offset:3456
    s_waitcnt lgkmcnt(4)
    s_barrier
    s_waitcnt lgkmcnt(2)
    v_add_f32 v72, v72, v74
    v_add_f32 v73, v73, v75
    s_waitcnt lgkmcnt(0)
    v_add_f32 v76, v76, v78
    v_add_f32 v77, v77, v79
    v_add_f32 v72, v72, v76
    v_add_f32 v73, v73, v77
    v_cvt_pk_bf16_f32 v72, v72, v73
    v_min_u32 v72, 0xfffffffe, v72
    buffer_store_dword v72, v10, s[8:11], s30 offen sc1
    v_smfmac_f32_16x16x64_bf16 v[56:59], v[24:27], a[128:135], v2
    v_smfmac_f32_16x16x64_bf16 v[60:63], v[24:27], a[160:167], v2
    v_smfmac_f32_16x16x64_bf16 v[56:59], v[28:31], a[136:143], v2
    v_smfmac_f32_16x16x64_bf16 v[60:63], v[28:31], a[168:175], v2
    v_smfmac_f32_16x16x64_bf16 v[56:59], v[32:35], a[144:151], v2
    v_smfmac_f32_16x16x64_bf16 v[60:63], v[32:35], a[176:183], v2
    v_smfmac_f32_16x16x64_bf16 v[56:59], v[36:39], a[152:159], v2
    v_smfmac_f32_16x16x64_bf16 v[60:63], v[36:39], a[184:191], v2
    v_mov_b32 v40, 0
    v_mov_b32 v41, 0
    v_mov_b32 v42, 0
    v_mov_b32 v43, 0
    v_mov_b32 v44, 0
    v_mov_b32 v45, 0
    v_mov_b32 v46, 0
    v_mov_b32 v47, 0
    v_permlane32_swap_b32 v56, v60
    v_permlane32_swap_b32 v57, v61
    v_permlane32_swap_b32 v58, v62
    v_permlane32_swap_b32 v59, v63
    v_add_f32 v56, v56, v60
    v_add_f32 v57, v57, v61
    v_add_f32 v58, v58, v62
    v_add_f32 v59, v59, v63
    ds_write_b128 v8, v[56:59]
    s_waitcnt lgkmcnt(0)
    s_barrier
    s_barrier
    s_cmp_eq_u32 s28, 63
    s_cbranch_scc1 .fin_135
    s_xor_b32 s38, s34, 0x4000
    s_xor_b32 s39, s34, 0x1000
    s_xor_b32 s40, s34, 0x5000
    v_mov_b32 v48, 0
    v_mov_b32 v49, 0
    v_mov_b32 v50, 0
    v_mov_b32 v51, 0
    v_mov_b32 v52, 0
    v_mov_b32 v53, 0
    v_mov_b32 v54, 0
    v_mov_b32 v55, 0
    v_mov_b32 v56, 0
    v_mov_b32 v57, 0
    v_mov_b32 v58, 0
    v_mov_b32 v59, 0
    v_mov_b32 v60, 0
    v_mov_b32 v61, 0
    v_mov_b32 v62, 0
    v_mov_b32 v63, 0
    s_barrier
    s_setprio 3
    buffer_load_dwordx4 v[24:27], v4, s[8:11], s30 offen offset:0 sc1
    s_setprio 2
    buffer_load_dwordx4 v[28:31], v4, s[8:11], s30 offen offset:1024 sc1
    s_setprio 1
    buffer_load_dwordx4 v[32:35], v4, s[8:11], s30 offen offset:2048 sc1
    s_setprio 0
    buffer_load_dwordx4 v[36:39], v4, s[8:11], s30 offen offset:3072 sc1
    s_waitcnt vmcnt(3)
    v_cmp_eq_u32 vcc, -1, v27
    s_cbranch_vccnz .gs_144
.gr_145:
    v_smfmac_f32_16x16x64_bf16 v[64:67], v[24:27], a[192:199], v2
    v_smfmac_f32_16x16x64_bf16 v[68:71], v[24:27], a[224:231], v2
    s_waitcnt vmcnt(2)
    v_cmp_eq_u32 vcc, -1, v31
    s_cbranch_vccnz .gs_146
.gr_147:
    v_smfmac_f32_16x16x64_bf16 v[64:67], v[28:31], a[200:207], v2
    v_smfmac_f32_16x16x64_bf16 v[68:71], v[28:31], a[232:239], v2
    s_waitcnt vmcnt(1)
    v_cmp_eq_u32 vcc, -1, v35
    s_cbranch_vccnz .gs_148
.gr_149:
    v_smfmac_f32_16x16x64_bf16 v[64:67], v[32:35], a[208:215], v2
    v_smfmac_f32_16x16x64_bf16 v[68:71], v[32:35], a[240:247], v2
    s_waitcnt vmcnt(0)
    v_cmp_eq_u32 vcc, -1, v39
    s_cbranch_vccnz .gs_150
.gr_151:
    v_smfmac_f32_16x16x64_bf16 v[64:67], v[36:39], a[216:223], v2
    v_smfmac_f32_16x16x64_bf16 v[68:71], v[36:39], a[248:255], v2
    s_nop 7
    v_permlane32_swap_b32 v64, v68
    v_permlane32_swap_b32 v65, v69
    v_permlane32_swap_b32 v66, v70
    v_permlane32_swap_b32 v67, v71
    v_add_f32 v64, v64, v68
    v_add_f32 v65, v65, v69
    v_add_f32 v66, v66, v70
    v_add_f32 v67, v67, v71
    ds_write2_b32 v7, v64, v65 offset0:0 offset1:36
    ds_write2_b32 v7, v66, v67 offset0:72 offset1:108
    s_waitcnt lgkmcnt(0)
    s_barrier
    ds_read_b128 v[72:75], v12 offset:0
    ds_read_b128 v[76:79], v12 offset:1152
    ds_read_b128 v[80:83], v12 offset:2304
    ds_read_b128 v[84:87], v12 offset:3456
    s_waitcnt lgkmcnt(2)
    v_add_f32 v72, v72, v76
    v_add_f32 v73, v73, v77
    v_add_f32 v74, v74, v78
    v_add_f32 v75, v75, v79
    s_waitcnt lgkmcnt(0)
    v_add_f32 v80, v80, v84
    v_add_f32 v81, v81, v85
    v_add_f32 v82, v82, v86
    v_add_f32 v83, v83, v87
    v_add_f32 v72, v72, v80
    v_add_f32 v73, v73, v81
    v_add_f32 v74, v74, v82
    v_add_f32 v75, v75, v83
    v_min_u32 v75, 0xfffffffe, v75
    buffer_store_dwordx4 v[72:75], v13, s[8:11], s34 offen sc1
    v_mov_b32 v64, 0
    v_mov_b32 v65, 0
    v_mov_b32 v66, 0
    v_mov_b32 v67, 0
    v_mov_b32 v68, 0
    v_mov_b32 v69, 0
    v_mov_b32 v70, 0
    v_mov_b32 v71, 0
    s_waitcnt vmcnt(0)
.pl_152:
    buffer_load_dwordx4 v[76:79], v13, s[8:11], s38 offen sc1
    buffer_load_dwordx4 v[80:83], v13, s[8:11], s39 offen sc1
    buffer_load_dwordx4 v[84:87], v13, s[8:11], s40 offen sc1
    s_waitcnt vmcnt(2)
    v_add_f32 v88, v72, v76
    v_add_f32 v89, v73, v77
    v_add_f32 v90, v74, v78
    v_add_f32 v91, v75, v79
    s_waitcnt vmcnt(0)
    v_max3_u32 v18, v79, v83, v87
    v_cmp_eq_u32 vcc, -1, v18
    v_add_f32 v80, v80, v84
    v_add_f32 v81, v81, v85
    v_add_f32 v82, v82, v86
    v_add_f32 v83, v83, v87
    v_add_f32 v88, v88, v80
    v_add_f32 v89, v89, v81
    v_add_f32 v90, v90, v82
    v_add_f32 v91, v91, v83
    v_cvt_pk_bf16_f32 v92, v88, v89
    v_cvt_pk_bf16_f32 v93, v90, v91
    v_min_u32 v93, 0xfffffffe, v93
    s_cbranch_vccnz .pr_153
    buffer_store_dwordx2 v[92:93], v14, s[8:11], s31 offen sc1
    s_mov_b32 s4, s30
    s_mov_b32 s30, s31
    s_mov_b32 s31, s32
    s_mov_b32 s32, s33
    s_mov_b32 s33, s4
    s_add_u32 s28, s28, 1
    s_mov_b32 s62, 0
    s_mov_b32 s4, s34
    s_mov_b32 s34, s35
    s_mov_b32 s35, s36
    s_mov_b32 s36, s37
    s_mov_b32 s37, s4
    s_branch .step_134
.fin_135:
    s_endpgm
.gs_136:
    buffer_load_dwordx4 v[24:27], v3, s[8:11], s30 offen offset:0 sc1
    buffer_load_dwordx4 v[28:31], v3, s[8:11], s30 offen offset:1024 sc1
    buffer_load_dwordx4 v[32:35], v3, s[8:11], s30 offen offset:2048 sc1
    buffer_load_dwordx4 v[36:39], v3, s[8:11], s30 offen offset:3072 sc1
    s_add_u32 s62, s62, 1
    s_cmp_gt_u32 s62, 0x100000
    s_cbranch_scc1 .mg_end_1
    s_waitcnt vmcnt(3)
    v_max_u32 v18, v25, v27
    v_cmp_eq_u32 vcc, -1, v18
    s_cbranch_vccz .gr_137
    s_branch .gs_136
.gs_138:
    buffer_load_dwordx4 v[28:31], v3, s[8:11], s30 offen offset:1024 sc1
    buffer_load_dwordx4 v[32:35], v3, s[8:11], s30 offen offset:2048 sc1
    buffer_load_dwordx4 v[36:39], v3, s[8:11], s30 offen offset:3072 sc1
    s_add_u32 s62, s62, 1
    s_cmp_gt_u32 s62, 0x100000
    s_cbranch_scc1 .mg_end_1
    s_waitcnt vmcnt(2)
    v_max_u32 v18, v29, v31
    v_cmp_eq_u32 vcc, -1, v18
    s_cbranch_vccz .gr_139
    s_branch .gs_138
.gs_140:
    buffer_load_dwordx4 v[32:35], v3, s[8:11], s30 offen offset:2048 sc1
    buffer_load_dwordx4 v[36:39], v3, s[8:11], s30 offen offset:3072 sc1
    s_add_u32 s62, s62, 1
    s_cmp_gt_u32 s62, 0x100000
    s_cbranch_scc1 .mg_end_1
    s_waitcnt vmcnt(1)
    v_max_u32 v18, v33, v35
    v_cmp_eq_u32 vcc, -1, v18
    s_cbranch_vccz .gr_141
    s_branch .gs_140
.gs_142:
    buffer_load_dwordx4 v[36:39], v3, s[8:11], s30 offen offset:3072 sc1
    s_add_u32 s62, s62, 1
    s_cmp_gt_u32 s62, 0x100000
    s_cbranch_scc1 .mg_end_1
    s_waitcnt vmcnt(0)
    v_max_u32 v18, v37, v39
    v_cmp_eq_u32 vcc, -1, v18
    s_cbranch_vccz .gr_143
    s_branch .gs_142
.gs_144:
    buffer_load_dwordx4 v[24:27], v4, s[8:11], s30 offen offset:0 sc1
    buffer_load_dwordx4 v[28:31], v4, s[8:11], s30 offen offset:1024 sc1
    buffer_load_dwordx4 v[32:35], v4, s[8:11], s30 offen offset:2048 sc1
    buffer_load_dwordx4 v[36:39], v4, s[8:11], s30 offen offset:3072 sc1
    s_add_u32 s62, s62, 1
    s_cmp_gt_u32 s62, 0x100000
    s_cbranch_scc1 .mg_end_1
    s_waitcnt vmcnt(3)
    v_cmp_eq_u32 vcc, -1, v27
    s_cbranch_vccz .gr_145
    s_branch .gs_144
.gs_146:
    buffer_load_dwordx4 v[28:31], v4, s[8:11], s30 offen offset:1024 sc1
    buffer_load_dwordx4 v[32:35], v4, s[8:11], s30 offen offset:2048 sc1
    buffer_load_dwordx4 v[36:39], v4, s[8:11], s30 offen offset:3072 sc1
    s_add_u32 s62, s62, 1
    s_cmp_gt_u32 s62, 0x100000
    s_cbranch_scc1 .mg_end_1
    s_waitcnt vmcnt(2)
    v_cmp_eq_u32 vcc, -1, v31
    s_cbranch_vccz .gr_147
    s_branch .gs_146
.gs_148:
    buffer_load_dwordx4 v[32:35], v4, s[8:11], s30 offen offset:2048 sc1
    buffer_load_dwordx4 v[36:39], v4, s[8:11], s30 offen offset:3072 sc1
    s_add_u32 s62, s62, 1
    s_cmp_gt_u32 s62, 0x100000
    s_cbranch_scc1 .mg_end_1
    s_waitcnt vmcnt(1)
    v_cmp_eq_u32 vcc, -1, v35
    s_cbranch_vccz .gr_149
    s_branch .gs_148
.gs_150:
    buffer_load_dwordx4 v[36:39], v4, s[8:11], s30 offen offset:3072 sc1
    s_add_u32 s62, s62, 1
    s_cmp_gt_u32 s62, 0x100000
    s_cbranch_scc1 .mg_end_1
    s_waitcnt vmcnt(0)
    v_cmp_eq_u32 vcc, -1, v39
    s_cbranch_vccz .gr_151
    s_branch .gs_150
.pr_153:
    s_add_u32 s62, s62, 1
    s_cmp_gt_u32 s62, 0x100000
    s_cbranch_scc1 .mg_end_1
    s_branch .pl_152
.w2_110:
    s_lshl_b32 s4, s56, 6
    s_lshl_b32 s5, s53, 2
    s_add_u32 s4, s4, s5
    s_add_u32 s4, s4, 92274736
    v_mov_b32 v14, s4
    v_bfe_u32 v254, v1, 0, 6
    v_mul_u32_u24 v12, 16, v254
    v_add_u32 v12, 17920, v12
    s_mov_b32 s62, 0
.wc_154:
    buffer_load_dword v18, v40, s[20:23], 0 offen offset:32 sc1
    s_add_u32 s62, s62, 1
    s_cmp_gt_u32 s62, 0x100000
    s_cbranch_scc1 .mg_end_1
    s_waitcnt vmcnt(0)
    v_readfirstlane_b32 s4, v18
    s_cmp_lt_u32 s4, 128
    s_cbranch_scc1 .wc_154
    s_barrier
.p2align 6
.step_155:
    s_barrier
    s_setprio 3
    buffer_load_dwordx4 v[24:27], v3, s[8:11], s30 offen offset:0 sc1
    s_setprio 2
    buffer_load_dwordx4 v[28:31], v3, s[8:11], s30 offen offset:1024 sc1
    s_setprio 1
    buffer_load_dwordx4 v[32:35], v3, s[8:11], s30 offen offset:2048 sc1
    s_setprio 0
    buffer_load_dwordx4 v[36:39], v3, s[8:11], s30 offen offset:3072 sc1
    s_waitcnt vmcnt(3)
    v_max_u32 v18, v25, v27
    v_cmp_eq_u32 vcc, -1, v18
    s_cbranch_vccnz .gs_157
.gr_158:
    v_smfmac_f32_16x16x64_bf16 v[40:43], v[24:27], a[0:7], v2
    v_smfmac_f32_16x16x64_bf16 v[44:47], v[24:27], a[32:39], v2
    s_waitcnt vmcnt(2)
    v_max_u32 v18, v29, v31
    v_cmp_eq_u32 vcc, -1, v18
    v_smfmac_f32_16x16x64_bf16 v[48:51], v[24:27], a[64:71], v2
    s_cbranch_vccnz .gs_159
.gr_160:
    v_smfmac_f32_16x16x64_bf16 v[40:43], v[28:31], a[8:15], v2
    v_smfmac_f32_16x16x64_bf16 v[44:47], v[28:31], a[40:47], v2
    v_smfmac_f32_16x16x64_bf16 v[52:55], v[24:27], a[96:103], v2
    s_waitcnt vmcnt(1)
    v_max_u32 v18, v33, v35
    v_cmp_eq_u32 vcc, -1, v18
    v_smfmac_f32_16x16x64_bf16 v[48:51], v[28:31], a[72:79], v2
    s_cbranch_vccnz .gs_161
.gr_162:
    v_smfmac_f32_16x16x64_bf16 v[40:43], v[32:35], a[16:23], v2
    v_smfmac_f32_16x16x64_bf16 v[44:47], v[32:35], a[48:55], v2
    v_smfmac_f32_16x16x64_bf16 v[52:55], v[28:31], a[104:111], v2
    s_waitcnt vmcnt(0)
    v_max_u32 v18, v37, v39
    v_cmp_eq_u32 vcc, -1, v18
    v_smfmac_f32_16x16x64_bf16 v[48:51], v[32:35], a[80:87], v2
    s_cbranch_vccnz .gs_163
.gr_164:
    v_smfmac_f32_16x16x64_bf16 v[40:43], v[36:39], a[24:31], v2
    v_smfmac_f32_16x16x64_bf16 v[44:47], v[36:39], a[56:63], v2
    v_smfmac_f32_16x16x64_bf16 v[52:55], v[32:35], a[112:119], v2
    v_smfmac_f32_16x16x64_bf16 v[48:51], v[36:39], a[88:95], v2
    v_permlane32_swap_b32 v40, v44
    v_permlane32_swap_b32 v41, v45
    v_smfmac_f32_16x16x64_bf16 v[52:55], v[36:39], a[120:127], v2
    v_permlane32_swap_b32 v42, v46
    v_permlane32_swap_b32 v43, v47
    v_add_f32 v40, v40, v44
    v_add_f32 v41, v41, v45
    v_add_f32 v42, v42, v46
    v_add_f32 v43, v43, v47
    ds_write2_b32 v5, v40, v41 offset0:0 offset1:36
    ds_write2_b32 v5, v42, v43 offset0:72 offset1:108
    v_permlane32_swap_b32 v48, v52
    v_permlane32_swap_b32 v49, v53
    v_permlane32_swap_b32 v50, v54
    v_permlane32_swap_b32 v51, v55
    v_add_f32 v48, v48, v52
    v_add_f32 v49, v49, v53
    v_add_f32 v50, v50, v54
    v_add_f32 v51, v51, v55
    ds_write2_b32 v6, v48, v49 offset0:0 offset1:36
    ds_write2_b32 v6, v50, v51 offset0:72 offset1:108
    s_waitcnt lgkmcnt(2)
    s_barrier
    s_waitcnt lgkmcnt(0)
    s_barrier
    ds_read_b64 v[72:73], v9 offset:0
    ds_read_b64 v[74:75], v9 offset:1152
    ds_read_b64 v[76:77], v9 offset:2304
    ds_read_b64 v[78:79], v9 offset:3456
    s_waitcnt lgkmcnt(2)
    v_add_f32 v72, v72, v74
    v_add_f32 v73, v73, v75
    s_waitcnt lgkmcnt(0)
    v_add_f32 v76, v76, v78
    v_add_f32 v77, v77, v79
    v_add_f32 v72, v72, v76
    v_add_f32 v73, v73, v77
    v_cvt_pk_bf16_f32 v72, v72, v73
    v_min_u32 v72, 0xfffffffe, v72
    buffer_store_dword v72, v10, s[8:11], s30 offen sc1
    v_smfmac_f32_16x16x64_bf16 v[56:59], v[24:27], a[128:135], v2
    v_smfmac_f32_16x16x64_bf16 v[60:63], v[24:27], a[160:167], v2
    v_smfmac_f32_16x16x64_bf16 v[56:59], v[28:31], a[136:143], v2
    v_smfmac_f32_16x16x64_bf16 v[60:63], v[28:31], a[168:175], v2
    v_smfmac_f32_16x16x64_bf16 v[56:59], v[32:35], a[144:151], v2
    v_smfmac_f32_16x16x64_bf16 v[60:63], v[32:35], a[176:183], v2
    v_smfmac_f32_16x16x64_bf16 v[56:59], v[36:39], a[152:159], v2
    v_smfmac_f32_16x16x64_bf16 v[60:63], v[36:39], a[184:191], v2
    ds_write_b32 v11, v72
    v_mov_b32 v40, 0
    v_mov_b32 v41, 0
    v_mov_b32 v42, 0
    v_mov_b32 v43, 0
    v_mov_b32 v44, 0
    v_mov_b32 v45, 0
    v_mov_b32 v46, 0
    v_mov_b32 v47, 0
    v_permlane32_swap_b32 v56, v60
    v_permlane32_swap_b32 v57, v61
    v_permlane32_swap_b32 v58, v62
    v_permlane32_swap_b32 v59, v63
    v_add_f32 v56, v56, v60
    v_add_f32 v57, v57, v61
    v_add_f32 v58, v58, v62
    v_add_f32 v59, v59, v63
    ds_write_b128 v8, v[56:59]
    s_waitcnt lgkmcnt(0)
    s_barrier
    s_barrier
    ds_read_b128 v[72:75], v12
    s_cmp_eq_u32 s28, 63
    s_cbranch_scc1 .fin_156
    v_mov_b32 v48, 0
    v_mov_b32 v49, 0
    v_mov_b32 v50, 0
    v_mov_b32 v51, 0
    v_mov_b32 v52, 0
    v_mov_b32 v53, 0
    v_mov_b32 v54, 0
    v_mov_b32 v55, 0
    v_mov_b32 v56, 0
    v_mov_b32 v57, 0
    v_mov_b32 v58, 0
    v_mov_b32 v59, 0
    v_mov_b32 v60, 0
    v_mov_b32 v61, 0
    v_mov_b32 v62, 0
    v_mov_b32 v63, 0
    s_barrier
    s_setprio 3
    buffer_load_dwordx4 v[24:27], v4, s[8:11], s30 offen offset:0 sc1
    s_setprio 2
    buffer_load_dwordx4 v[28:31], v4, s[8:11], s30 offen offset:1024 sc1
    s_setprio 1
    buffer_load_dwordx4 v[32:35], v4, s[8:11], s30 offen offset:2048 sc1
    s_setprio 0
    buffer_load_dwordx4 v[36:39], v4, s[8:11], s30 offen offset:3072 sc1
    s_waitcnt vmcnt(3)
    v_cmp_eq_u32 vcc, -1, v27
    s_cbranch_vccnz .gs_165
.gr_166:
    v_smfmac_f32_16x16x64_bf16 v[64:67], v[24:27], a[192:199], v2
    v_smfmac_f32_16x16x64_bf16 v[68:71], v[24:27], a[224:231], v2
    s_waitcnt vmcnt(2)
    v_cmp_eq_u32 vcc, -1, v31
    s_cbranch_vccnz .gs_167
.gr_168:
    v_smfmac_f32_16x16x64_bf16 v[64:67], v[28:31], a[200:207], v2
    v_smfmac_f32_16x16x64_bf16 v[68:71], v[28:31], a[232:239], v2
    s_waitcnt vmcnt(1)
    v_cmp_eq_u32 vcc, -1, v35
    s_cbranch_vccnz .gs_169
.gr_170:
    v_smfmac_f32_16x16x64_bf16 v[64:67], v[32:35], a[208:215], v2
    v_smfmac_f32_16x16x64_bf16 v[68:71], v[32:35], a[240:247], v2
    s_waitcnt vmcnt(0)
    v_cmp_eq_u32 vcc, -1, v39
    s_cbranch_vccnz .gs_171
.gr_172:
    v_smfmac_f32_16x16x64_bf16 v[64:67], v[36:39], a[216:223], v2
    v_smfmac_f32_16x16x64_bf16 v[68:71], v[36:39], a[248:255], v2
    s_nop 7
    v_permlane32_swap_b32 v64, v68
    v_permlane32_swap_b32 v65, v69
    v_permlane32_swap_b32 v66, v70
    v_permlane32_swap_b32 v67, v71
    v_add_f32 v64, v64, v68
    v_add_f32 v65, v65, v69
    v_add_f32 v66, v66, v70
    v_add_f32 v67, v67, v71
    ds_write2_b32 v7, v64, v65 offset0:0 offset1:36
    ds_write2_b32 v7, v66, v67 offset0:72 offset1:108
    s_waitcnt lgkmcnt(0)
    s_barrier
    buffer_store_dwordx4 v[72:75], v244, s[8:11], s41 offen sc1
    v_mov_b32 v18, s28
    s_mov_b64 exec, 1
    buffer_store_dword v18, v14, s[8:11], 0 offen sc1
    s_mov_b64 exec, -1
    v_mov_b32 v64, 0
    v_mov_b32 v65, 0
    v_mov_b32 v66, 0
    v_mov_b32 v67, 0
    v_mov_b32 v68, 0
    v_mov_b32 v69, 0
    v_mov_b32 v70, 0
    v_mov_b32 v71, 0
    s_mov_b32 s4, s30
    s_mov_b32 s30, s31
    s_mov_b32 s31, s32
    s_mov_b32 s32, s33
    s_mov_b32 s33, s4
    s_add_u32 s28, s28, 1
    s_mov_b32 s62, 0
    s_add_u32 s41, s41, 0x20000
    s_branch .step_155
.fin_156:
    s_waitcnt lgkmcnt(0)
    buffer_store_dwordx4 v[72:75], v244, s[8:11], s41 offen sc1
    s_waitcnt vmcnt(0)
    v_mov_b32 v18, 64
    s_mov_b64 exec, 1
    buffer_store_dword v18, v14, s[8:11], 0 offen sc1
    s_mov_b64 exec, -1
    s_endpgm
.gs_157:
    buffer_load_dwordx4 v[24:27], v3, s[8:11], s30 offen offset:0 sc1
    buffer_load_dwordx4 v[28:31], v3, s[8:11], s30 offen offset:1024 sc1
    buffer_load_dwordx4 v[32:35], v3, s[8:11], s30 offen offset:2048 sc1
    buffer_load_dwordx4 v[36:39], v3, s[8:11], s30 offen offset:3072 sc1
    s_add_u32 s62, s62, 1
    s_cmp_gt_u32 s62, 0x100000
    s_cbranch_scc1 .mg_end_1
    s_waitcnt vmcnt(3)
    v_max_u32 v18, v25, v27
    v_cmp_eq_u32 vcc, -1, v18
    s_cbranch_vccz .gr_158
    s_branch .gs_157
.gs_159:
    buffer_load_dwordx4 v[28:31], v3, s[8:11], s30 offen offset:1024 sc1
    buffer_load_dwordx4 v[32:35], v3, s[8:11], s30 offen offset:2048 sc1
    buffer_load_dwordx4 v[36:39], v3, s[8:11], s30 offen offset:3072 sc1
    s_add_u32 s62, s62, 1
    s_cmp_gt_u32 s62, 0x100000
    s_cbranch_scc1 .mg_end_1
    s_waitcnt vmcnt(2)
    v_max_u32 v18, v29, v31
    v_cmp_eq_u32 vcc, -1, v18
    s_cbranch_vccz .gr_160
    s_branch .gs_159
.gs_161:
    buffer_load_dwordx4 v[32:35], v3, s[8:11], s30 offen offset:2048 sc1
    buffer_load_dwordx4 v[36:39], v3, s[8:11], s30 offen offset:3072 sc1
    s_add_u32 s62, s62, 1
    s_cmp_gt_u32 s62, 0x100000
    s_cbranch_scc1 .mg_end_1
    s_waitcnt vmcnt(1)
    v_max_u32 v18, v33, v35
    v_cmp_eq_u32 vcc, -1, v18
    s_cbranch_vccz .gr_162
    s_branch .gs_161
.gs_163:
    buffer_load_dwordx4 v[36:39], v3, s[8:11], s30 offen offset:3072 sc1
    s_add_u32 s62, s62, 1
    s_cmp_gt_u32 s62, 0x100000
    s_cbranch_scc1 .mg_end_1
    s_waitcnt vmcnt(0)
    v_max_u32 v18, v37, v39
    v_cmp_eq_u32 vcc, -1, v18
    s_cbranch_vccz .gr_164
    s_branch .gs_163
.gs_165:
    buffer_load_dwordx4 v[24:27], v4, s[8:11], s30 offen offset:0 sc1
    buffer_load_dwordx4 v[28:31], v4, s[8:11], s30 offen offset:1024 sc1
    buffer_load_dwordx4 v[32:35], v4, s[8:11], s30 offen offset:2048 sc1
    buffer_load_dwordx4 v[36:39], v4, s[8:11], s30 offen offset:3072 sc1
    s_add_u32 s62, s62, 1
    s_cmp_gt_u32 s62, 0x100000
    s_cbranch_scc1 .mg_end_1
    s_waitcnt vmcnt(3)
    v_cmp_eq_u32 vcc, -1, v27
    s_cbranch_vccz .gr_166
    s_branch .gs_165
.gs_167:
    buffer_load_dwordx4 v[28:31], v4, s[8:11], s30 offen offset:1024 sc1
    buffer_load_dwordx4 v[32:35], v4, s[8:11], s30 offen offset:2048 sc1
    buffer_load_dwordx4 v[36:39], v4, s[8:11], s30 offen offset:3072 sc1
    s_add_u32 s62, s62, 1
    s_cmp_gt_u32 s62, 0x100000
    s_cbranch_scc1 .mg_end_1
    s_waitcnt vmcnt(2)
    v_cmp_eq_u32 vcc, -1, v31
    s_cbranch_vccz .gr_168
    s_branch .gs_167
.gs_169:
    buffer_load_dwordx4 v[32:35], v4, s[8:11], s30 offen offset:2048 sc1
    buffer_load_dwordx4 v[36:39], v4, s[8:11], s30 offen offset:3072 sc1
    s_add_u32 s62, s62, 1
    s_cmp_gt_u32 s62, 0x100000
    s_cbranch_scc1 .mg_end_1
    s_waitcnt vmcnt(1)
    v_cmp_eq_u32 vcc, -1, v35
    s_cbranch_vccz .gr_170
    s_branch .gs_169
.gs_171:
    buffer_load_dwordx4 v[36:39], v4, s[8:11], s30 offen offset:3072 sc1
    s_add_u32 s62, s62, 1
    s_cmp_gt_u32 s62, 0x100000
    s_cbranch_scc1 .mg_end_1
    s_waitcnt vmcnt(0)
    v_cmp_eq_u32 vcc, -1, v39
    s_cbranch_vccz .gr_172
    s_branch .gs_171
.w3_111:
    v_bfe_u32 v254, v1, 3, 1
    v_mul_u32_u24 v12, 512, v254
    v_bfe_u32 v254, v1, 5, 1
    v_mul_u32_u24 v254, 256, v254
    v_add_u32 v12, v12, v254
    v_bfe_u32 v254, v1, 2, 1
    v_mul_u32_u24 v254, 128, v254
    v_add_u32 v12, v12, v254
    v_bfe_u32 v254, v1, 0, 2
    v_mul_u32_u24 v254, 16, v254
    v_add_u32 v12, v12, v254
    v_bfe_u32 v254, v1, 4, 1
    v_mul_u32_u24 v254, 8, v254
    v_add_u32 v12, v12, v254
    v_add_u32 v12, 13824, v12
    v_bfe_u32 v254, v1, 2, 2
    v_mul_u32_u24 v14, 128, v254
    v_bfe_u32 v254, v1, 0, 2
    v_mul_u32_u24 v254, 16, v254
    v_add_u32 v14, v14, v254
    v_bfe_u32 v254, v1, 4, 2
    v_mul_u32_u24 v254, 4, v254
    v_add_u32 v14, v14, v254
    v_add_u32 v14, 18432, v14
    v_bfe_u32 v254, v1, 0, 6
    v_mul_u32_u24 v15, 16, v254
    v_add_u32 v15, s101, v15
    s_lshl_b32 s4, s56, 6
    s_add_u32 s4, s4, 92274704
    v_bfe_u32 v254, v1, 0, 3
    v_mul_u32_u24 v13, 4, v254
    v_add_u32 v13, s4, v13
    s_mov_b32 s62, 0
.wc_173:
    buffer_load_dword v18, v40, s[20:23], 0 offen offset:36 sc1
    s_add_u32 s62, s62, 1
    s_cmp_gt_u32 s62, 0x100000
    s_cbranch_scc1 .mg_end_1
    s_waitcnt vmcnt(0)
    v_readfirstlane_b32 s4, v18
    s_cmp_lt_u32 s4, 128
    s_cbranch_scc1 .wc_173
    s_cmp_ge_u32 s46, 2
    s_cbranch_scc1 .kvd_175
    s_mov_b32 s62, 0
.kv_174:
    buffer_load_dword v18, v13, s[8:11], 0 offen sc1
    s_add_u32 s62, s62, 1
    s_cmp_gt_u32 s62, 0x100000
    s_cbranch_scc1 .mg_end_1
    s_waitcnt vmcnt(0)
    v_min_u32_dpp v18, v18, v18 quad_perm:[1,0,3,2] row_mask:0xf bank_mask:0xf
    s_nop 1
    v_min_u32_dpp v18, v18, v18 quad_perm:[2,3,0,1] row_mask:0xf bank_mask:0xf
    s_nop 1
    v_min_u32_dpp v18, v18, v18 row_half_mirror row_mask:0xf bank_mask:0xf
    s_nop 0
    v_readfirstlane_b32 s46, v18
    s_cmp_lt_u32 s46, 2
    s_cbranch_scc1 .kv_174
.kvd_175:
    s_barrier
.p2align 6
.step_176:
    s_barrier
    s_setprio 3
    buffer_load_dwordx4 v[24:27], v3, s[8:11], s30 offen offset:0 sc1
    s_setprio 2
    buffer_load_dwordx4 v[28:31], v3, s[8:11], s30 offen offset:1024 sc1
    s_setprio 1
    buffer_load_dwordx4 v[32:35], v3, s[8:11], s30 offen offset:2048 sc1
    s_setprio 0
    buffer_load_dwordx4 v[36:39], v3, s[8:11], s30 offen offset:3072 sc1
    s_waitcnt vmcnt(3)
    v_max_u32 v18, v25, v27
    v_cmp_eq_u32 vcc, -1, v18
    s_cbranch_vccnz .gs_178
.gr_179:
    v_smfmac_f32_16x16x64_bf16 v[40:43], v[24:27], a[0:7], v2
    v_smfmac_f32_16x16x64_bf16 v[44:47], v[24:27], a[32:39], v2
    s_waitcnt vmcnt(2)
    v_max_u32 v18, v29, v31
    v_cmp_eq_u32 vcc, -1, v18
    v_smfmac_f32_16x16x64_bf16 v[48:51], v[24:27], a[64:71], v2
    s_cbranch_vccnz .gs_180
.gr_181:
    v_smfmac_f32_16x16x64_bf16 v[40:43], v[28:31], a[8:15], v2
    v_smfmac_f32_16x16x64_bf16 v[44:47], v[28:31], a[40:47], v2
    v_smfmac_f32_16x16x64_bf16 v[52:55], v[24:27], a[96:103], v2
    s_waitcnt vmcnt(1)
    v_max_u32 v18, v33, v35
    v_cmp_eq_u32 vcc, -1, v18
    v_smfmac_f32_16x16x64_bf16 v[48:51], v[28:31], a[72:79], v2
    s_cbranch_vccnz .gs_182
.gr_183:
    v_smfmac_f32_16x16x64_bf16 v[40:43], v[32:35], a[16:23], v2
    v_smfmac_f32_16x16x64_bf16 v[44:47], v[32:35], a[48:55], v2
    v_smfmac_f32_16x16x64_bf16 v[52:55], v[28:31], a[104:111], v2
    s_waitcnt vmcnt(0)
    v_max_u32 v18, v37, v39
    v_cmp_eq_u32 vcc, -1, v18
    v_smfmac_f32_16x16x64_bf16 v[48:51], v[32:35], a[80:87], v2
    s_cbranch_vccnz .gs_184
.gr_185:
    v_smfmac_f32_16x16x64_bf16 v[40:43], v[36:39], a[24:31], v2
    v_smfmac_f32_16x16x64_bf16 v[44:47], v[36:39], a[56:63], v2
    v_smfmac_f32_16x16x64_bf16 v[52:55], v[32:35], a[112:119], v2
    v_smfmac_f32_16x16x64_bf16 v[48:51], v[36:39], a[88:95], v2
    v_permlane32_swap_b32 v40, v44
    v_permlane32_swap_b32 v41, v45
    v_smfmac_f32_16x16x64_bf16 v[52:55], v[36:39], a[120:127], v2
    v_permlane32_swap_b32 v42, v46
    v_permlane32_swap_b32 v43, v47
    v_add_f32 v40, v40, v44
    v_add_f32 v41, v41, v45
    v_add_f32 v42, v42, v46
    v_add_f32 v43, v43, v47
    ds_write2_b32 v5, v40, v41 offset0:0 offset1:36
    ds_write2_b32 v5, v42, v43 offset0:72 offset1:108
    v_permlane32_swap_b32 v48, v52
    v_permlane32_swap_b32 v49, v53
    v_permlane32_swap_b32 v50, v54
    v_permlane32_swap_b32 v51, v55
    v_add_f32 v48, v48, v52
    v_add_f32 v49, v49, v53
    v_add_f32 v50, v50, v54
    v_add_f32 v51, v51, v55
    ds_write2_b32 v6, v48, v49 offset0:0 offset1:36
    ds_write2_b32 v6, v50, v51 offset0:72 offset1:108
    s_waitcnt lgkmcnt(2)
    s_barrier
    s_waitcnt lgkmcnt(0)
    s_barrier
    ds_read_b64 v[72:73], v9 offset:0
    ds_read_b64 v[74:75], v9 offset:1152
    ds_read_b64 v[76:77], v9 offset:2304
    ds_read_b64 v[78:79], v9 offset:3456
    s_waitcnt lgkmcnt(2)
    v_add_f32 v72, v72, v74
    v_add_f32 v73, v73, v75
    s_waitcnt lgkmcnt(0)
    v_add_f32 v76, v76, v78
    v_add_f32 v77, v77, v79
    v_add_f32 v72, v72, v76
    v_add_f32 v73, v73, v77
    v_cvt_pk_bf16_f32 v72, v72, v73
    v_min_u32 v72, 0xfffffffe, v72
    buffer_store_dword v72, v10, s[8:11], s30 offen sc1
    v_smfmac_f32_16x16x64_bf16 v[56:59], v[24:27], a[128:135], v2
    v_smfmac_f32_16x16x64_bf16 v[60:63], v[24:27], a[160:167], v2
    v_smfmac_f32_16x16x64_bf16 v[56:59], v[28:31], a[136:143], v2
    v_smfmac_f32_16x16x64_bf16 v[60:63], v[28:31], a[168:175], v2
    v_smfmac_f32_16x16x64_bf16 v[56:59], v[32:35], a[144:151], v2
    v_smfmac_f32_16x16x64_bf16 v[60:63], v[32:35], a[176:183], v2
    v_smfmac_f32_16x16x64_bf16 v[56:59], v[36:39], a[152:159], v2
    v_smfmac_f32_16x16x64_bf16 v[60:63], v[36:39], a[184:191], v2
    ds_write_b32 v11, v72
    v_mov_b32 v40, 0
    v_mov_b32 v41, 0
    v_mov_b32 v42, 0
    v_mov_b32 v43, 0
    v_mov_b32 v44, 0
    v_mov_b32 v45, 0
    v_mov_b32 v46, 0
    v_mov_b32 v47, 0
    v_permlane32_swap_b32 v56, v60
    v_permlane32_swap_b32 v57, v61
    v_permlane32_swap_b32 v58, v62
    v_permlane32_swap_b32 v59, v63
    v_add_f32 v56, v56, v60
    v_add_f32 v57, v57, v61
    v_add_f32 v58, v58, v62
    v_add_f32 v59, v59, v63
    ds_write_b128 v8, v[56:59]
    s_waitcnt lgkmcnt(0)
    s_barrier
    ds_read_b64 v[72:73], v12 offset:0
    ds_read_b64 v[74:75], v12 offset:1024
    ds_read_b64 v[76:77], v12 offset:2048
    ds_read_b64 v[78:79], v12 offset:3072
    ds_read_b64 v[80:81], v12 offset:64
    ds_read_b64 v[82:83], v12 offset:1088
    ds_read_b64 v[84:85], v12 offset:2112
    ds_read_b64 v[86:87], v12 offset:3136
    s_waitcnt lgkmcnt(4)
    v_add_f32 v72, v72, v74
    v_add_f32 v73, v73, v75
    v_add_f32 v76, v76, v78
    v_add_f32 v77, v77, v79
    v_add_f32 v72, v72, v76
    v_add_f32 v73, v73, v77
    v_cvt_pk_bf16_f32 v72, v72, v73
    s_waitcnt lgkmcnt(0)
    v_add_f32 v80, v80, v82
    v_add_f32 v81, v81, v83
    v_add_f32 v84, v84, v86
    v_add_f32 v85, v85, v87
    v_add_f32 v80, v80, v84
    v_add_f32 v81, v81, v85
    v_cvt_pk_bf16_f32 v80, v80, v81
    ds_write_b32 v14, v72
    ds_write_b32 v14, v80 offset:64
    s_waitcnt lgkmcnt(0)
    s_barrier
    s_cmp_eq_u32 s28, 63
    s_cbranch_scc1 .fin_177
    v_mov_b32 v48, 0
    v_mov_b32 v49, 0
    v_mov_b32 v50, 0
    v_mov_b32 v51, 0
    v_mov_b32 v52, 0
    v_mov_b32 v53, 0
    v_mov_b32 v54, 0
    v_mov_b32 v55, 0
    v_mov_b32 v56, 0
    v_mov_b32 v57, 0
    v_mov_b32 v58, 0
    v_mov_b32 v59, 0
    v_mov_b32 v60, 0
    v_mov_b32 v61, 0
    v_mov_b32 v62, 0
    v_mov_b32 v63, 0
    s_barrier
    s_setprio 3
    buffer_load_dwordx4 v[24:27], v4, s[8:11], s30 offen offset:0 sc1
    s_setprio 2
    buffer_load_dwordx4 v[28:31], v4, s[8:11], s30 offen offset:1024 sc1
    s_setprio 1
    buffer_load_dwordx4 v[32:35], v4, s[8:11], s30 offen offset:2048 sc1
    s_setprio 0
    buffer_load_dwordx4 v[36:39], v4, s[8:11], s30 offen offset:3072 sc1
    s_waitcnt vmcnt(3)
    v_cmp_eq_u32 vcc, -1, v27
    s_cbranch_vccnz .gs_186
.gr_187:
    v_smfmac_f32_16x16x64_bf16 v[64:67], v[24:27], a[192:199], v2
    v_smfmac_f32_16x16x64_bf16 v[68:71], v[24:27], a[224:231], v2
    s_waitcnt vmcnt(2)
    v_cmp_eq_u32 vcc, -1, v31
    s_cbranch_vccnz .gs_188
.gr_189:
    v_smfmac_f32_16x16x64_bf16 v[64:67], v[28:31], a[200:207], v2
    v_smfmac_f32_16x16x64_bf16 v[68:71], v[28:31], a[232:239], v2
    s_waitcnt vmcnt(1)
    v_cmp_eq_u32 vcc, -1, v35
    s_cbranch_vccnz .gs_190
.gr_191:
    v_smfmac_f32_16x16x64_bf16 v[64:67], v[32:35], a[208:215], v2
    v_smfmac_f32_16x16x64_bf16 v[68:71], v[32:35], a[240:247], v2
    s_waitcnt vmcnt(0)
    v_cmp_eq_u32 vcc, -1, v39
    s_cbranch_vccnz .gs_192
.gr_193:
    v_smfmac_f32_16x16x64_bf16 v[64:67], v[36:39], a[216:223], v2
    v_smfmac_f32_16x16x64_bf16 v[68:71], v[36:39], a[248:255], v2
    s_nop 7
    v_permlane32_swap_b32 v64, v68
    v_permlane32_swap_b32 v65, v69
    v_permlane32_swap_b32 v66, v70
    v_permlane32_swap_b32 v67, v71
    v_add_f32 v64, v64, v68
    v_add_f32 v65, v65, v69
    v_add_f32 v66, v66, v70
    v_add_f32 v67, v67, v71
    ds_write2_b32 v7, v64, v65 offset0:0 offset1:36
    ds_write2_b32 v7, v66, v67 offset0:72 offset1:108
    s_waitcnt lgkmcnt(0)
    s_barrier
    buffer_store_dwordx4 v[20:23], v15, s[8:11], s36 offen sc1
    buffer_store_dwordx4 v[20:23], v244, s[8:11], s32 offen sc1
    buffer_store_dwordx4 v[20:23], v245, s[8:11], s32 offen sc1
    s_add_u32 s5, s28, 3
    s_min_u32 s5, s5, 64
    s_cmp_ge_u32 s46, s5
    s_cbranch_scc1 .kvd_195
    s_mov_b32 s62, 0
.kv_194:
    buffer_load_dword v18, v13, s[8:11], 0 offen sc1
    s_add_u32 s62, s62, 1
    s_cmp_gt_u32 s62, 0x100000
    s_cbranch_scc1 .mg_end_1
    s_waitcnt vmcnt(0)
    v_min_u32_dpp v18, v18, v18 quad_perm:[1,0,3,2] row_mask:0xf bank_mask:0xf
    s_nop 1
    v_min_u32_dpp v18, v18, v18 quad_perm:[2,3,0,1] row_mask:0xf bank_mask:0xf
    s_nop 1
    v_min_u32_dpp v18, v18, v18 row_half_mirror row_mask:0xf bank_mask:0xf
    s_nop 0
    v_readfirstlane_b32 s46, v18
    s_cmp_lt_u32 s46, s5
    s_cbranch_scc1 .kv_194
.kvd_195:
    v_mov_b32 v64, 0
    v_mov_b32 v65, 0
    v_mov_b32 v66, 0
    v_mov_b32 v67, 0
    v_mov_b32 v68, 0
    v_mov_b32 v69, 0
    v_mov_b32 v70, 0
    v_mov_b32 v71, 0
    s_mov_b32 s4, s30
    s_mov_b32 s30, s31
    s_mov_b32 s31, s32
    s_mov_b32 s32, s33
    s_mov_b32 s33, s4
    s_add_u32 s28, s28, 1
    s_mov_b32 s62, 0
    s_mov_b32 s4, s34
    s_mov_b32 s34, s35
    s_mov_b32 s35, s36
    s_mov_b32 s36, s37
    s_mov_b32 s37, s4
    s_add_u32 s41, s41, 0x20000
    s_branch .step_176
.fin_177:
    s_endpgm
.gs_178:
    buffer_load_dwordx4 v[24:27], v3, s[8:11], s30 offen offset:0 sc1
    buffer_load_dwordx4 v[28:31], v3, s[8:11], s30 offen offset:1024 sc1
    buffer_load_dwordx4 v[32:35], v3, s[8:11], s30 offen offset:2048 sc1
    buffer_load_dwordx4 v[36:39], v3, s[8:11], s30 offen offset:3072 sc1
    s_add_u32 s62, s62, 1
    s_cmp_gt_u32 s62, 0x100000
    s_cbranch_scc1 .mg_end_1
    s_waitcnt vmcnt(3)
    v_max_u32 v18, v25, v27
    v_cmp_eq_u32 vcc, -1, v18
    s_cbranch_vccz .gr_179
    s_branch .gs_178
.gs_180:
    buffer_load_dwordx4 v[28:31], v3, s[8:11], s30 offen offset:1024 sc1
    buffer_load_dwordx4 v[32:35], v3, s[8:11], s30 offen offset:2048 sc1
    buffer_load_dwordx4 v[36:39], v3, s[8:11], s30 offen offset:3072 sc1
    s_add_u32 s62, s62, 1
    s_cmp_gt_u32 s62, 0x100000
    s_cbranch_scc1 .mg_end_1
    s_waitcnt vmcnt(2)
    v_max_u32 v18, v29, v31
    v_cmp_eq_u32 vcc, -1, v18
    s_cbranch_vccz .gr_181
    s_branch .gs_180
.gs_182:
    buffer_load_dwordx4 v[32:35], v3, s[8:11], s30 offen offset:2048 sc1
    buffer_load_dwordx4 v[36:39], v3, s[8:11], s30 offen offset:3072 sc1
    s_add_u32 s62, s62, 1
    s_cmp_gt_u32 s62, 0x100000
    s_cbranch_scc1 .mg_end_1
    s_waitcnt vmcnt(1)
    v_max_u32 v18, v33, v35
    v_cmp_eq_u32 vcc, -1, v18
    s_cbranch_vccz .gr_183
    s_branch .gs_182
.gs_184:
    buffer_load_dwordx4 v[36:39], v3, s[8:11], s30 offen offset:3072 sc1
    s_add_u32 s62, s62, 1
    s_cmp_gt_u32 s62, 0x100000
    s_cbranch_scc1 .mg_end_1
    s_waitcnt vmcnt(0)
    v_max_u32 v18, v37, v39
    v_cmp_eq_u32 vcc, -1, v18
    s_cbranch_vccz .gr_185
    s_branch .gs_184
.gs_186:
    buffer_load_dwordx4 v[24:27], v4, s[8:11], s30 offen offset:0 sc1
    buffer_load_dwordx4 v[28:31], v4, s[8:11], s30 offen offset:1024 sc1
    buffer_load_dwordx4 v[32:35], v4, s[8:11], s30 offen offset:2048 sc1
    buffer_load_dwordx4 v[36:39], v4, s[8:11], s30 offen offset:3072 sc1
    s_add_u32 s62, s62, 1
    s_cmp_gt_u32 s62, 0x100000
    s_cbranch_scc1 .mg_end_1
    s_waitcnt vmcnt(3)
    v_cmp_eq_u32 vcc, -1, v27
    s_cbranch_vccz .gr_187
    s_branch .gs_186
.gs_188:
    buffer_load_dwordx4 v[28:31], v4, s[8:11], s30 offen offset:1024 sc1
    buffer_load_dwordx4 v[32:35], v4, s[8:11], s30 offen offset:2048 sc1
    buffer_load_dwordx4 v[36:39], v4, s[8:11], s30 offen offset:3072 sc1
    s_add_u32 s62, s62, 1
    s_cmp_gt_u32 s62, 0x100000
    s_cbranch_scc1 .mg_end_1
    s_waitcnt vmcnt(2)
    v_cmp_eq_u32 vcc, -1, v31
    s_cbranch_vccz .gr_189
    s_branch .gs_188
.gs_190:
    buffer_load_dwordx4 v[32:35], v4, s[8:11], s30 offen offset:2048 sc1
    buffer_load_dwordx4 v[36:39], v4, s[8:11], s30 offen offset:3072 sc1
    s_add_u32 s62, s62, 1
    s_cmp_gt_u32 s62, 0x100000
    s_cbranch_scc1 .mg_end_1
    s_waitcnt vmcnt(1)
    v_cmp_eq_u32 vcc, -1, v35
    s_cbranch_vccz .gr_191
    s_branch .gs_190
.gs_192:
    buffer_load_dwordx4 v[36:39], v4, s[8:11], s30 offen offset:3072 sc1
    s_add_u32 s62, s62, 1
    s_cmp_gt_u32 s62, 0x100000
    s_cbranch_scc1 .mg_end_1
    s_waitcnt vmcnt(0)
    v_cmp_eq_u32 vcc, -1, v39
    s_cbranch_vccz .gr_193
    s_branch .gs_192
.mg_bg_2:
    s_sub_u32 s98, s25, 4
    s_mov_b32 s99, s26
    s_mov_b32 s96, 0
    v_and_b32 v1, 63, v0
    v_mov_b32 v250, 0
    v_mov_b32 v251, 0
    s_cmp_eq_u32 s98, 3
    s_cbranch_scc1 .abr_196
    s_lshl_b32 s4, s98, 3
    s_add_u32 s4, s4, 64
    s_load_dwordx2 s[40:41], s[0:1], 0
    s_load_dwordx2 s[42:43], s[0:1], s4
    s_lshl_b32 s4, s99, 8
    s_lshl_b32 s5, s24, 6
    s_add_u32 s4, s4, s5
    s_lshl_b32 s6, s24, 14
    v_bfe_u32 v254, v1, 2, 4
    v_mul_u32_u24 v240, 8192, v254
    v_bfe_u32 v254, v1, 0, 2
    v_mul_u32_u24 v254, 16, v254
    v_add_u32 v240, v240, v254
    v_add_u32 v240, s4, v240
    v_bfe_u32 v254, v1, 4, 2
    v_mul_u32_u24 v242, 512, v254
    v_bfe_u32 v254, v1, 2, 2
    v_mul_u32_u24 v254, 64, v254
    v_add_u32 v242, v242, v254
    v_bfe_u32 v254, v1, 0, 2
    v_mul_u32_u24 v254, 16, v254
    v_add_u32 v242, v242, v254
    v_add_u32 v242, s6, v242
    v_add_u32 v243, 0x10000, v242
    s_waitcnt lgkmcnt(0)
    s_mov_b32 s12, s40
    s_and_b32 s13, s41, 0xffff
    s_mov_b32 s14, 0x400000
    s_mov_b32 s15, 0x00020000
    s_mov_b32 s16, s42
    s_and_b32 s17, s43, 0xffff
    s_mov_b32 s18, 0x800000
    s_mov_b32 s19, 0x00020000
    s_add_u32 m0, s6, 0
    s_mov_b32 s5, 0
    buffer_load_dwordx4 v240, s[16:19], s5 offen lds
    s_add_u32 m0, s6, 1024
    s_mov_b32 s5, 131072
    buffer_load_dwordx4 v240, s[16:19], s5 offen lds
    s_add_u32 m0, s6, 2048
    s_mov_b32 s5, 262144
    buffer_load_dwordx4 v240, s[16:19], s5 offen lds
    s_add_u32 m0, s6, 3072
    s_mov_b32 s5, 393216
    buffer_load_dwordx4 v240, s[16:19], s5 offen lds
    s_add_u32 m0, s6, 4096
    s_mov_b32 s5, 524288
    buffer_load_dwordx4 v240, s[16:19], s5 offen lds
    s_add_u32 m0, s6, 5120
    s_mov_b32 s5, 655360
    buffer_load_dwordx4 v240, s[16:19], s5 offen lds
    s_add_u32 m0, s6, 6144
    s_mov_b32 s5, 786432
    buffer_load_dwordx4 v240, s[16:19], s5 offen lds
    s_add_u32 m0, s6, 7168
    s_mov_b32 s5, 917504
    buffer_load_dwordx4 v240, s[16:19], s5 offen lds
    s_add_u32 m0, s6, 8192
    s_mov_b32 s5, 1048576
    buffer_load_dwordx4 v240, s[16:19], s5 offen lds
    s_add_u32 m0, s6, 9216
    s_mov_b32 s5, 1179648
    buffer_load_dwordx4 v240, s[16:19], s5 offen lds
    s_add_u32 m0, s6, 10240
    s_mov_b32 s5, 1310720
    buffer_load_dwordx4 v240, s[16:19], s5 offen lds
    s_add_u32 m0, s6, 11264
    s_mov_b32 s5, 1441792
    buffer_load_dwordx4 v240, s[16:19], s5 offen lds
    s_add_u32 m0, s6, 12288
    s_mov_b32 s5, 1572864
    buffer_load_dwordx4 v240, s[16:19], s5 offen lds
    s_add_u32 m0, s6, 13312
    s_mov_b32 s5, 1703936
    buffer_load_dwordx4 v240, s[16:19], s5 offen lds
    s_add_u32 m0, s6, 14336
    s_mov_b32 s5, 1835008
    buffer_load_dwordx4 v240, s[16:19], s5 offen lds
    s_add_u32 m0, s6, 15360
    s_mov_b32 s5, 1966080
    buffer_load_dwordx4 v240, s[16:19], s5 offen lds
    s_add_u32 m0, s6, 65536
    s_mov_b32 s5, 2097152
    buffer_load_dwordx4 v240, s[16:19], s5 offen lds
    s_add_u32 m0, s6, 66560
    s_mov_b32 s5, 2228224
    buffer_load_dwordx4 v240, s[16:19], s5 offen lds
    s_add_u32 m0, s6, 67584
    s_mov_b32 s5, 2359296
    buffer_load_dwordx4 v240, s[16:19], s5 offen lds
    s_add_u32 m0, s6, 68608
    s_mov_b32 s5, 2490368
    buffer_load_dwordx4 v240, s[16:19], s5 offen lds
    s_add_u32 m0, s6, 69632
    s_mov_b32 s5, 2621440
    buffer_load_dwordx4 v240, s[16:19], s5 offen lds
    s_add_u32 m0, s6, 70656
    s_mov_b32 s5, 2752512
    buffer_load_dwordx4 v240, s[16:19], s5 offen lds
    s_add_u32 m0, s6, 71680
    s_mov_b32 s5, 2883584
    buffer_load_dwordx4 v240, s[16:19], s5 offen lds
    s_add_u32 m0, s6, 72704
    s_mov_b32 s5, 3014656
    buffer_load_dwordx4 v240, s[16:19], s5 offen lds
    s_add_u32 m0, s6, 73728
    s_mov_b32 s5, 3145728
    buffer_load_dwordx4 v240, s[16:19], s5 offen lds
    s_add_u32 m0, s6, 74752
    s_mov_b32 s5, 3276800
    buffer_load_dwordx4 v240, s[16:19], s5 offen lds
    s_add_u32 m0, s6, 75776
    s_mov_b32 s5, 3407872
    buffer_load_dwordx4 v240, s[16:19], s5 offen lds
    s_add_u32 m0, s6, 76800
    s_mov_b32 s5, 3538944
    buffer_load_dwordx4 v240, s[16:19], s5 offen lds
    s_add_u32 m0, s6, 77824
    s_mov_b32 s5, 3670016
    buffer_load_dwordx4 v240, s[16:19], s5 offen lds
    s_add_u32 m0, s6, 78848
    s_mov_b32 s5, 3801088
    buffer_load_dwordx4 v240, s[16:19], s5 offen lds
    s_add_u32 m0, s6, 79872
    s_mov_b32 s5, 3932160
    buffer_load_dwordx4 v240, s[16:19], s5 offen lds
    s_add_u32 m0, s6, 80896
    s_mov_b32 s5, 4063232
    buffer_load_dwordx4 v240, s[16:19], s5 offen lds
    v_and_b32 v2, 15, v1
    v_lshrrev_b32 v3, 4, v1
    v_lshlrev_b32 v4, 11, v2
    v_add_u32 v5, 0, v3
    v_xor_b32 v5, v5, v2
    v_lshl_add_u32 v8, v5, 4, v4
    v_add_u32 v12, 0x10000, v8
    v_add_u32 v5, 4, v3
    v_xor_b32 v5, v5, v2
    v_lshl_add_u32 v9, v5, 4, v4
    v_add_u32 v13, 0x10000, v9
    v_add_u32 v5, 8, v3
    v_xor_b32 v5, v5, v2
    v_lshl_add_u32 v10, v5, 4, v4
    v_add_u32 v14, 0x10000, v10
    v_add_u32 v5, 12, v3
    v_xor_b32 v5, v5, v2
    v_lshl_add_u32 v11, v5, 4, v4
    v_add_u32 v15, 0x10000, v11
    s_lshl_b32 s4, s24, 3
    s_and_b32 s4, s4, 8
    s_add_u32 s5, s4, 0
    v_xor_b32 v5, s5, v1
    s_add_u32 s5, s6, 0
    v_lshlrev_b32 v5, 4, v5
    v_add_u32 v16, s5, v5
    s_add_u32 s5, s4, 1
    v_xor_b32 v5, s5, v1
    s_add_u32 s5, s6, 0
    v_lshlrev_b32 v5, 4, v5
    v_add_u32 v17, s5, v5
    s_add_u32 s5, s4, 2
    v_xor_b32 v5, s5, v1
    s_add_u32 s5, s6, 4096
    v_lshlrev_b32 v5, 4, v5
    v_add_u32 v18, s5, v5
    s_add_u32 s5, s4, 3
    v_xor_b32 v5, s5, v1
    s_add_u32 s5, s6, 4096
    v_lshlrev_b32 v5, 4, v5
    v_add_u32 v19, s5, v5
    s_add_u32 s5, s4, 4
    v_xor_b32 v5, s5, v1
    s_add_u32 s5, s6, 8192
    v_lshlrev_b32 v5, 4, v5
    v_add_u32 v20, s5, v5
    s_add_u32 s5, s4, 5
    v_xor_b32 v5, s5, v1
    s_add_u32 s5, s6, 8192
    v_lshlrev_b32 v5, 4, v5
    v_add_u32 v21, s5, v5
    s_add_u32 s5, s4, 6
    v_xor_b32 v5, s5, v1
    s_add_u32 s5, s6, 12288
    v_lshlrev_b32 v5, 4, v5
    v_add_u32 v22, s5, v5
    s_add_u32 s5, s4, 7
    v_xor_b32 v5, s5, v1
    s_add_u32 s5, s6, 12288
    v_lshlrev_b32 v5, 4, v5
    v_add_u32 v23, s5, v5
    s_cmp_eq_u32 s98, 2
    s_cselect_b32 s4, 11, 10
    s_cselect_b32 s5, 1, 4
    s_lshl_b32 s5, s5, 10
    s_lshl_b32 s4, s24, s4
    v_lshlrev_b32 v24, 4, v1
    v_add_u32 v24, s4, v24
    v_add_u32 v25, s5, v24
    v_mov_b32 v26, 0
    s_lshl_b32 s4, s99, 11
    s_lshl_b32 s5, s24, 9
    s_add_u32 s4, s4, s5
    s_add_u32 s4, s4, 196608
    v_lshlrev_b32 v28, 3, v1
    v_add_u32 v28, s4, v28
    s_lshl_b32 s31, s98, 24
    s_lshl_b32 s4, s99, 13
    s_add_u32 s31, s31, s4
    s_mov_b32 s30, 75497472
    s_mov_b32 s28, 0
    s_mov_b32 s29, 0
    s_waitcnt vmcnt(16)
    ds_read_b64_tr_b16 a[0:1], v242 offset:0
    ds_read_b64_tr_b16 a[2:3], v242 offset:256
    ds_read_b64_tr_b16 a[4:5], v242 offset:8
    ds_read_b64_tr_b16 a[6:7], v242 offset:264
    ds_read_b64_tr_b16 a[8:9], v242 offset:2048
    ds_read_b64_tr_b16 a[10:11], v242 offset:2304
    ds_read_b64_tr_b16 a[12:13], v242 offset:2056
    ds_read_b64_tr_b16 a[14:15], v242 offset:2312
    ds_read_b64_tr_b16 a[16:17], v242 offset:4096
    ds_read_b64_tr_b16 a[18:19], v242 offset:4352
    ds_read_b64_tr_b16 a[20:21], v242 offset:4104
    ds_read_b64_tr_b16 a[22:23], v242 offset:4360
    ds_read_b64_tr_b16 a[24:25], v242 offset:6144
    ds_read_b64_tr_b16 a[26:27], v242 offset:6400
    ds_read_b64_tr_b16 a[28:29], v242 offset:6152
    ds_read_b64_tr_b16 a[30:31], v242 offset:6408
    ds_read_b64_tr_b16 a[32:33], v242 offset:8192
    ds_read_b64_tr_b16 a[34:35], v242 offset:8448
    ds_read_b64_tr_b16 a[36:37], v242 offset:8200
    ds_read_b64_tr_b16 a[38:39], v242 offset:8456
    ds_read_b64_tr_b16 a[40:41], v242 offset:10240
    ds_read_b64_tr_b16 a[42:43], v242 offset:10496
    ds_read_b64_tr_b16 a[44:45], v242 offset:10248
    ds_read_b64_tr_b16 a[46:47], v242 offset:10504
    ds_read_b64_tr_b16 a[48:49], v242 offset:12288
    ds_read_b64_tr_b16 a[50:51], v242 offset:12544
    ds_read_b64_tr_b16 a[52:53], v242 offset:12296
    ds_read_b64_tr_b16 a[54:55], v242 offset:12552
    ds_read_b64_tr_b16 a[56:57], v242 offset:14336
    ds_read_b64_tr_b16 a[58:59], v242 offset:14592
    ds_read_b64_tr_b16 a[60:61], v242 offset:14344
    ds_read_b64_tr_b16 a[62:63], v242 offset:14600
    s_waitcnt lgkmcnt(0)
    v_and_b32 v239, 7, v0
    v_lshlrev_b32 v239, 2, v239
    buffer_load_dword v238, v239, s[20:23], 0 offen sc1
    s_add_u32 m0, s6, 0
    s_mov_b32 s5, 4194304
    buffer_load_dwordx4 v240, s[16:19], s5 offen lds
    s_add_u32 m0, s6, 1024
    s_mov_b32 s5, 4325376
    buffer_load_dwordx4 v240, s[16:19], s5 offen lds
    s_add_u32 m0, s6, 2048
    s_mov_b32 s5, 4456448
    buffer_load_dwordx4 v240, s[16:19], s5 offen lds
    s_add_u32 m0, s6, 3072
    s_mov_b32 s5, 4587520
    buffer_load_dwordx4 v240, s[16:19], s5 offen lds
    s_add_u32 m0, s6, 4096
    s_mov_b32 s5, 4718592
    buffer_load_dwordx4 v240, s[16:19], s5 offen lds
    s_add_u32 m0, s6, 5120
    s_mov_b32 s5, 4849664
    buffer_load_dwordx4 v240, s[16:19], s5 offen lds
    s_add_u32 m0, s6, 6144
    s_mov_b32 s5, 4980736
    buffer_load_dwordx4 v240, s[16:19], s5 offen lds
    s_add_u32 m0, s6, 7168
    s_mov_b32 s5, 5111808
    buffer_load_dwordx4 v240, s[16:19], s5 offen lds
    s_add_u32 m0, s6, 8192
    s_mov_b32 s5, 5242880
    buffer_load_dwordx4 v240, s[16:19], s5 offen lds
    s_add_u32 m0, s6, 9216
    s_mov_b32 s5, 5373952
    buffer_load_dwordx4 v240, s[16:19], s5 offen lds
    s_add_u32 m0, s6, 10240
    s_mov_b32 s5, 5505024
    buffer_load_dwordx4 v240, s[16:19], s5 offen lds
    s_add_u32 m0, s6, 11264
    s_mov_b32 s5, 5636096
    buffer_load_dwordx4 v240, s[16:19], s5 offen lds
    s_add_u32 m0, s6, 12288
    s_mov_b32 s5, 5767168
    buffer_load_dwordx4 v240, s[16:19], s5 offen lds
    s_add_u32 m0, s6, 13312
    s_mov_b32 s5, 5898240
    buffer_load_dwordx4 v240, s[16:19], s5 offen lds
    s_add_u32 m0, s6, 14336
    s_mov_b32 s5, 6029312
    buffer_load_dwordx4 v240, s[16:19], s5 offen lds
    s_add_u32 m0, s6, 15360
    s_mov_b32 s5, 6160384
    buffer_load_dwordx4 v240, s[16:19], s5 offen lds
    s_waitcnt vmcnt(16)
    s_cmp_lg_u32 s27, 0
    s_cbranch_scc1 .vd_199
    s_mov_b32 s62, 0
.vp_198:
    v_cmp_ne_u32 vcc, 32, v238
    s_cbranch_vccz .vd_199
    v_readlane_b32 s64, v238, 0
    v_readlane_b32 s65, v238, 1
    v_readlane_b32 s66, v238, 2
    v_readlane_b32 s67, v238, 3
    v_readlane_b32 s68, v238, 4
    v_readlane_b32 s69, v238, 5
    v_readlane_b32 s70, v238, 6
    v_readlane_b32 s71, v238, 7
    s_nop 3
    s_add_u32 s4, s64, s65
    s_add_u32 s5, s66, s67
    s_add_u32 s72, s68, s69
    s_add_u32 s73, s70, s71
    s_add_u32 s4, s4, s5
    s_add_u32 s72, s72, s73
    s_add_u32 s4, s4, s72
    s_cmp_ge_u32 s4, 256
    s_cbranch_scc1 .vs_200
    s_add_u32 s62, s62, 1
    s_cmp_gt_u32 s62, 0x100000
    s_cbranch_scc1 .mg_end_1
    buffer_load_dword v238, v239, s[20:23], 0 offen sc1
    s_waitcnt vmcnt(0)
    s_branch .vp_198
.vs_200:
    s_lshr_b32 s25, s2, 5
    s_and_b32 s26, s2, 31
    s_mov_b32 s27, 1
    s_waitcnt vmcnt(0) lgkmcnt(0)
    s_barrier
    s_branch .mg_role_3
.vd_199:
    s_lshl_b32 s4, s99, 6
    s_lshl_b32 s5, s24, 2
    s_add_u32 s4, s4, s5
    s_lshl_b32 s5, s98, 4
    s_add_u32 s4, s4, s5
    s_add_u32 s94, s4, 92274688
    v_mov_b32 v4, 0
    s_mov_b64 exec, 1
    buffer_store_dword v4, v4, s[8:11], s94 offen sc1
    s_mov_b64 exec, -1
    ds_read_b64_tr_b16 a[64:65], v243 offset:0
    ds_read_b64_tr_b16 a[66:67], v243 offset:256
    ds_read_b64_tr_b16 a[68:69], v243 offset:8
    ds_read_b64_tr_b16 a[70:71], v243 offset:264
    ds_read_b64_tr_b16 a[72:73], v243 offset:2048
    ds_read_b64_tr_b16 a[74:75], v243 offset:2304
    ds_read_b64_tr_b16 a[76:77], v243 offset:2056
    ds_read_b64_tr_b16 a[78:79], v243 offset:2312
    ds_read_b64_tr_b16 a[80:81], v243 offset:4096
    ds_read_b64_tr_b16 a[82:83], v243 offset:4352
    ds_read_b64_tr_b16 a[84:85], v243 offset:4104
    ds_read_b64_tr_b16 a[86:87], v243 offset:4360
    ds_read_b64_tr_b16 a[88:89], v243 offset:6144
    ds_read_b64_tr_b16 a[90:91], v243 offset:6400
    ds_read_b64_tr_b16 a[92:93], v243 offset:6152
    ds_read_b64_tr_b16 a[94:95], v243 offset:6408
    ds_read_b64_tr_b16 a[96:97], v243 offset:8192
    ds_read_b64_tr_b16 a[98:99], v243 offset:8448
    ds_read_b64_tr_b16 a[100:101], v243 offset:8200
    ds_read_b64_tr_b16 a[102:103], v243 offset:8456
    ds_read_b64_tr_b16 a[104:105], v243 offset:10240
    ds_read_b64_tr_b16 a[106:107], v243 offset:10496
    ds_read_b64_tr_b16 a[108:109], v243 offset:10248
    ds_read_b64_tr_b16 a[110:111], v243 offset:10504
    ds_read_b64_tr_b16 a[112:113], v243 offset:12288
    ds_read_b64_tr_b16 a[114:115], v243 offset:12544
    ds_read_b64_tr_b16 a[116:117], v243 offset:12296
    ds_read_b64_tr_b16 a[118:119], v243 offset:12552
    ds_read_b64_tr_b16 a[120:121], v243 offset:14336
    ds_read_b64_tr_b16 a[122:123], v243 offset:14592
    ds_read_b64_tr_b16 a[124:125], v243 offset:14344
    ds_read_b64_tr_b16 a[126:127], v243 offset:14600
    s_waitcnt lgkmcnt(0)
    s_add_u32 m0, s6, 65536
    s_mov_b32 s5, 6291456
    buffer_load_dwordx4 v240, s[16:19], s5 offen lds
    s_add_u32 m0, s6, 66560
    s_mov_b32 s5, 6422528
    buffer_load_dwordx4 v240, s[16:19], s5 offen lds
    s_add_u32 m0, s6, 67584
    s_mov_b32 s5, 6553600
    buffer_load_dwordx4 v240, s[16:19], s5 offen lds
    s_add_u32 m0, s6, 68608
    s_mov_b32 s5, 6684672
    buffer_load_dwordx4 v240, s[16:19], s5 offen lds
    s_add_u32 m0, s6, 69632
    s_mov_b32 s5, 6815744
    buffer_load_dwordx4 v240, s[16:19], s5 offen lds
    s_add_u32 m0, s6, 70656
    s_mov_b32 s5, 6946816
    buffer_load_dwordx4 v240, s[16:19], s5 offen lds
    s_add_u32 m0, s6, 71680
    s_mov_b32 s5, 7077888
    buffer_load_dwordx4 v240, s[16:19], s5 offen lds
    s_add_u32 m0, s6, 72704
    s_mov_b32 s5, 7208960
    buffer_load_dwordx4 v240, s[16:19], s5 offen lds
    s_add_u32 m0, s6, 73728
    s_mov_b32 s5, 7340032
    buffer_load_dwordx4 v240, s[16:19], s5 offen lds
    s_add_u32 m0, s6, 74752
    s_mov_b32 s5, 7471104
    buffer_load_dwordx4 v240, s[16:19], s5 offen lds
    s_add_u32 m0, s6, 75776
    s_mov_b32 s5, 7602176
    buffer_load_dwordx4 v240, s[16:19], s5 offen lds
    s_add_u32 m0, s6, 76800
    s_mov_b32 s5, 7733248
    buffer_load_dwordx4 v240, s[16:19], s5 offen lds
    s_add_u32 m0, s6, 77824
    s_mov_b32 s5, 7864320
    buffer_load_dwordx4 v240, s[16:19], s5 offen lds
    s_add_u32 m0, s6, 78848
    s_mov_b32 s5, 7995392
    buffer_load_dwordx4 v240, s[16:19], s5 offen lds
    s_add_u32 m0, s6, 79872
    s_mov_b32 s5, 8126464
    buffer_load_dwordx4 v240, s[16:19], s5 offen lds
    s_add_u32 m0, s6, 80896
    s_mov_b32 s5, 8257536
    buffer_load_dwordx4 v240, s[16:19], s5 offen lds
    s_waitcnt vmcnt(16)
    ds_read_b64_tr_b16 a[128:129], v242 offset:0
    ds_read_b64_tr_b16 a[130:131], v242 offset:256
    ds_read_b64_tr_b16 a[132:133], v242 offset:8
    ds_read_b64_tr_b16 a[134:135], v242 offset:264
    ds_read_b64_tr_b16 a[136:137], v242 offset:2048
    ds_read_b64_tr_b16 a[138:139], v242 offset:2304
    ds_read_b64_tr_b16 a[140:141], v242 offset:2056
    ds_read_b64_tr_b16 a[142:143], v242 offset:2312
    ds_read_b64_tr_b16 a[144:145], v242 offset:4096
    ds_read_b64_tr_b16 a[146:147], v242 offset:4352
    ds_read_b64_tr_b16 a[148:149], v242 offset:4104
    ds_read_b64_tr_b16 a[150:151], v242 offset:4360
    ds_read_b64_tr_b16 a[152:153], v242 offset:6144
    ds_read_b64_tr_b16 a[154:155], v242 offset:6400
    ds_read_b64_tr_b16 a[156:157], v242 offset:6152
    ds_read_b64_tr_b16 a[158:159], v242 offset:6408
    ds_read_b64_tr_b16 a[160:161], v242 offset:8192
    ds_read_b64_tr_b16 a[162:163], v242 offset:8448
    ds_read_b64_tr_b16 a[164:165], v242 offset:8200
    ds_read_b64_tr_b16 a[166:167], v242 offset:8456
    ds_read_b64_tr_b16 a[168:169], v242 offset:10240
    ds_read_b64_tr_b16 a[170:171], v242 offset:10496
    ds_read_b64_tr_b16 a[172:173], v242 offset:10248
    ds_read_b64_tr_b16 a[174:175], v242 offset:10504
    ds_read_b64_tr_b16 a[176:177], v242 offset:12288
    ds_read_b64_tr_b16 a[178:179], v242 offset:12544
    ds_read_b64_tr_b16 a[180:181], v242 offset:12296
    ds_read_b64_tr_b16 a[182:183], v242 offset:12552
    ds_read_b64_tr_b16 a[184:185], v242 offset:14336
    ds_read_b64_tr_b16 a[186:187], v242 offset:14592
    ds_read_b64_tr_b16 a[188:189], v242 offset:14344
    ds_read_b64_tr_b16 a[190:191], v242 offset:14600
    s_waitcnt lgkmcnt(0)
    s_barrier
    s_add_u32 m0, s6, 0
    s_nop 0
    buffer_load_dwordx4 v16, s[12:15], s29 offen offset:0 lds
    buffer_load_dwordx4 v16, s[12:15], s29 offen offset:1024 lds
    buffer_load_dwordx4 v17, s[12:15], s29 offen offset:2048 lds
    buffer_load_dwordx4 v17, s[12:15], s29 offen offset:3072 lds
    s_add_u32 m0, s6, 4096
    s_nop 0
    buffer_load_dwordx4 v18, s[12:15], s29 offen offset:0 lds
    buffer_load_dwordx4 v18, s[12:15], s29 offen offset:1024 lds
    buffer_load_dwordx4 v19, s[12:15], s29 offen offset:2048 lds
    buffer_load_dwordx4 v19, s[12:15], s29 offen offset:3072 lds
    s_add_u32 m0, s6, 8192
    s_nop 0
    buffer_load_dwordx4 v20, s[12:15], s29 offen offset:0 lds
    buffer_load_dwordx4 v20, s[12:15], s29 offen offset:1024 lds
    buffer_load_dwordx4 v21, s[12:15], s29 offen offset:2048 lds
    buffer_load_dwordx4 v21, s[12:15], s29 offen offset:3072 lds
    s_add_u32 m0, s6, 12288
    s_nop 0
    buffer_load_dwordx4 v22, s[12:15], s29 offen offset:0 lds
    buffer_load_dwordx4 v22, s[12:15], s29 offen offset:1024 lds
    buffer_load_dwordx4 v23, s[12:15], s29 offen offset:2048 lds
    buffer_load_dwordx4 v23, s[12:15], s29 offen offset:3072 lds
    s_cmp_lg_u32 s24, 0
    s_cbranch_scc1 .sg_201
    s_mov_b64 exec, 1
    v_mov_b32 v4, 1
    v_mov_b32 v5, 0
    buffer_atomic_add v4, v5, s[20:23], 0 offen offset:36 sc1
    s_mov_b64 exec, -1
.sg_201:
    s_waitcnt vmcnt(16)
    ds_read_b64_tr_b16 a[192:193], v243 offset:0
    ds_read_b64_tr_b16 a[194:195], v243 offset:256
    ds_read_b64_tr_b16 a[196:197], v243 offset:8
    ds_read_b64_tr_b16 a[198:199], v243 offset:264
    ds_read_b64_tr_b16 a[200:201], v243 offset:2048
    ds_read_b64_tr_b16 a[202:203], v243 offset:2304
    ds_read_b64_tr_b16 a[204:205], v243 offset:2056
    ds_read_b64_tr_b16 a[206:207], v243 offset:2312
    ds_read_b64_tr_b16 a[208:209], v243 offset:4096
    ds_read_b64_tr_b16 a[210:211], v243 offset:4352
    ds_read_b64_tr_b16 a[212:213], v243 offset:4104
    ds_read_b64_tr_b16 a[214:215], v243 offset:4360
    ds_read_b64_tr_b16 a[216:217], v243 offset:6144
    ds_read_b64_tr_b16 a[218:219], v243 offset:6400
    ds_read_b64_tr_b16 a[220:221], v243 offset:6152
    ds_read_b64_tr_b16 a[222:223], v243 offset:6408
    ds_read_b64_tr_b16 a[224:225], v243 offset:8192
    ds_read_b64_tr_b16 a[226:227], v243 offset:8448
    ds_read_b64_tr_b16 a[228:229], v243 offset:8200
    ds_read_b64_tr_b16 a[230:231], v243 offset:8456
    ds_read_b64_tr_b16 a[232:233], v243 offset:10240
    ds_read_b64_tr_b16 a[234:235], v243 offset:10496
    ds_read_b64_tr_b16 a[236:237], v243 offset:10248
    ds_read_b64_tr_b16 a[238:239], v243 offset:10504
    ds_read_b64_tr_b16 a[240:241], v243 offset:12288
    ds_read_b64_tr_b16 a[242:243], v243 offset:12544
    ds_read_b64_tr_b16 a[244:245], v243 offset:12296
    ds_read_b64_tr_b16 a[246:247], v243 offset:12552
    ds_read_b64_tr_b16 a[248:249], v243 offset:14336
    ds_read_b64_tr_b16 a[250:251], v243 offset:14592
    ds_read_b64_tr_b16 a[252:253], v243 offset:14344
    ds_read_b64_tr_b16 a[254:255], v243 offset:14600
    s_waitcnt lgkmcnt(0)
    s_waitcnt vmcnt(0)
    s_barrier
    s_mov_b32 s29, 0x10000
    ds_read_b128 v[64:67], v8 offset:0
    ds_read_b128 v[68:71], v8 offset:32768
    ds_read_b128 v[72:75], v9 offset:0
    ds_read_b128 v[76:79], v9 offset:32768
    ds_read_b128 v[80:83], v10 offset:0
    ds_read_b128 v[84:87], v10 offset:32768
    ds_read_b128 v[88:91], v11 offset:0
    ds_read_b128 v[92:95], v11 offset:32768
    ds_read_b128 v[96:99], v8 offset:256
    ds_read_b128 v[100:103], v8 offset:33024
    ds_read_b128 v[104:107], v9 offset:256
    ds_read_b128 v[108:111], v9 offset:33024
    ds_read_b128 v[112:115], v10 offset:256
    ds_read_b128 v[116:119], v10 offset:33024
    ds_read_b128 v[120:123], v11 offset:256
    ds_read_b128 v[124:127], v11 offset:33024
    s_add_u32 m0, s6, 65536
    s_nop 0
    buffer_load_dwordx4 v16, s[12:15], s29 offen offset:0 lds
    buffer_load_dwordx4 v16, s[12:15], s29 offen offset:1024 lds
    buffer_load_dwordx4 v17, s[12:15], s29 offen offset:2048 lds
    buffer_load_dwordx4 v17, s[12:15], s29 offen offset:3072 lds
    s_add_u32 m0, s6, 69632
    s_nop 0
    buffer_load_dwordx4 v18, s[12:15], s29 offen offset:0 lds
    buffer_load_dwordx4 v18, s[12:15], s29 offen offset:1024 lds
    s_cmp_eq_u32 s98, 2
    s_cbranch_scc1 .vt_202
.p2align 6
.ql_204:
    s_waitcnt lgkmcnt(12)
    v_mfma_f32_16x16x32_bf16 v[192:195], a[0:3], v[64:67], 0
    ds_read_b128 v[128:131], v8 offset:512
    v_mfma_f32_16x16x32_bf16 v[196:199], a[4:7], v[64:67], 0
    v_mfma_f32_16x16x32_bf16 v[200:203], a[0:3], v[68:71], 0
    ds_read_b128 v[132:135], v8 offset:33280
    v_mfma_f32_16x16x32_bf16 v[204:207], a[4:7], v[68:71], 0
    buffer_load_dwordx4 v19, s[12:15], s29 offen offset:2048 lds
    v_mfma_f32_16x16x32_bf16 v[192:195], a[8:11], v[72:75], v[192:195]
    ds_read_b128 v[136:139], v9 offset:512
    v_mfma_f32_16x16x32_bf16 v[196:199], a[12:15], v[72:75], v[196:199]
    v_cvt_pk_bf16_f32 v224, v208, v209
    v_cvt_pk_bf16_f32 v225, v210, v211
    v_mfma_f32_16x16x32_bf16 v[200:203], a[8:11], v[76:79], v[200:203]
    ds_read_b128 v[140:143], v9 offset:33280
    v_mfma_f32_16x16x32_bf16 v[204:207], a[12:15], v[76:79], v[204:207]
    buffer_load_dwordx4 v19, s[12:15], s29 offen offset:3072 lds
    s_waitcnt lgkmcnt(12)
    v_mfma_f32_16x16x32_bf16 v[192:195], a[16:19], v[80:83], v[192:195]
    ds_read_b128 v[144:147], v10 offset:512
    v_mfma_f32_16x16x32_bf16 v[196:199], a[20:23], v[80:83], v[196:199]
    s_add_u32 m0, s6, 73728
    v_cvt_pk_bf16_f32 v226, v212, v213
    v_cvt_pk_bf16_f32 v227, v214, v215
    v_mfma_f32_16x16x32_bf16 v[200:203], a[16:19], v[84:87], v[200:203]
    ds_read_b128 v[148:151], v10 offset:33280
    v_mfma_f32_16x16x32_bf16 v[204:207], a[20:23], v[84:87], v[204:207]
    buffer_load_dwordx4 v20, s[12:15], s29 offen offset:0 lds
    v_mfma_f32_16x16x32_bf16 v[192:195], a[24:27], v[88:91], v[192:195]
    ds_read_b128 v[152:155], v11 offset:512
    v_cvt_pk_bf16_f32 v228, v216, v217
    v_mfma_f32_16x16x32_bf16 v[196:199], a[28:31], v[88:91], v[196:199]
    buffer_store_dwordx4 v[224:227], v24, s[8:11], s30 offen sc1
    v_mfma_f32_16x16x32_bf16 v[200:203], a[24:27], v[92:95], v[200:203]
    ds_read_b128 v[156:159], v11 offset:33280
    v_cvt_pk_bf16_f32 v229, v218, v219
    v_mfma_f32_16x16x32_bf16 v[204:207], a[28:31], v[92:95], v[204:207]
    buffer_load_dwordx4 v20, s[12:15], s29 offen offset:1024 lds
    s_waitcnt lgkmcnt(12)
    v_mfma_f32_16x16x32_bf16 v[192:195], a[32:35], v[96:99], v[192:195]
    ds_read_b128 v[160:163], v8 offset:768
    v_mfma_f32_16x16x32_bf16 v[196:199], a[36:39], v[96:99], v[196:199]
    v_cvt_pk_bf16_f32 v230, v220, v221
    v_cvt_pk_bf16_f32 v231, v222, v223
    v_mfma_f32_16x16x32_bf16 v[200:203], a[32:35], v[100:103], v[200:203]
    ds_read_b128 v[164:167], v8 offset:33536
    v_mfma_f32_16x16x32_bf16 v[204:207], a[36:39], v[100:103], v[204:207]
    buffer_load_dwordx4 v21, s[12:15], s29 offen offset:2048 lds
    v_mfma_f32_16x16x32_bf16 v[192:195], a[40:43], v[104:107], v[192:195]
    ds_read_b128 v[168:171], v9 offset:768
    v_mfma_f32_16x16x32_bf16 v[196:199], a[44:47], v[104:107], v[196:199]
    buffer_store_dwordx4 v[228:231], v25, s[8:11], s30 offen sc1
    v_mfma_f32_16x16x32_bf16 v[200:203], a[40:43], v[108:111], v[200:203]
    ds_read_b128 v[172:175], v9 offset:33536
    v_mfma_f32_16x16x32_bf16 v[204:207], a[44:47], v[108:111], v[204:207]
    buffer_load_dwordx4 v21, s[12:15], s29 offen offset:3072 lds
    s_waitcnt lgkmcnt(12)
    v_mfma_f32_16x16x32_bf16 v[192:195], a[48:51], v[112:115], v[192:195]
    ds_read_b128 v[176:179], v10 offset:768
    v_mfma_f32_16x16x32_bf16 v[196:199], a[52:55], v[112:115], v[196:199]
    s_add_u32 m0, s6, 77824
    s_mov_b32 s30, s31
    v_mfma_f32_16x16x32_bf16 v[200:203], a[48:51], v[116:119], v[200:203]
    ds_read_b128 v[180:183], v10 offset:33536
    v_mfma_f32_16x16x32_bf16 v[204:207], a[52:55], v[116:119], v[204:207]
    buffer_load_dwordx4 v22, s[12:15], s29 offen offset:0 lds
    v_mfma_f32_16x16x32_bf16 v[192:195], a[56:59], v[120:123], v[192:195]
    ds_read_b128 v[184:187], v11 offset:768
    v_mfma_f32_16x16x32_bf16 v[196:199], a[60:63], v[120:123], v[196:199]
    s_add_u32 s31, s31, 262144
    v_mfma_f32_16x16x32_bf16 v[200:203], a[56:59], v[124:127], v[200:203]
    ds_read_b128 v[188:191], v11 offset:33536
    v_mfma_f32_16x16x32_bf16 v[204:207], a[60:63], v[124:127], v[204:207]
    buffer_load_dwordx4 v22, s[12:15], s29 offen offset:1024 lds
    s_waitcnt lgkmcnt(12)
    v_mfma_f32_16x16x32_bf16 v[192:195], a[64:67], v[128:131], v[192:195]
    ds_read_b128 v[64:67], v8 offset:1024
    v_mfma_f32_16x16x32_bf16 v[196:199], a[68:71], v[128:131], v[196:199]
    v_mfma_f32_16x16x32_bf16 v[200:203], a[64:67], v[132:135], v[200:203]
    ds_read_b128 v[68:71], v8 offset:33792
    v_mfma_f32_16x16x32_bf16 v[204:207], a[68:71], v[132:135], v[204:207]
    buffer_load_dwordx4 v23, s[12:15], s29 offen offset:2048 lds
    v_mfma_f32_16x16x32_bf16 v[192:195], a[72:75], v[136:139], v[192:195]
    ds_read_b128 v[72:75], v9 offset:1024
    v_mfma_f32_16x16x32_bf16 v[196:199], a[76:79], v[136:139], v[196:199]
    v_mfma_f32_16x16x32_bf16 v[200:203], a[72:75], v[140:143], v[200:203]
    ds_read_b128 v[76:79], v9 offset:33792
    v_mfma_f32_16x16x32_bf16 v[204:207], a[76:79], v[140:143], v[204:207]
    buffer_load_dwordx4 v23, s[12:15], s29 offen offset:3072 lds
    s_waitcnt lgkmcnt(12)
    v_mfma_f32_16x16x32_bf16 v[192:195], a[80:83], v[144:147], v[192:195]
    ds_read_b128 v[80:83], v10 offset:1024
    v_mfma_f32_16x16x32_bf16 v[196:199], a[84:87], v[144:147], v[196:199]
    v_mfma_f32_16x16x32_bf16 v[200:203], a[80:83], v[148:151], v[200:203]
    ds_read_b128 v[84:87], v10 offset:33792
    v_mfma_f32_16x16x32_bf16 v[204:207], a[84:87], v[148:151], v[204:207]
    buffer_load_dword v29, v28, s[12:15], s29 offen
    v_mfma_f32_16x16x32_bf16 v[192:195], a[88:91], v[152:155], v[192:195]
    ds_read_b128 v[88:91], v11 offset:1024
    v_mfma_f32_16x16x32_bf16 v[196:199], a[92:95], v[152:155], v[196:199]
    v_mfma_f32_16x16x32_bf16 v[200:203], a[88:91], v[156:159], v[200:203]
    ds_read_b128 v[92:95], v11 offset:33792
    v_mfma_f32_16x16x32_bf16 v[204:207], a[92:95], v[156:159], v[204:207]
    s_waitcnt lgkmcnt(12)
    v_mfma_f32_16x16x32_bf16 v[192:195], a[96:99], v[160:163], v[192:195]
    ds_read_b128 v[96:99], v8 offset:1280
    v_mfma_f32_16x16x32_bf16 v[196:199], a[100:103], v[160:163], v[196:199]
    v_mfma_f32_16x16x32_bf16 v[200:203], a[96:99], v[164:167], v[200:203]
    ds_read_b128 v[100:103], v8 offset:34048
    v_mfma_f32_16x16x32_bf16 v[204:207], a[100:103], v[164:167], v[204:207]
    v_mfma_f32_16x16x32_bf16 v[192:195], a[104:107], v[168:171], v[192:195]
    ds_read_b128 v[104:107], v9 offset:1280
    v_mfma_f32_16x16x32_bf16 v[196:199], a[108:111], v[168:171], v[196:199]
    v_mfma_f32_16x16x32_bf16 v[200:203], a[104:107], v[172:175], v[200:203]
    ds_read_b128 v[108:111], v9 offset:34048
    v_mfma_f32_16x16x32_bf16 v[204:207], a[108:111], v[172:175], v[204:207]
    s_waitcnt lgkmcnt(12)
    v_mfma_f32_16x16x32_bf16 v[192:195], a[112:115], v[176:179], v[192:195]
    ds_read_b128 v[112:115], v10 offset:1280
    v_mfma_f32_16x16x32_bf16 v[196:199], a[116:119], v[176:179], v[196:199]
    v_mfma_f32_16x16x32_bf16 v[200:203], a[112:115], v[180:183], v[200:203]
    ds_read_b128 v[116:119], v10 offset:34048
    v_mfma_f32_16x16x32_bf16 v[204:207], a[116:119], v[180:183], v[204:207]
    v_mfma_f32_16x16x32_bf16 v[192:195], a[120:123], v[184:187], v[192:195]
    ds_read_b128 v[120:123], v11 offset:1280
    v_mfma_f32_16x16x32_bf16 v[196:199], a[124:127], v[184:187], v[196:199]
    v_mfma_f32_16x16x32_bf16 v[200:203], a[120:123], v[188:191], v[200:203]
    ds_read_b128 v[124:127], v11 offset:34048
    v_mfma_f32_16x16x32_bf16 v[204:207], a[124:127], v[188:191], v[204:207]
    s_waitcnt lgkmcnt(12)
    v_mfma_f32_16x16x32_bf16 v[192:195], a[128:131], v[64:67], v[192:195]
    ds_read_b128 v[128:131], v8 offset:1536
    v_mfma_f32_16x16x32_bf16 v[196:199], a[132:135], v[64:67], v[196:199]
    v_mfma_f32_16x16x32_bf16 v[200:203], a[128:131], v[68:71], v[200:203]
    ds_read_b128 v[132:135], v8 offset:34304
    v_mfma_f32_16x16x32_bf16 v[204:207], a[132:135], v[68:71], v[204:207]
    v_mfma_f32_16x16x32_bf16 v[192:195], a[136:139], v[72:75], v[192:195]
    ds_read_b128 v[136:139], v9 offset:1536
    v_mfma_f32_16x16x32_bf16 v[196:199], a[140:143], v[72:75], v[196:199]
    v_mfma_f32_16x16x32_bf16 v[200:203], a[136:139], v[76:79], v[200:203]
    ds_read_b128 v[140:143], v9 offset:34304
    v_mfma_f32_16x16x32_bf16 v[204:207], a[140:143], v[76:79], v[204:207]
    s_waitcnt lgkmcnt(12)
    v_mfma_f32_16x16x32_bf16 v[192:195], a[144:147], v[80:83], v[192:195]
    ds_read_b128 v[144:147], v10 offset:1536
    v_mfma_f32_16x16x32_bf16 v[196:199], a[148:151], v[80:83], v[196:199]
    v_mfma_f32_16x16x32_bf16 v[200:203], a[144:147], v[84:87], v[200:203]
    ds_read_b128 v[148:151], v10 offset:34304
    v_mfma_f32_16x16x32_bf16 v[204:207], a[148:151], v[84:87], v[204:207]
    v_mfma_f32_16x16x32_bf16 v[192:195], a[152:155], v[88:91], v[192:195]
    ds_read_b128 v[152:155], v11 offset:1536
    v_mfma_f32_16x16x32_bf16 v[196:199], a[156:159], v[88:91], v[196:199]
    v_mfma_f32_16x16x32_bf16 v[200:203], a[152:155], v[92:95], v[200:203]
    ds_read_b128 v[156:159], v11 offset:34304
    v_mfma_f32_16x16x32_bf16 v[204:207], a[156:159], v[92:95], v[204:207]
    s_waitcnt lgkmcnt(12)
    v_mfma_f32_16x16x32_bf16 v[192:195], a[160:163], v[96:99], v[192:195]
    ds_read_b128 v[160:163], v8 offset:1792
    v_mfma_f32_16x16x32_bf16 v[196:199], a[164:167], v[96:99], v[196:199]
    v_mfma_f32_16x16x32_bf16 v[200:203], a[160:163], v[100:103], v[200:203]
    ds_read_b128 v[164:167], v8 offset:34560
    v_mfma_f32_16x16x32_bf16 v[204:207], a[164:167], v[100:103], v[204:207]
    v_mfma_f32_16x16x32_bf16 v[192:195], a[168:171], v[104:107], v[192:195]
    ds_read_b128 v[168:171], v9 offset:1792
    v_mfma_f32_16x16x32_bf16 v[196:199], a[172:175], v[104:107], v[196:199]
    v_mfma_f32_16x16x32_bf16 v[200:203], a[168:171], v[108:111], v[200:203]
    ds_read_b128 v[172:175], v9 offset:34560
    v_mfma_f32_16x16x32_bf16 v[204:207], a[172:175], v[108:111], v[204:207]
    s_waitcnt lgkmcnt(12)
    v_mfma_f32_16x16x32_bf16 v[192:195], a[176:179], v[112:115], v[192:195]
    ds_read_b128 v[176:179], v10 offset:1792
    v_mfma_f32_16x16x32_bf16 v[196:199], a[180:183], v[112:115], v[196:199]
    s_waitcnt vmcnt(6)
    v_mov_b32 v27, s28
    s_mov_b64 exec, 1
    buffer_store_dword v27, v26, s[8:11], s94 offen sc1
    s_mov_b64 exec, -1
    v_mfma_f32_16x16x32_bf16 v[200:203], a[176:179], v[116:119], v[200:203]
    ds_read_b128 v[180:183], v10 offset:34560
    v_mfma_f32_16x16x32_bf16 v[204:207], a[180:183], v[116:119], v[204:207]
    v_mfma_f32_16x16x32_bf16 v[192:195], a[184:187], v[120:123], v[192:195]
    ds_read_b128 v[184:187], v11 offset:1792
    v_mfma_f32_16x16x32_bf16 v[196:199], a[188:191], v[120:123], v[196:199]
    s_add_u32 s28, s28, 1
    v_mfma_f32_16x16x32_bf16 v[200:203], a[184:187], v[124:127], v[200:203]
    ds_read_b128 v[188:191], v11 offset:34560
    v_mfma_f32_16x16x32_bf16 v[204:207], a[188:191], v[124:127], v[204:207]
    s_waitcnt lgkmcnt(12)
    v_mfma_f32_16x16x32_bf16 v[192:195], a[192:195], v[128:131], v[192:195]
    v_mfma_f32_16x16x32_bf16 v[196:199], a[196:199], v[128:131], v[196:199]
    v_mfma_f32_16x16x32_bf16 v[200:203], a[192:195], v[132:135], v[200:203]
    v_mfma_f32_16x16x32_bf16 v[204:207], a[196:199], v[132:135], v[204:207]
    v_mfma_f32_16x16x32_bf16 v[192:195], a[200:203], v[136:139], v[192:195]
    v_mfma_f32_16x16x32_bf16 v[196:199], a[204:207], v[136:139], v[196:199]
    s_add_u32 s29, s29, 0x10000
    s_min_u32 s29, s29, 0x3f0000
    v_mfma_f32_16x16x32_bf16 v[200:203], a[200:203], v[140:143], v[200:203]
    v_mfma_f32_16x16x32_bf16 v[204:207], a[204:207], v[140:143], v[204:207]
    s_waitcnt vmcnt(2) lgkmcnt(0)
    s_barrier
    v_mfma_f32_16x16x32_bf16 v[192:195], a[208:211], v[144:147], v[192:195]
    ds_read_b128 v[64:67], v12 offset:0
    ds_read_b128 v[68:71], v12 offset:32768
    v_mfma_f32_16x16x32_bf16 v[196:199], a[212:215], v[144:147], v[196:199]
    s_add_u32 m0, s6, 0
    v_mfma_f32_16x16x32_bf16 v[200:203], a[208:211], v[148:151], v[200:203]
    ds_read_b128 v[72:75], v13 offset:0
    ds_read_b128 v[76:79], v13 offset:32768
    v_mfma_f32_16x16x32_bf16 v[204:207], a[212:215], v[148:151], v[204:207]
    buffer_load_dwordx4 v16, s[12:15], s29 offen offset:0 lds
    v_mfma_f32_16x16x32_bf16 v[192:195], a[216:219], v[152:155], v[192:195]
    ds_read_b128 v[80:83], v14 offset:0
    ds_read_b128 v[84:87], v14 offset:32768
    v_mfma_f32_16x16x32_bf16 v[196:199], a[220:223], v[152:155], v[196:199]
    v_mfma_f32_16x16x32_bf16 v[200:203], a[216:219], v[156:159], v[200:203]
    ds_read_b128 v[88:91], v15 offset:0
    ds_read_b128 v[92:95], v15 offset:32768
    v_mfma_f32_16x16x32_bf16 v[204:207], a[220:223], v[156:159], v[204:207]
    buffer_load_dwordx4 v16, s[12:15], s29 offen offset:1024 lds
    v_mfma_f32_16x16x32_bf16 v[192:195], a[224:227], v[160:163], v[192:195]
    ds_read_b128 v[96:99], v12 offset:256
    v_mfma_f32_16x16x32_bf16 v[196:199], a[228:231], v[160:163], v[196:199]
    v_mfma_f32_16x16x32_bf16 v[200:203], a[224:227], v[164:167], v[200:203]
    ds_read_b128 v[100:103], v12 offset:33024
    v_mfma_f32_16x16x32_bf16 v[204:207], a[228:231], v[164:167], v[204:207]
    buffer_load_dwordx4 v17, s[12:15], s29 offen offset:2048 lds
    v_mfma_f32_16x16x32_bf16 v[192:195], a[232:235], v[168:171], v[192:195]
    ds_read_b128 v[104:107], v13 offset:256
    v_mfma_f32_16x16x32_bf16 v[196:199], a[236:239], v[168:171], v[196:199]
    v_mfma_f32_16x16x32_bf16 v[200:203], a[232:235], v[172:175], v[200:203]
    ds_read_b128 v[108:111], v13 offset:33024
    v_mfma_f32_16x16x32_bf16 v[204:207], a[236:239], v[172:175], v[204:207]
    buffer_load_dwordx4 v17, s[12:15], s29 offen offset:3072 lds
    v_mfma_f32_16x16x32_bf16 v[192:195], a[240:243], v[176:179], v[192:195]
    ds_read_b128 v[112:115], v14 offset:256
    v_mfma_f32_16x16x32_bf16 v[196:199], a[244:247], v[176:179], v[196:199]
    s_add_u32 m0, s6, 4096
    v_mfma_f32_16x16x32_bf16 v[200:203], a[240:243], v[180:183], v[200:203]
    ds_read_b128 v[116:119], v14 offset:33024
    v_mfma_f32_16x16x32_bf16 v[204:207], a[244:247], v[180:183], v[204:207]
    buffer_load_dwordx4 v18, s[12:15], s29 offen offset:0 lds
    v_mfma_f32_16x16x32_bf16 v[192:195], a[248:251], v[184:187], v[192:195]
    ds_read_b128 v[120:123], v15 offset:256
    v_mfma_f32_16x16x32_bf16 v[196:199], a[252:255], v[184:187], v[196:199]
    v_mfma_f32_16x16x32_bf16 v[200:203], a[248:251], v[188:191], v[200:203]
    ds_read_b128 v[124:127], v15 offset:33024
    v_mfma_f32_16x16x32_bf16 v[204:207], a[252:255], v[188:191], v[204:207]
    buffer_load_dwordx4 v18, s[12:15], s29 offen offset:1024 lds
    s_waitcnt lgkmcnt(12)
    v_mfma_f32_16x16x32_bf16 v[208:211], a[0:3], v[64:67], 0
    ds_read_b128 v[128:131], v12 offset:512
    v_mfma_f32_16x16x32_bf16 v[212:215], a[4:7], v[64:67], 0
    v_mfma_f32_16x16x32_bf16 v[216:219], a[0:3], v[68:71], 0
    ds_read_b128 v[132:135], v12 offset:33280
    v_mfma_f32_16x16x32_bf16 v[220:223], a[4:7], v[68:71], 0
    buffer_load_dwordx4 v19, s[12:15], s29 offen offset:2048 lds
    v_mfma_f32_16x16x32_bf16 v[208:211], a[8:11], v[72:75], v[208:211]
    ds_read_b128 v[136:139], v13 offset:512
    v_mfma_f32_16x16x32_bf16 v[212:215], a[12:15], v[72:75], v[212:215]
    v_cvt_pk_bf16_f32 v224, v192, v193
    v_cvt_pk_bf16_f32 v225, v194, v195
    v_mfma_f32_16x16x32_bf16 v[216:219], a[8:11], v[76:79], v[216:219]
    ds_read_b128 v[140:143], v13 offset:33280
    v_mfma_f32_16x16x32_bf16 v[220:223], a[12:15], v[76:79], v[220:223]
    buffer_load_dwordx4 v19, s[12:15], s29 offen offset:3072 lds
    s_waitcnt lgkmcnt(12)
    v_mfma_f32_16x16x32_bf16 v[208:211], a[16:19], v[80:83], v[208:211]
    ds_read_b128 v[144:147], v14 offset:512
    v_mfma_f32_16x16x32_bf16 v[212:215], a[20:23], v[80:83], v[212:215]
    s_add_u32 m0, s6, 8192
    v_cvt_pk_bf16_f32 v226, v196, v197
    v_cvt_pk_bf16_f32 v227, v198, v199
    v_mfma_f32_16x16x32_bf16 v[216:219], a[16:19], v[84:87], v[216:219]
    ds_read_b128 v[148:151], v14 offset:33280
    v_mfma_f32_16x16x32_bf16 v[220:223], a[20:23], v[84:87], v[220:223]
    buffer_load_dwordx4 v20, s[12:15], s29 offen offset:0 lds
    v_mfma_f32_16x16x32_bf16 v[208:211], a[24:27], v[88:91], v[208:211]
    ds_read_b128 v[152:155], v15 offset:512
    v_cvt_pk_bf16_f32 v228, v200, v201
    v_mfma_f32_16x16x32_bf16 v[212:215], a[28:31], v[88:91], v[212:215]
    buffer_store_dwordx4 v[224:227], v24, s[8:11], s30 offen sc1
    v_mfma_f32_16x16x32_bf16 v[216:219], a[24:27], v[92:95], v[216:219]
    ds_read_b128 v[156:159], v15 offset:33280
    v_cvt_pk_bf16_f32 v229, v202, v203
    v_mfma_f32_16x16x32_bf16 v[220:223], a[28:31], v[92:95], v[220:223]
    buffer_load_dwordx4 v20, s[12:15], s29 offen offset:1024 lds
    s_waitcnt lgkmcnt(12)
    v_mfma_f32_16x16x32_bf16 v[208:211], a[32:35], v[96:99], v[208:211]
    ds_read_b128 v[160:163], v12 offset:768
    v_mfma_f32_16x16x32_bf16 v[212:215], a[36:39], v[96:99], v[212:215]
    v_cvt_pk_bf16_f32 v230, v204, v205
    v_cvt_pk_bf16_f32 v231, v206, v207
    v_mfma_f32_16x16x32_bf16 v[216:219], a[32:35], v[100:103], v[216:219]
    ds_read_b128 v[164:167], v12 offset:33536
    v_mfma_f32_16x16x32_bf16 v[220:223], a[36:39], v[100:103], v[220:223]
    buffer_load_dwordx4 v21, s[12:15], s29 offen offset:2048 lds
    v_mfma_f32_16x16x32_bf16 v[208:211], a[40:43], v[104:107], v[208:211]
    ds_read_b128 v[168:171], v13 offset:768
    v_mfma_f32_16x16x32_bf16 v[212:215], a[44:47], v[104:107], v[212:215]
    buffer_store_dwordx4 v[228:231], v25, s[8:11], s30 offen sc1
    v_mfma_f32_16x16x32_bf16 v[216:219], a[40:43], v[108:111], v[216:219]
    ds_read_b128 v[172:175], v13 offset:33536
    v_mfma_f32_16x16x32_bf16 v[220:223], a[44:47], v[108:111], v[220:223]
    buffer_load_dwordx4 v21, s[12:15], s29 offen offset:3072 lds
    s_waitcnt lgkmcnt(12)
    v_mfma_f32_16x16x32_bf16 v[208:211], a[48:51], v[112:115], v[208:211]
    ds_read_b128 v[176:179], v14 offset:768
    v_mfma_f32_16x16x32_bf16 v[212:215], a[52:55], v[112:115], v[212:215]
    s_add_u32 m0, s6, 12288
    s_mov_b32 s30, s31
    v_mfma_f32_16x16x32_bf16 v[216:219], a[48:51], v[116:119], v[216:219]
    ds_read_b128 v[180:183], v14 offset:33536
    v_mfma_f32_16x16x32_bf16 v[220:223], a[52:55], v[116:119], v[220:223]
    buffer_load_dwordx4 v22, s[12:15], s29 offen offset:0 lds
    v_mfma_f32_16x16x32_bf16 v[208:211], a[56:59], v[120:123], v[208:211]
    ds_read_b128 v[184:187], v15 offset:768
    v_mfma_f32_16x16x32_bf16 v[212:215], a[60:63], v[120:123], v[212:215]
    s_add_u32 s31, s31, 262144
    v_mfma_f32_16x16x32_bf16 v[216:219], a[56:59], v[124:127], v[216:219]
    ds_read_b128 v[188:191], v15 offset:33536
    v_mfma_f32_16x16x32_bf16 v[220:223], a[60:63], v[124:127], v[220:223]
    buffer_load_dwordx4 v22, s[12:15], s29 offen offset:1024 lds
    s_waitcnt lgkmcnt(12)
    v_mfma_f32_16x16x32_bf16 v[208:211], a[64:67], v[128:131], v[208:211]
    ds_read_b128 v[64:67], v12 offset:1024
    v_mfma_f32_16x16x32_bf16 v[212:215], a[68:71], v[128:131], v[212:215]
    v_mfma_f32_16x16x32_bf16 v[216:219], a[64:67], v[132:135], v[216:219]
    ds_read_b128 v[68:71], v12 offset:33792
    v_mfma_f32_16x16x32_bf16 v[220:223], a[68:71], v[132:135], v[220:223]
    buffer_load_dwordx4 v23, s[12:15], s29 offen offset:2048 lds
    v_mfma_f32_16x16x32_bf16 v[208:211], a[72:75], v[136:139], v[208:211]
    ds_read_b128 v[72:75], v13 offset:1024
    v_mfma_f32_16x16x32_bf16 v[212:215], a[76:79], v[136:139], v[212:215]
    v_mfma_f32_16x16x32_bf16 v[216:219], a[72:75], v[140:143], v[216:219]
    ds_read_b128 v[76:79], v13 offset:33792
    v_mfma_f32_16x16x32_bf16 v[220:223], a[76:79], v[140:143], v[220:223]
    buffer_load_dwordx4 v23, s[12:15], s29 offen offset:3072 lds
    s_waitcnt lgkmcnt(12)
    v_mfma_f32_16x16x32_bf16 v[208:211], a[80:83], v[144:147], v[208:211]
    ds_read_b128 v[80:83], v14 offset:1024
    v_mfma_f32_16x16x32_bf16 v[212:215], a[84:87], v[144:147], v[212:215]
    v_mfma_f32_16x16x32_bf16 v[216:219], a[80:83], v[148:151], v[216:219]
    ds_read_b128 v[84:87], v14 offset:33792
    v_mfma_f32_16x16x32_bf16 v[220:223], a[84:87], v[148:151], v[220:223]
    buffer_load_dword v29, v28, s[12:15], s29 offen
    v_mfma_f32_16x16x32_bf16 v[208:211], a[88:91], v[152:155], v[208:211]
    ds_read_b128 v[88:91], v15 offset:1024
    v_mfma_f32_16x16x32_bf16 v[212:215], a[92:95], v[152:155], v[212:215]
    v_mfma_f32_16x16x32_bf16 v[216:219], a[88:91], v[156:159], v[216:219]
    ds_read_b128 v[92:95], v15 offset:33792
    v_mfma_f32_16x16x32_bf16 v[220:223], a[92:95], v[156:159], v[220:223]
    s_waitcnt lgkmcnt(12)
    v_mfma_f32_16x16x32_bf16 v[208:211], a[96:99], v[160:163], v[208:211]
    ds_read_b128 v[96:99], v12 offset:1280
    v_mfma_f32_16x16x32_bf16 v[212:215], a[100:103], v[160:163], v[212:215]
    v_mfma_f32_16x16x32_bf16 v[216:219], a[96:99], v[164:167], v[216:219]
    ds_read_b128 v[100:103], v12 offset:34048
    v_mfma_f32_16x16x32_bf16 v[220:223], a[100:103], v[164:167], v[220:223]
    v_mfma_f32_16x16x32_bf16 v[208:211], a[104:107], v[168:171], v[208:211]
    ds_read_b128 v[104:107], v13 offset:1280
    v_mfma_f32_16x16x32_bf16 v[212:215], a[108:111], v[168:171], v[212:215]
    v_mfma_f32_16x16x32_bf16 v[216:219], a[104:107], v[172:175], v[216:219]
    ds_read_b128 v[108:111], v13 offset:34048
    v_mfma_f32_16x16x32_bf16 v[220:223], a[108:111], v[172:175], v[220:223]
    s_waitcnt lgkmcnt(12)
    v_mfma_f32_16x16x32_bf16 v[208:211], a[112:115], v[176:179], v[208:211]
    ds_read_b128 v[112:115], v14 offset:1280
    v_mfma_f32_16x16x32_bf16 v[212:215], a[116:119], v[176:179], v[212:215]
    v_mfma_f32_16x16x32_bf16 v[216:219], a[112:115], v[180:183], v[216:219]
    ds_read_b128 v[116:119], v14 offset:34048
    v_mfma_f32_16x16x32_bf16 v[220:223], a[116:119], v[180:183], v[220:223]
    v_mfma_f32_16x16x32_bf16 v[208:211], a[120:123], v[184:187], v[208:211]
    ds_read_b128 v[120:123], v15 offset:1280
    v_mfma_f32_16x16x32_bf16 v[212:215], a[124:127], v[184:187], v[212:215]
    v_mfma_f32_16x16x32_bf16 v[216:219], a[120:123], v[188:191], v[216:219]
    ds_read_b128 v[124:127], v15 offset:34048
    v_mfma_f32_16x16x32_bf16 v[220:223], a[124:127], v[188:191], v[220:223]
    s_waitcnt lgkmcnt(12)
    v_mfma_f32_16x16x32_bf16 v[208:211], a[128:131], v[64:67], v[208:211]
    ds_read_b128 v[128:131], v12 offset:1536
    v_mfma_f32_16x16x32_bf16 v[212:215], a[132:135], v[64:67], v[212:215]
    v_mfma_f32_16x16x32_bf16 v[216:219], a[128:131], v[68:71], v[216:219]
    ds_read_b128 v[132:135], v12 offset:34304
    v_mfma_f32_16x16x32_bf16 v[220:223], a[132:135], v[68:71], v[220:223]
    v_mfma_f32_16x16x32_bf16 v[208:211], a[136:139], v[72:75], v[208:211]
    ds_read_b128 v[136:139], v13 offset:1536
    v_mfma_f32_16x16x32_bf16 v[212:215], a[140:143], v[72:75], v[212:215]
    v_mfma_f32_16x16x32_bf16 v[216:219], a[136:139], v[76:79], v[216:219]
    ds_read_b128 v[140:143], v13 offset:34304
    v_mfma_f32_16x16x32_bf16 v[220:223], a[140:143], v[76:79], v[220:223]
    s_waitcnt lgkmcnt(12)
    v_mfma_f32_16x16x32_bf16 v[208:211], a[144:147], v[80:83], v[208:211]
    ds_read_b128 v[144:147], v14 offset:1536
    v_mfma_f32_16x16x32_bf16 v[212:215], a[148:151], v[80:83], v[212:215]
    v_mfma_f32_16x16x32_bf16 v[216:219], a[144:147], v[84:87], v[216:219]
    ds_read_b128 v[148:151], v14 offset:34304
    v_mfma_f32_16x16x32_bf16 v[220:223], a[148:151], v[84:87], v[220:223]
    v_mfma_f32_16x16x32_bf16 v[208:211], a[152:155], v[88:91], v[208:211]
    ds_read_b128 v[152:155], v15 offset:1536
    v_mfma_f32_16x16x32_bf16 v[212:215], a[156:159], v[88:91], v[212:215]
    v_mfma_f32_16x16x32_bf16 v[216:219], a[152:155], v[92:95], v[216:219]
    ds_read_b128 v[156:159], v15 offset:34304
    v_mfma_f32_16x16x32_bf16 v[220:223], a[156:159], v[92:95], v[220:223]
    s_waitcnt lgkmcnt(12)
    v_mfma_f32_16x16x32_bf16 v[208:211], a[160:163], v[96:99], v[208:211]
    ds_read_b128 v[160:163], v12 offset:1792
    v_mfma_f32_16x16x32_bf16 v[212:215], a[164:167], v[96:99], v[212:215]
    v_mfma_f32_16x16x32_bf16 v[216:219], a[160:163], v[100:103], v[216:219]
    ds_read_b128 v[164:167], v12 offset:34560
    v_mfma_f32_16x16x32_bf16 v[220:223], a[164:167], v[100:103], v[220:223]
    v_mfma_f32_16x16x32_bf16 v[208:211], a[168:171], v[104:107], v[208:211]
    ds_read_b128 v[168:171], v13 offset:1792
    v_mfma_f32_16x16x32_bf16 v[212:215], a[172:175], v[104:107], v[212:215]
    v_mfma_f32_16x16x32_bf16 v[216:219], a[168:171], v[108:111], v[216:219]
    ds_read_b128 v[172:175], v13 offset:34560
    v_mfma_f32_16x16x32_bf16 v[220:223], a[172:175], v[108:111], v[220:223]
    s_waitcnt lgkmcnt(12)
    v_mfma_f32_16x16x32_bf16 v[208:211], a[176:179], v[112:115], v[208:211]
    ds_read_b128 v[176:179], v14 offset:1792
    v_mfma_f32_16x16x32_bf16 v[212:215], a[180:183], v[112:115], v[212:215]
    s_waitcnt vmcnt(6)
    v_mov_b32 v27, s28
    s_mov_b64 exec, 1
    buffer_store_dword v27, v26, s[8:11], s94 offen sc1
    s_mov_b64 exec, -1
    v_mfma_f32_16x16x32_bf16 v[216:219], a[176:179], v[116:119], v[216:219]
    ds_read_b128 v[180:183], v14 offset:34560
    v_mfma_f32_16x16x32_bf16 v[220:223], a[180:183], v[116:119], v[220:223]
    v_mfma_f32_16x16x32_bf16 v[208:211], a[184:187], v[120:123], v[208:211]
    ds_read_b128 v[184:187], v15 offset:1792
    v_mfma_f32_16x16x32_bf16 v[212:215], a[188:191], v[120:123], v[212:215]
    s_add_u32 s28, s28, 1
    v_mfma_f32_16x16x32_bf16 v[216:219], a[184:187], v[124:127], v[216:219]
    ds_read_b128 v[188:191], v15 offset:34560
    v_mfma_f32_16x16x32_bf16 v[220:223], a[188:191], v[124:127], v[220:223]
    s_waitcnt lgkmcnt(12)
    v_mfma_f32_16x16x32_bf16 v[208:211], a[192:195], v[128:131], v[208:211]
    v_mfma_f32_16x16x32_bf16 v[212:215], a[196:199], v[128:131], v[212:215]
    v_mfma_f32_16x16x32_bf16 v[216:219], a[192:195], v[132:135], v[216:219]
    v_mfma_f32_16x16x32_bf16 v[220:223], a[196:199], v[132:135], v[220:223]
    v_mfma_f32_16x16x32_bf16 v[208:211], a[200:203], v[136:139], v[208:211]
    v_mfma_f32_16x16x32_bf16 v[212:215], a[204:207], v[136:139], v[212:215]
    s_add_u32 s29, s29, 0x10000
    s_min_u32 s29, s29, 0x3f0000
    v_mfma_f32_16x16x32_bf16 v[216:219], a[200:203], v[140:143], v[216:219]
    v_mfma_f32_16x16x32_bf16 v[220:223], a[204:207], v[140:143], v[220:223]
    s_waitcnt vmcnt(2) lgkmcnt(0)
    s_barrier
    v_mfma_f32_16x16x32_bf16 v[208:211], a[208:211], v[144:147], v[208:211]
    ds_read_b128 v[64:67], v8 offset:0
    ds_read_b128 v[68:71], v8 offset:32768
    v_mfma_f32_16x16x32_bf16 v[212:215], a[212:215], v[144:147], v[212:215]
    s_add_u32 m0, s6, 65536
    v_mfma_f32_16x16x32_bf16 v[216:219], a[208:211], v[148:151], v[216:219]
    ds_read_b128 v[72:75], v9 offset:0
    ds_read_b128 v[76:79], v9 offset:32768
    v_mfma_f32_16x16x32_bf16 v[220:223], a[212:215], v[148:151], v[220:223]
    buffer_load_dwordx4 v16, s[12:15], s29 offen offset:0 lds
    v_mfma_f32_16x16x32_bf16 v[208:211], a[216:219], v[152:155], v[208:211]
    ds_read_b128 v[80:83], v10 offset:0
    ds_read_b128 v[84:87], v10 offset:32768
    v_mfma_f32_16x16x32_bf16 v[212:215], a[220:223], v[152:155], v[212:215]
    v_mfma_f32_16x16x32_bf16 v[216:219], a[216:219], v[156:159], v[216:219]
    ds_read_b128 v[88:91], v11 offset:0
    ds_read_b128 v[92:95], v11 offset:32768
    v_mfma_f32_16x16x32_bf16 v[220:223], a[220:223], v[156:159], v[220:223]
    buffer_load_dwordx4 v16, s[12:15], s29 offen offset:1024 lds
    v_mfma_f32_16x16x32_bf16 v[208:211], a[224:227], v[160:163], v[208:211]
    ds_read_b128 v[96:99], v8 offset:256
    v_mfma_f32_16x16x32_bf16 v[212:215], a[228:231], v[160:163], v[212:215]
    v_mfma_f32_16x16x32_bf16 v[216:219], a[224:227], v[164:167], v[216:219]
    ds_read_b128 v[100:103], v8 offset:33024
    v_mfma_f32_16x16x32_bf16 v[220:223], a[228:231], v[164:167], v[220:223]
    buffer_load_dwordx4 v17, s[12:15], s29 offen offset:2048 lds
    v_mfma_f32_16x16x32_bf16 v[208:211], a[232:235], v[168:171], v[208:211]
    ds_read_b128 v[104:107], v9 offset:256
    v_mfma_f32_16x16x32_bf16 v[212:215], a[236:239], v[168:171], v[212:215]
    v_mfma_f32_16x16x32_bf16 v[216:219], a[232:235], v[172:175], v[216:219]
    ds_read_b128 v[108:111], v9 offset:33024
    v_mfma_f32_16x16x32_bf16 v[220:223], a[236:239], v[172:175], v[220:223]
    buffer_load_dwordx4 v17, s[12:15], s29 offen offset:3072 lds
    v_mfma_f32_16x16x32_bf16 v[208:211], a[240:243], v[176:179], v[208:211]
    ds_read_b128 v[112:115], v10 offset:256
    v_mfma_f32_16x16x32_bf16 v[212:215], a[244:247], v[176:179], v[212:215]
    s_add_u32 m0, s6, 69632
    v_mfma_f32_16x16x32_bf16 v[216:219], a[240:243], v[180:183], v[216:219]
    ds_read_b128 v[116:119], v10 offset:33024
    v_mfma_f32_16x16x32_bf16 v[220:223], a[244:247], v[180:183], v[220:223]
    buffer_load_dwordx4 v18, s[12:15], s29 offen offset:0 lds
    v_mfma_f32_16x16x32_bf16 v[208:211], a[248:251], v[184:187], v[208:211]
    ds_read_b128 v[120:123], v11 offset:256
    v_mfma_f32_16x16x32_bf16 v[212:215], a[252:255], v[184:187], v[212:215]
    v_mfma_f32_16x16x32_bf16 v[216:219], a[248:251], v[188:191], v[216:219]
    ds_read_b128 v[124:127], v11 offset:33024
    v_mfma_f32_16x16x32_bf16 v[220:223], a[252:255], v[188:191], v[220:223]
    buffer_load_dwordx4 v18, s[12:15], s29 offen offset:1024 lds
    s_cmp_lt_u32 s28, 64
    s_cbranch_scc1 .ql_204
    s_branch .qe_203
.vt_202:
.p2align 6
.ql_205:
    s_waitcnt lgkmcnt(12)
    v_mfma_f32_16x16x32_bf16 v[192:195], v[64:67], a[0:3], 0
    ds_read_b128 v[128:131], v8 offset:512
    v_mfma_f32_16x16x32_bf16 v[200:203], v[64:67], a[4:7], 0
    v_mfma_f32_16x16x32_bf16 v[196:199], v[68:71], a[0:3], 0
    ds_read_b128 v[132:135], v8 offset:33280
    v_mfma_f32_16x16x32_bf16 v[204:207], v[68:71], a[4:7], 0
    buffer_load_dwordx4 v19, s[12:15], s29 offen offset:2048 lds
    v_mfma_f32_16x16x32_bf16 v[192:195], v[72:75], a[8:11], v[192:195]
    ds_read_b128 v[136:139], v9 offset:512
    v_mfma_f32_16x16x32_bf16 v[200:203], v[72:75], a[12:15], v[200:203]
    v_cvt_pk_bf16_f32 v224, v208, v209
    v_cvt_pk_bf16_f32 v225, v210, v211
    v_mfma_f32_16x16x32_bf16 v[196:199], v[76:79], a[8:11], v[196:199]
    ds_read_b128 v[140:143], v9 offset:33280
    v_mfma_f32_16x16x32_bf16 v[204:207], v[76:79], a[12:15], v[204:207]
    buffer_load_dwordx4 v19, s[12:15], s29 offen offset:3072 lds
    s_waitcnt lgkmcnt(12)
    v_mfma_f32_16x16x32_bf16 v[192:195], v[80:83], a[16:19], v[192:195]
    ds_read_b128 v[144:147], v10 offset:512
    v_mfma_f32_16x16x32_bf16 v[200:203], v[80:83], a[20:23], v[200:203]
    s_add_u32 m0, s6, 73728
    v_cvt_pk_bf16_f32 v226, v212, v213
    v_cvt_pk_bf16_f32 v227, v214, v215
    v_mfma_f32_16x16x32_bf16 v[196:199], v[84:87], a[16:19], v[196:199]
    ds_read_b128 v[148:151], v10 offset:33280
    v_mfma_f32_16x16x32_bf16 v[204:207], v[84:87], a[20:23], v[204:207]
    buffer_load_dwordx4 v20, s[12:15], s29 offen offset:0 lds
    v_mfma_f32_16x16x32_bf16 v[192:195], v[88:91], a[24:27], v[192:195]
    ds_read_b128 v[152:155], v11 offset:512
    v_cvt_pk_bf16_f32 v228, v216, v217
    v_mfma_f32_16x16x32_bf16 v[200:203], v[88:91], a[28:31], v[200:203]
    buffer_store_dwordx4 v[224:227], v24, s[8:11], s30 offen sc1
    v_mfma_f32_16x16x32_bf16 v[196:199], v[92:95], a[24:27], v[196:199]
    ds_read_b128 v[156:159], v11 offset:33280
    v_cvt_pk_bf16_f32 v229, v218, v219
    v_mfma_f32_16x16x32_bf16 v[204:207], v[92:95], a[28:31], v[204:207]
    buffer_load_dwordx4 v20, s[12:15], s29 offen offset:1024 lds
    s_waitcnt lgkmcnt(12)
    v_mfma_f32_16x16x32_bf16 v[192:195], v[96:99], a[32:35], v[192:195]
    ds_read_b128 v[160:163], v8 offset:768
    v_mfma_f32_16x16x32_bf16 v[200:203], v[96:99], a[36:39], v[200:203]
    v_cvt_pk_bf16_f32 v230, v220, v221
    v_cvt_pk_bf16_f32 v231, v222, v223
    v_mfma_f32_16x16x32_bf16 v[196:199], v[100:103], a[32:35], v[196:199]
    ds_read_b128 v[164:167], v8 offset:33536
    v_mfma_f32_16x16x32_bf16 v[204:207], v[100:103], a[36:39], v[204:207]
    buffer_load_dwordx4 v21, s[12:15], s29 offen offset:2048 lds
    v_mfma_f32_16x16x32_bf16 v[192:195], v[104:107], a[40:43], v[192:195]
    ds_read_b128 v[168:171], v9 offset:768
    v_mfma_f32_16x16x32_bf16 v[200:203], v[104:107], a[44:47], v[200:203]
    buffer_store_dwordx4 v[228:231], v25, s[8:11], s30 offen sc1
    v_mfma_f32_16x16x32_bf16 v[196:199], v[108:111], a[40:43], v[196:199]
    ds_read_b128 v[172:175], v9 offset:33536
    v_mfma_f32_16x16x32_bf16 v[204:207], v[108:111], a[44:47], v[204:207]
    buffer_load_dwordx4 v21, s[12:15], s29 offen offset:3072 lds
    s_waitcnt lgkmcnt(12)
    v_mfma_f32_16x16x32_bf16 v[192:195], v[112:115], a[48:51], v[192:195]
    ds_read_b128 v[176:179], v10 offset:768
    v_mfma_f32_16x16x32_bf16 v[200:203], v[112:115], a[52:55], v[200:203]
    s_add_u32 m0, s6, 77824
    s_mov_b32 s30, s31
    v_mfma_f32_16x16x32_bf16 v[196:199], v[116:119], a[48:51], v[196:199]
    ds_read_b128 v[180:183], v10 offset:33536
    v_mfma_f32_16x16x32_bf16 v[204:207], v[116:119], a[52:55], v[204:207]
    buffer_load_dwordx4 v22, s[12:15], s29 offen offset:0 lds
    v_mfma_f32_16x16x32_bf16 v[192:195], v[120:123], a[56:59], v[192:195]
    ds_read_b128 v[184:187], v11 offset:768
    v_mfma_f32_16x16x32_bf16 v[200:203], v[120:123], a[60:63], v[200:203]
    s_add_u32 s31, s31, 262144
    v_mfma_f32_16x16x32_bf16 v[196:199], v[124:127], a[56:59], v[196:199]
    ds_read_b128 v[188:191], v11 offset:33536
    v_mfma_f32_16x16x32_bf16 v[204:207], v[124:127], a[60:63], v[204:207]
    buffer_load_dwordx4 v22, s[12:15], s29 offen offset:1024 lds
    s_waitcnt lgkmcnt(12)
    v_mfma_f32_16x16x32_bf16 v[192:195], v[128:131], a[64:67], v[192:195]
    ds_read_b128 v[64:67], v8 offset:1024
    v_mfma_f32_16x16x32_bf16 v[200:203], v[128:131], a[68:71], v[200:203]
    v_mfma_f32_16x16x32_bf16 v[196:199], v[132:135], a[64:67], v[196:199]
    ds_read_b128 v[68:71], v8 offset:33792
    v_mfma_f32_16x16x32_bf16 v[204:207], v[132:135], a[68:71], v[204:207]
    buffer_load_dwordx4 v23, s[12:15], s29 offen offset:2048 lds
    v_mfma_f32_16x16x32_bf16 v[192:195], v[136:139], a[72:75], v[192:195]
    ds_read_b128 v[72:75], v9 offset:1024
    v_mfma_f32_16x16x32_bf16 v[200:203], v[136:139], a[76:79], v[200:203]
    v_mfma_f32_16x16x32_bf16 v[196:199], v[140:143], a[72:75], v[196:199]
    ds_read_b128 v[76:79], v9 offset:33792
    v_mfma_f32_16x16x32_bf16 v[204:207], v[140:143], a[76:79], v[204:207]
    buffer_load_dwordx4 v23, s[12:15], s29 offen offset:3072 lds
    s_waitcnt lgkmcnt(12)
    v_mfma_f32_16x16x32_bf16 v[192:195], v[144:147], a[80:83], v[192:195]
    ds_read_b128 v[80:83], v10 offset:1024
    v_mfma_f32_16x16x32_bf16 v[200:203], v[144:147], a[84:87], v[200:203]
    v_mfma_f32_16x16x32_bf16 v[196:199], v[148:151], a[80:83], v[196:199]
    ds_read_b128 v[84:87], v10 offset:33792
    v_mfma_f32_16x16x32_bf16 v[204:207], v[148:151], a[84:87], v[204:207]
    buffer_load_dword v29, v28, s[12:15], s29 offen
    v_mfma_f32_16x16x32_bf16 v[192:195], v[152:155], a[88:91], v[192:195]
    ds_read_b128 v[88:91], v11 offset:1024
    v_mfma_f32_16x16x32_bf16 v[200:203], v[152:155], a[92:95], v[200:203]
    v_mfma_f32_16x16x32_bf16 v[196:199], v[156:159], a[88:91], v[196:199]
    ds_read_b128 v[92:95], v11 offset:33792
    v_mfma_f32_16x16x32_bf16 v[204:207], v[156:159], a[92:95], v[204:207]
    s_waitcnt lgkmcnt(12)
    v_mfma_f32_16x16x32_bf16 v[192:195], v[160:163], a[96:99], v[192:195]
    ds_read_b128 v[96:99], v8 offset:1280
    v_mfma_f32_16x16x32_bf16 v[200:203], v[160:163], a[100:103], v[200:203]
    v_mfma_f32_16x16x32_bf16 v[196:199], v[164:167], a[96:99], v[196:199]
    ds_read_b128 v[100:103], v8 offset:34048
    v_mfma_f32_16x16x32_bf16 v[204:207], v[164:167], a[100:103], v[204:207]
    v_mfma_f32_16x16x32_bf16 v[192:195], v[168:171], a[104:107], v[192:195]
    ds_read_b128 v[104:107], v9 offset:1280
    v_mfma_f32_16x16x32_bf16 v[200:203], v[168:171], a[108:111], v[200:203]
    v_mfma_f32_16x16x32_bf16 v[196:199], v[172:175], a[104:107], v[196:199]
    ds_read_b128 v[108:111], v9 offset:34048
    v_mfma_f32_16x16x32_bf16 v[204:207], v[172:175], a[108:111], v[204:207]
    s_waitcnt lgkmcnt(12)
    v_mfma_f32_16x16x32_bf16 v[192:195], v[176:179], a[112:115], v[192:195]
    ds_read_b128 v[112:115], v10 offset:1280
    v_mfma_f32_16x16x32_bf16 v[200:203], v[176:179], a[116:119], v[200:203]
    v_mfma_f32_16x16x32_bf16 v[196:199], v[180:183], a[112:115], v[196:199]
    ds_read_b128 v[116:119], v10 offset:34048
    v_mfma_f32_16x16x32_bf16 v[204:207], v[180:183], a[116:119], v[204:207]
    v_mfma_f32_16x16x32_bf16 v[192:195], v[184:187], a[120:123], v[192:195]
    ds_read_b128 v[120:123], v11 offset:1280
    v_mfma_f32_16x16x32_bf16 v[200:203], v[184:187], a[124:127], v[200:203]
    v_mfma_f32_16x16x32_bf16 v[196:199], v[188:191], a[120:123], v[196:199]
    ds_read_b128 v[124:127], v11 offset:34048
    v_mfma_f32_16x16x32_bf16 v[204:207], v[188:191], a[124:127], v[204:207]
    s_waitcnt lgkmcnt(12)
    v_mfma_f32_16x16x32_bf16 v[192:195], v[64:67], a[128:131], v[192:195]
    ds_read_b128 v[128:131], v8 offset:1536
    v_mfma_f32_16x16x32_bf16 v[200:203], v[64:67], a[132:135], v[200:203]
    v_mfma_f32_16x16x32_bf16 v[196:199], v[68:71], a[128:131], v[196:199]
    ds_read_b128 v[132:135], v8 offset:34304
    v_mfma_f32_16x16x32_bf16 v[204:207], v[68:71], a[132:135], v[204:207]
    v_mfma_f32_16x16x32_bf16 v[192:195], v[72:75], a[136:139], v[192:195]
    ds_read_b128 v[136:139], v9 offset:1536
    v_mfma_f32_16x16x32_bf16 v[200:203], v[72:75], a[140:143], v[200:203]
    v_mfma_f32_16x16x32_bf16 v[196:199], v[76:79], a[136:139], v[196:199]
    ds_read_b128 v[140:143], v9 offset:34304
    v_mfma_f32_16x16x32_bf16 v[204:207], v[76:79], a[140:143], v[204:207]
    s_waitcnt lgkmcnt(12)
    v_mfma_f32_16x16x32_bf16 v[192:195], v[80:83], a[144:147], v[192:195]
    ds_read_b128 v[144:147], v10 offset:1536
    v_mfma_f32_16x16x32_bf16 v[200:203], v[80:83], a[148:151], v[200:203]
    v_mfma_f32_16x16x32_bf16 v[196:199], v[84:87], a[144:147], v[196:199]
    ds_read_b128 v[148:151], v10 offset:34304
    v_mfma_f32_16x16x32_bf16 v[204:207], v[84:87], a[148:151], v[204:207]
    v_mfma_f32_16x16x32_bf16 v[192:195], v[88:91], a[152:155], v[192:195]
    ds_read_b128 v[152:155], v11 offset:1536
    v_mfma_f32_16x16x32_bf16 v[200:203], v[88:91], a[156:159], v[200:203]
    v_mfma_f32_16x16x32_bf16 v[196:199], v[92:95], a[152:155], v[196:199]
    ds_read_b128 v[156:159], v11 offset:34304
    v_mfma_f32_16x16x32_bf16 v[204:207], v[92:95], a[156:159], v[204:207]
    s_waitcnt lgkmcnt(12)
    v_mfma_f32_16x16x32_bf16 v[192:195], v[96:99], a[160:163], v[192:195]
    ds_read_b128 v[160:163], v8 offset:1792
    v_mfma_f32_16x16x32_bf16 v[200:203], v[96:99], a[164:167], v[200:203]
    v_mfma_f32_16x16x32_bf16 v[196:199], v[100:103], a[160:163], v[196:199]
    ds_read_b128 v[164:167], v8 offset:34560
    v_mfma_f32_16x16x32_bf16 v[204:207], v[100:103], a[164:167], v[204:207]
    v_mfma_f32_16x16x32_bf16 v[192:195], v[104:107], a[168:171], v[192:195]
    ds_read_b128 v[168:171], v9 offset:1792
    v_mfma_f32_16x16x32_bf16 v[200:203], v[104:107], a[172:175], v[200:203]
    v_mfma_f32_16x16x32_bf16 v[196:199], v[108:111], a[168:171], v[196:199]
    ds_read_b128 v[172:175], v9 offset:34560
    v_mfma_f32_16x16x32_bf16 v[204:207], v[108:111], a[172:175], v[204:207]
    s_waitcnt lgkmcnt(12)
    v_mfma_f32_16x16x32_bf16 v[192:195], v[112:115], a[176:179], v[192:195]
    ds_read_b128 v[176:179], v10 offset:1792
    v_mfma_f32_16x16x32_bf16 v[200:203], v[112:115], a[180:183], v[200:203]
    s_waitcnt vmcnt(6)
    v_mov_b32 v27, s28
    s_mov_b64 exec, 1
    buffer_store_dword v27, v26, s[8:11], s94 offen sc1
    s_mov_b64 exec, -1
    v_mfma_f32_16x16x32_bf16 v[196:199], v[116:119], a[176:179], v[196:199]
    ds_read_b128 v[180:183], v10 offset:34560
    v_mfma_f32_16x16x32_bf16 v[204:207], v[116:119], a[180:183], v[204:207]
    v_mfma_f32_16x16x32_bf16 v[192:195], v[120:123], a[184:187], v[192:195]
    ds_read_b128 v[184:187], v11 offset:1792
    v_mfma_f32_16x16x32_bf16 v[200:203], v[120:123], a[188:191], v[200:203]
    s_add_u32 s28, s28, 1
    v_mfma_f32_16x16x32_bf16 v[196:199], v[124:127], a[184:187], v[196:199]
    ds_read_b128 v[188:191], v11 offset:34560
    v_mfma_f32_16x16x32_bf16 v[204:207], v[124:127], a[188:191], v[204:207]
    s_waitcnt lgkmcnt(12)
    v_mfma_f32_16x16x32_bf16 v[192:195], v[128:131], a[192:195], v[192:195]
    v_mfma_f32_16x16x32_bf16 v[200:203], v[128:131], a[196:199], v[200:203]
    v_mfma_f32_16x16x32_bf16 v[196:199], v[132:135], a[192:195], v[196:199]
    v_mfma_f32_16x16x32_bf16 v[204:207], v[132:135], a[196:199], v[204:207]
    v_mfma_f32_16x16x32_bf16 v[192:195], v[136:139], a[200:203], v[192:195]
    v_mfma_f32_16x16x32_bf16 v[200:203], v[136:139], a[204:207], v[200:203]
    s_add_u32 s29, s29, 0x10000
    s_min_u32 s29, s29, 0x3f0000
    v_mfma_f32_16x16x32_bf16 v[196:199], v[140:143], a[200:203], v[196:199]
    v_mfma_f32_16x16x32_bf16 v[204:207], v[140:143], a[204:207], v[204:207]
    s_waitcnt vmcnt(2) lgkmcnt(0)
    s_barrier
    v_mfma_f32_16x16x32_bf16 v[192:195], v[144:147], a[208:211], v[192:195]
    ds_read_b128 v[64:67], v12 offset:0
    ds_read_b128 v[68:71], v12 offset:32768
    v_mfma_f32_16x16x32_bf16 v[200:203], v[144:147], a[212:215], v[200:203]
    s_add_u32 m0, s6, 0
    v_mfma_f32_16x16x32_bf16 v[196:199], v[148:151], a[208:211], v[196:199]
    ds_read_b128 v[72:75], v13 offset:0
    ds_read_b128 v[76:79], v13 offset:32768
    v_mfma_f32_16x16x32_bf16 v[204:207], v[148:151], a[212:215], v[204:207]
    buffer_load_dwordx4 v16, s[12:15], s29 offen offset:0 lds
    v_mfma_f32_16x16x32_bf16 v[192:195], v[152:155], a[216:219], v[192:195]
    ds_read_b128 v[80:83], v14 offset:0
    ds_read_b128 v[84:87], v14 offset:32768
    v_mfma_f32_16x16x32_bf16 v[200:203], v[152:155], a[220:223], v[200:203]
    v_mfma_f32_16x16x32_bf16 v[196:199], v[156:159], a[216:219], v[196:199]
    ds_read_b128 v[88:91], v15 offset:0
    ds_read_b128 v[92:95], v15 offset:32768
    v_mfma_f32_16x16x32_bf16 v[204:207], v[156:159], a[220:223], v[204:207]
    buffer_load_dwordx4 v16, s[12:15], s29 offen offset:1024 lds
    v_mfma_f32_16x16x32_bf16 v[192:195], v[160:163], a[224:227], v[192:195]
    ds_read_b128 v[96:99], v12 offset:256
    v_mfma_f32_16x16x32_bf16 v[200:203], v[160:163], a[228:231], v[200:203]
    v_mfma_f32_16x16x32_bf16 v[196:199], v[164:167], a[224:227], v[196:199]
    ds_read_b128 v[100:103], v12 offset:33024
    v_mfma_f32_16x16x32_bf16 v[204:207], v[164:167], a[228:231], v[204:207]
    buffer_load_dwordx4 v17, s[12:15], s29 offen offset:2048 lds
    v_mfma_f32_16x16x32_bf16 v[192:195], v[168:171], a[232:235], v[192:195]
    ds_read_b128 v[104:107], v13 offset:256
    v_mfma_f32_16x16x32_bf16 v[200:203], v[168:171], a[236:239], v[200:203]
    v_mfma_f32_16x16x32_bf16 v[196:199], v[172:175], a[232:235], v[196:199]
    ds_read_b128 v[108:111], v13 offset:33024
    v_mfma_f32_16x16x32_bf16 v[204:207], v[172:175], a[236:239], v[204:207]
    buffer_load_dwordx4 v17, s[12:15], s29 offen offset:3072 lds
    v_mfma_f32_16x16x32_bf16 v[192:195], v[176:179], a[240:243], v[192:195]
    ds_read_b128 v[112:115], v14 offset:256
    v_mfma_f32_16x16x32_bf16 v[200:203], v[176:179], a[244:247], v[200:203]
    s_add_u32 m0, s6, 4096
    v_mfma_f32_16x16x32_bf16 v[196:199], v[180:183], a[240:243], v[196:199]
    ds_read_b128 v[116:119], v14 offset:33024
    v_mfma_f32_16x16x32_bf16 v[204:207], v[180:183], a[244:247], v[204:207]
    buffer_load_dwordx4 v18, s[12:15], s29 offen offset:0 lds
    v_mfma_f32_16x16x32_bf16 v[192:195], v[184:187], a[248:251], v[192:195]
    ds_read_b128 v[120:123], v15 offset:256
    v_mfma_f32_16x16x32_bf16 v[200:203], v[184:187], a[252:255], v[200:203]
    v_mfma_f32_16x16x32_bf16 v[196:199], v[188:191], a[248:251], v[196:199]
    ds_read_b128 v[124:127], v15 offset:33024
    v_mfma_f32_16x16x32_bf16 v[204:207], v[188:191], a[252:255], v[204:207]
    buffer_load_dwordx4 v18, s[12:15], s29 offen offset:1024 lds
    s_waitcnt lgkmcnt(12)
    v_mfma_f32_16x16x32_bf16 v[208:211], v[64:67], a[0:3], 0
    ds_read_b128 v[128:131], v12 offset:512
    v_mfma_f32_16x16x32_bf16 v[216:219], v[64:67], a[4:7], 0
    v_mfma_f32_16x16x32_bf16 v[212:215], v[68:71], a[0:3], 0
    ds_read_b128 v[132:135], v12 offset:33280
    v_mfma_f32_16x16x32_bf16 v[220:223], v[68:71], a[4:7], 0
    buffer_load_dwordx4 v19, s[12:15], s29 offen offset:2048 lds
    v_mfma_f32_16x16x32_bf16 v[208:211], v[72:75], a[8:11], v[208:211]
    ds_read_b128 v[136:139], v13 offset:512
    v_mfma_f32_16x16x32_bf16 v[216:219], v[72:75], a[12:15], v[216:219]
    v_cvt_pk_bf16_f32 v224, v192, v193
    v_cvt_pk_bf16_f32 v225, v194, v195
    v_mfma_f32_16x16x32_bf16 v[212:215], v[76:79], a[8:11], v[212:215]
    ds_read_b128 v[140:143], v13 offset:33280
    v_mfma_f32_16x16x32_bf16 v[220:223], v[76:79], a[12:15], v[220:223]
    buffer_load_dwordx4 v19, s[12:15], s29 offen offset:3072 lds
    s_waitcnt lgkmcnt(12)
    v_mfma_f32_16x16x32_bf16 v[208:211], v[80:83], a[16:19], v[208:211]
    ds_read_b128 v[144:147], v14 offset:512
    v_mfma_f32_16x16x32_bf16 v[216:219], v[80:83], a[20:23], v[216:219]
    s_add_u32 m0, s6, 8192
    v_cvt_pk_bf16_f32 v226, v196, v197
    v_cvt_pk_bf16_f32 v227, v198, v199
    v_mfma_f32_16x16x32_bf16 v[212:215], v[84:87], a[16:19], v[212:215]
    ds_read_b128 v[148:151], v14 offset:33280
    v_mfma_f32_16x16x32_bf16 v[220:223], v[84:87], a[20:23], v[220:223]
    buffer_load_dwordx4 v20, s[12:15], s29 offen offset:0 lds
    v_mfma_f32_16x16x32_bf16 v[208:211], v[88:91], a[24:27], v[208:211]
    ds_read_b128 v[152:155], v15 offset:512
    v_cvt_pk_bf16_f32 v228, v200, v201
    v_mfma_f32_16x16x32_bf16 v[216:219], v[88:91], a[28:31], v[216:219]
    buffer_store_dwordx4 v[224:227], v24, s[8:11], s30 offen sc1
    v_mfma_f32_16x16x32_bf16 v[212:215], v[92:95], a[24:27], v[212:215]
    ds_read_b128 v[156:159], v15 offset:33280
    v_cvt_pk_bf16_f32 v229, v202, v203
    v_mfma_f32_16x16x32_bf16 v[220:223], v[92:95], a[28:31], v[220:223]
    buffer_load_dwordx4 v20, s[12:15], s29 offen offset:1024 lds
    s_waitcnt lgkmcnt(12)
    v_mfma_f32_16x16x32_bf16 v[208:211], v[96:99], a[32:35], v[208:211]
    ds_read_b128 v[160:163], v12 offset:768
    v_mfma_f32_16x16x32_bf16 v[216:219], v[96:99], a[36:39], v[216:219]
    v_cvt_pk_bf16_f32 v230, v204, v205
    v_cvt_pk_bf16_f32 v231, v206, v207
    v_mfma_f32_16x16x32_bf16 v[212:215], v[100:103], a[32:35], v[212:215]
    ds_read_b128 v[164:167], v12 offset:33536
    v_mfma_f32_16x16x32_bf16 v[220:223], v[100:103], a[36:39], v[220:223]
    buffer_load_dwordx4 v21, s[12:15], s29 offen offset:2048 lds
    v_mfma_f32_16x16x32_bf16 v[208:211], v[104:107], a[40:43], v[208:211]
    ds_read_b128 v[168:171], v13 offset:768
    v_mfma_f32_16x16x32_bf16 v[216:219], v[104:107], a[44:47], v[216:219]
    buffer_store_dwordx4 v[228:231], v25, s[8:11], s30 offen sc1
    v_mfma_f32_16x16x32_bf16 v[212:215], v[108:111], a[40:43], v[212:215]
    ds_read_b128 v[172:175], v13 offset:33536
    v_mfma_f32_16x16x32_bf16 v[220:223], v[108:111], a[44:47], v[220:223]
    buffer_load_dwordx4 v21, s[12:15], s29 offen offset:3072 lds
    s_waitcnt lgkmcnt(12)
    v_mfma_f32_16x16x32_bf16 v[208:211], v[112:115], a[48:51], v[208:211]
    ds_read_b128 v[176:179], v14 offset:768
    v_mfma_f32_16x16x32_bf16 v[216:219], v[112:115], a[52:55], v[216:219]
    s_add_u32 m0, s6, 12288
    s_mov_b32 s30, s31
    v_mfma_f32_16x16x32_bf16 v[212:215], v[116:119], a[48:51], v[212:215]
    ds_read_b128 v[180:183], v14 offset:33536
    v_mfma_f32_16x16x32_bf16 v[220:223], v[116:119], a[52:55], v[220:223]
    buffer_load_dwordx4 v22, s[12:15], s29 offen offset:0 lds
    v_mfma_f32_16x16x32_bf16 v[208:211], v[120:123], a[56:59], v[208:211]
    ds_read_b128 v[184:187], v15 offset:768
    v_mfma_f32_16x16x32_bf16 v[216:219], v[120:123], a[60:63], v[216:219]
    s_add_u32 s31, s31, 262144
    v_mfma_f32_16x16x32_bf16 v[212:215], v[124:127], a[56:59], v[212:215]
    ds_read_b128 v[188:191], v15 offset:33536
    v_mfma_f32_16x16x32_bf16 v[220:223], v[124:127], a[60:63], v[220:223]
    buffer_load_dwordx4 v22, s[12:15], s29 offen offset:1024 lds
    s_waitcnt lgkmcnt(12)
    v_mfma_f32_16x16x32_bf16 v[208:211], v[128:131], a[64:67], v[208:211]
    ds_read_b128 v[64:67], v12 offset:1024
    v_mfma_f32_16x16x32_bf16 v[216:219], v[128:131], a[68:71], v[216:219]
    v_mfma_f32_16x16x32_bf16 v[212:215], v[132:135], a[64:67], v[212:215]
    ds_read_b128 v[68:71], v12 offset:33792
    v_mfma_f32_16x16x32_bf16 v[220:223], v[132:135], a[68:71], v[220:223]
    buffer_load_dwordx4 v23, s[12:15], s29 offen offset:2048 lds
    v_mfma_f32_16x16x32_bf16 v[208:211], v[136:139], a[72:75], v[208:211]
    ds_read_b128 v[72:75], v13 offset:1024
    v_mfma_f32_16x16x32_bf16 v[216:219], v[136:139], a[76:79], v[216:219]
    v_mfma_f32_16x16x32_bf16 v[212:215], v[140:143], a[72:75], v[212:215]
    ds_read_b128 v[76:79], v13 offset:33792
    v_mfma_f32_16x16x32_bf16 v[220:223], v[140:143], a[76:79], v[220:223]
    buffer_load_dwordx4 v23, s[12:15], s29 offen offset:3072 lds
    s_waitcnt lgkmcnt(12)
    v_mfma_f32_16x16x32_bf16 v[208:211], v[144:147], a[80:83], v[208:211]
    ds_read_b128 v[80:83], v14 offset:1024
    v_mfma_f32_16x16x32_bf16 v[216:219], v[144:147], a[84:87], v[216:219]
    v_mfma_f32_16x16x32_bf16 v[212:215], v[148:151], a[80:83], v[212:215]
    ds_read_b128 v[84:87], v14 offset:33792
    v_mfma_f32_16x16x32_bf16 v[220:223], v[148:151], a[84:87], v[220:223]
    buffer_load_dword v29, v28, s[12:15], s29 offen
    v_mfma_f32_16x16x32_bf16 v[208:211], v[152:155], a[88:91], v[208:211]
    ds_read_b128 v[88:91], v15 offset:1024
    v_mfma_f32_16x16x32_bf16 v[216:219], v[152:155], a[92:95], v[216:219]
    v_mfma_f32_16x16x32_bf16 v[212:215], v[156:159], a[88:91], v[212:215]
    ds_read_b128 v[92:95], v15 offset:33792
    v_mfma_f32_16x16x32_bf16 v[220:223], v[156:159], a[92:95], v[220:223]
    s_waitcnt lgkmcnt(12)
    v_mfma_f32_16x16x32_bf16 v[208:211], v[160:163], a[96:99], v[208:211]
    ds_read_b128 v[96:99], v12 offset:1280
    v_mfma_f32_16x16x32_bf16 v[216:219], v[160:163], a[100:103], v[216:219]
    v_mfma_f32_16x16x32_bf16 v[212:215], v[164:167], a[96:99], v[212:215]
    ds_read_b128 v[100:103], v12 offset:34048
    v_mfma_f32_16x16x32_bf16 v[220:223], v[164:167], a[100:103], v[220:223]
    v_mfma_f32_16x16x32_bf16 v[208:211], v[168:171], a[104:107], v[208:211]
    ds_read_b128 v[104:107], v13 offset:1280
    v_mfma_f32_16x16x32_bf16 v[216:219], v[168:171], a[108:111], v[216:219]
    v_mfma_f32_16x16x32_bf16 v[212:215], v[172:175], a[104:107], v[212:215]
    ds_read_b128 v[108:111], v13 offset:34048
    v_mfma_f32_16x16x32_bf16 v[220:223], v[172:175], a[108:111], v[220:223]
    s_waitcnt lgkmcnt(12)
    v_mfma_f32_16x16x32_bf16 v[208:211], v[176:179], a[112:115], v[208:211]
    ds_read_b128 v[112:115], v14 offset:1280
    v_mfma_f32_16x16x32_bf16 v[216:219], v[176:179], a[116:119], v[216:219]
    v_mfma_f32_16x16x32_bf16 v[212:215], v[180:183], a[112:115], v[212:215]
    ds_read_b128 v[116:119], v14 offset:34048
    v_mfma_f32_16x16x32_bf16 v[220:223], v[180:183], a[116:119], v[220:223]
    v_mfma_f32_16x16x32_bf16 v[208:211], v[184:187], a[120:123], v[208:211]
    ds_read_b128 v[120:123], v15 offset:1280
    v_mfma_f32_16x16x32_bf16 v[216:219], v[184:187], a[124:127], v[216:219]
    v_mfma_f32_16x16x32_bf16 v[212:215], v[188:191], a[120:123], v[212:215]
    ds_read_b128 v[124:127], v15 offset:34048
    v_mfma_f32_16x16x32_bf16 v[220:223], v[188:191], a[124:127], v[220:223]
    s_waitcnt lgkmcnt(12)
    v_mfma_f32_16x16x32_bf16 v[208:211], v[64:67], a[128:131], v[208:211]
    ds_read_b128 v[128:131], v12 offset:1536
    v_mfma_f32_16x16x32_bf16 v[216:219], v[64:67], a[132:135], v[216:219]
    v_mfma_f32_16x16x32_bf16 v[212:215], v[68:71], a[128:131], v[212:215]
    ds_read_b128 v[132:135], v12 offset:34304
    v_mfma_f32_16x16x32_bf16 v[220:223], v[68:71], a[132:135], v[220:223]
    v_mfma_f32_16x16x32_bf16 v[208:211], v[72:75], a[136:139], v[208:211]
    ds_read_b128 v[136:139], v13 offset:1536
    v_mfma_f32_16x16x32_bf16 v[216:219], v[72:75], a[140:143], v[216:219]
    v_mfma_f32_16x16x32_bf16 v[212:215], v[76:79], a[136:139], v[212:215]
    ds_read_b128 v[140:143], v13 offset:34304
    v_mfma_f32_16x16x32_bf16 v[220:223], v[76:79], a[140:143], v[220:223]
    s_waitcnt lgkmcnt(12)
    v_mfma_f32_16x16x32_bf16 v[208:211], v[80:83], a[144:147], v[208:211]
    ds_read_b128 v[144:147], v14 offset:1536
    v_mfma_f32_16x16x32_bf16 v[216:219], v[80:83], a[148:151], v[216:219]
    v_mfma_f32_16x16x32_bf16 v[212:215], v[84:87], a[144:147], v[212:215]
    ds_read_b128 v[148:151], v14 offset:34304
    v_mfma_f32_16x16x32_bf16 v[220:223], v[84:87], a[148:151], v[220:223]
    v_mfma_f32_16x16x32_bf16 v[208:211], v[88:91], a[152:155], v[208:211]
    ds_read_b128 v[152:155], v15 offset:1536
    v_mfma_f32_16x16x32_bf16 v[216:219], v[88:91], a[156:159], v[216:219]
    v_mfma_f32_16x16x32_bf16 v[212:215], v[92:95], a[152:155], v[212:215]
    ds_read_b128 v[156:159], v15 offset:34304
    v_mfma_f32_16x16x32_bf16 v[220:223], v[92:95], a[156:159], v[220:223]
    s_waitcnt lgkmcnt(12)
    v_mfma_f32_16x16x32_bf16 v[208:211], v[96:99], a[160:163], v[208:211]
    ds_read_b128 v[160:163], v12 offset:1792
    v_mfma_f32_16x16x32_bf16 v[216:219], v[96:99], a[164:167], v[216:219]
    v_mfma_f32_16x16x32_bf16 v[212:215], v[100:103], a[160:163], v[212:215]
    ds_read_b128 v[164:167], v12 offset:34560
    v_mfma_f32_16x16x32_bf16 v[220:223], v[100:103], a[164:167], v[220:223]
    v_mfma_f32_16x16x32_bf16 v[208:211], v[104:107], a[168:171], v[208:211]
    ds_read_b128 v[168:171], v13 offset:1792
    v_mfma_f32_16x16x32_bf16 v[216:219], v[104:107], a[172:175], v[216:219]
    v_mfma_f32_16x16x32_bf16 v[212:215], v[108:111], a[168:171], v[212:215]
    ds_read_b128 v[172:175], v13 offset:34560
    v_mfma_f32_16x16x32_bf16 v[220:223], v[108:111], a[172:175], v[220:223]
    s_waitcnt lgkmcnt(12)
    v_mfma_f32_16x16x32_bf16 v[208:211], v[112:115], a[176:179], v[208:211]
    ds_read_b128 v[176:179], v14 offset:1792
    v_mfma_f32_16x16x32_bf16 v[216:219], v[112:115], a[180:183], v[216:219]
    s_waitcnt vmcnt(6)
    v_mov_b32 v27, s28
    s_mov_b64 exec, 1
    buffer_store_dword v27, v26, s[8:11], s94 offen sc1
    s_mov_b64 exec, -1
    v_mfma_f32_16x16x32_bf16 v[212:215], v[116:119], a[176:179], v[212:215]
    ds_read_b128 v[180:183], v14 offset:34560
    v_mfma_f32_16x16x32_bf16 v[220:223], v[116:119], a[180:183], v[220:223]
    v_mfma_f32_16x16x32_bf16 v[208:211], v[120:123], a[184:187], v[208:211]
    ds_read_b128 v[184:187], v15 offset:1792
    v_mfma_f32_16x16x32_bf16 v[216:219], v[120:123], a[188:191], v[216:219]
    s_add_u32 s28, s28, 1
    v_mfma_f32_16x16x32_bf16 v[212:215], v[124:127], a[184:187], v[212:215]
    ds_read_b128 v[188:191], v15 offset:34560
    v_mfma_f32_16x16x32_bf16 v[220:223], v[124:127], a[188:191], v[220:223]
    s_waitcnt lgkmcnt(12)
    v_mfma_f32_16x16x32_bf16 v[208:211], v[128:131], a[192:195], v[208:211]
    v_mfma_f32_16x16x32_bf16 v[216:219], v[128:131], a[196:199], v[216:219]
    v_mfma_f32_16x16x32_bf16 v[212:215], v[132:135], a[192:195], v[212:215]
    v_mfma_f32_16x16x32_bf16 v[220:223], v[132:135], a[196:199], v[220:223]
    v_mfma_f32_16x16x32_bf16 v[208:211], v[136:139], a[200:203], v[208:211]
    v_mfma_f32_16x16x32_bf16 v[216:219], v[136:139], a[204:207], v[216:219]
    s_add_u32 s29, s29, 0x10000
    s_min_u32 s29, s29, 0x3f0000
    v_mfma_f32_16x16x32_bf16 v[212:215], v[140:143], a[200:203], v[212:215]
    v_mfma_f32_16x16x32_bf16 v[220:223], v[140:143], a[204:207], v[220:223]
    s_waitcnt vmcnt(2) lgkmcnt(0)
    s_barrier
    v_mfma_f32_16x16x32_bf16 v[208:211], v[144:147], a[208:211], v[208:211]
    ds_read_b128 v[64:67], v8 offset:0
    ds_read_b128 v[68:71], v8 offset:32768
    v_mfma_f32_16x16x32_bf16 v[216:219], v[144:147], a[212:215], v[216:219]
    s_add_u32 m0, s6, 65536
    v_mfma_f32_16x16x32_bf16 v[212:215], v[148:151], a[208:211], v[212:215]
    ds_read_b128 v[72:75], v9 offset:0
    ds_read_b128 v[76:79], v9 offset:32768
    v_mfma_f32_16x16x32_bf16 v[220:223], v[148:151], a[212:215], v[220:223]
    buffer_load_dwordx4 v16, s[12:15], s29 offen offset:0 lds
    v_mfma_f32_16x16x32_bf16 v[208:211], v[152:155], a[216:219], v[208:211]
    ds_read_b128 v[80:83], v10 offset:0
    ds_read_b128 v[84:87], v10 offset:32768
    v_mfma_f32_16x16x32_bf16 v[216:219], v[152:155], a[220:223], v[216:219]
    v_mfma_f32_16x16x32_bf16 v[212:215], v[156:159], a[216:219], v[212:215]
    ds_read_b128 v[88:91], v11 offset:0
    ds_read_b128 v[92:95], v11 offset:32768
    v_mfma_f32_16x16x32_bf16 v[220:223], v[156:159], a[220:223], v[220:223]
    buffer_load_dwordx4 v16, s[12:15], s29 offen offset:1024 lds
    v_mfma_f32_16x16x32_bf16 v[208:211], v[160:163], a[224:227], v[208:211]
    ds_read_b128 v[96:99], v8 offset:256
    v_mfma_f32_16x16x32_bf16 v[216:219], v[160:163], a[228:231], v[216:219]
    v_mfma_f32_16x16x32_bf16 v[212:215], v[164:167], a[224:227], v[212:215]
    ds_read_b128 v[100:103], v8 offset:33024
    v_mfma_f32_16x16x32_bf16 v[220:223], v[164:167], a[228:231], v[220:223]
    buffer_load_dwordx4 v17, s[12:15], s29 offen offset:2048 lds
    v_mfma_f32_16x16x32_bf16 v[208:211], v[168:171], a[232:235], v[208:211]
    ds_read_b128 v[104:107], v9 offset:256
    v_mfma_f32_16x16x32_bf16 v[216:219], v[168:171], a[236:239], v[216:219]
    v_mfma_f32_16x16x32_bf16 v[212:215], v[172:175], a[232:235], v[212:215]
    ds_read_b128 v[108:111], v9 offset:33024
    v_mfma_f32_16x16x32_bf16 v[220:223], v[172:175], a[236:239], v[220:223]
    buffer_load_dwordx4 v17, s[12:15], s29 offen offset:3072 lds
    v_mfma_f32_16x16x32_bf16 v[208:211], v[176:179], a[240:243], v[208:211]
    ds_read_b128 v[112:115], v10 offset:256
    v_mfma_f32_16x16x32_bf16 v[216:219], v[176:179], a[244:247], v[216:219]
    s_add_u32 m0, s6, 69632
    v_mfma_f32_16x16x32_bf16 v[212:215], v[180:183], a[240:243], v[212:215]
    ds_read_b128 v[116:119], v10 offset:33024
    v_mfma_f32_16x16x32_bf16 v[220:223], v[180:183], a[244:247], v[220:223]
    buffer_load_dwordx4 v18, s[12:15], s29 offen offset:0 lds
    v_mfma_f32_16x16x32_bf16 v[208:211], v[184:187], a[248:251], v[208:211]
    ds_read_b128 v[120:123], v11 offset:256
    v_mfma_f32_16x16x32_bf16 v[216:219], v[184:187], a[252:255], v[216:219]
    v_mfma_f32_16x16x32_bf16 v[212:215], v[188:191], a[248:251], v[212:215]
    ds_read_b128 v[124:127], v11 offset:33024
    v_mfma_f32_16x16x32_bf16 v[220:223], v[188:191], a[252:255], v[220:223]
    buffer_load_dwordx4 v18, s[12:15], s29 offen offset:1024 lds
    s_cmp_lt_u32 s28, 64
    s_cbranch_scc1 .ql_205
.qe_203:
    s_nop 7
    v_cvt_pk_bf16_f32 v224, v208, v209
    v_cvt_pk_bf16_f32 v225, v210, v211
    v_cvt_pk_bf16_f32 v226, v212, v213
    v_cvt_pk_bf16_f32 v227, v214, v215
    v_cvt_pk_bf16_f32 v228, v216, v217
    v_cvt_pk_bf16_f32 v229, v218, v219
    v_cvt_pk_bf16_f32 v230, v220, v221
    v_cvt_pk_bf16_f32 v231, v222, v223
    buffer_store_dwordx4 v[224:227], v24, s[8:11], s30 offen sc1
    buffer_store_dwordx4 v[228:231], v25, s[8:11], s30 offen sc1
    s_waitcnt vmcnt(0) lgkmcnt(0)
    v_mov_b32 v27, s28
    s_mov_b64 exec, 1
    buffer_store_dword v27, v26, s[8:11], s94 offen sc1
    s_mov_b64 exec, -1
    s_branch .ph2_197
.abr_196:
    v_and_b32 v239, 7, v0
    v_lshlrev_b32 v239, 2, v239
    buffer_load_dword v238, v239, s[20:23], 0 offen sc1
    s_waitcnt vmcnt(0)
    s_cmp_lg_u32 s27, 0
    s_cbranch_scc1 .vd_207
    s_mov_b32 s62, 0
.vp_206:
    v_cmp_ne_u32 vcc, 32, v238
    s_cbranch_vccz .vd_207
    v_readlane_b32 s64, v238, 0
    v_readlane_b32 s65, v238, 1
    v_readlane_b32 s66, v238, 2
    v_readlane_b32 s67, v238, 3
    v_readlane_b32 s68, v238, 4
    v_readlane_b32 s69, v238, 5
    v_readlane_b32 s70, v238, 6
    v_readlane_b32 s71, v238, 7
    s_nop 3
    s_add_u32 s4, s64, s65
    s_add_u32 s5, s66, s67
    s_add_u32 s72, s68, s69
    s_add_u32 s73, s70, s71
    s_add_u32 s4, s4, s5
    s_add_u32 s72, s72, s73
    s_add_u32 s4, s4, s72
    s_cmp_ge_u32 s4, 256
    s_cbranch_scc1 .vs_208
    s_add_u32 s62, s62, 1
    s_cmp_gt_u32 s62, 0x100000
    s_cbranch_scc1 .mg_end_1
    buffer_load_dword v238, v239, s[20:23], 0 offen sc1
    s_waitcnt vmcnt(0)
    s_branch .vp_206
.vs_208:
    s_lshr_b32 s25, s2, 5
    s_and_b32 s26, s2, 31
    s_mov_b32 s27, 1
    s_waitcnt vmcnt(0) lgkmcnt(0)
    s_barrier
    s_branch .mg_role_3
.vd_207:
    s_lshl_b32 s4, s99, 4
    s_lshl_b32 s5, s24, 2
    s_add_u32 s4, s4, s5
    s_add_u32 s94, s4, 92278784
    v_mov_b32 v4, 0
    s_mov_b64 exec, 1
    buffer_store_dword v4, v4, s[8:11], s94 offen sc1
    s_mov_b64 exec, -1
    s_waitcnt vmcnt(0)
    s_barrier
    s_cmp_lg_u32 s24, 0
    s_cbranch_scc1 .sg_209
    s_mov_b64 exec, 1
    v_mov_b32 v4, 1
    v_mov_b32 v5, 0
    buffer_atomic_add v4, v5, s[20:23], 0 offen offset:36 sc1
    s_mov_b64 exec, -1
.sg_209:
    s_load_dwordx8 s[40:47], s[0:1], 0
    s_load_dwordx4 s[48:51], s[0:1], 32
    s_load_dwordx2 s[52:53], s[0:1], 104
    s_mul_i32 s6, s24, 8320
    s_add_u32 s6, s6, 122880
    s_lshl_b32 s4, s99, 17
    s_lshl_b32 s5, s24, 15
    s_add_u32 s4, s4, s5
    v_lshlrev_b32 v2, 4, v1
    v_bfe_u32 v254, v1, 0, 4
    v_mul_u32_u24 v3, 2048, v254
    v_bfe_u32 v254, v1, 4, 2
    v_mul_u32_u24 v254, 16, v254
    v_add_u32 v3, v3, v254
    v_add_u32 v3, s4, v3
    v_bfe_u32 v254, v1, 4, 2
    v_mul_u32_u24 v4, 16, v254
    v_add_u32 v4, s6, v4
    s_waitcnt lgkmcnt(0)
    s_mov_b32 s12, s40
    s_and_b32 s13, s41, 0xffff
    s_mov_b32 s14, 0x400000
    s_mov_b32 s15, 0x00020000
    s_mov_b32 s16, s42
    s_and_b32 s17, s43, 0xffff
    s_mov_b32 s18, 0x400000
    s_mov_b32 s19, 0x00020000
    s_mov_b32 s28, s44
    s_and_b32 s29, s45, 0xffff
    s_mov_b32 s30, 0x400000
    s_mov_b32 s31, 0x00020000
    s_mov_b32 s32, s46
    s_and_b32 s33, s47, 0xffff
    s_mov_b32 s34, 0x2000
    s_mov_b32 s35, 0x00020000
    s_mov_b32 s36, s48
    s_and_b32 s37, s49, 0xffff
    s_mov_b32 s38, 0x400000
    s_mov_b32 s39, 0x00020000
    s_mov_b32 s56, s52
    s_and_b32 s57, s53, 0xffff
    s_mov_b32 s58, 0x800
    s_mov_b32 s59, 0x00020000
    s_mov_b32 m0, s6
    s_lshl_b32 s60, s99, 4
    buffer_load_dwordx4 v2, s[56:59], 0 offen lds
    buffer_load_dwordx4 v2, s[56:59], 0 offen offset:1024 lds
    s_add_u32 s61, s60, s24
    v_subrev_u32 v5, 4, v2
    buffer_load_dwordx4 a[0:3], v3, s[12:15], 0 offen offset:0
    buffer_load_dwordx4 a[4:7], v3, s[12:15], 0 offen offset:64
    buffer_load_dwordx4 a[8:11], v3, s[12:15], 0 offen offset:128
    buffer_load_dwordx4 a[12:15], v3, s[12:15], 0 offen offset:192
    buffer_load_dwordx4 a[16:19], v3, s[12:15], 0 offen offset:256
    buffer_load_dwordx4 a[20:23], v3, s[12:15], 0 offen offset:320
    buffer_load_dwordx4 a[24:27], v3, s[12:15], 0 offen offset:384
    buffer_load_dwordx4 a[28:31], v3, s[12:15], 0 offen offset:448
    buffer_load_dwordx4 a[32:35], v3, s[12:15], 0 offen offset:512
    buffer_load_dwordx4 a[36:39], v3, s[12:15], 0 offen offset:576
    buffer_load_dwordx4 a[40:43], v3, s[12:15], 0 offen offset:640
    buffer_load_dwordx4 a[44:47], v3, s[12:15], 0 offen offset:704
    buffer_load_dwordx4 a[48:51], v3, s[12:15], 0 offen offset:768
    buffer_load_dwordx4 a[52:55], v3, s[12:15], 0 offen offset:832
    buffer_load_dwordx4 a[56:59], v3, s[12:15], 0 offen offset:896
    buffer_load_dwordx4 a[60:63], v3, s[12:15], 0 offen offset:960
    buffer_load_dwordx4 a[64:67], v3, s[12:15], 0 offen offset:1024
    buffer_load_dwordx4 a[68:71], v3, s[12:15], 0 offen offset:1088
    buffer_load_dwordx4 a[72:75], v3, s[12:15], 0 offen offset:1152
    buffer_load_dwordx4 a[76:79], v3, s[12:15], 0 offen offset:1216
    buffer_load_dwordx4 a[80:83], v3, s[12:15], 0 offen offset:1280
    buffer_load_dwordx4 a[84:87], v3, s[12:15], 0 offen offset:1344
    buffer_load_dwordx4 a[88:91], v3, s[12:15], 0 offen offset:1408
    buffer_load_dwordx4 a[92:95], v3, s[12:15], 0 offen offset:1472
    buffer_load_dwordx4 a[96:99], v3, s[12:15], 0 offen offset:1536
    buffer_load_dwordx4 a[100:103], v3, s[12:15], 0 offen offset:1600
    buffer_load_dwordx4 a[104:107], v3, s[12:15], 0 offen offset:1664
    buffer_load_dwordx4 a[108:111], v3, s[12:15], 0 offen offset:1728
    buffer_load_dwordx4 a[112:115], v3, s[12:15], 0 offen offset:1792
    buffer_load_dwordx4 a[116:119], v3, s[12:15], 0 offen offset:1856
    buffer_load_dwordx4 a[120:123], v3, s[12:15], 0 offen offset:1920
    buffer_load_dwordx4 a[124:127], v3, s[12:15], 0 offen offset:1984
    s_lshl_b32 s4, s24, 19
    s_lshl_b32 s5, s99, 5
    s_add_u32 s4, s4, s5
    v_bfe_u32 v254, v1, 1, 5
    v_mul_u32_u24 v7, 16384, v254
    v_bfe_u32 v254, v1, 0, 1
    v_mul_u32_u24 v254, 16, v254
    v_add_u32 v7, v7, v254
    v_add_u32 v7, s4, v7
    s_waitcnt vmcnt(32)
    ds_read_b128 a[128:131], v4 offset:0
    ds_read_b128 a[132:135], v4 offset:64
    ds_read_b128 a[136:139], v4 offset:128
    ds_read_b128 a[140:143], v4 offset:192
    ds_read_b128 a[144:147], v4 offset:256
    ds_read_b128 a[148:151], v4 offset:320
    ds_read_b128 a[152:155], v4 offset:384
    ds_read_b128 a[156:159], v4 offset:448
    ds_read_b128 a[160:163], v4 offset:512
    ds_read_b128 a[164:167], v4 offset:576
    ds_read_b128 a[168:171], v4 offset:640
    ds_read_b128 a[172:175], v4 offset:704
    ds_read_b128 a[176:179], v4 offset:768
    ds_read_b128 a[180:183], v4 offset:832
    ds_read_b128 a[184:187], v4 offset:896
    ds_read_b128 a[188:191], v4 offset:960
    ds_read_b128 a[192:195], v4 offset:1024
    ds_read_b128 a[196:199], v4 offset:1088
    ds_read_b128 a[200:203], v4 offset:1152
    ds_read_b128 a[204:207], v4 offset:1216
    ds_read_b128 a[208:211], v4 offset:1280
    ds_read_b128 a[212:215], v4 offset:1344
    ds_read_b128 a[216:219], v4 offset:1408
    ds_read_b128 a[220:223], v4 offset:1472
    ds_read_b128 a[224:227], v4 offset:1536
    ds_read_b128 a[228:231], v4 offset:1600
    ds_read_b128 a[232:235], v4 offset:1664
    ds_read_b128 a[236:239], v4 offset:1728
    ds_read_b128 a[240:243], v4 offset:1792
    ds_read_b128 a[244:247], v4 offset:1856
    ds_read_b128 a[248:251], v4 offset:1920
    ds_read_b128 a[252:255], v4 offset:1984
    v_subrev_u32 v8, 6144, v7
    buffer_load_dwordx4 v[32:35], v8, s[16:19], 0 offen
    v_subrev_u32 v8, 4096, v7
    buffer_load_dwordx4 v[36:39], v8, s[16:19], 0 offen
    v_subrev_u32 v8, 2048, v7
    buffer_load_dwordx4 v[40:43], v8, s[16:19], 0 offen
    s_mov_b32 s4, 0
    buffer_load_dwordx4 v[44:47], v7, s[16:19], s4 offen offset:0
    buffer_load_dwordx4 v[76:79], v7, s[28:31], s4 offen offset:0
    buffer_load_dwordx4 v[48:51], v7, s[16:19], s4 offen offset:2048
    buffer_load_dwordx4 v[80:83], v7, s[28:31], s4 offen offset:2048
    s_mov_b32 s4, 4096
    buffer_load_dwordx4 v[52:55], v7, s[16:19], s4 offen offset:0
    buffer_load_dwordx4 v[84:87], v7, s[28:31], s4 offen offset:0
    buffer_load_dwordx4 v[56:59], v7, s[16:19], s4 offen offset:2048
    buffer_load_dwordx4 v[88:91], v7, s[28:31], s4 offen offset:2048
    s_mov_b32 s4, 8192
    buffer_load_dwordx4 v[60:63], v7, s[16:19], s4 offen offset:0
    buffer_load_dwordx4 v[92:95], v7, s[28:31], s4 offen offset:0
    buffer_load_dwordx4 v[64:67], v7, s[16:19], s4 offen offset:2048
    buffer_load_dwordx4 v[96:99], v7, s[28:31], s4 offen offset:2048
    s_mov_b32 s4, 12288
    buffer_load_dwordx4 v[68:71], v7, s[16:19], s4 offen offset:0
    buffer_load_dwordx4 v[100:103], v7, s[28:31], s4 offen offset:0
    buffer_load_dwordx4 v[72:75], v7, s[16:19], s4 offen offset:2048
    buffer_load_dwordx4 v[104:107], v7, s[28:31], s4 offen offset:2048
    v_add_u32 v9, s6, v2
    v_and_b32 v12, 31, v1
    v_lshrrev_b32 v13, 5, v1
    v_lshlrev_b32 v14, 3, v13
    v_sub_u32 v14, v12, v14
    v_add_u32 v15, 10, v14
    v_and_b32 v10, 1, v15
    v_xor_b32 v10, 1, v10
    v_mul_u32_u24 v10, 4160, v10
    v_lshrrev_b32 v15, 1, v15
    v_lshl_add_u32 v10, v15, 2, v10
    v_add_u32 v10, s6, v10
    v_mul_u32_u24 v11, 80, v12
    v_lshl_add_u32 v11, v13, 4, v11
    s_mul_i32 s4, s24, 7680
    s_sub_u32 s4, s4, 2480
    v_add_u32 v11, s4, v11
    v_cmp_eq_u32 vcc, 7, v14
    v_mov_b32 v15, 0xffff
    s_nop 0
    v_cndmask_b32 v24, 0, v15, vcc
    v_cmp_eq_u32 vcc, 6, v14
    v_mov_b32 v15, 0xffff0000
    s_nop 0
    v_cndmask_b32 v24, v24, v15, vcc
    v_cmp_eq_u32 vcc, 5, v14
    v_mov_b32 v15, 0xffff
    s_nop 0
    v_cndmask_b32 v25, 0, v15, vcc
    v_cmp_eq_u32 vcc, 4, v14
    v_mov_b32 v15, 0xffff0000
    s_nop 0
    v_cndmask_b32 v25, v25, v15, vcc
    v_cmp_eq_u32 vcc, 3, v14
    v_mov_b32 v15, 0xffff
    s_nop 0
    v_cndmask_b32 v26, 0, v15, vcc
    v_cmp_eq_u32 vcc, 2, v14
    v_mov_b32 v15, 0xffff0000
    s_nop 0
    v_cndmask_b32 v26, v26, v15, vcc
    v_cmp_eq_u32 vcc, 1, v14
    v_mov_b32 v15, 0xffff
    s_nop 0
    v_cndmask_b32 v27, 0, v15, vcc
    v_cmp_eq_u32 vcc, 0, v14
    v_mov_b32 v15, 0xffff0000
    s_nop 0
    v_cndmask_b32 v27, v27, v15, vcc
    v_cmp_eq_u32 vcc, 23, v14
    v_mov_b32 v15, 0xffff
    s_nop 0
    v_cndmask_b32 v28, 0, v15, vcc
    v_cmp_eq_u32 vcc, 22, v14
    v_mov_b32 v15, 0xffff0000
    s_nop 0
    v_cndmask_b32 v28, v28, v15, vcc
    v_cmp_eq_u32 vcc, 21, v14
    v_mov_b32 v15, 0xffff
    s_nop 0
    v_cndmask_b32 v29, 0, v15, vcc
    v_cmp_eq_u32 vcc, 20, v14
    v_mov_b32 v15, 0xffff0000
    s_nop 0
    v_cndmask_b32 v29, v29, v15, vcc
    v_cmp_eq_u32 vcc, 19, v14
    v_mov_b32 v15, 0xffff
    s_nop 0
    v_cndmask_b32 v30, 0, v15, vcc
    v_cmp_eq_u32 vcc, 18, v14
    v_mov_b32 v15, 0xffff0000
    s_nop 0
    v_cndmask_b32 v30, v30, v15, vcc
    v_cmp_eq_u32 vcc, 17, v14
    v_mov_b32 v15, 0xffff
    s_nop 0
    v_cndmask_b32 v31, 0, v15, vcc
    v_cmp_eq_u32 vcc, 16, v14
    v_mov_b32 v15, 0xffff0000
    s_nop 0
    v_cndmask_b32 v31, v31, v15, vcc
    s_waitcnt lgkmcnt(0)
    s_waitcnt vmcnt(50)
    v_mfma_f32_16x16x32_bf16 v[216:219], a[128:131], a[0:3], 0
    s_waitcnt vmcnt(49)
    v_mfma_f32_16x16x32_bf16 v[216:219], a[132:135], a[4:7], v[216:219]
    s_waitcnt vmcnt(48)
    v_mfma_f32_16x16x32_bf16 v[216:219], a[136:139], a[8:11], v[216:219]
    s_waitcnt vmcnt(47)
    v_mfma_f32_16x16x32_bf16 v[216:219], a[140:143], a[12:15], v[216:219]
    s_waitcnt vmcnt(46)
    v_mfma_f32_16x16x32_bf16 v[216:219], a[144:147], a[16:19], v[216:219]
    s_waitcnt vmcnt(45)
    v_mfma_f32_16x16x32_bf16 v[216:219], a[148:151], a[20:23], v[216:219]
    s_waitcnt vmcnt(44)
    v_mfma_f32_16x16x32_bf16 v[216:219], a[152:155], a[24:27], v[216:219]
    s_waitcnt vmcnt(43)
    v_mfma_f32_16x16x32_bf16 v[216:219], a[156:159], a[28:31], v[216:219]
    s_waitcnt vmcnt(42)
    v_mfma_f32_16x16x32_bf16 v[216:219], a[160:163], a[32:35], v[216:219]
    s_waitcnt vmcnt(41)
    v_mfma_f32_16x16x32_bf16 v[216:219], a[164:167], a[36:39], v[216:219]
    s_waitcnt vmcnt(40)
    v_mfma_f32_16x16x32_bf16 v[216:219], a[168:171], a[40:43], v[216:219]
    s_waitcnt vmcnt(39)
    v_mfma_f32_16x16x32_bf16 v[216:219], a[172:175], a[44:47], v[216:219]
    s_waitcnt vmcnt(38)
    v_mfma_f32_16x16x32_bf16 v[216:219], a[176:179], a[48:51], v[216:219]
    s_waitcnt vmcnt(37)
    v_mfma_f32_16x16x32_bf16 v[216:219], a[180:183], a[52:55], v[216:219]
    s_waitcnt vmcnt(36)
    v_mfma_f32_16x16x32_bf16 v[216:219], a[184:187], a[56:59], v[216:219]
    s_waitcnt vmcnt(35)
    v_mfma_f32_16x16x32_bf16 v[216:219], a[188:191], a[60:63], v[216:219]
    s_waitcnt vmcnt(34)
    v_mfma_f32_16x16x32_bf16 v[216:219], a[192:195], a[64:67], v[216:219]
    s_waitcnt vmcnt(33)
    v_mfma_f32_16x16x32_bf16 v[216:219], a[196:199], a[68:71], v[216:219]
    s_waitcnt vmcnt(32)
    v_mfma_f32_16x16x32_bf16 v[216:219], a[200:203], a[72:75], v[216:219]
    s_waitcnt vmcnt(31)
    v_mfma_f32_16x16x32_bf16 v[216:219], a[204:207], a[76:79], v[216:219]
    s_waitcnt vmcnt(30)
    v_mfma_f32_16x16x32_bf16 v[216:219], a[208:211], a[80:83], v[216:219]
    s_waitcnt vmcnt(29)
    v_mfma_f32_16x16x32_bf16 v[216:219], a[212:215], a[84:87], v[216:219]
    s_waitcnt vmcnt(28)
    v_mfma_f32_16x16x32_bf16 v[216:219], a[216:219], a[88:91], v[216:219]
    s_waitcnt vmcnt(27)
    v_mfma_f32_16x16x32_bf16 v[216:219], a[220:223], a[92:95], v[216:219]
    s_waitcnt vmcnt(26)
    v_mfma_f32_16x16x32_bf16 v[216:219], a[224:227], a[96:99], v[216:219]
    s_waitcnt vmcnt(25)
    v_mfma_f32_16x16x32_bf16 v[216:219], a[228:231], a[100:103], v[216:219]
    s_waitcnt vmcnt(24)
    v_mfma_f32_16x16x32_bf16 v[216:219], a[232:235], a[104:107], v[216:219]
    s_waitcnt vmcnt(23)
    v_mfma_f32_16x16x32_bf16 v[216:219], a[236:239], a[108:111], v[216:219]
    s_waitcnt vmcnt(22)
    v_mfma_f32_16x16x32_bf16 v[216:219], a[240:243], a[112:115], v[216:219]
    s_waitcnt vmcnt(21)
    v_mfma_f32_16x16x32_bf16 v[216:219], a[244:247], a[116:119], v[216:219]
    s_waitcnt vmcnt(20)
    v_mfma_f32_16x16x32_bf16 v[216:219], a[248:251], a[120:123], v[216:219]
    s_waitcnt vmcnt(19)
    v_mfma_f32_16x16x32_bf16 v[216:219], a[252:255], a[124:127], v[216:219]
    v_add_u32 v7, 2097152, v7
    v_subrev_u32 v8, 6144, v7
    buffer_load_dwordx4 v[108:111], v8, s[16:19], 0 offen
    v_subrev_u32 v8, 4096, v7
    buffer_load_dwordx4 v[112:115], v8, s[16:19], 0 offen
    v_subrev_u32 v8, 2048, v7
    buffer_load_dwordx4 v[116:119], v8, s[16:19], 0 offen
    s_mov_b32 s4, 0
    buffer_load_dwordx4 v[120:123], v7, s[16:19], s4 offen offset:0
    buffer_load_dwordx4 v[152:155], v7, s[28:31], s4 offen offset:0
    buffer_load_dwordx4 v[124:127], v7, s[16:19], s4 offen offset:2048
    buffer_load_dwordx4 v[156:159], v7, s[28:31], s4 offen offset:2048
    s_mov_b32 s4, 4096
    buffer_load_dwordx4 v[128:131], v7, s[16:19], s4 offen offset:0
    buffer_load_dwordx4 v[160:163], v7, s[28:31], s4 offen offset:0
    buffer_load_dwordx4 v[132:135], v7, s[16:19], s4 offen offset:2048
    buffer_load_dwordx4 v[164:167], v7, s[28:31], s4 offen offset:2048
    s_mov_b32 s4, 8192
    buffer_load_dwordx4 v[136:139], v7, s[16:19], s4 offen offset:0
    buffer_load_dwordx4 v[168:171], v7, s[28:31], s4 offen offset:0
    buffer_load_dwordx4 v[140:143], v7, s[16:19], s4 offen offset:2048
    buffer_load_dwordx4 v[172:175], v7, s[28:31], s4 offen offset:2048
    s_mov_b32 s4, 12288
    buffer_load_dwordx4 v[144:147], v7, s[16:19], s4 offen offset:0
    buffer_load_dwordx4 v[176:179], v7, s[28:31], s4 offen offset:0
    buffer_load_dwordx4 v[148:151], v7, s[16:19], s4 offen offset:2048
    buffer_load_dwordx4 v[180:183], v7, s[28:31], s4 offen offset:2048
    v_subrev_u32 v7, 2096128, v7
    v_cvt_pk_bf16_f32 v216, v216, v216
    v_lshlrev_b32 v216, 16, v216
    v_mul_f32 v216, 0xbfb8aa3b, v216
    v_exp_f32 v216, v216
    s_lshl_b32 s4, s99, 8
    v_add_f32 v216, 1.0, v216
    v_rcp_f32 v216, v216
    s_lshl_b32 s5, s24, 6
    v_cvt_pk_bf16_f32 v216, v216, v216
    v_lshlrev_b32 v216, 16, v216
    s_add_u32 s4, s4, s5
    s_add_u32 s4, s4, 121634816
    v_lshlrev_b32 v15, 2, v1
    s_mov_b64 exec, 0xffff
    buffer_store_dword v216, v15, s[8:11], s4 offen sc1
    s_mov_b64 exec, -1
    v_mov_b32 v220, 0
    v_mov_b32 v221, 0
    v_mov_b32 v222, 0
    v_mov_b32 v223, 0
    s_mul_i32 s4, s24, 7680
    v_add_u32 v15, s4, v2
    ds_write_b128 v15, v[220:223] offset:0
    ds_write_b128 v15, v[220:223] offset:1024
    ds_write_b128 v15, v[220:223] offset:1536
    v_add_u32 v15, 30720, v15
    ds_write_b128 v15, v[220:223] offset:0
    ds_write_b128 v15, v[220:223] offset:1024
    ds_write_b128 v15, v[220:223] offset:1536
    v_add_u32 v15, 30720, v15
    ds_write_b128 v15, v[220:223] offset:0
    ds_write_b128 v15, v[220:223] offset:1024
    ds_write_b128 v15, v[220:223] offset:1536
    v_add_u32 v15, 30720, v15
    ds_write_b128 v15, v[220:223] offset:0
    ds_write_b128 v15, v[220:223] offset:1024
    ds_write_b128 v15, v[220:223] offset:1536
    v_add_u32 v15, 30720, v15
    s_mov_b64 exec, 0xf
    ds_write_b128 v9, v[220:223]
    ds_write_b128 v9, v[220:223] offset:4160
    s_mov_b64 exec, -1
    s_mul_i32 s4, s24, 640
    s_add_u32 s4, s4, 2560
    v_bfe_u32 v254, v1, 0, 1
    v_mul_u32_u24 v12, 61440, v254
    v_bfe_u32 v254, v1, 3, 3
    v_mul_u32_u24 v254, 80, v254
    v_add_u32 v12, v12, v254
    v_bfe_u32 v254, v1, 1, 2
    v_mul_u32_u24 v254, 16, v254
    v_add_u32 v12, v12, v254
    v_add_u32 v12, s4, v12
    s_lshl_b32 s4, s99, 7
    v_bfe_u32 v254, v1, 0, 1
    v_mul_u32_u24 v13, 64, v254
    v_add_u32 v13, s4, v13
    s_mov_b32 s63, 0
.pass_210:
    buffer_load_dwordx4 v[216:219], v13, s[32:35], 0 offen offset:0
    buffer_load_dwordx4 v[220:223], v13, s[32:35], 0 offen offset:16
    buffer_load_dwordx4 v[224:227], v13, s[32:35], 0 offen offset:32
    buffer_load_dwordx4 v[228:231], v13, s[32:35], 0 offen offset:48
    v_add_u32 v13, 4096, v13
    s_waitcnt vmcnt(0)
    v_lshlrev_b32 v184, 16, v216
    v_lshlrev_b32 v185, 16, v218
    v_and_b32 v186, 0xffff0000, v216
    v_and_b32 v187, 0xffff0000, v218
    v_lshlrev_b32 v188, 16, v217
    v_lshlrev_b32 v189, 16, v219
    v_and_b32 v190, 0xffff0000, v217
    v_and_b32 v191, 0xffff0000, v219
    v_lshlrev_b32 v192, 16, v220
    v_lshlrev_b32 v193, 16, v222
    v_and_b32 v194, 0xffff0000, v220
    v_and_b32 v195, 0xffff0000, v222
    v_lshlrev_b32 v196, 16, v221
    v_lshlrev_b32 v197, 16, v223
    v_and_b32 v198, 0xffff0000, v221
    v_and_b32 v199, 0xffff0000, v223
    v_lshlrev_b32 v200, 16, v224
    v_lshlrev_b32 v201, 16, v226
    v_and_b32 v202, 0xffff0000, v224
    v_and_b32 v203, 0xffff0000, v226
    v_lshlrev_b32 v204, 16, v225
    v_lshlrev_b32 v205, 16, v227
    v_and_b32 v206, 0xffff0000, v225
    v_and_b32 v207, 0xffff0000, v227
    v_lshlrev_b32 v208, 16, v228
    v_lshlrev_b32 v209, 16, v230
    v_and_b32 v210, 0xffff0000, v228
    v_and_b32 v211, 0xffff0000, v230
    v_lshlrev_b32 v212, 16, v229
    v_lshlrev_b32 v213, 16, v231
    v_and_b32 v214, 0xffff0000, v229
    v_and_b32 v215, 0xffff0000, v231
    v_lshlrev_b32 v216, 16, v32
    v_and_b32 v217, 0xffff0000, v32
    v_lshlrev_b32 v218, 16, v36
    v_and_b32 v219, 0xffff0000, v36
    v_lshlrev_b32 v220, 16, v40
    v_and_b32 v221, 0xffff0000, v40
    v_lshlrev_b32 v222, 16, v44
    v_and_b32 v223, 0xffff0000, v44
    v_lshlrev_b32 v224, 16, v48
    v_and_b32 v225, 0xffff0000, v48
    v_lshlrev_b32 v226, 16, v52
    v_and_b32 v227, 0xffff0000, v52
    v_lshlrev_b32 v228, 16, v56
    v_and_b32 v229, 0xffff0000, v56
    v_lshlrev_b32 v230, 16, v60
    v_and_b32 v231, 0xffff0000, v60
    v_lshlrev_b32 v232, 16, v64
    v_and_b32 v233, 0xffff0000, v64
    v_lshlrev_b32 v234, 16, v68
    v_and_b32 v235, 0xffff0000, v68
    v_lshlrev_b32 v236, 16, v72
    v_and_b32 v237, 0xffff0000, v72
    v_pk_mul_f32 v[216:217], v[216:217], v[190:191]
    v_lshlrev_b32 v238, 16, v76
    v_pk_fma_f32 v[216:217], v[218:219], v[188:189], v[216:217]
    v_and_b32 v239, 0xffff0000, v76
    v_pk_fma_f32 v[216:217], v[220:221], v[186:187], v[216:217]
    v_pk_fma_f32 v[216:217], v[222:223], v[184:185], v[216:217]
    v_pk_mul_f32 v[216:217], v[216:217], v[238:239]
    v_pk_mul_f32 v[218:219], v[218:219], v[190:191]
    v_lshlrev_b32 v240, 16, v80
    v_pk_fma_f32 v[218:219], v[220:221], v[188:189], v[218:219]
    v_and_b32 v241, 0xffff0000, v80
    v_pk_fma_f32 v[218:219], v[222:223], v[186:187], v[218:219]
    v_pk_fma_f32 v[218:219], v[224:225], v[184:185], v[218:219]
    v_pk_mul_f32 v[218:219], v[218:219], v[240:241]
    v_pk_mul_f32 v[220:221], v[220:221], v[190:191]
    v_lshlrev_b32 v238, 16, v84
    v_pk_fma_f32 v[220:221], v[222:223], v[188:189], v[220:221]
    v_and_b32 v239, 0xffff0000, v84
    v_pk_fma_f32 v[220:221], v[224:225], v[186:187], v[220:221]
    v_pk_fma_f32 v[220:221], v[226:227], v[184:185], v[220:221]
    v_pk_mul_f32 v[220:221], v[220:221], v[238:239]
    v_pk_mul_f32 v[222:223], v[222:223], v[190:191]
    v_lshlrev_b32 v240, 16, v88
    v_pk_fma_f32 v[222:223], v[224:225], v[188:189], v[222:223]
    v_and_b32 v241, 0xffff0000, v88
    v_pk_fma_f32 v[222:223], v[226:227], v[186:187], v[222:223]
    v_pk_fma_f32 v[222:223], v[228:229], v[184:185], v[222:223]
    v_pk_mul_f32 v[222:223], v[222:223], v[240:241]
    v_pk_mul_f32 v[224:225], v[224:225], v[190:191]
    v_lshlrev_b32 v238, 16, v92
    v_pk_fma_f32 v[224:225], v[226:227], v[188:189], v[224:225]
    v_and_b32 v239, 0xffff0000, v92
    v_pk_fma_f32 v[224:225], v[228:229], v[186:187], v[224:225]
    v_pk_fma_f32 v[224:225], v[230:231], v[184:185], v[224:225]
    v_pk_mul_f32 v[224:225], v[224:225], v[238:239]
    v_pk_mul_f32 v[226:227], v[226:227], v[190:191]
    v_lshlrev_b32 v240, 16, v96
    v_pk_fma_f32 v[226:227], v[228:229], v[188:189], v[226:227]
    v_and_b32 v241, 0xffff0000, v96
    v_pk_fma_f32 v[226:227], v[230:231], v[186:187], v[226:227]
    v_pk_fma_f32 v[226:227], v[232:233], v[184:185], v[226:227]
    v_pk_mul_f32 v[226:227], v[226:227], v[240:241]
    v_pk_mul_f32 v[228:229], v[228:229], v[190:191]
    v_lshlrev_b32 v238, 16, v100
    v_pk_fma_f32 v[228:229], v[230:231], v[188:189], v[228:229]
    v_and_b32 v239, 0xffff0000, v100
    v_pk_fma_f32 v[228:229], v[232:233], v[186:187], v[228:229]
    v_pk_fma_f32 v[228:229], v[234:235], v[184:185], v[228:229]
    v_pk_mul_f32 v[228:229], v[228:229], v[238:239]
    v_pk_mul_f32 v[230:231], v[230:231], v[190:191]
    v_lshlrev_b32 v240, 16, v104
    v_pk_fma_f32 v[230:231], v[232:233], v[188:189], v[230:231]
    v_and_b32 v241, 0xffff0000, v104
    v_pk_fma_f32 v[230:231], v[234:235], v[186:187], v[230:231]
    v_pk_fma_f32 v[230:231], v[236:237], v[184:185], v[230:231]
    v_pk_mul_f32 v[230:231], v[230:231], v[240:241]
    v_cvt_pk_bf16_f32 v242, v230, v228
    v_cvt_pk_bf16_f32 v243, v226, v224
    v_cvt_pk_bf16_f32 v244, v222, v220
    v_cvt_pk_bf16_f32 v245, v218, v216
    ds_write_b128 v12, v[242:245] offset:0
    v_cvt_pk_bf16_f32 v246, v231, v229
    v_cvt_pk_bf16_f32 v247, v227, v225
    v_cvt_pk_bf16_f32 v248, v223, v221
    v_cvt_pk_bf16_f32 v249, v219, v217
    ds_write_b128 v12, v[246:249] offset:7680
    v_lshlrev_b32 v216, 16, v33
    v_and_b32 v217, 0xffff0000, v33
    v_lshlrev_b32 v218, 16, v37
    v_and_b32 v219, 0xffff0000, v37
    v_lshlrev_b32 v220, 16, v41
    v_and_b32 v221, 0xffff0000, v41
    v_lshlrev_b32 v222, 16, v45
    v_and_b32 v223, 0xffff0000, v45
    v_lshlrev_b32 v224, 16, v49
    v_and_b32 v225, 0xffff0000, v49
    v_lshlrev_b32 v226, 16, v53
    v_and_b32 v227, 0xffff0000, v53
    v_lshlrev_b32 v228, 16, v57
    v_and_b32 v229, 0xffff0000, v57
    v_lshlrev_b32 v230, 16, v61
    v_and_b32 v231, 0xffff0000, v61
    v_lshlrev_b32 v232, 16, v65
    v_and_b32 v233, 0xffff0000, v65
    v_lshlrev_b32 v234, 16, v69
    v_and_b32 v235, 0xffff0000, v69
    v_lshlrev_b32 v236, 16, v73
    v_and_b32 v237, 0xffff0000, v73
    v_pk_mul_f32 v[216:217], v[216:217], v[198:199]
    v_lshlrev_b32 v238, 16, v77
    v_pk_fma_f32 v[216:217], v[218:219], v[196:197], v[216:217]
    v_and_b32 v239, 0xffff0000, v77
    v_pk_fma_f32 v[216:217], v[220:221], v[194:195], v[216:217]
    v_pk_fma_f32 v[216:217], v[222:223], v[192:193], v[216:217]
    v_pk_mul_f32 v[216:217], v[216:217], v[238:239]
    v_pk_mul_f32 v[218:219], v[218:219], v[198:199]
    v_lshlrev_b32 v240, 16, v81
    v_pk_fma_f32 v[218:219], v[220:221], v[196:197], v[218:219]
    v_and_b32 v241, 0xffff0000, v81
    v_pk_fma_f32 v[218:219], v[222:223], v[194:195], v[218:219]
    v_pk_fma_f32 v[218:219], v[224:225], v[192:193], v[218:219]
    v_pk_mul_f32 v[218:219], v[218:219], v[240:241]
    v_pk_mul_f32 v[220:221], v[220:221], v[198:199]
    v_lshlrev_b32 v238, 16, v85
    v_pk_fma_f32 v[220:221], v[222:223], v[196:197], v[220:221]
    v_and_b32 v239, 0xffff0000, v85
    v_pk_fma_f32 v[220:221], v[224:225], v[194:195], v[220:221]
    v_pk_fma_f32 v[220:221], v[226:227], v[192:193], v[220:221]
    v_pk_mul_f32 v[220:221], v[220:221], v[238:239]
    v_pk_mul_f32 v[222:223], v[222:223], v[198:199]
    v_lshlrev_b32 v240, 16, v89
    v_pk_fma_f32 v[222:223], v[224:225], v[196:197], v[222:223]
    v_and_b32 v241, 0xffff0000, v89
    v_pk_fma_f32 v[222:223], v[226:227], v[194:195], v[222:223]
    v_pk_fma_f32 v[222:223], v[228:229], v[192:193], v[222:223]
    v_pk_mul_f32 v[222:223], v[222:223], v[240:241]
    v_pk_mul_f32 v[224:225], v[224:225], v[198:199]
    v_lshlrev_b32 v238, 16, v93
    v_pk_fma_f32 v[224:225], v[226:227], v[196:197], v[224:225]
    v_and_b32 v239, 0xffff0000, v93
    v_pk_fma_f32 v[224:225], v[228:229], v[194:195], v[224:225]
    v_pk_fma_f32 v[224:225], v[230:231], v[192:193], v[224:225]
    v_pk_mul_f32 v[224:225], v[224:225], v[238:239]
    v_pk_mul_f32 v[226:227], v[226:227], v[198:199]
    v_lshlrev_b32 v240, 16, v97
    v_pk_fma_f32 v[226:227], v[228:229], v[196:197], v[226:227]
    v_and_b32 v241, 0xffff0000, v97
    v_pk_fma_f32 v[226:227], v[230:231], v[194:195], v[226:227]
    v_pk_fma_f32 v[226:227], v[232:233], v[192:193], v[226:227]
    v_pk_mul_f32 v[226:227], v[226:227], v[240:241]
    v_pk_mul_f32 v[228:229], v[228:229], v[198:199]
    v_lshlrev_b32 v238, 16, v101
    v_pk_fma_f32 v[228:229], v[230:231], v[196:197], v[228:229]
    v_and_b32 v239, 0xffff0000, v101
    v_pk_fma_f32 v[228:229], v[232:233], v[194:195], v[228:229]
    v_pk_fma_f32 v[228:229], v[234:235], v[192:193], v[228:229]
    v_pk_mul_f32 v[228:229], v[228:229], v[238:239]
    v_pk_mul_f32 v[230:231], v[230:231], v[198:199]
    v_lshlrev_b32 v240, 16, v105
    v_pk_fma_f32 v[230:231], v[232:233], v[196:197], v[230:231]
    v_and_b32 v241, 0xffff0000, v105
    v_pk_fma_f32 v[230:231], v[234:235], v[194:195], v[230:231]
    v_pk_fma_f32 v[230:231], v[236:237], v[192:193], v[230:231]
    v_pk_mul_f32 v[230:231], v[230:231], v[240:241]
    v_cvt_pk_bf16_f32 v242, v230, v228
    v_cvt_pk_bf16_f32 v243, v226, v224
    v_cvt_pk_bf16_f32 v244, v222, v220
    v_cvt_pk_bf16_f32 v245, v218, v216
    ds_write_b128 v12, v[242:245] offset:15360
    v_cvt_pk_bf16_f32 v246, v231, v229
    v_cvt_pk_bf16_f32 v247, v227, v225
    v_cvt_pk_bf16_f32 v248, v223, v221
    v_cvt_pk_bf16_f32 v249, v219, v217
    ds_write_b128 v12, v[246:249] offset:23040
    v_lshlrev_b32 v216, 16, v34
    v_and_b32 v217, 0xffff0000, v34
    v_lshlrev_b32 v218, 16, v38
    v_and_b32 v219, 0xffff0000, v38
    v_lshlrev_b32 v220, 16, v42
    v_and_b32 v221, 0xffff0000, v42
    v_lshlrev_b32 v222, 16, v46
    v_and_b32 v223, 0xffff0000, v46
    v_lshlrev_b32 v224, 16, v50
    v_and_b32 v225, 0xffff0000, v50
    v_lshlrev_b32 v226, 16, v54
    v_and_b32 v227, 0xffff0000, v54
    v_lshlrev_b32 v228, 16, v58
    v_and_b32 v229, 0xffff0000, v58
    v_lshlrev_b32 v230, 16, v62
    v_and_b32 v231, 0xffff0000, v62
    v_lshlrev_b32 v232, 16, v66
    v_and_b32 v233, 0xffff0000, v66
    v_lshlrev_b32 v234, 16, v70
    v_and_b32 v235, 0xffff0000, v70
    v_lshlrev_b32 v236, 16, v74
    v_and_b32 v237, 0xffff0000, v74
    v_pk_mul_f32 v[216:217], v[216:217], v[206:207]
    v_lshlrev_b32 v238, 16, v78
    v_pk_fma_f32 v[216:217], v[218:219], v[204:205], v[216:217]
    v_and_b32 v239, 0xffff0000, v78
    v_pk_fma_f32 v[216:217], v[220:221], v[202:203], v[216:217]
    v_pk_fma_f32 v[216:217], v[222:223], v[200:201], v[216:217]
    v_pk_mul_f32 v[216:217], v[216:217], v[238:239]
    v_pk_mul_f32 v[218:219], v[218:219], v[206:207]
    v_lshlrev_b32 v240, 16, v82
    v_pk_fma_f32 v[218:219], v[220:221], v[204:205], v[218:219]
    v_and_b32 v241, 0xffff0000, v82
    v_pk_fma_f32 v[218:219], v[222:223], v[202:203], v[218:219]
    v_pk_fma_f32 v[218:219], v[224:225], v[200:201], v[218:219]
    v_pk_mul_f32 v[218:219], v[218:219], v[240:241]
    v_pk_mul_f32 v[220:221], v[220:221], v[206:207]
    v_lshlrev_b32 v238, 16, v86
    v_pk_fma_f32 v[220:221], v[222:223], v[204:205], v[220:221]
    v_and_b32 v239, 0xffff0000, v86
    v_pk_fma_f32 v[220:221], v[224:225], v[202:203], v[220:221]
    v_pk_fma_f32 v[220:221], v[226:227], v[200:201], v[220:221]
    v_pk_mul_f32 v[220:221], v[220:221], v[238:239]
    v_pk_mul_f32 v[222:223], v[222:223], v[206:207]
    v_lshlrev_b32 v240, 16, v90
    v_pk_fma_f32 v[222:223], v[224:225], v[204:205], v[222:223]
    v_and_b32 v241, 0xffff0000, v90
    v_pk_fma_f32 v[222:223], v[226:227], v[202:203], v[222:223]
    v_pk_fma_f32 v[222:223], v[228:229], v[200:201], v[222:223]
    v_pk_mul_f32 v[222:223], v[222:223], v[240:241]
    v_pk_mul_f32 v[224:225], v[224:225], v[206:207]
    v_lshlrev_b32 v238, 16, v94
    v_pk_fma_f32 v[224:225], v[226:227], v[204:205], v[224:225]
    v_and_b32 v239, 0xffff0000, v94
    v_pk_fma_f32 v[224:225], v[228:229], v[202:203], v[224:225]
    v_pk_fma_f32 v[224:225], v[230:231], v[200:201], v[224:225]
    v_pk_mul_f32 v[224:225], v[224:225], v[238:239]
    v_pk_mul_f32 v[226:227], v[226:227], v[206:207]
    v_lshlrev_b32 v240, 16, v98
    v_pk_fma_f32 v[226:227], v[228:229], v[204:205], v[226:227]
    v_and_b32 v241, 0xffff0000, v98
    v_pk_fma_f32 v[226:227], v[230:231], v[202:203], v[226:227]
    v_pk_fma_f32 v[226:227], v[232:233], v[200:201], v[226:227]
    v_pk_mul_f32 v[226:227], v[226:227], v[240:241]
    v_pk_mul_f32 v[228:229], v[228:229], v[206:207]
    v_lshlrev_b32 v238, 16, v102
    v_pk_fma_f32 v[228:229], v[230:231], v[204:205], v[228:229]
    v_and_b32 v239, 0xffff0000, v102
    v_pk_fma_f32 v[228:229], v[232:233], v[202:203], v[228:229]
    v_pk_fma_f32 v[228:229], v[234:235], v[200:201], v[228:229]
    v_pk_mul_f32 v[228:229], v[228:229], v[238:239]
    v_pk_mul_f32 v[230:231], v[230:231], v[206:207]
    v_lshlrev_b32 v240, 16, v106
    v_pk_fma_f32 v[230:231], v[232:233], v[204:205], v[230:231]
    v_and_b32 v241, 0xffff0000, v106
    v_pk_fma_f32 v[230:231], v[234:235], v[202:203], v[230:231]
    v_pk_fma_f32 v[230:231], v[236:237], v[200:201], v[230:231]
    v_pk_mul_f32 v[230:231], v[230:231], v[240:241]
    v_cvt_pk_bf16_f32 v242, v230, v228
    v_cvt_pk_bf16_f32 v243, v226, v224
    v_cvt_pk_bf16_f32 v244, v222, v220
    v_cvt_pk_bf16_f32 v245, v218, v216
    ds_write_b128 v12, v[242:245] offset:30720
    v_cvt_pk_bf16_f32 v246, v231, v229
    v_cvt_pk_bf16_f32 v247, v227, v225
    v_cvt_pk_bf16_f32 v248, v223, v221
    v_cvt_pk_bf16_f32 v249, v219, v217
    ds_write_b128 v12, v[246:249] offset:38400
    v_lshlrev_b32 v216, 16, v35
    v_and_b32 v217, 0xffff0000, v35
    v_lshlrev_b32 v218, 16, v39
    v_and_b32 v219, 0xffff0000, v39
    v_lshlrev_b32 v220, 16, v43
    v_and_b32 v221, 0xffff0000, v43
    v_lshlrev_b32 v222, 16, v47
    v_and_b32 v223, 0xffff0000, v47
    v_lshlrev_b32 v224, 16, v51
    v_and_b32 v225, 0xffff0000, v51
    v_lshlrev_b32 v226, 16, v55
    v_and_b32 v227, 0xffff0000, v55
    v_lshlrev_b32 v228, 16, v59
    v_and_b32 v229, 0xffff0000, v59
    v_lshlrev_b32 v230, 16, v63
    v_and_b32 v231, 0xffff0000, v63
    v_lshlrev_b32 v232, 16, v67
    v_and_b32 v233, 0xffff0000, v67
    v_lshlrev_b32 v234, 16, v71
    v_and_b32 v235, 0xffff0000, v71
    v_lshlrev_b32 v236, 16, v75
    v_and_b32 v237, 0xffff0000, v75
    v_pk_mul_f32 v[216:217], v[216:217], v[214:215]
    v_lshlrev_b32 v238, 16, v79
    v_pk_fma_f32 v[216:217], v[218:219], v[212:213], v[216:217]
    v_and_b32 v239, 0xffff0000, v79
    v_pk_fma_f32 v[216:217], v[220:221], v[210:211], v[216:217]
    v_pk_fma_f32 v[216:217], v[222:223], v[208:209], v[216:217]
    v_pk_mul_f32 v[216:217], v[216:217], v[238:239]
    v_pk_mul_f32 v[218:219], v[218:219], v[214:215]
    v_lshlrev_b32 v240, 16, v83
    v_pk_fma_f32 v[218:219], v[220:221], v[212:213], v[218:219]
    v_and_b32 v241, 0xffff0000, v83
    v_pk_fma_f32 v[218:219], v[222:223], v[210:211], v[218:219]
    v_pk_fma_f32 v[218:219], v[224:225], v[208:209], v[218:219]
    v_pk_mul_f32 v[218:219], v[218:219], v[240:241]
    v_pk_mul_f32 v[220:221], v[220:221], v[214:215]
    v_lshlrev_b32 v238, 16, v87
    v_pk_fma_f32 v[220:221], v[222:223], v[212:213], v[220:221]
    v_and_b32 v239, 0xffff0000, v87
    v_pk_fma_f32 v[220:221], v[224:225], v[210:211], v[220:221]
    v_pk_fma_f32 v[220:221], v[226:227], v[208:209], v[220:221]
    v_pk_mul_f32 v[220:221], v[220:221], v[238:239]
    v_pk_mul_f32 v[222:223], v[222:223], v[214:215]
    v_lshlrev_b32 v240, 16, v91
    v_pk_fma_f32 v[222:223], v[224:225], v[212:213], v[222:223]
    v_and_b32 v241, 0xffff0000, v91
    v_pk_fma_f32 v[222:223], v[226:227], v[210:211], v[222:223]
    v_pk_fma_f32 v[222:223], v[228:229], v[208:209], v[222:223]
    v_pk_mul_f32 v[222:223], v[222:223], v[240:241]
    v_pk_mul_f32 v[224:225], v[224:225], v[214:215]
    v_lshlrev_b32 v238, 16, v95
    v_pk_fma_f32 v[224:225], v[226:227], v[212:213], v[224:225]
    v_and_b32 v239, 0xffff0000, v95
    v_pk_fma_f32 v[224:225], v[228:229], v[210:211], v[224:225]
    v_pk_fma_f32 v[224:225], v[230:231], v[208:209], v[224:225]
    v_pk_mul_f32 v[224:225], v[224:225], v[238:239]
    v_pk_mul_f32 v[226:227], v[226:227], v[214:215]
    v_lshlrev_b32 v240, 16, v99
    v_pk_fma_f32 v[226:227], v[228:229], v[212:213], v[226:227]
    v_and_b32 v241, 0xffff0000, v99
    v_pk_fma_f32 v[226:227], v[230:231], v[210:211], v[226:227]
    v_pk_fma_f32 v[226:227], v[232:233], v[208:209], v[226:227]
    v_pk_mul_f32 v[226:227], v[226:227], v[240:241]
    v_pk_mul_f32 v[228:229], v[228:229], v[214:215]
    v_lshlrev_b32 v238, 16, v103
    v_pk_fma_f32 v[228:229], v[230:231], v[212:213], v[228:229]
    v_and_b32 v239, 0xffff0000, v103
    v_pk_fma_f32 v[228:229], v[232:233], v[210:211], v[228:229]
    v_pk_fma_f32 v[228:229], v[234:235], v[208:209], v[228:229]
    v_pk_mul_f32 v[228:229], v[228:229], v[238:239]
    v_pk_mul_f32 v[230:231], v[230:231], v[214:215]
    v_lshlrev_b32 v240, 16, v107
    v_pk_fma_f32 v[230:231], v[232:233], v[212:213], v[230:231]
    v_and_b32 v241, 0xffff0000, v107
    v_pk_fma_f32 v[230:231], v[234:235], v[210:211], v[230:231]
    v_pk_fma_f32 v[230:231], v[236:237], v[208:209], v[230:231]
    v_pk_mul_f32 v[230:231], v[230:231], v[240:241]
    v_cvt_pk_bf16_f32 v242, v230, v228
    v_cvt_pk_bf16_f32 v243, v226, v224
    v_cvt_pk_bf16_f32 v244, v222, v220
    v_cvt_pk_bf16_f32 v245, v218, v216
    ds_write_b128 v12, v[242:245] offset:46080
    v_cvt_pk_bf16_f32 v246, v231, v229
    v_cvt_pk_bf16_f32 v247, v227, v225
    v_cvt_pk_bf16_f32 v248, v223, v221
    v_cvt_pk_bf16_f32 v249, v219, v217
    ds_write_b128 v12, v[246:249] offset:53760
    v_lshlrev_b32 v216, 16, v108
    v_and_b32 v217, 0xffff0000, v108
    v_lshlrev_b32 v218, 16, v112
    v_and_b32 v219, 0xffff0000, v112
    v_lshlrev_b32 v220, 16, v116
    v_and_b32 v221, 0xffff0000, v116
    v_lshlrev_b32 v222, 16, v120
    v_and_b32 v223, 0xffff0000, v120
    v_lshlrev_b32 v224, 16, v124
    v_and_b32 v225, 0xffff0000, v124
    v_lshlrev_b32 v226, 16, v128
    v_and_b32 v227, 0xffff0000, v128
    v_lshlrev_b32 v228, 16, v132
    v_and_b32 v229, 0xffff0000, v132
    v_lshlrev_b32 v230, 16, v136
    v_and_b32 v231, 0xffff0000, v136
    v_lshlrev_b32 v232, 16, v140
    v_and_b32 v233, 0xffff0000, v140
    v_lshlrev_b32 v234, 16, v144
    v_and_b32 v235, 0xffff0000, v144
    v_lshlrev_b32 v236, 16, v148
    v_and_b32 v237, 0xffff0000, v148
    v_pk_mul_f32 v[216:217], v[216:217], v[190:191]
    v_lshlrev_b32 v238, 16, v152
    v_pk_fma_f32 v[216:217], v[218:219], v[188:189], v[216:217]
    v_and_b32 v239, 0xffff0000, v152
    v_pk_fma_f32 v[216:217], v[220:221], v[186:187], v[216:217]
    v_pk_fma_f32 v[216:217], v[222:223], v[184:185], v[216:217]
    v_pk_mul_f32 v[216:217], v[216:217], v[238:239]
    v_pk_mul_f32 v[218:219], v[218:219], v[190:191]
    v_lshlrev_b32 v240, 16, v156
    v_pk_fma_f32 v[218:219], v[220:221], v[188:189], v[218:219]
    v_and_b32 v241, 0xffff0000, v156
    v_pk_fma_f32 v[218:219], v[222:223], v[186:187], v[218:219]
    v_pk_fma_f32 v[218:219], v[224:225], v[184:185], v[218:219]
    v_pk_mul_f32 v[218:219], v[218:219], v[240:241]
    v_pk_mul_f32 v[220:221], v[220:221], v[190:191]
    v_lshlrev_b32 v238, 16, v160
    v_pk_fma_f32 v[220:221], v[222:223], v[188:189], v[220:221]
    v_and_b32 v239, 0xffff0000, v160
    v_pk_fma_f32 v[220:221], v[224:225], v[186:187], v[220:221]
    v_pk_fma_f32 v[220:221], v[226:227], v[184:185], v[220:221]
    v_pk_mul_f32 v[220:221], v[220:221], v[238:239]
    v_pk_mul_f32 v[222:223], v[222:223], v[190:191]
    v_lshlrev_b32 v240, 16, v164
    v_pk_fma_f32 v[222:223], v[224:225], v[188:189], v[222:223]
    v_and_b32 v241, 0xffff0000, v164
    v_pk_fma_f32 v[222:223], v[226:227], v[186:187], v[222:223]
    v_pk_fma_f32 v[222:223], v[228:229], v[184:185], v[222:223]
    v_pk_mul_f32 v[222:223], v[222:223], v[240:241]
    v_pk_mul_f32 v[224:225], v[224:225], v[190:191]
    v_lshlrev_b32 v238, 16, v168
    v_pk_fma_f32 v[224:225], v[226:227], v[188:189], v[224:225]
    v_and_b32 v239, 0xffff0000, v168
    v_pk_fma_f32 v[224:225], v[228:229], v[186:187], v[224:225]
    v_pk_fma_f32 v[224:225], v[230:231], v[184:185], v[224:225]
    v_pk_mul_f32 v[224:225], v[224:225], v[238:239]
    v_pk_mul_f32 v[226:227], v[226:227], v[190:191]
    v_lshlrev_b32 v240, 16, v172
    v_pk_fma_f32 v[226:227], v[228:229], v[188:189], v[226:227]
    v_and_b32 v241, 0xffff0000, v172
    v_pk_fma_f32 v[226:227], v[230:231], v[186:187], v[226:227]
    v_pk_fma_f32 v[226:227], v[232:233], v[184:185], v[226:227]
    v_pk_mul_f32 v[226:227], v[226:227], v[240:241]
    v_pk_mul_f32 v[228:229], v[228:229], v[190:191]
    v_lshlrev_b32 v238, 16, v176
    v_pk_fma_f32 v[228:229], v[230:231], v[188:189], v[228:229]
    v_and_b32 v239, 0xffff0000, v176
    v_pk_fma_f32 v[228:229], v[232:233], v[186:187], v[228:229]
    v_pk_fma_f32 v[228:229], v[234:235], v[184:185], v[228:229]
    v_pk_mul_f32 v[228:229], v[228:229], v[238:239]
    v_pk_mul_f32 v[230:231], v[230:231], v[190:191]
    v_lshlrev_b32 v240, 16, v180
    v_pk_fma_f32 v[230:231], v[232:233], v[188:189], v[230:231]
    v_and_b32 v241, 0xffff0000, v180
    v_pk_fma_f32 v[230:231], v[234:235], v[186:187], v[230:231]
    v_pk_fma_f32 v[230:231], v[236:237], v[184:185], v[230:231]
    v_pk_mul_f32 v[230:231], v[230:231], v[240:241]
    v_cvt_pk_bf16_f32 v242, v230, v228
    v_cvt_pk_bf16_f32 v243, v226, v224
    v_cvt_pk_bf16_f32 v244, v222, v220
    v_cvt_pk_bf16_f32 v245, v218, v216
    ds_write_b128 v12, v[242:245] offset:2560
    v_cvt_pk_bf16_f32 v246, v231, v229
    v_cvt_pk_bf16_f32 v247, v227, v225
    v_cvt_pk_bf16_f32 v248, v223, v221
    v_cvt_pk_bf16_f32 v249, v219, v217
    ds_write_b128 v12, v[246:249] offset:10240
    v_lshlrev_b32 v216, 16, v109
    v_and_b32 v217, 0xffff0000, v109
    v_lshlrev_b32 v218, 16, v113
    v_and_b32 v219, 0xffff0000, v113
    v_lshlrev_b32 v220, 16, v117
    v_and_b32 v221, 0xffff0000, v117
    v_lshlrev_b32 v222, 16, v121
    v_and_b32 v223, 0xffff0000, v121
    v_lshlrev_b32 v224, 16, v125
    v_and_b32 v225, 0xffff0000, v125
    v_lshlrev_b32 v226, 16, v129
    v_and_b32 v227, 0xffff0000, v129
    v_lshlrev_b32 v228, 16, v133
    v_and_b32 v229, 0xffff0000, v133
    v_lshlrev_b32 v230, 16, v137
    v_and_b32 v231, 0xffff0000, v137
    v_lshlrev_b32 v232, 16, v141
    v_and_b32 v233, 0xffff0000, v141
    v_lshlrev_b32 v234, 16, v145
    v_and_b32 v235, 0xffff0000, v145
    v_lshlrev_b32 v236, 16, v149
    v_and_b32 v237, 0xffff0000, v149
    v_pk_mul_f32 v[216:217], v[216:217], v[198:199]
    v_lshlrev_b32 v238, 16, v153
    v_pk_fma_f32 v[216:217], v[218:219], v[196:197], v[216:217]
    v_and_b32 v239, 0xffff0000, v153
    v_pk_fma_f32 v[216:217], v[220:221], v[194:195], v[216:217]
    v_pk_fma_f32 v[216:217], v[222:223], v[192:193], v[216:217]
    v_pk_mul_f32 v[216:217], v[216:217], v[238:239]
    v_pk_mul_f32 v[218:219], v[218:219], v[198:199]
    v_lshlrev_b32 v240, 16, v157
    v_pk_fma_f32 v[218:219], v[220:221], v[196:197], v[218:219]
    v_and_b32 v241, 0xffff0000, v157
    v_pk_fma_f32 v[218:219], v[222:223], v[194:195], v[218:219]
    v_pk_fma_f32 v[218:219], v[224:225], v[192:193], v[218:219]
    v_pk_mul_f32 v[218:219], v[218:219], v[240:241]
    v_pk_mul_f32 v[220:221], v[220:221], v[198:199]
    v_lshlrev_b32 v238, 16, v161
    v_pk_fma_f32 v[220:221], v[222:223], v[196:197], v[220:221]
    v_and_b32 v239, 0xffff0000, v161
    v_pk_fma_f32 v[220:221], v[224:225], v[194:195], v[220:221]
    v_pk_fma_f32 v[220:221], v[226:227], v[192:193], v[220:221]
    v_pk_mul_f32 v[220:221], v[220:221], v[238:239]
    v_pk_mul_f32 v[222:223], v[222:223], v[198:199]
    v_lshlrev_b32 v240, 16, v165
    v_pk_fma_f32 v[222:223], v[224:225], v[196:197], v[222:223]
    v_and_b32 v241, 0xffff0000, v165
    v_pk_fma_f32 v[222:223], v[226:227], v[194:195], v[222:223]
    v_pk_fma_f32 v[222:223], v[228:229], v[192:193], v[222:223]
    v_pk_mul_f32 v[222:223], v[222:223], v[240:241]
    v_pk_mul_f32 v[224:225], v[224:225], v[198:199]
    v_lshlrev_b32 v238, 16, v169
    v_pk_fma_f32 v[224:225], v[226:227], v[196:197], v[224:225]
    v_and_b32 v239, 0xffff0000, v169
    v_pk_fma_f32 v[224:225], v[228:229], v[194:195], v[224:225]
    v_pk_fma_f32 v[224:225], v[230:231], v[192:193], v[224:225]
    v_pk_mul_f32 v[224:225], v[224:225], v[238:239]
    v_pk_mul_f32 v[226:227], v[226:227], v[198:199]
    v_lshlrev_b32 v240, 16, v173
    v_pk_fma_f32 v[226:227], v[228:229], v[196:197], v[226:227]
    v_and_b32 v241, 0xffff0000, v173
    v_pk_fma_f32 v[226:227], v[230:231], v[194:195], v[226:227]
    v_pk_fma_f32 v[226:227], v[232:233], v[192:193], v[226:227]
    v_pk_mul_f32 v[226:227], v[226:227], v[240:241]
    v_pk_mul_f32 v[228:229], v[228:229], v[198:199]
    v_lshlrev_b32 v238, 16, v177
    v_pk_fma_f32 v[228:229], v[230:231], v[196:197], v[228:229]
    v_and_b32 v239, 0xffff0000, v177
    v_pk_fma_f32 v[228:229], v[232:233], v[194:195], v[228:229]
    v_pk_fma_f32 v[228:229], v[234:235], v[192:193], v[228:229]
    v_pk_mul_f32 v[228:229], v[228:229], v[238:239]
    v_pk_mul_f32 v[230:231], v[230:231], v[198:199]
    v_lshlrev_b32 v240, 16, v181
    v_pk_fma_f32 v[230:231], v[232:233], v[196:197], v[230:231]
    v_and_b32 v241, 0xffff0000, v181
    v_pk_fma_f32 v[230:231], v[234:235], v[194:195], v[230:231]
    v_pk_fma_f32 v[230:231], v[236:237], v[192:193], v[230:231]
    v_pk_mul_f32 v[230:231], v[230:231], v[240:241]
    v_cvt_pk_bf16_f32 v242, v230, v228
    v_cvt_pk_bf16_f32 v243, v226, v224
    v_cvt_pk_bf16_f32 v244, v222, v220
    v_cvt_pk_bf16_f32 v245, v218, v216
    ds_write_b128 v12, v[242:245] offset:17920
    v_cvt_pk_bf16_f32 v246, v231, v229
    v_cvt_pk_bf16_f32 v247, v227, v225
    v_cvt_pk_bf16_f32 v248, v223, v221
    v_cvt_pk_bf16_f32 v249, v219, v217
    ds_write_b128 v12, v[246:249] offset:25600
    v_lshlrev_b32 v216, 16, v110
    v_and_b32 v217, 0xffff0000, v110
    v_lshlrev_b32 v218, 16, v114
    v_and_b32 v219, 0xffff0000, v114
    v_lshlrev_b32 v220, 16, v118
    v_and_b32 v221, 0xffff0000, v118
    v_lshlrev_b32 v222, 16, v122
    v_and_b32 v223, 0xffff0000, v122
    v_lshlrev_b32 v224, 16, v126
    v_and_b32 v225, 0xffff0000, v126
    v_lshlrev_b32 v226, 16, v130
    v_and_b32 v227, 0xffff0000, v130
    v_lshlrev_b32 v228, 16, v134
    v_and_b32 v229, 0xffff0000, v134
    v_lshlrev_b32 v230, 16, v138
    v_and_b32 v231, 0xffff0000, v138
    v_lshlrev_b32 v232, 16, v142
    v_and_b32 v233, 0xffff0000, v142
    v_lshlrev_b32 v234, 16, v146
    v_and_b32 v235, 0xffff0000, v146
    v_lshlrev_b32 v236, 16, v150
    v_and_b32 v237, 0xffff0000, v150
    v_pk_mul_f32 v[216:217], v[216:217], v[206:207]
    v_lshlrev_b32 v238, 16, v154
    v_pk_fma_f32 v[216:217], v[218:219], v[204:205], v[216:217]
    v_and_b32 v239, 0xffff0000, v154
    v_pk_fma_f32 v[216:217], v[220:221], v[202:203], v[216:217]
    v_pk_fma_f32 v[216:217], v[222:223], v[200:201], v[216:217]
    v_pk_mul_f32 v[216:217], v[216:217], v[238:239]
    v_pk_mul_f32 v[218:219], v[218:219], v[206:207]
    v_lshlrev_b32 v240, 16, v158
    v_pk_fma_f32 v[218:219], v[220:221], v[204:205], v[218:219]
    v_and_b32 v241, 0xffff0000, v158
    v_pk_fma_f32 v[218:219], v[222:223], v[202:203], v[218:219]
    v_pk_fma_f32 v[218:219], v[224:225], v[200:201], v[218:219]
    v_pk_mul_f32 v[218:219], v[218:219], v[240:241]
    v_pk_mul_f32 v[220:221], v[220:221], v[206:207]
    v_lshlrev_b32 v238, 16, v162
    v_pk_fma_f32 v[220:221], v[222:223], v[204:205], v[220:221]
    v_and_b32 v239, 0xffff0000, v162
    v_pk_fma_f32 v[220:221], v[224:225], v[202:203], v[220:221]
    v_pk_fma_f32 v[220:221], v[226:227], v[200:201], v[220:221]
    v_pk_mul_f32 v[220:221], v[220:221], v[238:239]
    v_pk_mul_f32 v[222:223], v[222:223], v[206:207]
    v_lshlrev_b32 v240, 16, v166
    v_pk_fma_f32 v[222:223], v[224:225], v[204:205], v[222:223]
    v_and_b32 v241, 0xffff0000, v166
    v_pk_fma_f32 v[222:223], v[226:227], v[202:203], v[222:223]
    v_pk_fma_f32 v[222:223], v[228:229], v[200:201], v[222:223]
    v_pk_mul_f32 v[222:223], v[222:223], v[240:241]
    v_pk_mul_f32 v[224:225], v[224:225], v[206:207]
    v_lshlrev_b32 v238, 16, v170
    v_pk_fma_f32 v[224:225], v[226:227], v[204:205], v[224:225]
    v_and_b32 v239, 0xffff0000, v170
    v_pk_fma_f32 v[224:225], v[228:229], v[202:203], v[224:225]
    v_pk_fma_f32 v[224:225], v[230:231], v[200:201], v[224:225]
    v_pk_mul_f32 v[224:225], v[224:225], v[238:239]
    v_pk_mul_f32 v[226:227], v[226:227], v[206:207]
    v_lshlrev_b32 v240, 16, v174
    v_pk_fma_f32 v[226:227], v[228:229], v[204:205], v[226:227]
    v_and_b32 v241, 0xffff0000, v174
    v_pk_fma_f32 v[226:227], v[230:231], v[202:203], v[226:227]
    v_pk_fma_f32 v[226:227], v[232:233], v[200:201], v[226:227]
    v_pk_mul_f32 v[226:227], v[226:227], v[240:241]
    v_pk_mul_f32 v[228:229], v[228:229], v[206:207]
    v_lshlrev_b32 v238, 16, v178
    v_pk_fma_f32 v[228:229], v[230:231], v[204:205], v[228:229]
    v_and_b32 v239, 0xffff0000, v178
    v_pk_fma_f32 v[228:229], v[232:233], v[202:203], v[228:229]
    v_pk_fma_f32 v[228:229], v[234:235], v[200:201], v[228:229]
    v_pk_mul_f32 v[228:229], v[228:229], v[238:239]
    v_pk_mul_f32 v[230:231], v[230:231], v[206:207]
    v_lshlrev_b32 v240, 16, v182
    v_pk_fma_f32 v[230:231], v[232:233], v[204:205], v[230:231]
    v_and_b32 v241, 0xffff0000, v182
    v_pk_fma_f32 v[230:231], v[234:235], v[202:203], v[230:231]
    v_pk_fma_f32 v[230:231], v[236:237], v[200:201], v[230:231]
    v_pk_mul_f32 v[230:231], v[230:231], v[240:241]
    v_cvt_pk_bf16_f32 v242, v230, v228
    v_cvt_pk_bf16_f32 v243, v226, v224
    v_cvt_pk_bf16_f32 v244, v222, v220
    v_cvt_pk_bf16_f32 v245, v218, v216
    ds_write_b128 v12, v[242:245] offset:33280
    v_cvt_pk_bf16_f32 v246, v231, v229
    v_cvt_pk_bf16_f32 v247, v227, v225
    v_cvt_pk_bf16_f32 v248, v223, v221
    v_cvt_pk_bf16_f32 v249, v219, v217
    ds_write_b128 v12, v[246:249] offset:40960
    v_lshlrev_b32 v216, 16, v111
    v_and_b32 v217, 0xffff0000, v111
    v_lshlrev_b32 v218, 16, v115
    v_and_b32 v219, 0xffff0000, v115
    v_lshlrev_b32 v220, 16, v119
    v_and_b32 v221, 0xffff0000, v119
    v_lshlrev_b32 v222, 16, v123
    v_and_b32 v223, 0xffff0000, v123
    v_lshlrev_b32 v224, 16, v127
    v_and_b32 v225, 0xffff0000, v127
    v_lshlrev_b32 v226, 16, v131
    v_and_b32 v227, 0xffff0000, v131
    v_lshlrev_b32 v228, 16, v135
    v_and_b32 v229, 0xffff0000, v135
    v_lshlrev_b32 v230, 16, v139
    v_and_b32 v231, 0xffff0000, v139
    v_lshlrev_b32 v232, 16, v143
    v_and_b32 v233, 0xffff0000, v143
    v_lshlrev_b32 v234, 16, v147
    v_and_b32 v235, 0xffff0000, v147
    v_lshlrev_b32 v236, 16, v151
    v_and_b32 v237, 0xffff0000, v151
    v_pk_mul_f32 v[216:217], v[216:217], v[214:215]
    v_lshlrev_b32 v238, 16, v155
    v_pk_fma_f32 v[216:217], v[218:219], v[212:213], v[216:217]
    v_and_b32 v239, 0xffff0000, v155
    v_pk_fma_f32 v[216:217], v[220:221], v[210:211], v[216:217]
    v_pk_fma_f32 v[216:217], v[222:223], v[208:209], v[216:217]
    v_pk_mul_f32 v[216:217], v[216:217], v[238:239]
    v_pk_mul_f32 v[218:219], v[218:219], v[214:215]
    v_lshlrev_b32 v240, 16, v159
    v_pk_fma_f32 v[218:219], v[220:221], v[212:213], v[218:219]
    v_and_b32 v241, 0xffff0000, v159
    v_pk_fma_f32 v[218:219], v[222:223], v[210:211], v[218:219]
    v_pk_fma_f32 v[218:219], v[224:225], v[208:209], v[218:219]
    v_pk_mul_f32 v[218:219], v[218:219], v[240:241]
    v_pk_mul_f32 v[220:221], v[220:221], v[214:215]
    v_lshlrev_b32 v238, 16, v163
    v_pk_fma_f32 v[220:221], v[222:223], v[212:213], v[220:221]
    v_and_b32 v239, 0xffff0000, v163
    v_pk_fma_f32 v[220:221], v[224:225], v[210:211], v[220:221]
    v_pk_fma_f32 v[220:221], v[226:227], v[208:209], v[220:221]
    v_pk_mul_f32 v[220:221], v[220:221], v[238:239]
    v_pk_mul_f32 v[222:223], v[222:223], v[214:215]
    v_lshlrev_b32 v240, 16, v167
    v_pk_fma_f32 v[222:223], v[224:225], v[212:213], v[222:223]
    v_and_b32 v241, 0xffff0000, v167
    v_pk_fma_f32 v[222:223], v[226:227], v[210:211], v[222:223]
    v_pk_fma_f32 v[222:223], v[228:229], v[208:209], v[222:223]
    v_pk_mul_f32 v[222:223], v[222:223], v[240:241]
    v_pk_mul_f32 v[224:225], v[224:225], v[214:215]
    v_lshlrev_b32 v238, 16, v171
    v_pk_fma_f32 v[224:225], v[226:227], v[212:213], v[224:225]
    v_and_b32 v239, 0xffff0000, v171
    v_pk_fma_f32 v[224:225], v[228:229], v[210:211], v[224:225]
    v_pk_fma_f32 v[224:225], v[230:231], v[208:209], v[224:225]
    v_pk_mul_f32 v[224:225], v[224:225], v[238:239]
    v_pk_mul_f32 v[226:227], v[226:227], v[214:215]
    v_lshlrev_b32 v240, 16, v175
    v_pk_fma_f32 v[226:227], v[228:229], v[212:213], v[226:227]
    v_and_b32 v241, 0xffff0000, v175
    v_pk_fma_f32 v[226:227], v[230:231], v[210:211], v[226:227]
    v_pk_fma_f32 v[226:227], v[232:233], v[208:209], v[226:227]
    v_pk_mul_f32 v[226:227], v[226:227], v[240:241]
    v_pk_mul_f32 v[228:229], v[228:229], v[214:215]
    v_lshlrev_b32 v238, 16, v179
    v_pk_fma_f32 v[228:229], v[230:231], v[212:213], v[228:229]
    v_and_b32 v239, 0xffff0000, v179
    v_pk_fma_f32 v[228:229], v[232:233], v[210:211], v[228:229]
    v_pk_fma_f32 v[228:229], v[234:235], v[208:209], v[228:229]
    v_pk_mul_f32 v[228:229], v[228:229], v[238:239]
    v_pk_mul_f32 v[230:231], v[230:231], v[214:215]
    v_lshlrev_b32 v240, 16, v183
    v_pk_fma_f32 v[230:231], v[232:233], v[212:213], v[230:231]
    v_and_b32 v241, 0xffff0000, v183
    v_pk_fma_f32 v[230:231], v[234:235], v[210:211], v[230:231]
    v_pk_fma_f32 v[230:231], v[236:237], v[208:209], v[230:231]
    v_pk_mul_f32 v[230:231], v[230:231], v[240:241]
    v_cvt_pk_bf16_f32 v242, v230, v228
    v_cvt_pk_bf16_f32 v243, v226, v224
    v_cvt_pk_bf16_f32 v244, v222, v220
    v_cvt_pk_bf16_f32 v245, v218, v216
    ds_write_b128 v12, v[242:245] offset:48640
    v_cvt_pk_bf16_f32 v246, v231, v229
    v_cvt_pk_bf16_f32 v247, v227, v225
    v_cvt_pk_bf16_f32 v248, v223, v221
    v_cvt_pk_bf16_f32 v249, v219, v217
    ds_write_b128 v12, v[246:249] offset:56320
    s_lshl_b32 s4, s61, 12
    v_add_u32 v6, s4, v5
    buffer_load_dwordx4 v[184:187], v2, s[36:39], s4 offen offset:0
    buffer_load_dwordx4 v[188:191], v2, s[36:39], s4 offen offset:1024
    buffer_load_dwordx4 v[192:195], v2, s[36:39], s4 offen offset:2048
    buffer_load_dwordx4 v[196:199], v2, s[36:39], s4 offen offset:3072
    buffer_load_dword v200, v6, s[36:39], 0 offen
    buffer_load_dword v201, v2, s[36:39], s4 offen offset:1020
    buffer_load_dword v202, v2, s[36:39], s4 offen offset:2044
    buffer_load_dword v203, v2, s[36:39], s4 offen offset:3068
    s_cmp_lg_u32 s63, 0
    s_cbranch_scc1 .nr_212
    v_subrev_u32 v8, 6144, v7
    buffer_load_dwordx4 v[32:35], v8, s[16:19], 0 offen
    v_subrev_u32 v8, 4096, v7
    buffer_load_dwordx4 v[36:39], v8, s[16:19], 0 offen
    v_subrev_u32 v8, 2048, v7
    buffer_load_dwordx4 v[40:43], v8, s[16:19], 0 offen
    s_mov_b32 s4, 0
    buffer_load_dwordx4 v[44:47], v7, s[16:19], s4 offen offset:0
    buffer_load_dwordx4 v[76:79], v7, s[28:31], s4 offen offset:0
    buffer_load_dwordx4 v[48:51], v7, s[16:19], s4 offen offset:2048
    buffer_load_dwordx4 v[80:83], v7, s[28:31], s4 offen offset:2048
    s_mov_b32 s4, 4096
    buffer_load_dwordx4 v[52:55], v7, s[16:19], s4 offen offset:0
    buffer_load_dwordx4 v[84:87], v7, s[28:31], s4 offen offset:0
    buffer_load_dwordx4 v[56:59], v7, s[16:19], s4 offen offset:2048
    buffer_load_dwordx4 v[88:91], v7, s[28:31], s4 offen offset:2048
    s_mov_b32 s4, 8192
    buffer_load_dwordx4 v[60:63], v7, s[16:19], s4 offen offset:0
    buffer_load_dwordx4 v[92:95], v7, s[28:31], s4 offen offset:0
    buffer_load_dwordx4 v[64:67], v7, s[16:19], s4 offen offset:2048
    buffer_load_dwordx4 v[96:99], v7, s[28:31], s4 offen offset:2048
    s_mov_b32 s4, 12288
    buffer_load_dwordx4 v[68:71], v7, s[16:19], s4 offen offset:0
    buffer_load_dwordx4 v[100:103], v7, s[28:31], s4 offen offset:0
    buffer_load_dwordx4 v[72:75], v7, s[16:19], s4 offen offset:2048
    buffer_load_dwordx4 v[104:107], v7, s[28:31], s4 offen offset:2048
    v_add_u32 v7, 2097152, v7
    v_subrev_u32 v8, 6144, v7
    buffer_load_dwordx4 v[108:111], v8, s[16:19], 0 offen
    v_subrev_u32 v8, 4096, v7
    buffer_load_dwordx4 v[112:115], v8, s[16:19], 0 offen
    v_subrev_u32 v8, 2048, v7
    buffer_load_dwordx4 v[116:119], v8, s[16:19], 0 offen
    s_mov_b32 s4, 0
    buffer_load_dwordx4 v[120:123], v7, s[16:19], s4 offen offset:0
    buffer_load_dwordx4 v[152:155], v7, s[28:31], s4 offen offset:0
    buffer_load_dwordx4 v[124:127], v7, s[16:19], s4 offen offset:2048
    buffer_load_dwordx4 v[156:159], v7, s[28:31], s4 offen offset:2048
    s_mov_b32 s4, 4096
    buffer_load_dwordx4 v[128:131], v7, s[16:19], s4 offen offset:0
    buffer_load_dwordx4 v[160:163], v7, s[28:31], s4 offen offset:0
    buffer_load_dwordx4 v[132:135], v7, s[16:19], s4 offen offset:2048
    buffer_load_dwordx4 v[164:167], v7, s[28:31], s4 offen offset:2048
    s_mov_b32 s4, 8192
    buffer_load_dwordx4 v[136:139], v7, s[16:19], s4 offen offset:0
    buffer_load_dwordx4 v[168:171], v7, s[28:31], s4 offen offset:0
    buffer_load_dwordx4 v[140:143], v7, s[16:19], s4 offen offset:2048
    buffer_load_dwordx4 v[172:175], v7, s[28:31], s4 offen offset:2048
    s_mov_b32 s4, 12288
    buffer_load_dwordx4 v[144:147], v7, s[16:19], s4 offen offset:0
    buffer_load_dwordx4 v[176:179], v7, s[28:31], s4 offen offset:0
    buffer_load_dwordx4 v[148:151], v7, s[16:19], s4 offen offset:2048
    buffer_load_dwordx4 v[180:183], v7, s[28:31], s4 offen offset:2048
    v_subrev_u32 v7, 2096128, v7
    s_waitcnt vmcnt(38)
.nr_212:
    s_cmp_lg_u32 s63, 0
    s_cbranch_scc0 .nr_212_b
    s_waitcnt vmcnt(0)
.nr_212_b:
    s_waitcnt lgkmcnt(0)
    s_barrier
    s_mov_b32 s64, 0
.chan_211:
    s_lshr_b32 s4, s61, 1
    s_lshl_b32 s4, s4, 2
    s_load_dword s65, s[50:51], s4
    s_lshl_b32 s7, s61, 12
    s_add_u32 s7, s7, 130023424
    v_writelane_b32 v200, 0, 0
    ds_write_b128 v9, v[184:187] offset:64
    v_alignbit_b32 v204, v184, v200, 16
    v_alignbit_b32 v205, v185, v184, 16
    v_alignbit_b32 v206, v186, v185, 16
    v_alignbit_b32 v207, v187, v186, 16
    ds_write_b128 v9, v[204:207] offset:4224
    ds_write_b128 v9, v[188:191] offset:1088
    v_alignbit_b32 v208, v188, v201, 16
    v_alignbit_b32 v209, v189, v188, 16
    v_alignbit_b32 v210, v190, v189, 16
    v_alignbit_b32 v211, v191, v190, 16
    ds_write_b128 v9, v[208:211] offset:5248
    ds_write_b128 v9, v[192:195] offset:2112
    v_alignbit_b32 v212, v192, v202, 16
    v_alignbit_b32 v213, v193, v192, 16
    v_alignbit_b32 v214, v194, v193, 16
    v_alignbit_b32 v215, v195, v194, 16
    ds_write_b128 v9, v[212:215] offset:6272
    ds_write_b128 v9, v[196:199] offset:3136
    v_alignbit_b32 v216, v196, v203, 16
    v_alignbit_b32 v217, v197, v196, 16
    v_alignbit_b32 v218, v198, v197, 16
    v_alignbit_b32 v219, v199, v198, 16
    ds_write_b128 v9, v[216:219] offset:7296
    s_and_b32 s4, s61, 1
    s_lshl_b32 s4, s4, 4
    s_waitcnt lgkmcnt(0)
    s_lshr_b32 s65, s65, s4
    s_pack_ll_b32_b16 s65, s65, s65
    s_add_u32 s61, s61, 4
    s_cmp_eq_u32 s64, 3
    s_cbranch_scc1 .chan_211_ns
    s_lshl_b32 s4, s61, 12
    v_add_u32 v6, s4, v5
    buffer_load_dwordx4 v[184:187], v2, s[36:39], s4 offen offset:0
    buffer_load_dwordx4 v[188:191], v2, s[36:39], s4 offen offset:1024
    buffer_load_dwordx4 v[192:195], v2, s[36:39], s4 offen offset:2048
    buffer_load_dwordx4 v[196:199], v2, s[36:39], s4 offen offset:3072
    buffer_load_dword v200, v6, s[36:39], 0 offen
    buffer_load_dword v201, v2, s[36:39], s4 offen offset:1020
    buffer_load_dword v202, v2, s[36:39], s4 offen offset:2044
    buffer_load_dword v203, v2, s[36:39], s4 offen offset:3068
.chan_211_ns:
    v_and_b32 v16, s65, v24
    v_and_b32 v17, s65, v25
    v_and_b32 v18, s65, v26
    v_and_b32 v19, s65, v27
    v_and_b32 v20, s65, v28
    v_and_b32 v21, s65, v29
    v_and_b32 v22, s65, v30
    v_and_b32 v23, s65, v31
    v_mov_b32 v14, v10
    ds_read2_b32 a[32:33], v14 offset0:0 offset1:1
    ds_read2_b32 a[34:35], v14 offset0:2 offset1:3
    ds_read_b128 a[56:59], v11 offset:7632
    ds_read_b128 a[60:63], v11 offset:5072
    ds_read2_b32 a[36:37], v14 offset0:8 offset1:9
    ds_read2_b32 a[38:39], v14 offset0:10 offset1:11
    ds_read_b128 a[64:67], v11 offset:7600
    ds_read_b128 a[68:71], v11 offset:5040
    ds_read2_b32 a[40:41], v14 offset0:16 offset1:17
    ds_read2_b32 a[42:43], v14 offset0:18 offset1:19
    ds_read_b128 a[72:75], v11 offset:7552
    ds_read_b128 a[76:79], v11 offset:4992
    s_waitcnt lgkmcnt(9)
    v_mfma_f32_32x32x16_bf16 a[16:31], a[32:35], a[56:59], 0
    v_mfma_f32_32x32x16_bf16 a[16:31], v[20:23], a[56:59], a[16:31]
    ds_read2_b32 a[44:45], v14 offset0:24 offset1:25
    ds_read2_b32 a[46:47], v14 offset0:26 offset1:27
    s_waitcnt lgkmcnt(10)
    v_mfma_f32_32x32x16_bf16 a[0:15], a[32:35], a[60:63], 0
    v_mfma_f32_32x32x16_bf16 a[0:15], v[20:23], a[60:63], a[0:15]
    ds_read_b128 a[80:83], v11 offset:7520
    ds_read_b128 a[84:87], v11 offset:4960
    s_waitcnt lgkmcnt(9)
    v_mfma_f32_32x32x16_bf16 a[16:31], a[36:39], a[64:67], a[16:31]
    v_mfma_f32_32x32x16_bf16 a[16:31], v[16:19], a[64:67], a[16:31]
    ds_read2_b32 a[48:49], v14 offset0:32 offset1:33
    ds_read2_b32 a[50:51], v14 offset0:34 offset1:35
    s_waitcnt lgkmcnt(10)
    v_mfma_f32_32x32x16_bf16 a[0:15], a[36:39], a[68:71], a[0:15]
    v_mfma_f32_32x32x16_bf16 a[0:15], v[16:19], a[68:71], a[0:15]
    ds_read_b128 a[56:59], v11 offset:7472
    ds_read_b128 a[60:63], v11 offset:4912
    s_waitcnt lgkmcnt(9)
    v_mfma_f32_32x32x16_bf16 a[16:31], a[40:43], a[72:75], a[16:31]
    ds_read2_b32 a[52:53], v14 offset0:40 offset1:41
    ds_read2_b32 a[54:55], v14 offset0:42 offset1:43
    s_waitcnt lgkmcnt(10)
    v_mfma_f32_32x32x16_bf16 a[0:15], a[40:43], a[76:79], a[0:15]
    ds_read_b128 a[64:67], v11 offset:7440
    ds_read_b128 a[68:71], v11 offset:4880
    s_waitcnt lgkmcnt(9)
    v_mfma_f32_32x32x16_bf16 a[16:31], a[44:47], a[80:83], a[16:31]
    ds_read2_b32 a[32:33], v14 offset0:48 offset1:49
    ds_read2_b32 a[34:35], v14 offset0:50 offset1:51
    s_waitcnt lgkmcnt(10)
    v_mfma_f32_32x32x16_bf16 a[0:15], a[44:47], a[84:87], a[0:15]
    ds_read_b128 a[72:75], v11 offset:7392
    ds_read_b128 a[76:79], v11 offset:4832
    s_waitcnt lgkmcnt(9)
    v_mfma_f32_32x32x16_bf16 a[16:31], a[48:51], a[56:59], a[16:31]
    ds_read2_b32 a[36:37], v14 offset0:56 offset1:57
    ds_read2_b32 a[38:39], v14 offset0:58 offset1:59
    s_waitcnt lgkmcnt(10)
    v_mfma_f32_32x32x16_bf16 a[0:15], a[48:51], a[60:63], a[0:15]
    ds_read_b128 a[80:83], v11 offset:7360
    ds_read_b128 a[84:87], v11 offset:4800
    s_waitcnt lgkmcnt(9)
    v_mfma_f32_32x32x16_bf16 a[16:31], a[52:55], a[64:67], a[16:31]
    ds_read2_b32 a[40:41], v14 offset0:64 offset1:65
    ds_read2_b32 a[42:43], v14 offset0:66 offset1:67
    s_waitcnt lgkmcnt(10)
    v_mfma_f32_32x32x16_bf16 a[0:15], a[52:55], a[68:71], a[0:15]
    ds_read_b128 a[56:59], v11 offset:7312
    ds_read_b128 a[60:63], v11 offset:4752
    s_waitcnt lgkmcnt(9)
    v_mfma_f32_32x32x16_bf16 a[16:31], a[32:35], a[72:75], a[16:31]
    ds_read2_b32 a[44:45], v14 offset0:72 offset1:73
    ds_read2_b32 a[46:47], v14 offset0:74 offset1:75
    s_waitcnt lgkmcnt(10)
    v_mfma_f32_32x32x16_bf16 a[0:15], a[32:35], a[76:79], a[0:15]
    ds_read_b128 a[64:67], v11 offset:7280
    ds_read_b128 a[68:71], v11 offset:4720
    s_waitcnt lgkmcnt(9)
    v_mfma_f32_32x32x16_bf16 a[16:31], a[36:39], a[80:83], a[16:31]
    ds_read2_b32 a[48:49], v14 offset0:80 offset1:81
    ds_read2_b32 a[50:51], v14 offset0:82 offset1:83
    s_waitcnt lgkmcnt(10)
    v_mfma_f32_32x32x16_bf16 a[0:15], a[36:39], a[84:87], a[0:15]
    ds_read_b128 a[72:75], v11 offset:7232
    ds_read_b128 a[76:79], v11 offset:4672
    s_waitcnt lgkmcnt(9)
    v_mfma_f32_32x32x16_bf16 a[16:31], a[40:43], a[56:59], a[16:31]
    ds_read2_b32 a[52:53], v14 offset0:88 offset1:89
    ds_read2_b32 a[54:55], v14 offset0:90 offset1:91
    s_waitcnt lgkmcnt(10)
    v_mfma_f32_32x32x16_bf16 a[0:15], a[40:43], a[60:63], a[0:15]
    ds_read_b128 a[80:83], v11 offset:7200
    ds_read_b128 a[84:87], v11 offset:4640
    s_waitcnt lgkmcnt(9)
    v_mfma_f32_32x32x16_bf16 a[16:31], a[44:47], a[64:67], a[16:31]
    ds_read2_b32 a[32:33], v14 offset0:96 offset1:97
    ds_read2_b32 a[34:35], v14 offset0:98 offset1:99
    s_waitcnt lgkmcnt(10)
    v_mfma_f32_32x32x16_bf16 a[0:15], a[44:47], a[68:71], a[0:15]
    ds_read_b128 a[56:59], v11 offset:7152
    ds_read_b128 a[60:63], v11 offset:4592
    s_waitcnt lgkmcnt(9)
    v_mfma_f32_32x32x16_bf16 a[16:31], a[48:51], a[72:75], a[16:31]
    ds_read2_b32 a[36:37], v14 offset0:104 offset1:105
    ds_read2_b32 a[38:39], v14 offset0:106 offset1:107
    s_waitcnt lgkmcnt(10)
    v_mfma_f32_32x32x16_bf16 a[0:15], a[48:51], a[76:79], a[0:15]
    ds_read_b128 a[64:67], v11 offset:7120
    ds_read_b128 a[68:71], v11 offset:4560
    s_waitcnt lgkmcnt(9)
    v_mfma_f32_32x32x16_bf16 a[16:31], a[52:55], a[80:83], a[16:31]
    ds_read2_b32 a[40:41], v14 offset0:112 offset1:113
    ds_read2_b32 a[42:43], v14 offset0:114 offset1:115
    s_waitcnt lgkmcnt(10)
    v_mfma_f32_32x32x16_bf16 a[0:15], a[52:55], a[84:87], a[0:15]
    ds_read_b128 a[72:75], v11 offset:7072
    ds_read_b128 a[76:79], v11 offset:4512
    s_waitcnt lgkmcnt(9)
    v_mfma_f32_32x32x16_bf16 a[16:31], a[32:35], a[56:59], a[16:31]
    ds_read2_b32 a[44:45], v14 offset0:120 offset1:121
    ds_read2_b32 a[46:47], v14 offset0:122 offset1:123
    s_waitcnt lgkmcnt(10)
    v_mfma_f32_32x32x16_bf16 a[0:15], a[32:35], a[60:63], a[0:15]
    ds_read_b128 a[80:83], v11 offset:7040
    ds_read_b128 a[84:87], v11 offset:4480
    s_waitcnt lgkmcnt(9)
    v_mfma_f32_32x32x16_bf16 a[16:31], a[36:39], a[64:67], a[16:31]
    ds_read2_b32 a[48:49], v14 offset0:128 offset1:129
    ds_read2_b32 a[50:51], v14 offset0:130 offset1:131
    s_waitcnt lgkmcnt(10)
    v_mfma_f32_32x32x16_bf16 a[0:15], a[36:39], a[68:71], a[0:15]
    ds_read_b128 a[56:59], v11 offset:6992
    ds_read_b128 a[60:63], v11 offset:4432
    s_waitcnt lgkmcnt(9)
    v_mfma_f32_32x32x16_bf16 a[16:31], a[40:43], a[72:75], a[16:31]
    ds_read2_b32 a[52:53], v14 offset0:136 offset1:137
    ds_read2_b32 a[54:55], v14 offset0:138 offset1:139
    s_waitcnt lgkmcnt(10)
    v_mfma_f32_32x32x16_bf16 a[0:15], a[40:43], a[76:79], a[0:15]
    ds_read_b128 a[64:67], v11 offset:6960
    ds_read_b128 a[68:71], v11 offset:4400
    s_waitcnt lgkmcnt(9)
    v_mfma_f32_32x32x16_bf16 a[16:31], a[44:47], a[80:83], a[16:31]
    ds_read2_b32 a[32:33], v14 offset0:144 offset1:145
    ds_read2_b32 a[34:35], v14 offset0:146 offset1:147
    s_waitcnt lgkmcnt(10)
    v_mfma_f32_32x32x16_bf16 a[0:15], a[44:47], a[84:87], a[0:15]
    ds_read_b128 a[72:75], v11 offset:6912
    ds_read_b128 a[76:79], v11 offset:4352
    s_waitcnt lgkmcnt(9)
    v_mfma_f32_32x32x16_bf16 a[16:31], a[48:51], a[56:59], a[16:31]
    ds_read2_b32 a[36:37], v14 offset0:152 offset1:153
    ds_read2_b32 a[38:39], v14 offset0:154 offset1:155
    s_waitcnt lgkmcnt(10)
    v_mfma_f32_32x32x16_bf16 a[0:15], a[48:51], a[60:63], a[0:15]
    ds_read_b128 a[80:83], v11 offset:6880
    ds_read_b128 a[84:87], v11 offset:4320
    s_waitcnt lgkmcnt(9)
    v_mfma_f32_32x32x16_bf16 a[16:31], a[52:55], a[64:67], a[16:31]
    ds_read2_b32 a[40:41], v14 offset0:160 offset1:161
    ds_read2_b32 a[42:43], v14 offset0:162 offset1:163
    s_waitcnt lgkmcnt(10)
    v_mfma_f32_32x32x16_bf16 a[0:15], a[52:55], a[68:71], a[0:15]
    ds_read_b128 a[56:59], v11 offset:6832
    ds_read_b128 a[60:63], v11 offset:4272
    s_waitcnt lgkmcnt(9)
    v_mfma_f32_32x32x16_bf16 a[16:31], a[32:35], a[72:75], a[16:31]
    ds_read2_b32 a[44:45], v14 offset0:168 offset1:169
    ds_read2_b32 a[46:47], v14 offset0:170 offset1:171
    s_waitcnt lgkmcnt(10)
    v_mfma_f32_32x32x16_bf16 a[0:15], a[32:35], a[76:79], a[0:15]
    ds_read_b128 a[64:67], v11 offset:6800
    ds_read_b128 a[68:71], v11 offset:4240
    s_waitcnt lgkmcnt(9)
    v_mfma_f32_32x32x16_bf16 a[16:31], a[36:39], a[80:83], a[16:31]
    ds_read2_b32 a[48:49], v14 offset0:176 offset1:177
    ds_read2_b32 a[50:51], v14 offset0:178 offset1:179
    s_waitcnt lgkmcnt(10)
    v_mfma_f32_32x32x16_bf16 a[0:15], a[36:39], a[84:87], a[0:15]
    ds_read_b128 a[72:75], v11 offset:6752
    ds_read_b128 a[76:79], v11 offset:4192
    s_waitcnt lgkmcnt(9)
    v_mfma_f32_32x32x16_bf16 a[16:31], a[40:43], a[56:59], a[16:31]
    ds_read2_b32 a[52:53], v14 offset0:184 offset1:185
    ds_read2_b32 a[54:55], v14 offset0:186 offset1:187
    s_waitcnt lgkmcnt(10)
    v_mfma_f32_32x32x16_bf16 a[0:15], a[40:43], a[60:63], a[0:15]
    ds_read_b128 a[80:83], v11 offset:6720
    ds_read_b128 a[84:87], v11 offset:4160
    s_waitcnt lgkmcnt(9)
    v_mfma_f32_32x32x16_bf16 a[16:31], a[44:47], a[64:67], a[16:31]
    ds_read2_b32 a[32:33], v14 offset0:192 offset1:193
    ds_read2_b32 a[34:35], v14 offset0:194 offset1:195
    s_waitcnt lgkmcnt(10)
    v_mfma_f32_32x32x16_bf16 a[0:15], a[44:47], a[68:71], a[0:15]
    ds_read_b128 a[56:59], v11 offset:6672
    ds_read_b128 a[60:63], v11 offset:4112
    s_waitcnt lgkmcnt(9)
    v_mfma_f32_32x32x16_bf16 a[16:31], a[48:51], a[72:75], a[16:31]
    ds_read2_b32 a[36:37], v14 offset0:200 offset1:201
    ds_read2_b32 a[38:39], v14 offset0:202 offset1:203
    s_waitcnt lgkmcnt(10)
    v_mfma_f32_32x32x16_bf16 a[0:15], a[48:51], a[76:79], a[0:15]
    ds_read_b128 a[64:67], v11 offset:6640
    ds_read_b128 a[68:71], v11 offset:4080
    s_waitcnt lgkmcnt(9)
    v_mfma_f32_32x32x16_bf16 a[16:31], a[52:55], a[80:83], a[16:31]
    ds_read2_b32 a[40:41], v14 offset0:208 offset1:209
    ds_read2_b32 a[42:43], v14 offset0:210 offset1:211
    s_waitcnt lgkmcnt(10)
    v_mfma_f32_32x32x16_bf16 a[0:15], a[52:55], a[84:87], a[0:15]
    ds_read_b128 a[72:75], v11 offset:6592
    ds_read_b128 a[76:79], v11 offset:4032
    s_waitcnt lgkmcnt(9)
    v_mfma_f32_32x32x16_bf16 a[16:31], a[32:35], a[56:59], a[16:31]
    ds_read2_b32 a[44:45], v14 offset0:216 offset1:217
    ds_read2_b32 a[46:47], v14 offset0:218 offset1:219
    s_waitcnt lgkmcnt(10)
    v_mfma_f32_32x32x16_bf16 a[0:15], a[32:35], a[60:63], a[0:15]
    ds_read_b128 a[80:83], v11 offset:6560
    ds_read_b128 a[84:87], v11 offset:4000
    s_waitcnt lgkmcnt(9)
    v_mfma_f32_32x32x16_bf16 a[16:31], a[36:39], a[64:67], a[16:31]
    ds_read2_b32 a[48:49], v14 offset0:224 offset1:225
    ds_read2_b32 a[50:51], v14 offset0:226 offset1:227
    s_waitcnt lgkmcnt(10)
    v_mfma_f32_32x32x16_bf16 a[0:15], a[36:39], a[68:71], a[0:15]
    ds_read_b128 a[56:59], v11 offset:6512
    ds_read_b128 a[60:63], v11 offset:3952
    s_waitcnt lgkmcnt(9)
    v_mfma_f32_32x32x16_bf16 a[16:31], a[40:43], a[72:75], a[16:31]
    ds_read2_b32 a[52:53], v14 offset0:232 offset1:233
    ds_read2_b32 a[54:55], v14 offset0:234 offset1:235
    s_waitcnt lgkmcnt(10)
    v_mfma_f32_32x32x16_bf16 a[0:15], a[40:43], a[76:79], a[0:15]
    ds_read_b128 a[64:67], v11 offset:6480
    ds_read_b128 a[68:71], v11 offset:3920
    s_waitcnt lgkmcnt(9)
    v_mfma_f32_32x32x16_bf16 a[16:31], a[44:47], a[80:83], a[16:31]
    ds_read2_b32 a[32:33], v14 offset0:240 offset1:241
    ds_read2_b32 a[34:35], v14 offset0:242 offset1:243
    s_waitcnt lgkmcnt(10)
    v_mfma_f32_32x32x16_bf16 a[0:15], a[44:47], a[84:87], a[0:15]
    ds_read_b128 a[72:75], v11 offset:6432
    ds_read_b128 a[76:79], v11 offset:3872
    s_waitcnt lgkmcnt(9)
    v_mfma_f32_32x32x16_bf16 a[16:31], a[48:51], a[56:59], a[16:31]
    ds_read2_b32 a[36:37], v14 offset0:248 offset1:249
    ds_read2_b32 a[38:39], v14 offset0:250 offset1:251
    v_add_u32 v14, 1024, v14
    s_waitcnt lgkmcnt(10)
    v_mfma_f32_32x32x16_bf16 a[0:15], a[48:51], a[60:63], a[0:15]
    ds_read_b128 a[80:83], v11 offset:6400
    ds_read_b128 a[84:87], v11 offset:3840
    s_waitcnt lgkmcnt(9)
    v_mfma_f32_32x32x16_bf16 a[16:31], a[52:55], a[64:67], a[16:31]
    ds_read2_b32 a[40:41], v14 offset0:0 offset1:1
    ds_read2_b32 a[42:43], v14 offset0:2 offset1:3
    s_waitcnt lgkmcnt(10)
    v_mfma_f32_32x32x16_bf16 a[0:15], a[52:55], a[68:71], a[0:15]
    ds_read_b128 a[56:59], v11 offset:6352
    ds_read_b128 a[60:63], v11 offset:3792
    s_waitcnt lgkmcnt(9)
    v_mfma_f32_32x32x16_bf16 a[16:31], a[32:35], a[72:75], a[16:31]
    ds_read2_b32 a[44:45], v14 offset0:8 offset1:9
    ds_read2_b32 a[46:47], v14 offset0:10 offset1:11
    s_waitcnt lgkmcnt(10)
    v_mfma_f32_32x32x16_bf16 a[0:15], a[32:35], a[76:79], a[0:15]
    ds_read_b128 a[64:67], v11 offset:6320
    ds_read_b128 a[68:71], v11 offset:3760
    s_waitcnt lgkmcnt(9)
    v_mfma_f32_32x32x16_bf16 a[16:31], a[36:39], a[80:83], a[16:31]
    ds_read2_b32 a[48:49], v14 offset0:16 offset1:17
    ds_read2_b32 a[50:51], v14 offset0:18 offset1:19
    s_waitcnt lgkmcnt(10)
    v_mfma_f32_32x32x16_bf16 a[0:15], a[36:39], a[84:87], a[0:15]
    ds_read_b128 a[72:75], v11 offset:6272
    ds_read_b128 a[76:79], v11 offset:3712
    s_waitcnt lgkmcnt(9)
    v_mfma_f32_32x32x16_bf16 a[16:31], a[40:43], a[56:59], a[16:31]
    ds_read2_b32 a[52:53], v14 offset0:24 offset1:25
    ds_read2_b32 a[54:55], v14 offset0:26 offset1:27
    s_waitcnt lgkmcnt(10)
    v_mfma_f32_32x32x16_bf16 a[0:15], a[40:43], a[60:63], a[0:15]
    ds_read_b128 a[80:83], v11 offset:6240
    ds_read_b128 a[84:87], v11 offset:3680
    s_waitcnt lgkmcnt(9)
    v_mfma_f32_32x32x16_bf16 a[16:31], a[44:47], a[64:67], a[16:31]
    ds_read2_b32 a[32:33], v14 offset0:32 offset1:33
    ds_read2_b32 a[34:35], v14 offset0:34 offset1:35
    s_waitcnt lgkmcnt(10)
    v_mfma_f32_32x32x16_bf16 a[0:15], a[44:47], a[68:71], a[0:15]
    ds_read_b128 a[56:59], v11 offset:6192
    ds_read_b128 a[60:63], v11 offset:3632
    s_waitcnt lgkmcnt(9)
    v_mfma_f32_32x32x16_bf16 a[16:31], a[48:51], a[72:75], a[16:31]
    ds_read2_b32 a[36:37], v14 offset0:40 offset1:41
    ds_read2_b32 a[38:39], v14 offset0:42 offset1:43
    s_waitcnt lgkmcnt(10)
    v_mfma_f32_32x32x16_bf16 a[0:15], a[48:51], a[76:79], a[0:15]
    ds_read_b128 a[64:67], v11 offset:6160
    ds_read_b128 a[68:71], v11 offset:3600
    s_waitcnt lgkmcnt(9)
    v_mfma_f32_32x32x16_bf16 a[16:31], a[52:55], a[80:83], a[16:31]
    ds_read2_b32 a[40:41], v14 offset0:48 offset1:49
    ds_read2_b32 a[42:43], v14 offset0:50 offset1:51
    s_waitcnt lgkmcnt(10)
    v_mfma_f32_32x32x16_bf16 a[0:15], a[52:55], a[84:87], a[0:15]
    ds_read_b128 a[72:75], v11 offset:6112
    ds_read_b128 a[76:79], v11 offset:3552
    s_waitcnt lgkmcnt(9)
    v_mfma_f32_32x32x16_bf16 a[16:31], a[32:35], a[56:59], a[16:31]
    ds_read2_b32 a[44:45], v14 offset0:56 offset1:57
    ds_read2_b32 a[46:47], v14 offset0:58 offset1:59
    s_waitcnt lgkmcnt(10)
    v_mfma_f32_32x32x16_bf16 a[0:15], a[32:35], a[60:63], a[0:15]
    ds_read_b128 a[80:83], v11 offset:6080
    ds_read_b128 a[84:87], v11 offset:3520
    s_waitcnt lgkmcnt(9)
    v_mfma_f32_32x32x16_bf16 a[16:31], a[36:39], a[64:67], a[16:31]
    ds_read2_b32 a[48:49], v14 offset0:64 offset1:65
    ds_read2_b32 a[50:51], v14 offset0:66 offset1:67
    s_waitcnt lgkmcnt(10)
    v_mfma_f32_32x32x16_bf16 a[0:15], a[36:39], a[68:71], a[0:15]
    ds_read_b128 a[56:59], v11 offset:6032
    ds_read_b128 a[60:63], v11 offset:3472
    s_waitcnt lgkmcnt(9)
    v_mfma_f32_32x32x16_bf16 a[16:31], a[40:43], a[72:75], a[16:31]
    ds_read2_b32 a[52:53], v14 offset0:72 offset1:73
    ds_read2_b32 a[54:55], v14 offset0:74 offset1:75
    s_waitcnt lgkmcnt(10)
    v_mfma_f32_32x32x16_bf16 a[0:15], a[40:43], a[76:79], a[0:15]
    ds_read_b128 a[64:67], v11 offset:6000
    ds_read_b128 a[68:71], v11 offset:3440
    s_waitcnt lgkmcnt(9)
    v_mfma_f32_32x32x16_bf16 a[16:31], a[44:47], a[80:83], a[16:31]
    ds_read2_b32 a[32:33], v14 offset0:80 offset1:81
    ds_read2_b32 a[34:35], v14 offset0:82 offset1:83
    s_waitcnt lgkmcnt(10)
    v_mfma_f32_32x32x16_bf16 a[0:15], a[44:47], a[84:87], a[0:15]
    ds_read_b128 a[72:75], v11 offset:5952
    ds_read_b128 a[76:79], v11 offset:3392
    s_waitcnt lgkmcnt(9)
    v_mfma_f32_32x32x16_bf16 a[16:31], a[48:51], a[56:59], a[16:31]
    ds_read2_b32 a[36:37], v14 offset0:88 offset1:89
    ds_read2_b32 a[38:39], v14 offset0:90 offset1:91
    s_waitcnt lgkmcnt(10)
    v_mfma_f32_32x32x16_bf16 a[0:15], a[48:51], a[60:63], a[0:15]
    ds_read_b128 a[80:83], v11 offset:5920
    ds_read_b128 a[84:87], v11 offset:3360
    s_waitcnt lgkmcnt(9)
    v_mfma_f32_32x32x16_bf16 a[16:31], a[52:55], a[64:67], a[16:31]
    ds_read2_b32 a[40:41], v14 offset0:96 offset1:97
    ds_read2_b32 a[42:43], v14 offset0:98 offset1:99
    s_waitcnt lgkmcnt(10)
    v_mfma_f32_32x32x16_bf16 a[0:15], a[52:55], a[68:71], a[0:15]
    ds_read_b128 a[56:59], v11 offset:5872
    ds_read_b128 a[60:63], v11 offset:3312
    s_waitcnt lgkmcnt(9)
    v_mfma_f32_32x32x16_bf16 a[16:31], a[32:35], a[72:75], a[16:31]
    ds_read2_b32 a[44:45], v14 offset0:104 offset1:105
    ds_read2_b32 a[46:47], v14 offset0:106 offset1:107
    s_waitcnt lgkmcnt(10)
    v_mfma_f32_32x32x16_bf16 a[0:15], a[32:35], a[76:79], a[0:15]
    ds_read_b128 a[64:67], v11 offset:5840
    ds_read_b128 a[68:71], v11 offset:3280
    s_waitcnt lgkmcnt(9)
    v_mfma_f32_32x32x16_bf16 a[16:31], a[36:39], a[80:83], a[16:31]
    ds_read2_b32 a[48:49], v14 offset0:112 offset1:113
    ds_read2_b32 a[50:51], v14 offset0:114 offset1:115
    s_waitcnt lgkmcnt(10)
    v_mfma_f32_32x32x16_bf16 a[0:15], a[36:39], a[84:87], a[0:15]
    ds_read_b128 a[72:75], v11 offset:5792
    ds_read_b128 a[76:79], v11 offset:3232
    s_waitcnt lgkmcnt(9)
    v_mfma_f32_32x32x16_bf16 a[16:31], a[40:43], a[56:59], a[16:31]
    ds_read2_b32 a[52:53], v14 offset0:120 offset1:121
    ds_read2_b32 a[54:55], v14 offset0:122 offset1:123
    s_waitcnt lgkmcnt(10)
    v_mfma_f32_32x32x16_bf16 a[0:15], a[40:43], a[60:63], a[0:15]
    ds_read_b128 a[80:83], v11 offset:5760
    ds_read_b128 a[84:87], v11 offset:3200
    s_waitcnt lgkmcnt(9)
    v_mfma_f32_32x32x16_bf16 a[16:31], a[44:47], a[64:67], a[16:31]
    ds_read2_b32 a[32:33], v14 offset0:128 offset1:129
    ds_read2_b32 a[34:35], v14 offset0:130 offset1:131
    s_waitcnt lgkmcnt(10)
    v_mfma_f32_32x32x16_bf16 a[0:15], a[44:47], a[68:71], a[0:15]
    ds_read_b128 a[56:59], v11 offset:5712
    ds_read_b128 a[60:63], v11 offset:3152
    s_waitcnt lgkmcnt(9)
    v_mfma_f32_32x32x16_bf16 a[16:31], a[48:51], a[72:75], a[16:31]
    ds_read2_b32 a[36:37], v14 offset0:136 offset1:137
    ds_read2_b32 a[38:39], v14 offset0:138 offset1:139
    s_waitcnt lgkmcnt(10)
    v_mfma_f32_32x32x16_bf16 a[0:15], a[48:51], a[76:79], a[0:15]
    ds_read_b128 a[64:67], v11 offset:5680
    ds_read_b128 a[68:71], v11 offset:3120
    s_waitcnt lgkmcnt(9)
    v_mfma_f32_32x32x16_bf16 a[16:31], a[52:55], a[80:83], a[16:31]
    ds_read2_b32 a[40:41], v14 offset0:144 offset1:145
    ds_read2_b32 a[42:43], v14 offset0:146 offset1:147
    s_waitcnt lgkmcnt(10)
    v_mfma_f32_32x32x16_bf16 a[0:15], a[52:55], a[84:87], a[0:15]
    ds_read_b128 a[72:75], v11 offset:5632
    ds_read_b128 a[76:79], v11 offset:3072
    s_waitcnt lgkmcnt(9)
    v_mfma_f32_32x32x16_bf16 a[16:31], a[32:35], a[56:59], a[16:31]
    ds_read2_b32 a[44:45], v14 offset0:152 offset1:153
    ds_read2_b32 a[46:47], v14 offset0:154 offset1:155
    s_waitcnt lgkmcnt(10)
    v_mfma_f32_32x32x16_bf16 a[0:15], a[32:35], a[60:63], a[0:15]
    ds_read_b128 a[80:83], v11 offset:5600
    ds_read_b128 a[84:87], v11 offset:3040
    s_waitcnt lgkmcnt(9)
    v_mfma_f32_32x32x16_bf16 a[16:31], a[36:39], a[64:67], a[16:31]
    ds_read2_b32 a[48:49], v14 offset0:160 offset1:161
    ds_read2_b32 a[50:51], v14 offset0:162 offset1:163
    s_waitcnt lgkmcnt(10)
    v_mfma_f32_32x32x16_bf16 a[0:15], a[36:39], a[68:71], a[0:15]
    ds_read_b128 a[56:59], v11 offset:5552
    ds_read_b128 a[60:63], v11 offset:2992
    s_waitcnt lgkmcnt(9)
    v_mfma_f32_32x32x16_bf16 a[16:31], a[40:43], a[72:75], a[16:31]
    ds_read2_b32 a[52:53], v14 offset0:168 offset1:169
    ds_read2_b32 a[54:55], v14 offset0:170 offset1:171
    s_waitcnt lgkmcnt(10)
    v_mfma_f32_32x32x16_bf16 a[0:15], a[40:43], a[76:79], a[0:15]
    ds_read_b128 a[64:67], v11 offset:5520
    ds_read_b128 a[68:71], v11 offset:2960
    s_waitcnt lgkmcnt(9)
    v_mfma_f32_32x32x16_bf16 a[16:31], a[44:47], a[80:83], a[16:31]
    ds_read2_b32 a[32:33], v14 offset0:176 offset1:177
    ds_read2_b32 a[34:35], v14 offset0:178 offset1:179
    s_waitcnt lgkmcnt(10)
    v_mfma_f32_32x32x16_bf16 a[0:15], a[44:47], a[84:87], a[0:15]
    ds_read_b128 a[72:75], v11 offset:5472
    ds_read_b128 a[76:79], v11 offset:2912
    s_waitcnt lgkmcnt(9)
    v_mfma_f32_32x32x16_bf16 a[16:31], a[48:51], a[56:59], a[16:31]
    ds_read2_b32 a[36:37], v14 offset0:184 offset1:185
    ds_read2_b32 a[38:39], v14 offset0:186 offset1:187
    s_waitcnt lgkmcnt(10)
    v_mfma_f32_32x32x16_bf16 a[0:15], a[48:51], a[60:63], a[0:15]
    ds_read_b128 a[80:83], v11 offset:5440
    ds_read_b128 a[84:87], v11 offset:2880
    s_waitcnt lgkmcnt(9)
    v_mfma_f32_32x32x16_bf16 a[16:31], a[52:55], a[64:67], a[16:31]
    ds_read2_b32 a[40:41], v14 offset0:192 offset1:193
    ds_read2_b32 a[42:43], v14 offset0:194 offset1:195
    s_waitcnt lgkmcnt(10)
    v_mfma_f32_32x32x16_bf16 a[0:15], a[52:55], a[68:71], a[0:15]
    ds_read_b128 a[56:59], v11 offset:5392
    ds_read_b128 a[60:63], v11 offset:2832
    s_waitcnt lgkmcnt(9)
    v_mfma_f32_32x32x16_bf16 a[16:31], a[32:35], a[72:75], a[16:31]
    ds_read2_b32 a[44:45], v14 offset0:200 offset1:201
    ds_read2_b32 a[46:47], v14 offset0:202 offset1:203
    s_waitcnt lgkmcnt(10)
    v_mfma_f32_32x32x16_bf16 a[0:15], a[32:35], a[76:79], a[0:15]
    ds_read_b128 a[64:67], v11 offset:5360
    ds_read_b128 a[68:71], v11 offset:2800
    s_waitcnt lgkmcnt(9)
    v_mfma_f32_32x32x16_bf16 a[16:31], a[36:39], a[80:83], a[16:31]
    ds_read2_b32 a[48:49], v14 offset0:208 offset1:209
    ds_read2_b32 a[50:51], v14 offset0:210 offset1:211
    s_waitcnt lgkmcnt(10)
    v_mfma_f32_32x32x16_bf16 a[0:15], a[36:39], a[84:87], a[0:15]
    ds_read_b128 a[72:75], v11 offset:5312
    ds_read_b128 a[76:79], v11 offset:2752
    s_waitcnt lgkmcnt(9)
    v_mfma_f32_32x32x16_bf16 a[16:31], a[40:43], a[56:59], a[16:31]
    ds_read2_b32 a[52:53], v14 offset0:216 offset1:217
    ds_read2_b32 a[54:55], v14 offset0:218 offset1:219
    s_waitcnt lgkmcnt(10)
    v_mfma_f32_32x32x16_bf16 a[0:15], a[40:43], a[60:63], a[0:15]
    ds_read_b128 a[80:83], v11 offset:5280
    ds_read_b128 a[84:87], v11 offset:2720
    s_waitcnt lgkmcnt(9)
    v_mfma_f32_32x32x16_bf16 a[16:31], a[44:47], a[64:67], a[16:31]
    ds_read2_b32 a[32:33], v14 offset0:224 offset1:225
    ds_read2_b32 a[34:35], v14 offset0:226 offset1:227
    s_waitcnt lgkmcnt(10)
    v_mfma_f32_32x32x16_bf16 a[0:15], a[44:47], a[68:71], a[0:15]
    ds_read_b128 a[56:59], v11 offset:5232
    ds_read_b128 a[60:63], v11 offset:2672
    s_waitcnt lgkmcnt(9)
    v_mfma_f32_32x32x16_bf16 a[16:31], a[48:51], a[72:75], a[16:31]
    ds_read2_b32 a[36:37], v14 offset0:232 offset1:233
    ds_read2_b32 a[38:39], v14 offset0:234 offset1:235
    s_waitcnt lgkmcnt(10)
    v_mfma_f32_32x32x16_bf16 a[0:15], a[48:51], a[76:79], a[0:15]
    ds_read_b128 a[64:67], v11 offset:5200
    ds_read_b128 a[68:71], v11 offset:2640
    s_waitcnt lgkmcnt(9)
    v_mfma_f32_32x32x16_bf16 a[16:31], a[52:55], a[80:83], a[16:31]
    ds_read2_b32 a[40:41], v14 offset0:240 offset1:241
    ds_read2_b32 a[42:43], v14 offset0:242 offset1:243
    s_waitcnt lgkmcnt(10)
    v_mfma_f32_32x32x16_bf16 a[0:15], a[52:55], a[84:87], a[0:15]
    ds_read_b128 a[72:75], v11 offset:5152
    ds_read_b128 a[76:79], v11 offset:2592
    s_waitcnt lgkmcnt(9)
    v_mfma_f32_32x32x16_bf16 a[16:31], a[32:35], a[56:59], a[16:31]
    ds_read2_b32 a[44:45], v14 offset0:248 offset1:249
    ds_read2_b32 a[46:47], v14 offset0:250 offset1:251
    v_add_u32 v14, 1024, v14
    s_waitcnt lgkmcnt(10)
    v_mfma_f32_32x32x16_bf16 a[0:15], a[32:35], a[60:63], a[0:15]
    ds_read_b128 a[80:83], v11 offset:5120
    ds_read_b128 a[84:87], v11 offset:2560
    s_waitcnt lgkmcnt(9)
    v_mfma_f32_32x32x16_bf16 a[16:31], a[36:39], a[64:67], a[16:31]
    ds_read2_b32 a[48:49], v14 offset0:0 offset1:1
    ds_read2_b32 a[50:51], v14 offset0:2 offset1:3
    s_waitcnt lgkmcnt(10)
    v_mfma_f32_32x32x16_bf16 a[0:15], a[36:39], a[68:71], a[0:15]
    ds_read_b128 a[56:59], v11 offset:5072
    ds_read2_b32 a[52:53], v14 offset0:8 offset1:9
    ds_read2_b32 a[54:55], v14 offset0:10 offset1:11
    s_waitcnt lgkmcnt(10)
    v_mfma_f32_32x32x16_bf16 a[16:31], a[40:43], a[72:75], a[16:31]
    ds_read_b128 a[60:63], v11 offset:5040
    s_waitcnt lgkmcnt(10)
    v_mfma_f32_32x32x16_bf16 a[0:15], a[40:43], a[76:79], a[0:15]
    ds_read2_b32 a[32:33], v14 offset0:16 offset1:17
    ds_read2_b32 a[34:35], v14 offset0:18 offset1:19
    ds_read_b128 a[64:67], v11 offset:4992
    s_waitcnt lgkmcnt(10)
    v_mfma_f32_32x32x16_bf16 a[16:31], a[44:47], a[80:83], a[16:31]
    ds_read2_b32 a[36:37], v14 offset0:24 offset1:25
    ds_read2_b32 a[38:39], v14 offset0:26 offset1:27
    s_waitcnt lgkmcnt(11)
    v_mfma_f32_32x32x16_bf16 a[0:15], a[44:47], a[84:87], a[0:15]
    ds_read_b128 a[68:71], v11 offset:4960
    ds_read2_b32 a[40:41], v14 offset0:32 offset1:33
    ds_read2_b32 a[42:43], v14 offset0:34 offset1:35
    s_waitcnt lgkmcnt(11)
    v_mfma_f32_32x32x16_bf16 a[16:31], a[48:51], a[56:59], a[16:31]
    ds_read_b128 a[72:75], v11 offset:4912
    ds_read2_b32 a[44:45], v14 offset0:40 offset1:41
    ds_read2_b32 a[46:47], v14 offset0:42 offset1:43
    s_waitcnt lgkmcnt(11)
    v_mfma_f32_32x32x16_bf16 a[16:31], a[52:55], a[60:63], a[16:31]
    ds_read_b128 a[76:79], v11 offset:4880
    ds_read2_b32 a[48:49], v14 offset0:48 offset1:49
    ds_read2_b32 a[50:51], v14 offset0:50 offset1:51
    s_waitcnt lgkmcnt(11)
    v_mfma_f32_32x32x16_bf16 a[16:31], a[32:35], a[64:67], a[16:31]
    ds_read_b128 a[80:83], v11 offset:4832
    ds_read2_b32 a[52:53], v14 offset0:56 offset1:57
    ds_read2_b32 a[54:55], v14 offset0:58 offset1:59
    s_waitcnt lgkmcnt(11)
    v_mfma_f32_32x32x16_bf16 a[16:31], a[36:39], a[68:71], a[16:31]
    ds_read_b128 a[84:87], v11 offset:4800
    ds_read2_b32 a[32:33], v14 offset0:64 offset1:65
    ds_read2_b32 a[34:35], v14 offset0:66 offset1:67
    s_waitcnt lgkmcnt(11)
    v_mfma_f32_32x32x16_bf16 a[16:31], a[40:43], a[72:75], a[16:31]
    ds_read_b128 a[56:59], v11 offset:4752
    ds_read2_b32 a[36:37], v14 offset0:72 offset1:73
    ds_read2_b32 a[38:39], v14 offset0:74 offset1:75
    s_waitcnt lgkmcnt(11)
    v_mfma_f32_32x32x16_bf16 a[16:31], a[44:47], a[76:79], a[16:31]
    ds_read_b128 a[60:63], v11 offset:4720
    ds_read2_b32 a[40:41], v14 offset0:80 offset1:81
    ds_read2_b32 a[42:43], v14 offset0:82 offset1:83
    s_waitcnt lgkmcnt(11)
    v_mfma_f32_32x32x16_bf16 a[16:31], a[48:51], a[80:83], a[16:31]
    ds_read_b128 a[64:67], v11 offset:4672
    ds_read2_b32 a[44:45], v14 offset0:88 offset1:89
    ds_read2_b32 a[46:47], v14 offset0:90 offset1:91
    s_waitcnt lgkmcnt(11)
    v_mfma_f32_32x32x16_bf16 a[16:31], a[52:55], a[84:87], a[16:31]
    ds_read_b128 a[68:71], v11 offset:4640
    ds_read2_b32 a[48:49], v14 offset0:96 offset1:97
    ds_read2_b32 a[50:51], v14 offset0:98 offset1:99
    s_waitcnt lgkmcnt(11)
    v_mfma_f32_32x32x16_bf16 a[16:31], a[32:35], a[56:59], a[16:31]
    ds_read_b128 a[72:75], v11 offset:4592
    ds_read2_b32 a[52:53], v14 offset0:104 offset1:105
    ds_read2_b32 a[54:55], v14 offset0:106 offset1:107
    s_waitcnt lgkmcnt(11)
    v_mfma_f32_32x32x16_bf16 a[16:31], a[36:39], a[60:63], a[16:31]
    ds_read_b128 a[76:79], v11 offset:4560
    ds_read2_b32 a[32:33], v14 offset0:112 offset1:113
    ds_read2_b32 a[34:35], v14 offset0:114 offset1:115
    s_waitcnt lgkmcnt(11)
    v_mfma_f32_32x32x16_bf16 a[16:31], a[40:43], a[64:67], a[16:31]
    ds_read_b128 a[80:83], v11 offset:4512
    ds_read2_b32 a[36:37], v14 offset0:120 offset1:121
    ds_read2_b32 a[38:39], v14 offset0:122 offset1:123
    s_waitcnt lgkmcnt(11)
    v_mfma_f32_32x32x16_bf16 a[16:31], a[44:47], a[68:71], a[16:31]
    ds_read_b128 a[84:87], v11 offset:4480
    ds_read2_b32 a[40:41], v14 offset0:128 offset1:129
    ds_read2_b32 a[42:43], v14 offset0:130 offset1:131
    s_waitcnt lgkmcnt(11)
    v_mfma_f32_32x32x16_bf16 a[16:31], a[48:51], a[72:75], a[16:31]
    ds_read_b128 a[56:59], v11 offset:4432
    ds_read2_b32 a[44:45], v14 offset0:136 offset1:137
    ds_read2_b32 a[46:47], v14 offset0:138 offset1:139
    s_waitcnt lgkmcnt(11)
    v_mfma_f32_32x32x16_bf16 a[16:31], a[52:55], a[76:79], a[16:31]
    ds_read_b128 a[60:63], v11 offset:4400
    ds_read2_b32 a[48:49], v14 offset0:144 offset1:145
    ds_read2_b32 a[50:51], v14 offset0:146 offset1:147
    s_waitcnt lgkmcnt(11)
    v_mfma_f32_32x32x16_bf16 a[16:31], a[32:35], a[80:83], a[16:31]
    ds_read_b128 a[64:67], v11 offset:4352
    ds_read2_b32 a[52:53], v14 offset0:152 offset1:153
    ds_read2_b32 a[54:55], v14 offset0:154 offset1:155
    s_waitcnt lgkmcnt(11)
    v_mfma_f32_32x32x16_bf16 a[16:31], a[36:39], a[84:87], a[16:31]
    ds_read_b128 a[68:71], v11 offset:4320
    ds_read2_b32 a[32:33], v14 offset0:160 offset1:161
    ds_read2_b32 a[34:35], v14 offset0:162 offset1:163
    s_waitcnt lgkmcnt(11)
    v_mfma_f32_32x32x16_bf16 a[16:31], a[40:43], a[56:59], a[16:31]
    ds_read_b128 a[72:75], v11 offset:4272
    ds_read2_b32 a[36:37], v14 offset0:168 offset1:169
    ds_read2_b32 a[38:39], v14 offset0:170 offset1:171
    s_waitcnt lgkmcnt(11)
    v_mfma_f32_32x32x16_bf16 a[16:31], a[44:47], a[60:63], a[16:31]
    ds_read_b128 a[76:79], v11 offset:4240
    ds_read2_b32 a[40:41], v14 offset0:176 offset1:177
    ds_read2_b32 a[42:43], v14 offset0:178 offset1:179
    s_waitcnt lgkmcnt(11)
    v_mfma_f32_32x32x16_bf16 a[16:31], a[48:51], a[64:67], a[16:31]
    ds_read_b128 a[80:83], v11 offset:4192
    ds_read2_b32 a[44:45], v14 offset0:184 offset1:185
    ds_read2_b32 a[46:47], v14 offset0:186 offset1:187
    s_waitcnt lgkmcnt(11)
    v_mfma_f32_32x32x16_bf16 a[16:31], a[52:55], a[68:71], a[16:31]
    ds_read_b128 a[84:87], v11 offset:4160
    ds_read2_b32 a[48:49], v14 offset0:192 offset1:193
    ds_read2_b32 a[50:51], v14 offset0:194 offset1:195
    s_waitcnt lgkmcnt(11)
    v_mfma_f32_32x32x16_bf16 a[16:31], a[32:35], a[72:75], a[16:31]
    ds_read_b128 a[56:59], v11 offset:4112
    ds_read2_b32 a[52:53], v14 offset0:200 offset1:201
    ds_read2_b32 a[54:55], v14 offset0:202 offset1:203
    s_waitcnt lgkmcnt(11)
    v_mfma_f32_32x32x16_bf16 a[16:31], a[36:39], a[76:79], a[16:31]
    ds_read_b128 a[60:63], v11 offset:4080
    ds_read2_b32 a[32:33], v14 offset0:208 offset1:209
    ds_read2_b32 a[34:35], v14 offset0:210 offset1:211
    s_waitcnt lgkmcnt(11)
    v_mfma_f32_32x32x16_bf16 a[16:31], a[40:43], a[80:83], a[16:31]
    ds_read_b128 a[64:67], v11 offset:4032
    ds_read2_b32 a[36:37], v14 offset0:216 offset1:217
    ds_read2_b32 a[38:39], v14 offset0:218 offset1:219
    s_waitcnt lgkmcnt(11)
    v_mfma_f32_32x32x16_bf16 a[16:31], a[44:47], a[84:87], a[16:31]
    ds_read_b128 a[68:71], v11 offset:4000
    ds_read2_b32 a[40:41], v14 offset0:224 offset1:225
    ds_read2_b32 a[42:43], v14 offset0:226 offset1:227
    s_waitcnt lgkmcnt(11)
    v_mfma_f32_32x32x16_bf16 a[16:31], a[48:51], a[56:59], a[16:31]
    ds_read_b128 a[72:75], v11 offset:3952
    ds_read2_b32 a[44:45], v14 offset0:232 offset1:233
    ds_read2_b32 a[46:47], v14 offset0:234 offset1:235
    s_waitcnt lgkmcnt(11)
    v_mfma_f32_32x32x16_bf16 a[16:31], a[52:55], a[60:63], a[16:31]
    ds_read_b128 a[76:79], v11 offset:3920
    ds_read2_b32 a[48:49], v14 offset0:240 offset1:241
    ds_read2_b32 a[50:51], v14 offset0:242 offset1:243
    s_waitcnt lgkmcnt(11)
    v_mfma_f32_32x32x16_bf16 a[16:31], a[32:35], a[64:67], a[16:31]
    ds_read_b128 a[80:83], v11 offset:3872
    ds_read2_b32 a[52:53], v14 offset0:248 offset1:249
    ds_read2_b32 a[54:55], v14 offset0:250 offset1:251
    v_add_u32 v14, 1024, v14
    s_waitcnt lgkmcnt(11)
    v_mfma_f32_32x32x16_bf16 a[16:31], a[36:39], a[68:71], a[16:31]
    ds_read_b128 a[84:87], v11 offset:3840
    ds_read2_b32 a[32:33], v14 offset0:0 offset1:1
    ds_read2_b32 a[34:35], v14 offset0:2 offset1:3
    s_waitcnt lgkmcnt(11)
    v_mfma_f32_32x32x16_bf16 a[16:31], a[40:43], a[72:75], a[16:31]
    ds_read_b128 a[56:59], v11 offset:3792
    ds_read2_b32 a[36:37], v14 offset0:8 offset1:9
    ds_read2_b32 a[38:39], v14 offset0:10 offset1:11
    s_waitcnt lgkmcnt(11)
    v_mfma_f32_32x32x16_bf16 a[16:31], a[44:47], a[76:79], a[16:31]
    ds_read_b128 a[60:63], v11 offset:3760
    ds_read2_b32 a[40:41], v14 offset0:16 offset1:17
    ds_read2_b32 a[42:43], v14 offset0:18 offset1:19
    s_waitcnt lgkmcnt(11)
    v_mfma_f32_32x32x16_bf16 a[16:31], a[48:51], a[80:83], a[16:31]
    ds_read_b128 a[64:67], v11 offset:3712
    ds_read2_b32 a[44:45], v14 offset0:24 offset1:25
    ds_read2_b32 a[46:47], v14 offset0:26 offset1:27
    s_waitcnt lgkmcnt(11)
    v_mfma_f32_32x32x16_bf16 a[16:31], a[52:55], a[84:87], a[16:31]
    ds_read_b128 a[68:71], v11 offset:3680
    ds_read2_b32 a[48:49], v14 offset0:32 offset1:33
    ds_read2_b32 a[50:51], v14 offset0:34 offset1:35
    s_waitcnt lgkmcnt(11)
    v_mfma_f32_32x32x16_bf16 a[16:31], a[32:35], a[56:59], a[16:31]
    ds_read_b128 a[72:75], v11 offset:3632
    ds_read2_b32 a[52:53], v14 offset0:40 offset1:41
    ds_read2_b32 a[54:55], v14 offset0:42 offset1:43
    s_waitcnt lgkmcnt(11)
    v_mfma_f32_32x32x16_bf16 a[16:31], a[36:39], a[60:63], a[16:31]
    ds_read_b128 a[76:79], v11 offset:3600
    ds_read2_b32 a[32:33], v14 offset0:48 offset1:49
    ds_read2_b32 a[34:35], v14 offset0:50 offset1:51
    s_waitcnt lgkmcnt(11)
    v_mfma_f32_32x32x16_bf16 a[16:31], a[40:43], a[64:67], a[16:31]
    ds_read_b128 a[80:83], v11 offset:3552
    ds_read2_b32 a[36:37], v14 offset0:56 offset1:57
    ds_read2_b32 a[38:39], v14 offset0:58 offset1:59
    s_waitcnt lgkmcnt(11)
    v_mfma_f32_32x32x16_bf16 a[16:31], a[44:47], a[68:71], a[16:31]
    ds_read_b128 a[84:87], v11 offset:3520
    ds_read2_b32 a[40:41], v14 offset0:64 offset1:65
    ds_read2_b32 a[42:43], v14 offset0:66 offset1:67
    s_waitcnt lgkmcnt(11)
    v_mfma_f32_32x32x16_bf16 a[16:31], a[48:51], a[72:75], a[16:31]
    ds_read_b128 a[56:59], v11 offset:3472
    ds_read2_b32 a[44:45], v14 offset0:72 offset1:73
    ds_read2_b32 a[46:47], v14 offset0:74 offset1:75
    s_waitcnt lgkmcnt(11)
    v_mfma_f32_32x32x16_bf16 a[16:31], a[52:55], a[76:79], a[16:31]
    ds_read_b128 a[60:63], v11 offset:3440
    ds_read2_b32 a[48:49], v14 offset0:80 offset1:81
    ds_read2_b32 a[50:51], v14 offset0:82 offset1:83
    s_waitcnt lgkmcnt(11)
    v_mfma_f32_32x32x16_bf16 a[16:31], a[32:35], a[80:83], a[16:31]
    ds_read_b128 a[64:67], v11 offset:3392
    ds_read2_b32 a[52:53], v14 offset0:88 offset1:89
    ds_read2_b32 a[54:55], v14 offset0:90 offset1:91
    s_waitcnt lgkmcnt(11)
    v_mfma_f32_32x32x16_bf16 a[16:31], a[36:39], a[84:87], a[16:31]
    ds_read_b128 a[68:71], v11 offset:3360
    ds_read2_b32 a[32:33], v14 offset0:96 offset1:97
    ds_read2_b32 a[34:35], v14 offset0:98 offset1:99
    s_waitcnt lgkmcnt(11)
    v_mfma_f32_32x32x16_bf16 a[16:31], a[40:43], a[56:59], a[16:31]
    ds_read_b128 a[72:75], v11 offset:3312
    ds_read2_b32 a[36:37], v14 offset0:104 offset1:105
    ds_read2_b32 a[38:39], v14 offset0:106 offset1:107
    s_waitcnt lgkmcnt(11)
    v_mfma_f32_32x32x16_bf16 a[16:31], a[44:47], a[60:63], a[16:31]
    ds_read_b128 a[76:79], v11 offset:3280
    ds_read2_b32 a[40:41], v14 offset0:112 offset1:113
    ds_read2_b32 a[42:43], v14 offset0:114 offset1:115
    s_waitcnt lgkmcnt(11)
    v_mfma_f32_32x32x16_bf16 a[16:31], a[48:51], a[64:67], a[16:31]
    ds_read_b128 a[80:83], v11 offset:3232
    ds_read2_b32 a[44:45], v14 offset0:120 offset1:121
    ds_read2_b32 a[46:47], v14 offset0:122 offset1:123
    s_waitcnt lgkmcnt(11)
    v_mfma_f32_32x32x16_bf16 a[16:31], a[52:55], a[68:71], a[16:31]
    ds_read_b128 a[84:87], v11 offset:3200
    ds_read2_b32 a[48:49], v14 offset0:128 offset1:129
    ds_read2_b32 a[50:51], v14 offset0:130 offset1:131
    s_waitcnt lgkmcnt(11)
    v_mfma_f32_32x32x16_bf16 a[16:31], a[32:35], a[72:75], a[16:31]
    ds_read_b128 a[56:59], v11 offset:3152
    ds_read2_b32 a[52:53], v14 offset0:136 offset1:137
    ds_read2_b32 a[54:55], v14 offset0:138 offset1:139
    s_waitcnt lgkmcnt(11)
    v_mfma_f32_32x32x16_bf16 a[16:31], a[36:39], a[76:79], a[16:31]
    ds_read_b128 a[60:63], v11 offset:3120
    ds_read2_b32 a[32:33], v14 offset0:144 offset1:145
    ds_read2_b32 a[34:35], v14 offset0:146 offset1:147
    s_waitcnt lgkmcnt(11)
    v_mfma_f32_32x32x16_bf16 a[16:31], a[40:43], a[80:83], a[16:31]
    ds_read_b128 a[64:67], v11 offset:3072
    ds_read2_b32 a[36:37], v14 offset0:152 offset1:153
    ds_read2_b32 a[38:39], v14 offset0:154 offset1:155
    s_waitcnt lgkmcnt(11)
    v_mfma_f32_32x32x16_bf16 a[16:31], a[44:47], a[84:87], a[16:31]
    ds_read_b128 a[68:71], v11 offset:3040
    ds_read2_b32 a[40:41], v14 offset0:160 offset1:161
    ds_read2_b32 a[42:43], v14 offset0:162 offset1:163
    s_waitcnt lgkmcnt(11)
    v_mfma_f32_32x32x16_bf16 a[16:31], a[48:51], a[56:59], a[16:31]
    ds_read_b128 a[72:75], v11 offset:2992
    ds_read2_b32 a[44:45], v14 offset0:168 offset1:169
    ds_read2_b32 a[46:47], v14 offset0:170 offset1:171
    s_waitcnt lgkmcnt(11)
    v_mfma_f32_32x32x16_bf16 a[16:31], a[52:55], a[60:63], a[16:31]
    ds_read_b128 a[76:79], v11 offset:2960
    ds_read2_b32 a[48:49], v14 offset0:176 offset1:177
    ds_read2_b32 a[50:51], v14 offset0:178 offset1:179
    s_waitcnt lgkmcnt(11)
    v_mfma_f32_32x32x16_bf16 a[16:31], a[32:35], a[64:67], a[16:31]
    ds_read_b128 a[80:83], v11 offset:2912
    ds_read2_b32 a[52:53], v14 offset0:184 offset1:185
    ds_read2_b32 a[54:55], v14 offset0:186 offset1:187
    s_waitcnt lgkmcnt(11)
    v_mfma_f32_32x32x16_bf16 a[16:31], a[36:39], a[68:71], a[16:31]
    ds_read_b128 a[84:87], v11 offset:2880
    ds_read2_b32 a[32:33], v14 offset0:192 offset1:193
    ds_read2_b32 a[34:35], v14 offset0:194 offset1:195
    s_waitcnt lgkmcnt(11)
    v_mfma_f32_32x32x16_bf16 a[16:31], a[40:43], a[72:75], a[16:31]
    ds_read_b128 a[56:59], v11 offset:2832
    ds_read2_b32 a[36:37], v14 offset0:200 offset1:201
    ds_read2_b32 a[38:39], v14 offset0:202 offset1:203
    s_waitcnt lgkmcnt(11)
    v_mfma_f32_32x32x16_bf16 a[16:31], a[44:47], a[76:79], a[16:31]
    ds_read_b128 a[60:63], v11 offset:2800
    ds_read2_b32 a[40:41], v14 offset0:208 offset1:209
    ds_read2_b32 a[42:43], v14 offset0:210 offset1:211
    s_waitcnt lgkmcnt(11)
    v_mfma_f32_32x32x16_bf16 a[16:31], a[48:51], a[80:83], a[16:31]
    ds_read_b128 a[64:67], v11 offset:2752
    ds_read2_b32 a[44:45], v14 offset0:216 offset1:217
    ds_read2_b32 a[46:47], v14 offset0:218 offset1:219
    s_waitcnt lgkmcnt(11)
    v_mfma_f32_32x32x16_bf16 a[16:31], a[52:55], a[84:87], a[16:31]
    ds_read_b128 a[68:71], v11 offset:2720
    ds_read2_b32 a[48:49], v14 offset0:224 offset1:225
    ds_read2_b32 a[50:51], v14 offset0:226 offset1:227
    s_waitcnt lgkmcnt(11)
    v_mfma_f32_32x32x16_bf16 a[16:31], a[32:35], a[56:59], a[16:31]
    ds_read_b128 a[72:75], v11 offset:2672
    ds_read2_b32 a[52:53], v14 offset0:232 offset1:233
    ds_read2_b32 a[54:55], v14 offset0:234 offset1:235
    s_waitcnt lgkmcnt(11)
    v_mfma_f32_32x32x16_bf16 a[16:31], a[36:39], a[60:63], a[16:31]
    ds_read_b128 a[76:79], v11 offset:2640
    ds_read2_b32 a[32:33], v14 offset0:240 offset1:241
    ds_read2_b32 a[34:35], v14 offset0:242 offset1:243
    s_waitcnt lgkmcnt(11)
    v_mfma_f32_32x32x16_bf16 a[16:31], a[40:43], a[64:67], a[16:31]
    ds_read_b128 a[80:83], v11 offset:2592
    ds_read2_b32 a[36:37], v14 offset0:248 offset1:249
    ds_read2_b32 a[38:39], v14 offset0:250 offset1:251
    v_add_u32 v14, 1024, v14
    s_waitcnt lgkmcnt(11)
    v_mfma_f32_32x32x16_bf16 a[16:31], a[44:47], a[68:71], a[16:31]
    ds_read_b128 a[84:87], v11 offset:2560
    s_waitcnt lgkmcnt(9)
    v_mfma_f32_32x32x16_bf16 a[16:31], a[48:51], a[72:75], a[16:31]
    s_waitcnt lgkmcnt(6)
    v_mfma_f32_32x32x16_bf16 a[16:31], a[52:55], a[76:79], a[16:31]
    s_waitcnt lgkmcnt(3)
    v_mfma_f32_32x32x16_bf16 a[16:31], a[32:35], a[80:83], a[16:31]
    s_waitcnt lgkmcnt(0)
    v_mfma_f32_32x32x16_bf16 a[16:31], a[36:39], a[84:87], a[16:31]
    v_accvgpr_read_b32 v220, a0
    v_accvgpr_read_b32 v221, a1
    v_accvgpr_read_b32 v222, a2
    v_accvgpr_read_b32 v223, a3
    v_accvgpr_read_b32 v224, a4
    v_accvgpr_read_b32 v225, a5
    v_accvgpr_read_b32 v226, a6
    v_accvgpr_read_b32 v227, a7
    v_accvgpr_read_b32 v228, a8
    v_accvgpr_read_b32 v229, a9
    v_accvgpr_read_b32 v230, a10
    v_accvgpr_read_b32 v231, a11
    v_accvgpr_read_b32 v232, a12
    v_accvgpr_read_b32 v233, a13
    v_accvgpr_read_b32 v234, a14
    v_accvgpr_read_b32 v235, a15
    v_cvt_pk_bf16_f32 v236, v220, v221
    v_cvt_pk_bf16_f32 v237, v222, v223
    v_cvt_pk_bf16_f32 v238, v224, v225
    v_cvt_pk_bf16_f32 v239, v226, v227
    v_cvt_pk_bf16_f32 v240, v228, v229
    v_cvt_pk_bf16_f32 v241, v230, v231
    v_cvt_pk_bf16_f32 v242, v232, v233
    v_cvt_pk_bf16_f32 v243, v234, v235
    s_nop 0
    v_permlane32_swap_b32 v236, v238
    v_permlane32_swap_b32 v237, v239
    v_permlane32_swap_b32 v240, v242
    v_permlane32_swap_b32 v241, v243
    buffer_store_dwordx4 v[236:239], v2, s[8:11], s7 offen offset:0 sc1
    buffer_store_dwordx4 v[240:243], v2, s[8:11], s7 offen offset:1024 sc1
    v_accvgpr_read_b32 v220, a16
    v_accvgpr_read_b32 v221, a17
    v_accvgpr_read_b32 v222, a18
    v_accvgpr_read_b32 v223, a19
    v_accvgpr_read_b32 v224, a20
    v_accvgpr_read_b32 v225, a21
    v_accvgpr_read_b32 v226, a22
    v_accvgpr_read_b32 v227, a23
    v_accvgpr_read_b32 v228, a24
    v_accvgpr_read_b32 v229, a25
    v_accvgpr_read_b32 v230, a26
    v_accvgpr_read_b32 v231, a27
    v_accvgpr_read_b32 v232, a28
    v_accvgpr_read_b32 v233, a29
    v_accvgpr_read_b32 v234, a30
    v_accvgpr_read_b32 v235, a31
    v_cvt_pk_bf16_f32 v236, v220, v221
    v_cvt_pk_bf16_f32 v237, v222, v223
    v_cvt_pk_bf16_f32 v238, v224, v225
    v_cvt_pk_bf16_f32 v239, v226, v227
    v_cvt_pk_bf16_f32 v240, v228, v229
    v_cvt_pk_bf16_f32 v241, v230, v231
    v_cvt_pk_bf16_f32 v242, v232, v233
    v_cvt_pk_bf16_f32 v243, v234, v235
    s_nop 0
    v_permlane32_swap_b32 v236, v238
    v_permlane32_swap_b32 v237, v239
    v_permlane32_swap_b32 v240, v242
    v_permlane32_swap_b32 v241, v243
    buffer_store_dwordx4 v[236:239], v2, s[8:11], s7 offen offset:2048 sc1
    buffer_store_dwordx4 v[240:243], v2, s[8:11], s7 offen offset:3072 sc1
    v_add_u32 v11, 30720, v11
    s_add_u32 s64, s64, 1
    s_cmp_lt_u32 s64, 4
    s_waitcnt vmcnt(4)
    s_cbranch_scc1 .chan_211
    v_subrev_u32 v11, 122880, v11
    s_add_u32 s61, s61, 496
    s_add_u32 s63, s63, 1
    s_cmp_lt_u32 s63, 2
    s_barrier
    s_cbranch_scc1 .pass_210
    s_waitcnt vmcnt(0)
    s_barrier
    s_cmp_lg_u32 s24, 0
    s_cbranch_scc1 .sg_213
    s_mov_b64 exec, 1
    v_mov_b32 v4, 1
    v_mov_b32 v5, 0
    buffer_atomic_add v4, v5, s[20:23], 0 offen offset:44 sc1
    s_mov_b64 exec, -1
.sg_213:
    s_and_b32 s34, s24, 1
    s_lshr_b32 s35, s24, 1
    s_lshl_b32 s4, s35, 10
    s_add_u32 s4, s4, 2048
    v_lshlrev_b32 v2, 4, v1
    v_bfe_u32 v254, v1, 4, 2
    v_mul_u32_u24 v3, 128, v254
    v_bfe_u32 v254, v1, 2, 2
    v_mul_u32_u24 v254, 32, v254
    v_add_u32 v3, v3, v254
    v_bfe_u32 v254, v1, 0, 1
    v_mul_u32_u24 v254, 16, v254
    v_add_u32 v3, v3, v254
    v_bfe_u32 v254, v1, 2, 2
    v_mul_u32_u24 v6, 128, v254
    v_bfe_u32 v254, v1, 0, 2
    v_mul_u32_u24 v254, 16, v254
    v_add_u32 v6, v6, v254
    v_bfe_u32 v254, v1, 4, 2
    v_mul_u32_u24 v254, 4, v254
    v_add_u32 v6, v6, v254
    v_add_u32 v6, s4, v6
    s_lshl_b32 s4, s99, 6
    s_add_u32 s4, s4, 92274688
    v_bfe_u32 v254, v1, 0, 4
    v_mul_u32_u24 v7, 4, v254
    v_add_u32 v7, s4, v7
    v_mov_b32 v136, 0
    v_mov_b32 v137, 0
    v_mov_b32 v138, 0
    v_mov_b32 v139, 0
    v_mov_b32 v140, 0
    v_mov_b32 v141, 0
    v_mov_b32 v142, 0
    v_mov_b32 v143, 0
    v_mov_b32 v144, 0
    v_mov_b32 v145, 0
    v_mov_b32 v146, 0
    v_mov_b32 v147, 0
    v_mov_b32 v148, 0
    v_mov_b32 v149, 0
    v_mov_b32 v150, 0
    v_mov_b32 v151, 0
    v_mov_b32 v232, 0
    v_mov_b32 v233, 0
    v_mov_b32 v234, 0
    v_mov_b32 v235, 0
    v_mov_b32 v236, 0
    v_mov_b32 v237, 0
    v_mov_b32 v238, 0
    v_mov_b32 v239, 0
    v_mov_b32 v240, 0
    v_mov_b32 v241, 0
    v_mov_b32 v242, 0
    v_mov_b32 v243, 0
    v_mov_b32 v244, 0
    v_mov_b32 v245, 0
    v_mov_b32 v246, 0
    v_mov_b32 v247, 0
    v_mov_b32 v16, 0
    v_mov_b32 v20, 0x3f803f80
    v_mov_b32 v17, 0
    v_mov_b32 v21, 0x3f803f80
    v_mov_b32 v18, 0
    v_mov_b32 v22, 0x3f803f80
    v_mov_b32 v19, 0
    v_mov_b32 v23, 0x3f803f80
    s_lshl_b32 s4, s34, 4
    v_and_b32 v24, 15, v1
    v_add_u32 v24, s4, v24
    v_lshrrev_b32 v25, 4, v1
    v_lshlrev_b32 v25, 2, v25
    v_mov_b32 v27, 0xff800000
    v_add_u32 v26, 0, v25
    v_cmp_le_u32 vcc, v26, v24
    s_nop 1
    v_cndmask_b32 v8, v27, v16, vcc
    v_add_u32 v26, 1, v25
    v_cmp_le_u32 vcc, v26, v24
    s_nop 1
    v_cndmask_b32 v9, v27, v16, vcc
    v_add_u32 v26, 2, v25
    v_cmp_le_u32 vcc, v26, v24
    s_nop 1
    v_cndmask_b32 v10, v27, v16, vcc
    v_add_u32 v26, 3, v25
    v_cmp_le_u32 vcc, v26, v24
    s_nop 1
    v_cndmask_b32 v11, v27, v16, vcc
    v_add_u32 v26, 16, v25
    v_cmp_le_u32 vcc, v26, v24
    s_nop 1
    v_cndmask_b32 v12, v27, v16, vcc
    v_add_u32 v26, 17, v25
    v_cmp_le_u32 vcc, v26, v24
    s_nop 1
    v_cndmask_b32 v13, v27, v16, vcc
    v_add_u32 v26, 18, v25
    v_cmp_le_u32 vcc, v26, v24
    s_nop 1
    v_cndmask_b32 v14, v27, v16, vcc
    v_add_u32 v26, 19, v25
    v_cmp_le_u32 vcc, v26, v24
    s_nop 1
    v_cndmask_b32 v15, v27, v16, vcc
    s_mov_b32 s30, 0
    s_mov_b32 s32, 0
    s_mov_b32 s33, 0
    s_mov_b32 s31, 0
    s_mov_b32 s45, 0x3e0293ee
    s_lshl_b32 s36, s99, 13
    s_lshl_b32 s37, s34, 12
    s_add_u32 s37, s37, s36
    s_lshl_b32 s38, s35, 12
    s_add_u32 s38, s38, s36
    s_add_u32 s38, s38, 33554432
    s_add_u32 s36, s36, 16777216
    s_lshl_b32 s39, s99, 12
    s_lshl_b32 s4, s34, 17
    s_add_u32 s40, s39, s4
    s_lshl_b32 s4, s35, 11
    s_add_u32 s40, s40, s4
    s_add_u32 s40, s40, 50331648
    s_add_u32 s39, s39, 67108864
    s_mov_b32 s62, 0
    v_mov_b32 v5, 0
.wc_214:
    buffer_load_dword v4, v5, s[20:23], 0 offen offset:32 sc1
    s_add_u32 s62, s62, 1
    s_cmp_gt_u32 s62, 0x200000
    s_cbranch_scc1 .mg_end_1
    s_waitcnt vmcnt(0)
    v_readfirstlane_b32 s4, v4
    s_cmp_ge_u32 s4, 128
    s_cbranch_scc1 .wd_215
    s_sleep 8
    s_branch .wc_214
.wd_215:
    s_mov_b32 s62, 0
    v_mov_b32 v5, 0
.wc_216:
    buffer_load_dword v4, v5, s[20:23], 0 offen offset:36 sc1
    s_add_u32 s62, s62, 1
    s_cmp_gt_u32 s62, 0x200000
    s_cbranch_scc1 .mg_end_1
    s_waitcnt vmcnt(0)
    v_readfirstlane_b32 s4, v4
    s_cmp_ge_u32 s4, 128
    s_cbranch_scc1 .wd_217
    s_sleep 8
    s_branch .wc_216
.wd_217:
    s_cmp_gt_u32 s32, s30
    s_cbranch_scc1 .ndd_219
    s_mov_b32 s62, 0
.nd_218:
    buffer_load_dword v4, v7, s[8:11], 0 offen sc1
    s_add_u32 s62, s62, 1
    s_cmp_gt_u32 s62, 0x200000
    s_cbranch_scc1 .mg_end_1
    s_waitcnt vmcnt(0)
    v_min_u32_dpp v4, v4, v4 quad_perm:[1,0,3,2] row_mask:0xf bank_mask:0xf
    s_nop 1
    v_min_u32_dpp v4, v4, v4 quad_perm:[2,3,0,1] row_mask:0xf bank_mask:0xf
    s_nop 1
    v_readlane_b32 s32, v4, 0
    v_readlane_b32 s4, v4, 4
    v_readlane_b32 s5, v4, 8
    v_readlane_b32 s33, v4, 12
    s_min_u32 s32, s32, s4
    s_min_u32 s32, s32, s5
    s_cmp_gt_u32 s32, s30
    s_cbranch_scc1 .ndd_219
    s_sleep 2
    s_branch .nd_218
.ndd_219:
    s_lshl_b32 s4, s30, 18
    s_add_u32 s48, s37, s4
    s_add_u32 s49, s36, s4
    s_add_u32 s50, s49, 4096
    s_add_u32 s51, s38, s4
    buffer_load_dwordx4 v[56:59], v2, s[8:11], s48 offen offset:0
    buffer_load_dwordx4 v[72:75], v2, s[8:11], s49 offen offset:0
    buffer_load_dwordx4 v[88:91], v2, s[8:11], s50 offen offset:0
    buffer_load_dwordx4 v[104:107], v2, s[8:11], s51 offen offset:0
    buffer_load_dwordx4 v[60:63], v2, s[8:11], s48 offen offset:1024
    buffer_load_dwordx4 v[76:79], v2, s[8:11], s49 offen offset:1024
    buffer_load_dwordx4 v[92:95], v2, s[8:11], s50 offen offset:1024
    buffer_load_dwordx4 v[108:111], v2, s[8:11], s51 offen offset:1024
    buffer_load_dwordx4 v[64:67], v2, s[8:11], s48 offen offset:2048
    buffer_load_dwordx4 v[80:83], v2, s[8:11], s49 offen offset:2048
    buffer_load_dwordx4 v[96:99], v2, s[8:11], s50 offen offset:2048
    buffer_load_dwordx4 v[112:115], v2, s[8:11], s51 offen offset:2048
    buffer_load_dwordx4 v[68:71], v2, s[8:11], s48 offen offset:3072
    buffer_load_dwordx4 v[84:87], v2, s[8:11], s49 offen offset:3072
    buffer_load_dwordx4 v[100:103], v2, s[8:11], s50 offen offset:3072
    buffer_load_dwordx4 v[116:119], v2, s[8:11], s51 offen offset:3072
.at_220:
    s_add_u32 s41, s30, 1
    s_min_u32 s42, s41, 63
    s_cmp_gt_u32 s32, s42
    s_cbranch_scc1 .ndd_225
    s_mov_b32 s62, 0
.nd_224:
    buffer_load_dword v4, v7, s[8:11], 0 offen sc1
    s_add_u32 s62, s62, 1
    s_cmp_gt_u32 s62, 0x200000
    s_cbranch_scc1 .mg_end_1
    s_waitcnt vmcnt(0)
    v_min_u32_dpp v4, v4, v4 quad_perm:[1,0,3,2] row_mask:0xf bank_mask:0xf
    s_nop 1
    v_min_u32_dpp v4, v4, v4 quad_perm:[2,3,0,1] row_mask:0xf bank_mask:0xf
    s_nop 1
    v_readlane_b32 s32, v4, 0
    v_readlane_b32 s4, v4, 4
    v_readlane_b32 s5, v4, 8
    v_readlane_b32 s33, v4, 12
    s_min_u32 s32, s32, s4
    s_min_u32 s32, s32, s5
    s_cmp_gt_u32 s32, s42
    s_cbranch_scc1 .ndd_225
    s_sleep 2
    s_branch .nd_224
.ndd_225:
    s_cmp_lg_u32 s31, 0
    s_cbranch_scc1 .hm_222
    s_cmp_gt_u32 s33, s30
    s_cbranch_scc1 .ndd_227
    s_mov_b32 s62, 0
.nd_226:
    buffer_load_dword v4, v7, s[8:11], 0 offen sc1
    s_add_u32 s62, s62, 1
    s_cmp_gt_u32 s62, 0x200000
    s_cbranch_scc1 .mg_end_1
    s_waitcnt vmcnt(0)
    v_min_u32_dpp v4, v4, v4 quad_perm:[1,0,3,2] row_mask:0xf bank_mask:0xf
    s_nop 1
    v_min_u32_dpp v4, v4, v4 quad_perm:[2,3,0,1] row_mask:0xf bank_mask:0xf
    s_nop 1
    v_readlane_b32 s32, v4, 0
    v_readlane_b32 s4, v4, 4
    v_readlane_b32 s5, v4, 8
    v_readlane_b32 s33, v4, 12
    s_min_u32 s32, s32, s4
    s_min_u32 s32, s32, s5
    s_cmp_gt_u32 s33, s30
    s_cbranch_scc1 .ndd_227
    s_sleep 2
    s_branch .nd_226
.ndd_227:
    s_lshl_b32 s4, s30, 17
    s_add_u32 s52, s39, s4
    buffer_load_dwordx4 v[120:123], v3, s[8:11], s52 offen offset:0
    buffer_load_dwordx4 v[124:127], v3, s[8:11], s52 offen offset:512
    buffer_load_dwordx4 v[128:131], v3, s[8:11], s52 offen offset:1024
    buffer_load_dwordx4 v[132:135], v3, s[8:11], s52 offen offset:1536
    buffer_load_dword v136, v6, s[8:11], s52 offen offset:0
    buffer_load_dword v140, v6, s[8:11], s52 offen offset:64
    buffer_load_dword v144, v6, s[8:11], s52 offen offset:512
    buffer_load_dword v148, v6, s[8:11], s52 offen offset:576
.hm_222:
    s_lshl_b32 s4, s42, 18
    s_add_u32 s48, s37, s4
    s_add_u32 s49, s36, s4
    s_add_u32 s50, s49, 4096
    s_add_u32 s51, s38, s4
    buffer_load_dwordx4 v[152:155], v2, s[8:11], s48 offen offset:0
    buffer_load_dwordx4 v[168:171], v2, s[8:11], s49 offen offset:0
    buffer_load_dwordx4 v[184:187], v2, s[8:11], s50 offen offset:0
    buffer_load_dwordx4 v[200:203], v2, s[8:11], s51 offen offset:0
    buffer_load_dwordx4 v[156:159], v2, s[8:11], s48 offen offset:1024
    buffer_load_dwordx4 v[172:175], v2, s[8:11], s49 offen offset:1024
    buffer_load_dwordx4 v[188:191], v2, s[8:11], s50 offen offset:1024
    buffer_load_dwordx4 v[204:207], v2, s[8:11], s51 offen offset:1024
    buffer_load_dwordx4 v[160:163], v2, s[8:11], s48 offen offset:2048
    buffer_load_dwordx4 v[176:179], v2, s[8:11], s49 offen offset:2048
    buffer_load_dwordx4 v[192:195], v2, s[8:11], s50 offen offset:2048
    buffer_load_dwordx4 v[208:211], v2, s[8:11], s51 offen offset:2048
    buffer_load_dwordx4 v[164:167], v2, s[8:11], s48 offen offset:3072
    buffer_load_dwordx4 v[180:183], v2, s[8:11], s49 offen offset:3072
    buffer_load_dwordx4 v[196:199], v2, s[8:11], s50 offen offset:3072
    buffer_load_dwordx4 v[212:215], v2, s[8:11], s51 offen offset:3072
    s_lshl_b32 s4, s30, 18
    s_add_u32 s53, s40, s4
    s_mov_b32 s31, 0
    s_cmp_gt_u32 s33, s41
    s_waitcnt vmcnt(16)
    s_cbranch_scc0 .nm_223
    s_mov_b32 s31, 1
    s_lshl_b32 s4, s41, 17
    s_add_u32 s52, s39, s4
    buffer_load_dwordx4 v[216:219], v3, s[8:11], s52 offen offset:0
    buffer_load_dwordx4 v[220:223], v3, s[8:11], s52 offen offset:512
    buffer_load_dwordx4 v[224:227], v3, s[8:11], s52 offen offset:1024
    buffer_load_dwordx4 v[228:231], v3, s[8:11], s52 offen offset:1536
    buffer_load_dword v232, v6, s[8:11], s52 offen offset:0
    buffer_load_dword v236, v6, s[8:11], s52 offen offset:64
    buffer_load_dword v240, v6, s[8:11], s52 offen offset:512
    buffer_load_dword v244, v6, s[8:11], s52 offen offset:576
.nm_223:
    v_mfma_f32_16x16x32_bf16 v[24:27], v[72:75], v[56:59], v[8:11]
    v_mfma_f32_16x16x32_bf16 v[28:31], v[88:91], v[56:59], v[12:15]
    v_mfma_f32_16x16x32_bf16 v[32:35], v[120:123], v[56:59], 0
    v_mfma_f32_16x16x32_bf16 v[24:27], v[76:79], v[60:63], v[24:27]
    v_mfma_f32_16x16x32_bf16 v[28:31], v[92:95], v[60:63], v[28:31]
    v_mfma_f32_16x16x32_bf16 v[32:35], v[124:127], v[60:63], v[32:35]
    v_mfma_f32_16x16x32_bf16 v[24:27], v[80:83], v[64:67], v[24:27]
    v_mfma_f32_16x16x32_bf16 v[28:31], v[96:99], v[64:67], v[28:31]
    v_mfma_f32_16x16x32_bf16 v[32:35], v[128:131], v[64:67], v[32:35]
    v_mfma_f32_16x16x32_bf16 v[24:27], v[84:87], v[68:71], v[24:27]
    v_mfma_f32_16x16x32_bf16 v[28:31], v[100:103], v[68:71], v[28:31]
    v_mfma_f32_16x16x32_bf16 v[32:35], v[132:135], v[68:71], v[32:35]
    v_mov_b32 v5, s41
    s_nop 5
    v_max3_f32 v46, v24, v25, v26
    v_max3_f32 v46, v46, v27, v28
    v_max3_f32 v47, v29, v30, v31
    v_max3_f32 v46, v46, v32, v33
    v_max_f32 v4, v46, v47
    v_max_f32 v47, v46, v47
    s_nop 1
    v_permlane16_swap_b32 v47, v4
    v_max_f32 v46, v47, v4
    v_max_f32 v47, v47, v4
    s_nop 1
    v_permlane32_swap_b32 v46, v47
    v_max_f32 v46, v46, v47
    v_mul_f32 v46, s45, v46
    v_fma_f32 v36, v24, s45, -v46
    v_fma_f32 v37, v25, s45, -v46
    v_fma_f32 v38, v26, s45, -v46
    v_fma_f32 v39, v27, s45, -v46
    v_fma_f32 v40, v28, s45, -v46
    v_fma_f32 v41, v29, s45, -v46
    v_fma_f32 v42, v30, s45, -v46
    v_fma_f32 v43, v31, s45, -v46
    v_fma_f32 v44, v32, s45, -v46
    v_fma_f32 v45, v33, s45, -v46
    v_exp_f32 v36, v36
    v_exp_f32 v37, v37
    v_exp_f32 v38, v38
    v_exp_f32 v39, v39
    v_exp_f32 v40, v40
    v_exp_f32 v41, v41
    v_exp_f32 v42, v42
    v_exp_f32 v43, v43
    v_exp_f32 v44, v44
    v_exp_f32 v45, v45
    s_nop 0
    v_cvt_pk_bf16_f32 v48, v36, v37
    v_cvt_pk_bf16_f32 v49, v38, v39
    v_cvt_pk_bf16_f32 v50, v40, v41
    v_cvt_pk_bf16_f32 v51, v42, v43
    v_cvt_pk_bf16_f32 v16, v44, v45
    s_nop 0
    v_mfma_f32_16x16x32_bf16 v[52:55], v[20:23], v[48:51], 0
    v_mfma_f32_16x16x32_bf16 v[52:55], v[20:23], v[16:19], v[52:55]
    v_mfma_f32_16x16x32_bf16 v[56:59], v[104:107], v[48:51], 0
    v_mfma_f32_16x16x32_bf16 v[56:59], v[136:139], v[16:19], v[56:59]
    v_mfma_f32_16x16x32_bf16 v[60:63], v[108:111], v[48:51], 0
    v_mfma_f32_16x16x32_bf16 v[60:63], v[140:143], v[16:19], v[60:63]
    v_mfma_f32_16x16x32_bf16 v[64:67], v[112:115], v[48:51], 0
    v_mfma_f32_16x16x32_bf16 v[64:67], v[144:147], v[16:19], v[64:67]
    v_mfma_f32_16x16x32_bf16 v[68:71], v[116:119], v[48:51], 0
    v_mfma_f32_16x16x32_bf16 v[68:71], v[148:151], v[16:19], v[68:71]
    v_rcp_f32 v46, v52
    s_nop 1
    v_mul_f32 v56, v46, v56
    v_mul_f32 v57, v46, v57
    v_mul_f32 v58, v46, v58
    v_mul_f32 v59, v46, v59
    v_cvt_pk_bf16_f32 v72, v56, v57
    v_cvt_pk_bf16_f32 v73, v58, v59
    v_mul_f32 v60, v46, v60
    v_mul_f32 v61, v46, v61
    v_mul_f32 v62, v46, v62
    v_mul_f32 v63, v46, v63
    v_cvt_pk_bf16_f32 v74, v60, v61
    v_cvt_pk_bf16_f32 v75, v62, v63
    buffer_store_dwordx4 v[72:75], v2, s[8:11], s53 offen offset:0 sc1
    v_mul_f32 v64, v46, v64
    v_mul_f32 v65, v46, v65
    v_mul_f32 v66, v46, v66
    v_mul_f32 v67, v46, v67
    v_cvt_pk_bf16_f32 v76, v64, v65
    v_cvt_pk_bf16_f32 v77, v66, v67
    v_mul_f32 v68, v46, v68
    v_mul_f32 v69, v46, v69
    v_mul_f32 v70, v46, v70
    v_mul_f32 v71, v46, v71
    v_cvt_pk_bf16_f32 v78, v68, v69
    v_cvt_pk_bf16_f32 v79, v70, v71
    buffer_store_dwordx4 v[76:79], v2, s[8:11], s53 offen offset:1024 sc1
    s_mov_b32 s30, s41
    s_cmp_lt_u32 s30, 64
    s_waitcnt vmcnt(0)
    s_mov_b64 exec, 1
    buffer_store_dword v5, v17, s[8:11], s94 offen sc1
    s_mov_b64 exec, -1
    s_add_u32 s41, s30, 1
    s_min_u32 s42, s41, 63
    s_cmp_gt_u32 s32, s42
    s_cbranch_scc1 .ndd_231
    s_mov_b32 s62, 0
.nd_230:
    buffer_load_dword v4, v7, s[8:11], 0 offen sc1
    s_add_u32 s62, s62, 1
    s_cmp_gt_u32 s62, 0x200000
    s_cbranch_scc1 .mg_end_1
    s_waitcnt vmcnt(0)
    v_min_u32_dpp v4, v4, v4 quad_perm:[1,0,3,2] row_mask:0xf bank_mask:0xf
    s_nop 1
    v_min_u32_dpp v4, v4, v4 quad_perm:[2,3,0,1] row_mask:0xf bank_mask:0xf
    s_nop 1
    v_readlane_b32 s32, v4, 0
    v_readlane_b32 s4, v4, 4
    v_readlane_b32 s5, v4, 8
    v_readlane_b32 s33, v4, 12
    s_min_u32 s32, s32, s4
    s_min_u32 s32, s32, s5
    s_cmp_gt_u32 s32, s42
    s_cbranch_scc1 .ndd_231
    s_sleep 2
    s_branch .nd_230
.ndd_231:
    s_cmp_lg_u32 s31, 0
    s_cbranch_scc1 .hm_228
    s_cmp_gt_u32 s33, s30
    s_cbranch_scc1 .ndd_233
    s_mov_b32 s62, 0
.nd_232:
    buffer_load_dword v4, v7, s[8:11], 0 offen sc1
    s_add_u32 s62, s62, 1
    s_cmp_gt_u32 s62, 0x200000
    s_cbranch_scc1 .mg_end_1
    s_waitcnt vmcnt(0)
    v_min_u32_dpp v4, v4, v4 quad_perm:[1,0,3,2] row_mask:0xf bank_mask:0xf
    s_nop 1
    v_min_u32_dpp v4, v4, v4 quad_perm:[2,3,0,1] row_mask:0xf bank_mask:0xf
    s_nop 1
    v_readlane_b32 s32, v4, 0
    v_readlane_b32 s4, v4, 4
    v_readlane_b32 s5, v4, 8
    v_readlane_b32 s33, v4, 12
    s_min_u32 s32, s32, s4
    s_min_u32 s32, s32, s5
    s_cmp_gt_u32 s33, s30
    s_cbranch_scc1 .ndd_233
    s_sleep 2
    s_branch .nd_232
.ndd_233:
    s_lshl_b32 s4, s30, 17
    s_add_u32 s52, s39, s4
    buffer_load_dwordx4 v[216:219], v3, s[8:11], s52 offen offset:0
    buffer_load_dwordx4 v[220:223], v3, s[8:11], s52 offen offset:512
    buffer_load_dwordx4 v[224:227], v3, s[8:11], s52 offen offset:1024
    buffer_load_dwordx4 v[228:231], v3, s[8:11], s52 offen offset:1536
    buffer_load_dword v232, v6, s[8:11], s52 offen offset:0
    buffer_load_dword v236, v6, s[8:11], s52 offen offset:64
    buffer_load_dword v240, v6, s[8:11], s52 offen offset:512
    buffer_load_dword v244, v6, s[8:11], s52 offen offset:576
.hm_228:
    s_lshl_b32 s4, s42, 18
    s_add_u32 s48, s37, s4
    s_add_u32 s49, s36, s4
    s_add_u32 s50, s49, 4096
    s_add_u32 s51, s38, s4
    buffer_load_dwordx4 v[56:59], v2, s[8:11], s48 offen offset:0
    buffer_load_dwordx4 v[72:75], v2, s[8:11], s49 offen offset:0
    buffer_load_dwordx4 v[88:91], v2, s[8:11], s50 offen offset:0
    buffer_load_dwordx4 v[104:107], v2, s[8:11], s51 offen offset:0
    buffer_load_dwordx4 v[60:63], v2, s[8:11], s48 offen offset:1024
    buffer_load_dwordx4 v[76:79], v2, s[8:11], s49 offen offset:1024
    buffer_load_dwordx4 v[92:95], v2, s[8:11], s50 offen offset:1024
    buffer_load_dwordx4 v[108:111], v2, s[8:11], s51 offen offset:1024
    buffer_load_dwordx4 v[64:67], v2, s[8:11], s48 offen offset:2048
    buffer_load_dwordx4 v[80:83], v2, s[8:11], s49 offen offset:2048
    buffer_load_dwordx4 v[96:99], v2, s[8:11], s50 offen offset:2048
    buffer_load_dwordx4 v[112:115], v2, s[8:11], s51 offen offset:2048
    buffer_load_dwordx4 v[68:71], v2, s[8:11], s48 offen offset:3072
    buffer_load_dwordx4 v[84:87], v2, s[8:11], s49 offen offset:3072
    buffer_load_dwordx4 v[100:103], v2, s[8:11], s50 offen offset:3072
    buffer_load_dwordx4 v[116:119], v2, s[8:11], s51 offen offset:3072
    s_lshl_b32 s4, s30, 18
    s_add_u32 s53, s40, s4
    s_mov_b32 s31, 0
    s_cmp_gt_u32 s33, s41
    s_waitcnt vmcnt(16)
    s_cbranch_scc0 .nm_229
    s_mov_b32 s31, 1
    s_lshl_b32 s4, s41, 17
    s_add_u32 s52, s39, s4
    buffer_load_dwordx4 v[120:123], v3, s[8:11], s52 offen offset:0
    buffer_load_dwordx4 v[124:127], v3, s[8:11], s52 offen offset:512
    buffer_load_dwordx4 v[128:131], v3, s[8:11], s52 offen offset:1024
    buffer_load_dwordx4 v[132:135], v3, s[8:11], s52 offen offset:1536
    buffer_load_dword v136, v6, s[8:11], s52 offen offset:0
    buffer_load_dword v140, v6, s[8:11], s52 offen offset:64
    buffer_load_dword v144, v6, s[8:11], s52 offen offset:512
    buffer_load_dword v148, v6, s[8:11], s52 offen offset:576
.nm_229:
    v_mfma_f32_16x16x32_bf16 v[24:27], v[168:171], v[152:155], v[8:11]
    v_mfma_f32_16x16x32_bf16 v[28:31], v[184:187], v[152:155], v[12:15]
    v_mfma_f32_16x16x32_bf16 v[32:35], v[216:219], v[152:155], 0
    v_mfma_f32_16x16x32_bf16 v[24:27], v[172:175], v[156:159], v[24:27]
    v_mfma_f32_16x16x32_bf16 v[28:31], v[188:191], v[156:159], v[28:31]
    v_mfma_f32_16x16x32_bf16 v[32:35], v[220:223], v[156:159], v[32:35]
    v_mfma_f32_16x16x32_bf16 v[24:27], v[176:179], v[160:163], v[24:27]
    v_mfma_f32_16x16x32_bf16 v[28:31], v[192:195], v[160:163], v[28:31]
    v_mfma_f32_16x16x32_bf16 v[32:35], v[224:227], v[160:163], v[32:35]
    v_mfma_f32_16x16x32_bf16 v[24:27], v[180:183], v[164:167], v[24:27]
    v_mfma_f32_16x16x32_bf16 v[28:31], v[196:199], v[164:167], v[28:31]
    v_mfma_f32_16x16x32_bf16 v[32:35], v[228:231], v[164:167], v[32:35]
    v_mov_b32 v5, s41
    s_nop 5
    v_max3_f32 v46, v24, v25, v26
    v_max3_f32 v46, v46, v27, v28
    v_max3_f32 v47, v29, v30, v31
    v_max3_f32 v46, v46, v32, v33
    v_max_f32 v4, v46, v47
    v_max_f32 v47, v46, v47
    s_nop 1
    v_permlane16_swap_b32 v47, v4
    v_max_f32 v46, v47, v4
    v_max_f32 v47, v47, v4
    s_nop 1
    v_permlane32_swap_b32 v46, v47
    v_max_f32 v46, v46, v47
    v_mul_f32 v46, s45, v46
    v_fma_f32 v36, v24, s45, -v46
    v_fma_f32 v37, v25, s45, -v46
    v_fma_f32 v38, v26, s45, -v46
    v_fma_f32 v39, v27, s45, -v46
    v_fma_f32 v40, v28, s45, -v46
    v_fma_f32 v41, v29, s45, -v46
    v_fma_f32 v42, v30, s45, -v46
    v_fma_f32 v43, v31, s45, -v46
    v_fma_f32 v44, v32, s45, -v46
    v_fma_f32 v45, v33, s45, -v46
    v_exp_f32 v36, v36
    v_exp_f32 v37, v37
    v_exp_f32 v38, v38
    v_exp_f32 v39, v39
    v_exp_f32 v40, v40
    v_exp_f32 v41, v41
    v_exp_f32 v42, v42
    v_exp_f32 v43, v43
    v_exp_f32 v44, v44
    v_exp_f32 v45, v45
    s_nop 0
    v_cvt_pk_bf16_f32 v48, v36, v37
    v_cvt_pk_bf16_f32 v49, v38, v39
    v_cvt_pk_bf16_f32 v50, v40, v41
    v_cvt_pk_bf16_f32 v51, v42, v43
    v_cvt_pk_bf16_f32 v16, v44, v45
    s_nop 0
    v_mfma_f32_16x16x32_bf16 v[52:55], v[20:23], v[48:51], 0
    v_mfma_f32_16x16x32_bf16 v[52:55], v[20:23], v[16:19], v[52:55]
    v_mfma_f32_16x16x32_bf16 v[152:155], v[200:203], v[48:51], 0
    v_mfma_f32_16x16x32_bf16 v[152:155], v[232:235], v[16:19], v[152:155]
    v_mfma_f32_16x16x32_bf16 v[156:159], v[204:207], v[48:51], 0
    v_mfma_f32_16x16x32_bf16 v[156:159], v[236:239], v[16:19], v[156:159]
    v_mfma_f32_16x16x32_bf16 v[160:163], v[208:211], v[48:51], 0
    v_mfma_f32_16x16x32_bf16 v[160:163], v[240:243], v[16:19], v[160:163]
    v_mfma_f32_16x16x32_bf16 v[164:167], v[212:215], v[48:51], 0
    v_mfma_f32_16x16x32_bf16 v[164:167], v[244:247], v[16:19], v[164:167]
    v_rcp_f32 v46, v52
    s_nop 1
    v_mul_f32 v152, v46, v152
    v_mul_f32 v153, v46, v153
    v_mul_f32 v154, v46, v154
    v_mul_f32 v155, v46, v155
    v_cvt_pk_bf16_f32 v168, v152, v153
    v_cvt_pk_bf16_f32 v169, v154, v155
    v_mul_f32 v156, v46, v156
    v_mul_f32 v157, v46, v157
    v_mul_f32 v158, v46, v158
    v_mul_f32 v159, v46, v159
    v_cvt_pk_bf16_f32 v170, v156, v157
    v_cvt_pk_bf16_f32 v171, v158, v159
    buffer_store_dwordx4 v[168:171], v2, s[8:11], s53 offen offset:0 sc1
    v_mul_f32 v160, v46, v160
    v_mul_f32 v161, v46, v161
    v_mul_f32 v162, v46, v162
    v_mul_f32 v163, v46, v163
    v_cvt_pk_bf16_f32 v172, v160, v161
    v_cvt_pk_bf16_f32 v173, v162, v163
    v_mul_f32 v164, v46, v164
    v_mul_f32 v165, v46, v165
    v_mul_f32 v166, v46, v166
    v_mul_f32 v167, v46, v167
    v_cvt_pk_bf16_f32 v174, v164, v165
    v_cvt_pk_bf16_f32 v175, v166, v167
    buffer_store_dwordx4 v[172:175], v2, s[8:11], s53 offen offset:1024 sc1
    s_mov_b32 s30, s41
    s_cmp_lt_u32 s30, 64
    s_waitcnt vmcnt(0)
    s_mov_b64 exec, 1
    buffer_store_dword v5, v17, s[8:11], s94 offen sc1
    s_mov_b64 exec, -1
    s_cbranch_scc1 .at_220
    s_endpgm
.ph2_197:
    s_load_dwordx2 s[42:43], s[0:1], 88
    s_load_dwordx2 s[44:45], s[0:1], 112
    s_lshl_b32 s4, s99, 6
    s_lshl_b32 s5, s24, 21
    s_add_u32 s4, s4, s5
    s_lshl_b32 s6, s24, 14
    v_bfe_u32 v254, v1, 2, 4
    v_mul_u32_u24 v240, 2048, v254
    v_bfe_u32 v254, v1, 0, 2
    v_mul_u32_u24 v254, 16, v254
    v_add_u32 v240, v240, v254
    v_add_u32 v240, s4, v240
    v_bfe_u32 v254, v1, 4, 2
    v_mul_u32_u24 v242, 512, v254
    v_bfe_u32 v254, v1, 2, 2
    v_mul_u32_u24 v254, 64, v254
    v_add_u32 v242, v242, v254
    v_bfe_u32 v254, v1, 0, 2
    v_mul_u32_u24 v254, 16, v254
    v_add_u32 v242, v242, v254
    v_add_u32 v242, s6, v242
    v_add_u32 v243, 0x10000, v242
    s_waitcnt lgkmcnt(0)
    s_barrier
    s_mov_b32 s16, s42
    s_and_b32 s17, s43, 0xffff
    s_mov_b32 s18, 0x800000
    s_mov_b32 s19, 0x00020000
    s_mov_b32 s84, s44
    s_and_b32 s85, s45, 0xffff
    s_mov_b32 s86, 0x400000
    s_mov_b32 s87, 0x00020000
    s_add_u32 m0, s6, 0
    s_mov_b32 s5, 0
    buffer_load_dwordx4 v240, s[16:19], s5 offen lds
    s_add_u32 m0, s6, 1024
    s_mov_b32 s5, 32768
    buffer_load_dwordx4 v240, s[16:19], s5 offen lds
    s_add_u32 m0, s6, 2048
    s_mov_b32 s5, 65536
    buffer_load_dwordx4 v240, s[16:19], s5 offen lds
    s_add_u32 m0, s6, 3072
    s_mov_b32 s5, 98304
    buffer_load_dwordx4 v240, s[16:19], s5 offen lds
    s_add_u32 m0, s6, 4096
    s_mov_b32 s5, 131072
    buffer_load_dwordx4 v240, s[16:19], s5 offen lds
    s_add_u32 m0, s6, 5120
    s_mov_b32 s5, 163840
    buffer_load_dwordx4 v240, s[16:19], s5 offen lds
    s_add_u32 m0, s6, 6144
    s_mov_b32 s5, 196608
    buffer_load_dwordx4 v240, s[16:19], s5 offen lds
    s_add_u32 m0, s6, 7168
    s_mov_b32 s5, 229376
    buffer_load_dwordx4 v240, s[16:19], s5 offen lds
    s_add_u32 m0, s6, 8192
    s_mov_b32 s5, 262144
    buffer_load_dwordx4 v240, s[16:19], s5 offen lds
    s_add_u32 m0, s6, 9216
    s_mov_b32 s5, 294912
    buffer_load_dwordx4 v240, s[16:19], s5 offen lds
    s_add_u32 m0, s6, 10240
    s_mov_b32 s5, 327680
    buffer_load_dwordx4 v240, s[16:19], s5 offen lds
    s_add_u32 m0, s6, 11264
    s_mov_b32 s5, 360448
    buffer_load_dwordx4 v240, s[16:19], s5 offen lds
    s_add_u32 m0, s6, 12288
    s_mov_b32 s5, 393216
    buffer_load_dwordx4 v240, s[16:19], s5 offen lds
    s_add_u32 m0, s6, 13312
    s_mov_b32 s5, 425984
    buffer_load_dwordx4 v240, s[16:19], s5 offen lds
    s_add_u32 m0, s6, 14336
    s_mov_b32 s5, 458752
    buffer_load_dwordx4 v240, s[16:19], s5 offen lds
    s_add_u32 m0, s6, 15360
    s_mov_b32 s5, 491520
    buffer_load_dwordx4 v240, s[16:19], s5 offen lds
    s_add_u32 m0, s6, 65536
    s_mov_b32 s5, 524288
    buffer_load_dwordx4 v240, s[16:19], s5 offen lds
    s_add_u32 m0, s6, 66560
    s_mov_b32 s5, 557056
    buffer_load_dwordx4 v240, s[16:19], s5 offen lds
    s_add_u32 m0, s6, 67584
    s_mov_b32 s5, 589824
    buffer_load_dwordx4 v240, s[16:19], s5 offen lds
    s_add_u32 m0, s6, 68608
    s_mov_b32 s5, 622592
    buffer_load_dwordx4 v240, s[16:19], s5 offen lds
    s_add_u32 m0, s6, 69632
    s_mov_b32 s5, 655360
    buffer_load_dwordx4 v240, s[16:19], s5 offen lds
    s_add_u32 m0, s6, 70656
    s_mov_b32 s5, 688128
    buffer_load_dwordx4 v240, s[16:19], s5 offen lds
    s_add_u32 m0, s6, 71680
    s_mov_b32 s5, 720896
    buffer_load_dwordx4 v240, s[16:19], s5 offen lds
    s_add_u32 m0, s6, 72704
    s_mov_b32 s5, 753664
    buffer_load_dwordx4 v240, s[16:19], s5 offen lds
    s_add_u32 m0, s6, 73728
    s_mov_b32 s5, 786432
    buffer_load_dwordx4 v240, s[16:19], s5 offen lds
    s_add_u32 m0, s6, 74752
    s_mov_b32 s5, 819200
    buffer_load_dwordx4 v240, s[16:19], s5 offen lds
    s_add_u32 m0, s6, 75776
    s_mov_b32 s5, 851968
    buffer_load_dwordx4 v240, s[16:19], s5 offen lds
    s_add_u32 m0, s6, 76800
    s_mov_b32 s5, 884736
    buffer_load_dwordx4 v240, s[16:19], s5 offen lds
    s_add_u32 m0, s6, 77824
    s_mov_b32 s5, 917504
    buffer_load_dwordx4 v240, s[16:19], s5 offen lds
    s_add_u32 m0, s6, 78848
    s_mov_b32 s5, 950272
    buffer_load_dwordx4 v240, s[16:19], s5 offen lds
    s_add_u32 m0, s6, 79872
    s_mov_b32 s5, 983040
    buffer_load_dwordx4 v240, s[16:19], s5 offen lds
    s_add_u32 m0, s6, 80896
    s_mov_b32 s5, 1015808
    buffer_load_dwordx4 v240, s[16:19], s5 offen lds
    s_and_b32 s34, s24, 1
    s_lshr_b32 s35, s24, 1
    v_lshlrev_b32 v2, 4, v1
    s_lshl_b32 s4, s24, 7
    s_add_u32 s4, s4, 92278784
    v_bfe_u32 v254, v1, 0, 4
    v_mul_u32_u24 v8, 8, v254
    v_add_u32 v8, s4, v8
    s_lshl_b32 s4, s24, 15
    v_add_u32 v9, s4, v2
    v_add_u32 v10, 0x20000, v9
    s_lshl_b32 s4, s24, 12
    v_add_u32 v11, s4, v2
    s_lshl_b32 s4, s35, 11
    s_lshl_b32 s5, s34, 7
    s_add_u32 s4, s4, s5
    v_bfe_u32 v254, v1, 0, 1
    v_mul_u32_u24 v12, 1024, v254
    v_bfe_u32 v254, v1, 1, 2
    v_mul_u32_u24 v254, 256, v254
    v_add_u32 v12, v12, v254
    v_bfe_u32 v254, v1, 3, 3
    v_mul_u32_u24 v254, 16, v254
    v_add_u32 v12, v12, v254
    v_add_u32 v12, s4, v12
    s_lshl_b32 s4, s24, 14
    s_lshl_b32 s5, s99, 6
    s_add_u32 s4, s4, s5
    v_bfe_u32 v254, v1, 3, 3
    v_mul_u32_u24 v13, 2048, v254
    v_bfe_u32 v254, v1, 0, 3
    v_mul_u32_u24 v254, 8, v254
    v_add_u32 v13, v13, v254
    v_add_u32 v13, s4, v13
    s_lshl_b32 s4, s99, 17
    s_lshl_b32 s5, s24, 9
    s_add_u32 s4, s4, s5
    v_bfe_u32 v254, v1, 0, 3
    v_mul_u32_u24 v14, 16384, v254
    v_bfe_u32 v254, v1, 3, 3
    v_mul_u32_u24 v254, 2, v254
    v_add_u32 v14, v14, v254
    v_add_u32 v14, s4, v14
    v_add_u32 v15, 4096, v14
    v_add_u32 v16, 8192, v14
    v_add_u32 v17, 12288, v14
    s_lshl_b32 s4, s24, 5
    v_bfe_u32 v254, v1, 3, 3
    v_mul_u32_u24 v18, 4, v254
    v_add_u32 v18, s4, v18
    s_lshl_b32 s4, s99, 13
    s_lshl_b32 s5, s24, 11
    s_add_u32 s4, s4, s5
    s_add_u32 s4, s4, 50331648
    v_bfe_u32 v254, v1, 0, 6
    v_mul_u32_u24 v19, 32, v254
    v_add_u32 v19, s4, v19
    s_mov_b32 s31, s98
    s_mov_b32 s33, 0
    s_waitcnt vmcnt(16)
    ds_read_b64_tr_b16 a[0:1], v242 offset:0
    ds_read_b64_tr_b16 a[2:3], v242 offset:256
    ds_read_b64_tr_b16 a[4:5], v242 offset:8
    ds_read_b64_tr_b16 a[6:7], v242 offset:264
    ds_read_b64_tr_b16 a[8:9], v242 offset:2048
    ds_read_b64_tr_b16 a[10:11], v242 offset:2304
    ds_read_b64_tr_b16 a[12:13], v242 offset:2056
    ds_read_b64_tr_b16 a[14:15], v242 offset:2312
    ds_read_b64_tr_b16 a[16:17], v242 offset:4096
    ds_read_b64_tr_b16 a[18:19], v242 offset:4352
    ds_read_b64_tr_b16 a[20:21], v242 offset:4104
    ds_read_b64_tr_b16 a[22:23], v242 offset:4360
    ds_read_b64_tr_b16 a[24:25], v242 offset:6144
    ds_read_b64_tr_b16 a[26:27], v242 offset:6400
    ds_read_b64_tr_b16 a[28:29], v242 offset:6152
    ds_read_b64_tr_b16 a[30:31], v242 offset:6408
    ds_read_b64_tr_b16 a[32:33], v242 offset:8192
    ds_read_b64_tr_b16 a[34:35], v242 offset:8448
    ds_read_b64_tr_b16 a[36:37], v242 offset:8200
    ds_read_b64_tr_b16 a[38:39], v242 offset:8456
    ds_read_b64_tr_b16 a[40:41], v242 offset:10240
    ds_read_b64_tr_b16 a[42:43], v242 offset:10496
    ds_read_b64_tr_b16 a[44:45], v242 offset:10248
    ds_read_b64_tr_b16 a[46:47], v242 offset:10504
    ds_read_b64_tr_b16 a[48:49], v242 offset:12288
    ds_read_b64_tr_b16 a[50:51], v242 offset:12544
    ds_read_b64_tr_b16 a[52:53], v242 offset:12296
    ds_read_b64_tr_b16 a[54:55], v242 offset:12552
    ds_read_b64_tr_b16 a[56:57], v242 offset:14336
    ds_read_b64_tr_b16 a[58:59], v242 offset:14592
    ds_read_b64_tr_b16 a[60:61], v242 offset:14344
    ds_read_b64_tr_b16 a[62:63], v242 offset:14600
    s_waitcnt lgkmcnt(0)
    s_add_u32 m0, s6, 0
    s_mov_b32 s5, 1048576
    buffer_load_dwordx4 v240, s[16:19], s5 offen lds
    s_add_u32 m0, s6, 1024
    s_mov_b32 s5, 1081344
    buffer_load_dwordx4 v240, s[16:19], s5 offen lds
    s_add_u32 m0, s6, 2048
    s_mov_b32 s5, 1114112
    buffer_load_dwordx4 v240, s[16:19], s5 offen lds
    s_add_u32 m0, s6, 3072
    s_mov_b32 s5, 1146880
    buffer_load_dwordx4 v240, s[16:19], s5 offen lds
    s_add_u32 m0, s6, 4096
    s_mov_b32 s5, 1179648
    buffer_load_dwordx4 v240, s[16:19], s5 offen lds
    s_add_u32 m0, s6, 5120
    s_mov_b32 s5, 1212416
    buffer_load_dwordx4 v240, s[16:19], s5 offen lds
    s_add_u32 m0, s6, 6144
    s_mov_b32 s5, 1245184
    buffer_load_dwordx4 v240, s[16:19], s5 offen lds
    s_add_u32 m0, s6, 7168
    s_mov_b32 s5, 1277952
    buffer_load_dwordx4 v240, s[16:19], s5 offen lds
    s_add_u32 m0, s6, 8192
    s_mov_b32 s5, 1310720
    buffer_load_dwordx4 v240, s[16:19], s5 offen lds
    s_add_u32 m0, s6, 9216
    s_mov_b32 s5, 1343488
    buffer_load_dwordx4 v240, s[16:19], s5 offen lds
    s_add_u32 m0, s6, 10240
    s_mov_b32 s5, 1376256
    buffer_load_dwordx4 v240, s[16:19], s5 offen lds
    s_add_u32 m0, s6, 11264
    s_mov_b32 s5, 1409024
    buffer_load_dwordx4 v240, s[16:19], s5 offen lds
    s_add_u32 m0, s6, 12288
    s_mov_b32 s5, 1441792
    buffer_load_dwordx4 v240, s[16:19], s5 offen lds
    s_add_u32 m0, s6, 13312
    s_mov_b32 s5, 1474560
    buffer_load_dwordx4 v240, s[16:19], s5 offen lds
    s_add_u32 m0, s6, 14336
    s_mov_b32 s5, 1507328
    buffer_load_dwordx4 v240, s[16:19], s5 offen lds
    s_add_u32 m0, s6, 15360
    s_mov_b32 s5, 1540096
    buffer_load_dwordx4 v240, s[16:19], s5 offen lds
    s_waitcnt vmcnt(16)
    ds_read_b64_tr_b16 a[64:65], v243 offset:0
    ds_read_b64_tr_b16 a[66:67], v243 offset:256
    ds_read_b64_tr_b16 a[68:69], v243 offset:8
    ds_read_b64_tr_b16 a[70:71], v243 offset:264
    ds_read_b64_tr_b16 a[72:73], v243 offset:2048
    ds_read_b64_tr_b16 a[74:75], v243 offset:2304
    ds_read_b64_tr_b16 a[76:77], v243 offset:2056
    ds_read_b64_tr_b16 a[78:79], v243 offset:2312
    ds_read_b64_tr_b16 a[80:81], v243 offset:4096
    ds_read_b64_tr_b16 a[82:83], v243 offset:4352
    ds_read_b64_tr_b16 a[84:85], v243 offset:4104
    ds_read_b64_tr_b16 a[86:87], v243 offset:4360
    ds_read_b64_tr_b16 a[88:89], v243 offset:6144
    ds_read_b64_tr_b16 a[90:91], v243 offset:6400
    ds_read_b64_tr_b16 a[92:93], v243 offset:6152
    ds_read_b64_tr_b16 a[94:95], v243 offset:6408
    ds_read_b64_tr_b16 a[96:97], v243 offset:8192
    ds_read_b64_tr_b16 a[98:99], v243 offset:8448
    ds_read_b64_tr_b16 a[100:101], v243 offset:8200
    ds_read_b64_tr_b16 a[102:103], v243 offset:8456
    ds_read_b64_tr_b16 a[104:105], v243 offset:10240
    ds_read_b64_tr_b16 a[106:107], v243 offset:10496
    ds_read_b64_tr_b16 a[108:109], v243 offset:10248
    ds_read_b64_tr_b16 a[110:111], v243 offset:10504
    ds_read_b64_tr_b16 a[112:113], v243 offset:12288
    ds_read_b64_tr_b16 a[114:115], v243 offset:12544
    ds_read_b64_tr_b16 a[116:117], v243 offset:12296
    ds_read_b64_tr_b16 a[118:119], v243 offset:12552
    ds_read_b64_tr_b16 a[120:121], v243 offset:14336
    ds_read_b64_tr_b16 a[122:123], v243 offset:14592
    ds_read_b64_tr_b16 a[124:125], v243 offset:14344
    ds_read_b64_tr_b16 a[126:127], v243 offset:14600
    s_waitcnt lgkmcnt(0)
    s_add_u32 m0, s6, 65536
    s_mov_b32 s5, 1572864
    buffer_load_dwordx4 v240, s[16:19], s5 offen lds
    s_add_u32 m0, s6, 66560
    s_mov_b32 s5, 1605632
    buffer_load_dwordx4 v240, s[16:19], s5 offen lds
    s_add_u32 m0, s6, 67584
    s_mov_b32 s5, 1638400
    buffer_load_dwordx4 v240, s[16:19], s5 offen lds
    s_add_u32 m0, s6, 68608
    s_mov_b32 s5, 1671168
    buffer_load_dwordx4 v240, s[16:19], s5 offen lds
    s_add_u32 m0, s6, 69632
    s_mov_b32 s5, 1703936
    buffer_load_dwordx4 v240, s[16:19], s5 offen lds
    s_add_u32 m0, s6, 70656
    s_mov_b32 s5, 1736704
    buffer_load_dwordx4 v240, s[16:19], s5 offen lds
    s_add_u32 m0, s6, 71680
    s_mov_b32 s5, 1769472
    buffer_load_dwordx4 v240, s[16:19], s5 offen lds
    s_add_u32 m0, s6, 72704
    s_mov_b32 s5, 1802240
    buffer_load_dwordx4 v240, s[16:19], s5 offen lds
    s_add_u32 m0, s6, 73728
    s_mov_b32 s5, 1835008
    buffer_load_dwordx4 v240, s[16:19], s5 offen lds
    s_add_u32 m0, s6, 74752
    s_mov_b32 s5, 1867776
    buffer_load_dwordx4 v240, s[16:19], s5 offen lds
    s_add_u32 m0, s6, 75776
    s_mov_b32 s5, 1900544
    buffer_load_dwordx4 v240, s[16:19], s5 offen lds
    s_add_u32 m0, s6, 76800
    s_mov_b32 s5, 1933312
    buffer_load_dwordx4 v240, s[16:19], s5 offen lds
    s_add_u32 m0, s6, 77824
    s_mov_b32 s5, 1966080
    buffer_load_dwordx4 v240, s[16:19], s5 offen lds
    s_add_u32 m0, s6, 78848
    s_mov_b32 s5, 1998848
    buffer_load_dwordx4 v240, s[16:19], s5 offen lds
    s_add_u32 m0, s6, 79872
    s_mov_b32 s5, 2031616
    buffer_load_dwordx4 v240, s[16:19], s5 offen lds
    s_add_u32 m0, s6, 80896
    s_mov_b32 s5, 2064384
    buffer_load_dwordx4 v240, s[16:19], s5 offen lds
    s_waitcnt vmcnt(16)
    ds_read_b64_tr_b16 a[128:129], v242 offset:0
    ds_read_b64_tr_b16 a[130:131], v242 offset:256
    ds_read_b64_tr_b16 a[132:133], v242 offset:8
    ds_read_b64_tr_b16 a[134:135], v242 offset:264
    ds_read_b64_tr_b16 a[136:137], v242 offset:2048
    ds_read_b64_tr_b16 a[138:139], v242 offset:2304
    ds_read_b64_tr_b16 a[140:141], v242 offset:2056
    ds_read_b64_tr_b16 a[142:143], v242 offset:2312
    ds_read_b64_tr_b16 a[144:145], v242 offset:4096
    ds_read_b64_tr_b16 a[146:147], v242 offset:4352
    ds_read_b64_tr_b16 a[148:149], v242 offset:4104
    ds_read_b64_tr_b16 a[150:151], v242 offset:4360
    ds_read_b64_tr_b16 a[152:153], v242 offset:6144
    ds_read_b64_tr_b16 a[154:155], v242 offset:6400
    ds_read_b64_tr_b16 a[156:157], v242 offset:6152
    ds_read_b64_tr_b16 a[158:159], v242 offset:6408
    ds_read_b64_tr_b16 a[160:161], v242 offset:8192
    ds_read_b64_tr_b16 a[162:163], v242 offset:8448
    ds_read_b64_tr_b16 a[164:165], v242 offset:8200
    ds_read_b64_tr_b16 a[166:167], v242 offset:8456
    ds_read_b64_tr_b16 a[168:169], v242 offset:10240
    ds_read_b64_tr_b16 a[170:171], v242 offset:10496
    ds_read_b64_tr_b16 a[172:173], v242 offset:10248
    ds_read_b64_tr_b16 a[174:175], v242 offset:10504
    ds_read_b64_tr_b16 a[176:177], v242 offset:12288
    ds_read_b64_tr_b16 a[178:179], v242 offset:12544
    ds_read_b64_tr_b16 a[180:181], v242 offset:12296
    ds_read_b64_tr_b16 a[182:183], v242 offset:12552
    ds_read_b64_tr_b16 a[184:185], v242 offset:14336
    ds_read_b64_tr_b16 a[186:187], v242 offset:14592
    ds_read_b64_tr_b16 a[188:189], v242 offset:14344
    ds_read_b64_tr_b16 a[190:191], v242 offset:14600
    s_waitcnt lgkmcnt(0)
    s_waitcnt vmcnt(0)
    ds_read_b64_tr_b16 a[192:193], v243 offset:0
    ds_read_b64_tr_b16 a[194:195], v243 offset:256
    ds_read_b64_tr_b16 a[196:197], v243 offset:8
    ds_read_b64_tr_b16 a[198:199], v243 offset:264
    ds_read_b64_tr_b16 a[200:201], v243 offset:2048
    ds_read_b64_tr_b16 a[202:203], v243 offset:2304
    ds_read_b64_tr_b16 a[204:205], v243 offset:2056
    ds_read_b64_tr_b16 a[206:207], v243 offset:2312
    ds_read_b64_tr_b16 a[208:209], v243 offset:4096
    ds_read_b64_tr_b16 a[210:211], v243 offset:4352
    ds_read_b64_tr_b16 a[212:213], v243 offset:4104
    ds_read_b64_tr_b16 a[214:215], v243 offset:4360
    ds_read_b64_tr_b16 a[216:217], v243 offset:6144
    ds_read_b64_tr_b16 a[218:219], v243 offset:6400
    ds_read_b64_tr_b16 a[220:221], v243 offset:6152
    ds_read_b64_tr_b16 a[222:223], v243 offset:6408
    ds_read_b64_tr_b16 a[224:225], v243 offset:8192
    ds_read_b64_tr_b16 a[226:227], v243 offset:8448
    ds_read_b64_tr_b16 a[228:229], v243 offset:8200
    ds_read_b64_tr_b16 a[230:231], v243 offset:8456
    ds_read_b64_tr_b16 a[232:233], v243 offset:10240
    ds_read_b64_tr_b16 a[234:235], v243 offset:10496
    ds_read_b64_tr_b16 a[236:237], v243 offset:10248
    ds_read_b64_tr_b16 a[238:239], v243 offset:10504
    ds_read_b64_tr_b16 a[240:241], v243 offset:12288
    ds_read_b64_tr_b16 a[242:243], v243 offset:12544
    ds_read_b64_tr_b16 a[244:245], v243 offset:12296
    ds_read_b64_tr_b16 a[246:247], v243 offset:12552
    ds_read_b64_tr_b16 a[248:249], v243 offset:14336
    ds_read_b64_tr_b16 a[250:251], v243 offset:14592
    ds_read_b64_tr_b16 a[252:253], v243 offset:14344
    ds_read_b64_tr_b16 a[254:255], v243 offset:14600
    s_waitcnt lgkmcnt(0)
    s_mov_b32 s62, 0
    v_mov_b32 v5, 0
.wc_234:
    buffer_load_dword v4, v5, s[20:23], 0 offen offset:36 sc1
    s_add_u32 s62, s62, 1
    s_cmp_gt_u32 s62, 0x200000
    s_cbranch_scc1 .mg_end_1
    s_waitcnt vmcnt(0)
    v_readfirstlane_b32 s4, v4
    s_cmp_ge_u32 s4, 128
    s_cbranch_scc1 .wd_235
    s_sleep 8
    s_branch .wc_234
.wd_235:
    s_mov_b32 s62, 0
    v_mov_b32 v5, 0
.wc_236:
    buffer_load_dword v4, v5, s[20:23], 0 offen offset:44 sc1
    s_add_u32 s62, s62, 1
    s_cmp_gt_u32 s62, 0x200000
    s_cbranch_scc1 .mg_end_1
    s_waitcnt vmcnt(0)
    v_readfirstlane_b32 s4, v4
    s_cmp_ge_u32 s4, 32
    s_cbranch_scc1 .wd_237
    s_sleep 8
    s_branch .wc_236
.wd_237:
    s_barrier
.cold_238:
    s_mov_b32 s62, 0
.gp_241:
    buffer_load_dwordx2 v[4:5], v8, s[8:11], 0 offen sc1
    s_add_u32 s62, s62, 1
    s_cmp_gt_u32 s62, 0x200000
    s_cbranch_scc1 .mg_end_1
    s_waitcnt vmcnt(0)
    v_min_u32 v4, v4, v5
    s_nop 1
    v_min_u32_dpp v4, v4, v4 quad_perm:[1,0,3,2] row_mask:0xf bank_mask:0xf
    s_nop 1
    v_min_u32_dpp v4, v4, v4 quad_perm:[2,3,0,1] row_mask:0xf bank_mask:0xf
    s_nop 1
    v_min_u32_dpp v4, v4, v4 row_half_mirror row_mask:0xf bank_mask:0xf
    s_nop 1
    v_min_u32_dpp v4, v4, v4 row_mirror row_mask:0xf bank_mask:0xf
    s_nop 1
    v_readfirstlane_b32 s33, v4
    s_cmp_gt_u32 s33, s31
    s_cbranch_scc1 .gd_242
    s_sleep 2
    s_branch .gp_241
.gd_242:
    s_lshl_b32 s57, s31, 16
    s_and_b32 s4, s31, 31
    s_lshl_b32 s4, s4, 4
    s_lshr_b32 s5, s31, 5
    s_lshl_b32 s5, s5, 11
    s_add_u32 s58, s4, s5
    s_add_u32 s58, s58, 130023424
    s_lshl_b32 s59, s31, 7
    s_add_u32 s59, s59, 121634816
    s_lshl_b32 s48, s31, 18
    s_add_u32 s4, s31, 4
    s_min_u32 s4, s4, s33
    s_sub_u32 s4, s4, 1
    s_lshl_b32 s4, s4, 18
    buffer_load_dword v6, v19, s[8:11], s48 offen
    buffer_load_dword v7, v19, s[8:11], s4 offen
    buffer_load_dwordx2 v[4:5], v8, s[8:11], 0 offen sc1
    buffer_load_dwordx2 v[208:209], v13, s[12:15], s57 offen
    buffer_load_dword v214, v18, s[8:11], s59 offen
    s_add_u32 s48, s48, 50331648
    buffer_load_ushort v210, v14, s[8:11], s58 offen
    buffer_load_ushort v211, v15, s[8:11], s58 offen
    buffer_load_ushort v212, v16, s[8:11], s58 offen
    buffer_load_ushort v213, v17, s[8:11], s58 offen
    s_add_u32 s49, s48, 4096
    s_add_u32 s50, s48, 8192
    s_add_u32 s51, s48, 12288
    s_add_u32 s52, s48, 16384
    s_add_u32 s53, s48, 20480
    s_add_u32 s54, s48, 24576
    s_add_u32 s55, s48, 28672
    buffer_load_dwordx4 v[64:67], v9, s[8:11], s48 offen offset:0
    buffer_load_dwordx4 v[68:71], v10, s[8:11], s48 offen offset:0
    buffer_load_dwordx4 v[72:75], v9, s[8:11], s48 offen offset:1024
    buffer_load_dwordx4 v[76:79], v10, s[8:11], s48 offen offset:1024
    buffer_load_dwordx4 v[80:83], v9, s[8:11], s48 offen offset:2048
    buffer_load_dwordx4 v[84:87], v10, s[8:11], s48 offen offset:2048
    buffer_load_dwordx4 v[88:91], v9, s[8:11], s48 offen offset:3072
    buffer_load_dwordx4 v[92:95], v10, s[8:11], s48 offen offset:3072
    buffer_load_dwordx4 v[96:99], v9, s[8:11], s49 offen offset:0
    buffer_load_dwordx4 v[100:103], v10, s[8:11], s49 offen offset:0
    buffer_load_dwordx4 v[104:107], v9, s[8:11], s49 offen offset:1024
    buffer_load_dwordx4 v[108:111], v10, s[8:11], s49 offen offset:1024
    buffer_load_dwordx4 v[112:115], v9, s[8:11], s49 offen offset:2048
    buffer_load_dwordx4 v[116:119], v10, s[8:11], s49 offen offset:2048
    buffer_load_dwordx4 v[120:123], v9, s[8:11], s49 offen offset:3072
    buffer_load_dwordx4 v[124:127], v10, s[8:11], s49 offen offset:3072
    buffer_load_dwordx4 v[128:131], v9, s[8:11], s50 offen offset:0
    buffer_load_dwordx4 v[132:135], v10, s[8:11], s50 offen offset:0
    buffer_load_dwordx4 v[136:139], v9, s[8:11], s50 offen offset:1024
    buffer_load_dwordx4 v[140:143], v10, s[8:11], s50 offen offset:1024
    buffer_load_dwordx4 v[144:147], v9, s[8:11], s50 offen offset:2048
    buffer_load_dwordx4 v[148:151], v10, s[8:11], s50 offen offset:2048
    buffer_load_dwordx4 v[152:155], v9, s[8:11], s50 offen offset:3072
    buffer_load_dwordx4 v[156:159], v10, s[8:11], s50 offen offset:3072
    buffer_load_dwordx4 v[160:163], v9, s[8:11], s51 offen offset:0
    buffer_load_dwordx4 v[164:167], v10, s[8:11], s51 offen offset:0
    buffer_load_dwordx4 v[168:171], v9, s[8:11], s51 offen offset:1024
    buffer_load_dwordx4 v[172:175], v10, s[8:11], s51 offen offset:1024
    buffer_load_dwordx4 v[176:179], v9, s[8:11], s51 offen offset:2048
    buffer_load_dwordx4 v[180:183], v10, s[8:11], s51 offen offset:2048
    buffer_load_dwordx4 v[184:187], v9, s[8:11], s51 offen offset:3072
    buffer_load_dwordx4 v[188:191], v10, s[8:11], s51 offen offset:3072
.main_239:
    s_waitcnt vmcnt(31)
    v_mfma_f32_16x16x32_bf16 v[192:195], a[0:3], v[64:67], 0
    v_mfma_f32_16x16x32_bf16 v[196:199], a[4:7], v[64:67], 0
    buffer_load_dwordx4 v[64:67], v9, s[8:11], s52 offen offset:0
    v_lshlrev_b32 v216, 16, v208
    s_waitcnt vmcnt(31)
    v_mfma_f32_16x16x32_bf16 v[200:203], a[0:3], v[68:71], 0
    v_mfma_f32_16x16x32_bf16 v[204:207], a[4:7], v[68:71], 0
    buffer_load_dwordx4 v[68:71], v10, s[8:11], s52 offen offset:0
    v_and_b32 v217, 0xffff0000, v208
    s_waitcnt vmcnt(31)
    v_mfma_f32_16x16x32_bf16 v[192:195], a[8:11], v[72:75], v[192:195]
    v_mfma_f32_16x16x32_bf16 v[196:199], a[12:15], v[72:75], v[196:199]
    buffer_load_dwordx4 v[72:75], v9, s[8:11], s52 offen offset:1024
    v_lshlrev_b32 v218, 16, v209
    s_waitcnt vmcnt(31)
    v_mfma_f32_16x16x32_bf16 v[200:203], a[8:11], v[76:79], v[200:203]
    v_mfma_f32_16x16x32_bf16 v[204:207], a[12:15], v[76:79], v[204:207]
    buffer_load_dwordx4 v[76:79], v10, s[8:11], s52 offen offset:1024
    v_and_b32 v219, 0xffff0000, v209
    s_waitcnt vmcnt(31)
    v_mfma_f32_16x16x32_bf16 v[192:195], a[16:19], v[80:83], v[192:195]
    v_mfma_f32_16x16x32_bf16 v[196:199], a[20:23], v[80:83], v[196:199]
    buffer_load_dwordx4 v[80:83], v9, s[8:11], s52 offen offset:2048
    v_lshlrev_b32 v210, 16, v210
    s_waitcnt vmcnt(31)
    v_mfma_f32_16x16x32_bf16 v[200:203], a[16:19], v[84:87], v[200:203]
    v_mfma_f32_16x16x32_bf16 v[204:207], a[20:23], v[84:87], v[204:207]
    buffer_load_dwordx4 v[84:87], v10, s[8:11], s52 offen offset:2048
    v_lshlrev_b32 v211, 16, v211
    s_waitcnt vmcnt(31)
    v_mfma_f32_16x16x32_bf16 v[192:195], a[24:27], v[88:91], v[192:195]
    v_mfma_f32_16x16x32_bf16 v[196:199], a[28:31], v[88:91], v[196:199]
    buffer_load_dwordx4 v[88:91], v9, s[8:11], s52 offen offset:3072
    v_lshlrev_b32 v212, 16, v212
    s_waitcnt vmcnt(31)
    v_mfma_f32_16x16x32_bf16 v[200:203], a[24:27], v[92:95], v[200:203]
    v_mfma_f32_16x16x32_bf16 v[204:207], a[28:31], v[92:95], v[204:207]
    buffer_load_dwordx4 v[92:95], v10, s[8:11], s52 offen offset:3072
    v_lshlrev_b32 v213, 16, v213
    s_waitcnt vmcnt(31)
    v_mfma_f32_16x16x32_bf16 v[192:195], a[32:35], v[96:99], v[192:195]
    v_mfma_f32_16x16x32_bf16 v[196:199], a[36:39], v[96:99], v[196:199]
    buffer_load_dwordx4 v[96:99], v9, s[8:11], s53 offen offset:0
    v_mul_f32 v216, v216, v210
    s_waitcnt vmcnt(31)
    v_mfma_f32_16x16x32_bf16 v[200:203], a[32:35], v[100:103], v[200:203]
    v_mfma_f32_16x16x32_bf16 v[204:207], a[36:39], v[100:103], v[204:207]
    buffer_load_dwordx4 v[100:103], v10, s[8:11], s53 offen offset:0
    v_mul_f32 v217, v217, v211
    s_waitcnt vmcnt(31)
    v_mfma_f32_16x16x32_bf16 v[192:195], a[40:43], v[104:107], v[192:195]
    v_mfma_f32_16x16x32_bf16 v[196:199], a[44:47], v[104:107], v[196:199]
    buffer_load_dwordx4 v[104:107], v9, s[8:11], s53 offen offset:1024
    v_mul_f32 v218, v218, v212
    s_waitcnt vmcnt(31)
    v_mfma_f32_16x16x32_bf16 v[200:203], a[40:43], v[108:111], v[200:203]
    v_mfma_f32_16x16x32_bf16 v[204:207], a[44:47], v[108:111], v[204:207]
    buffer_load_dwordx4 v[108:111], v10, s[8:11], s53 offen offset:1024
    v_mul_f32 v219, v219, v213
    s_waitcnt vmcnt(31)
    v_mfma_f32_16x16x32_bf16 v[192:195], a[48:51], v[112:115], v[192:195]
    v_mfma_f32_16x16x32_bf16 v[196:199], a[52:55], v[112:115], v[196:199]
    buffer_load_dwordx4 v[112:115], v9, s[8:11], s53 offen offset:2048
    v_mul_f32 v216, v216, v214
    s_waitcnt vmcnt(31)
    v_mfma_f32_16x16x32_bf16 v[200:203], a[48:51], v[116:119], v[200:203]
    v_mfma_f32_16x16x32_bf16 v[204:207], a[52:55], v[116:119], v[204:207]
    buffer_load_dwordx4 v[116:119], v10, s[8:11], s53 offen offset:2048
    v_mul_f32 v217, v217, v214
    s_waitcnt vmcnt(31)
    v_mfma_f32_16x16x32_bf16 v[192:195], a[56:59], v[120:123], v[192:195]
    v_mfma_f32_16x16x32_bf16 v[196:199], a[60:63], v[120:123], v[196:199]
    buffer_load_dwordx4 v[120:123], v9, s[8:11], s53 offen offset:3072
    v_mul_f32 v218, v218, v214
    s_waitcnt vmcnt(31)
    v_mfma_f32_16x16x32_bf16 v[200:203], a[56:59], v[124:127], v[200:203]
    v_mfma_f32_16x16x32_bf16 v[204:207], a[60:63], v[124:127], v[204:207]
    buffer_load_dwordx4 v[124:127], v10, s[8:11], s53 offen offset:3072
    v_mul_f32 v219, v219, v214
    s_waitcnt vmcnt(31)
    v_mfma_f32_16x16x32_bf16 v[192:195], a[64:67], v[128:131], v[192:195]
    v_mfma_f32_16x16x32_bf16 v[196:199], a[68:71], v[128:131], v[196:199]
    buffer_load_dwordx4 v[128:131], v9, s[8:11], s54 offen offset:0
    v_sub_f32 v220, 1.0, v214
    s_waitcnt vmcnt(31)
    v_mfma_f32_16x16x32_bf16 v[200:203], a[64:67], v[132:135], v[200:203]
    v_mfma_f32_16x16x32_bf16 v[204:207], a[68:71], v[132:135], v[204:207]
    buffer_load_dwordx4 v[132:135], v10, s[8:11], s54 offen offset:0
    s_mov_b32 s56, s57
    s_waitcnt vmcnt(31)
    v_mfma_f32_16x16x32_bf16 v[192:195], a[72:75], v[136:139], v[192:195]
    v_mfma_f32_16x16x32_bf16 v[196:199], a[76:79], v[136:139], v[196:199]
    buffer_load_dwordx4 v[136:139], v9, s[8:11], s54 offen offset:1024
    s_add_u32 s30, s31, 3
    s_waitcnt vmcnt(31)
    v_mfma_f32_16x16x32_bf16 v[200:203], a[72:75], v[140:143], v[200:203]
    v_mfma_f32_16x16x32_bf16 v[204:207], a[76:79], v[140:143], v[204:207]
    buffer_load_dwordx4 v[140:143], v10, s[8:11], s54 offen offset:1024
    s_waitcnt vmcnt(31)
    v_mfma_f32_16x16x32_bf16 v[192:195], a[80:83], v[144:147], v[192:195]
    v_mfma_f32_16x16x32_bf16 v[196:199], a[84:87], v[144:147], v[196:199]
    buffer_load_dwordx4 v[144:147], v9, s[8:11], s54 offen offset:2048
    s_waitcnt vmcnt(31)
    v_mfma_f32_16x16x32_bf16 v[200:203], a[80:83], v[148:151], v[200:203]
    v_mfma_f32_16x16x32_bf16 v[204:207], a[84:87], v[148:151], v[204:207]
    buffer_load_dwordx4 v[148:151], v10, s[8:11], s54 offen offset:2048
    s_waitcnt vmcnt(31)
    v_mfma_f32_16x16x32_bf16 v[192:195], a[88:91], v[152:155], v[192:195]
    v_mfma_f32_16x16x32_bf16 v[196:199], a[92:95], v[152:155], v[196:199]
    buffer_load_dwordx4 v[152:155], v9, s[8:11], s54 offen offset:3072
    s_waitcnt vmcnt(31)
    v_mfma_f32_16x16x32_bf16 v[200:203], a[88:91], v[156:159], v[200:203]
    v_mfma_f32_16x16x32_bf16 v[204:207], a[92:95], v[156:159], v[204:207]
    buffer_load_dwordx4 v[156:159], v10, s[8:11], s54 offen offset:3072
    s_waitcnt vmcnt(31)
    v_mfma_f32_16x16x32_bf16 v[192:195], a[96:99], v[160:163], v[192:195]
    v_mfma_f32_16x16x32_bf16 v[196:199], a[100:103], v[160:163], v[196:199]
    buffer_load_dwordx4 v[160:163], v9, s[8:11], s55 offen offset:0
    v_min_u32 v4, v4, v5
    s_nop 1
    v_min_u32_dpp v4, v4, v4 quad_perm:[1,0,3,2] row_mask:0xf bank_mask:0xf
    s_nop 1
    v_min_u32_dpp v4, v4, v4 quad_perm:[2,3,0,1] row_mask:0xf bank_mask:0xf
    s_nop 1
    v_min_u32_dpp v4, v4, v4 row_half_mirror row_mask:0xf bank_mask:0xf
    s_nop 1
    v_min_u32_dpp v4, v4, v4 row_mirror row_mask:0xf bank_mask:0xf
    s_nop 1
    v_readfirstlane_b32 s33, v4
    s_waitcnt vmcnt(31)
    v_mfma_f32_16x16x32_bf16 v[200:203], a[96:99], v[164:167], v[200:203]
    v_mfma_f32_16x16x32_bf16 v[204:207], a[100:103], v[164:167], v[204:207]
    buffer_load_dwordx4 v[164:167], v10, s[8:11], s55 offen offset:0
    s_waitcnt vmcnt(31)
    v_mfma_f32_16x16x32_bf16 v[192:195], a[104:107], v[168:171], v[192:195]
    v_mfma_f32_16x16x32_bf16 v[196:199], a[108:111], v[168:171], v[196:199]
    buffer_load_dwordx4 v[168:171], v9, s[8:11], s55 offen offset:1024
    s_waitcnt vmcnt(31)
    v_mfma_f32_16x16x32_bf16 v[200:203], a[104:107], v[172:175], v[200:203]
    v_mfma_f32_16x16x32_bf16 v[204:207], a[108:111], v[172:175], v[204:207]
    buffer_load_dwordx4 v[172:175], v10, s[8:11], s55 offen offset:1024
    s_waitcnt vmcnt(31)
    v_mfma_f32_16x16x32_bf16 v[192:195], a[112:115], v[176:179], v[192:195]
    v_mfma_f32_16x16x32_bf16 v[196:199], a[116:119], v[176:179], v[196:199]
    buffer_load_dwordx4 v[176:179], v9, s[8:11], s55 offen offset:2048
    s_waitcnt vmcnt(31)
    v_mfma_f32_16x16x32_bf16 v[200:203], a[112:115], v[180:183], v[200:203]
    v_mfma_f32_16x16x32_bf16 v[204:207], a[116:119], v[180:183], v[204:207]
    buffer_load_dwordx4 v[180:183], v10, s[8:11], s55 offen offset:2048
    s_waitcnt vmcnt(31)
    v_mfma_f32_16x16x32_bf16 v[192:195], a[120:123], v[184:187], v[192:195]
    v_mfma_f32_16x16x32_bf16 v[196:199], a[124:127], v[184:187], v[196:199]
    buffer_load_dwordx4 v[184:187], v9, s[8:11], s55 offen offset:3072
    s_waitcnt vmcnt(31)
    v_mfma_f32_16x16x32_bf16 v[200:203], a[120:123], v[188:191], v[200:203]
    v_mfma_f32_16x16x32_bf16 v[204:207], a[124:127], v[188:191], v[204:207]
    buffer_load_dwordx4 v[188:191], v10, s[8:11], s55 offen offset:3072
    s_cmp_gt_u32 s33, s30
    s_cbranch_scc0 .drain_240
    s_lshl_b32 s57, s30, 16
    s_and_b32 s4, s30, 31
    s_lshl_b32 s4, s4, 4
    s_lshr_b32 s5, s30, 5
    s_lshl_b32 s5, s5, 11
    s_add_u32 s58, s4, s5
    s_add_u32 s58, s58, 130023424
    s_lshl_b32 s59, s30, 7
    s_add_u32 s59, s59, 121634816
    s_lshl_b32 s48, s30, 18
    s_add_u32 s4, s30, 4
    s_min_u32 s4, s4, s33
    s_sub_u32 s4, s4, 1
    s_lshl_b32 s4, s4, 18
    buffer_load_dword v6, v19, s[8:11], s48 offen
    buffer_load_dword v7, v19, s[8:11], s4 offen
    buffer_load_dwordx2 v[4:5], v8, s[8:11], 0 offen sc1
    buffer_load_dwordx2 v[208:209], v13, s[12:15], s57 offen
    buffer_load_dword v214, v18, s[8:11], s59 offen
    s_add_u32 s48, s48, 50331648
    buffer_load_ushort v210, v14, s[8:11], s58 offen
    buffer_load_ushort v211, v15, s[8:11], s58 offen
    buffer_load_ushort v212, v16, s[8:11], s58 offen
    buffer_load_ushort v213, v17, s[8:11], s58 offen
    s_add_u32 s49, s48, 4096
    s_add_u32 s50, s48, 8192
    s_add_u32 s51, s48, 12288
    s_add_u32 s52, s48, 16384
    s_add_u32 s53, s48, 20480
    s_add_u32 s54, s48, 24576
    s_add_u32 s55, s48, 28672
    s_waitcnt vmcnt(40)
    v_mfma_f32_16x16x32_bf16 v[192:195], a[128:131], v[64:67], v[192:195]
    v_mfma_f32_16x16x32_bf16 v[196:199], a[132:135], v[64:67], v[196:199]
    buffer_load_dwordx4 v[64:67], v9, s[8:11], s48 offen offset:0
    s_waitcnt vmcnt(40)
    v_mfma_f32_16x16x32_bf16 v[200:203], a[128:131], v[68:71], v[200:203]
    v_mfma_f32_16x16x32_bf16 v[204:207], a[132:135], v[68:71], v[204:207]
    buffer_load_dwordx4 v[68:71], v10, s[8:11], s48 offen offset:0
    s_waitcnt vmcnt(40)
    v_mfma_f32_16x16x32_bf16 v[192:195], a[136:139], v[72:75], v[192:195]
    v_mfma_f32_16x16x32_bf16 v[196:199], a[140:143], v[72:75], v[196:199]
    buffer_load_dwordx4 v[72:75], v9, s[8:11], s48 offen offset:1024
    s_waitcnt vmcnt(40)
    v_mfma_f32_16x16x32_bf16 v[200:203], a[136:139], v[76:79], v[200:203]
    v_mfma_f32_16x16x32_bf16 v[204:207], a[140:143], v[76:79], v[204:207]
    buffer_load_dwordx4 v[76:79], v10, s[8:11], s48 offen offset:1024
    s_waitcnt vmcnt(40)
    v_mfma_f32_16x16x32_bf16 v[192:195], a[144:147], v[80:83], v[192:195]
    v_mfma_f32_16x16x32_bf16 v[196:199], a[148:151], v[80:83], v[196:199]
    buffer_load_dwordx4 v[80:83], v9, s[8:11], s48 offen offset:2048
    s_waitcnt vmcnt(40)
    v_mfma_f32_16x16x32_bf16 v[200:203], a[144:147], v[84:87], v[200:203]
    v_mfma_f32_16x16x32_bf16 v[204:207], a[148:151], v[84:87], v[204:207]
    buffer_load_dwordx4 v[84:87], v10, s[8:11], s48 offen offset:2048
    s_waitcnt vmcnt(40)
    v_mfma_f32_16x16x32_bf16 v[192:195], a[152:155], v[88:91], v[192:195]
    v_mfma_f32_16x16x32_bf16 v[196:199], a[156:159], v[88:91], v[196:199]
    buffer_load_dwordx4 v[88:91], v9, s[8:11], s48 offen offset:3072
    s_waitcnt vmcnt(40)
    v_mfma_f32_16x16x32_bf16 v[200:203], a[152:155], v[92:95], v[200:203]
    v_mfma_f32_16x16x32_bf16 v[204:207], a[156:159], v[92:95], v[204:207]
    buffer_load_dwordx4 v[92:95], v10, s[8:11], s48 offen offset:3072
    s_waitcnt vmcnt(40)
    v_mfma_f32_16x16x32_bf16 v[192:195], a[160:163], v[96:99], v[192:195]
    v_mfma_f32_16x16x32_bf16 v[196:199], a[164:167], v[96:99], v[196:199]
    buffer_load_dwordx4 v[96:99], v9, s[8:11], s49 offen offset:0
    s_waitcnt vmcnt(40)
    v_mfma_f32_16x16x32_bf16 v[200:203], a[160:163], v[100:103], v[200:203]
    v_mfma_f32_16x16x32_bf16 v[204:207], a[164:167], v[100:103], v[204:207]
    buffer_load_dwordx4 v[100:103], v10, s[8:11], s49 offen offset:0
    s_waitcnt vmcnt(40)
    v_mfma_f32_16x16x32_bf16 v[192:195], a[168:171], v[104:107], v[192:195]
    v_mfma_f32_16x16x32_bf16 v[196:199], a[172:175], v[104:107], v[196:199]
    buffer_load_dwordx4 v[104:107], v9, s[8:11], s49 offen offset:1024
    s_waitcnt vmcnt(40)
    v_mfma_f32_16x16x32_bf16 v[200:203], a[168:171], v[108:111], v[200:203]
    v_mfma_f32_16x16x32_bf16 v[204:207], a[172:175], v[108:111], v[204:207]
    buffer_load_dwordx4 v[108:111], v10, s[8:11], s49 offen offset:1024
    s_waitcnt vmcnt(40)
    v_mfma_f32_16x16x32_bf16 v[192:195], a[176:179], v[112:115], v[192:195]
    v_mfma_f32_16x16x32_bf16 v[196:199], a[180:183], v[112:115], v[196:199]
    buffer_load_dwordx4 v[112:115], v9, s[8:11], s49 offen offset:2048
    s_waitcnt vmcnt(40)
    v_mfma_f32_16x16x32_bf16 v[200:203], a[176:179], v[116:119], v[200:203]
    v_mfma_f32_16x16x32_bf16 v[204:207], a[180:183], v[116:119], v[204:207]
    buffer_load_dwordx4 v[116:119], v10, s[8:11], s49 offen offset:2048
    s_waitcnt vmcnt(40)
    v_mfma_f32_16x16x32_bf16 v[192:195], a[184:187], v[120:123], v[192:195]
    v_mfma_f32_16x16x32_bf16 v[196:199], a[188:191], v[120:123], v[196:199]
    buffer_load_dwordx4 v[120:123], v9, s[8:11], s49 offen offset:3072
    s_waitcnt vmcnt(40)
    v_mfma_f32_16x16x32_bf16 v[200:203], a[184:187], v[124:127], v[200:203]
    v_mfma_f32_16x16x32_bf16 v[204:207], a[188:191], v[124:127], v[204:207]
    buffer_load_dwordx4 v[124:127], v10, s[8:11], s49 offen offset:3072
    s_waitcnt vmcnt(40)
    v_mfma_f32_16x16x32_bf16 v[192:195], a[192:195], v[128:131], v[192:195]
    v_mfma_f32_16x16x32_bf16 v[196:199], a[196:199], v[128:131], v[196:199]
    buffer_load_dwordx4 v[128:131], v9, s[8:11], s50 offen offset:0
    s_waitcnt vmcnt(40)
    v_mfma_f32_16x16x32_bf16 v[200:203], a[192:195], v[132:135], v[200:203]
    v_mfma_f32_16x16x32_bf16 v[204:207], a[196:199], v[132:135], v[204:207]
    buffer_load_dwordx4 v[132:135], v10, s[8:11], s50 offen offset:0
    s_waitcnt vmcnt(40)
    v_mfma_f32_16x16x32_bf16 v[192:195], a[200:203], v[136:139], v[192:195]
    v_mfma_f32_16x16x32_bf16 v[196:199], a[204:207], v[136:139], v[196:199]
    buffer_load_dwordx4 v[136:139], v9, s[8:11], s50 offen offset:1024
    s_waitcnt vmcnt(40)
    v_mfma_f32_16x16x32_bf16 v[200:203], a[200:203], v[140:143], v[200:203]
    v_mfma_f32_16x16x32_bf16 v[204:207], a[204:207], v[140:143], v[204:207]
    buffer_load_dwordx4 v[140:143], v10, s[8:11], s50 offen offset:1024
    s_waitcnt vmcnt(40)
    v_mfma_f32_16x16x32_bf16 v[192:195], a[208:211], v[144:147], v[192:195]
    v_mfma_f32_16x16x32_bf16 v[196:199], a[212:215], v[144:147], v[196:199]
    buffer_load_dwordx4 v[144:147], v9, s[8:11], s50 offen offset:2048
    s_waitcnt vmcnt(40)
    v_mfma_f32_16x16x32_bf16 v[200:203], a[208:211], v[148:151], v[200:203]
    v_mfma_f32_16x16x32_bf16 v[204:207], a[212:215], v[148:151], v[204:207]
    buffer_load_dwordx4 v[148:151], v10, s[8:11], s50 offen offset:2048
    s_waitcnt vmcnt(40)
    v_mfma_f32_16x16x32_bf16 v[192:195], a[216:219], v[152:155], v[192:195]
    v_mfma_f32_16x16x32_bf16 v[196:199], a[220:223], v[152:155], v[196:199]
    buffer_load_dwordx4 v[152:155], v9, s[8:11], s50 offen offset:3072
    s_waitcnt vmcnt(40)
    v_mfma_f32_16x16x32_bf16 v[200:203], a[216:219], v[156:159], v[200:203]
    v_mfma_f32_16x16x32_bf16 v[204:207], a[220:223], v[156:159], v[204:207]
    buffer_load_dwordx4 v[156:159], v10, s[8:11], s50 offen offset:3072
    s_waitcnt vmcnt(40)
    v_mfma_f32_16x16x32_bf16 v[192:195], a[224:227], v[160:163], v[192:195]
    v_mfma_f32_16x16x32_bf16 v[196:199], a[228:231], v[160:163], v[196:199]
    buffer_load_dwordx4 v[160:163], v9, s[8:11], s51 offen offset:0
    s_waitcnt vmcnt(40)
    v_mfma_f32_16x16x32_bf16 v[200:203], a[224:227], v[164:167], v[200:203]
    v_mfma_f32_16x16x32_bf16 v[204:207], a[228:231], v[164:167], v[204:207]
    buffer_load_dwordx4 v[164:167], v10, s[8:11], s51 offen offset:0
    s_waitcnt vmcnt(40)
    v_mfma_f32_16x16x32_bf16 v[192:195], a[232:235], v[168:171], v[192:195]
    v_mfma_f32_16x16x32_bf16 v[196:199], a[236:239], v[168:171], v[196:199]
    buffer_load_dwordx4 v[168:171], v9, s[8:11], s51 offen offset:1024
    s_waitcnt vmcnt(40)
    v_mfma_f32_16x16x32_bf16 v[200:203], a[232:235], v[172:175], v[200:203]
    v_mfma_f32_16x16x32_bf16 v[204:207], a[236:239], v[172:175], v[204:207]
    buffer_load_dwordx4 v[172:175], v10, s[8:11], s51 offen offset:1024
    s_waitcnt vmcnt(40)
    v_mfma_f32_16x16x32_bf16 v[192:195], a[240:243], v[176:179], v[192:195]
    v_mfma_f32_16x16x32_bf16 v[196:199], a[244:247], v[176:179], v[196:199]
    buffer_load_dwordx4 v[176:179], v9, s[8:11], s51 offen offset:2048
    s_waitcnt vmcnt(40)
    v_mfma_f32_16x16x32_bf16 v[200:203], a[240:243], v[180:183], v[200:203]
    v_mfma_f32_16x16x32_bf16 v[204:207], a[244:247], v[180:183], v[204:207]
    buffer_load_dwordx4 v[180:183], v10, s[8:11], s51 offen offset:2048
    s_waitcnt vmcnt(40)
    v_mfma_f32_16x16x32_bf16 v[192:195], a[248:251], v[184:187], v[192:195]
    v_mfma_f32_16x16x32_bf16 v[196:199], a[252:255], v[184:187], v[196:199]
    buffer_load_dwordx4 v[184:187], v9, s[8:11], s51 offen offset:3072
    s_waitcnt vmcnt(40)
    v_mfma_f32_16x16x32_bf16 v[200:203], a[248:251], v[188:191], v[200:203]
    v_mfma_f32_16x16x32_bf16 v[204:207], a[252:255], v[188:191], v[204:207]
    buffer_load_dwordx4 v[188:191], v10, s[8:11], s51 offen offset:3072
    s_nop 5
    ds_write_b128 v11, v[192:195] offset:0
    ds_write_b128 v11, v[196:199] offset:1024
    ds_write_b128 v11, v[200:203] offset:2048
    ds_write_b128 v11, v[204:207] offset:3072
    s_waitcnt lgkmcnt(0)
    s_barrier
    ds_read_b128 v[224:227], v12 offset:0
    ds_read_b128 v[228:231], v12 offset:4096
    ds_read_b128 v[232:235], v12 offset:8192
    ds_read_b128 v[236:239], v12 offset:12288
    v_xor_b32 v11, 0x4000, v11
    v_xor_b32 v12, 0x4000, v12
    s_waitcnt lgkmcnt(2)
    v_add_f32 v224, v224, v228
    v_add_f32 v225, v225, v229
    v_add_f32 v226, v226, v230
    v_add_f32 v227, v227, v231
    s_waitcnt lgkmcnt(0)
    v_add_f32 v232, v232, v236
    v_add_f32 v233, v233, v237
    v_add_f32 v234, v234, v238
    v_add_f32 v235, v235, v239
    v_add_f32 v224, v224, v232
    v_add_f32 v225, v225, v233
    v_add_f32 v226, v226, v234
    v_add_f32 v227, v227, v235
    v_fma_f32 v224, v224, v220, v216
    v_fma_f32 v225, v225, v220, v217
    v_fma_f32 v226, v226, v220, v218
    v_fma_f32 v227, v227, v220, v219
    v_cvt_pk_bf16_f32 v228, v224, v225
    v_cvt_pk_bf16_f32 v229, v226, v227
    buffer_store_dwordx2 v[228:229], v13, s[84:87], s56 offen
    s_mov_b32 s31, s30
    s_branch .main_239
.drain_240:
    s_waitcnt vmcnt(31)
    v_mfma_f32_16x16x32_bf16 v[192:195], a[128:131], v[64:67], v[192:195]
    v_mfma_f32_16x16x32_bf16 v[196:199], a[132:135], v[64:67], v[196:199]
    s_waitcnt vmcnt(30)
    v_mfma_f32_16x16x32_bf16 v[200:203], a[128:131], v[68:71], v[200:203]
    v_mfma_f32_16x16x32_bf16 v[204:207], a[132:135], v[68:71], v[204:207]
    s_waitcnt vmcnt(29)
    v_mfma_f32_16x16x32_bf16 v[192:195], a[136:139], v[72:75], v[192:195]
    v_mfma_f32_16x16x32_bf16 v[196:199], a[140:143], v[72:75], v[196:199]
    s_waitcnt vmcnt(28)
    v_mfma_f32_16x16x32_bf16 v[200:203], a[136:139], v[76:79], v[200:203]
    v_mfma_f32_16x16x32_bf16 v[204:207], a[140:143], v[76:79], v[204:207]
    s_waitcnt vmcnt(27)
    v_mfma_f32_16x16x32_bf16 v[192:195], a[144:147], v[80:83], v[192:195]
    v_mfma_f32_16x16x32_bf16 v[196:199], a[148:151], v[80:83], v[196:199]
    s_waitcnt vmcnt(26)
    v_mfma_f32_16x16x32_bf16 v[200:203], a[144:147], v[84:87], v[200:203]
    v_mfma_f32_16x16x32_bf16 v[204:207], a[148:151], v[84:87], v[204:207]
    s_waitcnt vmcnt(25)
    v_mfma_f32_16x16x32_bf16 v[192:195], a[152:155], v[88:91], v[192:195]
    v_mfma_f32_16x16x32_bf16 v[196:199], a[156:159], v[88:91], v[196:199]
    s_waitcnt vmcnt(24)
    v_mfma_f32_16x16x32_bf16 v[200:203], a[152:155], v[92:95], v[200:203]
    v_mfma_f32_16x16x32_bf16 v[204:207], a[156:159], v[92:95], v[204:207]
    s_waitcnt vmcnt(23)
    v_mfma_f32_16x16x32_bf16 v[192:195], a[160:163], v[96:99], v[192:195]
    v_mfma_f32_16x16x32_bf16 v[196:199], a[164:167], v[96:99], v[196:199]
    s_waitcnt vmcnt(22)
    v_mfma_f32_16x16x32_bf16 v[200:203], a[160:163], v[100:103], v[200:203]
    v_mfma_f32_16x16x32_bf16 v[204:207], a[164:167], v[100:103], v[204:207]
    s_waitcnt vmcnt(21)
    v_mfma_f32_16x16x32_bf16 v[192:195], a[168:171], v[104:107], v[192:195]
    v_mfma_f32_16x16x32_bf16 v[196:199], a[172:175], v[104:107], v[196:199]
    s_waitcnt vmcnt(20)
    v_mfma_f32_16x16x32_bf16 v[200:203], a[168:171], v[108:111], v[200:203]
    v_mfma_f32_16x16x32_bf16 v[204:207], a[172:175], v[108:111], v[204:207]
    s_waitcnt vmcnt(19)
    v_mfma_f32_16x16x32_bf16 v[192:195], a[176:179], v[112:115], v[192:195]
    v_mfma_f32_16x16x32_bf16 v[196:199], a[180:183], v[112:115], v[196:199]
    s_waitcnt vmcnt(18)
    v_mfma_f32_16x16x32_bf16 v[200:203], a[176:179], v[116:119], v[200:203]
    v_mfma_f32_16x16x32_bf16 v[204:207], a[180:183], v[116:119], v[204:207]
    s_waitcnt vmcnt(17)
    v_mfma_f32_16x16x32_bf16 v[192:195], a[184:187], v[120:123], v[192:195]
    v_mfma_f32_16x16x32_bf16 v[196:199], a[188:191], v[120:123], v[196:199]
    s_waitcnt vmcnt(16)
    v_mfma_f32_16x16x32_bf16 v[200:203], a[184:187], v[124:127], v[200:203]
    v_mfma_f32_16x16x32_bf16 v[204:207], a[188:191], v[124:127], v[204:207]
    s_waitcnt vmcnt(15)
    v_mfma_f32_16x16x32_bf16 v[192:195], a[192:195], v[128:131], v[192:195]
    v_mfma_f32_16x16x32_bf16 v[196:199], a[196:199], v[128:131], v[196:199]
    s_waitcnt vmcnt(14)
    v_mfma_f32_16x16x32_bf16 v[200:203], a[192:195], v[132:135], v[200:203]
    v_mfma_f32_16x16x32_bf16 v[204:207], a[196:199], v[132:135], v[204:207]
    s_waitcnt vmcnt(13)
    v_mfma_f32_16x16x32_bf16 v[192:195], a[200:203], v[136:139], v[192:195]
    v_mfma_f32_16x16x32_bf16 v[196:199], a[204:207], v[136:139], v[196:199]
    s_waitcnt vmcnt(12)
    v_mfma_f32_16x16x32_bf16 v[200:203], a[200:203], v[140:143], v[200:203]
    v_mfma_f32_16x16x32_bf16 v[204:207], a[204:207], v[140:143], v[204:207]
    s_waitcnt vmcnt(11)
    v_mfma_f32_16x16x32_bf16 v[192:195], a[208:211], v[144:147], v[192:195]
    v_mfma_f32_16x16x32_bf16 v[196:199], a[212:215], v[144:147], v[196:199]
    s_waitcnt vmcnt(10)
    v_mfma_f32_16x16x32_bf16 v[200:203], a[208:211], v[148:151], v[200:203]
    v_mfma_f32_16x16x32_bf16 v[204:207], a[212:215], v[148:151], v[204:207]
    s_waitcnt vmcnt(9)
    v_mfma_f32_16x16x32_bf16 v[192:195], a[216:219], v[152:155], v[192:195]
    v_mfma_f32_16x16x32_bf16 v[196:199], a[220:223], v[152:155], v[196:199]
    s_waitcnt vmcnt(8)
    v_mfma_f32_16x16x32_bf16 v[200:203], a[216:219], v[156:159], v[200:203]
    v_mfma_f32_16x16x32_bf16 v[204:207], a[220:223], v[156:159], v[204:207]
    s_waitcnt vmcnt(7)
    v_mfma_f32_16x16x32_bf16 v[192:195], a[224:227], v[160:163], v[192:195]
    v_mfma_f32_16x16x32_bf16 v[196:199], a[228:231], v[160:163], v[196:199]
    s_waitcnt vmcnt(6)
    v_mfma_f32_16x16x32_bf16 v[200:203], a[224:227], v[164:167], v[200:203]
    v_mfma_f32_16x16x32_bf16 v[204:207], a[228:231], v[164:167], v[204:207]
    s_waitcnt vmcnt(5)
    v_mfma_f32_16x16x32_bf16 v[192:195], a[232:235], v[168:171], v[192:195]
    v_mfma_f32_16x16x32_bf16 v[196:199], a[236:239], v[168:171], v[196:199]
    s_waitcnt vmcnt(4)
    v_mfma_f32_16x16x32_bf16 v[200:203], a[232:235], v[172:175], v[200:203]
    v_mfma_f32_16x16x32_bf16 v[204:207], a[236:239], v[172:175], v[204:207]
    s_waitcnt vmcnt(3)
    v_mfma_f32_16x16x32_bf16 v[192:195], a[240:243], v[176:179], v[192:195]
    v_mfma_f32_16x16x32_bf16 v[196:199], a[244:247], v[176:179], v[196:199]
    s_waitcnt vmcnt(2)
    v_mfma_f32_16x16x32_bf16 v[200:203], a[240:243], v[180:183], v[200:203]
    v_mfma_f32_16x16x32_bf16 v[204:207], a[244:247], v[180:183], v[204:207]
    s_waitcnt vmcnt(1)
    v_mfma_f32_16x16x32_bf16 v[192:195], a[248:251], v[184:187], v[192:195]
    v_mfma_f32_16x16x32_bf16 v[196:199], a[252:255], v[184:187], v[196:199]
    s_waitcnt vmcnt(0)
    v_mfma_f32_16x16x32_bf16 v[200:203], a[248:251], v[188:191], v[200:203]
    v_mfma_f32_16x16x32_bf16 v[204:207], a[252:255], v[188:191], v[204:207]
    s_nop 5
    ds_write_b128 v11, v[192:195] offset:0
    ds_write_b128 v11, v[196:199] offset:1024
    ds_write_b128 v11, v[200:203] offset:2048
    ds_write_b128 v11, v[204:207] offset:3072
    s_waitcnt lgkmcnt(0)
    s_barrier
    ds_read_b128 v[224:227], v12 offset:0
    ds_read_b128 v[228:231], v12 offset:4096
    ds_read_b128 v[232:235], v12 offset:8192
    ds_read_b128 v[236:239], v12 offset:12288
    v_xor_b32 v11, 0x4000, v11
    v_xor_b32 v12, 0x4000, v12
    s_waitcnt lgkmcnt(2)
    v_add_f32 v224, v224, v228
    v_add_f32 v225, v225, v229
    v_add_f32 v226, v226, v230
    v_add_f32 v227, v227, v231
    s_waitcnt lgkmcnt(0)
    v_add_f32 v232, v232, v236
    v_add_f32 v233, v233, v237
    v_add_f32 v234, v234, v238
    v_add_f32 v235, v235, v239
    v_add_f32 v224, v224, v232
    v_add_f32 v225, v225, v233
    v_add_f32 v226, v226, v234
    v_add_f32 v227, v227, v235
    v_fma_f32 v224, v224, v220, v216
    v_fma_f32 v225, v225, v220, v217
    v_fma_f32 v226, v226, v220, v218
    v_fma_f32 v227, v227, v220, v219
    v_cvt_pk_bf16_f32 v228, v224, v225
    v_cvt_pk_bf16_f32 v229, v226, v227
    buffer_store_dwordx2 v[228:229], v13, s[84:87], s56 offen
    s_mov_b32 s31, s30
    s_cmp_lt_u32 s31, 64
    s_cbranch_scc1 .cold_238
    s_endpgm
.mg_end_1:
    s_endpgm
.section .rodata,"a"
.p2align 6
.amdhsa_kernel mega_kernel
  .amdhsa_next_free_vgpr 512
  .amdhsa_next_free_sgpr 102
  .amdhsa_accum_offset 256
  .amdhsa_group_segment_fixed_size 0
  .amdhsa_kernarg_size 136
  .amdhsa_user_sgpr_count 2
  .amdhsa_user_sgpr_kernarg_segment_ptr 1
  .amdhsa_system_sgpr_workgroup_id_x 1
.end_amdhsa_kernel
```

```asm
; @launch kernel=mega_kernel grid=(256,1,1) block=(256,1,1) lds=163840
.amdgcn_target "amdgcn-amd-amdhsa--gfx950"
.text
.globl mega_kernel
.p2align 8
.type mega_kernel,@function
mega_kernel:
    s_cmp_ge_u32 s2, 256
    s_cbranch_scc1 .mg_end_1
    s_load_dwordx4 s[52:55], s[0:1], 120
    s_load_dwordx2 s[40:41], s[0:1], 56
    s_getreg_b32 s3, hwreg(HW_REG_XCC_ID)
    v_and_b32 v1, 63, v0
    v_lshrrev_b32 v4, 6, v0
    s_and_b32 s3, s3, 7
    v_readfirstlane_b32 s24, v4
    s_waitcnt lgkmcnt(0)
    s_mov_b32 s8, s54
    s_and_b32 s9, s55, 0xffff
    s_mov_b32 s10, 0x10000000
    s_mov_b32 s11, 0x00020000
    s_mov_b32 s20, s52
    s_and_b32 s21, s53, 0xffff
    s_mov_b32 s22, 0x100
    s_mov_b32 s23, 0x00020000
    s_mov_b32 s100, s54
    v_mov_b32 v7, 163832
    s_cmp_lg_u32 s24, 0
    s_cbranch_scc1 .noat_4
    s_mov_b64 exec, 1
    v_mov_b32 v5, 1
    s_lshl_b32 s4, s3, 2
    v_mov_b32 v6, s4
    buffer_atomic_add v5, v6, s[20:23], 0 offen sc0 sc1
    s_mov_b64 exec, -1
.noat_4:
    s_sub_u32 s101, 0, s100
    s_and_b32 s101, s101, 0x1fffff
    s_add_u32 s101, s101, 100663296
    s_lshl_b32 s4, s2, 2
    s_add_u32 s4, s4, s24
    s_lshl_b32 s5, s4, 11
    s_add_u32 s5, s5, s101
    v_lshlrev_b32 v8, 4, v1
    v_mov_b32 v20, -1
    v_mov_b32 v21, -1
    v_mov_b32 v22, -1
    v_mov_b32 v23, -1
    s_cmp_ge_u32 s4, 64
    s_cbranch_scc1 .m0_5
    s_mov_b32 s12, s40
    s_and_b32 s13, s41, 0xffff
    s_mov_b32 s14, 0x4000
    s_mov_b32 s15, 0x00020000
    s_and_b32 s6, s4, 15
    s_lshl_b32 s6, s6, 7
    v_bfe_u32 v254, v1, 0, 3
    v_mul_u32_u24 v9, 2048, v254
    v_bfe_u32 v254, v1, 3, 2
    v_mul_u32_u24 v254, 16, v254
    v_add_u32 v9, v9, v254
    v_bfe_u32 v254, v1, 5, 1
    v_mul_u32_u24 v254, 64, v254
    v_add_u32 v9, v9, v254
    buffer_load_dwordx4 v[24:27], v9, s[12:15], s6 offen
.m0_5:
    buffer_store_dwordx4 v[20:23], v8, s[8:11], s5 offen sc1
    buffer_store_dwordx4 v[20:23], v8, s[8:11], s5 offen offset:1024 sc1
    s_lshl_b32 s5, s4, 10
    s_sub_u32 s6, s4, 64
    s_cmp_ge_u32 s6, 20
    s_cbranch_scc1 .nf_7
    v_mov_b32 v24, 0
    v_mov_b32 v25, 0
    v_mov_b32 v26, 0
    v_mov_b32 v27, 0
    s_add_u32 s6, s5, 92209152
    buffer_store_dwordx4 v[24:27], v8, s[8:11], s6 offen sc1
.nf_7:
    s_add_u32 s5, s5, 83886080
    s_cmp_ge_u32 s4, 64
    s_cbranch_scc1 .m1_6
    s_waitcnt vmcnt(2)
    v_mov_b32 v20, v24
    v_min_u32 v21, 0xfffffffe, v25
    v_mov_b32 v22, v26
    v_min_u32 v23, 0xfffffffe, v27
.m1_6:
    buffer_store_dwordx4 v[20:23], v8, s[8:11], s5 offen sc1
    s_waitcnt vmcnt(0)
    s_cmp_lg_u32 s24, 0
    s_cbranch_scc1 .nw_9
    s_mov_b64 exec, 1
    ds_write_b32 v7, v5
    s_waitcnt lgkmcnt(0)
    s_mov_b64 exec, -1
.nw_9:
    s_barrier
    ds_read_b32 v5, v7
    s_cmp_lg_u32 s24, 1
    s_cbranch_scc1 .ns_8
    s_mov_b64 exec, 1
    v_mov_b32 v6, 1
    buffer_atomic_add v6, v8, s[20:23], 0 offen offset:32 sc1
    s_mov_b64 exec, -1
.ns_8:
    s_waitcnt lgkmcnt(0)
    v_readfirstlane_b32 s26, v5
    s_mov_b32 s25, s3
    s_mov_b32 s27, 0
    s_and_b32 s26, s26, 31
.mg_role_3:
    s_cmp_ge_u32 s25, 4
    s_cbranch_scc1 .mg_bg_2
    s_load_dwordx8 s[84:91], s[0:1], 64
    v_and_b32 v1, 63, v0
    s_lshl_b32 s4, s25, 3
    s_and_b32 s5, s26, 4
    s_or_b32 s4, s4, s5
    s_cbranch_scc1 .nocal_10
    s_cmp_lg_u32 s24, 3
    s_cbranch_scc1 .calb_11
    s_lshr_b32 s4, s26, 1
    s_and_b32 s4, s4, 12
    s_and_b32 s5, s26, 3
    s_or_b32 s4, s4, s5
    s_lshl_b32 s5, s4, 11
    s_add_u32 s5, s5, s101
    s_mov_b64 exec, 1
    v_mov_b32 v4, -1
    v_mov_b32 v5, 0
    s_mov_b32 s7, 0xffff
    s_memtime s[72:73]
    s_waitcnt lgkmcnt(0)
    buffer_store_dword v4, v5, s[8:11], s5 offen sc1
    s_waitcnt vmcnt(0)
    s_memtime s[74:75]
    s_waitcnt lgkmcnt(0)
    s_sub_u32 s74, s74, s72
    s_min_u32 s7, s7, s74
    s_memtime s[72:73]
    s_waitcnt lgkmcnt(0)
    buffer_store_dword v4, v5, s[8:11], s5 offen sc1
    s_waitcnt vmcnt(0)
    s_memtime s[74:75]
    s_waitcnt lgkmcnt(0)
    s_sub_u32 s74, s74, s72
    s_min_u32 s7, s7, s74
    s_memtime s[72:73]
    s_waitcnt lgkmcnt(0)
    buffer_store_dword v4, v5, s[8:11], s5 offen sc1
    s_waitcnt vmcnt(0)
    s_memtime s[74:75]
    s_waitcnt lgkmcnt(0)
    s_sub_u32 s74, s74, s72
    s_min_u32 s7, s7, s74
    s_lshl_b32 s5, s4, 1
    s_add_u32 s5, s5, 128
    v_mov_b32 v4, s7
    buffer_store_short v4, v5, s[20:23], s5 offen sc1
    s_mov_b64 exec, -1
.calb_11:
    s_barrier
.nocal_10:
    s_lshl_b32 s4, s25, 11
    s_lshl_b32 s5, s26, 6
    s_add_u32 s4, s4, s5
    s_lshl_b32 s6, s24, 21
    s_add_u32 s4, s4, s6
    s_lshl_b32 s7, s25, 21
    s_lshl_b32 s6, s24, 19
    s_add_u32 s7, s7, s6
    s_add_u32 s7, s7, s5
    s_lshl_b32 s6, s24, 15
    v_bfe_u32 v4, v1, 4, 1
    v_lshlrev_b32 v4, 1, v4
    v_and_b32 v5, 3, v1
    v_xor_b32 v4, v4, v5
    v_lshlrev_b32 v4, 4, v4
    v_bfe_u32 v254, v1, 2, 1
    v_mul_u32_u24 v5, 1, v254
    v_bfe_u32 v254, v1, 3, 1
    v_mul_u32_u24 v254, 8, v254
    v_add_u32 v5, v5, v254
    v_bfe_u32 v254, v1, 4, 1
    v_mul_u32_u24 v254, 4, v254
    v_add_u32 v5, v5, v254
    v_bfe_u32 v254, v1, 5, 1
    v_mul_u32_u24 v254, 2, v254
    v_add_u32 v5, v5, v254
    v_lshlrev_b32 v6, 13, v5
    v_add_u32 v6, v6, v4
    v_add_u32 v240, s4, v6
    v_lshlrev_b32 v6, 11, v5
    v_add_u32 v6, v6, v4
    v_add_u32 v241, s7, v6
    v_bfe_u32 v254, v1, 2, 2
    v_mul_u32_u24 v242, 64, v254
    v_bfe_u32 v254, v1, 4, 1
    v_mul_u32_u24 v254, 288, v254
    v_add_u32 v242, v242, v254
    v_bfe_u32 v254, v1, 5, 1
    v_mul_u32_u24 v254, 1024, v254
    v_add_u32 v242, v242, v254
    v_bfe_u32 v254, v1, 0, 2
    v_mul_u32_u24 v254, 8, v254
    v_add_u32 v242, v242, v254
    v_add_u32 v242, s6, v242
    v_xor_b32 v243, 32, v242
    s_waitcnt lgkmcnt(0)
    s_mov_b32 s16, s84
    s_and_b32 s17, s85, 0xffff
    s_mov_b32 s18, 0x800000
    s_mov_b32 s19, 0x00020000
    s_and_b32 s4, s26, 1
    s_lshl_b32 s98, s4, 11
    s_lshl_b32 s99, s4, 18
    s_add_u32 s98, s98, s6
    s_xor_b32 m0, s98, 0
    s_xor_b32 s5, s99, 0
    buffer_load_dwordx4 v240, s[16:19], s5 offen nt lds
    s_xor_b32 m0, s98, 1024
    s_xor_b32 s5, s99, 131072
    buffer_load_dwordx4 v240, s[16:19], s5 offen nt lds
    s_xor_b32 m0, s98, 2048
    s_xor_b32 s5, s99, 262144
    buffer_load_dwordx4 v240, s[16:19], s5 offen nt lds
    s_xor_b32 m0, s98, 3072
    s_xor_b32 s5, s99, 393216
    buffer_load_dwordx4 v240, s[16:19], s5 offen nt lds
    s_xor_b32 m0, s98, 4096
    s_xor_b32 s5, s99, 524288
    buffer_load_dwordx4 v240, s[16:19], s5 offen nt lds
    s_xor_b32 m0, s98, 5120
    s_xor_b32 s5, s99, 655360
    buffer_load_dwordx4 v240, s[16:19], s5 offen nt lds
    s_xor_b32 m0, s98, 6144
    s_xor_b32 s5, s99, 786432
    buffer_load_dwordx4 v240, s[16:19], s5 offen nt lds
    s_xor_b32 m0, s98, 7168
    s_xor_b32 s5, s99, 917504
    buffer_load_dwordx4 v240, s[16:19], s5 offen nt lds
    s_xor_b32 m0, s98, 8192
    s_xor_b32 s5, s99, 1048576
    buffer_load_dwordx4 v240, s[16:19], s5 offen nt lds
    s_xor_b32 m0, s98, 9216
    s_xor_b32 s5, s99, 1179648
    buffer_load_dwordx4 v240, s[16:19], s5 offen nt lds
    s_xor_b32 m0, s98, 10240
    s_xor_b32 s5, s99, 1310720
    buffer_load_dwordx4 v240, s[16:19], s5 offen nt lds
    s_xor_b32 m0, s98, 11264
    s_xor_b32 s5, s99, 1441792
    buffer_load_dwordx4 v240, s[16:19], s5 offen nt lds
    s_xor_b32 m0, s98, 12288
    s_xor_b32 s5, s99, 1572864
    buffer_load_dwordx4 v240, s[16:19], s5 offen nt lds
    s_xor_b32 m0, s98, 13312
    s_xor_b32 s5, s99, 1703936
    buffer_load_dwordx4 v240, s[16:19], s5 offen nt lds
    s_xor_b32 m0, s98, 14336
    s_xor_b32 s5, s99, 1835008
    buffer_load_dwordx4 v240, s[16:19], s5 offen nt lds
    s_xor_b32 m0, s98, 15360
    s_xor_b32 s5, s99, 1966080
    buffer_load_dwordx4 v240, s[16:19], s5 offen nt lds
    s_mov_b32 s16, s86
    s_and_b32 s17, s87, 0xffff
    s_mov_b32 s18, 0x800000
    s_mov_b32 s19, 0x00020000
    s_and_b32 s4, s26, 1
    s_lshl_b32 s98, s4, 11
    s_lshl_b32 s99, s4, 18
    s_add_u32 s98, s98, s6
    s_xor_b32 m0, s98, 16384
    s_xor_b32 s5, s99, 0
    buffer_load_dwordx4 v240, s[16:19], s5 offen nt lds
    s_xor_b32 m0, s98, 17408
    s_xor_b32 s5, s99, 131072
    buffer_load_dwordx4 v240, s[16:19], s5 offen nt lds
    s_xor_b32 m0, s98, 18432
    s_xor_b32 s5, s99, 262144
    buffer_load_dwordx4 v240, s[16:19], s5 offen nt lds
    s_xor_b32 m0, s98, 19456
    s_xor_b32 s5, s99, 393216
    buffer_load_dwordx4 v240, s[16:19], s5 offen nt lds
    s_xor_b32 m0, s98, 20480
    s_xor_b32 s5, s99, 524288
    buffer_load_dwordx4 v240, s[16:19], s5 offen nt lds
    s_xor_b32 m0, s98, 21504
    s_xor_b32 s5, s99, 655360
    buffer_load_dwordx4 v240, s[16:19], s5 offen nt lds
    s_xor_b32 m0, s98, 22528
    s_xor_b32 s5, s99, 786432
    buffer_load_dwordx4 v240, s[16:19], s5 offen nt lds
    s_xor_b32 m0, s98, 23552
    s_xor_b32 s5, s99, 917504
    buffer_load_dwordx4 v240, s[16:19], s5 offen nt lds
    s_xor_b32 m0, s98, 24576
    s_xor_b32 s5, s99, 1048576
    buffer_load_dwordx4 v240, s[16:19], s5 offen nt lds
    s_xor_b32 m0, s98, 25600
    s_xor_b32 s5, s99, 1179648
    buffer_load_dwordx4 v240, s[16:19], s5 offen nt lds
    s_xor_b32 m0, s98, 26624
    s_xor_b32 s5, s99, 1310720
    buffer_load_dwordx4 v240, s[16:19], s5 offen nt lds
    s_xor_b32 m0, s98, 27648
    s_xor_b32 s5, s99, 1441792
    buffer_load_dwordx4 v240, s[16:19], s5 offen nt lds
    s_xor_b32 m0, s98, 28672
    s_xor_b32 s5, s99, 1572864
    buffer_load_dwordx4 v240, s[16:19], s5 offen nt lds
    s_xor_b32 m0, s98, 29696
    s_xor_b32 s5, s99, 1703936
    buffer_load_dwordx4 v240, s[16:19], s5 offen nt lds
    s_xor_b32 m0, s98, 30720
    s_xor_b32 s5, s99, 1835008
    buffer_load_dwordx4 v240, s[16:19], s5 offen nt lds
    s_xor_b32 m0, s98, 31744
    s_xor_b32 s5, s99, 1966080
    buffer_load_dwordx4 v240, s[16:19], s5 offen nt lds
    s_lshr_b32 s52, s26, 2
    s_and_b32 s53, s26, 3
    s_lshl_b32 s54, s25, 14
    s_lshl_b32 s55, s26, 9
    s_add_u32 s55, s55, s54
    s_lshl_b32 s56, s25, 3
    s_add_u32 s56, s56, s52
    s_lshl_b32 s57, s56, 12
    s_lshl_b32 s58, s53, 9
    s_add_u32 s58, s58, s57
    s_mov_b32 s48, 0x00ff00ff
    s_mov_b32 s49, 0x00ff00ff
    s_mov_b32 s50, 0xff00ff00
    s_mov_b32 s51, 0xff00ff00
    v_mov_b32 v2, 0x4444
    v_mov_b32 v4, 0xeeee
    s_lshl_b32 s4, s24, 12
    s_add_u32 s4, s4, s54
    v_cndmask_b32 v2, v4, v2, s[48:49]
    v_bfe_u32 v254, v1, 0, 6
    v_mul_u32_u24 v3, 16, v254
    v_add_u32 v3, s4, v3
    v_add_u32 v4, 0x10000, v3
    s_mul_i32 s4, s24, 1152
    v_bfe_u32 v254, v1, 4, 1
    v_mul_u32_u24 v5, 576, v254
    v_bfe_u32 v254, v1, 5, 1
    v_mul_u32_u24 v254, 64, v254
    v_add_u32 v5, v5, v254
    v_bfe_u32 v254, v1, 0, 4
    v_mul_u32_u24 v254, 4, v254
    v_add_u32 v5, v5, v254
    v_add_u32 v5, s4, v5
    v_add_u32 v6, 4608, v5
    v_add_u32 v7, 9216, v5
    s_lshl_b32 s4, s24, 10
    v_bfe_u32 v254, v1, 0, 6
    v_mul_u32_u24 v8, 16, v254
    v_add_u32 v8, 13824, v8
    v_add_u32 v8, s4, v8
    s_and_b32 s4, s24, 1
    s_lshr_b32 s5, s24, 1
    s_lshl_b32 s59, s4, 6
    s_mul_i32 s60, s5, 4608
    s_add_u32 s59, s59, s60
    s_lshl_b32 s4, s4, 8
    s_add_u32 s60, s58, s4
    s_lshl_b32 s5, s5, 11
    s_add_u32 s61, s60, s5
    v_bfe_u32 v254, v1, 2, 3
    v_mul_u32_u24 v9, 144, v254
    v_bfe_u32 v254, v1, 5, 1
    v_mul_u32_u24 v254, 32, v254
    v_add_u32 v9, v9, v254
    v_bfe_u32 v254, v1, 0, 2
    v_mul_u32_u24 v254, 8, v254
    v_add_u32 v9, v9, v254
    v_add_u32 v9, s59, v9
    v_bfe_u32 v254, v1, 0, 6
    v_mul_u32_u24 v10, 4, v254
    v_add_u32 v10, 131072, v10
    v_add_u32 v10, s61, v10
    v_bfe_u32 v254, v1, 0, 6
    v_mul_u32_u24 v11, 4, v254
    v_add_u32 v11, 17920, v11
    v_add_u32 v11, s4, v11
    v_mov_b32 v20, -1
    v_mov_b32 v21, -1
    v_mov_b32 v22, -1
    v_mov_b32 v23, -1
    v_mov_b32 v40, 0
    v_mov_b32 v41, 0
    v_mov_b32 v42, 0
    v_mov_b32 v43, 0
    v_mov_b32 v44, 0
    v_mov_b32 v45, 0
    v_mov_b32 v46, 0
    v_mov_b32 v47, 0
    v_mov_b32 v48, 0
    v_mov_b32 v49, 0
    v_mov_b32 v50, 0
    v_mov_b32 v51, 0
    v_mov_b32 v52, 0
    v_mov_b32 v53, 0
    v_mov_b32 v54, 0
    v_mov_b32 v55, 0
    v_mov_b32 v56, 0
    v_mov_b32 v57, 0
    v_mov_b32 v58, 0
    v_mov_b32 v59, 0
    v_mov_b32 v60, 0
    v_mov_b32 v61, 0
    v_mov_b32 v62, 0
    v_mov_b32 v63, 0
    v_mov_b32 v64, 0
    v_mov_b32 v65, 0
    v_mov_b32 v66, 0
    v_mov_b32 v67, 0
    v_mov_b32 v68, 0
    v_mov_b32 v69, 0
    v_mov_b32 v70, 0
    v_mov_b32 v71, 0
    v_bfe_u32 v254, v1, 0, 5
    v_mul_u32_u24 v244, 16, v254
    v_bfe_u32 v254, v1, 5, 1
    v_mul_u32_u24 v254, 2048, v254
    v_add_u32 v244, v244, v254
    v_add_u32 v244, 131072, v244
    v_add_u32 v244, s58, v244
    v_bfe_u32 v254, v1, 0, 5
    v_mul_u32_u24 v245, 16, v254
    v_bfe_u32 v254, v1, 5, 1
    v_mul_u32_u24 v254, 65536, v254
    v_add_u32 v245, v245, v254
    v_add_u32 v245, s55, v245
    s_waitcnt vmcnt(16)
    ds_read_b64_tr_b16 a[0:1], v242 offset:0
    ds_read_b64_tr_b16 a[2:3], v242 offset:512
    ds_read_b64_tr_b16 a[4:5], v242 offset:2048
    ds_read_b64_tr_b16 a[6:7], v242 offset:2560
    ds_read_b64_tr_b16 a[8:9], v242 offset:4096
    ds_read_b64_tr_b16 a[10:11], v242 offset:4608
    ds_read_b64_tr_b16 a[12:13], v242 offset:6144
    ds_read_b64_tr_b16 a[14:15], v242 offset:6656
    ds_read_b64_tr_b16 a[16:17], v242 offset:8192
    ds_read_b64_tr_b16 a[18:19], v242 offset:8704
    ds_read_b64_tr_b16 a[20:21], v242 offset:10240
    ds_read_b64_tr_b16 a[22:23], v242 offset:10752
    ds_read_b64_tr_b16 a[24:25], v242 offset:12288
    ds_read_b64_tr_b16 a[26:27], v242 offset:12800
    ds_read_b64_tr_b16 a[28:29], v242 offset:14336
    ds_read_b64_tr_b16 a[30:31], v242 offset:14848
    ds_read_b64_tr_b16 a[32:33], v243 offset:0
    ds_read_b64_tr_b16 a[34:35], v243 offset:512
    ds_read_b64_tr_b16 a[36:37], v243 offset:2048
    ds_read_b64_tr_b16 a[38:39], v243 offset:2560
    ds_read_b64_tr_b16 a[40:41], v243 offset:4096
    ds_read_b64_tr_b16 a[42:43], v243 offset:4608
    ds_read_b64_tr_b16 a[44:45], v243 offset:6144
    ds_read_b64_tr_b16 a[46:47], v243 offset:6656
    ds_read_b64_tr_b16 a[48:49], v243 offset:8192
    ds_read_b64_tr_b16 a[50:51], v243 offset:8704
    ds_read_b64_tr_b16 a[52:53], v243 offset:10240
    ds_read_b64_tr_b16 a[54:55], v243 offset:10752
    ds_read_b64_tr_b16 a[56:57], v243 offset:12288
    ds_read_b64_tr_b16 a[58:59], v243 offset:12800
    ds_read_b64_tr_b16 a[60:61], v243 offset:14336
    ds_read_b64_tr_b16 a[62:63], v243 offset:14848
    s_waitcnt lgkmcnt(0)
    s_mov_b32 s16, s88
    s_and_b32 s17, s89, 0xffff
    s_mov_b32 s18, 0x800000
    s_mov_b32 s19, 0x00020000
    s_and_b32 s4, s26, 1
    s_lshl_b32 s98, s4, 11
    s_lshl_b32 s99, s4, 18
    s_add_u32 s98, s98, s6
    s_xor_b32 m0, s98, 0
    s_xor_b32 s5, s99, 0
    buffer_load_dwordx4 v240, s[16:19], s5 offen nt lds
    s_xor_b32 m0, s98, 1024
    s_xor_b32 s5, s99, 131072
    buffer_load_dwordx4 v240, s[16:19], s5 offen nt lds
    s_xor_b32 m0, s98, 2048
    s_xor_b32 s5, s99, 262144
    buffer_load_dwordx4 v240, s[16:19], s5 offen nt lds
    s_xor_b32 m0, s98, 3072
    s_xor_b32 s5, s99, 393216
    buffer_load_dwordx4 v240, s[16:19], s5 offen nt lds
    s_xor_b32 m0, s98, 4096
    s_xor_b32 s5, s99, 524288
    buffer_load_dwordx4 v240, s[16:19], s5 offen nt lds
    s_xor_b32 m0, s98, 5120
    s_xor_b32 s5, s99, 655360
    buffer_load_dwordx4 v240, s[16:19], s5 offen nt lds
    s_xor_b32 m0, s98, 6144
    s_xor_b32 s5, s99, 786432
    buffer_load_dwordx4 v240, s[16:19], s5 offen nt lds
    s_xor_b32 m0, s98, 7168
    s_xor_b32 s5, s99, 917504
    buffer_load_dwordx4 v240, s[16:19], s5 offen nt lds
    s_xor_b32 m0, s98, 8192
    s_xor_b32 s5, s99, 1048576
    buffer_load_dwordx4 v240, s[16:19], s5 offen nt lds
    s_xor_b32 m0, s98, 9216
    s_xor_b32 s5, s99, 1179648
    buffer_load_dwordx4 v240, s[16:19], s5 offen nt lds
    s_xor_b32 m0, s98, 10240
    s_xor_b32 s5, s99, 1310720
    buffer_load_dwordx4 v240, s[16:19], s5 offen nt lds
    s_xor_b32 m0, s98, 11264
    s_xor_b32 s5, s99, 1441792
    buffer_load_dwordx4 v240, s[16:19], s5 offen nt lds
    s_xor_b32 m0, s98, 12288
    s_xor_b32 s5, s99, 1572864
    buffer_load_dwordx4 v240, s[16:19], s5 offen nt lds
    s_xor_b32 m0, s98, 13312
    s_xor_b32 s5, s99, 1703936
    buffer_load_dwordx4 v240, s[16:19], s5 offen nt lds
    s_xor_b32 m0, s98, 14336
    s_xor_b32 s5, s99, 1835008
    buffer_load_dwordx4 v240, s[16:19], s5 offen nt lds
    s_xor_b32 m0, s98, 15360
    s_xor_b32 s5, s99, 1966080
    buffer_load_dwordx4 v240, s[16:19], s5 offen nt lds
    s_waitcnt vmcnt(16)
    ds_read_b64_tr_b16 a[64:65], v242 offset:16384
    ds_read_b64_tr_b16 a[66:67], v242 offset:16896
    ds_read_b64_tr_b16 a[68:69], v242 offset:18432
    ds_read_b64_tr_b16 a[70:71], v242 offset:18944
    ds_read_b64_tr_b16 a[72:73], v242 offset:20480
    ds_read_b64_tr_b16 a[74:75], v242 offset:20992
    ds_read_b64_tr_b16 a[76:77], v242 offset:22528
    ds_read_b64_tr_b16 a[78:79], v242 offset:23040
    ds_read_b64_tr_b16 a[80:81], v242 offset:24576
    ds_read_b64_tr_b16 a[82:83], v242 offset:25088
    ds_read_b64_tr_b16 a[84:85], v242 offset:26624
    ds_read_b64_tr_b16 a[86:87], v242 offset:27136
    ds_read_b64_tr_b16 a[88:89], v242 offset:28672
    ds_read_b64_tr_b16 a[90:91], v242 offset:29184
    ds_read_b64_tr_b16 a[92:93], v242 offset:30720
    ds_read_b64_tr_b16 a[94:95], v242 offset:31232
    ds_read_b64_tr_b16 a[96:97], v243 offset:16384
    ds_read_b64_tr_b16 a[98:99], v243 offset:16896
    ds_read_b64_tr_b16 a[100:101], v243 offset:18432
    ds_read_b64_tr_b16 a[102:103], v243 offset:18944
    ds_read_b64_tr_b16 a[104:105], v243 offset:20480
    ds_read_b64_tr_b16 a[106:107], v243 offset:20992
    ds_read_b64_tr_b16 a[108:109], v243 offset:22528
    ds_read_b64_tr_b16 a[110:111], v243 offset:23040
    ds_read_b64_tr_b16 a[112:113], v243 offset:24576
    ds_read_b64_tr_b16 a[114:115], v243 offset:25088
    ds_read_b64_tr_b16 a[116:117], v243 offset:26624
    ds_read_b64_tr_b16 a[118:119], v243 offset:27136
    ds_read_b64_tr_b16 a[120:121], v243 offset:28672
    ds_read_b64_tr_b16 a[122:123], v243 offset:29184
    ds_read_b64_tr_b16 a[124:125], v243 offset:30720
    ds_read_b64_tr_b16 a[126:127], v243 offset:31232
    s_waitcnt lgkmcnt(0)
    v_lshlrev_b32 v239, 2, v1
    buffer_load_dword v238, v239, s[20:23], 0 offen sc1
    s_mov_b32 s16, s90
    s_and_b32 s17, s91, 0xffff
    s_mov_b32 s18, 0x800000
    s_mov_b32 s19, 0x00020000
    s_and_b32 s4, s26, 1
    s_lshl_b32 s98, s4, 11
    s_lshl_b32 s99, s4, 16
    s_add_u32 s98, s98, s6
    s_xor_b32 m0, s98, 16384
    s_xor_b32 s5, s99, 0
    buffer_load_dwordx4 v241, s[16:19], s5 offen nt lds
    s_xor_b32 m0, s98, 17408
    s_xor_b32 s5, s99, 32768
    buffer_load_dwordx4 v241, s[16:19], s5 offen nt lds
    s_xor_b32 m0, s98, 18432
    s_xor_b32 s5, s99, 65536
    buffer_load_dwordx4 v241, s[16:19], s5 offen nt lds
    s_xor_b32 m0, s98, 19456
    s_xor_b32 s5, s99, 98304
    buffer_load_dwordx4 v241, s[16:19], s5 offen nt lds
    s_xor_b32 m0, s98, 20480
    s_xor_b32 s5, s99, 131072
    buffer_load_dwordx4 v241, s[16:19], s5 offen nt lds
    s_xor_b32 m0, s98, 21504
    s_xor_b32 s5, s99, 163840
    buffer_load_dwordx4 v241, s[16:19], s5 offen nt lds
    s_xor_b32 m0, s98, 22528
    s_xor_b32 s5, s99, 196608
    buffer_load_dwordx4 v241, s[16:19], s5 offen nt lds
    s_xor_b32 m0, s98, 23552
    s_xor_b32 s5, s99, 229376
    buffer_load_dwordx4 v241, s[16:19], s5 offen nt lds
    s_xor_b32 m0, s98, 24576
    s_xor_b32 s5, s99, 262144
    buffer_load_dwordx4 v241, s[16:19], s5 offen nt lds
    s_xor_b32 m0, s98, 25600
    s_xor_b32 s5, s99, 294912
    buffer_load_dwordx4 v241, s[16:19], s5 offen nt lds
    s_xor_b32 m0, s98, 26624
    s_xor_b32 s5, s99, 327680
    buffer_load_dwordx4 v241, s[16:19], s5 offen nt lds
    s_xor_b32 m0, s98, 27648
    s_xor_b32 s5, s99, 360448
    buffer_load_dwordx4 v241, s[16:19], s5 offen nt lds
    s_xor_b32 m0, s98, 28672
    s_xor_b32 s5, s99, 393216
    buffer_load_dwordx4 v241, s[16:19], s5 offen nt lds
    s_xor_b32 m0, s98, 29696
    s_xor_b32 s5, s99, 425984
    buffer_load_dwordx4 v241, s[16:19], s5 offen nt lds
    s_xor_b32 m0, s98, 30720
    s_xor_b32 s5, s99, 458752
    buffer_load_dwordx4 v241, s[16:19], s5 offen nt lds
    s_xor_b32 m0, s98, 31744
    s_xor_b32 s5, s99, 491520
    buffer_load_dwordx4 v241, s[16:19], s5 offen nt lds
    s_waitcnt vmcnt(16)
    s_cmp_lg_u32 s27, 0
    s_cbranch_scc1 .vd_13
    s_mov_b32 s62, 0
.vp_12:
    v_readlane_b32 s4, v238, 8
    s_cmp_ge_u32 s4, 256
    s_cbranch_scc1 .va_14
    s_add_u32 s62, s62, 1
    s_cmp_gt_u32 s62, 0x100000
    s_cbranch_scc1 .mg_end_1
    s_sleep 16
    buffer_load_dword v238, v239, s[20:23], 0 offen sc1
    s_waitcnt vmcnt(0)
    s_branch .vp_12
.va_14:
    v_cmp_ne_u32 vcc, 32, v238
    s_and_b32 s4, vcc_lo, 0xff
    s_cbranch_scc0 .vd_13
    s_lshr_b32 s25, s2, 5
    s_and_b32 s26, s2, 31
    s_mov_b32 s27, 1
    s_waitcnt vmcnt(0) lgkmcnt(0)
    s_barrier
    s_branch .mg_role_3
.vd_13:
    ds_read_b64_tr_b16 a[128:129], v242 offset:0
    ds_read_b64_tr_b16 a[130:131], v242 offset:512
    ds_read_b64_tr_b16 a[132:133], v242 offset:2048
    ds_read_b64_tr_b16 a[134:135], v242 offset:2560
    ds_read_b64_tr_b16 a[136:137], v242 offset:4096
    ds_read_b64_tr_b16 a[138:139], v242 offset:4608
    ds_read_b64_tr_b16 a[140:141], v242 offset:6144
    ds_read_b64_tr_b16 a[142:143], v242 offset:6656
    ds_read_b64_tr_b16 a[144:145], v242 offset:8192
    ds_read_b64_tr_b16 a[146:147], v242 offset:8704
    ds_read_b64_tr_b16 a[148:149], v242 offset:10240
    ds_read_b64_tr_b16 a[150:151], v242 offset:10752
    ds_read_b64_tr_b16 a[152:153], v242 offset:12288
    ds_read_b64_tr_b16 a[154:155], v242 offset:12800
    ds_read_b64_tr_b16 a[156:157], v242 offset:14336
    ds_read_b64_tr_b16 a[158:159], v242 offset:14848
    ds_read_b64_tr_b16 a[160:161], v243 offset:0
    ds_read_b64_tr_b16 a[162:163], v243 offset:512
    ds_read_b64_tr_b16 a[164:165], v243 offset:2048
    ds_read_b64_tr_b16 a[166:167], v243 offset:2560
    ds_read_b64_tr_b16 a[168:169], v243 offset:4096
    ds_read_b64_tr_b16 a[170:171], v243 offset:4608
    ds_read_b64_tr_b16 a[172:173], v243 offset:6144
    ds_read_b64_tr_b16 a[174:175], v243 offset:6656
    ds_read_b64_tr_b16 a[176:177], v243 offset:8192
    ds_read_b64_tr_b16 a[178:179], v243 offset:8704
    ds_read_b64_tr_b16 a[180:181], v243 offset:10240
    ds_read_b64_tr_b16 a[182:183], v243 offset:10752
    ds_read_b64_tr_b16 a[184:185], v243 offset:12288
    ds_read_b64_tr_b16 a[186:187], v243 offset:12800
    ds_read_b64_tr_b16 a[188:189], v243 offset:14336
    ds_read_b64_tr_b16 a[190:191], v243 offset:14848
    s_waitcnt lgkmcnt(0)
    s_mov_b32 s47, 0
    s_cmp_lg_u32 s27, 0
    s_cbranch_scc1 .cd_16
    s_mov_b32 s62, 0
.cp_15:
    v_and_b32 v18, 0xffff, v238
    v_lshrrev_b32 v19, 16, v238
    v_min_u32 v17, v18, v19
    v_cmp_eq_u32 vcc, 0, v17
    s_and_b32 s4, vcc_hi, 0xff
    s_cbranch_scc0 .cg_17
    s_add_u32 s62, s62, 1
    s_cmp_gt_u32 s62, 0x100000
    s_cbranch_scc1 .mg_end_1
    s_sleep 16
    buffer_load_dword v238, v239, s[20:23], 0 offen sc1
    s_waitcnt vmcnt(0)
    s_branch .cp_15
.cg_17:
    v_readlane_b32 s66, v18, 32
    v_readlane_b32 s67, v19, 32
    v_readlane_b32 s68, v18, 33
    v_readlane_b32 s69, v19, 33
    v_readlane_b32 s70, v18, 34
    v_readlane_b32 s71, v19, 34
    v_readlane_b32 s72, v18, 35
    v_readlane_b32 s73, v19, 35
    v_readlane_b32 s74, v18, 36
    v_readlane_b32 s75, v19, 36
    v_readlane_b32 s76, v18, 37
    v_readlane_b32 s77, v19, 37
    v_readlane_b32 s78, v18, 38
    v_readlane_b32 s79, v19, 38
    v_readlane_b32 s80, v18, 39
    v_readlane_b32 s81, v19, 39
    s_nop 3
    s_add_u32 s4, s66, s67
    s_add_u32 s4, s4, s68
    s_add_u32 s4, s4, s69
    s_add_u32 s4, s4, s74
    s_add_u32 s4, s4, s75
    s_add_u32 s4, s4, s76
    s_add_u32 s4, s4, s77
    s_add_u32 s5, s70, s71
    s_add_u32 s5, s5, s72
    s_add_u32 s5, s5, s73
    s_add_u32 s5, s5, s78
    s_add_u32 s5, s5, s79
    s_add_u32 s5, s5, s80
    s_add_u32 s5, s5, s81
    s_cmp_lt_u32 s5, s4
    s_cselect_b32 s47, 0x2000, 0
    s_cselect_b32 s66, s70, s66
    s_cselect_b32 s67, s71, s67
    s_cselect_b32 s68, s72, s68
    s_cselect_b32 s69, s73, s69
    s_cselect_b32 s74, s78, s74
    s_cselect_b32 s75, s79, s75
    s_cselect_b32 s76, s80, s76
    s_cselect_b32 s77, s81, s77
    s_add_u32 s4, s66, s68
    s_add_u32 s4, s4, s74
    s_add_u32 s4, s4, s76
    s_add_u32 s5, s67, s69
    s_add_u32 s5, s5, s75
    s_add_u32 s5, s5, s77
    s_cmp_lt_u32 s5, s4
    s_cselect_b32 s4, 2048, 0
    s_or_b32 s47, s47, s4
    s_add_u32 s4, s66, s67
    s_add_u32 s4, s4, s74
    s_add_u32 s4, s4, s75
    s_add_u32 s5, s68, s69
    s_add_u32 s5, s5, s76
    s_add_u32 s5, s5, s77
    s_cmp_lt_u32 s5, s4
    s_cselect_b32 s4, 4096, 0
    s_or_b32 s47, s47, s4
    s_add_u32 s4, s66, s67
    s_add_u32 s4, s4, s68
    s_add_u32 s4, s4, s69
    s_add_u32 s5, s74, s75
    s_add_u32 s5, s5, s76
    s_add_u32 s5, s5, s77
    s_cmp_lt_u32 s5, s4
    s_cselect_b32 s4, 16384, 0
    s_or_b32 s47, s47, s4
.cd_16:
    s_cmp_lg_u32 s27, 0
    s_cbranch_scc1 .slowv_18
    s_mov_b32 s28, 0
    s_mov_b32 s30, 83886080
    s_mov_b32 s31, 84148224
    s_mov_b32 s32, 84410368
    s_mov_b32 s33, 84672512
    s_mov_b32 s41, 66977792
    s_lshl_b32 s42, s56, 13
    s_lshl_b32 s4, s53, 11
    s_add_u32 s44, s42, s4
    s_add_u32 s44, s44, 33554432
    s_add_u32 s42, s42, 16777216
    s_add_u32 s43, s42, 4096
    s_add_u32 s96, s44, 524288
    s_sub_u32 s95, s96, 16777216
    s_mov_b32 s62, 0
    s_mov_b32 s45, 0x3e0293ee
    s_mov_b32 s46, 0
    s_and_b32 s4, s25, 1
    s_lshl_b32 s4, s4, 14
    s_lshr_b32 s5, s25, 1
    s_lshl_b32 s5, s5, 12
    s_or_b32 s4, s4, s5
    s_xor_b32 s47, s47, s4
    s_and_b32 s5, s26, 1
    s_lshl_b32 s5, s5, 10
    s_lshr_b32 s4, s26, 1
    s_lshl_b32 s4, s4, 15
    s_or_b32 s5, s5, s4
    s_bfe_u32 s4, s26, 0x10004
    s_lshl_b32 s4, s4, 11
    s_xor_b32 s5, s5, s4
    s_xor_b32 s34, s5, s47
    s_xor_b32 s35, s34, 0x84000
    s_xor_b32 s36, s34, 0x101000
    s_xor_b32 s37, s34, 0x185000
    s_cmp_eq_u32 s24, 1
    s_cbranch_scc1 .w1_20
    s_cmp_eq_u32 s24, 2
    s_cbranch_scc1 .w2_21
    s_cmp_eq_u32 s24, 3
    s_cbranch_scc1 .w3_22
.w0_19:
    v_bfe_u32 v254, v1, 4, 2
    v_mul_u32_u24 v12, 128, v254
    v_bfe_u32 v254, v1, 0, 3
    v_mul_u32_u24 v254, 16, v254
    v_add_u32 v12, v12, v254
    v_add_u32 v12, 131072, v12
    v_add_u32 v12, s57, v12
    v_bfe_u32 v254, v1, 4, 2
    v_mul_u32_u24 v13, 128, v254
    v_bfe_u32 v254, v1, 2, 2
    v_mul_u32_u24 v254, 32, v254
    v_add_u32 v13, v13, v254
    v_bfe_u32 v254, v1, 0, 1
    v_mul_u32_u24 v254, 16, v254
    v_add_u32 v13, v13, v254
    v_add_u32 v13, 133120, v13
    v_add_u32 v13, s57, v13
    v_bfe_u32 v254, v1, 4, 2
    v_mul_u32_u24 v14, 128, v254
    v_bfe_u32 v254, v1, 0, 4
    v_mul_u32_u24 v254, 16, v254
    v_add_u32 v14, v14, v254
    v_add_u32 v14, 65536, v14
    v_add_u32 v14, s55, v14
    v_bfe_u32 v254, v1, 0, 6
    v_mul_u32_u24 v15, 16, v254
    v_bfe_u32 v254, v1, 2, 2
    v_mul_u32_u24 v16, 128, v254
    v_bfe_u32 v254, v1, 0, 2
    v_mul_u32_u24 v254, 16, v254
    v_add_u32 v16, v16, v254
    v_bfe_u32 v254, v1, 4, 2
    v_mul_u32_u24 v254, 4, v254
    v_add_u32 v16, v16, v254
    v_add_u32 v16, 18432, v16
    v_mov_b32 v144, 0
    v_mov_b32 v145, 0
    v_mov_b32 v146, 0
    v_mov_b32 v147, 0
    v_mov_b32 v148, 0
    v_mov_b32 v149, 0
    v_mov_b32 v150, 0
    v_mov_b32 v151, 0
    v_mov_b32 v152, 0
    v_mov_b32 v153, 0
    v_mov_b32 v154, 0
    v_mov_b32 v155, 0
    v_mov_b32 v156, 0
    v_mov_b32 v157, 0
    v_mov_b32 v158, 0
    v_mov_b32 v159, 0
    v_mov_b32 v160, 0
    v_mov_b32 v161, 0
    v_mov_b32 v162, 0
    v_mov_b32 v163, 0
    v_mov_b32 v164, 0
    v_mov_b32 v165, 0
    v_mov_b32 v166, 0
    v_mov_b32 v167, 0
    v_mov_b32 v168, 0
    v_mov_b32 v169, 0
    v_mov_b32 v170, 0
    v_mov_b32 v171, 0
    v_mov_b32 v172, 0
    v_mov_b32 v173, 0
    v_mov_b32 v174, 0
    v_mov_b32 v175, 0
    v_mov_b32 v208, 0
    v_mov_b32 v209, 0
    v_mov_b32 v210, 0
    v_mov_b32 v211, 0
    v_mov_b32 v212, 0
    v_mov_b32 v213, 0
    v_mov_b32 v214, 0
    v_mov_b32 v215, 0
    v_mov_b32 v216, 0
    v_mov_b32 v217, 0
    v_mov_b32 v218, 0
    v_mov_b32 v219, 0
    v_mov_b32 v18, 0xff800000
    v_cndmask_b32 v200, v18, 0, s[48:49]
    v_mov_b32 v220, 0x3f803f80
    v_cndmask_b32 v201, v18, 0, s[48:49]
    v_mov_b32 v221, 0x3f803f80
    v_cndmask_b32 v202, v18, 0, s[48:49]
    v_mov_b32 v222, 0x3f803f80
    v_cndmask_b32 v203, v18, 0, s[48:49]
    v_mov_b32 v223, 0x3f803f80
    s_waitcnt vmcnt(0)
    ds_read_b64_tr_b16 a[192:193], v242 offset:16384
    ds_read_b64_tr_b16 a[194:195], v242 offset:16896
    ds_read_b64_tr_b16 a[196:197], v242 offset:18432
    ds_read_b64_tr_b16 a[198:199], v242 offset:18944
    ds_read_b64_tr_b16 a[200:201], v242 offset:20480
    ds_read_b64_tr_b16 a[202:203], v242 offset:20992
    ds_read_b64_tr_b16 a[204:205], v242 offset:22528
    ds_read_b64_tr_b16 a[206:207], v242 offset:23040
    ds_read_b64_tr_b16 a[208:209], v242 offset:24576
    ds_read_b64_tr_b16 a[210:211], v242 offset:25088
    ds_read_b64_tr_b16 a[212:213], v242 offset:26624
    ds_read_b64_tr_b16 a[214:215], v242 offset:27136
    ds_read_b64_tr_b16 a[216:217], v242 offset:28672
    ds_read_b64_tr_b16 a[218:219], v242 offset:29184
    ds_read_b64_tr_b16 a[220:221], v242 offset:30720
    ds_read_b64_tr_b16 a[222:223], v242 offset:31232
    ds_read_b64_tr_b16 a[224:225], v243 offset:16384
    ds_read_b64_tr_b16 a[226:227], v243 offset:16896
    ds_read_b64_tr_b16 a[228:229], v243 offset:18432
    ds_read_b64_tr_b16 a[230:231], v243 offset:18944
    ds_read_b64_tr_b16 a[232:233], v243 offset:20480
    ds_read_b64_tr_b16 a[234:235], v243 offset:20992
    ds_read_b64_tr_b16 a[236:237], v243 offset:22528
    ds_read_b64_tr_b16 a[238:239], v243 offset:23040
    ds_read_b64_tr_b16 a[240:241], v243 offset:24576
    ds_read_b64_tr_b16 a[242:243], v243 offset:25088
    ds_read_b64_tr_b16 a[244:245], v243 offset:26624
    ds_read_b64_tr_b16 a[246:247], v243 offset:27136
    ds_read_b64_tr_b16 a[248:249], v243 offset:28672
    ds_read_b64_tr_b16 a[250:251], v243 offset:29184
    ds_read_b64_tr_b16 a[252:253], v243 offset:30720
    ds_read_b64_tr_b16 a[254:255], v243 offset:31232
    s_waitcnt lgkmcnt(0)
    s_barrier
    buffer_load_dwordx4 v[104:107], v15, s[8:11], s42 offen offset:0
    buffer_load_dwordx4 v[108:111], v15, s[8:11], s42 offen offset:1024
    buffer_load_dwordx4 v[112:115], v15, s[8:11], s42 offen offset:2048
    buffer_load_dwordx4 v[116:119], v15, s[8:11], s42 offen offset:3072
    buffer_load_dwordx4 v[120:123], v15, s[8:11], s43 offen offset:0
    buffer_load_dwordx4 v[124:127], v15, s[8:11], s43 offen offset:1024
    buffer_load_dwordx4 v[128:131], v15, s[8:11], s43 offen offset:2048
    buffer_load_dwordx4 v[132:135], v15, s[8:11], s43 offen offset:3072
    buffer_load_dwordx4 v[136:139], v15, s[8:11], s44 offen offset:0
    buffer_load_dwordx4 v[140:143], v15, s[8:11], s44 offen offset:1024
    s_add_u32 s42, s42, 262144
    s_add_u32 s43, s43, 262144
    s_add_u32 s44, s44, 262144
.p2align 6
.step_23:
    s_barrier
    s_setprio 3
    buffer_load_dwordx4 v[24:27], v3, s[8:11], s30 offen offset:0 sc1
    s_setprio 2
    buffer_load_dwordx4 v[28:31], v3, s[8:11], s30 offen offset:1024 sc1
    s_setprio 1
    buffer_load_dwordx4 v[32:35], v3, s[8:11], s30 offen offset:2048 sc1
    s_setprio 0
    buffer_load_dwordx4 v[36:39], v3, s[8:11], s30 offen offset:3072 sc1
    s_waitcnt vmcnt(3)
    v_max_u32 v18, v25, v27
    v_cmp_eq_u32 vcc, -1, v18
    s_cbranch_vccnz .gs_25
.gr_26:
    v_smfmac_f32_16x16x64_bf16 v[40:43], v[24:27], a[0:7], v2
    v_smfmac_f32_16x16x64_bf16 v[44:47], v[24:27], a[32:39], v2
    s_waitcnt vmcnt(2)
    v_max_u32 v18, v29, v31
    v_cmp_eq_u32 vcc, -1, v18
    v_smfmac_f32_16x16x64_bf16 v[48:51], v[24:27], a[64:71], v2
    s_cbranch_vccnz .gs_27
.gr_28:
    v_smfmac_f32_16x16x64_bf16 v[40:43], v[28:31], a[8:15], v2
    v_smfmac_f32_16x16x64_bf16 v[44:47], v[28:31], a[40:47], v2
    v_smfmac_f32_16x16x64_bf16 v[52:55], v[24:27], a[96:103], v2
    s_waitcnt vmcnt(1)
    v_max_u32 v18, v33, v35
    v_cmp_eq_u32 vcc, -1, v18
    v_smfmac_f32_16x16x64_bf16 v[48:51], v[28:31], a[72:79], v2
    s_cbranch_vccnz .gs_29
.gr_30:
    v_smfmac_f32_16x16x64_bf16 v[40:43], v[32:35], a[16:23], v2
    v_smfmac_f32_16x16x64_bf16 v[44:47], v[32:35], a[48:55], v2
    v_smfmac_f32_16x16x64_bf16 v[52:55], v[28:31], a[104:111], v2
    s_waitcnt vmcnt(0)
    v_max_u32 v18, v37, v39
    v_cmp_eq_u32 vcc, -1, v18
    v_smfmac_f32_16x16x64_bf16 v[48:51], v[32:35], a[80:87], v2
    s_cbranch_vccnz .gs_31
.gr_32:
    v_smfmac_f32_16x16x64_bf16 v[40:43], v[36:39], a[24:31], v2
    v_smfmac_f32_16x16x64_bf16 v[44:47], v[36:39], a[56:63], v2
    v_smfmac_f32_16x16x64_bf16 v[52:55], v[32:35], a[112:119], v2
    v_smfmac_f32_16x16x64_bf16 v[48:51], v[36:39], a[88:95], v2
    v_permlane32_swap_b32 v40, v44
    v_permlane32_swap_b32 v41, v45
    v_smfmac_f32_16x16x64_bf16 v[52:55], v[36:39], a[120:127], v2
    v_permlane32_swap_b32 v42, v46
    v_permlane32_swap_b32 v43, v47
    v_add_f32 v40, v40, v44
    v_add_f32 v41, v41, v45
    v_add_f32 v42, v42, v46
    v_add_f32 v43, v43, v47
    ds_write2_b32 v5, v40, v41 offset0:0 offset1:36
    ds_write2_b32 v5, v42, v43 offset0:72 offset1:108
    v_permlane32_swap_b32 v48, v52
    v_permlane32_swap_b32 v49, v53
    v_permlane32_swap_b32 v50, v54
    v_permlane32_swap_b32 v51, v55
    v_add_f32 v48, v48, v52
    v_add_f32 v49, v49, v53
    v_add_f32 v50, v50, v54
    v_add_f32 v51, v51, v55
    ds_write2_b32 v6, v48, v49 offset0:0 offset1:36
    ds_write2_b32 v6, v50, v51 offset0:72 offset1:108
    s_waitcnt lgkmcnt(2)
    s_barrier
    ds_read_b64 v[72:73], v9 offset:0
    ds_read_b64 v[74:75], v9 offset:1152
    ds_read_b64 v[76:77], v9 offset:2304
    ds_read_b64 v[78:79], v9 offset:3456
    s_waitcnt lgkmcnt(4)
    s_barrier
    s_waitcnt lgkmcnt(2)
    v_add_f32 v72, v72, v74
    v_add_f32 v73, v73, v75
    s_waitcnt lgkmcnt(0)
    v_add_f32 v76, v76, v78
    v_add_f32 v77, v77, v79
    v_add_f32 v72, v72, v76
    v_add_f32 v73, v73, v77
    v_cvt_pk_bf16_f32 v72, v72, v73
    v_min_u32 v72, 0xfffffffe, v72
    buffer_store_dword v72, v10, s[8:11], s30 offen
    v_smfmac_f32_16x16x64_bf16 v[56:59], v[24:27], a[128:135], v2
    v_smfmac_f32_16x16x64_bf16 v[60:63], v[24:27], a[160:167], v2
    v_smfmac_f32_16x16x64_bf16 v[56:59], v[28:31], a[136:143], v2
    v_smfmac_f32_16x16x64_bf16 v[60:63], v[28:31], a[168:175], v2
    v_smfmac_f32_16x16x64_bf16 v[56:59], v[32:35], a[144:151], v2
    v_smfmac_f32_16x16x64_bf16 v[60:63], v[32:35], a[176:183], v2
    v_smfmac_f32_16x16x64_bf16 v[56:59], v[36:39], a[152:159], v2
    v_smfmac_f32_16x16x64_bf16 v[60:63], v[36:39], a[184:191], v2
    v_mov_b32 v40, 0
    v_mov_b32 v41, 0
    v_mov_b32 v42, 0
    v_mov_b32 v43, 0
    v_mov_b32 v44, 0
    v_mov_b32 v45, 0
    v_mov_b32 v46, 0
    v_mov_b32 v47, 0
    v_permlane32_swap_b32 v56, v60
    v_permlane32_swap_b32 v57, v61
    v_permlane32_swap_b32 v58, v62
    v_permlane32_swap_b32 v59, v63
    v_add_f32 v56, v56, v60
    v_add_f32 v57, v57, v61
    v_add_f32 v58, v58, v62
    v_add_f32 v59, v59, v63
    ds_write_b128 v8, v[56:59]
    s_cmp_eq_u32 s28, 63
    s_cbranch_scc1 .fin_24
    s_waitcnt vmcnt(0)
    s_mov_b64 exec, s[48:49]
    buffer_load_dwordx4 v[144:147], v12, s[8:11], s30 offen offset:0 sc1
    buffer_load_dwordx4 v[148:151], v12, s[8:11], s30 offen offset:512 sc1
    buffer_load_dwordx4 v[152:155], v12, s[8:11], s30 offen offset:1024 sc1
    buffer_load_dwordx4 v[156:159], v12, s[8:11], s30 offen offset:1536 sc1
    s_mov_b64 exec, s[50:51]
    buffer_load_dwordx4 v[160:163], v12, s[8:11], s30 offen offset:0 sc1
    buffer_load_dwordx4 v[164:167], v12, s[8:11], s30 offen offset:512 sc1
    buffer_load_dwordx4 v[168:171], v12, s[8:11], s30 offen offset:1024 sc1
    buffer_load_dwordx4 v[172:175], v12, s[8:11], s30 offen offset:1536 sc1
    s_mov_b64 exec, -1
    buffer_load_dwordx4 v[176:179], v13, s[8:11], s30 offen offset:0 sc1
    buffer_load_dwordx4 v[180:183], v13, s[8:11], s30 offen offset:512 sc1
    buffer_load_dwordx4 v[184:187], v13, s[8:11], s30 offen offset:1024 sc1
    buffer_load_dwordx4 v[188:191], v13, s[8:11], s30 offen offset:1536 sc1
    s_waitcnt lgkmcnt(0)
    s_barrier
.mf_33:
    s_waitcnt vmcnt(11)
    v_mfma_f32_16x16x32_bf16 v[192:195], v[104:107], v[144:147], 0
    v_max3_u32 v18, v144, v145, v146
    v_max_u32 v18, v18, v147
    s_waitcnt vmcnt(10)
    v_mfma_f32_16x16x32_bf16 v[192:195], v[108:111], v[148:151], v[192:195]
    v_max3_u32 v18, v18, v148, v149
    v_max3_u32 v18, v18, v150, v151
    s_waitcnt vmcnt(9)
    v_mfma_f32_16x16x32_bf16 v[192:195], v[112:115], v[152:155], v[192:195]
    v_max3_u32 v18, v18, v152, v153
    v_max3_u32 v18, v18, v154, v155
    s_waitcnt vmcnt(8)
    v_mfma_f32_16x16x32_bf16 v[192:195], v[116:119], v[156:159], v[192:195]
    v_max3_u32 v18, v18, v156, v157
    v_max3_u32 v18, v18, v158, v159
    s_waitcnt vmcnt(7)
    v_mfma_f32_16x16x32_bf16 v[192:195], v[120:123], v[160:163], v[192:195]
    v_cmp_eq_u32 vcc, -1, v18
    s_waitcnt vmcnt(6)
    v_mfma_f32_16x16x32_bf16 v[192:195], v[124:127], v[164:167], v[192:195]
    s_cbranch_vccnz .re_34
    s_waitcnt vmcnt(5)
    v_mfma_f32_16x16x32_bf16 v[192:195], v[128:131], v[168:171], v[192:195]
    s_waitcnt vmcnt(4)
    v_mfma_f32_16x16x32_bf16 v[192:195], v[132:135], v[172:175], v[192:195]
.mk_35:
    s_waitcnt vmcnt(3)
    v_mfma_f32_16x16x32_bf16 v[196:199], v[176:179], v[144:147], v[200:203]
    v_max3_u32 v18, v176, v177, v178
    v_max_u32 v18, v18, v179
    s_waitcnt vmcnt(2)
    v_mfma_f32_16x16x32_bf16 v[196:199], v[180:183], v[148:151], v[196:199]
    v_max3_u32 v18, v18, v180, v181
    v_max3_u32 v18, v18, v182, v183
    s_waitcnt vmcnt(1)
    v_mfma_f32_16x16x32_bf16 v[196:199], v[184:187], v[152:155], v[196:199]
    v_max3_u32 v18, v18, v184, v185
    v_max3_u32 v18, v18, v186, v187
    s_waitcnt vmcnt(0)
    v_mfma_f32_16x16x32_bf16 v[196:199], v[188:191], v[156:159], v[196:199]
    v_max3_u32 v18, v18, v188, v189
    v_max3_u32 v18, v18, v190, v191
    v_cmp_eq_u32 vcc, -1, v18
    v_max3_f32 v19, v192, v193, v194
    s_cbranch_vccnz .rk_36
    s_barrier
    ds_read_b32 v212, v16
    ds_read_b32 v216, v16 offset:64
    v_max3_f32 v18, v195, v196, v197
    v_max_f32 v18, v18, v19
    s_nop 1
    v_max_f32_dpp v19, v18, v18 row_ror:8 row_mask:0xf bank_mask:0xf
    v_max_f32_dpp v17, v18, v18 row_ror:8 row_mask:0xf bank_mask:0xf
    s_nop 1
    v_permlane16_swap_b32 v19, v17
    v_max_f32 v18, v19, v17
    v_max_f32 v19, v19, v17
    s_nop 1
    v_permlane32_swap_b32 v18, v19
    v_max_f32 v18, v18, v19
    v_mul_f32 v18, s45, v18
    v_fma_f32 v240, v192, s45, -v18
    v_fma_f32 v241, v193, s45, -v18
    v_fma_f32 v242, v194, s45, -v18
    v_fma_f32 v243, v195, s45, -v18
    v_fma_f32 v244, v196, s45, -v18
    v_fma_f32 v245, v197, s45, -v18
    v_exp_f32 v240, v240
    v_exp_f32 v241, v241
    v_exp_f32 v242, v242
    v_exp_f32 v243, v243
    v_exp_f32 v244, v244
    v_exp_f32 v245, v245
    v_cvt_pk_bf16_f32 v204, v240, v241
    v_cvt_pk_bf16_f32 v205, v242, v243
    v_cvt_pk_bf16_f32 v208, v244, v245
    s_waitcnt lgkmcnt(0)
    v_mov_b32_dpp v206, v204 row_ror:8 row_mask:0xf bank_mask:0xf
    v_mov_b32_dpp v207, v205 row_ror:8 row_mask:0xf bank_mask:0xf
    v_mfma_f32_16x16x32_bf16 v[224:227], v[220:223], v[208:211], 0
    v_mfma_f32_16x16x32_bf16 v[224:227], v[220:223], v[204:207], v[224:227]
    v_mfma_f32_16x16x32_bf16 v[228:231], v[212:215], v[208:211], 0
    v_mfma_f32_16x16x32_bf16 v[228:231], v[136:139], v[204:207], v[228:231]
    v_mfma_f32_16x16x32_bf16 v[232:235], v[216:219], v[208:211], 0
    v_rcp_f32 v18, v224
    v_mfma_f32_16x16x32_bf16 v[232:235], v[140:143], v[204:207], v[232:235]
    s_mov_b64 exec, s[48:49]
    v_mul_f32 v228, v18, v228
    v_mul_f32 v229, v18, v229
    v_mul_f32 v230, v18, v230
    v_mul_f32 v231, v18, v231
    v_cvt_pk_bf16_f32 v236, v228, v229
    v_cvt_pk_bf16_f32 v237, v230, v231
    s_nop 1
    v_mul_f32 v232, v18, v232
    v_mul_f32 v233, v18, v233
    v_mul_f32 v234, v18, v234
    v_mul_f32 v235, v18, v235
    v_cvt_pk_bf16_f32 v238, v232, v233
    v_cvt_pk_bf16_f32 v239, v234, v235
    v_min_u32 v239, 0xfffffffe, v239
    buffer_store_dwordx4 v[236:239], v14, s[8:11], s30 offen
    s_mov_b64 exec, -1
    v_mov_b32 v48, 0
    v_mov_b32 v49, 0
    v_mov_b32 v50, 0
    v_mov_b32 v51, 0
    v_mov_b32 v52, 0
    v_mov_b32 v53, 0
    v_mov_b32 v54, 0
    v_mov_b32 v55, 0
    v_mov_b32 v56, 0
    v_mov_b32 v57, 0
    v_mov_b32 v58, 0
    v_mov_b32 v59, 0
    v_mov_b32 v60, 0
    v_mov_b32 v61, 0
    v_mov_b32 v62, 0
    v_mov_b32 v63, 0
    s_waitcnt vmcnt(0)
    s_barrier
    s_setprio 3
    buffer_load_dwordx4 v[24:27], v4, s[8:11], s30 offen offset:0 sc1
    s_setprio 2
    buffer_load_dwordx4 v[28:31], v4, s[8:11], s30 offen offset:1024 sc1
    s_setprio 1
    buffer_load_dwordx4 v[32:35], v4, s[8:11], s30 offen offset:2048 sc1
    s_setprio 0
    buffer_load_dwordx4 v[36:39], v4, s[8:11], s30 offen offset:3072 sc1
    s_waitcnt vmcnt(3)
    v_cmp_eq_u32 vcc, -1, v27
    s_cbranch_vccnz .gs_37
.gr_38:
    v_smfmac_f32_16x16x64_bf16 v[64:67], v[24:27], a[192:199], v2
    v_smfmac_f32_16x16x64_bf16 v[68:71], v[24:27], a[224:231], v2
    s_waitcnt vmcnt(2)
    v_cmp_eq_u32 vcc, -1, v31
    s_cbranch_vccnz .gs_39
.gr_40:
    v_smfmac_f32_16x16x64_bf16 v[64:67], v[28:31], a[200:207], v2
    v_smfmac_f32_16x16x64_bf16 v[68:71], v[28:31], a[232:239], v2
    s_waitcnt vmcnt(1)
    v_cmp_eq_u32 vcc, -1, v35
    s_cbranch_vccnz .gs_41
.gr_42:
    v_smfmac_f32_16x16x64_bf16 v[64:67], v[32:35], a[208:215], v2
    v_smfmac_f32_16x16x64_bf16 v[68:71], v[32:35], a[240:247], v2
    s_waitcnt vmcnt(0)
    v_cmp_eq_u32 vcc, -1, v39
    s_cbranch_vccnz .gs_43
.gr_44:
    v_smfmac_f32_16x16x64_bf16 v[64:67], v[36:39], a[216:223], v2
    v_smfmac_f32_16x16x64_bf16 v[68:71], v[36:39], a[248:255], v2
    s_nop 7
    v_permlane32_swap_b32 v64, v68
    v_permlane32_swap_b32 v65, v69
    v_permlane32_swap_b32 v66, v70
    v_permlane32_swap_b32 v67, v71
    v_add_f32 v64, v64, v68
    v_add_f32 v65, v65, v69
    v_add_f32 v66, v66, v70
    v_add_f32 v67, v67, v71
    ds_write2_b32 v7, v64, v65 offset0:0 offset1:36
    ds_write2_b32 v7, v66, v67 offset0:72 offset1:108
    s_waitcnt lgkmcnt(0)
    s_barrier
    buffer_load_dwordx4 v[104:107], v15, s[8:11], s42 offen offset:0
    buffer_load_dwordx4 v[108:111], v15, s[8:11], s42 offen offset:1024
    buffer_load_dwordx4 v[112:115], v15, s[8:11], s42 offen offset:2048
    buffer_load_dwordx4 v[116:119], v15, s[8:11], s42 offen offset:3072
    buffer_load_dwordx4 v[120:123], v15, s[8:11], s43 offen offset:0
    buffer_load_dwordx4 v[124:127], v15, s[8:11], s43 offen offset:1024
    buffer_load_dwordx4 v[128:131], v15, s[8:11], s43 offen offset:2048
    buffer_load_dwordx4 v[132:135], v15, s[8:11], s43 offen offset:3072
    buffer_load_dwordx4 v[136:139], v15, s[8:11], s44 offen offset:0
    buffer_load_dwordx4 v[140:143], v15, s[8:11], s44 offen offset:1024
    s_add_u32 s42, s42, 262144
    s_add_u32 s43, s43, 262144
    s_add_u32 s44, s44, 262144
    v_mov_b32 v64, 0
    v_mov_b32 v65, 0
    v_mov_b32 v66, 0
    v_mov_b32 v67, 0
    v_mov_b32 v68, 0
    v_mov_b32 v69, 0
    v_mov_b32 v70, 0
    v_mov_b32 v71, 0
    s_mov_b32 s4, s30
    s_mov_b32 s30, s31
    s_mov_b32 s31, s32
    s_mov_b32 s32, s33
    s_mov_b32 s33, s4
    s_add_u32 s28, s28, 1
    s_mov_b32 s62, 0
    s_branch .step_23
.fin_24:
    s_waitcnt lgkmcnt(0)
    s_barrier
    s_barrier
    s_endpgm
.gs_25:
    buffer_load_dwordx4 v[24:27], v3, s[8:11], s30 offen offset:0 sc1
    buffer_load_dwordx4 v[28:31], v3, s[8:11], s30 offen offset:1024 sc1
    buffer_load_dwordx4 v[32:35], v3, s[8:11], s30 offen offset:2048 sc1
    buffer_load_dwordx4 v[36:39], v3, s[8:11], s30 offen offset:3072 sc1
    s_add_u32 s62, s62, 1
    s_cmp_gt_u32 s62, 0x100000
    s_cbranch_scc1 .mg_end_1
    s_waitcnt vmcnt(3)
    v_max_u32 v18, v25, v27
    v_cmp_eq_u32 vcc, -1, v18
    s_cbranch_vccz .gr_26
    s_branch .gs_25
.gs_27:
    buffer_load_dwordx4 v[28:31], v3, s[8:11], s30 offen offset:1024 sc1
    buffer_load_dwordx4 v[32:35], v3, s[8:11], s30 offen offset:2048 sc1
    buffer_load_dwordx4 v[36:39], v3, s[8:11], s30 offen offset:3072 sc1
    s_add_u32 s62, s62, 1
    s_cmp_gt_u32 s62, 0x100000
    s_cbranch_scc1 .mg_end_1
    s_waitcnt vmcnt(2)
    v_max_u32 v18, v29, v31
    v_cmp_eq_u32 vcc, -1, v18
    s_cbranch_vccz .gr_28
    s_branch .gs_27
.gs_29:
    buffer_load_dwordx4 v[32:35], v3, s[8:11], s30 offen offset:2048 sc1
    buffer_load_dwordx4 v[36:39], v3, s[8:11], s30 offen offset:3072 sc1
    s_add_u32 s62, s62, 1
    s_cmp_gt_u32 s62, 0x100000
    s_cbranch_scc1 .mg_end_1
    s_waitcnt vmcnt(1)
    v_max_u32 v18, v33, v35
    v_cmp_eq_u32 vcc, -1, v18
    s_cbranch_vccz .gr_30
    s_branch .gs_29
.gs_31:
    buffer_load_dwordx4 v[36:39], v3, s[8:11], s30 offen offset:3072 sc1
    s_add_u32 s62, s62, 1
    s_cmp_gt_u32 s62, 0x100000
    s_cbranch_scc1 .mg_end_1
    s_waitcnt vmcnt(0)
    v_max_u32 v18, v37, v39
    v_cmp_eq_u32 vcc, -1, v18
    s_cbranch_vccz .gr_32
    s_branch .gs_31
.re_34:
    s_mov_b64 exec, s[48:49]
    buffer_load_dwordx4 v[144:147], v12, s[8:11], s30 offen offset:0 sc1
    buffer_load_dwordx4 v[148:151], v12, s[8:11], s30 offen offset:512 sc1
    buffer_load_dwordx4 v[152:155], v12, s[8:11], s30 offen offset:1024 sc1
    buffer_load_dwordx4 v[156:159], v12, s[8:11], s30 offen offset:1536 sc1
    s_mov_b64 exec, s[50:51]
    buffer_load_dwordx4 v[160:163], v12, s[8:11], s30 offen offset:0 sc1
    buffer_load_dwordx4 v[164:167], v12, s[8:11], s30 offen offset:512 sc1
    buffer_load_dwordx4 v[168:171], v12, s[8:11], s30 offen offset:1024 sc1
    buffer_load_dwordx4 v[172:175], v12, s[8:11], s30 offen offset:1536 sc1
    s_mov_b64 exec, -1
    buffer_load_dwordx4 v[176:179], v13, s[8:11], s30 offen offset:0 sc1
    buffer_load_dwordx4 v[180:183], v13, s[8:11], s30 offen offset:512 sc1
    buffer_load_dwordx4 v[184:187], v13, s[8:11], s30 offen offset:1024 sc1
    buffer_load_dwordx4 v[188:191], v13, s[8:11], s30 offen offset:1536 sc1
    s_add_u32 s62, s62, 1
    s_cmp_gt_u32 s62, 0x100000
    s_cbranch_scc1 .mg_end_1
    s_branch .mf_33
.rk_36:
    buffer_load_dwordx4 v[176:179], v13, s[8:11], s30 offen offset:0 sc1
    buffer_load_dwordx4 v[180:183], v13, s[8:11], s30 offen offset:512 sc1
    buffer_load_dwordx4 v[184:187], v13, s[8:11], s30 offen offset:1024 sc1
    buffer_load_dwordx4 v[188:191], v13, s[8:11], s30 offen offset:1536 sc1
    s_add_u32 s62, s62, 1
    s_cmp_gt_u32 s62, 0x100000
    s_cbranch_scc1 .mg_end_1
    s_branch .mk_35
.gs_37:
    buffer_load_dwordx4 v[24:27], v4, s[8:11], s30 offen offset:0 sc1
    buffer_load_dwordx4 v[28:31], v4, s[8:11], s30 offen offset:1024 sc1
    buffer_load_dwordx4 v[32:35], v4, s[8:11], s30 offen offset:2048 sc1
    buffer_load_dwordx4 v[36:39], v4, s[8:11], s30 offen offset:3072 sc1
    s_add_u32 s62, s62, 1
    s_cmp_gt_u32 s62, 0x100000
    s_cbranch_scc1 .mg_end_1
    s_waitcnt vmcnt(3)
    v_cmp_eq_u32 vcc, -1, v27
    s_cbranch_vccz .gr_38
    s_branch .gs_37
.gs_39:
    buffer_load_dwordx4 v[28:31], v4, s[8:11], s30 offen offset:1024 sc1
    buffer_load_dwordx4 v[32:35], v4, s[8:11], s30 offen offset:2048 sc1
    buffer_load_dwordx4 v[36:39], v4, s[8:11], s30 offen offset:3072 sc1
    s_add_u32 s62, s62, 1
    s_cmp_gt_u32 s62, 0x100000
    s_cbranch_scc1 .mg_end_1
    s_waitcnt vmcnt(2)
    v_cmp_eq_u32 vcc, -1, v31
    s_cbranch_vccz .gr_40
    s_branch .gs_39
.gs_41:
    buffer_load_dwordx4 v[32:35], v4, s[8:11], s30 offen offset:2048 sc1
    buffer_load_dwordx4 v[36:39], v4, s[8:11], s30 offen offset:3072 sc1
    s_add_u32 s62, s62, 1
    s_cmp_gt_u32 s62, 0x100000
    s_cbranch_scc1 .mg_end_1
    s_waitcnt vmcnt(1)
    v_cmp_eq_u32 vcc, -1, v35
    s_cbranch_vccz .gr_42
    s_branch .gs_41
.gs_43:
    buffer_load_dwordx4 v[36:39], v4, s[8:11], s30 offen offset:3072 sc1
    s_add_u32 s62, s62, 1
    s_cmp_gt_u32 s62, 0x100000
    s_cbranch_scc1 .mg_end_1
    s_waitcnt vmcnt(0)
    v_cmp_eq_u32 vcc, -1, v39
    s_cbranch_vccz .gr_44
    s_branch .gs_43
.w1_20:
    v_bfe_u32 v254, v1, 1, 3
    v_mul_u32_u24 v12, 144, v254
    v_bfe_u32 v254, v1, 4, 2
    v_mul_u32_u24 v254, 32, v254
    v_add_u32 v12, v12, v254
    v_bfe_u32 v254, v1, 0, 1
    v_mul_u32_u24 v254, 16, v254
    v_add_u32 v12, v12, v254
    v_add_u32 v12, 9216, v12
    v_bfe_u32 v254, v1, 0, 6
    v_mul_u32_u24 v13, 16, v254
    v_add_u32 v13, s101, v13
    v_bfe_u32 v254, v1, 0, 6
    v_mul_u32_u24 v14, 8, v254
    v_add_u32 v14, s55, v14
    s_waitcnt vmcnt(0)
    ds_read_b64_tr_b16 a[192:193], v242 offset:16384
    ds_read_b64_tr_b16 a[194:195], v242 offset:16896
    ds_read_b64_tr_b16 a[196:197], v242 offset:18432
    ds_read_b64_tr_b16 a[198:199], v242 offset:18944
    ds_read_b64_tr_b16 a[200:201], v242 offset:20480
    ds_read_b64_tr_b16 a[202:203], v242 offset:20992
    ds_read_b64_tr_b16 a[204:205], v242 offset:22528
    ds_read_b64_tr_b16 a[206:207], v242 offset:23040
    ds_read_b64_tr_b16 a[208:209], v242 offset:24576
    ds_read_b64_tr_b16 a[210:211], v242 offset:25088
    ds_read_b64_tr_b16 a[212:213], v242 offset:26624
    ds_read_b64_tr_b16 a[214:215], v242 offset:27136
    ds_read_b64_tr_b16 a[216:217], v242 offset:28672
    ds_read_b64_tr_b16 a[218:219], v242 offset:29184
    ds_read_b64_tr_b16 a[220:221], v242 offset:30720
    ds_read_b64_tr_b16 a[222:223], v242 offset:31232
    ds_read_b64_tr_b16 a[224:225], v243 offset:16384
    ds_read_b64_tr_b16 a[226:227], v243 offset:16896
    ds_read_b64_tr_b16 a[228:229], v243 offset:18432
    ds_read_b64_tr_b16 a[230:231], v243 offset:18944
    ds_read_b64_tr_b16 a[232:233], v243 offset:20480
    ds_read_b64_tr_b16 a[234:235], v243 offset:20992
    ds_read_b64_tr_b16 a[236:237], v243 offset:22528
    ds_read_b64_tr_b16 a[238:239], v243 offset:23040
    ds_read_b64_tr_b16 a[240:241], v243 offset:24576
    ds_read_b64_tr_b16 a[242:243], v243 offset:25088
    ds_read_b64_tr_b16 a[244:245], v243 offset:26624
    ds_read_b64_tr_b16 a[246:247], v243 offset:27136
    ds_read_b64_tr_b16 a[248:249], v243 offset:28672
    ds_read_b64_tr_b16 a[250:251], v243 offset:29184
    ds_read_b64_tr_b16 a[252:253], v243 offset:30720
    ds_read_b64_tr_b16 a[254:255], v243 offset:31232
    s_waitcnt lgkmcnt(0)
    s_barrier
.p2align 6
.step_45:
    s_waitcnt vmcnt(0)
    s_barrier
    s_setprio 3
    buffer_load_dwordx4 v[24:27], v3, s[8:11], s30 offen offset:0 sc1
    s_setprio 2
    buffer_load_dwordx4 v[28:31], v3, s[8:11], s30 offen offset:1024 sc1
    s_setprio 1
    buffer_load_dwordx4 v[32:35], v3, s[8:11], s30 offen offset:2048 sc1
    s_setprio 0
    buffer_load_dwordx4 v[36:39], v3, s[8:11], s30 offen offset:3072 sc1
    s_waitcnt vmcnt(3)
    v_max_u32 v18, v25, v27
    v_cmp_eq_u32 vcc, -1, v18
    s_cbranch_vccnz .gs_47
.gr_48:
    v_smfmac_f32_16x16x64_bf16 v[40:43], v[24:27], a[0:7], v2
    v_smfmac_f32_16x16x64_bf16 v[44:47], v[24:27], a[32:39], v2
    s_waitcnt vmcnt(2)
    v_max_u32 v18, v29, v31
    v_cmp_eq_u32 vcc, -1, v18
    v_smfmac_f32_16x16x64_bf16 v[48:51], v[24:27], a[64:71], v2
    s_cbranch_vccnz .gs_49
.gr_50:
    v_smfmac_f32_16x16x64_bf16 v[40:43], v[28:31], a[8:15], v2
    v_smfmac_f32_16x16x64_bf16 v[44:47], v[28:31], a[40:47], v2
    v_smfmac_f32_16x16x64_bf16 v[52:55], v[24:27], a[96:103], v2
    s_waitcnt vmcnt(1)
    v_max_u32 v18, v33, v35
    v_cmp_eq_u32 vcc, -1, v18
    v_smfmac_f32_16x16x64_bf16 v[48:51], v[28:31], a[72:79], v2
    s_cbranch_vccnz .gs_51
.gr_52:
    v_smfmac_f32_16x16x64_bf16 v[40:43], v[32:35], a[16:23], v2
    v_smfmac_f32_16x16x64_bf16 v[44:47], v[32:35], a[48:55], v2
    v_smfmac_f32_16x16x64_bf16 v[52:55], v[28:31], a[104:111], v2
    s_waitcnt vmcnt(0)
    v_max_u32 v18, v37, v39
    v_cmp_eq_u32 vcc, -1, v18
    v_smfmac_f32_16x16x64_bf16 v[48:51], v[32:35], a[80:87], v2
    s_cbranch_vccnz .gs_53
.gr_54:
    v_smfmac_f32_16x16x64_bf16 v[40:43], v[36:39], a[24:31], v2
    v_smfmac_f32_16x16x64_bf16 v[44:47], v[36:39], a[56:63], v2
    v_smfmac_f32_16x16x64_bf16 v[52:55], v[32:35], a[112:119], v2
    v_smfmac_f32_16x16x64_bf16 v[48:51], v[36:39], a[88:95], v2
    v_permlane32_swap_b32 v40, v44
    v_permlane32_swap_b32 v41, v45
    v_smfmac_f32_16x16x64_bf16 v[52:55], v[36:39], a[120:127], v2
    v_permlane32_swap_b32 v42, v46
    v_permlane32_swap_b32 v43, v47
    v_add_f32 v40, v40, v44
    v_add_f32 v41, v41, v45
    v_add_f32 v42, v42, v46
    v_add_f32 v43, v43, v47
    ds_write2_b32 v5, v40, v41 offset0:0 offset1:36
    ds_write2_b32 v5, v42, v43 offset0:72 offset1:108
    v_permlane32_swap_b32 v48, v52
    v_permlane32_swap_b32 v49, v53
    v_permlane32_swap_b32 v50, v54
    v_permlane32_swap_b32 v51, v55
    v_add_f32 v48, v48, v52
    v_add_f32 v49, v49, v53
    v_add_f32 v50, v50, v54
    v_add_f32 v51, v51, v55
    ds_write2_b32 v6, v48, v49 offset0:0 offset1:36
    ds_write2_b32 v6, v50, v51 offset0:72 offset1:108
    s_waitcnt lgkmcnt(2)
    s_barrier
    ds_read_b64 v[72:73], v9 offset:0
    ds_read_b64 v[74:75], v9 offset:1152
    ds_read_b64 v[76:77], v9 offset:2304
    ds_read_b64 v[78:79], v9 offset:3456
    s_waitcnt lgkmcnt(4)
    s_barrier
    s_waitcnt lgkmcnt(2)
    v_add_f32 v72, v72, v74
    v_add_f32 v73, v73, v75
    s_waitcnt lgkmcnt(0)
    v_add_f32 v76, v76, v78
    v_add_f32 v77, v77, v79
    v_add_f32 v72, v72, v76
    v_add_f32 v73, v73, v77
    v_cvt_pk_bf16_f32 v72, v72, v73
    v_min_u32 v72, 0xfffffffe, v72
    buffer_store_dword v72, v10, s[8:11], s30 offen
    v_smfmac_f32_16x16x64_bf16 v[56:59], v[24:27], a[128:135], v2
    v_smfmac_f32_16x16x64_bf16 v[60:63], v[24:27], a[160:167], v2
    v_smfmac_f32_16x16x64_bf16 v[56:59], v[28:31], a[136:143], v2
    v_smfmac_f32_16x16x64_bf16 v[60:63], v[28:31], a[168:175], v2
    v_smfmac_f32_16x16x64_bf16 v[56:59], v[32:35], a[144:151], v2
    v_smfmac_f32_16x16x64_bf16 v[60:63], v[32:35], a[176:183], v2
    v_smfmac_f32_16x16x64_bf16 v[56:59], v[36:39], a[152:159], v2
    v_smfmac_f32_16x16x64_bf16 v[60:63], v[36:39], a[184:191], v2
    v_mov_b32 v40, 0
    v_mov_b32 v41, 0
    v_mov_b32 v42, 0
    v_mov_b32 v43, 0
    v_mov_b32 v44, 0
    v_mov_b32 v45, 0
    v_mov_b32 v46, 0
    v_mov_b32 v47, 0
    v_permlane32_swap_b32 v56, v60
    v_permlane32_swap_b32 v57, v61
    v_permlane32_swap_b32 v58, v62
    v_permlane32_swap_b32 v59, v63
    v_add_f32 v56, v56, v60
    v_add_f32 v57, v57, v61
    v_add_f32 v58, v58, v62
    v_add_f32 v59, v59, v63
    ds_write_b128 v8, v[56:59]
    s_waitcnt lgkmcnt(0)
    s_barrier
    s_barrier
    s_cmp_eq_u32 s28, 63
    s_cbranch_scc1 .fin_46
    s_xor_b32 s38, s34, 0x4000
    s_xor_b32 s39, s34, 0x1000
    s_xor_b32 s40, s34, 0x5000
    v_mov_b32 v48, 0
    v_mov_b32 v49, 0
    v_mov_b32 v50, 0
    v_mov_b32 v51, 0
    v_mov_b32 v52, 0
    v_mov_b32 v53, 0
    v_mov_b32 v54, 0
    v_mov_b32 v55, 0
    v_mov_b32 v56, 0
    v_mov_b32 v57, 0
    v_mov_b32 v58, 0
    v_mov_b32 v59, 0
    v_mov_b32 v60, 0
    v_mov_b32 v61, 0
    v_mov_b32 v62, 0
    v_mov_b32 v63, 0
    s_barrier
    s_setprio 3
    buffer_load_dwordx4 v[24:27], v4, s[8:11], s30 offen offset:0 sc1
    s_setprio 2
    buffer_load_dwordx4 v[28:31], v4, s[8:11], s30 offen offset:1024 sc1
    s_setprio 1
    buffer_load_dwordx4 v[32:35], v4, s[8:11], s30 offen offset:2048 sc1
    s_setprio 0
    buffer_load_dwordx4 v[36:39], v4, s[8:11], s30 offen offset:3072 sc1
    s_waitcnt vmcnt(3)
    v_cmp_eq_u32 vcc, -1, v27
    s_cbranch_vccnz .gs_55
.gr_56:
    v_smfmac_f32_16x16x64_bf16 v[64:67], v[24:27], a[192:199], v2
    v_smfmac_f32_16x16x64_bf16 v[68:71], v[24:27], a[224:231], v2
    s_waitcnt vmcnt(2)
    v_cmp_eq_u32 vcc, -1, v31
    s_cbranch_vccnz .gs_57
.gr_58:
    v_smfmac_f32_16x16x64_bf16 v[64:67], v[28:31], a[200:207], v2
    v_smfmac_f32_16x16x64_bf16 v[68:71], v[28:31], a[232:239], v2
    s_waitcnt vmcnt(1)
    v_cmp_eq_u32 vcc, -1, v35
    s_cbranch_vccnz .gs_59
.gr_60:
    v_smfmac_f32_16x16x64_bf16 v[64:67], v[32:35], a[208:215], v2
    v_smfmac_f32_16x16x64_bf16 v[68:71], v[32:35], a[240:247], v2
    s_waitcnt vmcnt(0)
    v_cmp_eq_u32 vcc, -1, v39
    s_cbranch_vccnz .gs_61
.gr_62:
    v_smfmac_f32_16x16x64_bf16 v[64:67], v[36:39], a[216:223], v2
    v_smfmac_f32_16x16x64_bf16 v[68:71], v[36:39], a[248:255], v2
    s_nop 7
    v_permlane32_swap_b32 v64, v68
    v_permlane32_swap_b32 v65, v69
    v_permlane32_swap_b32 v66, v70
    v_permlane32_swap_b32 v67, v71
    v_add_f32 v64, v64, v68
    v_add_f32 v65, v65, v69
    v_add_f32 v66, v66, v70
    v_add_f32 v67, v67, v71
    ds_write2_b32 v7, v64, v65 offset0:0 offset1:36
    ds_write2_b32 v7, v66, v67 offset0:72 offset1:108
    s_waitcnt lgkmcnt(0)
    s_barrier
    ds_read_b128 v[72:75], v12 offset:0
    ds_read_b128 v[76:79], v12 offset:1152
    ds_read_b128 v[80:83], v12 offset:2304
    ds_read_b128 v[84:87], v12 offset:3456
    s_waitcnt lgkmcnt(2)
    v_add_f32 v72, v72, v76
    v_add_f32 v73, v73, v77
    v_add_f32 v74, v74, v78
    v_add_f32 v75, v75, v79
    s_waitcnt lgkmcnt(0)
    v_add_f32 v80, v80, v84
    v_add_f32 v81, v81, v85
    v_add_f32 v82, v82, v86
    v_add_f32 v83, v83, v87
    v_add_f32 v72, v72, v80
    v_add_f32 v73, v73, v81
    v_add_f32 v74, v74, v82
    v_add_f32 v75, v75, v83
    v_min_u32 v75, 0xfffffffe, v75
    buffer_store_dwordx4 v[72:75], v13, s[8:11], s34 offen sc1
    v_mov_b32 v64, 0
    v_mov_b32 v65, 0
    v_mov_b32 v66, 0
    v_mov_b32 v67, 0
    v_mov_b32 v68, 0
    v_mov_b32 v69, 0
    v_mov_b32 v70, 0
    v_mov_b32 v71, 0
    s_waitcnt vmcnt(0)
.pl_63:
    buffer_load_dwordx4 v[76:79], v13, s[8:11], s38 offen sc1
    buffer_load_dwordx4 v[80:83], v13, s[8:11], s39 offen sc1
    buffer_load_dwordx4 v[84:87], v13, s[8:11], s40 offen sc1
    s_waitcnt vmcnt(2)
    v_add_f32 v88, v72, v76
    v_add_f32 v89, v73, v77
    v_add_f32 v90, v74, v78
    v_add_f32 v91, v75, v79
    s_waitcnt vmcnt(0)
    v_max3_u32 v18, v79, v83, v87
    v_cmp_eq_u32 vcc, -1, v18
    v_add_f32 v80, v80, v84
    v_add_f32 v81, v81, v85
    v_add_f32 v82, v82, v86
    v_add_f32 v83, v83, v87
    v_add_f32 v88, v88, v80
    v_add_f32 v89, v89, v81
    v_add_f32 v90, v90, v82
    v_add_f32 v91, v91, v83
    v_cvt_pk_bf16_f32 v92, v88, v89
    v_cvt_pk_bf16_f32 v93, v90, v91
    v_min_u32 v93, 0xfffffffe, v93
    s_cbranch_vccnz .pr_64
    buffer_store_dwordx2 v[92:93], v14, s[8:11], s31 offen
    s_mov_b32 s4, s30
    s_mov_b32 s30, s31
    s_mov_b32 s31, s32
    s_mov_b32 s32, s33
    s_mov_b32 s33, s4
    s_add_u32 s28, s28, 1
    s_mov_b32 s62, 0
    s_mov_b32 s4, s34
    s_mov_b32 s34, s35
    s_mov_b32 s35, s36
    s_mov_b32 s36, s37
    s_mov_b32 s37, s4
    s_branch .step_45
.fin_46:
    s_endpgm
.gs_47:
    buffer_load_dwordx4 v[24:27], v3, s[8:11], s30 offen offset:0 sc1
    buffer_load_dwordx4 v[28:31], v3, s[8:11], s30 offen offset:1024 sc1
    buffer_load_dwordx4 v[32:35], v3, s[8:11], s30 offen offset:2048 sc1
    buffer_load_dwordx4 v[36:39], v3, s[8:11], s30 offen offset:3072 sc1
    s_add_u32 s62, s62, 1
    s_cmp_gt_u32 s62, 0x100000
    s_cbranch_scc1 .mg_end_1
    s_waitcnt vmcnt(3)
    v_max_u32 v18, v25, v27
    v_cmp_eq_u32 vcc, -1, v18
    s_cbranch_vccz .gr_48
    s_branch .gs_47
.gs_49:
    buffer_load_dwordx4 v[28:31], v3, s[8:11], s30 offen offset:1024 sc1
    buffer_load_dwordx4 v[32:35], v3, s[8:11], s30 offen offset:2048 sc1
    buffer_load_dwordx4 v[36:39], v3, s[8:11], s30 offen offset:3072 sc1
    s_add_u32 s62, s62, 1
    s_cmp_gt_u32 s62, 0x100000
    s_cbranch_scc1 .mg_end_1
    s_waitcnt vmcnt(2)
    v_max_u32 v18, v29, v31
    v_cmp_eq_u32 vcc, -1, v18
    s_cbranch_vccz .gr_50
    s_branch .gs_49
.gs_51:
    buffer_load_dwordx4 v[32:35], v3, s[8:11], s30 offen offset:2048 sc1
    buffer_load_dwordx4 v[36:39], v3, s[8:11], s30 offen offset:3072 sc1
    s_add_u32 s62, s62, 1
    s_cmp_gt_u32 s62, 0x100000
    s_cbranch_scc1 .mg_end_1
    s_waitcnt vmcnt(1)
    v_max_u32 v18, v33, v35
    v_cmp_eq_u32 vcc, -1, v18
    s_cbranch_vccz .gr_52
    s_branch .gs_51
.gs_53:
    buffer_load_dwordx4 v[36:39], v3, s[8:11], s30 offen offset:3072 sc1
    s_add_u32 s62, s62, 1
    s_cmp_gt_u32 s62, 0x100000
    s_cbranch_scc1 .mg_end_1
    s_waitcnt vmcnt(0)
    v_max_u32 v18, v37, v39
    v_cmp_eq_u32 vcc, -1, v18
    s_cbranch_vccz .gr_54
    s_branch .gs_53
.gs_55:
    buffer_load_dwordx4 v[24:27], v4, s[8:11], s30 offen offset:0 sc1
    buffer_load_dwordx4 v[28:31], v4, s[8:11], s30 offen offset:1024 sc1
    buffer_load_dwordx4 v[32:35], v4, s[8:11], s30 offen offset:2048 sc1
    buffer_load_dwordx4 v[36:39], v4, s[8:11], s30 offen offset:3072 sc1
    s_add_u32 s62, s62, 1
    s_cmp_gt_u32 s62, 0x100000
    s_cbranch_scc1 .mg_end_1
    s_waitcnt vmcnt(3)
    v_cmp_eq_u32 vcc, -1, v27
    s_cbranch_vccz .gr_56
    s_branch .gs_55
.gs_57:
    buffer_load_dwordx4 v[28:31], v4, s[8:11], s30 offen offset:1024 sc1
    buffer_load_dwordx4 v[32:35], v4, s[8:11], s30 offen offset:2048 sc1
    buffer_load_dwordx4 v[36:39], v4, s[8:11], s30 offen offset:3072 sc1
    s_add_u32 s62, s62, 1
    s_cmp_gt_u32 s62, 0x100000
    s_cbranch_scc1 .mg_end_1
    s_waitcnt vmcnt(2)
    v_cmp_eq_u32 vcc, -1, v31
    s_cbranch_vccz .gr_58
    s_branch .gs_57
.gs_59:
    buffer_load_dwordx4 v[32:35], v4, s[8:11], s30 offen offset:2048 sc1
    buffer_load_dwordx4 v[36:39], v4, s[8:11], s30 offen offset:3072 sc1
    s_add_u32 s62, s62, 1
    s_cmp_gt_u32 s62, 0x100000
    s_cbranch_scc1 .mg_end_1
    s_waitcnt vmcnt(1)
    v_cmp_eq_u32 vcc, -1, v35
    s_cbranch_vccz .gr_60
    s_branch .gs_59
.gs_61:
    buffer_load_dwordx4 v[36:39], v4, s[8:11], s30 offen offset:3072 sc1
    s_add_u32 s62, s62, 1
    s_cmp_gt_u32 s62, 0x100000
    s_cbranch_scc1 .mg_end_1
    s_waitcnt vmcnt(0)
    v_cmp_eq_u32 vcc, -1, v39
    s_cbranch_vccz .gr_62
    s_branch .gs_61
.pr_64:
    s_add_u32 s62, s62, 1
    s_cmp_gt_u32 s62, 0x100000
    s_cbranch_scc1 .mg_end_1
    s_branch .pl_63
.w2_21:
    s_lshl_b32 s4, s56, 7
    s_lshl_b32 s5, s53, 2
    s_add_u32 s4, s4, s5
    s_add_u32 s4, s4, 92274688
    v_mov_b32 v14, s4
    v_bfe_u32 v254, v1, 0, 6
    v_mul_u32_u24 v12, 16, v254
    v_add_u32 v12, 17920, v12
    s_waitcnt vmcnt(0)
    ds_read_b64_tr_b16 a[192:193], v242 offset:16384
    ds_read_b64_tr_b16 a[194:195], v242 offset:16896
    ds_read_b64_tr_b16 a[196:197], v242 offset:18432
    ds_read_b64_tr_b16 a[198:199], v242 offset:18944
    ds_read_b64_tr_b16 a[200:201], v242 offset:20480
    ds_read_b64_tr_b16 a[202:203], v242 offset:20992
    ds_read_b64_tr_b16 a[204:205], v242 offset:22528
    ds_read_b64_tr_b16 a[206:207], v242 offset:23040
    ds_read_b64_tr_b16 a[208:209], v242 offset:24576
    ds_read_b64_tr_b16 a[210:211], v242 offset:25088
    ds_read_b64_tr_b16 a[212:213], v242 offset:26624
    ds_read_b64_tr_b16 a[214:215], v242 offset:27136
    ds_read_b64_tr_b16 a[216:217], v242 offset:28672
    ds_read_b64_tr_b16 a[218:219], v242 offset:29184
    ds_read_b64_tr_b16 a[220:221], v242 offset:30720
    ds_read_b64_tr_b16 a[222:223], v242 offset:31232
    ds_read_b64_tr_b16 a[224:225], v243 offset:16384
    ds_read_b64_tr_b16 a[226:227], v243 offset:16896
    ds_read_b64_tr_b16 a[228:229], v243 offset:18432
    ds_read_b64_tr_b16 a[230:231], v243 offset:18944
    ds_read_b64_tr_b16 a[232:233], v243 offset:20480
    ds_read_b64_tr_b16 a[234:235], v243 offset:20992
    ds_read_b64_tr_b16 a[236:237], v243 offset:22528
    ds_read_b64_tr_b16 a[238:239], v243 offset:23040
    ds_read_b64_tr_b16 a[240:241], v243 offset:24576
    ds_read_b64_tr_b16 a[242:243], v243 offset:25088
    ds_read_b64_tr_b16 a[244:245], v243 offset:26624
    ds_read_b64_tr_b16 a[246:247], v243 offset:27136
    ds_read_b64_tr_b16 a[248:249], v243 offset:28672
    ds_read_b64_tr_b16 a[250:251], v243 offset:29184
    ds_read_b64_tr_b16 a[252:253], v243 offset:30720
    ds_read_b64_tr_b16 a[254:255], v243 offset:31232
    s_waitcnt lgkmcnt(0)
    s_barrier
.p2align 6
.step_65:
    s_barrier
    s_setprio 3
    buffer_load_dwordx4 v[24:27], v3, s[8:11], s30 offen offset:0 sc1
    s_setprio 2
    buffer_load_dwordx4 v[28:31], v3, s[8:11], s30 offen offset:1024 sc1
    s_setprio 1
    buffer_load_dwordx4 v[32:35], v3, s[8:11], s30 offen offset:2048 sc1
    s_setprio 0
    buffer_load_dwordx4 v[36:39], v3, s[8:11], s30 offen offset:3072 sc1
    s_waitcnt vmcnt(3)
    v_max_u32 v18, v25, v27
    v_cmp_eq_u32 vcc, -1, v18
    s_cbranch_vccnz .gs_67
.gr_68:
    v_smfmac_f32_16x16x64_bf16 v[40:43], v[24:27], a[0:7], v2
    v_smfmac_f32_16x16x64_bf16 v[44:47], v[24:27], a[32:39], v2
    s_waitcnt vmcnt(2)
    v_max_u32 v18, v29, v31
    v_cmp_eq_u32 vcc, -1, v18
    v_smfmac_f32_16x16x64_bf16 v[48:51], v[24:27], a[64:71], v2
    s_cbranch_vccnz .gs_69
.gr_70:
    v_smfmac_f32_16x16x64_bf16 v[40:43], v[28:31], a[8:15], v2
    v_smfmac_f32_16x16x64_bf16 v[44:47], v[28:31], a[40:47], v2
    v_smfmac_f32_16x16x64_bf16 v[52:55], v[24:27], a[96:103], v2
    s_waitcnt vmcnt(1)
    v_max_u32 v18, v33, v35
    v_cmp_eq_u32 vcc, -1, v18
    v_smfmac_f32_16x16x64_bf16 v[48:51], v[28:31], a[72:79], v2
    s_cbranch_vccnz .gs_71
.gr_72:
    v_smfmac_f32_16x16x64_bf16 v[40:43], v[32:35], a[16:23], v2
    v_smfmac_f32_16x16x64_bf16 v[44:47], v[32:35], a[48:55], v2
    v_smfmac_f32_16x16x64_bf16 v[52:55], v[28:31], a[104:111], v2
    s_waitcnt vmcnt(0)
    v_max_u32 v18, v37, v39
    v_cmp_eq_u32 vcc, -1, v18
    v_smfmac_f32_16x16x64_bf16 v[48:51], v[32:35], a[80:87], v2
    s_cbranch_vccnz .gs_73
.gr_74:
    v_smfmac_f32_16x16x64_bf16 v[40:43], v[36:39], a[24:31], v2
    v_smfmac_f32_16x16x64_bf16 v[44:47], v[36:39], a[56:63], v2
    v_smfmac_f32_16x16x64_bf16 v[52:55], v[32:35], a[112:119], v2
    v_smfmac_f32_16x16x64_bf16 v[48:51], v[36:39], a[88:95], v2
    v_permlane32_swap_b32 v40, v44
    v_permlane32_swap_b32 v41, v45
    v_smfmac_f32_16x16x64_bf16 v[52:55], v[36:39], a[120:127], v2
    v_permlane32_swap_b32 v42, v46
    v_permlane32_swap_b32 v43, v47
    v_add_f32 v40, v40, v44
    v_add_f32 v41, v41, v45
    v_add_f32 v42, v42, v46
    v_add_f32 v43, v43, v47
    ds_write2_b32 v5, v40, v41 offset0:0 offset1:36
    ds_write2_b32 v5, v42, v43 offset0:72 offset1:108
    v_permlane32_swap_b32 v48, v52
    v_permlane32_swap_b32 v49, v53
    v_permlane32_swap_b32 v50, v54
    v_permlane32_swap_b32 v51, v55
    v_add_f32 v48, v48, v52
    v_add_f32 v49, v49, v53
    v_add_f32 v50, v50, v54
    v_add_f32 v51, v51, v55
    ds_write2_b32 v6, v48, v49 offset0:0 offset1:36
    ds_write2_b32 v6, v50, v51 offset0:72 offset1:108
    s_waitcnt lgkmcnt(2)
    s_barrier
    s_waitcnt lgkmcnt(0)
    s_barrier
    ds_read_b64 v[72:73], v9 offset:0
    ds_read_b64 v[74:75], v9 offset:1152
    ds_read_b64 v[76:77], v9 offset:2304
    ds_read_b64 v[78:79], v9 offset:3456
    s_waitcnt lgkmcnt(2)
    v_add_f32 v72, v72, v74
    v_add_f32 v73, v73, v75
    s_waitcnt lgkmcnt(0)
    v_add_f32 v76, v76, v78
    v_add_f32 v77, v77, v79
    v_add_f32 v72, v72, v76
    v_add_f32 v73, v73, v77
    v_cvt_pk_bf16_f32 v72, v72, v73
    v_min_u32 v72, 0xfffffffe, v72
    buffer_store_dword v72, v10, s[8:11], s30 offen
    v_smfmac_f32_16x16x64_bf16 v[56:59], v[24:27], a[128:135], v2
    v_smfmac_f32_16x16x64_bf16 v[60:63], v[24:27], a[160:167], v2
    v_smfmac_f32_16x16x64_bf16 v[56:59], v[28:31], a[136:143], v2
    v_smfmac_f32_16x16x64_bf16 v[60:63], v[28:31], a[168:175], v2
    v_smfmac_f32_16x16x64_bf16 v[56:59], v[32:35], a[144:151], v2
    v_smfmac_f32_16x16x64_bf16 v[60:63], v[32:35], a[176:183], v2
    v_smfmac_f32_16x16x64_bf16 v[56:59], v[36:39], a[152:159], v2
    v_smfmac_f32_16x16x64_bf16 v[60:63], v[36:39], a[184:191], v2
    ds_write_b32 v11, v72
    v_mov_b32 v40, 0
    v_mov_b32 v41, 0
    v_mov_b32 v42, 0
    v_mov_b32 v43, 0
    v_mov_b32 v44, 0
    v_mov_b32 v45, 0
    v_mov_b32 v46, 0
    v_mov_b32 v47, 0
    v_permlane32_swap_b32 v56, v60
    v_permlane32_swap_b32 v57, v61
    v_permlane32_swap_b32 v58, v62
    v_permlane32_swap_b32 v59, v63
    v_add_f32 v56, v56, v60
    v_add_f32 v57, v57, v61
    v_add_f32 v58, v58, v62
    v_add_f32 v59, v59, v63
    ds_write_b128 v8, v[56:59]
    s_waitcnt lgkmcnt(0)
    s_barrier
    s_barrier
    ds_read_b128 v[72:75], v12
    s_cmp_eq_u32 s28, 63
    s_cbranch_scc1 .fin_66
    v_mov_b32 v48, 0
    v_mov_b32 v49, 0
    v_mov_b32 v50, 0
    v_mov_b32 v51, 0
    v_mov_b32 v52, 0
    v_mov_b32 v53, 0
    v_mov_b32 v54, 0
    v_mov_b32 v55, 0
    v_mov_b32 v56, 0
    v_mov_b32 v57, 0
    v_mov_b32 v58, 0
    v_mov_b32 v59, 0
    v_mov_b32 v60, 0
    v_mov_b32 v61, 0
    v_mov_b32 v62, 0
    v_mov_b32 v63, 0
    s_barrier
    s_setprio 3
    buffer_load_dwordx4 v[24:27], v4, s[8:11], s30 offen offset:0 sc1
    s_setprio 2
    buffer_load_dwordx4 v[28:31], v4, s[8:11], s30 offen offset:1024 sc1
    s_setprio 1
    buffer_load_dwordx4 v[32:35], v4, s[8:11], s30 offen offset:2048 sc1
    s_setprio 0
    buffer_load_dwordx4 v[36:39], v4, s[8:11], s30 offen offset:3072 sc1
    s_waitcnt vmcnt(3)
    v_cmp_eq_u32 vcc, -1, v27
    s_cbranch_vccnz .gs_75
.gr_76:
    v_smfmac_f32_16x16x64_bf16 v[64:67], v[24:27], a[192:199], v2
    v_smfmac_f32_16x16x64_bf16 v[68:71], v[24:27], a[224:231], v2
    s_waitcnt vmcnt(2)
    v_cmp_eq_u32 vcc, -1, v31
    s_cbranch_vccnz .gs_77
.gr_78:
    v_smfmac_f32_16x16x64_bf16 v[64:67], v[28:31], a[200:207], v2
    v_smfmac_f32_16x16x64_bf16 v[68:71], v[28:31], a[232:239], v2
    s_waitcnt vmcnt(1)
    v_cmp_eq_u32 vcc, -1, v35
    s_cbranch_vccnz .gs_79
.gr_80:
    v_smfmac_f32_16x16x64_bf16 v[64:67], v[32:35], a[208:215], v2
    v_smfmac_f32_16x16x64_bf16 v[68:71], v[32:35], a[240:247], v2
    s_waitcnt vmcnt(0)
    v_cmp_eq_u32 vcc, -1, v39
    s_cbranch_vccnz .gs_81
.gr_82:
    v_smfmac_f32_16x16x64_bf16 v[64:67], v[36:39], a[216:223], v2
    v_smfmac_f32_16x16x64_bf16 v[68:71], v[36:39], a[248:255], v2
    s_nop 7
    v_permlane32_swap_b32 v64, v68
    v_permlane32_swap_b32 v65, v69
    v_permlane32_swap_b32 v66, v70
    v_permlane32_swap_b32 v67, v71
    v_add_f32 v64, v64, v68
    v_add_f32 v65, v65, v69
    v_add_f32 v66, v66, v70
    v_add_f32 v67, v67, v71
    ds_write2_b32 v7, v64, v65 offset0:0 offset1:36
    ds_write2_b32 v7, v66, v67 offset0:72 offset1:108
    s_waitcnt lgkmcnt(0)
    s_barrier
    buffer_store_dwordx4 v[72:75], v244, s[8:11], s41 offen sc1
    v_mov_b32 v18, s28
    s_mov_b64 exec, 1
    buffer_store_dword v18, v14, s[8:11], 0 offen sc1
    s_mov_b64 exec, -1
    v_mov_b32 v64, 0
    v_mov_b32 v65, 0
    v_mov_b32 v66, 0
    v_mov_b32 v67, 0
    v_mov_b32 v68, 0
    v_mov_b32 v69, 0
    v_mov_b32 v70, 0
    v_mov_b32 v71, 0
    s_mov_b32 s4, s30
    s_mov_b32 s30, s31
    s_mov_b32 s31, s32
    s_mov_b32 s32, s33
    s_mov_b32 s33, s4
    s_add_u32 s28, s28, 1
    s_mov_b32 s62, 0
    s_add_u32 s41, s41, 0x20000
    s_branch .step_65
.fin_66:
    s_waitcnt lgkmcnt(0)
    buffer_store_dwordx4 v[72:75], v244, s[8:11], s41 offen sc1
    s_waitcnt vmcnt(0)
    v_mov_b32 v18, 64
    s_mov_b64 exec, 1
    buffer_store_dword v18, v14, s[8:11], 0 offen sc1
    s_mov_b64 exec, -1
    s_endpgm
.gs_67:
    buffer_load_dwordx4 v[24:27], v3, s[8:11], s30 offen offset:0 sc1
    buffer_load_dwordx4 v[28:31], v3, s[8:11], s30 offen offset:1024 sc1
    buffer_load_dwordx4 v[32:35], v3, s[8:11], s30 offen offset:2048 sc1
    buffer_load_dwordx4 v[36:39], v3, s[8:11], s30 offen offset:3072 sc1
    s_add_u32 s62, s62, 1
    s_cmp_gt_u32 s62, 0x100000
    s_cbranch_scc1 .mg_end_1
    s_waitcnt vmcnt(3)
    v_max_u32 v18, v25, v27
    v_cmp_eq_u32 vcc, -1, v18
    s_cbranch_vccz .gr_68
    s_branch .gs_67
.gs_69:
    buffer_load_dwordx4 v[28:31], v3, s[8:11], s30 offen offset:1024 sc1
    buffer_load_dwordx4 v[32:35], v3, s[8:11], s30 offen offset:2048 sc1
    buffer_load_dwordx4 v[36:39], v3, s[8:11], s30 offen offset:3072 sc1
    s_add_u32 s62, s62, 1
    s_cmp_gt_u32 s62, 0x100000
    s_cbranch_scc1 .mg_end_1
    s_waitcnt vmcnt(2)
    v_max_u32 v18, v29, v31
    v_cmp_eq_u32 vcc, -1, v18
    s_cbranch_vccz .gr_70
    s_branch .gs_69
.gs_71:
    buffer_load_dwordx4 v[32:35], v3, s[8:11], s30 offen offset:2048 sc1
    buffer_load_dwordx4 v[36:39], v3, s[8:11], s30 offen offset:3072 sc1
    s_add_u32 s62, s62, 1
    s_cmp_gt_u32 s62, 0x100000
    s_cbranch_scc1 .mg_end_1
    s_waitcnt vmcnt(1)
    v_max_u32 v18, v33, v35
    v_cmp_eq_u32 vcc, -1, v18
    s_cbranch_vccz .gr_72
    s_branch .gs_71
.gs_73:
    buffer_load_dwordx4 v[36:39], v3, s[8:11], s30 offen offset:3072 sc1
    s_add_u32 s62, s62, 1
    s_cmp_gt_u32 s62, 0x100000
    s_cbranch_scc1 .mg_end_1
    s_waitcnt vmcnt(0)
    v_max_u32 v18, v37, v39
    v_cmp_eq_u32 vcc, -1, v18
    s_cbranch_vccz .gr_74
    s_branch .gs_73
.gs_75:
    buffer_load_dwordx4 v[24:27], v4, s[8:11], s30 offen offset:0 sc1
    buffer_load_dwordx4 v[28:31], v4, s[8:11], s30 offen offset:1024 sc1
    buffer_load_dwordx4 v[32:35], v4, s[8:11], s30 offen offset:2048 sc1
    buffer_load_dwordx4 v[36:39], v4, s[8:11], s30 offen offset:3072 sc1
    s_add_u32 s62, s62, 1
    s_cmp_gt_u32 s62, 0x100000
    s_cbranch_scc1 .mg_end_1
    s_waitcnt vmcnt(3)
    v_cmp_eq_u32 vcc, -1, v27
    s_cbranch_vccz .gr_76
    s_branch .gs_75
.gs_77:
    buffer_load_dwordx4 v[28:31], v4, s[8:11], s30 offen offset:1024 sc1
    buffer_load_dwordx4 v[32:35], v4, s[8:11], s30 offen offset:2048 sc1
    buffer_load_dwordx4 v[36:39], v4, s[8:11], s30 offen offset:3072 sc1
    s_add_u32 s62, s62, 1
    s_cmp_gt_u32 s62, 0x100000
    s_cbranch_scc1 .mg_end_1
    s_waitcnt vmcnt(2)
    v_cmp_eq_u32 vcc, -1, v31
    s_cbranch_vccz .gr_78
    s_branch .gs_77
.gs_79:
    buffer_load_dwordx4 v[32:35], v4, s[8:11], s30 offen offset:2048 sc1
    buffer_load_dwordx4 v[36:39], v4, s[8:11], s30 offen offset:3072 sc1
    s_add_u32 s62, s62, 1
    s_cmp_gt_u32 s62, 0x100000
    s_cbranch_scc1 .mg_end_1
    s_waitcnt vmcnt(1)
    v_cmp_eq_u32 vcc, -1, v35
    s_cbranch_vccz .gr_80
    s_branch .gs_79
.gs_81:
    buffer_load_dwordx4 v[36:39], v4, s[8:11], s30 offen offset:3072 sc1
    s_add_u32 s62, s62, 1
    s_cmp_gt_u32 s62, 0x100000
    s_cbranch_scc1 .mg_end_1
    s_waitcnt vmcnt(0)
    v_cmp_eq_u32 vcc, -1, v39
    s_cbranch_vccz .gr_82
    s_branch .gs_81
.w3_22:
    v_bfe_u32 v254, v1, 3, 1
    v_mul_u32_u24 v12, 512, v254
    v_bfe_u32 v254, v1, 5, 1
    v_mul_u32_u24 v254, 256, v254
    v_add_u32 v12, v12, v254
    v_bfe_u32 v254, v1, 2, 1
    v_mul_u32_u24 v254, 128, v254
    v_add_u32 v12, v12, v254
    v_bfe_u32 v254, v1, 0, 2
    v_mul_u32_u24 v254, 16, v254
    v_add_u32 v12, v12, v254
    v_bfe_u32 v254, v1, 4, 1
    v_mul_u32_u24 v254, 8, v254
    v_add_u32 v12, v12, v254
    v_add_u32 v12, 13824, v12
    v_bfe_u32 v254, v1, 2, 2
    v_mul_u32_u24 v14, 128, v254
    v_bfe_u32 v254, v1, 0, 2
    v_mul_u32_u24 v254, 16, v254
    v_add_u32 v14, v14, v254
    v_bfe_u32 v254, v1, 4, 2
    v_mul_u32_u24 v254, 4, v254
    v_add_u32 v14, v14, v254
    v_add_u32 v14, 18432, v14
    v_bfe_u32 v254, v1, 0, 6
    v_mul_u32_u24 v15, 16, v254
    v_add_u32 v15, s101, v15
    s_lshl_b32 s4, s56, 7
    s_add_u32 s4, s4, 92278784
    v_bfe_u32 v254, v1, 0, 2
    v_mul_u32_u24 v13, 4, v254
    v_bfe_u32 v254, v1, 2, 1
    v_mul_u32_u24 v254, 4096, v254
    v_add_u32 v13, v13, v254
    v_add_u32 v13, s4, v13
    s_waitcnt vmcnt(0)
    ds_read_b64_tr_b16 a[192:193], v242 offset:16384
    ds_read_b64_tr_b16 a[194:195], v242 offset:16896
    ds_read_b64_tr_b16 a[196:197], v242 offset:18432
    ds_read_b64_tr_b16 a[198:199], v242 offset:18944
    ds_read_b64_tr_b16 a[200:201], v242 offset:20480
    ds_read_b64_tr_b16 a[202:203], v242 offset:20992
    ds_read_b64_tr_b16 a[204:205], v242 offset:22528
    ds_read_b64_tr_b16 a[206:207], v242 offset:23040
    ds_read_b64_tr_b16 a[208:209], v242 offset:24576
    ds_read_b64_tr_b16 a[210:211], v242 offset:25088
    ds_read_b64_tr_b16 a[212:213], v242 offset:26624
    ds_read_b64_tr_b16 a[214:215], v242 offset:27136
    ds_read_b64_tr_b16 a[216:217], v242 offset:28672
    ds_read_b64_tr_b16 a[218:219], v242 offset:29184
    ds_read_b64_tr_b16 a[220:221], v242 offset:30720
    ds_read_b64_tr_b16 a[222:223], v242 offset:31232
    ds_read_b64_tr_b16 a[224:225], v243 offset:16384
    ds_read_b64_tr_b16 a[226:227], v243 offset:16896
    ds_read_b64_tr_b16 a[228:229], v243 offset:18432
    ds_read_b64_tr_b16 a[230:231], v243 offset:18944
    ds_read_b64_tr_b16 a[232:233], v243 offset:20480
    ds_read_b64_tr_b16 a[234:235], v243 offset:20992
    ds_read_b64_tr_b16 a[236:237], v243 offset:22528
    ds_read_b64_tr_b16 a[238:239], v243 offset:23040
    ds_read_b64_tr_b16 a[240:241], v243 offset:24576
    ds_read_b64_tr_b16 a[242:243], v243 offset:25088
    ds_read_b64_tr_b16 a[244:245], v243 offset:26624
    ds_read_b64_tr_b16 a[246:247], v243 offset:27136
    ds_read_b64_tr_b16 a[248:249], v243 offset:28672
    ds_read_b64_tr_b16 a[250:251], v243 offset:29184
    ds_read_b64_tr_b16 a[252:253], v243 offset:30720
    ds_read_b64_tr_b16 a[254:255], v243 offset:31232
    s_waitcnt lgkmcnt(0)
    s_cmp_ge_u32 s46, 2
    s_cbranch_scc1 .kvd_84
    s_mov_b32 s62, 0
.kv_83:
    buffer_load_dword v18, v13, s[8:11], 0 offen sc1
    s_add_u32 s62, s62, 1
    s_cmp_gt_u32 s62, 0x100000
    s_cbranch_scc1 .mg_end_1
    s_waitcnt vmcnt(0)
    v_min_u32_dpp v18, v18, v18 quad_perm:[1,0,3,2] row_mask:0xf bank_mask:0xf
    s_nop 1
    v_min_u32_dpp v18, v18, v18 quad_perm:[2,3,0,1] row_mask:0xf bank_mask:0xf
    s_nop 1
    v_min_u32_dpp v18, v18, v18 row_half_mirror row_mask:0xf bank_mask:0xf
    s_nop 0
    v_readfirstlane_b32 s46, v18
    s_cmp_lt_u32 s46, 2
    s_cbranch_scc1 .kv_83
.kvd_84:
    s_barrier
.p2align 6
.step_85:
    s_barrier
    s_setprio 3
    buffer_load_dwordx4 v[24:27], v3, s[8:11], s30 offen offset:0 sc1
    s_setprio 2
    buffer_load_dwordx4 v[28:31], v3, s[8:11], s30 offen offset:1024 sc1
    s_setprio 1
    buffer_load_dwordx4 v[32:35], v3, s[8:11], s30 offen offset:2048 sc1
    s_setprio 0
    buffer_load_dwordx4 v[36:39], v3, s[8:11], s30 offen offset:3072 sc1
    s_waitcnt vmcnt(3)
    v_max_u32 v18, v25, v27
    v_cmp_eq_u32 vcc, -1, v18
    s_cbranch_vccnz .gs_87
.gr_88:
    v_smfmac_f32_16x16x64_bf16 v[40:43], v[24:27], a[0:7], v2
    v_smfmac_f32_16x16x64_bf16 v[44:47], v[24:27], a[32:39], v2
    s_waitcnt vmcnt(2)
    v_max_u32 v18, v29, v31
    v_cmp_eq_u32 vcc, -1, v18
    v_smfmac_f32_16x16x64_bf16 v[48:51], v[24:27], a[64:71], v2
    s_cbranch_vccnz .gs_89
.gr_90:
    v_smfmac_f32_16x16x64_bf16 v[40:43], v[28:31], a[8:15], v2
    v_smfmac_f32_16x16x64_bf16 v[44:47], v[28:31], a[40:47], v2
    v_smfmac_f32_16x16x64_bf16 v[52:55], v[24:27], a[96:103], v2
    s_waitcnt vmcnt(1)
    v_max_u32 v18, v33, v35
    v_cmp_eq_u32 vcc, -1, v18
    v_smfmac_f32_16x16x64_bf16 v[48:51], v[28:31], a[72:79], v2
    s_cbranch_vccnz .gs_91
.gr_92:
    v_smfmac_f32_16x16x64_bf16 v[40:43], v[32:35], a[16:23], v2
    v_smfmac_f32_16x16x64_bf16 v[44:47], v[32:35], a[48:55], v2
    v_smfmac_f32_16x16x64_bf16 v[52:55], v[28:31], a[104:111], v2
    s_waitcnt vmcnt(0)
    v_max_u32 v18, v37, v39
    v_cmp_eq_u32 vcc, -1, v18
    v_smfmac_f32_16x16x64_bf16 v[48:51], v[32:35], a[80:87], v2
    s_cbranch_vccnz .gs_93
.gr_94:
    v_smfmac_f32_16x16x64_bf16 v[40:43], v[36:39], a[24:31], v2
    v_smfmac_f32_16x16x64_bf16 v[44:47], v[36:39], a[56:63], v2
    v_smfmac_f32_16x16x64_bf16 v[52:55], v[32:35], a[112:119], v2
    v_smfmac_f32_16x16x64_bf16 v[48:51], v[36:39], a[88:95], v2
    v_permlane32_swap_b32 v40, v44
    v_permlane32_swap_b32 v41, v45
    v_smfmac_f32_16x16x64_bf16 v[52:55], v[36:39], a[120:127], v2
    v_permlane32_swap_b32 v42, v46
    v_permlane32_swap_b32 v43, v47
    v_add_f32 v40, v40, v44
    v_add_f32 v41, v41, v45
    v_add_f32 v42, v42, v46
    v_add_f32 v43, v43, v47
    ds_write2_b32 v5, v40, v41 offset0:0 offset1:36
    ds_write2_b32 v5, v42, v43 offset0:72 offset1:108
    v_permlane32_swap_b32 v48, v52
    v_permlane32_swap_b32 v49, v53
    v_permlane32_swap_b32 v50, v54
    v_permlane32_swap_b32 v51, v55
    v_add_f32 v48, v48, v52
    v_add_f32 v49, v49, v53
    v_add_f32 v50, v50, v54
    v_add_f32 v51, v51, v55
    ds_write2_b32 v6, v48, v49 offset0:0 offset1:36
    ds_write2_b32 v6, v50, v51 offset0:72 offset1:108
    s_waitcnt lgkmcnt(2)
    s_barrier
    s_waitcnt lgkmcnt(0)
    s_barrier
    ds_read_b64 v[72:73], v9 offset:0
    ds_read_b64 v[74:75], v9 offset:1152
    ds_read_b64 v[76:77], v9 offset:2304
    ds_read_b64 v[78:79], v9 offset:3456
    s_waitcnt lgkmcnt(2)
    v_add_f32 v72, v72, v74
    v_add_f32 v73, v73, v75
    s_waitcnt lgkmcnt(0)
    v_add_f32 v76, v76, v78
    v_add_f32 v77, v77, v79
    v_add_f32 v72, v72, v76
    v_add_f32 v73, v73, v77
    v_cvt_pk_bf16_f32 v72, v72, v73
    v_min_u32 v72, 0xfffffffe, v72
    buffer_store_dword v72, v10, s[8:11], s30 offen
    v_smfmac_f32_16x16x64_bf16 v[56:59], v[24:27], a[128:135], v2
    v_smfmac_f32_16x16x64_bf16 v[60:63], v[24:27], a[160:167], v2
    v_smfmac_f32_16x16x64_bf16 v[56:59], v[28:31], a[136:143], v2
    v_smfmac_f32_16x16x64_bf16 v[60:63], v[28:31], a[168:175], v2
    v_smfmac_f32_16x16x64_bf16 v[56:59], v[32:35], a[144:151], v2
    v_smfmac_f32_16x16x64_bf16 v[60:63], v[32:35], a[176:183], v2
    v_smfmac_f32_16x16x64_bf16 v[56:59], v[36:39], a[152:159], v2
    v_smfmac_f32_16x16x64_bf16 v[60:63], v[36:39], a[184:191], v2
    ds_write_b32 v11, v72
    v_mov_b32 v40, 0
    v_mov_b32 v41, 0
    v_mov_b32 v42, 0
    v_mov_b32 v43, 0
    v_mov_b32 v44, 0
    v_mov_b32 v45, 0
    v_mov_b32 v46, 0
    v_mov_b32 v47, 0
    v_permlane32_swap_b32 v56, v60
    v_permlane32_swap_b32 v57, v61
    v_permlane32_swap_b32 v58, v62
    v_permlane32_swap_b32 v59, v63
    v_add_f32 v56, v56, v60
    v_add_f32 v57, v57, v61
    v_add_f32 v58, v58, v62
    v_add_f32 v59, v59, v63
    ds_write_b128 v8, v[56:59]
    s_waitcnt lgkmcnt(0)
    s_barrier
    ds_read_b64 v[72:73], v12 offset:0
    ds_read_b64 v[74:75], v12 offset:1024
    ds_read_b64 v[76:77], v12 offset:2048
    ds_read_b64 v[78:79], v12 offset:3072
    ds_read_b64 v[80:81], v12 offset:64
    ds_read_b64 v[82:83], v12 offset:1088
    ds_read_b64 v[84:85], v12 offset:2112
    ds_read_b64 v[86:87], v12 offset:3136
    s_waitcnt lgkmcnt(4)
    v_add_f32 v72, v72, v74
    v_add_f32 v73, v73, v75
    v_add_f32 v76, v76, v78
    v_add_f32 v77, v77, v79
    v_add_f32 v72, v72, v76
    v_add_f32 v73, v73, v77
    v_cvt_pk_bf16_f32 v72, v72, v73
    s_waitcnt lgkmcnt(0)
    v_add_f32 v80, v80, v82
    v_add_f32 v81, v81, v83
    v_add_f32 v84, v84, v86
    v_add_f32 v85, v85, v87
    v_add_f32 v80, v80, v84
    v_add_f32 v81, v81, v85
    v_cvt_pk_bf16_f32 v80, v80, v81
    ds_write_b32 v14, v72
    ds_write_b32 v14, v80 offset:64
    s_waitcnt lgkmcnt(0)
    s_barrier
    s_cmp_eq_u32 s28, 63
    s_cbranch_scc1 .fin_86
    v_mov_b32 v48, 0
    v_mov_b32 v49, 0
    v_mov_b32 v50, 0
    v_mov_b32 v51, 0
    v_mov_b32 v52, 0
    v_mov_b32 v53, 0
    v_mov_b32 v54, 0
    v_mov_b32 v55, 0
    v_mov_b32 v56, 0
    v_mov_b32 v57, 0
    v_mov_b32 v58, 0
    v_mov_b32 v59, 0
    v_mov_b32 v60, 0
    v_mov_b32 v61, 0
    v_mov_b32 v62, 0
    v_mov_b32 v63, 0
    s_barrier
    s_setprio 3
    buffer_load_dwordx4 v[24:27], v4, s[8:11], s30 offen offset:0 sc1
    s_setprio 2
    buffer_load_dwordx4 v[28:31], v4, s[8:11], s30 offen offset:1024 sc1
    s_setprio 1
    buffer_load_dwordx4 v[32:35], v4, s[8:11], s30 offen offset:2048 sc1
    s_setprio 0
    buffer_load_dwordx4 v[36:39], v4, s[8:11], s30 offen offset:3072 sc1
    s_waitcnt vmcnt(3)
    v_cmp_eq_u32 vcc, -1, v27
    s_cbranch_vccnz .gs_95
.gr_96:
    v_smfmac_f32_16x16x64_bf16 v[64:67], v[24:27], a[192:199], v2
    v_smfmac_f32_16x16x64_bf16 v[68:71], v[24:27], a[224:231], v2
    s_waitcnt vmcnt(2)
    v_cmp_eq_u32 vcc, -1, v31
    s_cbranch_vccnz .gs_97
.gr_98:
    v_smfmac_f32_16x16x64_bf16 v[64:67], v[28:31], a[200:207], v2
    v_smfmac_f32_16x16x64_bf16 v[68:71], v[28:31], a[232:239], v2
    s_waitcnt vmcnt(1)
    v_cmp_eq_u32 vcc, -1, v35
    s_cbranch_vccnz .gs_99
.gr_100:
    v_smfmac_f32_16x16x64_bf16 v[64:67], v[32:35], a[208:215], v2
    v_smfmac_f32_16x16x64_bf16 v[68:71], v[32:35], a[240:247], v2
    s_waitcnt vmcnt(0)
    v_cmp_eq_u32 vcc, -1, v39
    s_cbranch_vccnz .gs_101
.gr_102:
    v_smfmac_f32_16x16x64_bf16 v[64:67], v[36:39], a[216:223], v2
    v_smfmac_f32_16x16x64_bf16 v[68:71], v[36:39], a[248:255], v2
    s_nop 7
    v_permlane32_swap_b32 v64, v68
    v_permlane32_swap_b32 v65, v69
    v_permlane32_swap_b32 v66, v70
    v_permlane32_swap_b32 v67, v71
    v_add_f32 v64, v64, v68
    v_add_f32 v65, v65, v69
    v_add_f32 v66, v66, v70
    v_add_f32 v67, v67, v71
    ds_write2_b32 v7, v64, v65 offset0:0 offset1:36
    ds_write2_b32 v7, v66, v67 offset0:72 offset1:108
    s_waitcnt lgkmcnt(0)
    s_barrier
    buffer_store_dwordx4 v[20:23], v15, s[8:11], s36 offen sc1
    buffer_store_dwordx4 v[20:23], v244, s[8:11], s32 offen
    buffer_store_dwordx4 v[20:23], v245, s[8:11], s32 offen
    s_add_u32 s5, s28, 3
    s_min_u32 s5, s5, 64
    s_cmp_ge_u32 s46, s5
    s_cbranch_scc1 .kvd_104
    s_mov_b32 s62, 0
.kv_103:
    buffer_load_dword v18, v13, s[8:11], 0 offen sc1
    s_add_u32 s62, s62, 1
    s_cmp_gt_u32 s62, 0x100000
    s_cbranch_scc1 .mg_end_1
    s_waitcnt vmcnt(0)
    v_min_u32_dpp v18, v18, v18 quad_perm:[1,0,3,2] row_mask:0xf bank_mask:0xf
    s_nop 1
    v_min_u32_dpp v18, v18, v18 quad_perm:[2,3,0,1] row_mask:0xf bank_mask:0xf
    s_nop 1
    v_min_u32_dpp v18, v18, v18 row_half_mirror row_mask:0xf bank_mask:0xf
    s_nop 0
    v_readfirstlane_b32 s46, v18
    s_cmp_lt_u32 s46, s5
    s_cbranch_scc1 .kv_103
.kvd_104:
    v_mov_b32 v64, 0
    v_mov_b32 v65, 0
    v_mov_b32 v66, 0
    v_mov_b32 v67, 0
    v_mov_b32 v68, 0
    v_mov_b32 v69, 0
    v_mov_b32 v70, 0
    v_mov_b32 v71, 0
    s_mov_b32 s4, s30
    s_mov_b32 s30, s31
    s_mov_b32 s31, s32
    s_mov_b32 s32, s33
    s_mov_b32 s33, s4
    s_add_u32 s28, s28, 1
    s_mov_b32 s62, 0
    s_mov_b32 s4, s34
    s_mov_b32 s34, s35
    s_mov_b32 s35, s36
    s_mov_b32 s36, s37
    s_mov_b32 s37, s4
    s_add_u32 s41, s41, 0x20000
    s_branch .step_85
.fin_86:
    s_endpgm
.gs_87:
    buffer_load_dwordx4 v[24:27], v3, s[8:11], s30 offen offset:0 sc1
    buffer_load_dwordx4 v[28:31], v3, s[8:11], s30 offen offset:1024 sc1
    buffer_load_dwordx4 v[32:35], v3, s[8:11], s30 offen offset:2048 sc1
    buffer_load_dwordx4 v[36:39], v3, s[8:11], s30 offen offset:3072 sc1
    s_add_u32 s62, s62, 1
    s_cmp_gt_u32 s62, 0x100000
    s_cbranch_scc1 .mg_end_1
    s_waitcnt vmcnt(3)
    v_max_u32 v18, v25, v27
    v_cmp_eq_u32 vcc, -1, v18
    s_cbranch_vccz .gr_88
    s_branch .gs_87
.gs_89:
    buffer_load_dwordx4 v[28:31], v3, s[8:11], s30 offen offset:1024 sc1
    buffer_load_dwordx4 v[32:35], v3, s[8:11], s30 offen offset:2048 sc1
    buffer_load_dwordx4 v[36:39], v3, s[8:11], s30 offen offset:3072 sc1
    s_add_u32 s62, s62, 1
    s_cmp_gt_u32 s62, 0x100000
    s_cbranch_scc1 .mg_end_1
    s_waitcnt vmcnt(2)
    v_max_u32 v18, v29, v31
    v_cmp_eq_u32 vcc, -1, v18
    s_cbranch_vccz .gr_90
    s_branch .gs_89
.gs_91:
    buffer_load_dwordx4 v[32:35], v3, s[8:11], s30 offen offset:2048 sc1
    buffer_load_dwordx4 v[36:39], v3, s[8:11], s30 offen offset:3072 sc1
    s_add_u32 s62, s62, 1
    s_cmp_gt_u32 s62, 0x100000
    s_cbranch_scc1 .mg_end_1
    s_waitcnt vmcnt(1)
    v_max_u32 v18, v33, v35
    v_cmp_eq_u32 vcc, -1, v18
    s_cbranch_vccz .gr_92
    s_branch .gs_91
.gs_93:
    buffer_load_dwordx4 v[36:39], v3, s[8:11], s30 offen offset:3072 sc1
    s_add_u32 s62, s62, 1
    s_cmp_gt_u32 s62, 0x100000
    s_cbranch_scc1 .mg_end_1
    s_waitcnt vmcnt(0)
    v_max_u32 v18, v37, v39
    v_cmp_eq_u32 vcc, -1, v18
    s_cbranch_vccz .gr_94
    s_branch .gs_93
.gs_95:
    buffer_load_dwordx4 v[24:27], v4, s[8:11], s30 offen offset:0 sc1
    buffer_load_dwordx4 v[28:31], v4, s[8:11], s30 offen offset:1024 sc1
    buffer_load_dwordx4 v[32:35], v4, s[8:11], s30 offen offset:2048 sc1
    buffer_load_dwordx4 v[36:39], v4, s[8:11], s30 offen offset:3072 sc1
    s_add_u32 s62, s62, 1
    s_cmp_gt_u32 s62, 0x100000
    s_cbranch_scc1 .mg_end_1
    s_waitcnt vmcnt(3)
    v_cmp_eq_u32 vcc, -1, v27
    s_cbranch_vccz .gr_96
    s_branch .gs_95
.gs_97:
    buffer_load_dwordx4 v[28:31], v4, s[8:11], s30 offen offset:1024 sc1
    buffer_load_dwordx4 v[32:35], v4, s[8:11], s30 offen offset:2048 sc1
    buffer_load_dwordx4 v[36:39], v4, s[8:11], s30 offen offset:3072 sc1
    s_add_u32 s62, s62, 1
    s_cmp_gt_u32 s62, 0x100000
    s_cbranch_scc1 .mg_end_1
    s_waitcnt vmcnt(2)
    v_cmp_eq_u32 vcc, -1, v31
    s_cbranch_vccz .gr_98
    s_branch .gs_97
.gs_99:
    buffer_load_dwordx4 v[32:35], v4, s[8:11], s30 offen offset:2048 sc1
    buffer_load_dwordx4 v[36:39], v4, s[8:11], s30 offen offset:3072 sc1
    s_add_u32 s62, s62, 1
    s_cmp_gt_u32 s62, 0x100000
    s_cbranch_scc1 .mg_end_1
    s_waitcnt vmcnt(1)
    v_cmp_eq_u32 vcc, -1, v35
    s_cbranch_vccz .gr_100
    s_branch .gs_99
.gs_101:
    buffer_load_dwordx4 v[36:39], v4, s[8:11], s30 offen offset:3072 sc1
    s_add_u32 s62, s62, 1
    s_cmp_gt_u32 s62, 0x100000
    s_cbranch_scc1 .mg_end_1
    s_waitcnt vmcnt(0)
    v_cmp_eq_u32 vcc, -1, v39
    s_cbranch_vccz .gr_102
    s_branch .gs_101
.slowv_18:
    s_mov_b32 s28, 0
    s_mov_b32 s30, 83886080
    s_mov_b32 s31, 84148224
    s_mov_b32 s32, 84410368
    s_mov_b32 s33, 84672512
    s_mov_b32 s41, 66977792
    s_lshl_b32 s42, s56, 13
    s_lshl_b32 s4, s53, 11
    s_add_u32 s44, s42, s4
    s_add_u32 s44, s44, 33554432
    s_add_u32 s42, s42, 16777216
    s_add_u32 s43, s42, 4096
    s_add_u32 s96, s44, 524288
    s_sub_u32 s95, s96, 16777216
    s_mov_b32 s62, 0
    s_mov_b32 s45, 0x3e0293ee
    s_mov_b32 s46, 0
    s_and_b32 s4, s25, 1
    s_lshl_b32 s4, s4, 14
    s_lshr_b32 s5, s25, 1
    s_lshl_b32 s5, s5, 12
    s_or_b32 s4, s4, s5
    s_xor_b32 s47, s47, s4
    s_and_b32 s5, s26, 1
    s_lshl_b32 s5, s5, 10
    s_lshr_b32 s4, s26, 1
    s_lshl_b32 s4, s4, 15
    s_or_b32 s5, s5, s4
    s_bfe_u32 s4, s26, 0x10004
    s_lshl_b32 s4, s4, 11
    s_xor_b32 s5, s5, s4
    s_xor_b32 s34, s5, s47
    s_xor_b32 s35, s34, 0x84000
    s_xor_b32 s36, s34, 0x101000
    s_xor_b32 s37, s34, 0x185000
    s_cmp_eq_u32 s24, 1
    s_cbranch_scc1 .w1_106
    s_cmp_eq_u32 s24, 2
    s_cbranch_scc1 .w2_107
    s_cmp_eq_u32 s24, 3
    s_cbranch_scc1 .w3_108
.w0_105:
    v_bfe_u32 v254, v1, 4, 2
    v_mul_u32_u24 v12, 128, v254
    v_bfe_u32 v254, v1, 0, 3
    v_mul_u32_u24 v254, 16, v254
    v_add_u32 v12, v12, v254
    v_add_u32 v12, 131072, v12
    v_add_u32 v12, s57, v12
    v_bfe_u32 v254, v1, 4, 2
    v_mul_u32_u24 v13, 128, v254
    v_bfe_u32 v254, v1, 2, 2
    v_mul_u32_u24 v254, 32, v254
    v_add_u32 v13, v13, v254
    v_bfe_u32 v254, v1, 0, 1
    v_mul_u32_u24 v254, 16, v254
    v_add_u32 v13, v13, v254
    v_add_u32 v13, 133120, v13
    v_add_u32 v13, s57, v13
    v_bfe_u32 v254, v1, 4, 2
    v_mul_u32_u24 v14, 128, v254
    v_bfe_u32 v254, v1, 0, 4
    v_mul_u32_u24 v254, 16, v254
    v_add_u32 v14, v14, v254
    v_add_u32 v14, 65536, v14
    v_add_u32 v14, s55, v14
    v_bfe_u32 v254, v1, 0, 6
    v_mul_u32_u24 v15, 16, v254
    v_bfe_u32 v254, v1, 2, 2
    v_mul_u32_u24 v16, 128, v254
    v_bfe_u32 v254, v1, 0, 2
    v_mul_u32_u24 v254, 16, v254
    v_add_u32 v16, v16, v254
    v_bfe_u32 v254, v1, 4, 2
    v_mul_u32_u24 v254, 4, v254
    v_add_u32 v16, v16, v254
    v_add_u32 v16, 18432, v16
    v_mov_b32 v144, 0
    v_mov_b32 v145, 0
    v_mov_b32 v146, 0
    v_mov_b32 v147, 0
    v_mov_b32 v148, 0
    v_mov_b32 v149, 0
    v_mov_b32 v150, 0
    v_mov_b32 v151, 0
    v_mov_b32 v152, 0
    v_mov_b32 v153, 0
    v_mov_b32 v154, 0
    v_mov_b32 v155, 0
    v_mov_b32 v156, 0
    v_mov_b32 v157, 0
    v_mov_b32 v158, 0
    v_mov_b32 v159, 0
    v_mov_b32 v160, 0
    v_mov_b32 v161, 0
    v_mov_b32 v162, 0
    v_mov_b32 v163, 0
    v_mov_b32 v164, 0
    v_mov_b32 v165, 0
    v_mov_b32 v166, 0
    v_mov_b32 v167, 0
    v_mov_b32 v168, 0
    v_mov_b32 v169, 0
    v_mov_b32 v170, 0
    v_mov_b32 v171, 0
    v_mov_b32 v172, 0
    v_mov_b32 v173, 0
    v_mov_b32 v174, 0
    v_mov_b32 v175, 0
    v_mov_b32 v208, 0
    v_mov_b32 v209, 0
    v_mov_b32 v210, 0
    v_mov_b32 v211, 0
    v_mov_b32 v212, 0
    v_mov_b32 v213, 0
    v_mov_b32 v214, 0
    v_mov_b32 v215, 0
    v_mov_b32 v216, 0
    v_mov_b32 v217, 0
    v_mov_b32 v218, 0
    v_mov_b32 v219, 0
    v_mov_b32 v18, 0xff800000
    v_cndmask_b32 v200, v18, 0, s[48:49]
    v_mov_b32 v220, 0x3f803f80
    v_cndmask_b32 v201, v18, 0, s[48:49]
    v_mov_b32 v221, 0x3f803f80
    v_cndmask_b32 v202, v18, 0, s[48:49]
    v_mov_b32 v222, 0x3f803f80
    v_cndmask_b32 v203, v18, 0, s[48:49]
    v_mov_b32 v223, 0x3f803f80
    s_waitcnt vmcnt(0)
    ds_read_b64_tr_b16 a[192:193], v242 offset:16384
    ds_read_b64_tr_b16 a[194:195], v242 offset:16896
    ds_read_b64_tr_b16 a[196:197], v242 offset:18432
    ds_read_b64_tr_b16 a[198:199], v242 offset:18944
    ds_read_b64_tr_b16 a[200:201], v242 offset:20480
    ds_read_b64_tr_b16 a[202:203], v242 offset:20992
    ds_read_b64_tr_b16 a[204:205], v242 offset:22528
    ds_read_b64_tr_b16 a[206:207], v242 offset:23040
    ds_read_b64_tr_b16 a[208:209], v242 offset:24576
    ds_read_b64_tr_b16 a[210:211], v242 offset:25088
    ds_read_b64_tr_b16 a[212:213], v242 offset:26624
    ds_read_b64_tr_b16 a[214:215], v242 offset:27136
    ds_read_b64_tr_b16 a[216:217], v242 offset:28672
    ds_read_b64_tr_b16 a[218:219], v242 offset:29184
    ds_read_b64_tr_b16 a[220:221], v242 offset:30720
    ds_read_b64_tr_b16 a[222:223], v242 offset:31232
    ds_read_b64_tr_b16 a[224:225], v243 offset:16384
    ds_read_b64_tr_b16 a[226:227], v243 offset:16896
    ds_read_b64_tr_b16 a[228:229], v243 offset:18432
    ds_read_b64_tr_b16 a[230:231], v243 offset:18944
    ds_read_b64_tr_b16 a[232:233], v243 offset:20480
    ds_read_b64_tr_b16 a[234:235], v243 offset:20992
    ds_read_b64_tr_b16 a[236:237], v243 offset:22528
    ds_read_b64_tr_b16 a[238:239], v243 offset:23040
    ds_read_b64_tr_b16 a[240:241], v243 offset:24576
    ds_read_b64_tr_b16 a[242:243], v243 offset:25088
    ds_read_b64_tr_b16 a[244:245], v243 offset:26624
    ds_read_b64_tr_b16 a[246:247], v243 offset:27136
    ds_read_b64_tr_b16 a[248:249], v243 offset:28672
    ds_read_b64_tr_b16 a[250:251], v243 offset:29184
    ds_read_b64_tr_b16 a[252:253], v243 offset:30720
    ds_read_b64_tr_b16 a[254:255], v243 offset:31232
    s_waitcnt lgkmcnt(0)
    s_barrier
    buffer_load_dwordx4 v[104:107], v15, s[8:11], s42 offen offset:0
    buffer_load_dwordx4 v[108:111], v15, s[8:11], s42 offen offset:1024
    buffer_load_dwordx4 v[112:115], v15, s[8:11], s42 offen offset:2048
    buffer_load_dwordx4 v[116:119], v15, s[8:11], s42 offen offset:3072
    buffer_load_dwordx4 v[120:123], v15, s[8:11], s43 offen offset:0
    buffer_load_dwordx4 v[124:127], v15, s[8:11], s43 offen offset:1024
    buffer_load_dwordx4 v[128:131], v15, s[8:11], s43 offen offset:2048
    buffer_load_dwordx4 v[132:135], v15, s[8:11], s43 offen offset:3072
    buffer_load_dwordx4 v[136:139], v15, s[8:11], s44 offen offset:0
    buffer_load_dwordx4 v[140:143], v15, s[8:11], s44 offen offset:1024
    s_add_u32 s42, s42, 262144
    s_add_u32 s43, s43, 262144
    s_add_u32 s44, s44, 262144
.p2align 6
.step_109:
    s_barrier
    s_setprio 3
    buffer_load_dwordx4 v[24:27], v3, s[8:11], s30 offen offset:0 sc1
    s_setprio 2
    buffer_load_dwordx4 v[28:31], v3, s[8:11], s30 offen offset:1024 sc1
    s_setprio 1
    buffer_load_dwordx4 v[32:35], v3, s[8:11], s30 offen offset:2048 sc1
    s_setprio 0
    buffer_load_dwordx4 v[36:39], v3, s[8:11], s30 offen offset:3072 sc1
    s_waitcnt vmcnt(3)
    v_max_u32 v18, v25, v27
    v_cmp_eq_u32 vcc, -1, v18
    s_cbranch_vccnz .gs_111
.gr_112:
    v_smfmac_f32_16x16x64_bf16 v[40:43], v[24:27], a[0:7], v2
    v_smfmac_f32_16x16x64_bf16 v[44:47], v[24:27], a[32:39], v2
    s_waitcnt vmcnt(2)
    v_max_u32 v18, v29, v31
    v_cmp_eq_u32 vcc, -1, v18
    v_smfmac_f32_16x16x64_bf16 v[48:51], v[24:27], a[64:71], v2
    s_cbranch_vccnz .gs_113
.gr_114:
    v_smfmac_f32_16x16x64_bf16 v[40:43], v[28:31], a[8:15], v2
    v_smfmac_f32_16x16x64_bf16 v[44:47], v[28:31], a[40:47], v2
    v_smfmac_f32_16x16x64_bf16 v[52:55], v[24:27], a[96:103], v2
    s_waitcnt vmcnt(1)
    v_max_u32 v18, v33, v35
    v_cmp_eq_u32 vcc, -1, v18
    v_smfmac_f32_16x16x64_bf16 v[48:51], v[28:31], a[72:79], v2
    s_cbranch_vccnz .gs_115
.gr_116:
    v_smfmac_f32_16x16x64_bf16 v[40:43], v[32:35], a[16:23], v2
    v_smfmac_f32_16x16x64_bf16 v[44:47], v[32:35], a[48:55], v2
    v_smfmac_f32_16x16x64_bf16 v[52:55], v[28:31], a[104:111], v2
    s_waitcnt vmcnt(0)
    v_max_u32 v18, v37, v39
    v_cmp_eq_u32 vcc, -1, v18
    v_smfmac_f32_16x16x64_bf16 v[48:51], v[32:35], a[80:87], v2
    s_cbranch_vccnz .gs_117
.gr_118:
    v_smfmac_f32_16x16x64_bf16 v[40:43], v[36:39], a[24:31], v2
    v_smfmac_f32_16x16x64_bf16 v[44:47], v[36:39], a[56:63], v2
    v_smfmac_f32_16x16x64_bf16 v[52:55], v[32:35], a[112:119], v2
    v_smfmac_f32_16x16x64_bf16 v[48:51], v[36:39], a[88:95], v2
    v_permlane32_swap_b32 v40, v44
    v_permlane32_swap_b32 v41, v45
    v_smfmac_f32_16x16x64_bf16 v[52:55], v[36:39], a[120:127], v2
    v_permlane32_swap_b32 v42, v46
    v_permlane32_swap_b32 v43, v47
    v_add_f32 v40, v40, v44
    v_add_f32 v41, v41, v45
    v_add_f32 v42, v42, v46
    v_add_f32 v43, v43, v47
    ds_write2_b32 v5, v40, v41 offset0:0 offset1:36
    ds_write2_b32 v5, v42, v43 offset0:72 offset1:108
    v_permlane32_swap_b32 v48, v52
    v_permlane32_swap_b32 v49, v53
    v_permlane32_swap_b32 v50, v54
    v_permlane32_swap_b32 v51, v55
    v_add_f32 v48, v48, v52
    v_add_f32 v49, v49, v53
    v_add_f32 v50, v50, v54
    v_add_f32 v51, v51, v55
    ds_write2_b32 v6, v48, v49 offset0:0 offset1:36
    ds_write2_b32 v6, v50, v51 offset0:72 offset1:108
    s_waitcnt lgkmcnt(2)
    s_barrier
    ds_read_b64 v[72:73], v9 offset:0
    ds_read_b64 v[74:75], v9 offset:1152
    ds_read_b64 v[76:77], v9 offset:2304
    ds_read_b64 v[78:79], v9 offset:3456
    s_waitcnt lgkmcnt(4)
    s_barrier
    s_waitcnt lgkmcnt(2)
    v_add_f32 v72, v72, v74
    v_add_f32 v73, v73, v75
    s_waitcnt lgkmcnt(0)
    v_add_f32 v76, v76, v78
    v_add_f32 v77, v77, v79
    v_add_f32 v72, v72, v76
    v_add_f32 v73, v73, v77
    v_cvt_pk_bf16_f32 v72, v72, v73
    v_min_u32 v72, 0xfffffffe, v72
    buffer_store_dword v72, v10, s[8:11], s30 offen sc1
    v_smfmac_f32_16x16x64_bf16 v[56:59], v[24:27], a[128:135], v2
    v_smfmac_f32_16x16x64_bf16 v[60:63], v[24:27], a[160:167], v2
    v_smfmac_f32_16x16x64_bf16 v[56:59], v[28:31], a[136:143], v2
    v_smfmac_f32_16x16x64_bf16 v[60:63], v[28:31], a[168:175], v2
    v_smfmac_f32_16x16x64_bf16 v[56:59], v[32:35], a[144:151], v2
    v_smfmac_f32_16x16x64_bf16 v[60:63], v[32:35], a[176:183], v2
    v_smfmac_f32_16x16x64_bf16 v[56:59], v[36:39], a[152:159], v2
    v_smfmac_f32_16x16x64_bf16 v[60:63], v[36:39], a[184:191], v2
    v_mov_b32 v40, 0
    v_mov_b32 v41, 0
    v_mov_b32 v42, 0
    v_mov_b32 v43, 0
    v_mov_b32 v44, 0
    v_mov_b32 v45, 0
    v_mov_b32 v46, 0
    v_mov_b32 v47, 0
    v_permlane32_swap_b32 v56, v60
    v_permlane32_swap_b32 v57, v61
    v_permlane32_swap_b32 v58, v62
    v_permlane32_swap_b32 v59, v63
    v_add_f32 v56, v56, v60
    v_add_f32 v57, v57, v61
    v_add_f32 v58, v58, v62
    v_add_f32 v59, v59, v63
    ds_write_b128 v8, v[56:59]
    s_cmp_eq_u32 s28, 63
    s_cbranch_scc1 .fin_110
    s_waitcnt vmcnt(0)
    s_mov_b64 exec, s[48:49]
    buffer_load_dwordx4 v[144:147], v12, s[8:11], s30 offen offset:0 sc1
    buffer_load_dwordx4 v[148:151], v12, s[8:11], s30 offen offset:512 sc1
    buffer_load_dwordx4 v[152:155], v12, s[8:11], s30 offen offset:1024 sc1
    buffer_load_dwordx4 v[156:159], v12, s[8:11], s30 offen offset:1536 sc1
    s_mov_b64 exec, s[50:51]
    buffer_load_dwordx4 v[160:163], v12, s[8:11], s30 offen offset:0 sc1
    buffer_load_dwordx4 v[164:167], v12, s[8:11], s30 offen offset:512 sc1
    buffer_load_dwordx4 v[168:171], v12, s[8:11], s30 offen offset:1024 sc1
    buffer_load_dwordx4 v[172:175], v12, s[8:11], s30 offen offset:1536 sc1
    s_mov_b64 exec, -1
    buffer_load_dwordx4 v[176:179], v13, s[8:11], s30 offen offset:0 sc1
    buffer_load_dwordx4 v[180:183], v13, s[8:11], s30 offen offset:512 sc1
    buffer_load_dwordx4 v[184:187], v13, s[8:11], s30 offen offset:1024 sc1
    buffer_load_dwordx4 v[188:191], v13, s[8:11], s30 offen offset:1536 sc1
    s_waitcnt lgkmcnt(0)
    s_barrier
.mf_119:
    s_waitcnt vmcnt(11)
    v_mfma_f32_16x16x32_bf16 v[192:195], v[104:107], v[144:147], 0
    v_max3_u32 v18, v144, v145, v146
    v_max_u32 v18, v18, v147
    s_waitcnt vmcnt(10)
    v_mfma_f32_16x16x32_bf16 v[192:195], v[108:111], v[148:151], v[192:195]
    v_max3_u32 v18, v18, v148, v149
    v_max3_u32 v18, v18, v150, v151
    s_waitcnt vmcnt(9)
    v_mfma_f32_16x16x32_bf16 v[192:195], v[112:115], v[152:155], v[192:195]
    v_max3_u32 v18, v18, v152, v153
    v_max3_u32 v18, v18, v154, v155
    s_waitcnt vmcnt(8)
    v_mfma_f32_16x16x32_bf16 v[192:195], v[116:119], v[156:159], v[192:195]
    v_max3_u32 v18, v18, v156, v157
    v_max3_u32 v18, v18, v158, v159
    s_waitcnt vmcnt(7)
    v_mfma_f32_16x16x32_bf16 v[192:195], v[120:123], v[160:163], v[192:195]
    v_cmp_eq_u32 vcc, -1, v18
    s_waitcnt vmcnt(6)
    v_mfma_f32_16x16x32_bf16 v[192:195], v[124:127], v[164:167], v[192:195]
    s_cbranch_vccnz .re_120
    s_waitcnt vmcnt(5)
    v_mfma_f32_16x16x32_bf16 v[192:195], v[128:131], v[168:171], v[192:195]
    s_waitcnt vmcnt(4)
    v_mfma_f32_16x16x32_bf16 v[192:195], v[132:135], v[172:175], v[192:195]
.mk_121:
    s_waitcnt vmcnt(3)
    v_mfma_f32_16x16x32_bf16 v[196:199], v[176:179], v[144:147], v[200:203]
    v_max3_u32 v18, v176, v177, v178
    v_max_u32 v18, v18, v179
    s_waitcnt vmcnt(2)
    v_mfma_f32_16x16x32_bf16 v[196:199], v[180:183], v[148:151], v[196:199]
    v_max3_u32 v18, v18, v180, v181
    v_max3_u32 v18, v18, v182, v183
    s_waitcnt vmcnt(1)
    v_mfma_f32_16x16x32_bf16 v[196:199], v[184:187], v[152:155], v[196:199]
    v_max3_u32 v18, v18, v184, v185
    v_max3_u32 v18, v18, v186, v187
    s_waitcnt vmcnt(0)
    v_mfma_f32_16x16x32_bf16 v[196:199], v[188:191], v[156:159], v[196:199]
    v_max3_u32 v18, v18, v188, v189
    v_max3_u32 v18, v18, v190, v191
    v_cmp_eq_u32 vcc, -1, v18
    v_max3_f32 v19, v192, v193, v194
    s_cbranch_vccnz .rk_122
    s_barrier
    ds_read_b32 v212, v16
    ds_read_b32 v216, v16 offset:64
    v_max3_f32 v18, v195, v196, v197
    v_max_f32 v18, v18, v19
    s_nop 1
    v_max_f32_dpp v19, v18, v18 row_ror:8 row_mask:0xf bank_mask:0xf
    v_max_f32_dpp v17, v18, v18 row_ror:8 row_mask:0xf bank_mask:0xf
    s_nop 1
    v_permlane16_swap_b32 v19, v17
    v_max_f32 v18, v19, v17
    v_max_f32 v19, v19, v17
    s_nop 1
    v_permlane32_swap_b32 v18, v19
    v_max_f32 v18, v18, v19
    v_mul_f32 v18, s45, v18
    v_fma_f32 v240, v192, s45, -v18
    v_fma_f32 v241, v193, s45, -v18
    v_fma_f32 v242, v194, s45, -v18
    v_fma_f32 v243, v195, s45, -v18
    v_fma_f32 v244, v196, s45, -v18
    v_fma_f32 v245, v197, s45, -v18
    v_exp_f32 v240, v240
    v_exp_f32 v241, v241
    v_exp_f32 v242, v242
    v_exp_f32 v243, v243
    v_exp_f32 v244, v244
    v_exp_f32 v245, v245
    v_cvt_pk_bf16_f32 v204, v240, v241
    v_cvt_pk_bf16_f32 v205, v242, v243
    v_cvt_pk_bf16_f32 v208, v244, v245
    s_waitcnt lgkmcnt(0)
    v_mov_b32_dpp v206, v204 row_ror:8 row_mask:0xf bank_mask:0xf
    v_mov_b32_dpp v207, v205 row_ror:8 row_mask:0xf bank_mask:0xf
    v_mfma_f32_16x16x32_bf16 v[224:227], v[220:223], v[208:211], 0
    v_mfma_f32_16x16x32_bf16 v[224:227], v[220:223], v[204:207], v[224:227]
    v_mfma_f32_16x16x32_bf16 v[228:231], v[212:215], v[208:211], 0
    v_mfma_f32_16x16x32_bf16 v[228:231], v[136:139], v[204:207], v[228:231]
    v_mfma_f32_16x16x32_bf16 v[232:235], v[216:219], v[208:211], 0
    v_rcp_f32 v18, v224
    v_mfma_f32_16x16x32_bf16 v[232:235], v[140:143], v[204:207], v[232:235]
    s_mov_b64 exec, s[48:49]
    v_mul_f32 v228, v18, v228
    v_mul_f32 v229, v18, v229
    v_mul_f32 v230, v18, v230
    v_mul_f32 v231, v18, v231
    v_cvt_pk_bf16_f32 v236, v228, v229
    v_cvt_pk_bf16_f32 v237, v230, v231
    s_nop 1
    v_mul_f32 v232, v18, v232
    v_mul_f32 v233, v18, v233
    v_mul_f32 v234, v18, v234
    v_mul_f32 v235, v18, v235
    v_cvt_pk_bf16_f32 v238, v232, v233
    v_cvt_pk_bf16_f32 v239, v234, v235
    v_min_u32 v239, 0xfffffffe, v239
    buffer_store_dwordx4 v[236:239], v14, s[8:11], s30 offen sc1
    s_mov_b64 exec, -1
    v_mov_b32 v48, 0
    v_mov_b32 v49, 0
    v_mov_b32 v50, 0
    v_mov_b32 v51, 0
    v_mov_b32 v52, 0
    v_mov_b32 v53, 0
    v_mov_b32 v54, 0
    v_mov_b32 v55, 0
    v_mov_b32 v56, 0
    v_mov_b32 v57, 0
    v_mov_b32 v58, 0
    v_mov_b32 v59, 0
    v_mov_b32 v60, 0
    v_mov_b32 v61, 0
    v_mov_b32 v62, 0
    v_mov_b32 v63, 0
    s_waitcnt vmcnt(0)
    s_barrier
    s_setprio 3
    buffer_load_dwordx4 v[24:27], v4, s[8:11], s30 offen offset:0 sc1
    s_setprio 2
    buffer_load_dwordx4 v[28:31], v4, s[8:11], s30 offen offset:1024 sc1
    s_setprio 1
    buffer_load_dwordx4 v[32:35], v4, s[8:11], s30 offen offset:2048 sc1
    s_setprio 0
    buffer_load_dwordx4 v[36:39], v4, s[8:11], s30 offen offset:3072 sc1
    s_waitcnt vmcnt(3)
    v_cmp_eq_u32 vcc, -1, v27
    s_cbranch_vccnz .gs_123
.gr_124:
    v_smfmac_f32_16x16x64_bf16 v[64:67], v[24:27], a[192:199], v2
    v_smfmac_f32_16x16x64_bf16 v[68:71], v[24:27], a[224:231], v2
    s_waitcnt vmcnt(2)
    v_cmp_eq_u32 vcc, -1, v31
    s_cbranch_vccnz .gs_125
.gr_126:
    v_smfmac_f32_16x16x64_bf16 v[64:67], v[28:31], a[200:207], v2
    v_smfmac_f32_16x16x64_bf16 v[68:71], v[28:31], a[232:239], v2
    s_waitcnt vmcnt(1)
    v_cmp_eq_u32 vcc, -1, v35
    s_cbranch_vccnz .gs_127
.gr_128:
    v_smfmac_f32_16x16x64_bf16 v[64:67], v[32:35], a[208:215], v2
    v_smfmac_f32_16x16x64_bf16 v[68:71], v[32:35], a[240:247], v2
    s_waitcnt vmcnt(0)
    v_cmp_eq_u32 vcc, -1, v39
    s_cbranch_vccnz .gs_129
.gr_130:
    v_smfmac_f32_16x16x64_bf16 v[64:67], v[36:39], a[216:223], v2
    v_smfmac_f32_16x16x64_bf16 v[68:71], v[36:39], a[248:255], v2
    s_nop 7
    v_permlane32_swap_b32 v64, v68
    v_permlane32_swap_b32 v65, v69
    v_permlane32_swap_b32 v66, v70
    v_permlane32_swap_b32 v67, v71
    v_add_f32 v64, v64, v68
    v_add_f32 v65, v65, v69
    v_add_f32 v66, v66, v70
    v_add_f32 v67, v67, v71
    ds_write2_b32 v7, v64, v65 offset0:0 offset1:36
    ds_write2_b32 v7, v66, v67 offset0:72 offset1:108
    s_waitcnt lgkmcnt(0)
    s_barrier
    buffer_load_dwordx4 v[104:107], v15, s[8:11], s42 offen offset:0
    buffer_load_dwordx4 v[108:111], v15, s[8:11], s42 offen offset:1024
    buffer_load_dwordx4 v[112:115], v15, s[8:11], s42 offen offset:2048
    buffer_load_dwordx4 v[116:119], v15, s[8:11], s42 offen offset:3072
    buffer_load_dwordx4 v[120:123], v15, s[8:11], s43 offen offset:0
    buffer_load_dwordx4 v[124:127], v15, s[8:11], s43 offen offset:1024
    buffer_load_dwordx4 v[128:131], v15, s[8:11], s43 offen offset:2048
    buffer_load_dwordx4 v[132:135], v15, s[8:11], s43 offen offset:3072
    buffer_load_dwordx4 v[136:139], v15, s[8:11], s44 offen offset:0
    buffer_load_dwordx4 v[140:143], v15, s[8:11], s44 offen offset:1024
    s_add_u32 s42, s42, 262144
    s_add_u32 s43, s43, 262144
    s_add_u32 s44, s44, 262144
    v_mov_b32 v64, 0
    v_mov_b32 v65, 0
    v_mov_b32 v66, 0
    v_mov_b32 v67, 0
    v_mov_b32 v68, 0
    v_mov_b32 v69, 0
    v_mov_b32 v70, 0
    v_mov_b32 v71, 0
    s_mov_b32 s4, s30
    s_mov_b32 s30, s31
    s_mov_b32 s31, s32
    s_mov_b32 s32, s33
    s_mov_b32 s33, s4
    s_add_u32 s28, s28, 1
    s_mov_b32 s62, 0
    s_branch .step_109
.fin_110:
    s_waitcnt lgkmcnt(0)
    s_barrier
    s_barrier
    s_endpgm
.gs_111:
    buffer_load_dwordx4 v[24:27], v3, s[8:11], s30 offen offset:0 sc1
    buffer_load_dwordx4 v[28:31], v3, s[8:11], s30 offen offset:1024 sc1
    buffer_load_dwordx4 v[32:35], v3, s[8:11], s30 offen offset:2048 sc1
    buffer_load_dwordx4 v[36:39], v3, s[8:11], s30 offen offset:3072 sc1
    s_add_u32 s62, s62, 1
    s_cmp_gt_u32 s62, 0x100000
    s_cbranch_scc1 .mg_end_1
    s_waitcnt vmcnt(3)
    v_max_u32 v18, v25, v27
    v_cmp_eq_u32 vcc, -1, v18
    s_cbranch_vccz .gr_112
    s_branch .gs_111
.gs_113:
    buffer_load_dwordx4 v[28:31], v3, s[8:11], s30 offen offset:1024 sc1
    buffer_load_dwordx4 v[32:35], v3, s[8:11], s30 offen offset:2048 sc1
    buffer_load_dwordx4 v[36:39], v3, s[8:11], s30 offen offset:3072 sc1
    s_add_u32 s62, s62, 1
    s_cmp_gt_u32 s62, 0x100000
    s_cbranch_scc1 .mg_end_1
    s_waitcnt vmcnt(2)
    v_max_u32 v18, v29, v31
    v_cmp_eq_u32 vcc, -1, v18
    s_cbranch_vccz .gr_114
    s_branch .gs_113
.gs_115:
    buffer_load_dwordx4 v[32:35], v3, s[8:11], s30 offen offset:2048 sc1
    buffer_load_dwordx4 v[36:39], v3, s[8:11], s30 offen offset:3072 sc1
    s_add_u32 s62, s62, 1
    s_cmp_gt_u32 s62, 0x100000
    s_cbranch_scc1 .mg_end_1
    s_waitcnt vmcnt(1)
    v_max_u32 v18, v33, v35
    v_cmp_eq_u32 vcc, -1, v18
    s_cbranch_vccz .gr_116
    s_branch .gs_115
.gs_117:
    buffer_load_dwordx4 v[36:39], v3, s[8:11], s30 offen offset:3072 sc1
    s_add_u32 s62, s62, 1
    s_cmp_gt_u32 s62, 0x100000
    s_cbranch_scc1 .mg_end_1
    s_waitcnt vmcnt(0)
    v_max_u32 v18, v37, v39
    v_cmp_eq_u32 vcc, -1, v18
    s_cbranch_vccz .gr_118
    s_branch .gs_117
.re_120:
    s_mov_b64 exec, s[48:49]
    buffer_load_dwordx4 v[144:147], v12, s[8:11], s30 offen offset:0 sc1
    buffer_load_dwordx4 v[148:151], v12, s[8:11], s30 offen offset:512 sc1
    buffer_load_dwordx4 v[152:155], v12, s[8:11], s30 offen offset:1024 sc1
    buffer_load_dwordx4 v[156:159], v12, s[8:11], s30 offen offset:1536 sc1
    s_mov_b64 exec, s[50:51]
    buffer_load_dwordx4 v[160:163], v12, s[8:11], s30 offen offset:0 sc1
    buffer_load_dwordx4 v[164:167], v12, s[8:11], s30 offen offset:512 sc1
    buffer_load_dwordx4 v[168:171], v12, s[8:11], s30 offen offset:1024 sc1
    buffer_load_dwordx4 v[172:175], v12, s[8:11], s30 offen offset:1536 sc1
    s_mov_b64 exec, -1
    buffer_load_dwordx4 v[176:179], v13, s[8:11], s30 offen offset:0 sc1
    buffer_load_dwordx4 v[180:183], v13, s[8:11], s30 offen offset:512 sc1
    buffer_load_dwordx4 v[184:187], v13, s[8:11], s30 offen offset:1024 sc1
    buffer_load_dwordx4 v[188:191], v13, s[8:11], s30 offen offset:1536 sc1
    s_add_u32 s62, s62, 1
    s_cmp_gt_u32 s62, 0x100000
    s_cbranch_scc1 .mg_end_1
    s_branch .mf_119
.rk_122:
    buffer_load_dwordx4 v[176:179], v13, s[8:11], s30 offen offset:0 sc1
    buffer_load_dwordx4 v[180:183], v13, s[8:11], s30 offen offset:512 sc1
    buffer_load_dwordx4 v[184:187], v13, s[8:11], s30 offen offset:1024 sc1
    buffer_load_dwordx4 v[188:191], v13, s[8:11], s30 offen offset:1536 sc1
    s_add_u32 s62, s62, 1
    s_cmp_gt_u32 s62, 0x100000
    s_cbranch_scc1 .mg_end_1
    s_branch .mk_121
.gs_123:
    buffer_load_dwordx4 v[24:27], v4, s[8:11], s30 offen offset:0 sc1
    buffer_load_dwordx4 v[28:31], v4, s[8:11], s30 offen offset:1024 sc1
    buffer_load_dwordx4 v[32:35], v4, s[8:11], s30 offen offset:2048 sc1
    buffer_load_dwordx4 v[36:39], v4, s[8:11], s30 offen offset:3072 sc1
    s_add_u32 s62, s62, 1
    s_cmp_gt_u32 s62, 0x100000
    s_cbranch_scc1 .mg_end_1
    s_waitcnt vmcnt(3)
    v_cmp_eq_u32 vcc, -1, v27
    s_cbranch_vccz .gr_124
    s_branch .gs_123
.gs_125:
    buffer_load_dwordx4 v[28:31], v4, s[8:11], s30 offen offset:1024 sc1
    buffer_load_dwordx4 v[32:35], v4, s[8:11], s30 offen offset:2048 sc1
    buffer_load_dwordx4 v[36:39], v4, s[8:11], s30 offen offset:3072 sc1
    s_add_u32 s62, s62, 1
    s_cmp_gt_u32 s62, 0x100000
    s_cbranch_scc1 .mg_end_1
    s_waitcnt vmcnt(2)
    v_cmp_eq_u32 vcc, -1, v31
    s_cbranch_vccz .gr_126
    s_branch .gs_125
.gs_127:
    buffer_load_dwordx4 v[32:35], v4, s[8:11], s30 offen offset:2048 sc1
    buffer_load_dwordx4 v[36:39], v4, s[8:11], s30 offen offset:3072 sc1
    s_add_u32 s62, s62, 1
    s_cmp_gt_u32 s62, 0x100000
    s_cbranch_scc1 .mg_end_1
    s_waitcnt vmcnt(1)
    v_cmp_eq_u32 vcc, -1, v35
    s_cbranch_vccz .gr_128
    s_branch .gs_127
.gs_129:
    buffer_load_dwordx4 v[36:39], v4, s[8:11], s30 offen offset:3072 sc1
    s_add_u32 s62, s62, 1
    s_cmp_gt_u32 s62, 0x100000
    s_cbranch_scc1 .mg_end_1
    s_waitcnt vmcnt(0)
    v_cmp_eq_u32 vcc, -1, v39
    s_cbranch_vccz .gr_130
    s_branch .gs_129
.w1_106:
    v_bfe_u32 v254, v1, 1, 3
    v_mul_u32_u24 v12, 144, v254
    v_bfe_u32 v254, v1, 4, 2
    v_mul_u32_u24 v254, 32, v254
    v_add_u32 v12, v12, v254
    v_bfe_u32 v254, v1, 0, 1
    v_mul_u32_u24 v254, 16, v254
    v_add_u32 v12, v12, v254
    v_add_u32 v12, 9216, v12
    v_bfe_u32 v254, v1, 0, 6
    v_mul_u32_u24 v13, 16, v254
    v_add_u32 v13, s101, v13
    v_bfe_u32 v254, v1, 0, 6
    v_mul_u32_u24 v14, 8, v254
    v_add_u32 v14, s55, v14
    s_waitcnt vmcnt(0)
    ds_read_b64_tr_b16 a[192:193], v242 offset:16384
    ds_read_b64_tr_b16 a[194:195], v242 offset:16896
    ds_read_b64_tr_b16 a[196:197], v242 offset:18432
    ds_read_b64_tr_b16 a[198:199], v242 offset:18944
    ds_read_b64_tr_b16 a[200:201], v242 offset:20480
    ds_read_b64_tr_b16 a[202:203], v242 offset:20992
    ds_read_b64_tr_b16 a[204:205], v242 offset:22528
    ds_read_b64_tr_b16 a[206:207], v242 offset:23040
    ds_read_b64_tr_b16 a[208:209], v242 offset:24576
    ds_read_b64_tr_b16 a[210:211], v242 offset:25088
    ds_read_b64_tr_b16 a[212:213], v242 offset:26624
    ds_read_b64_tr_b16 a[214:215], v242 offset:27136
    ds_read_b64_tr_b16 a[216:217], v242 offset:28672
    ds_read_b64_tr_b16 a[218:219], v242 offset:29184
    ds_read_b64_tr_b16 a[220:221], v242 offset:30720
    ds_read_b64_tr_b16 a[222:223], v242 offset:31232
    ds_read_b64_tr_b16 a[224:225], v243 offset:16384
    ds_read_b64_tr_b16 a[226:227], v243 offset:16896
    ds_read_b64_tr_b16 a[228:229], v243 offset:18432
    ds_read_b64_tr_b16 a[230:231], v243 offset:18944
    ds_read_b64_tr_b16 a[232:233], v243 offset:20480
    ds_read_b64_tr_b16 a[234:235], v243 offset:20992
    ds_read_b64_tr_b16 a[236:237], v243 offset:22528
    ds_read_b64_tr_b16 a[238:239], v243 offset:23040
    ds_read_b64_tr_b16 a[240:241], v243 offset:24576
    ds_read_b64_tr_b16 a[242:243], v243 offset:25088
    ds_read_b64_tr_b16 a[244:245], v243 offset:26624
    ds_read_b64_tr_b16 a[246:247], v243 offset:27136
    ds_read_b64_tr_b16 a[248:249], v243 offset:28672
    ds_read_b64_tr_b16 a[250:251], v243 offset:29184
    ds_read_b64_tr_b16 a[252:253], v243 offset:30720
    ds_read_b64_tr_b16 a[254:255], v243 offset:31232
    s_waitcnt lgkmcnt(0)
    s_barrier
.p2align 6
.step_131:
    s_waitcnt vmcnt(0)
    s_barrier
    s_setprio 3
    buffer_load_dwordx4 v[24:27], v3, s[8:11], s30 offen offset:0 sc1
    s_setprio 2
    buffer_load_dwordx4 v[28:31], v3, s[8:11], s30 offen offset:1024 sc1
    s_setprio 1
    buffer_load_dwordx4 v[32:35], v3, s[8:11], s30 offen offset:2048 sc1
    s_setprio 0
    buffer_load_dwordx4 v[36:39], v3, s[8:11], s30 offen offset:3072 sc1
    s_waitcnt vmcnt(3)
    v_max_u32 v18, v25, v27
    v_cmp_eq_u32 vcc, -1, v18
    s_cbranch_vccnz .gs_133
.gr_134:
    v_smfmac_f32_16x16x64_bf16 v[40:43], v[24:27], a[0:7], v2
    v_smfmac_f32_16x16x64_bf16 v[44:47], v[24:27], a[32:39], v2
    s_waitcnt vmcnt(2)
    v_max_u32 v18, v29, v31
    v_cmp_eq_u32 vcc, -1, v18
    v_smfmac_f32_16x16x64_bf16 v[48:51], v[24:27], a[64:71], v2
    s_cbranch_vccnz .gs_135
.gr_136:
    v_smfmac_f32_16x16x64_bf16 v[40:43], v[28:31], a[8:15], v2
    v_smfmac_f32_16x16x64_bf16 v[44:47], v[28:31], a[40:47], v2
    v_smfmac_f32_16x16x64_bf16 v[52:55], v[24:27], a[96:103], v2
    s_waitcnt vmcnt(1)
    v_max_u32 v18, v33, v35
    v_cmp_eq_u32 vcc, -1, v18
    v_smfmac_f32_16x16x64_bf16 v[48:51], v[28:31], a[72:79], v2
    s_cbranch_vccnz .gs_137
.gr_138:
    v_smfmac_f32_16x16x64_bf16 v[40:43], v[32:35], a[16:23], v2
    v_smfmac_f32_16x16x64_bf16 v[44:47], v[32:35], a[48:55], v2
    v_smfmac_f32_16x16x64_bf16 v[52:55], v[28:31], a[104:111], v2
    s_waitcnt vmcnt(0)
    v_max_u32 v18, v37, v39
    v_cmp_eq_u32 vcc, -1, v18
    v_smfmac_f32_16x16x64_bf16 v[48:51], v[32:35], a[80:87], v2
    s_cbranch_vccnz .gs_139
.gr_140:
    v_smfmac_f32_16x16x64_bf16 v[40:43], v[36:39], a[24:31], v2
    v_smfmac_f32_16x16x64_bf16 v[44:47], v[36:39], a[56:63], v2
    v_smfmac_f32_16x16x64_bf16 v[52:55], v[32:35], a[112:119], v2
    v_smfmac_f32_16x16x64_bf16 v[48:51], v[36:39], a[88:95], v2
    v_permlane32_swap_b32 v40, v44
    v_permlane32_swap_b32 v41, v45
    v_smfmac_f32_16x16x64_bf16 v[52:55], v[36:39], a[120:127], v2
    v_permlane32_swap_b32 v42, v46
    v_permlane32_swap_b32 v43, v47
    v_add_f32 v40, v40, v44
    v_add_f32 v41, v41, v45
    v_add_f32 v42, v42, v46
    v_add_f32 v43, v43, v47
    ds_write2_b32 v5, v40, v41 offset0:0 offset1:36
    ds_write2_b32 v5, v42, v43 offset0:72 offset1:108
    v_permlane32_swap_b32 v48, v52
    v_permlane32_swap_b32 v49, v53
    v_permlane32_swap_b32 v50, v54
    v_permlane32_swap_b32 v51, v55
    v_add_f32 v48, v48, v52
    v_add_f32 v49, v49, v53
    v_add_f32 v50, v50, v54
    v_add_f32 v51, v51, v55
    ds_write2_b32 v6, v48, v49 offset0:0 offset1:36
    ds_write2_b32 v6, v50, v51 offset0:72 offset1:108
    s_waitcnt lgkmcnt(2)
    s_barrier
    ds_read_b64 v[72:73], v9 offset:0
    ds_read_b64 v[74:75], v9 offset:1152
    ds_read_b64 v[76:77], v9 offset:2304
    ds_read_b64 v[78:79], v9 offset:3456
    s_waitcnt lgkmcnt(4)
    s_barrier
    s_waitcnt lgkmcnt(2)
    v_add_f32 v72, v72, v74
    v_add_f32 v73, v73, v75
    s_waitcnt lgkmcnt(0)
    v_add_f32 v76, v76, v78
    v_add_f32 v77, v77, v79
    v_add_f32 v72, v72, v76
    v_add_f32 v73, v73, v77
    v_cvt_pk_bf16_f32 v72, v72, v73
    v_min_u32 v72, 0xfffffffe, v72
    buffer_store_dword v72, v10, s[8:11], s30 offen sc1
    v_smfmac_f32_16x16x64_bf16 v[56:59], v[24:27], a[128:135], v2
    v_smfmac_f32_16x16x64_bf16 v[60:63], v[24:27], a[160:167], v2
    v_smfmac_f32_16x16x64_bf16 v[56:59], v[28:31], a[136:143], v2
    v_smfmac_f32_16x16x64_bf16 v[60:63], v[28:31], a[168:175], v2
    v_smfmac_f32_16x16x64_bf16 v[56:59], v[32:35], a[144:151], v2
    v_smfmac_f32_16x16x64_bf16 v[60:63], v[32:35], a[176:183], v2
    v_smfmac_f32_16x16x64_bf16 v[56:59], v[36:39], a[152:159], v2
    v_smfmac_f32_16x16x64_bf16 v[60:63], v[36:39], a[184:191], v2
    v_mov_b32 v40, 0
    v_mov_b32 v41, 0
    v_mov_b32 v42, 0
    v_mov_b32 v43, 0
    v_mov_b32 v44, 0
    v_mov_b32 v45, 0
    v_mov_b32 v46, 0
    v_mov_b32 v47, 0
    v_permlane32_swap_b32 v56, v60
    v_permlane32_swap_b32 v57, v61
    v_permlane32_swap_b32 v58, v62
    v_permlane32_swap_b32 v59, v63
    v_add_f32 v56, v56, v60
    v_add_f32 v57, v57, v61
    v_add_f32 v58, v58, v62
    v_add_f32 v59, v59, v63
    ds_write_b128 v8, v[56:59]
    s_waitcnt lgkmcnt(0)
    s_barrier
    s_barrier
    s_cmp_eq_u32 s28, 63
    s_cbranch_scc1 .fin_132
    s_xor_b32 s38, s34, 0x4000
    s_xor_b32 s39, s34, 0x1000
    s_xor_b32 s40, s34, 0x5000
    v_mov_b32 v48, 0
    v_mov_b32 v49, 0
    v_mov_b32 v50, 0
    v_mov_b32 v51, 0
    v_mov_b32 v52, 0
    v_mov_b32 v53, 0
    v_mov_b32 v54, 0
    v_mov_b32 v55, 0
    v_mov_b32 v56, 0
    v_mov_b32 v57, 0
    v_mov_b32 v58, 0
    v_mov_b32 v59, 0
    v_mov_b32 v60, 0
    v_mov_b32 v61, 0
    v_mov_b32 v62, 0
    v_mov_b32 v63, 0
    s_barrier
    s_setprio 3
    buffer_load_dwordx4 v[24:27], v4, s[8:11], s30 offen offset:0 sc1
    s_setprio 2
    buffer_load_dwordx4 v[28:31], v4, s[8:11], s30 offen offset:1024 sc1
    s_setprio 1
    buffer_load_dwordx4 v[32:35], v4, s[8:11], s30 offen offset:2048 sc1
    s_setprio 0
    buffer_load_dwordx4 v[36:39], v4, s[8:11], s30 offen offset:3072 sc1
    s_waitcnt vmcnt(3)
    v_cmp_eq_u32 vcc, -1, v27
    s_cbranch_vccnz .gs_141
.gr_142:
    v_smfmac_f32_16x16x64_bf16 v[64:67], v[24:27], a[192:199], v2
    v_smfmac_f32_16x16x64_bf16 v[68:71], v[24:27], a[224:231], v2
    s_waitcnt vmcnt(2)
    v_cmp_eq_u32 vcc, -1, v31
    s_cbranch_vccnz .gs_143
.gr_144:
    v_smfmac_f32_16x16x64_bf16 v[64:67], v[28:31], a[200:207], v2
    v_smfmac_f32_16x16x64_bf16 v[68:71], v[28:31], a[232:239], v2
    s_waitcnt vmcnt(1)
    v_cmp_eq_u32 vcc, -1, v35
    s_cbranch_vccnz .gs_145
.gr_146:
    v_smfmac_f32_16x16x64_bf16 v[64:67], v[32:35], a[208:215], v2
    v_smfmac_f32_16x16x64_bf16 v[68:71], v[32:35], a[240:247], v2
    s_waitcnt vmcnt(0)
    v_cmp_eq_u32 vcc, -1, v39
    s_cbranch_vccnz .gs_147
.gr_148:
    v_smfmac_f32_16x16x64_bf16 v[64:67], v[36:39], a[216:223], v2
    v_smfmac_f32_16x16x64_bf16 v[68:71], v[36:39], a[248:255], v2
    s_nop 7
    v_permlane32_swap_b32 v64, v68
    v_permlane32_swap_b32 v65, v69
    v_permlane32_swap_b32 v66, v70
    v_permlane32_swap_b32 v67, v71
    v_add_f32 v64, v64, v68
    v_add_f32 v65, v65, v69
    v_add_f32 v66, v66, v70
    v_add_f32 v67, v67, v71
    ds_write2_b32 v7, v64, v65 offset0:0 offset1:36
    ds_write2_b32 v7, v66, v67 offset0:72 offset1:108
    s_waitcnt lgkmcnt(0)
    s_barrier
    ds_read_b128 v[72:75], v12 offset:0
    ds_read_b128 v[76:79], v12 offset:1152
    ds_read_b128 v[80:83], v12 offset:2304
    ds_read_b128 v[84:87], v12 offset:3456
    s_waitcnt lgkmcnt(2)
    v_add_f32 v72, v72, v76
    v_add_f32 v73, v73, v77
    v_add_f32 v74, v74, v78
    v_add_f32 v75, v75, v79
    s_waitcnt lgkmcnt(0)
    v_add_f32 v80, v80, v84
    v_add_f32 v81, v81, v85
    v_add_f32 v82, v82, v86
    v_add_f32 v83, v83, v87
    v_add_f32 v72, v72, v80
    v_add_f32 v73, v73, v81
    v_add_f32 v74, v74, v82
    v_add_f32 v75, v75, v83
    v_min_u32 v75, 0xfffffffe, v75
    buffer_store_dwordx4 v[72:75], v13, s[8:11], s34 offen sc1
    v_mov_b32 v64, 0
    v_mov_b32 v65, 0
    v_mov_b32 v66, 0
    v_mov_b32 v67, 0
    v_mov_b32 v68, 0
    v_mov_b32 v69, 0
    v_mov_b32 v70, 0
    v_mov_b32 v71, 0
    s_waitcnt vmcnt(0)
.pl_149:
    buffer_load_dwordx4 v[76:79], v13, s[8:11], s38 offen sc1
    buffer_load_dwordx4 v[80:83], v13, s[8:11], s39 offen sc1
    buffer_load_dwordx4 v[84:87], v13, s[8:11], s40 offen sc1
    s_waitcnt vmcnt(2)
    v_add_f32 v88, v72, v76
    v_add_f32 v89, v73, v77
    v_add_f32 v90, v74, v78
    v_add_f32 v91, v75, v79
    s_waitcnt vmcnt(0)
    v_max3_u32 v18, v79, v83, v87
    v_cmp_eq_u32 vcc, -1, v18
    v_add_f32 v80, v80, v84
    v_add_f32 v81, v81, v85
    v_add_f32 v82, v82, v86
    v_add_f32 v83, v83, v87
    v_add_f32 v88, v88, v80
    v_add_f32 v89, v89, v81
    v_add_f32 v90, v90, v82
    v_add_f32 v91, v91, v83
    v_cvt_pk_bf16_f32 v92, v88, v89
    v_cvt_pk_bf16_f32 v93, v90, v91
    v_min_u32 v93, 0xfffffffe, v93
    s_cbranch_vccnz .pr_150
    buffer_store_dwordx2 v[92:93], v14, s[8:11], s31 offen sc1
    s_mov_b32 s4, s30
    s_mov_b32 s30, s31
    s_mov_b32 s31, s32
    s_mov_b32 s32, s33
    s_mov_b32 s33, s4
    s_add_u32 s28, s28, 1
    s_mov_b32 s62, 0
    s_mov_b32 s4, s34
    s_mov_b32 s34, s35
    s_mov_b32 s35, s36
    s_mov_b32 s36, s37
    s_mov_b32 s37, s4
    s_branch .step_131
.fin_132:
    s_endpgm
.gs_133:
    buffer_load_dwordx4 v[24:27], v3, s[8:11], s30 offen offset:0 sc1
    buffer_load_dwordx4 v[28:31], v3, s[8:11], s30 offen offset:1024 sc1
    buffer_load_dwordx4 v[32:35], v3, s[8:11], s30 offen offset:2048 sc1
    buffer_load_dwordx4 v[36:39], v3, s[8:11], s30 offen offset:3072 sc1
    s_add_u32 s62, s62, 1
    s_cmp_gt_u32 s62, 0x100000
    s_cbranch_scc1 .mg_end_1
    s_waitcnt vmcnt(3)
    v_max_u32 v18, v25, v27
    v_cmp_eq_u32 vcc, -1, v18
    s_cbranch_vccz .gr_134
    s_branch .gs_133
.gs_135:
    buffer_load_dwordx4 v[28:31], v3, s[8:11], s30 offen offset:1024 sc1
    buffer_load_dwordx4 v[32:35], v3, s[8:11], s30 offen offset:2048 sc1
    buffer_load_dwordx4 v[36:39], v3, s[8:11], s30 offen offset:3072 sc1
    s_add_u32 s62, s62, 1
    s_cmp_gt_u32 s62, 0x100000
    s_cbranch_scc1 .mg_end_1
    s_waitcnt vmcnt(2)
    v_max_u32 v18, v29, v31
    v_cmp_eq_u32 vcc, -1, v18
    s_cbranch_vccz .gr_136
    s_branch .gs_135
.gs_137:
    buffer_load_dwordx4 v[32:35], v3, s[8:11], s30 offen offset:2048 sc1
    buffer_load_dwordx4 v[36:39], v3, s[8:11], s30 offen offset:3072 sc1
    s_add_u32 s62, s62, 1
    s_cmp_gt_u32 s62, 0x100000
    s_cbranch_scc1 .mg_end_1
    s_waitcnt vmcnt(1)
    v_max_u32 v18, v33, v35
    v_cmp_eq_u32 vcc, -1, v18
    s_cbranch_vccz .gr_138
    s_branch .gs_137
.gs_139:
    buffer_load_dwordx4 v[36:39], v3, s[8:11], s30 offen offset:3072 sc1
    s_add_u32 s62, s62, 1
    s_cmp_gt_u32 s62, 0x100000
    s_cbranch_scc1 .mg_end_1
    s_waitcnt vmcnt(0)
    v_max_u32 v18, v37, v39
    v_cmp_eq_u32 vcc, -1, v18
    s_cbranch_vccz .gr_140
    s_branch .gs_139
.gs_141:
    buffer_load_dwordx4 v[24:27], v4, s[8:11], s30 offen offset:0 sc1
    buffer_load_dwordx4 v[28:31], v4, s[8:11], s30 offen offset:1024 sc1
    buffer_load_dwordx4 v[32:35], v4, s[8:11], s30 offen offset:2048 sc1
    buffer_load_dwordx4 v[36:39], v4, s[8:11], s30 offen offset:3072 sc1
    s_add_u32 s62, s62, 1
    s_cmp_gt_u32 s62, 0x100000
    s_cbranch_scc1 .mg_end_1
    s_waitcnt vmcnt(3)
    v_cmp_eq_u32 vcc, -1, v27
    s_cbranch_vccz .gr_142
    s_branch .gs_141
.gs_143:
    buffer_load_dwordx4 v[28:31], v4, s[8:11], s30 offen offset:1024 sc1
    buffer_load_dwordx4 v[32:35], v4, s[8:11], s30 offen offset:2048 sc1
    buffer_load_dwordx4 v[36:39], v4, s[8:11], s30 offen offset:3072 sc1
    s_add_u32 s62, s62, 1
    s_cmp_gt_u32 s62, 0x100000
    s_cbranch_scc1 .mg_end_1
    s_waitcnt vmcnt(2)
    v_cmp_eq_u32 vcc, -1, v31
    s_cbranch_vccz .gr_144
    s_branch .gs_143
.gs_145:
    buffer_load_dwordx4 v[32:35], v4, s[8:11], s30 offen offset:2048 sc1
    buffer_load_dwordx4 v[36:39], v4, s[8:11], s30 offen offset:3072 sc1
    s_add_u32 s62, s62, 1
    s_cmp_gt_u32 s62, 0x100000
    s_cbranch_scc1 .mg_end_1
    s_waitcnt vmcnt(1)
    v_cmp_eq_u32 vcc, -1, v35
    s_cbranch_vccz .gr_146
    s_branch .gs_145
.gs_147:
    buffer_load_dwordx4 v[36:39], v4, s[8:11], s30 offen offset:3072 sc1
    s_add_u32 s62, s62, 1
    s_cmp_gt_u32 s62, 0x100000
    s_cbranch_scc1 .mg_end_1
    s_waitcnt vmcnt(0)
    v_cmp_eq_u32 vcc, -1, v39
    s_cbranch_vccz .gr_148
    s_branch .gs_147
.pr_150:
    s_add_u32 s62, s62, 1
    s_cmp_gt_u32 s62, 0x100000
    s_cbranch_scc1 .mg_end_1
    s_branch .pl_149
.w2_107:
    s_lshl_b32 s4, s56, 7
    s_lshl_b32 s5, s53, 2
    s_add_u32 s4, s4, s5
    s_add_u32 s4, s4, 92274688
    v_mov_b32 v14, s4
    v_bfe_u32 v254, v1, 0, 6
    v_mul_u32_u24 v12, 16, v254
    v_add_u32 v12, 17920, v12
    s_waitcnt vmcnt(0)
    ds_read_b64_tr_b16 a[192:193], v242 offset:16384
    ds_read_b64_tr_b16 a[194:195], v242 offset:16896
    ds_read_b64_tr_b16 a[196:197], v242 offset:18432
    ds_read_b64_tr_b16 a[198:199], v242 offset:18944
    ds_read_b64_tr_b16 a[200:201], v242 offset:20480
    ds_read_b64_tr_b16 a[202:203], v242 offset:20992
    ds_read_b64_tr_b16 a[204:205], v242 offset:22528
    ds_read_b64_tr_b16 a[206:207], v242 offset:23040
    ds_read_b64_tr_b16 a[208:209], v242 offset:24576
    ds_read_b64_tr_b16 a[210:211], v242 offset:25088
    ds_read_b64_tr_b16 a[212:213], v242 offset:26624
    ds_read_b64_tr_b16 a[214:215], v242 offset:27136
    ds_read_b64_tr_b16 a[216:217], v242 offset:28672
    ds_read_b64_tr_b16 a[218:219], v242 offset:29184
    ds_read_b64_tr_b16 a[220:221], v242 offset:30720
    ds_read_b64_tr_b16 a[222:223], v242 offset:31232
    ds_read_b64_tr_b16 a[224:225], v243 offset:16384
    ds_read_b64_tr_b16 a[226:227], v243 offset:16896
    ds_read_b64_tr_b16 a[228:229], v243 offset:18432
    ds_read_b64_tr_b16 a[230:231], v243 offset:18944
    ds_read_b64_tr_b16 a[232:233], v243 offset:20480
    ds_read_b64_tr_b16 a[234:235], v243 offset:20992
    ds_read_b64_tr_b16 a[236:237], v243 offset:22528
    ds_read_b64_tr_b16 a[238:239], v243 offset:23040
    ds_read_b64_tr_b16 a[240:241], v243 offset:24576
    ds_read_b64_tr_b16 a[242:243], v243 offset:25088
    ds_read_b64_tr_b16 a[244:245], v243 offset:26624
    ds_read_b64_tr_b16 a[246:247], v243 offset:27136
    ds_read_b64_tr_b16 a[248:249], v243 offset:28672
    ds_read_b64_tr_b16 a[250:251], v243 offset:29184
    ds_read_b64_tr_b16 a[252:253], v243 offset:30720
    ds_read_b64_tr_b16 a[254:255], v243 offset:31232
    s_waitcnt lgkmcnt(0)
    s_barrier
.p2align 6
.step_151:
    s_barrier
    s_setprio 3
    buffer_load_dwordx4 v[24:27], v3, s[8:11], s30 offen offset:0 sc1
    s_setprio 2
    buffer_load_dwordx4 v[28:31], v3, s[8:11], s30 offen offset:1024 sc1
    s_setprio 1
    buffer_load_dwordx4 v[32:35], v3, s[8:11], s30 offen offset:2048 sc1
    s_setprio 0
    buffer_load_dwordx4 v[36:39], v3, s[8:11], s30 offen offset:3072 sc1
    s_waitcnt vmcnt(3)
    v_max_u32 v18, v25, v27
    v_cmp_eq_u32 vcc, -1, v18
    s_cbranch_vccnz .gs_153
.gr_154:
    v_smfmac_f32_16x16x64_bf16 v[40:43], v[24:27], a[0:7], v2
    v_smfmac_f32_16x16x64_bf16 v[44:47], v[24:27], a[32:39], v2
    s_waitcnt vmcnt(2)
    v_max_u32 v18, v29, v31
    v_cmp_eq_u32 vcc, -1, v18
    v_smfmac_f32_16x16x64_bf16 v[48:51], v[24:27], a[64:71], v2
    s_cbranch_vccnz .gs_155
.gr_156:
    v_smfmac_f32_16x16x64_bf16 v[40:43], v[28:31], a[8:15], v2
    v_smfmac_f32_16x16x64_bf16 v[44:47], v[28:31], a[40:47], v2
    v_smfmac_f32_16x16x64_bf16 v[52:55], v[24:27], a[96:103], v2
    s_waitcnt vmcnt(1)
    v_max_u32 v18, v33, v35
    v_cmp_eq_u32 vcc, -1, v18
    v_smfmac_f32_16x16x64_bf16 v[48:51], v[28:31], a[72:79], v2
    s_cbranch_vccnz .gs_157
.gr_158:
    v_smfmac_f32_16x16x64_bf16 v[40:43], v[32:35], a[16:23], v2
    v_smfmac_f32_16x16x64_bf16 v[44:47], v[32:35], a[48:55], v2
    v_smfmac_f32_16x16x64_bf16 v[52:55], v[28:31], a[104:111], v2
    s_waitcnt vmcnt(0)
    v_max_u32 v18, v37, v39
    v_cmp_eq_u32 vcc, -1, v18
    v_smfmac_f32_16x16x64_bf16 v[48:51], v[32:35], a[80:87], v2
    s_cbranch_vccnz .gs_159
.gr_160:
    v_smfmac_f32_16x16x64_bf16 v[40:43], v[36:39], a[24:31], v2
    v_smfmac_f32_16x16x64_bf16 v[44:47], v[36:39], a[56:63], v2
    v_smfmac_f32_16x16x64_bf16 v[52:55], v[32:35], a[112:119], v2
    v_smfmac_f32_16x16x64_bf16 v[48:51], v[36:39], a[88:95], v2
    v_permlane32_swap_b32 v40, v44
    v_permlane32_swap_b32 v41, v45
    v_smfmac_f32_16x16x64_bf16 v[52:55], v[36:39], a[120:127], v2
    v_permlane32_swap_b32 v42, v46
    v_permlane32_swap_b32 v43, v47
    v_add_f32 v40, v40, v44
    v_add_f32 v41, v41, v45
    v_add_f32 v42, v42, v46
    v_add_f32 v43, v43, v47
    ds_write2_b32 v5, v40, v41 offset0:0 offset1:36
    ds_write2_b32 v5, v42, v43 offset0:72 offset1:108
    v_permlane32_swap_b32 v48, v52
    v_permlane32_swap_b32 v49, v53
    v_permlane32_swap_b32 v50, v54
    v_permlane32_swap_b32 v51, v55
    v_add_f32 v48, v48, v52
    v_add_f32 v49, v49, v53
    v_add_f32 v50, v50, v54
    v_add_f32 v51, v51, v55
    ds_write2_b32 v6, v48, v49 offset0:0 offset1:36
    ds_write2_b32 v6, v50, v51 offset0:72 offset1:108
    s_waitcnt lgkmcnt(2)
    s_barrier
    s_waitcnt lgkmcnt(0)
    s_barrier
    ds_read_b64 v[72:73], v9 offset:0
    ds_read_b64 v[74:75], v9 offset:1152
    ds_read_b64 v[76:77], v9 offset:2304
    ds_read_b64 v[78:79], v9 offset:3456
    s_waitcnt lgkmcnt(2)
    v_add_f32 v72, v72, v74
    v_add_f32 v73, v73, v75
    s_waitcnt lgkmcnt(0)
    v_add_f32 v76, v76, v78
    v_add_f32 v77, v77, v79
    v_add_f32 v72, v72, v76
    v_add_f32 v73, v73, v77
    v_cvt_pk_bf16_f32 v72, v72, v73
    v_min_u32 v72, 0xfffffffe, v72
    buffer_store_dword v72, v10, s[8:11], s30 offen sc1
    v_smfmac_f32_16x16x64_bf16 v[56:59], v[24:27], a[128:135], v2
    v_smfmac_f32_16x16x64_bf16 v[60:63], v[24:27], a[160:167], v2
    v_smfmac_f32_16x16x64_bf16 v[56:59], v[28:31], a[136:143], v2
    v_smfmac_f32_16x16x64_bf16 v[60:63], v[28:31], a[168:175], v2
    v_smfmac_f32_16x16x64_bf16 v[56:59], v[32:35], a[144:151], v2
    v_smfmac_f32_16x16x64_bf16 v[60:63], v[32:35], a[176:183], v2
    v_smfmac_f32_16x16x64_bf16 v[56:59], v[36:39], a[152:159], v2
    v_smfmac_f32_16x16x64_bf16 v[60:63], v[36:39], a[184:191], v2
    ds_write_b32 v11, v72
    v_mov_b32 v40, 0
    v_mov_b32 v41, 0
    v_mov_b32 v42, 0
    v_mov_b32 v43, 0
    v_mov_b32 v44, 0
    v_mov_b32 v45, 0
    v_mov_b32 v46, 0
    v_mov_b32 v47, 0
    v_permlane32_swap_b32 v56, v60
    v_permlane32_swap_b32 v57, v61
    v_permlane32_swap_b32 v58, v62
    v_permlane32_swap_b32 v59, v63
    v_add_f32 v56, v56, v60
    v_add_f32 v57, v57, v61
    v_add_f32 v58, v58, v62
    v_add_f32 v59, v59, v63
    ds_write_b128 v8, v[56:59]
    s_waitcnt lgkmcnt(0)
    s_barrier
    s_barrier
    ds_read_b128 v[72:75], v12
    s_cmp_eq_u32 s28, 63
    s_cbranch_scc1 .fin_152
    v_mov_b32 v48, 0
    v_mov_b32 v49, 0
    v_mov_b32 v50, 0
    v_mov_b32 v51, 0
    v_mov_b32 v52, 0
    v_mov_b32 v53, 0
    v_mov_b32 v54, 0
    v_mov_b32 v55, 0
    v_mov_b32 v56, 0
    v_mov_b32 v57, 0
    v_mov_b32 v58, 0
    v_mov_b32 v59, 0
    v_mov_b32 v60, 0
    v_mov_b32 v61, 0
    v_mov_b32 v62, 0
    v_mov_b32 v63, 0
    s_barrier
    s_setprio 3
    buffer_load_dwordx4 v[24:27], v4, s[8:11], s30 offen offset:0 sc1
    s_setprio 2
    buffer_load_dwordx4 v[28:31], v4, s[8:11], s30 offen offset:1024 sc1
    s_setprio 1
    buffer_load_dwordx4 v[32:35], v4, s[8:11], s30 offen offset:2048 sc1
    s_setprio 0
    buffer_load_dwordx4 v[36:39], v4, s[8:11], s30 offen offset:3072 sc1
    s_waitcnt vmcnt(3)
    v_cmp_eq_u32 vcc, -1, v27
    s_cbranch_vccnz .gs_161
.gr_162:
    v_smfmac_f32_16x16x64_bf16 v[64:67], v[24:27], a[192:199], v2
    v_smfmac_f32_16x16x64_bf16 v[68:71], v[24:27], a[224:231], v2
    s_waitcnt vmcnt(2)
    v_cmp_eq_u32 vcc, -1, v31
    s_cbranch_vccnz .gs_163
.gr_164:
    v_smfmac_f32_16x16x64_bf16 v[64:67], v[28:31], a[200:207], v2
    v_smfmac_f32_16x16x64_bf16 v[68:71], v[28:31], a[232:239], v2
    s_waitcnt vmcnt(1)
    v_cmp_eq_u32 vcc, -1, v35
    s_cbranch_vccnz .gs_165
.gr_166:
    v_smfmac_f32_16x16x64_bf16 v[64:67], v[32:35], a[208:215], v2
    v_smfmac_f32_16x16x64_bf16 v[68:71], v[32:35], a[240:247], v2
    s_waitcnt vmcnt(0)
    v_cmp_eq_u32 vcc, -1, v39
    s_cbranch_vccnz .gs_167
.gr_168:
    v_smfmac_f32_16x16x64_bf16 v[64:67], v[36:39], a[216:223], v2
    v_smfmac_f32_16x16x64_bf16 v[68:71], v[36:39], a[248:255], v2
    s_nop 7
    v_permlane32_swap_b32 v64, v68
    v_permlane32_swap_b32 v65, v69
    v_permlane32_swap_b32 v66, v70
    v_permlane32_swap_b32 v67, v71
    v_add_f32 v64, v64, v68
    v_add_f32 v65, v65, v69
    v_add_f32 v66, v66, v70
    v_add_f32 v67, v67, v71
    ds_write2_b32 v7, v64, v65 offset0:0 offset1:36
    ds_write2_b32 v7, v66, v67 offset0:72 offset1:108
    s_waitcnt lgkmcnt(0)
    s_barrier
    buffer_store_dwordx4 v[72:75], v244, s[8:11], s41 offen sc1
    v_mov_b32 v18, s28
    s_mov_b64 exec, 1
    buffer_store_dword v18, v14, s[8:11], 0 offen sc1
    s_mov_b64 exec, -1
    v_mov_b32 v64, 0
    v_mov_b32 v65, 0
    v_mov_b32 v66, 0
    v_mov_b32 v67, 0
    v_mov_b32 v68, 0
    v_mov_b32 v69, 0
    v_mov_b32 v70, 0
    v_mov_b32 v71, 0
    s_mov_b32 s4, s30
    s_mov_b32 s30, s31
    s_mov_b32 s31, s32
    s_mov_b32 s32, s33
    s_mov_b32 s33, s4
    s_add_u32 s28, s28, 1
    s_mov_b32 s62, 0
    s_add_u32 s41, s41, 0x20000
    s_branch .step_151
.fin_152:
    s_waitcnt lgkmcnt(0)
    buffer_store_dwordx4 v[72:75], v244, s[8:11], s41 offen sc1
    s_waitcnt vmcnt(0)
    v_mov_b32 v18, 64
    s_mov_b64 exec, 1
    buffer_store_dword v18, v14, s[8:11], 0 offen sc1
    s_mov_b64 exec, -1
    s_endpgm
.gs_153:
    buffer_load_dwordx4 v[24:27], v3, s[8:11], s30 offen offset:0 sc1
    buffer_load_dwordx4 v[28:31], v3, s[8:11], s30 offen offset:1024 sc1
    buffer_load_dwordx4 v[32:35], v3, s[8:11], s30 offen offset:2048 sc1
    buffer_load_dwordx4 v[36:39], v3, s[8:11], s30 offen offset:3072 sc1
    s_add_u32 s62, s62, 1
    s_cmp_gt_u32 s62, 0x100000
    s_cbranch_scc1 .mg_end_1
    s_waitcnt vmcnt(3)
    v_max_u32 v18, v25, v27
    v_cmp_eq_u32 vcc, -1, v18
    s_cbranch_vccz .gr_154
    s_branch .gs_153
.gs_155:
    buffer_load_dwordx4 v[28:31], v3, s[8:11], s30 offen offset:1024 sc1
    buffer_load_dwordx4 v[32:35], v3, s[8:11], s30 offen offset:2048 sc1
    buffer_load_dwordx4 v[36:39], v3, s[8:11], s30 offen offset:3072 sc1
    s_add_u32 s62, s62, 1
    s_cmp_gt_u32 s62, 0x100000
    s_cbranch_scc1 .mg_end_1
    s_waitcnt vmcnt(2)
    v_max_u32 v18, v29, v31
    v_cmp_eq_u32 vcc, -1, v18
    s_cbranch_vccz .gr_156
    s_branch .gs_155
.gs_157:
    buffer_load_dwordx4 v[32:35], v3, s[8:11], s30 offen offset:2048 sc1
    buffer_load_dwordx4 v[36:39], v3, s[8:11], s30 offen offset:3072 sc1
    s_add_u32 s62, s62, 1
    s_cmp_gt_u32 s62, 0x100000
    s_cbranch_scc1 .mg_end_1
    s_waitcnt vmcnt(1)
    v_max_u32 v18, v33, v35
    v_cmp_eq_u32 vcc, -1, v18
    s_cbranch_vccz .gr_158
    s_branch .gs_157
.gs_159:
    buffer_load_dwordx4 v[36:39], v3, s[8:11], s30 offen offset:3072 sc1
    s_add_u32 s62, s62, 1
    s_cmp_gt_u32 s62, 0x100000
    s_cbranch_scc1 .mg_end_1
    s_waitcnt vmcnt(0)
    v_max_u32 v18, v37, v39
    v_cmp_eq_u32 vcc, -1, v18
    s_cbranch_vccz .gr_160
    s_branch .gs_159
.gs_161:
    buffer_load_dwordx4 v[24:27], v4, s[8:11], s30 offen offset:0 sc1
    buffer_load_dwordx4 v[28:31], v4, s[8:11], s30 offen offset:1024 sc1
    buffer_load_dwordx4 v[32:35], v4, s[8:11], s30 offen offset:2048 sc1
    buffer_load_dwordx4 v[36:39], v4, s[8:11], s30 offen offset:3072 sc1
    s_add_u32 s62, s62, 1
    s_cmp_gt_u32 s62, 0x100000
    s_cbranch_scc1 .mg_end_1
    s_waitcnt vmcnt(3)
    v_cmp_eq_u32 vcc, -1, v27
    s_cbranch_vccz .gr_162
    s_branch .gs_161
.gs_163:
    buffer_load_dwordx4 v[28:31], v4, s[8:11], s30 offen offset:1024 sc1
    buffer_load_dwordx4 v[32:35], v4, s[8:11], s30 offen offset:2048 sc1
    buffer_load_dwordx4 v[36:39], v4, s[8:11], s30 offen offset:3072 sc1
    s_add_u32 s62, s62, 1
    s_cmp_gt_u32 s62, 0x100000
    s_cbranch_scc1 .mg_end_1
    s_waitcnt vmcnt(2)
    v_cmp_eq_u32 vcc, -1, v31
    s_cbranch_vccz .gr_164
    s_branch .gs_163
.gs_165:
    buffer_load_dwordx4 v[32:35], v4, s[8:11], s30 offen offset:2048 sc1
    buffer_load_dwordx4 v[36:39], v4, s[8:11], s30 offen offset:3072 sc1
    s_add_u32 s62, s62, 1
    s_cmp_gt_u32 s62, 0x100000
    s_cbranch_scc1 .mg_end_1
    s_waitcnt vmcnt(1)
    v_cmp_eq_u32 vcc, -1, v35
    s_cbranch_vccz .gr_166
    s_branch .gs_165
.gs_167:
    buffer_load_dwordx4 v[36:39], v4, s[8:11], s30 offen offset:3072 sc1
    s_add_u32 s62, s62, 1
    s_cmp_gt_u32 s62, 0x100000
    s_cbranch_scc1 .mg_end_1
    s_waitcnt vmcnt(0)
    v_cmp_eq_u32 vcc, -1, v39
    s_cbranch_vccz .gr_168
    s_branch .gs_167
.w3_108:
    v_bfe_u32 v254, v1, 3, 1
    v_mul_u32_u24 v12, 512, v254
    v_bfe_u32 v254, v1, 5, 1
    v_mul_u32_u24 v254, 256, v254
    v_add_u32 v12, v12, v254
    v_bfe_u32 v254, v1, 2, 1
    v_mul_u32_u24 v254, 128, v254
    v_add_u32 v12, v12, v254
    v_bfe_u32 v254, v1, 0, 2
    v_mul_u32_u24 v254, 16, v254
    v_add_u32 v12, v12, v254
    v_bfe_u32 v254, v1, 4, 1
    v_mul_u32_u24 v254, 8, v254
    v_add_u32 v12, v12, v254
    v_add_u32 v12, 13824, v12
    v_bfe_u32 v254, v1, 2, 2
    v_mul_u32_u24 v14, 128, v254
    v_bfe_u32 v254, v1, 0, 2
    v_mul_u32_u24 v254, 16, v254
    v_add_u32 v14, v14, v254
    v_bfe_u32 v254, v1, 4, 2
    v_mul_u32_u24 v254, 4, v254
    v_add_u32 v14, v14, v254
    v_add_u32 v14, 18432, v14
    v_bfe_u32 v254, v1, 0, 6
    v_mul_u32_u24 v15, 16, v254
    v_add_u32 v15, s101, v15
    s_lshl_b32 s4, s56, 7
    s_add_u32 s4, s4, 92278784
    v_bfe_u32 v254, v1, 0, 2
    v_mul_u32_u24 v13, 4, v254
    v_bfe_u32 v254, v1, 2, 1
    v_mul_u32_u24 v254, 4096, v254
    v_add_u32 v13, v13, v254
    v_add_u32 v13, s4, v13
    s_waitcnt vmcnt(0)
    ds_read_b64_tr_b16 a[192:193], v242 offset:16384
    ds_read_b64_tr_b16 a[194:195], v242 offset:16896
    ds_read_b64_tr_b16 a[196:197], v242 offset:18432
    ds_read_b64_tr_b16 a[198:199], v242 offset:18944
    ds_read_b64_tr_b16 a[200:201], v242 offset:20480
    ds_read_b64_tr_b16 a[202:203], v242 offset:20992
    ds_read_b64_tr_b16 a[204:205], v242 offset:22528
    ds_read_b64_tr_b16 a[206:207], v242 offset:23040
    ds_read_b64_tr_b16 a[208:209], v242 offset:24576
    ds_read_b64_tr_b16 a[210:211], v242 offset:25088
    ds_read_b64_tr_b16 a[212:213], v242 offset:26624
    ds_read_b64_tr_b16 a[214:215], v242 offset:27136
    ds_read_b64_tr_b16 a[216:217], v242 offset:28672
    ds_read_b64_tr_b16 a[218:219], v242 offset:29184
    ds_read_b64_tr_b16 a[220:221], v242 offset:30720
    ds_read_b64_tr_b16 a[222:223], v242 offset:31232
    ds_read_b64_tr_b16 a[224:225], v243 offset:16384
    ds_read_b64_tr_b16 a[226:227], v243 offset:16896
    ds_read_b64_tr_b16 a[228:229], v243 offset:18432
    ds_read_b64_tr_b16 a[230:231], v243 offset:18944
    ds_read_b64_tr_b16 a[232:233], v243 offset:20480
    ds_read_b64_tr_b16 a[234:235], v243 offset:20992
    ds_read_b64_tr_b16 a[236:237], v243 offset:22528
    ds_read_b64_tr_b16 a[238:239], v243 offset:23040
    ds_read_b64_tr_b16 a[240:241], v243 offset:24576
    ds_read_b64_tr_b16 a[242:243], v243 offset:25088
    ds_read_b64_tr_b16 a[244:245], v243 offset:26624
    ds_read_b64_tr_b16 a[246:247], v243 offset:27136
    ds_read_b64_tr_b16 a[248:249], v243 offset:28672
    ds_read_b64_tr_b16 a[250:251], v243 offset:29184
    ds_read_b64_tr_b16 a[252:253], v243 offset:30720
    ds_read_b64_tr_b16 a[254:255], v243 offset:31232
    s_waitcnt lgkmcnt(0)
    s_cmp_ge_u32 s46, 2
    s_cbranch_scc1 .kvd_170
    s_mov_b32 s62, 0
.kv_169:
    buffer_load_dword v18, v13, s[8:11], 0 offen sc1
    s_add_u32 s62, s62, 1
    s_cmp_gt_u32 s62, 0x100000
    s_cbranch_scc1 .mg_end_1
    s_waitcnt vmcnt(0)
    v_min_u32_dpp v18, v18, v18 quad_perm:[1,0,3,2] row_mask:0xf bank_mask:0xf
    s_nop 1
    v_min_u32_dpp v18, v18, v18 quad_perm:[2,3,0,1] row_mask:0xf bank_mask:0xf
    s_nop 1
    v_min_u32_dpp v18, v18, v18 row_half_mirror row_mask:0xf bank_mask:0xf
    s_nop 0
    v_readfirstlane_b32 s46, v18
    s_cmp_lt_u32 s46, 2
    s_cbranch_scc1 .kv_169
.kvd_170:
    s_barrier
.p2align 6
.step_171:
    s_barrier
    s_setprio 3
    buffer_load_dwordx4 v[24:27], v3, s[8:11], s30 offen offset:0 sc1
    s_setprio 2
    buffer_load_dwordx4 v[28:31], v3, s[8:11], s30 offen offset:1024 sc1
    s_setprio 1
    buffer_load_dwordx4 v[32:35], v3, s[8:11], s30 offen offset:2048 sc1
    s_setprio 0
    buffer_load_dwordx4 v[36:39], v3, s[8:11], s30 offen offset:3072 sc1
    s_waitcnt vmcnt(3)
    v_max_u32 v18, v25, v27
    v_cmp_eq_u32 vcc, -1, v18
    s_cbranch_vccnz .gs_173
.gr_174:
    v_smfmac_f32_16x16x64_bf16 v[40:43], v[24:27], a[0:7], v2
    v_smfmac_f32_16x16x64_bf16 v[44:47], v[24:27], a[32:39], v2
    s_waitcnt vmcnt(2)
    v_max_u32 v18, v29, v31
    v_cmp_eq_u32 vcc, -1, v18
    v_smfmac_f32_16x16x64_bf16 v[48:51], v[24:27], a[64:71], v2
    s_cbranch_vccnz .gs_175
.gr_176:
    v_smfmac_f32_16x16x64_bf16 v[40:43], v[28:31], a[8:15], v2
    v_smfmac_f32_16x16x64_bf16 v[44:47], v[28:31], a[40:47], v2
    v_smfmac_f32_16x16x64_bf16 v[52:55], v[24:27], a[96:103], v2
    s_waitcnt vmcnt(1)
    v_max_u32 v18, v33, v35
    v_cmp_eq_u32 vcc, -1, v18
    v_smfmac_f32_16x16x64_bf16 v[48:51], v[28:31], a[72:79], v2
    s_cbranch_vccnz .gs_177
.gr_178:
    v_smfmac_f32_16x16x64_bf16 v[40:43], v[32:35], a[16:23], v2
    v_smfmac_f32_16x16x64_bf16 v[44:47], v[32:35], a[48:55], v2
    v_smfmac_f32_16x16x64_bf16 v[52:55], v[28:31], a[104:111], v2
    s_waitcnt vmcnt(0)
    v_max_u32 v18, v37, v39
    v_cmp_eq_u32 vcc, -1, v18
    v_smfmac_f32_16x16x64_bf16 v[48:51], v[32:35], a[80:87], v2
    s_cbranch_vccnz .gs_179
.gr_180:
    v_smfmac_f32_16x16x64_bf16 v[40:43], v[36:39], a[24:31], v2
    v_smfmac_f32_16x16x64_bf16 v[44:47], v[36:39], a[56:63], v2
    v_smfmac_f32_16x16x64_bf16 v[52:55], v[32:35], a[112:119], v2
    v_smfmac_f32_16x16x64_bf16 v[48:51], v[36:39], a[88:95], v2
    v_permlane32_swap_b32 v40, v44
    v_permlane32_swap_b32 v41, v45
    v_smfmac_f32_16x16x64_bf16 v[52:55], v[36:39], a[120:127], v2
    v_permlane32_swap_b32 v42, v46
    v_permlane32_swap_b32 v43, v47
    v_add_f32 v40, v40, v44
    v_add_f32 v41, v41, v45
    v_add_f32 v42, v42, v46
    v_add_f32 v43, v43, v47
    ds_write2_b32 v5, v40, v41 offset0:0 offset1:36
    ds_write2_b32 v5, v42, v43 offset0:72 offset1:108
    v_permlane32_swap_b32 v48, v52
    v_permlane32_swap_b32 v49, v53
    v_permlane32_swap_b32 v50, v54
    v_permlane32_swap_b32 v51, v55
    v_add_f32 v48, v48, v52
    v_add_f32 v49, v49, v53
    v_add_f32 v50, v50, v54
    v_add_f32 v51, v51, v55
    ds_write2_b32 v6, v48, v49 offset0:0 offset1:36
    ds_write2_b32 v6, v50, v51 offset0:72 offset1:108
    s_waitcnt lgkmcnt(2)
    s_barrier
    s_waitcnt lgkmcnt(0)
    s_barrier
    ds_read_b64 v[72:73], v9 offset:0
    ds_read_b64 v[74:75], v9 offset:1152
    ds_read_b64 v[76:77], v9 offset:2304
    ds_read_b64 v[78:79], v9 offset:3456
    s_waitcnt lgkmcnt(2)
    v_add_f32 v72, v72, v74
    v_add_f32 v73, v73, v75
    s_waitcnt lgkmcnt(0)
    v_add_f32 v76, v76, v78
    v_add_f32 v77, v77, v79
    v_add_f32 v72, v72, v76
    v_add_f32 v73, v73, v77
    v_cvt_pk_bf16_f32 v72, v72, v73
    v_min_u32 v72, 0xfffffffe, v72
    buffer_store_dword v72, v10, s[8:11], s30 offen sc1
    v_smfmac_f32_16x16x64_bf16 v[56:59], v[24:27], a[128:135], v2
    v_smfmac_f32_16x16x64_bf16 v[60:63], v[24:27], a[160:167], v2
    v_smfmac_f32_16x16x64_bf16 v[56:59], v[28:31], a[136:143], v2
    v_smfmac_f32_16x16x64_bf16 v[60:63], v[28:31], a[168:175], v2
    v_smfmac_f32_16x16x64_bf16 v[56:59], v[32:35], a[144:151], v2
    v_smfmac_f32_16x16x64_bf16 v[60:63], v[32:35], a[176:183], v2
    v_smfmac_f32_16x16x64_bf16 v[56:59], v[36:39], a[152:159], v2
    v_smfmac_f32_16x16x64_bf16 v[60:63], v[36:39], a[184:191], v2
    ds_write_b32 v11, v72
    v_mov_b32 v40, 0
    v_mov_b32 v41, 0
    v_mov_b32 v42, 0
    v_mov_b32 v43, 0
    v_mov_b32 v44, 0
    v_mov_b32 v45, 0
    v_mov_b32 v46, 0
    v_mov_b32 v47, 0
    v_permlane32_swap_b32 v56, v60
    v_permlane32_swap_b32 v57, v61
    v_permlane32_swap_b32 v58, v62
    v_permlane32_swap_b32 v59, v63
    v_add_f32 v56, v56, v60
    v_add_f32 v57, v57, v61
    v_add_f32 v58, v58, v62
    v_add_f32 v59, v59, v63
    ds_write_b128 v8, v[56:59]
    s_waitcnt lgkmcnt(0)
    s_barrier
    ds_read_b64 v[72:73], v12 offset:0
    ds_read_b64 v[74:75], v12 offset:1024
    ds_read_b64 v[76:77], v12 offset:2048
    ds_read_b64 v[78:79], v12 offset:3072
    ds_read_b64 v[80:81], v12 offset:64
    ds_read_b64 v[82:83], v12 offset:1088
    ds_read_b64 v[84:85], v12 offset:2112
    ds_read_b64 v[86:87], v12 offset:3136
    s_waitcnt lgkmcnt(4)
    v_add_f32 v72, v72, v74
    v_add_f32 v73, v73, v75
    v_add_f32 v76, v76, v78
    v_add_f32 v77, v77, v79
    v_add_f32 v72, v72, v76
    v_add_f32 v73, v73, v77
    v_cvt_pk_bf16_f32 v72, v72, v73
    s_waitcnt lgkmcnt(0)
    v_add_f32 v80, v80, v82
    v_add_f32 v81, v81, v83
    v_add_f32 v84, v84, v86
    v_add_f32 v85, v85, v87
    v_add_f32 v80, v80, v84
    v_add_f32 v81, v81, v85
    v_cvt_pk_bf16_f32 v80, v80, v81
    ds_write_b32 v14, v72
    ds_write_b32 v14, v80 offset:64
    s_waitcnt lgkmcnt(0)
    s_barrier
    s_cmp_eq_u32 s28, 63
    s_cbranch_scc1 .fin_172
    v_mov_b32 v48, 0
    v_mov_b32 v49, 0
    v_mov_b32 v50, 0
    v_mov_b32 v51, 0
    v_mov_b32 v52, 0
    v_mov_b32 v53, 0
    v_mov_b32 v54, 0
    v_mov_b32 v55, 0
    v_mov_b32 v56, 0
    v_mov_b32 v57, 0
    v_mov_b32 v58, 0
    v_mov_b32 v59, 0
    v_mov_b32 v60, 0
    v_mov_b32 v61, 0
    v_mov_b32 v62, 0
    v_mov_b32 v63, 0
    s_barrier
    s_setprio 3
    buffer_load_dwordx4 v[24:27], v4, s[8:11], s30 offen offset:0 sc1
    s_setprio 2
    buffer_load_dwordx4 v[28:31], v4, s[8:11], s30 offen offset:1024 sc1
    s_setprio 1
    buffer_load_dwordx4 v[32:35], v4, s[8:11], s30 offen offset:2048 sc1
    s_setprio 0
    buffer_load_dwordx4 v[36:39], v4, s[8:11], s30 offen offset:3072 sc1
    s_waitcnt vmcnt(3)
    v_cmp_eq_u32 vcc, -1, v27
    s_cbranch_vccnz .gs_181
.gr_182:
    v_smfmac_f32_16x16x64_bf16 v[64:67], v[24:27], a[192:199], v2
    v_smfmac_f32_16x16x64_bf16 v[68:71], v[24:27], a[224:231], v2
    s_waitcnt vmcnt(2)
    v_cmp_eq_u32 vcc, -1, v31
    s_cbranch_vccnz .gs_183
.gr_184:
    v_smfmac_f32_16x16x64_bf16 v[64:67], v[28:31], a[200:207], v2
    v_smfmac_f32_16x16x64_bf16 v[68:71], v[28:31], a[232:239], v2
    s_waitcnt vmcnt(1)
    v_cmp_eq_u32 vcc, -1, v35
    s_cbranch_vccnz .gs_185
.gr_186:
    v_smfmac_f32_16x16x64_bf16 v[64:67], v[32:35], a[208:215], v2
    v_smfmac_f32_16x16x64_bf16 v[68:71], v[32:35], a[240:247], v2
    s_waitcnt vmcnt(0)
    v_cmp_eq_u32 vcc, -1, v39
    s_cbranch_vccnz .gs_187
.gr_188:
    v_smfmac_f32_16x16x64_bf16 v[64:67], v[36:39], a[216:223], v2
    v_smfmac_f32_16x16x64_bf16 v[68:71], v[36:39], a[248:255], v2
    s_nop 7
    v_permlane32_swap_b32 v64, v68
    v_permlane32_swap_b32 v65, v69
    v_permlane32_swap_b32 v66, v70
    v_permlane32_swap_b32 v67, v71
    v_add_f32 v64, v64, v68
    v_add_f32 v65, v65, v69
    v_add_f32 v66, v66, v70
    v_add_f32 v67, v67, v71
    ds_write2_b32 v7, v64, v65 offset0:0 offset1:36
    ds_write2_b32 v7, v66, v67 offset0:72 offset1:108
    s_waitcnt lgkmcnt(0)
    s_barrier
    buffer_store_dwordx4 v[20:23], v15, s[8:11], s36 offen sc1
    buffer_store_dwordx4 v[20:23], v244, s[8:11], s32 offen sc1
    buffer_store_dwordx4 v[20:23], v245, s[8:11], s32 offen sc1
    s_add_u32 s5, s28, 3
    s_min_u32 s5, s5, 64
    s_cmp_ge_u32 s46, s5
    s_cbranch_scc1 .kvd_190
    s_mov_b32 s62, 0
.kv_189:
    buffer_load_dword v18, v13, s[8:11], 0 offen sc1
    s_add_u32 s62, s62, 1
    s_cmp_gt_u32 s62, 0x100000
    s_cbranch_scc1 .mg_end_1
    s_waitcnt vmcnt(0)
    v_min_u32_dpp v18, v18, v18 quad_perm:[1,0,3,2] row_mask:0xf bank_mask:0xf
    s_nop 1
    v_min_u32_dpp v18, v18, v18 quad_perm:[2,3,0,1] row_mask:0xf bank_mask:0xf
    s_nop 1
    v_min_u32_dpp v18, v18, v18 row_half_mirror row_mask:0xf bank_mask:0xf
    s_nop 0
    v_readfirstlane_b32 s46, v18
    s_cmp_lt_u32 s46, s5
    s_cbranch_scc1 .kv_189
.kvd_190:
    v_mov_b32 v64, 0
    v_mov_b32 v65, 0
    v_mov_b32 v66, 0
    v_mov_b32 v67, 0
    v_mov_b32 v68, 0
    v_mov_b32 v69, 0
    v_mov_b32 v70, 0
    v_mov_b32 v71, 0
    s_mov_b32 s4, s30
    s_mov_b32 s30, s31
    s_mov_b32 s31, s32
    s_mov_b32 s32, s33
    s_mov_b32 s33, s4
    s_add_u32 s28, s28, 1
    s_mov_b32 s62, 0
    s_mov_b32 s4, s34
    s_mov_b32 s34, s35
    s_mov_b32 s35, s36
    s_mov_b32 s36, s37
    s_mov_b32 s37, s4
    s_add_u32 s41, s41, 0x20000
    s_branch .step_171
.fin_172:
    s_endpgm
.gs_173:
    buffer_load_dwordx4 v[24:27], v3, s[8:11], s30 offen offset:0 sc1
    buffer_load_dwordx4 v[28:31], v3, s[8:11], s30 offen offset:1024 sc1
    buffer_load_dwordx4 v[32:35], v3, s[8:11], s30 offen offset:2048 sc1
    buffer_load_dwordx4 v[36:39], v3, s[8:11], s30 offen offset:3072 sc1
    s_add_u32 s62, s62, 1
    s_cmp_gt_u32 s62, 0x100000
    s_cbranch_scc1 .mg_end_1
    s_waitcnt vmcnt(3)
    v_max_u32 v18, v25, v27
    v_cmp_eq_u32 vcc, -1, v18
    s_cbranch_vccz .gr_174
    s_branch .gs_173
.gs_175:
    buffer_load_dwordx4 v[28:31], v3, s[8:11], s30 offen offset:1024 sc1
    buffer_load_dwordx4 v[32:35], v3, s[8:11], s30 offen offset:2048 sc1
    buffer_load_dwordx4 v[36:39], v3, s[8:11], s30 offen offset:3072 sc1
    s_add_u32 s62, s62, 1
    s_cmp_gt_u32 s62, 0x100000
    s_cbranch_scc1 .mg_end_1
    s_waitcnt vmcnt(2)
    v_max_u32 v18, v29, v31
    v_cmp_eq_u32 vcc, -1, v18
    s_cbranch_vccz .gr_176
    s_branch .gs_175
.gs_177:
    buffer_load_dwordx4 v[32:35], v3, s[8:11], s30 offen offset:2048 sc1
    buffer_load_dwordx4 v[36:39], v3, s[8:11], s30 offen offset:3072 sc1
    s_add_u32 s62, s62, 1
    s_cmp_gt_u32 s62, 0x100000
    s_cbranch_scc1 .mg_end_1
    s_waitcnt vmcnt(1)
    v_max_u32 v18, v33, v35
    v_cmp_eq_u32 vcc, -1, v18
    s_cbranch_vccz .gr_178
    s_branch .gs_177
.gs_179:
    buffer_load_dwordx4 v[36:39], v3, s[8:11], s30 offen offset:3072 sc1
    s_add_u32 s62, s62, 1
    s_cmp_gt_u32 s62, 0x100000
    s_cbranch_scc1 .mg_end_1
    s_waitcnt vmcnt(0)
    v_max_u32 v18, v37, v39
    v_cmp_eq_u32 vcc, -1, v18
    s_cbranch_vccz .gr_180
    s_branch .gs_179
.gs_181:
    buffer_load_dwordx4 v[24:27], v4, s[8:11], s30 offen offset:0 sc1
    buffer_load_dwordx4 v[28:31], v4, s[8:11], s30 offen offset:1024 sc1
    buffer_load_dwordx4 v[32:35], v4, s[8:11], s30 offen offset:2048 sc1
    buffer_load_dwordx4 v[36:39], v4, s[8:11], s30 offen offset:3072 sc1
    s_add_u32 s62, s62, 1
    s_cmp_gt_u32 s62, 0x100000
    s_cbranch_scc1 .mg_end_1
    s_waitcnt vmcnt(3)
    v_cmp_eq_u32 vcc, -1, v27
    s_cbranch_vccz .gr_182
    s_branch .gs_181
.gs_183:
    buffer_load_dwordx4 v[28:31], v4, s[8:11], s30 offen offset:1024 sc1
    buffer_load_dwordx4 v[32:35], v4, s[8:11], s30 offen offset:2048 sc1
    buffer_load_dwordx4 v[36:39], v4, s[8:11], s30 offen offset:3072 sc1
    s_add_u32 s62, s62, 1
    s_cmp_gt_u32 s62, 0x100000
    s_cbranch_scc1 .mg_end_1
    s_waitcnt vmcnt(2)
    v_cmp_eq_u32 vcc, -1, v31
    s_cbranch_vccz .gr_184
    s_branch .gs_183
.gs_185:
    buffer_load_dwordx4 v[32:35], v4, s[8:11], s30 offen offset:2048 sc1
    buffer_load_dwordx4 v[36:39], v4, s[8:11], s30 offen offset:3072 sc1
    s_add_u32 s62, s62, 1
    s_cmp_gt_u32 s62, 0x100000
    s_cbranch_scc1 .mg_end_1
    s_waitcnt vmcnt(1)
    v_cmp_eq_u32 vcc, -1, v35
    s_cbranch_vccz .gr_186
    s_branch .gs_185
.gs_187:
    buffer_load_dwordx4 v[36:39], v4, s[8:11], s30 offen offset:3072 sc1
    s_add_u32 s62, s62, 1
    s_cmp_gt_u32 s62, 0x100000
    s_cbranch_scc1 .mg_end_1
    s_waitcnt vmcnt(0)
    v_cmp_eq_u32 vcc, -1, v39
    s_cbranch_vccz .gr_188
    s_branch .gs_187
.mg_bg_2:
    s_lshr_b32 s98, s26, 3
    s_add_u32 s98, s98, 1
    s_and_b32 s98, s98, 3
    s_and_b32 s99, s25, 3
    s_lshl_b32 s99, s99, 3
    s_and_b32 s4, s26, 7
    s_add_u32 s99, s99, s4
    s_mov_b32 s96, 0
    v_and_b32 v1, 63, v0
    v_mov_b32 v250, 0
    v_mov_b32 v251, 0
    s_bitcmp0_b32 s26, 4
    s_cbranch_scc1 .qkv_192
    s_bfe_u32 s95, s26, 0x10003
    s_load_dwordx8 s[40:47], s[0:1], 0
    s_load_dwordx4 s[48:51], s[0:1], 32
    s_load_dwordx2 s[52:53], s[0:1], 104
    s_mul_i32 s6, s24, 8320
    s_add_u32 s6, s6, 122880
    s_lshl_b32 s97, s95, 5
    s_add_u32 s97, s97, s99
    s_lshl_b32 s4, s97, 16
    s_lshl_b32 s5, s24, 14
    s_add_u32 s4, s4, s5
    v_lshlrev_b32 v2, 4, v1
    v_bfe_u32 v254, v1, 0, 3
    v_mul_u32_u24 v3, 2048, v254
    v_bfe_u32 v254, v1, 4, 2
    v_mul_u32_u24 v254, 16, v254
    v_add_u32 v3, v3, v254
    v_add_u32 v3, s4, v3
    v_bfe_u32 v254, v1, 4, 2
    v_mul_u32_u24 v4, 16, v254
    v_add_u32 v4, s6, v4
    s_waitcnt lgkmcnt(0)
    s_mov_b32 s12, s40
    s_and_b32 s13, s41, 0xffff
    s_mov_b32 s14, 0x400000
    s_mov_b32 s15, 0x00020000
    s_mov_b32 s16, s42
    s_and_b32 s17, s43, 0xffff
    s_mov_b32 s18, 0x400000
    s_mov_b32 s19, 0x00020000
    s_mov_b32 s28, s44
    s_and_b32 s29, s45, 0xffff
    s_mov_b32 s30, 0x400000
    s_mov_b32 s31, 0x00020000
    s_mov_b32 s32, s46
    s_and_b32 s33, s47, 0xffff
    s_mov_b32 s34, 0x2000
    s_mov_b32 s35, 0x00020000
    s_mov_b32 s36, s48
    s_and_b32 s37, s49, 0xffff
    s_mov_b32 s38, 0x400000
    s_mov_b32 s39, 0x00020000
    s_mov_b32 s56, s52
    s_and_b32 s57, s53, 0xffff
    s_mov_b32 s58, 0x800
    s_mov_b32 s59, 0x00020000
    s_mov_b32 m0, s6
    s_lshl_b32 s60, s97, 4
    buffer_load_dwordx4 v2, s[56:59], 0 offen lds
    buffer_load_dwordx4 v2, s[56:59], 0 offen offset:1024 lds
    s_add_u32 s61, s60, s24
    v_subrev_u32 v5, 4, v2
    buffer_load_dwordx4 a[0:3], v3, s[12:15], 0 offen offset:0
    buffer_load_dwordx4 a[4:7], v3, s[12:15], 0 offen offset:64
    buffer_load_dwordx4 a[8:11], v3, s[12:15], 0 offen offset:128
    buffer_load_dwordx4 a[12:15], v3, s[12:15], 0 offen offset:192
    buffer_load_dwordx4 a[16:19], v3, s[12:15], 0 offen offset:256
    buffer_load_dwordx4 a[20:23], v3, s[12:15], 0 offen offset:320
    buffer_load_dwordx4 a[24:27], v3, s[12:15], 0 offen offset:384
    buffer_load_dwordx4 a[28:31], v3, s[12:15], 0 offen offset:448
    buffer_load_dwordx4 a[32:35], v3, s[12:15], 0 offen offset:512
    buffer_load_dwordx4 a[36:39], v3, s[12:15], 0 offen offset:576
    buffer_load_dwordx4 a[40:43], v3, s[12:15], 0 offen offset:640
    buffer_load_dwordx4 a[44:47], v3, s[12:15], 0 offen offset:704
    buffer_load_dwordx4 a[48:51], v3, s[12:15], 0 offen offset:768
    buffer_load_dwordx4 a[52:55], v3, s[12:15], 0 offen offset:832
    buffer_load_dwordx4 a[56:59], v3, s[12:15], 0 offen offset:896
    buffer_load_dwordx4 a[60:63], v3, s[12:15], 0 offen offset:960
    buffer_load_dwordx4 a[64:67], v3, s[12:15], 0 offen offset:1024
    buffer_load_dwordx4 a[68:71], v3, s[12:15], 0 offen offset:1088
    buffer_load_dwordx4 a[72:75], v3, s[12:15], 0 offen offset:1152
    buffer_load_dwordx4 a[76:79], v3, s[12:15], 0 offen offset:1216
    buffer_load_dwordx4 a[80:83], v3, s[12:15], 0 offen offset:1280
    buffer_load_dwordx4 a[84:87], v3, s[12:15], 0 offen offset:1344
    buffer_load_dwordx4 a[88:91], v3, s[12:15], 0 offen offset:1408
    buffer_load_dwordx4 a[92:95], v3, s[12:15], 0 offen offset:1472
    buffer_load_dwordx4 a[96:99], v3, s[12:15], 0 offen offset:1536
    buffer_load_dwordx4 a[100:103], v3, s[12:15], 0 offen offset:1600
    buffer_load_dwordx4 a[104:107], v3, s[12:15], 0 offen offset:1664
    buffer_load_dwordx4 a[108:111], v3, s[12:15], 0 offen offset:1728
    buffer_load_dwordx4 a[112:115], v3, s[12:15], 0 offen offset:1792
    buffer_load_dwordx4 a[116:119], v3, s[12:15], 0 offen offset:1856
    buffer_load_dwordx4 a[120:123], v3, s[12:15], 0 offen offset:1920
    buffer_load_dwordx4 a[124:127], v3, s[12:15], 0 offen offset:1984
    s_lshl_b32 s4, s24, 19
    s_lshl_b32 s5, s97, 5
    s_add_u32 s4, s4, s5
    v_bfe_u32 v254, v1, 1, 5
    v_mul_u32_u24 v7, 16384, v254
    v_bfe_u32 v254, v1, 0, 1
    v_mul_u32_u24 v254, 16, v254
    v_add_u32 v7, v7, v254
    v_add_u32 v7, s4, v7
    s_waitcnt vmcnt(32)
    ds_read_b128 a[128:131], v4 offset:0
    ds_read_b128 a[132:135], v4 offset:64
    ds_read_b128 a[136:139], v4 offset:128
    ds_read_b128 a[140:143], v4 offset:192
    ds_read_b128 a[144:147], v4 offset:256
    ds_read_b128 a[148:151], v4 offset:320
    ds_read_b128 a[152:155], v4 offset:384
    ds_read_b128 a[156:159], v4 offset:448
    ds_read_b128 a[160:163], v4 offset:512
    ds_read_b128 a[164:167], v4 offset:576
    ds_read_b128 a[168:171], v4 offset:640
    ds_read_b128 a[172:175], v4 offset:704
    ds_read_b128 a[176:179], v4 offset:768
    ds_read_b128 a[180:183], v4 offset:832
    ds_read_b128 a[184:187], v4 offset:896
    ds_read_b128 a[188:191], v4 offset:960
    ds_read_b128 a[192:195], v4 offset:1024
    ds_read_b128 a[196:199], v4 offset:1088
    ds_read_b128 a[200:203], v4 offset:1152
    ds_read_b128 a[204:207], v4 offset:1216
    ds_read_b128 a[208:211], v4 offset:1280
    ds_read_b128 a[212:215], v4 offset:1344
    ds_read_b128 a[216:219], v4 offset:1408
    ds_read_b128 a[220:223], v4 offset:1472
    ds_read_b128 a[224:227], v4 offset:1536
    ds_read_b128 a[228:231], v4 offset:1600
    ds_read_b128 a[232:235], v4 offset:1664
    ds_read_b128 a[236:239], v4 offset:1728
    ds_read_b128 a[240:243], v4 offset:1792
    ds_read_b128 a[244:247], v4 offset:1856
    ds_read_b128 a[248:251], v4 offset:1920
    ds_read_b128 a[252:255], v4 offset:1984
    v_subrev_u32 v8, 6144, v7
    buffer_load_dwordx4 v[32:35], v8, s[16:19], 0 offen
    v_subrev_u32 v8, 4096, v7
    buffer_load_dwordx4 v[36:39], v8, s[16:19], 0 offen
    v_subrev_u32 v8, 2048, v7
    buffer_load_dwordx4 v[40:43], v8, s[16:19], 0 offen
    s_mov_b32 s4, 0
    buffer_load_dwordx4 v[44:47], v7, s[16:19], s4 offen offset:0
    buffer_load_dwordx4 v[76:79], v7, s[28:31], s4 offen offset:0
    buffer_load_dwordx4 v[48:51], v7, s[16:19], s4 offen offset:2048
    buffer_load_dwordx4 v[80:83], v7, s[28:31], s4 offen offset:2048
    s_mov_b32 s4, 4096
    buffer_load_dwordx4 v[52:55], v7, s[16:19], s4 offen offset:0
    buffer_load_dwordx4 v[84:87], v7, s[28:31], s4 offen offset:0
    buffer_load_dwordx4 v[56:59], v7, s[16:19], s4 offen offset:2048
    buffer_load_dwordx4 v[88:91], v7, s[28:31], s4 offen offset:2048
    s_mov_b32 s4, 8192
    buffer_load_dwordx4 v[60:63], v7, s[16:19], s4 offen offset:0
    buffer_load_dwordx4 v[92:95], v7, s[28:31], s4 offen offset:0
    buffer_load_dwordx4 v[64:67], v7, s[16:19], s4 offen offset:2048
    buffer_load_dwordx4 v[96:99], v7, s[28:31], s4 offen offset:2048
    s_mov_b32 s4, 12288
    buffer_load_dwordx4 v[68:71], v7, s[16:19], s4 offen offset:0
    buffer_load_dwordx4 v[100:103], v7, s[28:31], s4 offen offset:0
    buffer_load_dwordx4 v[72:75], v7, s[16:19], s4 offen offset:2048
    buffer_load_dwordx4 v[104:107], v7, s[28:31], s4 offen offset:2048
    v_add_u32 v9, s6, v2
    v_and_b32 v12, 31, v1
    v_lshrrev_b32 v13, 5, v1
    v_lshlrev_b32 v14, 3, v13
    v_sub_u32 v14, v12, v14
    v_add_u32 v15, 10, v14
    v_and_b32 v10, 1, v15
    v_xor_b32 v10, 1, v10
    v_mul_u32_u24 v10, 4160, v10
    v_lshrrev_b32 v15, 1, v15
    v_lshl_add_u32 v10, v15, 2, v10
    v_add_u32 v10, s6, v10
    v_mul_u32_u24 v11, 80, v12
    v_lshl_add_u32 v11, v13, 4, v11
    s_mul_i32 s4, s24, 7680
    s_sub_u32 s4, s4, 2480
    v_add_u32 v11, s4, v11
    v_cmp_eq_u32 vcc, 7, v14
    v_mov_b32 v15, 0xffff
    s_nop 0
    v_cndmask_b32 v24, 0, v15, vcc
    v_cmp_eq_u32 vcc, 6, v14
    v_mov_b32 v15, 0xffff0000
    s_nop 0
    v_cndmask_b32 v24, v24, v15, vcc
    v_cmp_eq_u32 vcc, 5, v14
    v_mov_b32 v15, 0xffff
    s_nop 0
    v_cndmask_b32 v25, 0, v15, vcc
    v_cmp_eq_u32 vcc, 4, v14
    v_mov_b32 v15, 0xffff0000
    s_nop 0
    v_cndmask_b32 v25, v25, v15, vcc
    v_cmp_eq_u32 vcc, 3, v14
    v_mov_b32 v15, 0xffff
    s_nop 0
    v_cndmask_b32 v26, 0, v15, vcc
    v_cmp_eq_u32 vcc, 2, v14
    v_mov_b32 v15, 0xffff0000
    s_nop 0
    v_cndmask_b32 v26, v26, v15, vcc
    v_cmp_eq_u32 vcc, 1, v14
    v_mov_b32 v15, 0xffff
    s_nop 0
    v_cndmask_b32 v27, 0, v15, vcc
    v_cmp_eq_u32 vcc, 0, v14
    v_mov_b32 v15, 0xffff0000
    s_nop 0
    v_cndmask_b32 v27, v27, v15, vcc
    v_cmp_eq_u32 vcc, 23, v14
    v_mov_b32 v15, 0xffff
    s_nop 0
    v_cndmask_b32 v28, 0, v15, vcc
    v_cmp_eq_u32 vcc, 22, v14
    v_mov_b32 v15, 0xffff0000
    s_nop 0
    v_cndmask_b32 v28, v28, v15, vcc
    v_cmp_eq_u32 vcc, 21, v14
    v_mov_b32 v15, 0xffff
    s_nop 0
    v_cndmask_b32 v29, 0, v15, vcc
    v_cmp_eq_u32 vcc, 20, v14
    v_mov_b32 v15, 0xffff0000
    s_nop 0
    v_cndmask_b32 v29, v29, v15, vcc
    v_cmp_eq_u32 vcc, 19, v14
    v_mov_b32 v15, 0xffff
    s_nop 0
    v_cndmask_b32 v30, 0, v15, vcc
    v_cmp_eq_u32 vcc, 18, v14
    v_mov_b32 v15, 0xffff0000
    s_nop 0
    v_cndmask_b32 v30, v30, v15, vcc
    v_cmp_eq_u32 vcc, 17, v14
    v_mov_b32 v15, 0xffff
    s_nop 0
    v_cndmask_b32 v31, 0, v15, vcc
    v_cmp_eq_u32 vcc, 16, v14
    v_mov_b32 v15, 0xffff0000
    s_nop 0
    v_cndmask_b32 v31, v31, v15, vcc
    s_waitcnt lgkmcnt(0)
    s_waitcnt vmcnt(50)
    v_mfma_f32_16x16x32_bf16 v[216:219], a[128:131], a[0:3], 0
    s_waitcnt vmcnt(49)
    v_mfma_f32_16x16x32_bf16 v[216:219], a[132:135], a[4:7], v[216:219]
    s_waitcnt vmcnt(48)
    v_mfma_f32_16x16x32_bf16 v[216:219], a[136:139], a[8:11], v[216:219]
    s_waitcnt vmcnt(47)
    v_mfma_f32_16x16x32_bf16 v[216:219], a[140:143], a[12:15], v[216:219]
    s_waitcnt vmcnt(46)
    v_mfma_f32_16x16x32_bf16 v[216:219], a[144:147], a[16:19], v[216:219]
    s_waitcnt vmcnt(45)
    v_mfma_f32_16x16x32_bf16 v[216:219], a[148:151], a[20:23], v[216:219]
    s_waitcnt vmcnt(44)
    v_mfma_f32_16x16x32_bf16 v[216:219], a[152:155], a[24:27], v[216:219]
    s_waitcnt vmcnt(43)
    v_mfma_f32_16x16x32_bf16 v[216:219], a[156:159], a[28:31], v[216:219]
    s_waitcnt vmcnt(42)
    v_mfma_f32_16x16x32_bf16 v[216:219], a[160:163], a[32:35], v[216:219]
    s_waitcnt vmcnt(41)
    v_mfma_f32_16x16x32_bf16 v[216:219], a[164:167], a[36:39], v[216:219]
    s_waitcnt vmcnt(40)
    v_mfma_f32_16x16x32_bf16 v[216:219], a[168:171], a[40:43], v[216:219]
    s_waitcnt vmcnt(39)
    v_mfma_f32_16x16x32_bf16 v[216:219], a[172:175], a[44:47], v[216:219]
    s_waitcnt vmcnt(38)
    v_mfma_f32_16x16x32_bf16 v[216:219], a[176:179], a[48:51], v[216:219]
    s_waitcnt vmcnt(37)
    v_mfma_f32_16x16x32_bf16 v[216:219], a[180:183], a[52:55], v[216:219]
    s_waitcnt vmcnt(36)
    v_mfma_f32_16x16x32_bf16 v[216:219], a[184:187], a[56:59], v[216:219]
    s_waitcnt vmcnt(35)
    v_mfma_f32_16x16x32_bf16 v[216:219], a[188:191], a[60:63], v[216:219]
    s_waitcnt vmcnt(34)
    v_mfma_f32_16x16x32_bf16 v[216:219], a[192:195], a[64:67], v[216:219]
    s_waitcnt vmcnt(33)
    v_mfma_f32_16x16x32_bf16 v[216:219], a[196:199], a[68:71], v[216:219]
    s_waitcnt vmcnt(32)
    v_mfma_f32_16x16x32_bf16 v[216:219], a[200:203], a[72:75], v[216:219]
    s_waitcnt vmcnt(31)
    v_mfma_f32_16x16x32_bf16 v[216:219], a[204:207], a[76:79], v[216:219]
    s_waitcnt vmcnt(30)
    v_mfma_f32_16x16x32_bf16 v[216:219], a[208:211], a[80:83], v[216:219]
    s_waitcnt vmcnt(29)
    v_mfma_f32_16x16x32_bf16 v[216:219], a[212:215], a[84:87], v[216:219]
    s_waitcnt vmcnt(28)
    v_mfma_f32_16x16x32_bf16 v[216:219], a[216:219], a[88:91], v[216:219]
    s_waitcnt vmcnt(27)
    v_mfma_f32_16x16x32_bf16 v[216:219], a[220:223], a[92:95], v[216:219]
    s_waitcnt vmcnt(26)
    v_mfma_f32_16x16x32_bf16 v[216:219], a[224:227], a[96:99], v[216:219]
    s_waitcnt vmcnt(25)
    v_mfma_f32_16x16x32_bf16 v[216:219], a[228:231], a[100:103], v[216:219]
    s_waitcnt vmcnt(24)
    v_mfma_f32_16x16x32_bf16 v[216:219], a[232:235], a[104:107], v[216:219]
    s_waitcnt vmcnt(23)
    v_mfma_f32_16x16x32_bf16 v[216:219], a[236:239], a[108:111], v[216:219]
    s_waitcnt vmcnt(22)
    v_mfma_f32_16x16x32_bf16 v[216:219], a[240:243], a[112:115], v[216:219]
    s_waitcnt vmcnt(21)
    v_mfma_f32_16x16x32_bf16 v[216:219], a[244:247], a[116:119], v[216:219]
    s_waitcnt vmcnt(20)
    v_mfma_f32_16x16x32_bf16 v[216:219], a[248:251], a[120:123], v[216:219]
    s_waitcnt vmcnt(19)
    v_mfma_f32_16x16x32_bf16 v[216:219], a[252:255], a[124:127], v[216:219]
    v_add_u32 v7, 2097152, v7
    v_subrev_u32 v8, 6144, v7
    buffer_load_dwordx4 v[108:111], v8, s[16:19], 0 offen
    v_subrev_u32 v8, 4096, v7
    buffer_load_dwordx4 v[112:115], v8, s[16:19], 0 offen
    v_subrev_u32 v8, 2048, v7
    buffer_load_dwordx4 v[116:119], v8, s[16:19], 0 offen
    s_mov_b32 s4, 0
    buffer_load_dwordx4 v[120:123], v7, s[16:19], s4 offen offset:0
    buffer_load_dwordx4 v[152:155], v7, s[28:31], s4 offen offset:0
    buffer_load_dwordx4 v[124:127], v7, s[16:19], s4 offen offset:2048
    buffer_load_dwordx4 v[156:159], v7, s[28:31], s4 offen offset:2048
    s_mov_b32 s4, 4096
    buffer_load_dwordx4 v[128:131], v7, s[16:19], s4 offen offset:0
    buffer_load_dwordx4 v[160:163], v7, s[28:31], s4 offen offset:0
    buffer_load_dwordx4 v[132:135], v7, s[16:19], s4 offen offset:2048
    buffer_load_dwordx4 v[164:167], v7, s[28:31], s4 offen offset:2048
    s_mov_b32 s4, 8192
    buffer_load_dwordx4 v[136:139], v7, s[16:19], s4 offen offset:0
    buffer_load_dwordx4 v[168:171], v7, s[28:31], s4 offen offset:0
    buffer_load_dwordx4 v[140:143], v7, s[16:19], s4 offen offset:2048
    buffer_load_dwordx4 v[172:175], v7, s[28:31], s4 offen offset:2048
    s_mov_b32 s4, 12288
    buffer_load_dwordx4 v[144:147], v7, s[16:19], s4 offen offset:0
    buffer_load_dwordx4 v[176:179], v7, s[28:31], s4 offen offset:0
    buffer_load_dwordx4 v[148:151], v7, s[16:19], s4 offen offset:2048
    buffer_load_dwordx4 v[180:183], v7, s[28:31], s4 offen offset:2048
    v_cvt_pk_bf16_f32 v216, v216, v216
    v_lshlrev_b32 v216, 16, v216
    v_mul_f32 v216, 0xbfb8aa3b, v216
    v_exp_f32 v216, v216
    s_lshl_b32 s4, s97, 7
    v_add_f32 v216, 1.0, v216
    v_rcp_f32 v216, v216
    s_lshl_b32 s5, s24, 5
    v_cvt_pk_bf16_f32 v216, v216, v216
    v_lshlrev_b32 v216, 16, v216
    s_add_u32 s4, s4, s5
    s_add_u32 s4, s4, 121634816
    v_lshlrev_b32 v15, 2, v1
    s_mov_b64 exec, 0xff
    buffer_store_dword v216, v15, s[8:11], s4 offen sc1
    s_mov_b64 exec, -1
    v_mov_b32 v220, 0
    v_mov_b32 v221, 0
    v_mov_b32 v222, 0
    v_mov_b32 v223, 0
    s_mul_i32 s4, s24, 7680
    v_add_u32 v15, s4, v2
    ds_write_b128 v15, v[220:223] offset:0
    ds_write_b128 v15, v[220:223] offset:1024
    ds_write_b128 v15, v[220:223] offset:1536
    v_add_u32 v15, 30720, v15
    ds_write_b128 v15, v[220:223] offset:0
    ds_write_b128 v15, v[220:223] offset:1024
    ds_write_b128 v15, v[220:223] offset:1536
    v_add_u32 v15, 30720, v15
    ds_write_b128 v15, v[220:223] offset:0
    ds_write_b128 v15, v[220:223] offset:1024
    ds_write_b128 v15, v[220:223] offset:1536
    v_add_u32 v15, 30720, v15
    ds_write_b128 v15, v[220:223] offset:0
    ds_write_b128 v15, v[220:223] offset:1024
    ds_write_b128 v15, v[220:223] offset:1536
    v_add_u32 v15, 30720, v15
    s_mov_b64 exec, 0xf
    ds_write_b128 v9, v[220:223]
    ds_write_b128 v9, v[220:223] offset:4160
    s_mov_b64 exec, -1
    s_mul_i32 s4, s24, 640
    s_add_u32 s4, s4, 2560
    v_bfe_u32 v254, v1, 0, 1
    v_mul_u32_u24 v12, 61440, v254
    v_bfe_u32 v254, v1, 3, 3
    v_mul_u32_u24 v254, 80, v254
    v_add_u32 v12, v12, v254
    v_bfe_u32 v254, v1, 1, 2
    v_mul_u32_u24 v254, 16, v254
    v_add_u32 v12, v12, v254
    v_add_u32 v12, s4, v12
    s_lshl_b32 s4, s97, 7
    v_bfe_u32 v254, v1, 0, 1
    v_mul_u32_u24 v13, 64, v254
    v_add_u32 v13, s4, v13
    buffer_load_dwordx4 v[216:219], v13, s[32:35], 0 offen offset:0
    buffer_load_dwordx4 v[220:223], v13, s[32:35], 0 offen offset:16
    buffer_load_dwordx4 v[224:227], v13, s[32:35], 0 offen offset:32
    buffer_load_dwordx4 v[228:231], v13, s[32:35], 0 offen offset:48
    v_lshlrev_b32 v239, 2, v1
    buffer_load_dword v238, v239, s[20:23], 0 offen sc1
    s_waitcnt vmcnt(0)
    s_cmp_lg_u32 s27, 0
    s_cbranch_scc1 .vd_197
    s_mov_b32 s62, 0
.vp_196:
    v_readlane_b32 s4, v238, 8
    s_cmp_ge_u32 s4, 256
    s_cbranch_scc1 .va_198
    s_add_u32 s62, s62, 1
    s_cmp_gt_u32 s62, 0x100000
    s_cbranch_scc1 .mg_end_1
    s_sleep 16
    buffer_load_dword v238, v239, s[20:23], 0 offen sc1
    s_waitcnt vmcnt(0)
    s_branch .vp_196
.va_198:
    v_cmp_ne_u32 vcc, 32, v238
    s_and_b32 s4, vcc_lo, 0xff
    s_cbranch_scc0 .vd_197
    s_lshr_b32 s25, s2, 5
    s_and_b32 s26, s2, 31
    s_mov_b32 s27, 1
    s_waitcnt vmcnt(0) lgkmcnt(0)
    s_barrier
    s_branch .mg_role_3
.vd_197:
    v_lshlrev_b32 v184, 16, v216
    v_lshlrev_b32 v185, 16, v218
    v_and_b32 v186, 0xffff0000, v216
    v_and_b32 v187, 0xffff0000, v218
    v_lshlrev_b32 v188, 16, v217
    v_lshlrev_b32 v189, 16, v219
    v_and_b32 v190, 0xffff0000, v217
    v_and_b32 v191, 0xffff0000, v219
    v_lshlrev_b32 v192, 16, v220
    v_lshlrev_b32 v193, 16, v222
    v_and_b32 v194, 0xffff0000, v220
    v_and_b32 v195, 0xffff0000, v222
    v_lshlrev_b32 v196, 16, v221
    v_lshlrev_b32 v197, 16, v223
    v_and_b32 v198, 0xffff0000, v221
    v_and_b32 v199, 0xffff0000, v223
    v_lshlrev_b32 v200, 16, v224
    v_lshlrev_b32 v201, 16, v226
    v_and_b32 v202, 0xffff0000, v224
    v_and_b32 v203, 0xffff0000, v226
    v_lshlrev_b32 v204, 16, v225
    v_lshlrev_b32 v205, 16, v227
    v_and_b32 v206, 0xffff0000, v225
    v_and_b32 v207, 0xffff0000, v227
    v_lshlrev_b32 v208, 16, v228
    v_lshlrev_b32 v209, 16, v230
    v_and_b32 v210, 0xffff0000, v228
    v_and_b32 v211, 0xffff0000, v230
    v_lshlrev_b32 v212, 16, v229
    v_lshlrev_b32 v213, 16, v231
    v_and_b32 v214, 0xffff0000, v229
    v_and_b32 v215, 0xffff0000, v231
    v_lshlrev_b32 v216, 16, v32
    v_and_b32 v217, 0xffff0000, v32
    v_lshlrev_b32 v218, 16, v36
    v_and_b32 v219, 0xffff0000, v36
    v_lshlrev_b32 v220, 16, v40
    v_and_b32 v221, 0xffff0000, v40
    v_lshlrev_b32 v222, 16, v44
    v_and_b32 v223, 0xffff0000, v44
    v_lshlrev_b32 v224, 16, v48
    v_and_b32 v225, 0xffff0000, v48
    v_lshlrev_b32 v226, 16, v52
    v_and_b32 v227, 0xffff0000, v52
    v_lshlrev_b32 v228, 16, v56
    v_and_b32 v229, 0xffff0000, v56
    v_lshlrev_b32 v230, 16, v60
    v_and_b32 v231, 0xffff0000, v60
    v_lshlrev_b32 v232, 16, v64
    v_and_b32 v233, 0xffff0000, v64
    v_lshlrev_b32 v234, 16, v68
    v_and_b32 v235, 0xffff0000, v68
    v_lshlrev_b32 v236, 16, v72
    v_and_b32 v237, 0xffff0000, v72
    v_pk_mul_f32 v[216:217], v[216:217], v[190:191]
    v_lshlrev_b32 v238, 16, v76
    v_pk_fma_f32 v[216:217], v[218:219], v[188:189], v[216:217]
    v_and_b32 v239, 0xffff0000, v76
    v_pk_fma_f32 v[216:217], v[220:221], v[186:187], v[216:217]
    v_pk_fma_f32 v[216:217], v[222:223], v[184:185], v[216:217]
    v_pk_mul_f32 v[216:217], v[216:217], v[238:239]
    v_pk_mul_f32 v[218:219], v[218:219], v[190:191]
    v_lshlrev_b32 v240, 16, v80
    v_pk_fma_f32 v[218:219], v[220:221], v[188:189], v[218:219]
    v_and_b32 v241, 0xffff0000, v80
    v_pk_fma_f32 v[218:219], v[222:223], v[186:187], v[218:219]
    v_pk_fma_f32 v[218:219], v[224:225], v[184:185], v[218:219]
    v_pk_mul_f32 v[218:219], v[218:219], v[240:241]
    v_pk_mul_f32 v[220:221], v[220:221], v[190:191]
    v_lshlrev_b32 v238, 16, v84
    v_pk_fma_f32 v[220:221], v[222:223], v[188:189], v[220:221]
    v_and_b32 v239, 0xffff0000, v84
    v_pk_fma_f32 v[220:221], v[224:225], v[186:187], v[220:221]
    v_pk_fma_f32 v[220:221], v[226:227], v[184:185], v[220:221]
    v_pk_mul_f32 v[220:221], v[220:221], v[238:239]
    v_pk_mul_f32 v[222:223], v[222:223], v[190:191]
    v_lshlrev_b32 v240, 16, v88
    v_pk_fma_f32 v[222:223], v[224:225], v[188:189], v[222:223]
    v_and_b32 v241, 0xffff0000, v88
    v_pk_fma_f32 v[222:223], v[226:227], v[186:187], v[222:223]
    v_pk_fma_f32 v[222:223], v[228:229], v[184:185], v[222:223]
    v_pk_mul_f32 v[222:223], v[222:223], v[240:241]
    v_pk_mul_f32 v[224:225], v[224:225], v[190:191]
    v_lshlrev_b32 v238, 16, v92
    v_pk_fma_f32 v[224:225], v[226:227], v[188:189], v[224:225]
    v_and_b32 v239, 0xffff0000, v92
    v_pk_fma_f32 v[224:225], v[228:229], v[186:187], v[224:225]
    v_pk_fma_f32 v[224:225], v[230:231], v[184:185], v[224:225]
    v_pk_mul_f32 v[224:225], v[224:225], v[238:239]
    v_pk_mul_f32 v[226:227], v[226:227], v[190:191]
    v_lshlrev_b32 v240, 16, v96
    v_pk_fma_f32 v[226:227], v[228:229], v[188:189], v[226:227]
    v_and_b32 v241, 0xffff0000, v96
    v_pk_fma_f32 v[226:227], v[230:231], v[186:187], v[226:227]
    v_pk_fma_f32 v[226:227], v[232:233], v[184:185], v[226:227]
    v_pk_mul_f32 v[226:227], v[226:227], v[240:241]
    v_pk_mul_f32 v[228:229], v[228:229], v[190:191]
    v_lshlrev_b32 v238, 16, v100
    v_pk_fma_f32 v[228:229], v[230:231], v[188:189], v[228:229]
    v_and_b32 v239, 0xffff0000, v100
    v_pk_fma_f32 v[228:229], v[232:233], v[186:187], v[228:229]
    v_pk_fma_f32 v[228:229], v[234:235], v[184:185], v[228:229]
    v_pk_mul_f32 v[228:229], v[228:229], v[238:239]
    v_pk_mul_f32 v[230:231], v[230:231], v[190:191]
    v_lshlrev_b32 v240, 16, v104
    v_pk_fma_f32 v[230:231], v[232:233], v[188:189], v[230:231]
    v_and_b32 v241, 0xffff0000, v104
    v_pk_fma_f32 v[230:231], v[234:235], v[186:187], v[230:231]
    v_pk_fma_f32 v[230:231], v[236:237], v[184:185], v[230:231]
    v_pk_mul_f32 v[230:231], v[230:231], v[240:241]
    v_cvt_pk_bf16_f32 v242, v230, v228
    v_cvt_pk_bf16_f32 v243, v226, v224
    v_cvt_pk_bf16_f32 v244, v222, v220
    v_cvt_pk_bf16_f32 v245, v218, v216
    ds_write_b128 v12, v[242:245] offset:0
    v_cvt_pk_bf16_f32 v246, v231, v229
    v_cvt_pk_bf16_f32 v247, v227, v225
    v_cvt_pk_bf16_f32 v248, v223, v221
    v_cvt_pk_bf16_f32 v249, v219, v217
    ds_write_b128 v12, v[246:249] offset:7680
    v_lshlrev_b32 v216, 16, v33
    v_and_b32 v217, 0xffff0000, v33
    v_lshlrev_b32 v218, 16, v37
    v_and_b32 v219, 0xffff0000, v37
    v_lshlrev_b32 v220, 16, v41
    v_and_b32 v221, 0xffff0000, v41
    v_lshlrev_b32 v222, 16, v45
    v_and_b32 v223, 0xffff0000, v45
    v_lshlrev_b32 v224, 16, v49
    v_and_b32 v225, 0xffff0000, v49
    v_lshlrev_b32 v226, 16, v53
    v_and_b32 v227, 0xffff0000, v53
    v_lshlrev_b32 v228, 16, v57
    v_and_b32 v229, 0xffff0000, v57
    v_lshlrev_b32 v230, 16, v61
    v_and_b32 v231, 0xffff0000, v61
    v_lshlrev_b32 v232, 16, v65
    v_and_b32 v233, 0xffff0000, v65
    v_lshlrev_b32 v234, 16, v69
    v_and_b32 v235, 0xffff0000, v69
    v_lshlrev_b32 v236, 16, v73
    v_and_b32 v237, 0xffff0000, v73
    v_pk_mul_f32 v[216:217], v[216:217], v[198:199]
    v_lshlrev_b32 v238, 16, v77
    v_pk_fma_f32 v[216:217], v[218:219], v[196:197], v[216:217]
    v_and_b32 v239, 0xffff0000, v77
    v_pk_fma_f32 v[216:217], v[220:221], v[194:195], v[216:217]
    v_pk_fma_f32 v[216:217], v[222:223], v[192:193], v[216:217]
    v_pk_mul_f32 v[216:217], v[216:217], v[238:239]
    v_pk_mul_f32 v[218:219], v[218:219], v[198:199]
    v_lshlrev_b32 v240, 16, v81
    v_pk_fma_f32 v[218:219], v[220:221], v[196:197], v[218:219]
    v_and_b32 v241, 0xffff0000, v81
    v_pk_fma_f32 v[218:219], v[222:223], v[194:195], v[218:219]
    v_pk_fma_f32 v[218:219], v[224:225], v[192:193], v[218:219]
    v_pk_mul_f32 v[218:219], v[218:219], v[240:241]
    v_pk_mul_f32 v[220:221], v[220:221], v[198:199]
    v_lshlrev_b32 v238, 16, v85
    v_pk_fma_f32 v[220:221], v[222:223], v[196:197], v[220:221]
    v_and_b32 v239, 0xffff0000, v85
    v_pk_fma_f32 v[220:221], v[224:225], v[194:195], v[220:221]
    v_pk_fma_f32 v[220:221], v[226:227], v[192:193], v[220:221]
    v_pk_mul_f32 v[220:221], v[220:221], v[238:239]
    v_pk_mul_f32 v[222:223], v[222:223], v[198:199]
    v_lshlrev_b32 v240, 16, v89
    v_pk_fma_f32 v[222:223], v[224:225], v[196:197], v[222:223]
    v_and_b32 v241, 0xffff0000, v89
    v_pk_fma_f32 v[222:223], v[226:227], v[194:195], v[222:223]
    v_pk_fma_f32 v[222:223], v[228:229], v[192:193], v[222:223]
    v_pk_mul_f32 v[222:223], v[222:223], v[240:241]
    v_pk_mul_f32 v[224:225], v[224:225], v[198:199]
    v_lshlrev_b32 v238, 16, v93
    v_pk_fma_f32 v[224:225], v[226:227], v[196:197], v[224:225]
    v_and_b32 v239, 0xffff0000, v93
    v_pk_fma_f32 v[224:225], v[228:229], v[194:195], v[224:225]
    v_pk_fma_f32 v[224:225], v[230:231], v[192:193], v[224:225]
    v_pk_mul_f32 v[224:225], v[224:225], v[238:239]
    v_pk_mul_f32 v[226:227], v[226:227], v[198:199]
    v_lshlrev_b32 v240, 16, v97
    v_pk_fma_f32 v[226:227], v[228:229], v[196:197], v[226:227]
    v_and_b32 v241, 0xffff0000, v97
    v_pk_fma_f32 v[226:227], v[230:231], v[194:195], v[226:227]
    v_pk_fma_f32 v[226:227], v[232:233], v[192:193], v[226:227]
    v_pk_mul_f32 v[226:227], v[226:227], v[240:241]
    v_pk_mul_f32 v[228:229], v[228:229], v[198:199]
    v_lshlrev_b32 v238, 16, v101
    v_pk_fma_f32 v[228:229], v[230:231], v[196:197], v[228:229]
    v_and_b32 v239, 0xffff0000, v101
    v_pk_fma_f32 v[228:229], v[232:233], v[194:195], v[228:229]
    v_pk_fma_f32 v[228:229], v[234:235], v[192:193], v[228:229]
    v_pk_mul_f32 v[228:229], v[228:229], v[238:239]
    v_pk_mul_f32 v[230:231], v[230:231], v[198:199]
    v_lshlrev_b32 v240, 16, v105
    v_pk_fma_f32 v[230:231], v[232:233], v[196:197], v[230:231]
    v_and_b32 v241, 0xffff0000, v105
    v_pk_fma_f32 v[230:231], v[234:235], v[194:195], v[230:231]
    v_pk_fma_f32 v[230:231], v[236:237], v[192:193], v[230:231]
    v_pk_mul_f32 v[230:231], v[230:231], v[240:241]
    v_cvt_pk_bf16_f32 v242, v230, v228
    v_cvt_pk_bf16_f32 v243, v226, v224
    v_cvt_pk_bf16_f32 v244, v222, v220
    v_cvt_pk_bf16_f32 v245, v218, v216
    ds_write_b128 v12, v[242:245] offset:15360
    v_cvt_pk_bf16_f32 v246, v231, v229
    v_cvt_pk_bf16_f32 v247, v227, v225
    v_cvt_pk_bf16_f32 v248, v223, v221
    v_cvt_pk_bf16_f32 v249, v219, v217
    ds_write_b128 v12, v[246:249] offset:23040
    v_lshlrev_b32 v216, 16, v34
    v_and_b32 v217, 0xffff0000, v34
    v_lshlrev_b32 v218, 16, v38
    v_and_b32 v219, 0xffff0000, v38
    v_lshlrev_b32 v220, 16, v42
    v_and_b32 v221, 0xffff0000, v42
    v_lshlrev_b32 v222, 16, v46
    v_and_b32 v223, 0xffff0000, v46
    v_lshlrev_b32 v224, 16, v50
    v_and_b32 v225, 0xffff0000, v50
    v_lshlrev_b32 v226, 16, v54
    v_and_b32 v227, 0xffff0000, v54
    v_lshlrev_b32 v228, 16, v58
    v_and_b32 v229, 0xffff0000, v58
    v_lshlrev_b32 v230, 16, v62
    v_and_b32 v231, 0xffff0000, v62
    v_lshlrev_b32 v232, 16, v66
    v_and_b32 v233, 0xffff0000, v66
    v_lshlrev_b32 v234, 16, v70
    v_and_b32 v235, 0xffff0000, v70
    v_lshlrev_b32 v236, 16, v74
    v_and_b32 v237, 0xffff0000, v74
    v_pk_mul_f32 v[216:217], v[216:217], v[206:207]
    v_lshlrev_b32 v238, 16, v78
    v_pk_fma_f32 v[216:217], v[218:219], v[204:205], v[216:217]
    v_and_b32 v239, 0xffff0000, v78
    v_pk_fma_f32 v[216:217], v[220:221], v[202:203], v[216:217]
    v_pk_fma_f32 v[216:217], v[222:223], v[200:201], v[216:217]
    v_pk_mul_f32 v[216:217], v[216:217], v[238:239]
    v_pk_mul_f32 v[218:219], v[218:219], v[206:207]
    v_lshlrev_b32 v240, 16, v82
    v_pk_fma_f32 v[218:219], v[220:221], v[204:205], v[218:219]
    v_and_b32 v241, 0xffff0000, v82
    v_pk_fma_f32 v[218:219], v[222:223], v[202:203], v[218:219]
    v_pk_fma_f32 v[218:219], v[224:225], v[200:201], v[218:219]
    v_pk_mul_f32 v[218:219], v[218:219], v[240:241]
    v_pk_mul_f32 v[220:221], v[220:221], v[206:207]
    v_lshlrev_b32 v238, 16, v86
    v_pk_fma_f32 v[220:221], v[222:223], v[204:205], v[220:221]
    v_and_b32 v239, 0xffff0000, v86
    v_pk_fma_f32 v[220:221], v[224:225], v[202:203], v[220:221]
    v_pk_fma_f32 v[220:221], v[226:227], v[200:201], v[220:221]
    v_pk_mul_f32 v[220:221], v[220:221], v[238:239]
    v_pk_mul_f32 v[222:223], v[222:223], v[206:207]
    v_lshlrev_b32 v240, 16, v90
    v_pk_fma_f32 v[222:223], v[224:225], v[204:205], v[222:223]
    v_and_b32 v241, 0xffff0000, v90
    v_pk_fma_f32 v[222:223], v[226:227], v[202:203], v[222:223]
    v_pk_fma_f32 v[222:223], v[228:229], v[200:201], v[222:223]
    v_pk_mul_f32 v[222:223], v[222:223], v[240:241]
    v_pk_mul_f32 v[224:225], v[224:225], v[206:207]
    v_lshlrev_b32 v238, 16, v94
    v_pk_fma_f32 v[224:225], v[226:227], v[204:205], v[224:225]
    v_and_b32 v239, 0xffff0000, v94
    v_pk_fma_f32 v[224:225], v[228:229], v[202:203], v[224:225]
    v_pk_fma_f32 v[224:225], v[230:231], v[200:201], v[224:225]
    v_pk_mul_f32 v[224:225], v[224:225], v[238:239]
    v_pk_mul_f32 v[226:227], v[226:227], v[206:207]
    v_lshlrev_b32 v240, 16, v98
    v_pk_fma_f32 v[226:227], v[228:229], v[204:205], v[226:227]
    v_and_b32 v241, 0xffff0000, v98
    v_pk_fma_f32 v[226:227], v[230:231], v[202:203], v[226:227]
    v_pk_fma_f32 v[226:227], v[232:233], v[200:201], v[226:227]
    v_pk_mul_f32 v[226:227], v[226:227], v[240:241]
    v_pk_mul_f32 v[228:229], v[228:229], v[206:207]
    v_lshlrev_b32 v238, 16, v102
    v_pk_fma_f32 v[228:229], v[230:231], v[204:205], v[228:229]
    v_and_b32 v239, 0xffff0000, v102
    v_pk_fma_f32 v[228:229], v[232:233], v[202:203], v[228:229]
    v_pk_fma_f32 v[228:229], v[234:235], v[200:201], v[228:229]
    v_pk_mul_f32 v[228:229], v[228:229], v[238:239]
    v_pk_mul_f32 v[230:231], v[230:231], v[206:207]
    v_lshlrev_b32 v240, 16, v106
    v_pk_fma_f32 v[230:231], v[232:233], v[204:205], v[230:231]
    v_and_b32 v241, 0xffff0000, v106
    v_pk_fma_f32 v[230:231], v[234:235], v[202:203], v[230:231]
    v_pk_fma_f32 v[230:231], v[236:237], v[200:201], v[230:231]
    v_pk_mul_f32 v[230:231], v[230:231], v[240:241]
    v_cvt_pk_bf16_f32 v242, v230, v228
    v_cvt_pk_bf16_f32 v243, v226, v224
    v_cvt_pk_bf16_f32 v244, v222, v220
    v_cvt_pk_bf16_f32 v245, v218, v216
    ds_write_b128 v12, v[242:245] offset:30720
    v_cvt_pk_bf16_f32 v246, v231, v229
    v_cvt_pk_bf16_f32 v247, v227, v225
    v_cvt_pk_bf16_f32 v248, v223, v221
    v_cvt_pk_bf16_f32 v249, v219, v217
    ds_write_b128 v12, v[246:249] offset:38400
    v_lshlrev_b32 v216, 16, v35
    v_and_b32 v217, 0xffff0000, v35
    v_lshlrev_b32 v218, 16, v39
    v_and_b32 v219, 0xffff0000, v39
    v_lshlrev_b32 v220, 16, v43
    v_and_b32 v221, 0xffff0000, v43
    v_lshlrev_b32 v222, 16, v47
    v_and_b32 v223, 0xffff0000, v47
    v_lshlrev_b32 v224, 16, v51
    v_and_b32 v225, 0xffff0000, v51
    v_lshlrev_b32 v226, 16, v55
    v_and_b32 v227, 0xffff0000, v55
    v_lshlrev_b32 v228, 16, v59
    v_and_b32 v229, 0xffff0000, v59
    v_lshlrev_b32 v230, 16, v63
    v_and_b32 v231, 0xffff0000, v63
    v_lshlrev_b32 v232, 16, v67
    v_and_b32 v233, 0xffff0000, v67
    v_lshlrev_b32 v234, 16, v71
    v_and_b32 v235, 0xffff0000, v71
    v_lshlrev_b32 v236, 16, v75
    v_and_b32 v237, 0xffff0000, v75
    v_pk_mul_f32 v[216:217], v[216:217], v[214:215]
    v_lshlrev_b32 v238, 16, v79
    v_pk_fma_f32 v[216:217], v[218:219], v[212:213], v[216:217]
    v_and_b32 v239, 0xffff0000, v79
    v_pk_fma_f32 v[216:217], v[220:221], v[210:211], v[216:217]
    v_pk_fma_f32 v[216:217], v[222:223], v[208:209], v[216:217]
    v_pk_mul_f32 v[216:217], v[216:217], v[238:239]
    v_pk_mul_f32 v[218:219], v[218:219], v[214:215]
    v_lshlrev_b32 v240, 16, v83
    v_pk_fma_f32 v[218:219], v[220:221], v[212:213], v[218:219]
    v_and_b32 v241, 0xffff0000, v83
    v_pk_fma_f32 v[218:219], v[222:223], v[210:211], v[218:219]
    v_pk_fma_f32 v[218:219], v[224:225], v[208:209], v[218:219]
    v_pk_mul_f32 v[218:219], v[218:219], v[240:241]
    v_pk_mul_f32 v[220:221], v[220:221], v[214:215]
    v_lshlrev_b32 v238, 16, v87
    v_pk_fma_f32 v[220:221], v[222:223], v[212:213], v[220:221]
    v_and_b32 v239, 0xffff0000, v87
    v_pk_fma_f32 v[220:221], v[224:225], v[210:211], v[220:221]
    v_pk_fma_f32 v[220:221], v[226:227], v[208:209], v[220:221]
    v_pk_mul_f32 v[220:221], v[220:221], v[238:239]
    v_pk_mul_f32 v[222:223], v[222:223], v[214:215]
    v_lshlrev_b32 v240, 16, v91
    v_pk_fma_f32 v[222:223], v[224:225], v[212:213], v[222:223]
    v_and_b32 v241, 0xffff0000, v91
    v_pk_fma_f32 v[222:223], v[226:227], v[210:211], v[222:223]
    v_pk_fma_f32 v[222:223], v[228:229], v[208:209], v[222:223]
    v_pk_mul_f32 v[222:223], v[222:223], v[240:241]
    v_pk_mul_f32 v[224:225], v[224:225], v[214:215]
    v_lshlrev_b32 v238, 16, v95
    v_pk_fma_f32 v[224:225], v[226:227], v[212:213], v[224:225]
    v_and_b32 v239, 0xffff0000, v95
    v_pk_fma_f32 v[224:225], v[228:229], v[210:211], v[224:225]
    v_pk_fma_f32 v[224:225], v[230:231], v[208:209], v[224:225]
    v_pk_mul_f32 v[224:225], v[224:225], v[238:239]
    v_pk_mul_f32 v[226:227], v[226:227], v[214:215]
    v_lshlrev_b32 v240, 16, v99
    v_pk_fma_f32 v[226:227], v[228:229], v[212:213], v[226:227]
    v_and_b32 v241, 0xffff0000, v99
    v_pk_fma_f32 v[226:227], v[230:231], v[210:211], v[226:227]
    v_pk_fma_f32 v[226:227], v[232:233], v[208:209], v[226:227]
    v_pk_mul_f32 v[226:227], v[226:227], v[240:241]
    v_pk_mul_f32 v[228:229], v[228:229], v[214:215]
    v_lshlrev_b32 v238, 16, v103
    v_pk_fma_f32 v[228:229], v[230:231], v[212:213], v[228:229]
    v_and_b32 v239, 0xffff0000, v103
    v_pk_fma_f32 v[228:229], v[232:233], v[210:211], v[228:229]
    v_pk_fma_f32 v[228:229], v[234:235], v[208:209], v[228:229]
    v_pk_mul_f32 v[228:229], v[228:229], v[238:239]
    v_pk_mul_f32 v[230:231], v[230:231], v[214:215]
    v_lshlrev_b32 v240, 16, v107
    v_pk_fma_f32 v[230:231], v[232:233], v[212:213], v[230:231]
    v_and_b32 v241, 0xffff0000, v107
    v_pk_fma_f32 v[230:231], v[234:235], v[210:211], v[230:231]
    v_pk_fma_f32 v[230:231], v[236:237], v[208:209], v[230:231]
    v_pk_mul_f32 v[230:231], v[230:231], v[240:241]
    v_cvt_pk_bf16_f32 v242, v230, v228
    v_cvt_pk_bf16_f32 v243, v226, v224
    v_cvt_pk_bf16_f32 v244, v222, v220
    v_cvt_pk_bf16_f32 v245, v218, v216
    ds_write_b128 v12, v[242:245] offset:46080
    v_cvt_pk_bf16_f32 v246, v231, v229
    v_cvt_pk_bf16_f32 v247, v227, v225
    v_cvt_pk_bf16_f32 v248, v223, v221
    v_cvt_pk_bf16_f32 v249, v219, v217
    ds_write_b128 v12, v[246:249] offset:53760
    v_lshlrev_b32 v216, 16, v108
    v_and_b32 v217, 0xffff0000, v108
    v_lshlrev_b32 v218, 16, v112
    v_and_b32 v219, 0xffff0000, v112
    v_lshlrev_b32 v220, 16, v116
    v_and_b32 v221, 0xffff0000, v116
    v_lshlrev_b32 v222, 16, v120
    v_and_b32 v223, 0xffff0000, v120
    v_lshlrev_b32 v224, 16, v124
    v_and_b32 v225, 0xffff0000, v124
    v_lshlrev_b32 v226, 16, v128
    v_and_b32 v227, 0xffff0000, v128
    v_lshlrev_b32 v228, 16, v132
    v_and_b32 v229, 0xffff0000, v132
    v_lshlrev_b32 v230, 16, v136
    v_and_b32 v231, 0xffff0000, v136
    v_lshlrev_b32 v232, 16, v140
    v_and_b32 v233, 0xffff0000, v140
    v_lshlrev_b32 v234, 16, v144
    v_and_b32 v235, 0xffff0000, v144
    v_lshlrev_b32 v236, 16, v148
    v_and_b32 v237, 0xffff0000, v148
    v_pk_mul_f32 v[216:217], v[216:217], v[190:191]
    v_lshlrev_b32 v238, 16, v152
    v_pk_fma_f32 v[216:217], v[218:219], v[188:189], v[216:217]
    v_and_b32 v239, 0xffff0000, v152
    v_pk_fma_f32 v[216:217], v[220:221], v[186:187], v[216:217]
    v_pk_fma_f32 v[216:217], v[222:223], v[184:185], v[216:217]
    v_pk_mul_f32 v[216:217], v[216:217], v[238:239]
    v_pk_mul_f32 v[218:219], v[218:219], v[190:191]
    v_lshlrev_b32 v240, 16, v156
    v_pk_fma_f32 v[218:219], v[220:221], v[188:189], v[218:219]
    v_and_b32 v241, 0xffff0000, v156
    v_pk_fma_f32 v[218:219], v[222:223], v[186:187], v[218:219]
    v_pk_fma_f32 v[218:219], v[224:225], v[184:185], v[218:219]
    v_pk_mul_f32 v[218:219], v[218:219], v[240:241]
    v_pk_mul_f32 v[220:221], v[220:221], v[190:191]
    v_lshlrev_b32 v238, 16, v160
    v_pk_fma_f32 v[220:221], v[222:223], v[188:189], v[220:221]
    v_and_b32 v239, 0xffff0000, v160
    v_pk_fma_f32 v[220:221], v[224:225], v[186:187], v[220:221]
    v_pk_fma_f32 v[220:221], v[226:227], v[184:185], v[220:221]
    v_pk_mul_f32 v[220:221], v[220:221], v[238:239]
    v_pk_mul_f32 v[222:223], v[222:223], v[190:191]
    v_lshlrev_b32 v240, 16, v164
    v_pk_fma_f32 v[222:223], v[224:225], v[188:189], v[222:223]
    v_and_b32 v241, 0xffff0000, v164
    v_pk_fma_f32 v[222:223], v[226:227], v[186:187], v[222:223]
    v_pk_fma_f32 v[222:223], v[228:229], v[184:185], v[222:223]
    v_pk_mul_f32 v[222:223], v[222:223], v[240:241]
    v_pk_mul_f32 v[224:225], v[224:225], v[190:191]
    v_lshlrev_b32 v238, 16, v168
    v_pk_fma_f32 v[224:225], v[226:227], v[188:189], v[224:225]
    v_and_b32 v239, 0xffff0000, v168
    v_pk_fma_f32 v[224:225], v[228:229], v[186:187], v[224:225]
    v_pk_fma_f32 v[224:225], v[230:231], v[184:185], v[224:225]
    v_pk_mul_f32 v[224:225], v[224:225], v[238:239]
    v_pk_mul_f32 v[226:227], v[226:227], v[190:191]
    v_lshlrev_b32 v240, 16, v172
    v_pk_fma_f32 v[226:227], v[228:229], v[188:189], v[226:227]
    v_and_b32 v241, 0xffff0000, v172
    v_pk_fma_f32 v[226:227], v[230:231], v[186:187], v[226:227]
    v_pk_fma_f32 v[226:227], v[232:233], v[184:185], v[226:227]
    v_pk_mul_f32 v[226:227], v[226:227], v[240:241]
    v_pk_mul_f32 v[228:229], v[228:229], v[190:191]
    v_lshlrev_b32 v238, 16, v176
    v_pk_fma_f32 v[228:229], v[230:231], v[188:189], v[228:229]
    v_and_b32 v239, 0xffff0000, v176
    v_pk_fma_f32 v[228:229], v[232:233], v[186:187], v[228:229]
    v_pk_fma_f32 v[228:229], v[234:235], v[184:185], v[228:229]
    v_pk_mul_f32 v[228:229], v[228:229], v[238:239]
    v_pk_mul_f32 v[230:231], v[230:231], v[190:191]
    v_lshlrev_b32 v240, 16, v180
    v_pk_fma_f32 v[230:231], v[232:233], v[188:189], v[230:231]
    v_and_b32 v241, 0xffff0000, v180
    v_pk_fma_f32 v[230:231], v[234:235], v[186:187], v[230:231]
    v_pk_fma_f32 v[230:231], v[236:237], v[184:185], v[230:231]
    v_pk_mul_f32 v[230:231], v[230:231], v[240:241]
    v_cvt_pk_bf16_f32 v242, v230, v228
    v_cvt_pk_bf16_f32 v243, v226, v224
    v_cvt_pk_bf16_f32 v244, v222, v220
    v_cvt_pk_bf16_f32 v245, v218, v216
    ds_write_b128 v12, v[242:245] offset:2560
    v_cvt_pk_bf16_f32 v246, v231, v229
    v_cvt_pk_bf16_f32 v247, v227, v225
    v_cvt_pk_bf16_f32 v248, v223, v221
    v_cvt_pk_bf16_f32 v249, v219, v217
    ds_write_b128 v12, v[246:249] offset:10240
    v_lshlrev_b32 v216, 16, v109
    v_and_b32 v217, 0xffff0000, v109
    v_lshlrev_b32 v218, 16, v113
    v_and_b32 v219, 0xffff0000, v113
    v_lshlrev_b32 v220, 16, v117
    v_and_b32 v221, 0xffff0000, v117
    v_lshlrev_b32 v222, 16, v121
    v_and_b32 v223, 0xffff0000, v121
    v_lshlrev_b32 v224, 16, v125
    v_and_b32 v225, 0xffff0000, v125
    v_lshlrev_b32 v226, 16, v129
    v_and_b32 v227, 0xffff0000, v129
    v_lshlrev_b32 v228, 16, v133
    v_and_b32 v229, 0xffff0000, v133
    v_lshlrev_b32 v230, 16, v137
    v_and_b32 v231, 0xffff0000, v137
    v_lshlrev_b32 v232, 16, v141
    v_and_b32 v233, 0xffff0000, v141
    v_lshlrev_b32 v234, 16, v145
    v_and_b32 v235, 0xffff0000, v145
    v_lshlrev_b32 v236, 16, v149
    v_and_b32 v237, 0xffff0000, v149
    v_pk_mul_f32 v[216:217], v[216:217], v[198:199]
    v_lshlrev_b32 v238, 16, v153
    v_pk_fma_f32 v[216:217], v[218:219], v[196:197], v[216:217]
    v_and_b32 v239, 0xffff0000, v153
    v_pk_fma_f32 v[216:217], v[220:221], v[194:195], v[216:217]
    v_pk_fma_f32 v[216:217], v[222:223], v[192:193], v[216:217]
    v_pk_mul_f32 v[216:217], v[216:217], v[238:239]
    v_pk_mul_f32 v[218:219], v[218:219], v[198:199]
    v_lshlrev_b32 v240, 16, v157
    v_pk_fma_f32 v[218:219], v[220:221], v[196:197], v[218:219]
    v_and_b32 v241, 0xffff0000, v157
    v_pk_fma_f32 v[218:219], v[222:223], v[194:195], v[218:219]
    v_pk_fma_f32 v[218:219], v[224:225], v[192:193], v[218:219]
    v_pk_mul_f32 v[218:219], v[218:219], v[240:241]
    v_pk_mul_f32 v[220:221], v[220:221], v[198:199]
    v_lshlrev_b32 v238, 16, v161
    v_pk_fma_f32 v[220:221], v[222:223], v[196:197], v[220:221]
    v_and_b32 v239, 0xffff0000, v161
    v_pk_fma_f32 v[220:221], v[224:225], v[194:195], v[220:221]
    v_pk_fma_f32 v[220:221], v[226:227], v[192:193], v[220:221]
    v_pk_mul_f32 v[220:221], v[220:221], v[238:239]
    v_pk_mul_f32 v[222:223], v[222:223], v[198:199]
    v_lshlrev_b32 v240, 16, v165
    v_pk_fma_f32 v[222:223], v[224:225], v[196:197], v[222:223]
    v_and_b32 v241, 0xffff0000, v165
    v_pk_fma_f32 v[222:223], v[226:227], v[194:195], v[222:223]
    v_pk_fma_f32 v[222:223], v[228:229], v[192:193], v[222:223]
    v_pk_mul_f32 v[222:223], v[222:223], v[240:241]
    v_pk_mul_f32 v[224:225], v[224:225], v[198:199]
    v_lshlrev_b32 v238, 16, v169
    v_pk_fma_f32 v[224:225], v[226:227], v[196:197], v[224:225]
    v_and_b32 v239, 0xffff0000, v169
    v_pk_fma_f32 v[224:225], v[228:229], v[194:195], v[224:225]
    v_pk_fma_f32 v[224:225], v[230:231], v[192:193], v[224:225]
    v_pk_mul_f32 v[224:225], v[224:225], v[238:239]
    v_pk_mul_f32 v[226:227], v[226:227], v[198:199]
    v_lshlrev_b32 v240, 16, v173
    v_pk_fma_f32 v[226:227], v[228:229], v[196:197], v[226:227]
    v_and_b32 v241, 0xffff0000, v173
    v_pk_fma_f32 v[226:227], v[230:231], v[194:195], v[226:227]
    v_pk_fma_f32 v[226:227], v[232:233], v[192:193], v[226:227]
    v_pk_mul_f32 v[226:227], v[226:227], v[240:241]
    v_pk_mul_f32 v[228:229], v[228:229], v[198:199]
    v_lshlrev_b32 v238, 16, v177
    v_pk_fma_f32 v[228:229], v[230:231], v[196:197], v[228:229]
    v_and_b32 v239, 0xffff0000, v177
    v_pk_fma_f32 v[228:229], v[232:233], v[194:195], v[228:229]
    v_pk_fma_f32 v[228:229], v[234:235], v[192:193], v[228:229]
    v_pk_mul_f32 v[228:229], v[228:229], v[238:239]
    v_pk_mul_f32 v[230:231], v[230:231], v[198:199]
    v_lshlrev_b32 v240, 16, v181
    v_pk_fma_f32 v[230:231], v[232:233], v[196:197], v[230:231]
    v_and_b32 v241, 0xffff0000, v181
    v_pk_fma_f32 v[230:231], v[234:235], v[194:195], v[230:231]
    v_pk_fma_f32 v[230:231], v[236:237], v[192:193], v[230:231]
    v_pk_mul_f32 v[230:231], v[230:231], v[240:241]
    v_cvt_pk_bf16_f32 v242, v230, v228
    v_cvt_pk_bf16_f32 v243, v226, v224
    v_cvt_pk_bf16_f32 v244, v222, v220
    v_cvt_pk_bf16_f32 v245, v218, v216
    ds_write_b128 v12, v[242:245] offset:17920
    v_cvt_pk_bf16_f32 v246, v231, v229
    v_cvt_pk_bf16_f32 v247, v227, v225
    v_cvt_pk_bf16_f32 v248, v223, v221
    v_cvt_pk_bf16_f32 v249, v219, v217
    ds_write_b128 v12, v[246:249] offset:25600
    v_lshlrev_b32 v216, 16, v110
    v_and_b32 v217, 0xffff0000, v110
    v_lshlrev_b32 v218, 16, v114
    v_and_b32 v219, 0xffff0000, v114
    v_lshlrev_b32 v220, 16, v118
    v_and_b32 v221, 0xffff0000, v118
    v_lshlrev_b32 v222, 16, v122
    v_and_b32 v223, 0xffff0000, v122
    v_lshlrev_b32 v224, 16, v126
    v_and_b32 v225, 0xffff0000, v126
    v_lshlrev_b32 v226, 16, v130
    v_and_b32 v227, 0xffff0000, v130
    v_lshlrev_b32 v228, 16, v134
    v_and_b32 v229, 0xffff0000, v134
    v_lshlrev_b32 v230, 16, v138
    v_and_b32 v231, 0xffff0000, v138
    v_lshlrev_b32 v232, 16, v142
    v_and_b32 v233, 0xffff0000, v142
    v_lshlrev_b32 v234, 16, v146
    v_and_b32 v235, 0xffff0000, v146
    v_lshlrev_b32 v236, 16, v150
    v_and_b32 v237, 0xffff0000, v150
    v_pk_mul_f32 v[216:217], v[216:217], v[206:207]
    v_lshlrev_b32 v238, 16, v154
    v_pk_fma_f32 v[216:217], v[218:219], v[204:205], v[216:217]
    v_and_b32 v239, 0xffff0000, v154
    v_pk_fma_f32 v[216:217], v[220:221], v[202:203], v[216:217]
    v_pk_fma_f32 v[216:217], v[222:223], v[200:201], v[216:217]
    v_pk_mul_f32 v[216:217], v[216:217], v[238:239]
    v_pk_mul_f32 v[218:219], v[218:219], v[206:207]
    v_lshlrev_b32 v240, 16, v158
    v_pk_fma_f32 v[218:219], v[220:221], v[204:205], v[218:219]
    v_and_b32 v241, 0xffff0000, v158
    v_pk_fma_f32 v[218:219], v[222:223], v[202:203], v[218:219]
    v_pk_fma_f32 v[218:219], v[224:225], v[200:201], v[218:219]
    v_pk_mul_f32 v[218:219], v[218:219], v[240:241]
    v_pk_mul_f32 v[220:221], v[220:221], v[206:207]
    v_lshlrev_b32 v238, 16, v162
    v_pk_fma_f32 v[220:221], v[222:223], v[204:205], v[220:221]
    v_and_b32 v239, 0xffff0000, v162
    v_pk_fma_f32 v[220:221], v[224:225], v[202:203], v[220:221]
    v_pk_fma_f32 v[220:221], v[226:227], v[200:201], v[220:221]
    v_pk_mul_f32 v[220:221], v[220:221], v[238:239]
    v_pk_mul_f32 v[222:223], v[222:223], v[206:207]
    v_lshlrev_b32 v240, 16, v166
    v_pk_fma_f32 v[222:223], v[224:225], v[204:205], v[222:223]
    v_and_b32 v241, 0xffff0000, v166
    v_pk_fma_f32 v[222:223], v[226:227], v[202:203], v[222:223]
    v_pk_fma_f32 v[222:223], v[228:229], v[200:201], v[222:223]
    v_pk_mul_f32 v[222:223], v[222:223], v[240:241]
    v_pk_mul_f32 v[224:225], v[224:225], v[206:207]
    v_lshlrev_b32 v238, 16, v170
    v_pk_fma_f32 v[224:225], v[226:227], v[204:205], v[224:225]
    v_and_b32 v239, 0xffff0000, v170
    v_pk_fma_f32 v[224:225], v[228:229], v[202:203], v[224:225]
    v_pk_fma_f32 v[224:225], v[230:231], v[200:201], v[224:225]
    v_pk_mul_f32 v[224:225], v[224:225], v[238:239]
    v_pk_mul_f32 v[226:227], v[226:227], v[206:207]
    v_lshlrev_b32 v240, 16, v174
    v_pk_fma_f32 v[226:227], v[228:229], v[204:205], v[226:227]
    v_and_b32 v241, 0xffff0000, v174
    v_pk_fma_f32 v[226:227], v[230:231], v[202:203], v[226:227]
    v_pk_fma_f32 v[226:227], v[232:233], v[200:201], v[226:227]
    v_pk_mul_f32 v[226:227], v[226:227], v[240:241]
    v_pk_mul_f32 v[228:229], v[228:229], v[206:207]
    v_lshlrev_b32 v238, 16, v178
    v_pk_fma_f32 v[228:229], v[230:231], v[204:205], v[228:229]
    v_and_b32 v239, 0xffff0000, v178
    v_pk_fma_f32 v[228:229], v[232:233], v[202:203], v[228:229]
    v_pk_fma_f32 v[228:229], v[234:235], v[200:201], v[228:229]
    v_pk_mul_f32 v[228:229], v[228:229], v[238:239]
    v_pk_mul_f32 v[230:231], v[230:231], v[206:207]
    v_lshlrev_b32 v240, 16, v182
    v_pk_fma_f32 v[230:231], v[232:233], v[204:205], v[230:231]
    v_and_b32 v241, 0xffff0000, v182
    v_pk_fma_f32 v[230:231], v[234:235], v[202:203], v[230:231]
    v_pk_fma_f32 v[230:231], v[236:237], v[200:201], v[230:231]
    v_pk_mul_f32 v[230:231], v[230:231], v[240:241]
    v_cvt_pk_bf16_f32 v242, v230, v228
    v_cvt_pk_bf16_f32 v243, v226, v224
    v_cvt_pk_bf16_f32 v244, v222, v220
    v_cvt_pk_bf16_f32 v245, v218, v216
    ds_write_b128 v12, v[242:245] offset:33280
    v_cvt_pk_bf16_f32 v246, v231, v229
    v_cvt_pk_bf16_f32 v247, v227, v225
    v_cvt_pk_bf16_f32 v248, v223, v221
    v_cvt_pk_bf16_f32 v249, v219, v217
    ds_write_b128 v12, v[246:249] offset:40960
    v_lshlrev_b32 v216, 16, v111
    v_and_b32 v217, 0xffff0000, v111
    v_lshlrev_b32 v218, 16, v115
    v_and_b32 v219, 0xffff0000, v115
    v_lshlrev_b32 v220, 16, v119
    v_and_b32 v221, 0xffff0000, v119
    v_lshlrev_b32 v222, 16, v123
    v_and_b32 v223, 0xffff0000, v123
    v_lshlrev_b32 v224, 16, v127
    v_and_b32 v225, 0xffff0000, v127
    v_lshlrev_b32 v226, 16, v131
    v_and_b32 v227, 0xffff0000, v131
    v_lshlrev_b32 v228, 16, v135
    v_and_b32 v229, 0xffff0000, v135
    v_lshlrev_b32 v230, 16, v139
    v_and_b32 v231, 0xffff0000, v139
    v_lshlrev_b32 v232, 16, v143
    v_and_b32 v233, 0xffff0000, v143
    v_lshlrev_b32 v234, 16, v147
    v_and_b32 v235, 0xffff0000, v147
    v_lshlrev_b32 v236, 16, v151
    v_and_b32 v237, 0xffff0000, v151
    v_pk_mul_f32 v[216:217], v[216:217], v[214:215]
    v_lshlrev_b32 v238, 16, v155
    v_pk_fma_f32 v[216:217], v[218:219], v[212:213], v[216:217]
    v_and_b32 v239, 0xffff0000, v155
    v_pk_fma_f32 v[216:217], v[220:221], v[210:211], v[216:217]
    v_pk_fma_f32 v[216:217], v[222:223], v[208:209], v[216:217]
    v_pk_mul_f32 v[216:217], v[216:217], v[238:239]
    v_pk_mul_f32 v[218:219], v[218:219], v[214:215]
    v_lshlrev_b32 v240, 16, v159
    v_pk_fma_f32 v[218:219], v[220:221], v[212:213], v[218:219]
    v_and_b32 v241, 0xffff0000, v159
    v_pk_fma_f32 v[218:219], v[222:223], v[210:211], v[218:219]
    v_pk_fma_f32 v[218:219], v[224:225], v[208:209], v[218:219]
    v_pk_mul_f32 v[218:219], v[218:219], v[240:241]
    v_pk_mul_f32 v[220:221], v[220:221], v[214:215]
    v_lshlrev_b32 v238, 16, v163
    v_pk_fma_f32 v[220:221], v[222:223], v[212:213], v[220:221]
    v_and_b32 v239, 0xffff0000, v163
    v_pk_fma_f32 v[220:221], v[224:225], v[210:211], v[220:221]
    v_pk_fma_f32 v[220:221], v[226:227], v[208:209], v[220:221]
    v_pk_mul_f32 v[220:221], v[220:221], v[238:239]
    v_pk_mul_f32 v[222:223], v[222:223], v[214:215]
    v_lshlrev_b32 v240, 16, v167
    v_pk_fma_f32 v[222:223], v[224:225], v[212:213], v[222:223]
    v_and_b32 v241, 0xffff0000, v167
    v_pk_fma_f32 v[222:223], v[226:227], v[210:211], v[222:223]
    v_pk_fma_f32 v[222:223], v[228:229], v[208:209], v[222:223]
    v_pk_mul_f32 v[222:223], v[222:223], v[240:241]
    v_pk_mul_f32 v[224:225], v[224:225], v[214:215]
    v_lshlrev_b32 v238, 16, v171
    v_pk_fma_f32 v[224:225], v[226:227], v[212:213], v[224:225]
    v_and_b32 v239, 0xffff0000, v171
    v_pk_fma_f32 v[224:225], v[228:229], v[210:211], v[224:225]
    v_pk_fma_f32 v[224:225], v[230:231], v[208:209], v[224:225]
    v_pk_mul_f32 v[224:225], v[224:225], v[238:239]
    v_pk_mul_f32 v[226:227], v[226:227], v[214:215]
    v_lshlrev_b32 v240, 16, v175
    v_pk_fma_f32 v[226:227], v[228:229], v[212:213], v[226:227]
    v_and_b32 v241, 0xffff0000, v175
    v_pk_fma_f32 v[226:227], v[230:231], v[210:211], v[226:227]
    v_pk_fma_f32 v[226:227], v[232:233], v[208:209], v[226:227]
    v_pk_mul_f32 v[226:227], v[226:227], v[240:241]
    v_pk_mul_f32 v[228:229], v[228:229], v[214:215]
    v_lshlrev_b32 v238, 16, v179
    v_pk_fma_f32 v[228:229], v[230:231], v[212:213], v[228:229]
    v_and_b32 v239, 0xffff0000, v179
    v_pk_fma_f32 v[228:229], v[232:233], v[210:211], v[228:229]
    v_pk_fma_f32 v[228:229], v[234:235], v[208:209], v[228:229]
    v_pk_mul_f32 v[228:229], v[228:229], v[238:239]
    v_pk_mul_f32 v[230:231], v[230:231], v[214:215]
    v_lshlrev_b32 v240, 16, v183
    v_pk_fma_f32 v[230:231], v[232:233], v[212:213], v[230:231]
    v_and_b32 v241, 0xffff0000, v183
    v_pk_fma_f32 v[230:231], v[234:235], v[210:211], v[230:231]
    v_pk_fma_f32 v[230:231], v[236:237], v[208:209], v[230:231]
    v_pk_mul_f32 v[230:231], v[230:231], v[240:241]
    v_cvt_pk_bf16_f32 v242, v230, v228
    v_cvt_pk_bf16_f32 v243, v226, v224
    v_cvt_pk_bf16_f32 v244, v222, v220
    v_cvt_pk_bf16_f32 v245, v218, v216
    ds_write_b128 v12, v[242:245] offset:48640
    v_cvt_pk_bf16_f32 v246, v231, v229
    v_cvt_pk_bf16_f32 v247, v227, v225
    v_cvt_pk_bf16_f32 v248, v223, v221
    v_cvt_pk_bf16_f32 v249, v219, v217
    ds_write_b128 v12, v[246:249] offset:56320
    s_lshl_b32 s4, s61, 12
    v_add_u32 v6, s4, v5
    buffer_load_dwordx4 v[184:187], v2, s[36:39], s4 offen offset:0
    buffer_load_dwordx4 v[188:191], v2, s[36:39], s4 offen offset:1024
    buffer_load_dwordx4 v[192:195], v2, s[36:39], s4 offen offset:2048
    buffer_load_dwordx4 v[196:199], v2, s[36:39], s4 offen offset:3072
    buffer_load_dword v200, v6, s[36:39], 0 offen
    buffer_load_dword v201, v2, s[36:39], s4 offen offset:1020
    buffer_load_dword v202, v2, s[36:39], s4 offen offset:2044
    buffer_load_dword v203, v2, s[36:39], s4 offen offset:3068
    s_waitcnt vmcnt(0)
    s_waitcnt lgkmcnt(0)
    s_barrier
    s_mov_b32 s64, 0
.chan_194:
    s_lshr_b32 s4, s61, 1
    s_lshl_b32 s4, s4, 2
    s_load_dword s65, s[50:51], s4
    s_lshl_b32 s7, s61, 12
    s_add_u32 s7, s7, 130023424
    v_writelane_b32 v200, 0, 0
    ds_write_b128 v9, v[184:187] offset:64
    v_alignbit_b32 v204, v184, v200, 16
    v_alignbit_b32 v205, v185, v184, 16
    v_alignbit_b32 v206, v186, v185, 16
    v_alignbit_b32 v207, v187, v186, 16
    ds_write_b128 v9, v[204:207] offset:4224
    ds_write_b128 v9, v[188:191] offset:1088
    v_alignbit_b32 v208, v188, v201, 16
    v_alignbit_b32 v209, v189, v188, 16
    v_alignbit_b32 v210, v190, v189, 16
    v_alignbit_b32 v211, v191, v190, 16
    ds_write_b128 v9, v[208:211] offset:5248
    ds_write_b128 v9, v[192:195] offset:2112
    v_alignbit_b32 v212, v192, v202, 16
    v_alignbit_b32 v213, v193, v192, 16
    v_alignbit_b32 v214, v194, v193, 16
    v_alignbit_b32 v215, v195, v194, 16
    ds_write_b128 v9, v[212:215] offset:6272
    ds_write_b128 v9, v[196:199] offset:3136
    v_alignbit_b32 v216, v196, v203, 16
    v_alignbit_b32 v217, v197, v196, 16
    v_alignbit_b32 v218, v198, v197, 16
    v_alignbit_b32 v219, v199, v198, 16
    ds_write_b128 v9, v[216:219] offset:7296
    s_and_b32 s4, s61, 1
    s_lshl_b32 s4, s4, 4
    s_waitcnt lgkmcnt(0)
    s_lshr_b32 s65, s65, s4
    s_pack_ll_b32_b16 s65, s65, s65
    s_add_u32 s61, s61, 4
    s_cmp_eq_u32 s64, 3
    s_cbranch_scc1 .chan_194_ns
    s_lshl_b32 s4, s61, 12
    v_add_u32 v6, s4, v5
    buffer_load_dwordx4 v[184:187], v2, s[36:39], s4 offen offset:0
    buffer_load_dwordx4 v[188:191], v2, s[36:39], s4 offen offset:1024
    buffer_load_dwordx4 v[192:195], v2, s[36:39], s4 offen offset:2048
    buffer_load_dwordx4 v[196:199], v2, s[36:39], s4 offen offset:3072
    buffer_load_dword v200, v6, s[36:39], 0 offen
    buffer_load_dword v201, v2, s[36:39], s4 offen offset:1020
    buffer_load_dword v202, v2, s[36:39], s4 offen offset:2044
    buffer_load_dword v203, v2, s[36:39], s4 offen offset:3068
.chan_194_ns:
    v_and_b32 v16, s65, v24
    v_and_b32 v17, s65, v25
    v_and_b32 v18, s65, v26
    v_and_b32 v19, s65, v27
    v_and_b32 v20, s65, v28
    v_and_b32 v21, s65, v29
    v_and_b32 v22, s65, v30
    v_and_b32 v23, s65, v31
    v_mov_b32 v14, v10
    ds_read2_b32 a[32:33], v14 offset0:0 offset1:1
    ds_read2_b32 a[34:35], v14 offset0:2 offset1:3
    ds_read_b128 a[56:59], v11 offset:7632
    ds_read_b128 a[60:63], v11 offset:5072
    ds_read2_b32 a[36:37], v14 offset0:8 offset1:9
    ds_read2_b32 a[38:39], v14 offset0:10 offset1:11
    ds_read_b128 a[64:67], v11 offset:7600
    ds_read_b128 a[68:71], v11 offset:5040
    ds_read2_b32 a[40:41], v14 offset0:16 offset1:17
    ds_read2_b32 a[42:43], v14 offset0:18 offset1:19
    ds_read_b128 a[72:75], v11 offset:7552
    ds_read_b128 a[76:79], v11 offset:4992
    s_waitcnt lgkmcnt(9)
    v_mfma_f32_32x32x16_bf16 a[16:31], a[32:35], a[56:59], 0
    v_mfma_f32_32x32x16_bf16 a[16:31], v[20:23], a[56:59], a[16:31]
    ds_read2_b32 a[44:45], v14 offset0:24 offset1:25
    ds_read2_b32 a[46:47], v14 offset0:26 offset1:27
    s_waitcnt lgkmcnt(10)
    v_mfma_f32_32x32x16_bf16 a[0:15], a[32:35], a[60:63], 0
    v_mfma_f32_32x32x16_bf16 a[0:15], v[20:23], a[60:63], a[0:15]
    ds_read_b128 a[80:83], v11 offset:7520
    ds_read_b128 a[84:87], v11 offset:4960
    s_waitcnt lgkmcnt(9)
    v_mfma_f32_32x32x16_bf16 a[16:31], a[36:39], a[64:67], a[16:31]
    v_mfma_f32_32x32x16_bf16 a[16:31], v[16:19], a[64:67], a[16:31]
    ds_read2_b32 a[48:49], v14 offset0:32 offset1:33
    ds_read2_b32 a[50:51], v14 offset0:34 offset1:35
    s_waitcnt lgkmcnt(10)
    v_mfma_f32_32x32x16_bf16 a[0:15], a[36:39], a[68:71], a[0:15]
    v_mfma_f32_32x32x16_bf16 a[0:15], v[16:19], a[68:71], a[0:15]
    ds_read_b128 a[56:59], v11 offset:7472
    ds_read_b128 a[60:63], v11 offset:4912
    s_waitcnt lgkmcnt(9)
    v_mfma_f32_32x32x16_bf16 a[16:31], a[40:43], a[72:75], a[16:31]
    ds_read2_b32 a[52:53], v14 offset0:40 offset1:41
    ds_read2_b32 a[54:55], v14 offset0:42 offset1:43
    s_waitcnt lgkmcnt(10)
    v_mfma_f32_32x32x16_bf16 a[0:15], a[40:43], a[76:79], a[0:15]
    ds_read_b128 a[64:67], v11 offset:7440
    ds_read_b128 a[68:71], v11 offset:4880
    s_waitcnt lgkmcnt(9)
    v_mfma_f32_32x32x16_bf16 a[16:31], a[44:47], a[80:83], a[16:31]
    ds_read2_b32 a[32:33], v14 offset0:48 offset1:49
    ds_read2_b32 a[34:35], v14 offset0:50 offset1:51
    s_waitcnt lgkmcnt(10)
    v_mfma_f32_32x32x16_bf16 a[0:15], a[44:47], a[84:87], a[0:15]
    ds_read_b128 a[72:75], v11 offset:7392
    ds_read_b128 a[76:79], v11 offset:4832
    s_waitcnt lgkmcnt(9)
    v_mfma_f32_32x32x16_bf16 a[16:31], a[48:51], a[56:59], a[16:31]
    ds_read2_b32 a[36:37], v14 offset0:56 offset1:57
    ds_read2_b32 a[38:39], v14 offset0:58 offset1:59
    s_waitcnt lgkmcnt(10)
    v_mfma_f32_32x32x16_bf16 a[0:15], a[48:51], a[60:63], a[0:15]
    ds_read_b128 a[80:83], v11 offset:7360
    ds_read_b128 a[84:87], v11 offset:4800
    s_waitcnt lgkmcnt(9)
    v_mfma_f32_32x32x16_bf16 a[16:31], a[52:55], a[64:67], a[16:31]
    ds_read2_b32 a[40:41], v14 offset0:64 offset1:65
    ds_read2_b32 a[42:43], v14 offset0:66 offset1:67
    s_waitcnt lgkmcnt(10)
    v_mfma_f32_32x32x16_bf16 a[0:15], a[52:55], a[68:71], a[0:15]
    ds_read_b128 a[56:59], v11 offset:7312
    ds_read_b128 a[60:63], v11 offset:4752
    s_waitcnt lgkmcnt(9)
    v_mfma_f32_32x32x16_bf16 a[16:31], a[32:35], a[72:75], a[16:31]
    ds_read2_b32 a[44:45], v14 offset0:72 offset1:73
    ds_read2_b32 a[46:47], v14 offset0:74 offset1:75
    s_waitcnt lgkmcnt(10)
    v_mfma_f32_32x32x16_bf16 a[0:15], a[32:35], a[76:79], a[0:15]
    ds_read_b128 a[64:67], v11 offset:7280
    ds_read_b128 a[68:71], v11 offset:4720
    s_waitcnt lgkmcnt(9)
    v_mfma_f32_32x32x16_bf16 a[16:31], a[36:39], a[80:83], a[16:31]
    ds_read2_b32 a[48:49], v14 offset0:80 offset1:81
    ds_read2_b32 a[50:51], v14 offset0:82 offset1:83
    s_waitcnt lgkmcnt(10)
    v_mfma_f32_32x32x16_bf16 a[0:15], a[36:39], a[84:87], a[0:15]
    ds_read_b128 a[72:75], v11 offset:7232
    ds_read_b128 a[76:79], v11 offset:4672
    s_waitcnt lgkmcnt(9)
    v_mfma_f32_32x32x16_bf16 a[16:31], a[40:43], a[56:59], a[16:31]
    ds_read2_b32 a[52:53], v14 offset0:88 offset1:89
    ds_read2_b32 a[54:55], v14 offset0:90 offset1:91
    s_waitcnt lgkmcnt(10)
    v_mfma_f32_32x32x16_bf16 a[0:15], a[40:43], a[60:63], a[0:15]
    ds_read_b128 a[80:83], v11 offset:7200
    ds_read_b128 a[84:87], v11 offset:4640
    s_waitcnt lgkmcnt(9)
    v_mfma_f32_32x32x16_bf16 a[16:31], a[44:47], a[64:67], a[16:31]
    ds_read2_b32 a[32:33], v14 offset0:96 offset1:97
    ds_read2_b32 a[34:35], v14 offset0:98 offset1:99
    s_waitcnt lgkmcnt(10)
    v_mfma_f32_32x32x16_bf16 a[0:15], a[44:47], a[68:71], a[0:15]
    ds_read_b128 a[56:59], v11 offset:7152
    ds_read_b128 a[60:63], v11 offset:4592
    s_waitcnt lgkmcnt(9)
    v_mfma_f32_32x32x16_bf16 a[16:31], a[48:51], a[72:75], a[16:31]
    ds_read2_b32 a[36:37], v14 offset0:104 offset1:105
    ds_read2_b32 a[38:39], v14 offset0:106 offset1:107
    s_waitcnt lgkmcnt(10)
    v_mfma_f32_32x32x16_bf16 a[0:15], a[48:51], a[76:79], a[0:15]
    ds_read_b128 a[64:67], v11 offset:7120
    ds_read_b128 a[68:71], v11 offset:4560
    s_waitcnt lgkmcnt(9)
    v_mfma_f32_32x32x16_bf16 a[16:31], a[52:55], a[80:83], a[16:31]
    ds_read2_b32 a[40:41], v14 offset0:112 offset1:113
    ds_read2_b32 a[42:43], v14 offset0:114 offset1:115
    s_waitcnt lgkmcnt(10)
    v_mfma_f32_32x32x16_bf16 a[0:15], a[52:55], a[84:87], a[0:15]
    ds_read_b128 a[72:75], v11 offset:7072
    ds_read_b128 a[76:79], v11 offset:4512
    s_waitcnt lgkmcnt(9)
    v_mfma_f32_32x32x16_bf16 a[16:31], a[32:35], a[56:59], a[16:31]
    ds_read2_b32 a[44:45], v14 offset0:120 offset1:121
    ds_read2_b32 a[46:47], v14 offset0:122 offset1:123
    s_waitcnt lgkmcnt(10)
    v_mfma_f32_32x32x16_bf16 a[0:15], a[32:35], a[60:63], a[0:15]
    ds_read_b128 a[80:83], v11 offset:7040
    ds_read_b128 a[84:87], v11 offset:4480
    s_waitcnt lgkmcnt(9)
    v_mfma_f32_32x32x16_bf16 a[16:31], a[36:39], a[64:67], a[16:31]
    ds_read2_b32 a[48:49], v14 offset0:128 offset1:129
    ds_read2_b32 a[50:51], v14 offset0:130 offset1:131
    s_waitcnt lgkmcnt(10)
    v_mfma_f32_32x32x16_bf16 a[0:15], a[36:39], a[68:71], a[0:15]
    ds_read_b128 a[56:59], v11 offset:6992
    ds_read_b128 a[60:63], v11 offset:4432
    s_waitcnt lgkmcnt(9)
    v_mfma_f32_32x32x16_bf16 a[16:31], a[40:43], a[72:75], a[16:31]
    ds_read2_b32 a[52:53], v14 offset0:136 offset1:137
    ds_read2_b32 a[54:55], v14 offset0:138 offset1:139
    s_waitcnt lgkmcnt(10)
    v_mfma_f32_32x32x16_bf16 a[0:15], a[40:43], a[76:79], a[0:15]
    ds_read_b128 a[64:67], v11 offset:6960
    ds_read_b128 a[68:71], v11 offset:4400
    s_waitcnt lgkmcnt(9)
    v_mfma_f32_32x32x16_bf16 a[16:31], a[44:47], a[80:83], a[16:31]
    ds_read2_b32 a[32:33], v14 offset0:144 offset1:145
    ds_read2_b32 a[34:35], v14 offset0:146 offset1:147
    s_waitcnt lgkmcnt(10)
    v_mfma_f32_32x32x16_bf16 a[0:15], a[44:47], a[84:87], a[0:15]
    ds_read_b128 a[72:75], v11 offset:6912
    ds_read_b128 a[76:79], v11 offset:4352
    s_waitcnt lgkmcnt(9)
    v_mfma_f32_32x32x16_bf16 a[16:31], a[48:51], a[56:59], a[16:31]
    ds_read2_b32 a[36:37], v14 offset0:152 offset1:153
    ds_read2_b32 a[38:39], v14 offset0:154 offset1:155
    s_waitcnt lgkmcnt(10)
    v_mfma_f32_32x32x16_bf16 a[0:15], a[48:51], a[60:63], a[0:15]
    ds_read_b128 a[80:83], v11 offset:6880
    ds_read_b128 a[84:87], v11 offset:4320
    s_waitcnt lgkmcnt(9)
    v_mfma_f32_32x32x16_bf16 a[16:31], a[52:55], a[64:67], a[16:31]
    ds_read2_b32 a[40:41], v14 offset0:160 offset1:161
    ds_read2_b32 a[42:43], v14 offset0:162 offset1:163
    s_waitcnt lgkmcnt(10)
    v_mfma_f32_32x32x16_bf16 a[0:15], a[52:55], a[68:71], a[0:15]
    ds_read_b128 a[56:59], v11 offset:6832
    ds_read_b128 a[60:63], v11 offset:4272
    s_waitcnt lgkmcnt(9)
    v_mfma_f32_32x32x16_bf16 a[16:31], a[32:35], a[72:75], a[16:31]
    ds_read2_b32 a[44:45], v14 offset0:168 offset1:169
    ds_read2_b32 a[46:47], v14 offset0:170 offset1:171
    s_waitcnt lgkmcnt(10)
    v_mfma_f32_32x32x16_bf16 a[0:15], a[32:35], a[76:79], a[0:15]
    ds_read_b128 a[64:67], v11 offset:6800
    ds_read_b128 a[68:71], v11 offset:4240
    s_waitcnt lgkmcnt(9)
    v_mfma_f32_32x32x16_bf16 a[16:31], a[36:39], a[80:83], a[16:31]
    ds_read2_b32 a[48:49], v14 offset0:176 offset1:177
    ds_read2_b32 a[50:51], v14 offset0:178 offset1:179
    s_waitcnt lgkmcnt(10)
    v_mfma_f32_32x32x16_bf16 a[0:15], a[36:39], a[84:87], a[0:15]
    ds_read_b128 a[72:75], v11 offset:6752
    ds_read_b128 a[76:79], v11 offset:4192
    s_waitcnt lgkmcnt(9)
    v_mfma_f32_32x32x16_bf16 a[16:31], a[40:43], a[56:59], a[16:31]
    ds_read2_b32 a[52:53], v14 offset0:184 offset1:185
    ds_read2_b32 a[54:55], v14 offset0:186 offset1:187
    s_waitcnt lgkmcnt(10)
    v_mfma_f32_32x32x16_bf16 a[0:15], a[40:43], a[60:63], a[0:15]
    ds_read_b128 a[80:83], v11 offset:6720
    ds_read_b128 a[84:87], v11 offset:4160
    s_waitcnt lgkmcnt(9)
    v_mfma_f32_32x32x16_bf16 a[16:31], a[44:47], a[64:67], a[16:31]
    ds_read2_b32 a[32:33], v14 offset0:192 offset1:193
    ds_read2_b32 a[34:35], v14 offset0:194 offset1:195
    s_waitcnt lgkmcnt(10)
    v_mfma_f32_32x32x16_bf16 a[0:15], a[44:47], a[68:71], a[0:15]
    ds_read_b128 a[56:59], v11 offset:6672
    ds_read_b128 a[60:63], v11 offset:4112
    s_waitcnt lgkmcnt(9)
    v_mfma_f32_32x32x16_bf16 a[16:31], a[48:51], a[72:75], a[16:31]
    ds_read2_b32 a[36:37], v14 offset0:200 offset1:201
    ds_read2_b32 a[38:39], v14 offset0:202 offset1:203
    s_waitcnt lgkmcnt(10)
    v_mfma_f32_32x32x16_bf16 a[0:15], a[48:51], a[76:79], a[0:15]
    ds_read_b128 a[64:67], v11 offset:6640
    ds_read_b128 a[68:71], v11 offset:4080
    s_waitcnt lgkmcnt(9)
    v_mfma_f32_32x32x16_bf16 a[16:31], a[52:55], a[80:83], a[16:31]
    ds_read2_b32 a[40:41], v14 offset0:208 offset1:209
    ds_read2_b32 a[42:43], v14 offset0:210 offset1:211
    s_waitcnt lgkmcnt(10)
    v_mfma_f32_32x32x16_bf16 a[0:15], a[52:55], a[84:87], a[0:15]
    ds_read_b128 a[72:75], v11 offset:6592
    ds_read_b128 a[76:79], v11 offset:4032
    s_waitcnt lgkmcnt(9)
    v_mfma_f32_32x32x16_bf16 a[16:31], a[32:35], a[56:59], a[16:31]
    ds_read2_b32 a[44:45], v14 offset0:216 offset1:217
    ds_read2_b32 a[46:47], v14 offset0:218 offset1:219
    s_waitcnt lgkmcnt(10)
    v_mfma_f32_32x32x16_bf16 a[0:15], a[32:35], a[60:63], a[0:15]
    ds_read_b128 a[80:83], v11 offset:6560
    ds_read_b128 a[84:87], v11 offset:4000
    s_waitcnt lgkmcnt(9)
    v_mfma_f32_32x32x16_bf16 a[16:31], a[36:39], a[64:67], a[16:31]
    ds_read2_b32 a[48:49], v14 offset0:224 offset1:225
    ds_read2_b32 a[50:51], v14 offset0:226 offset1:227
    s_waitcnt lgkmcnt(10)
    v_mfma_f32_32x32x16_bf16 a[0:15], a[36:39], a[68:71], a[0:15]
    ds_read_b128 a[56:59], v11 offset:6512
    ds_read_b128 a[60:63], v11 offset:3952
    s_waitcnt lgkmcnt(9)
    v_mfma_f32_32x32x16_bf16 a[16:31], a[40:43], a[72:75], a[16:31]
    ds_read2_b32 a[52:53], v14 offset0:232 offset1:233
    ds_read2_b32 a[54:55], v14 offset0:234 offset1:235
    s_waitcnt lgkmcnt(10)
    v_mfma_f32_32x32x16_bf16 a[0:15], a[40:43], a[76:79], a[0:15]
    ds_read_b128 a[64:67], v11 offset:6480
    ds_read_b128 a[68:71], v11 offset:3920
    s_waitcnt lgkmcnt(9)
    v_mfma_f32_32x32x16_bf16 a[16:31], a[44:47], a[80:83], a[16:31]
    ds_read2_b32 a[32:33], v14 offset0:240 offset1:241
    ds_read2_b32 a[34:35], v14 offset0:242 offset1:243
    s_waitcnt lgkmcnt(10)
    v_mfma_f32_32x32x16_bf16 a[0:15], a[44:47], a[84:87], a[0:15]
    ds_read_b128 a[72:75], v11 offset:6432
    ds_read_b128 a[76:79], v11 offset:3872
    s_waitcnt lgkmcnt(9)
    v_mfma_f32_32x32x16_bf16 a[16:31], a[48:51], a[56:59], a[16:31]
    ds_read2_b32 a[36:37], v14 offset0:248 offset1:249
    ds_read2_b32 a[38:39], v14 offset0:250 offset1:251
    v_add_u32 v14, 1024, v14
    s_waitcnt lgkmcnt(10)
    v_mfma_f32_32x32x16_bf16 a[0:15], a[48:51], a[60:63], a[0:15]
    ds_read_b128 a[80:83], v11 offset:6400
    ds_read_b128 a[84:87], v11 offset:3840
    s_waitcnt lgkmcnt(9)
    v_mfma_f32_32x32x16_bf16 a[16:31], a[52:55], a[64:67], a[16:31]
    ds_read2_b32 a[40:41], v14 offset0:0 offset1:1
    ds_read2_b32 a[42:43], v14 offset0:2 offset1:3
    s_waitcnt lgkmcnt(10)
    v_mfma_f32_32x32x16_bf16 a[0:15], a[52:55], a[68:71], a[0:15]
    ds_read_b128 a[56:59], v11 offset:6352
    ds_read_b128 a[60:63], v11 offset:3792
    s_waitcnt lgkmcnt(9)
    v_mfma_f32_32x32x16_bf16 a[16:31], a[32:35], a[72:75], a[16:31]
    ds_read2_b32 a[44:45], v14 offset0:8 offset1:9
    ds_read2_b32 a[46:47], v14 offset0:10 offset1:11
    s_waitcnt lgkmcnt(10)
    v_mfma_f32_32x32x16_bf16 a[0:15], a[32:35], a[76:79], a[0:15]
    ds_read_b128 a[64:67], v11 offset:6320
    ds_read_b128 a[68:71], v11 offset:3760
    s_waitcnt lgkmcnt(9)
    v_mfma_f32_32x32x16_bf16 a[16:31], a[36:39], a[80:83], a[16:31]
    ds_read2_b32 a[48:49], v14 offset0:16 offset1:17
    ds_read2_b32 a[50:51], v14 offset0:18 offset1:19
    s_waitcnt lgkmcnt(10)
    v_mfma_f32_32x32x16_bf16 a[0:15], a[36:39], a[84:87], a[0:15]
    ds_read_b128 a[72:75], v11 offset:6272
    ds_read_b128 a[76:79], v11 offset:3712
    s_waitcnt lgkmcnt(9)
    v_mfma_f32_32x32x16_bf16 a[16:31], a[40:43], a[56:59], a[16:31]
    ds_read2_b32 a[52:53], v14 offset0:24 offset1:25
    ds_read2_b32 a[54:55], v14 offset0:26 offset1:27
    s_waitcnt lgkmcnt(10)
    v_mfma_f32_32x32x16_bf16 a[0:15], a[40:43], a[60:63], a[0:15]
    ds_read_b128 a[80:83], v11 offset:6240
    ds_read_b128 a[84:87], v11 offset:3680
    s_waitcnt lgkmcnt(9)
    v_mfma_f32_32x32x16_bf16 a[16:31], a[44:47], a[64:67], a[16:31]
    ds_read2_b32 a[32:33], v14 offset0:32 offset1:33
    ds_read2_b32 a[34:35], v14 offset0:34 offset1:35
    s_waitcnt lgkmcnt(10)
    v_mfma_f32_32x32x16_bf16 a[0:15], a[44:47], a[68:71], a[0:15]
    ds_read_b128 a[56:59], v11 offset:6192
    ds_read_b128 a[60:63], v11 offset:3632
    s_waitcnt lgkmcnt(9)
    v_mfma_f32_32x32x16_bf16 a[16:31], a[48:51], a[72:75], a[16:31]
    ds_read2_b32 a[36:37], v14 offset0:40 offset1:41
    ds_read2_b32 a[38:39], v14 offset0:42 offset1:43
    s_waitcnt lgkmcnt(10)
    v_mfma_f32_32x32x16_bf16 a[0:15], a[48:51], a[76:79], a[0:15]
    ds_read_b128 a[64:67], v11 offset:6160
    ds_read_b128 a[68:71], v11 offset:3600
    s_waitcnt lgkmcnt(9)
    v_mfma_f32_32x32x16_bf16 a[16:31], a[52:55], a[80:83], a[16:31]
    ds_read2_b32 a[40:41], v14 offset0:48 offset1:49
    ds_read2_b32 a[42:43], v14 offset0:50 offset1:51
    s_waitcnt lgkmcnt(10)
    v_mfma_f32_32x32x16_bf16 a[0:15], a[52:55], a[84:87], a[0:15]
    ds_read_b128 a[72:75], v11 offset:6112
    ds_read_b128 a[76:79], v11 offset:3552
    s_waitcnt lgkmcnt(9)
    v_mfma_f32_32x32x16_bf16 a[16:31], a[32:35], a[56:59], a[16:31]
    ds_read2_b32 a[44:45], v14 offset0:56 offset1:57
    ds_read2_b32 a[46:47], v14 offset0:58 offset1:59
    s_waitcnt lgkmcnt(10)
    v_mfma_f32_32x32x16_bf16 a[0:15], a[32:35], a[60:63], a[0:15]
    ds_read_b128 a[80:83], v11 offset:6080
    ds_read_b128 a[84:87], v11 offset:3520
    s_waitcnt lgkmcnt(9)
    v_mfma_f32_32x32x16_bf16 a[16:31], a[36:39], a[64:67], a[16:31]
    ds_read2_b32 a[48:49], v14 offset0:64 offset1:65
    ds_read2_b32 a[50:51], v14 offset0:66 offset1:67
    s_waitcnt lgkmcnt(10)
    v_mfma_f32_32x32x16_bf16 a[0:15], a[36:39], a[68:71], a[0:15]
    ds_read_b128 a[56:59], v11 offset:6032
    ds_read_b128 a[60:63], v11 offset:3472
    s_waitcnt lgkmcnt(9)
    v_mfma_f32_32x32x16_bf16 a[16:31], a[40:43], a[72:75], a[16:31]
    ds_read2_b32 a[52:53], v14 offset0:72 offset1:73
    ds_read2_b32 a[54:55], v14 offset0:74 offset1:75
    s_waitcnt lgkmcnt(10)
    v_mfma_f32_32x32x16_bf16 a[0:15], a[40:43], a[76:79], a[0:15]
    ds_read_b128 a[64:67], v11 offset:6000
    ds_read_b128 a[68:71], v11 offset:3440
    s_waitcnt lgkmcnt(9)
    v_mfma_f32_32x32x16_bf16 a[16:31], a[44:47], a[80:83], a[16:31]
    ds_read2_b32 a[32:33], v14 offset0:80 offset1:81
    ds_read2_b32 a[34:35], v14 offset0:82 offset1:83
    s_waitcnt lgkmcnt(10)
    v_mfma_f32_32x32x16_bf16 a[0:15], a[44:47], a[84:87], a[0:15]
    ds_read_b128 a[72:75], v11 offset:5952
    ds_read_b128 a[76:79], v11 offset:3392
    s_waitcnt lgkmcnt(9)
    v_mfma_f32_32x32x16_bf16 a[16:31], a[48:51], a[56:59], a[16:31]
    ds_read2_b32 a[36:37], v14 offset0:88 offset1:89
    ds_read2_b32 a[38:39], v14 offset0:90 offset1:91
    s_waitcnt lgkmcnt(10)
    v_mfma_f32_32x32x16_bf16 a[0:15], a[48:51], a[60:63], a[0:15]
    ds_read_b128 a[80:83], v11 offset:5920
    ds_read_b128 a[84:87], v11 offset:3360
    s_waitcnt lgkmcnt(9)
    v_mfma_f32_32x32x16_bf16 a[16:31], a[52:55], a[64:67], a[16:31]
    ds_read2_b32 a[40:41], v14 offset0:96 offset1:97
    ds_read2_b32 a[42:43], v14 offset0:98 offset1:99
    s_waitcnt lgkmcnt(10)
    v_mfma_f32_32x32x16_bf16 a[0:15], a[52:55], a[68:71], a[0:15]
    ds_read_b128 a[56:59], v11 offset:5872
    ds_read_b128 a[60:63], v11 offset:3312
    s_waitcnt lgkmcnt(9)
    v_mfma_f32_32x32x16_bf16 a[16:31], a[32:35], a[72:75], a[16:31]
    ds_read2_b32 a[44:45], v14 offset0:104 offset1:105
    ds_read2_b32 a[46:47], v14 offset0:106 offset1:107
    s_waitcnt lgkmcnt(10)
    v_mfma_f32_32x32x16_bf16 a[0:15], a[32:35], a[76:79], a[0:15]
    ds_read_b128 a[64:67], v11 offset:5840
    ds_read_b128 a[68:71], v11 offset:3280
    s_waitcnt lgkmcnt(9)
    v_mfma_f32_32x32x16_bf16 a[16:31], a[36:39], a[80:83], a[16:31]
    ds_read2_b32 a[48:49], v14 offset0:112 offset1:113
    ds_read2_b32 a[50:51], v14 offset0:114 offset1:115
    s_waitcnt lgkmcnt(10)
    v_mfma_f32_32x32x16_bf16 a[0:15], a[36:39], a[84:87], a[0:15]
    ds_read_b128 a[72:75], v11 offset:5792
    ds_read_b128 a[76:79], v11 offset:3232
    s_waitcnt lgkmcnt(9)
    v_mfma_f32_32x32x16_bf16 a[16:31], a[40:43], a[56:59], a[16:31]
    ds_read2_b32 a[52:53], v14 offset0:120 offset1:121
    ds_read2_b32 a[54:55], v14 offset0:122 offset1:123
    s_waitcnt lgkmcnt(10)
    v_mfma_f32_32x32x16_bf16 a[0:15], a[40:43], a[60:63], a[0:15]
    ds_read_b128 a[80:83], v11 offset:5760
    ds_read_b128 a[84:87], v11 offset:3200
    s_waitcnt lgkmcnt(9)
    v_mfma_f32_32x32x16_bf16 a[16:31], a[44:47], a[64:67], a[16:31]
    ds_read2_b32 a[32:33], v14 offset0:128 offset1:129
    ds_read2_b32 a[34:35], v14 offset0:130 offset1:131
    s_waitcnt lgkmcnt(10)
    v_mfma_f32_32x32x16_bf16 a[0:15], a[44:47], a[68:71], a[0:15]
    ds_read_b128 a[56:59], v11 offset:5712
    ds_read_b128 a[60:63], v11 offset:3152
    s_waitcnt lgkmcnt(9)
    v_mfma_f32_32x32x16_bf16 a[16:31], a[48:51], a[72:75], a[16:31]
    ds_read2_b32 a[36:37], v14 offset0:136 offset1:137
    ds_read2_b32 a[38:39], v14 offset0:138 offset1:139
    s_waitcnt lgkmcnt(10)
    v_mfma_f32_32x32x16_bf16 a[0:15], a[48:51], a[76:79], a[0:15]
    ds_read_b128 a[64:67], v11 offset:5680
    ds_read_b128 a[68:71], v11 offset:3120
    s_waitcnt lgkmcnt(9)
    v_mfma_f32_32x32x16_bf16 a[16:31], a[52:55], a[80:83], a[16:31]
    ds_read2_b32 a[40:41], v14 offset0:144 offset1:145
    ds_read2_b32 a[42:43], v14 offset0:146 offset1:147
    s_waitcnt lgkmcnt(10)
    v_mfma_f32_32x32x16_bf16 a[0:15], a[52:55], a[84:87], a[0:15]
    ds_read_b128 a[72:75], v11 offset:5632
    ds_read_b128 a[76:79], v11 offset:3072
    s_waitcnt lgkmcnt(9)
    v_mfma_f32_32x32x16_bf16 a[16:31], a[32:35], a[56:59], a[16:31]
    ds_read2_b32 a[44:45], v14 offset0:152 offset1:153
    ds_read2_b32 a[46:47], v14 offset0:154 offset1:155
    s_waitcnt lgkmcnt(10)
    v_mfma_f32_32x32x16_bf16 a[0:15], a[32:35], a[60:63], a[0:15]
    ds_read_b128 a[80:83], v11 offset:5600
    ds_read_b128 a[84:87], v11 offset:3040
    s_waitcnt lgkmcnt(9)
    v_mfma_f32_32x32x16_bf16 a[16:31], a[36:39], a[64:67], a[16:31]
    ds_read2_b32 a[48:49], v14 offset0:160 offset1:161
    ds_read2_b32 a[50:51], v14 offset0:162 offset1:163
    s_waitcnt lgkmcnt(10)
    v_mfma_f32_32x32x16_bf16 a[0:15], a[36:39], a[68:71], a[0:15]
    ds_read_b128 a[56:59], v11 offset:5552
    ds_read_b128 a[60:63], v11 offset:2992
    s_waitcnt lgkmcnt(9)
    v_mfma_f32_32x32x16_bf16 a[16:31], a[40:43], a[72:75], a[16:31]
    ds_read2_b32 a[52:53], v14 offset0:168 offset1:169
    ds_read2_b32 a[54:55], v14 offset0:170 offset1:171
    s_waitcnt lgkmcnt(10)
    v_mfma_f32_32x32x16_bf16 a[0:15], a[40:43], a[76:79], a[0:15]
    ds_read_b128 a[64:67], v11 offset:5520
    ds_read_b128 a[68:71], v11 offset:2960
    s_waitcnt lgkmcnt(9)
    v_mfma_f32_32x32x16_bf16 a[16:31], a[44:47], a[80:83], a[16:31]
    ds_read2_b32 a[32:33], v14 offset0:176 offset1:177
    ds_read2_b32 a[34:35], v14 offset0:178 offset1:179
    s_waitcnt lgkmcnt(10)
    v_mfma_f32_32x32x16_bf16 a[0:15], a[44:47], a[84:87], a[0:15]
    ds_read_b128 a[72:75], v11 offset:5472
    ds_read_b128 a[76:79], v11 offset:2912
    s_waitcnt lgkmcnt(9)
    v_mfma_f32_32x32x16_bf16 a[16:31], a[48:51], a[56:59], a[16:31]
    ds_read2_b32 a[36:37], v14 offset0:184 offset1:185
    ds_read2_b32 a[38:39], v14 offset0:186 offset1:187
    s_waitcnt lgkmcnt(10)
    v_mfma_f32_32x32x16_bf16 a[0:15], a[48:51], a[60:63], a[0:15]
    ds_read_b128 a[80:83], v11 offset:5440
    ds_read_b128 a[84:87], v11 offset:2880
    s_waitcnt lgkmcnt(9)
    v_mfma_f32_32x32x16_bf16 a[16:31], a[52:55], a[64:67], a[16:31]
    ds_read2_b32 a[40:41], v14 offset0:192 offset1:193
    ds_read2_b32 a[42:43], v14 offset0:194 offset1:195
    s_waitcnt lgkmcnt(10)
    v_mfma_f32_32x32x16_bf16 a[0:15], a[52:55], a[68:71], a[0:15]
    ds_read_b128 a[56:59], v11 offset:5392
    ds_read_b128 a[60:63], v11 offset:2832
    s_waitcnt lgkmcnt(9)
    v_mfma_f32_32x32x16_bf16 a[16:31], a[32:35], a[72:75], a[16:31]
    ds_read2_b32 a[44:45], v14 offset0:200 offset1:201
    ds_read2_b32 a[46:47], v14 offset0:202 offset1:203
    s_waitcnt lgkmcnt(10)
    v_mfma_f32_32x32x16_bf16 a[0:15], a[32:35], a[76:79], a[0:15]
    ds_read_b128 a[64:67], v11 offset:5360
    ds_read_b128 a[68:71], v11 offset:2800
    s_waitcnt lgkmcnt(9)
    v_mfma_f32_32x32x16_bf16 a[16:31], a[36:39], a[80:83], a[16:31]
    ds_read2_b32 a[48:49], v14 offset0:208 offset1:209
    ds_read2_b32 a[50:51], v14 offset0:210 offset1:211
    s_waitcnt lgkmcnt(10)
    v_mfma_f32_32x32x16_bf16 a[0:15], a[36:39], a[84:87], a[0:15]
    ds_read_b128 a[72:75], v11 offset:5312
    ds_read_b128 a[76:79], v11 offset:2752
    s_waitcnt lgkmcnt(9)
    v_mfma_f32_32x32x16_bf16 a[16:31], a[40:43], a[56:59], a[16:31]
    ds_read2_b32 a[52:53], v14 offset0:216 offset1:217
    ds_read2_b32 a[54:55], v14 offset0:218 offset1:219
    s_waitcnt lgkmcnt(10)
    v_mfma_f32_32x32x16_bf16 a[0:15], a[40:43], a[60:63], a[0:15]
    ds_read_b128 a[80:83], v11 offset:5280
    ds_read_b128 a[84:87], v11 offset:2720
    s_waitcnt lgkmcnt(9)
    v_mfma_f32_32x32x16_bf16 a[16:31], a[44:47], a[64:67], a[16:31]
    ds_read2_b32 a[32:33], v14 offset0:224 offset1:225
    ds_read2_b32 a[34:35], v14 offset0:226 offset1:227
    s_waitcnt lgkmcnt(10)
    v_mfma_f32_32x32x16_bf16 a[0:15], a[44:47], a[68:71], a[0:15]
    ds_read_b128 a[56:59], v11 offset:5232
    ds_read_b128 a[60:63], v11 offset:2672
    s_waitcnt lgkmcnt(9)
    v_mfma_f32_32x32x16_bf16 a[16:31], a[48:51], a[72:75], a[16:31]
    ds_read2_b32 a[36:37], v14 offset0:232 offset1:233
    ds_read2_b32 a[38:39], v14 offset0:234 offset1:235
    s_waitcnt lgkmcnt(10)
    v_mfma_f32_32x32x16_bf16 a[0:15], a[48:51], a[76:79], a[0:15]
    ds_read_b128 a[64:67], v11 offset:5200
    ds_read_b128 a[68:71], v11 offset:2640
    s_waitcnt lgkmcnt(9)
    v_mfma_f32_32x32x16_bf16 a[16:31], a[52:55], a[80:83], a[16:31]
    ds_read2_b32 a[40:41], v14 offset0:240 offset1:241
    ds_read2_b32 a[42:43], v14 offset0:242 offset1:243
    s_waitcnt lgkmcnt(10)
    v_mfma_f32_32x32x16_bf16 a[0:15], a[52:55], a[84:87], a[0:15]
    ds_read_b128 a[72:75], v11 offset:5152
    ds_read_b128 a[76:79], v11 offset:2592
    s_waitcnt lgkmcnt(9)
    v_mfma_f32_32x32x16_bf16 a[16:31], a[32:35], a[56:59], a[16:31]
    ds_read2_b32 a[44:45], v14 offset0:248 offset1:249
    ds_read2_b32 a[46:47], v14 offset0:250 offset1:251
    v_add_u32 v14, 1024, v14
    s_waitcnt lgkmcnt(10)
    v_mfma_f32_32x32x16_bf16 a[0:15], a[32:35], a[60:63], a[0:15]
    ds_read_b128 a[80:83], v11 offset:5120
    ds_read_b128 a[84:87], v11 offset:2560
    s_waitcnt lgkmcnt(9)
    v_mfma_f32_32x32x16_bf16 a[16:31], a[36:39], a[64:67], a[16:31]
    ds_read2_b32 a[48:49], v14 offset0:0 offset1:1
    ds_read2_b32 a[50:51], v14 offset0:2 offset1:3
    s_waitcnt lgkmcnt(10)
    v_mfma_f32_32x32x16_bf16 a[0:15], a[36:39], a[68:71], a[0:15]
    ds_read_b128 a[56:59], v11 offset:5072
    ds_read2_b32 a[52:53], v14 offset0:8 offset1:9
    ds_read2_b32 a[54:55], v14 offset0:10 offset1:11
    s_waitcnt lgkmcnt(10)
    v_mfma_f32_32x32x16_bf16 a[16:31], a[40:43], a[72:75], a[16:31]
    ds_read_b128 a[60:63], v11 offset:5040
    s_waitcnt lgkmcnt(10)
    v_mfma_f32_32x32x16_bf16 a[0:15], a[40:43], a[76:79], a[0:15]
    ds_read2_b32 a[32:33], v14 offset0:16 offset1:17
    ds_read2_b32 a[34:35], v14 offset0:18 offset1:19
    ds_read_b128 a[64:67], v11 offset:4992
    s_waitcnt lgkmcnt(10)
    v_mfma_f32_32x32x16_bf16 a[16:31], a[44:47], a[80:83], a[16:31]
    ds_read2_b32 a[36:37], v14 offset0:24 offset1:25
    ds_read2_b32 a[38:39], v14 offset0:26 offset1:27
    s_waitcnt lgkmcnt(11)
    v_mfma_f32_32x32x16_bf16 a[0:15], a[44:47], a[84:87], a[0:15]
    ds_read_b128 a[68:71], v11 offset:4960
    ds_read2_b32 a[40:41], v14 offset0:32 offset1:33
    ds_read2_b32 a[42:43], v14 offset0:34 offset1:35
    s_waitcnt lgkmcnt(11)
    v_mfma_f32_32x32x16_bf16 a[16:31], a[48:51], a[56:59], a[16:31]
    ds_read_b128 a[72:75], v11 offset:4912
    ds_read2_b32 a[44:45], v14 offset0:40 offset1:41
    ds_read2_b32 a[46:47], v14 offset0:42 offset1:43
    s_waitcnt lgkmcnt(11)
    v_mfma_f32_32x32x16_bf16 a[16:31], a[52:55], a[60:63], a[16:31]
    ds_read_b128 a[76:79], v11 offset:4880
    ds_read2_b32 a[48:49], v14 offset0:48 offset1:49
    ds_read2_b32 a[50:51], v14 offset0:50 offset1:51
    s_waitcnt lgkmcnt(11)
    v_mfma_f32_32x32x16_bf16 a[16:31], a[32:35], a[64:67], a[16:31]
    ds_read_b128 a[80:83], v11 offset:4832
    ds_read2_b32 a[52:53], v14 offset0:56 offset1:57
    ds_read2_b32 a[54:55], v14 offset0:58 offset1:59
    s_waitcnt lgkmcnt(11)
    v_mfma_f32_32x32x16_bf16 a[16:31], a[36:39], a[68:71], a[16:31]
    ds_read_b128 a[84:87], v11 offset:4800
    ds_read2_b32 a[32:33], v14 offset0:64 offset1:65
    ds_read2_b32 a[34:35], v14 offset0:66 offset1:67
    s_waitcnt lgkmcnt(11)
    v_mfma_f32_32x32x16_bf16 a[16:31], a[40:43], a[72:75], a[16:31]
    ds_read_b128 a[56:59], v11 offset:4752
    ds_read2_b32 a[36:37], v14 offset0:72 offset1:73
    ds_read2_b32 a[38:39], v14 offset0:74 offset1:75
    s_waitcnt lgkmcnt(11)
    v_mfma_f32_32x32x16_bf16 a[16:31], a[44:47], a[76:79], a[16:31]
    ds_read_b128 a[60:63], v11 offset:4720
    ds_read2_b32 a[40:41], v14 offset0:80 offset1:81
    ds_read2_b32 a[42:43], v14 offset0:82 offset1:83
    s_waitcnt lgkmcnt(11)
    v_mfma_f32_32x32x16_bf16 a[16:31], a[48:51], a[80:83], a[16:31]
    ds_read_b128 a[64:67], v11 offset:4672
    ds_read2_b32 a[44:45], v14 offset0:88 offset1:89
    ds_read2_b32 a[46:47], v14 offset0:90 offset1:91
    s_waitcnt lgkmcnt(11)
    v_mfma_f32_32x32x16_bf16 a[16:31], a[52:55], a[84:87], a[16:31]
    ds_read_b128 a[68:71], v11 offset:4640
    ds_read2_b32 a[48:49], v14 offset0:96 offset1:97
    ds_read2_b32 a[50:51], v14 offset0:98 offset1:99
    s_waitcnt lgkmcnt(11)
    v_mfma_f32_32x32x16_bf16 a[16:31], a[32:35], a[56:59], a[16:31]
    ds_read_b128 a[72:75], v11 offset:4592
    ds_read2_b32 a[52:53], v14 offset0:104 offset1:105
    ds_read2_b32 a[54:55], v14 offset0:106 offset1:107
    s_waitcnt lgkmcnt(11)
    v_mfma_f32_32x32x16_bf16 a[16:31], a[36:39], a[60:63], a[16:31]
    ds_read_b128 a[76:79], v11 offset:4560
    ds_read2_b32 a[32:33], v14 offset0:112 offset1:113
    ds_read2_b32 a[34:35], v14 offset0:114 offset1:115
    s_waitcnt lgkmcnt(11)
    v_mfma_f32_32x32x16_bf16 a[16:31], a[40:43], a[64:67], a[16:31]
    ds_read_b128 a[80:83], v11 offset:4512
    ds_read2_b32 a[36:37], v14 offset0:120 offset1:121
    ds_read2_b32 a[38:39], v14 offset0:122 offset1:123
    s_waitcnt lgkmcnt(11)
    v_mfma_f32_32x32x16_bf16 a[16:31], a[44:47], a[68:71], a[16:31]
    ds_read_b128 a[84:87], v11 offset:4480
    ds_read2_b32 a[40:41], v14 offset0:128 offset1:129
    ds_read2_b32 a[42:43], v14 offset0:130 offset1:131
    s_waitcnt lgkmcnt(11)
    v_mfma_f32_32x32x16_bf16 a[16:31], a[48:51], a[72:75], a[16:31]
    ds_read_b128 a[56:59], v11 offset:4432
    ds_read2_b32 a[44:45], v14 offset0:136 offset1:137
    ds_read2_b32 a[46:47], v14 offset0:138 offset1:139
    s_waitcnt lgkmcnt(11)
    v_mfma_f32_32x32x16_bf16 a[16:31], a[52:55], a[76:79], a[16:31]
    ds_read_b128 a[60:63], v11 offset:4400
    ds_read2_b32 a[48:49], v14 offset0:144 offset1:145
    ds_read2_b32 a[50:51], v14 offset0:146 offset1:147
    s_waitcnt lgkmcnt(11)
    v_mfma_f32_32x32x16_bf16 a[16:31], a[32:35], a[80:83], a[16:31]
    ds_read_b128 a[64:67], v11 offset:4352
    ds_read2_b32 a[52:53], v14 offset0:152 offset1:153
    ds_read2_b32 a[54:55], v14 offset0:154 offset1:155
    s_waitcnt lgkmcnt(11)
    v_mfma_f32_32x32x16_bf16 a[16:31], a[36:39], a[84:87], a[16:31]
    ds_read_b128 a[68:71], v11 offset:4320
    ds_read2_b32 a[32:33], v14 offset0:160 offset1:161
    ds_read2_b32 a[34:35], v14 offset0:162 offset1:163
    s_waitcnt lgkmcnt(11)
    v_mfma_f32_32x32x16_bf16 a[16:31], a[40:43], a[56:59], a[16:31]
    ds_read_b128 a[72:75], v11 offset:4272
    ds_read2_b32 a[36:37], v14 offset0:168 offset1:169
    ds_read2_b32 a[38:39], v14 offset0:170 offset1:171
    s_waitcnt lgkmcnt(11)
    v_mfma_f32_32x32x16_bf16 a[16:31], a[44:47], a[60:63], a[16:31]
    ds_read_b128 a[76:79], v11 offset:4240
    ds_read2_b32 a[40:41], v14 offset0:176 offset1:177
    ds_read2_b32 a[42:43], v14 offset0:178 offset1:179
    s_waitcnt lgkmcnt(11)
    v_mfma_f32_32x32x16_bf16 a[16:31], a[48:51], a[64:67], a[16:31]
    ds_read_b128 a[80:83], v11 offset:4192
    ds_read2_b32 a[44:45], v14 offset0:184 offset1:185
    ds_read2_b32 a[46:47], v14 offset0:186 offset1:187
    s_waitcnt lgkmcnt(11)
    v_mfma_f32_32x32x16_bf16 a[16:31], a[52:55], a[68:71], a[16:31]
    ds_read_b128 a[84:87], v11 offset:4160
    ds_read2_b32 a[48:49], v14 offset0:192 offset1:193
    ds_read2_b32 a[50:51], v14 offset0:194 offset1:195
    s_waitcnt lgkmcnt(11)
    v_mfma_f32_32x32x16_bf16 a[16:31], a[32:35], a[72:75], a[16:31]
    ds_read_b128 a[56:59], v11 offset:4112
    ds_read2_b32 a[52:53], v14 offset0:200 offset1:201
    ds_read2_b32 a[54:55], v14 offset0:202 offset1:203
    s_waitcnt lgkmcnt(11)
    v_mfma_f32_32x32x16_bf16 a[16:31], a[36:39], a[76:79], a[16:31]
    ds_read_b128 a[60:63], v11 offset:4080
    ds_read2_b32 a[32:33], v14 offset0:208 offset1:209
    ds_read2_b32 a[34:35], v14 offset0:210 offset1:211
    s_waitcnt lgkmcnt(11)
    v_mfma_f32_32x32x16_bf16 a[16:31], a[40:43], a[80:83], a[16:31]
    ds_read_b128 a[64:67], v11 offset:4032
    ds_read2_b32 a[36:37], v14 offset0:216 offset1:217
    ds_read2_b32 a[38:39], v14 offset0:218 offset1:219
    s_waitcnt lgkmcnt(11)
    v_mfma_f32_32x32x16_bf16 a[16:31], a[44:47], a[84:87], a[16:31]
    ds_read_b128 a[68:71], v11 offset:4000
    ds_read2_b32 a[40:41], v14 offset0:224 offset1:225
    ds_read2_b32 a[42:43], v14 offset0:226 offset1:227
    s_waitcnt lgkmcnt(11)
    v_mfma_f32_32x32x16_bf16 a[16:31], a[48:51], a[56:59], a[16:31]
    ds_read_b128 a[72:75], v11 offset:3952
    ds_read2_b32 a[44:45], v14 offset0:232 offset1:233
    ds_read2_b32 a[46:47], v14 offset0:234 offset1:235
    s_waitcnt lgkmcnt(11)
    v_mfma_f32_32x32x16_bf16 a[16:31], a[52:55], a[60:63], a[16:31]
    ds_read_b128 a[76:79], v11 offset:3920
    ds_read2_b32 a[48:49], v14 offset0:240 offset1:241
    ds_read2_b32 a[50:51], v14 offset0:242 offset1:243
    s_waitcnt lgkmcnt(11)
    v_mfma_f32_32x32x16_bf16 a[16:31], a[32:35], a[64:67], a[16:31]
    ds_read_b128 a[80:83], v11 offset:3872
    ds_read2_b32 a[52:53], v14 offset0:248 offset1:249
    ds_read2_b32 a[54:55], v14 offset0:250 offset1:251
    v_add_u32 v14, 1024, v14
    s_waitcnt lgkmcnt(11)
    v_mfma_f32_32x32x16_bf16 a[16:31], a[36:39], a[68:71], a[16:31]
    ds_read_b128 a[84:87], v11 offset:3840
    ds_read2_b32 a[32:33], v14 offset0:0 offset1:1
    ds_read2_b32 a[34:35], v14 offset0:2 offset1:3
    s_waitcnt lgkmcnt(11)
    v_mfma_f32_32x32x16_bf16 a[16:31], a[40:43], a[72:75], a[16:31]
    ds_read_b128 a[56:59], v11 offset:3792
    ds_read2_b32 a[36:37], v14 offset0:8 offset1:9
    ds_read2_b32 a[38:39], v14 offset0:10 offset1:11
    s_waitcnt lgkmcnt(11)
    v_mfma_f32_32x32x16_bf16 a[16:31], a[44:47], a[76:79], a[16:31]
    ds_read_b128 a[60:63], v11 offset:3760
    ds_read2_b32 a[40:41], v14 offset0:16 offset1:17
    ds_read2_b32 a[42:43], v14 offset0:18 offset1:19
    s_waitcnt lgkmcnt(11)
    v_mfma_f32_32x32x16_bf16 a[16:31], a[48:51], a[80:83], a[16:31]
    ds_read_b128 a[64:67], v11 offset:3712
    ds_read2_b32 a[44:45], v14 offset0:24 offset1:25
    ds_read2_b32 a[46:47], v14 offset0:26 offset1:27
    s_waitcnt lgkmcnt(11)
    v_mfma_f32_32x32x16_bf16 a[16:31], a[52:55], a[84:87], a[16:31]
    ds_read_b128 a[68:71], v11 offset:3680
    ds_read2_b32 a[48:49], v14 offset0:32 offset1:33
    ds_read2_b32 a[50:51], v14 offset0:34 offset1:35
    s_waitcnt lgkmcnt(11)
    v_mfma_f32_32x32x16_bf16 a[16:31], a[32:35], a[56:59], a[16:31]
    ds_read_b128 a[72:75], v11 offset:3632
    ds_read2_b32 a[52:53], v14 offset0:40 offset1:41
    ds_read2_b32 a[54:55], v14 offset0:42 offset1:43
    s_waitcnt lgkmcnt(11)
    v_mfma_f32_32x32x16_bf16 a[16:31], a[36:39], a[60:63], a[16:31]
    ds_read_b128 a[76:79], v11 offset:3600
    ds_read2_b32 a[32:33], v14 offset0:48 offset1:49
    ds_read2_b32 a[34:35], v14 offset0:50 offset1:51
    s_waitcnt lgkmcnt(11)
    v_mfma_f32_32x32x16_bf16 a[16:31], a[40:43], a[64:67], a[16:31]
    ds_read_b128 a[80:83], v11 offset:3552
    ds_read2_b32 a[36:37], v14 offset0:56 offset1:57
    ds_read2_b32 a[38:39], v14 offset0:58 offset1:59
    s_waitcnt lgkmcnt(11)
    v_mfma_f32_32x32x16_bf16 a[16:31], a[44:47], a[68:71], a[16:31]
    ds_read_b128 a[84:87], v11 offset:3520
    ds_read2_b32 a[40:41], v14 offset0:64 offset1:65
    ds_read2_b32 a[42:43], v14 offset0:66 offset1:67
    s_waitcnt lgkmcnt(11)
    v_mfma_f32_32x32x16_bf16 a[16:31], a[48:51], a[72:75], a[16:31]
    ds_read_b128 a[56:59], v11 offset:3472
    ds_read2_b32 a[44:45], v14 offset0:72 offset1:73
    ds_read2_b32 a[46:47], v14 offset0:74 offset1:75
    s_waitcnt lgkmcnt(11)
    v_mfma_f32_32x32x16_bf16 a[16:31], a[52:55], a[76:79], a[16:31]
    ds_read_b128 a[60:63], v11 offset:3440
    ds_read2_b32 a[48:49], v14 offset0:80 offset1:81
    ds_read2_b32 a[50:51], v14 offset0:82 offset1:83
    s_waitcnt lgkmcnt(11)
    v_mfma_f32_32x32x16_bf16 a[16:31], a[32:35], a[80:83], a[16:31]
    ds_read_b128 a[64:67], v11 offset:3392
    ds_read2_b32 a[52:53], v14 offset0:88 offset1:89
    ds_read2_b32 a[54:55], v14 offset0:90 offset1:91
    s_waitcnt lgkmcnt(11)
    v_mfma_f32_32x32x16_bf16 a[16:31], a[36:39], a[84:87], a[16:31]
    ds_read_b128 a[68:71], v11 offset:3360
    ds_read2_b32 a[32:33], v14 offset0:96 offset1:97
    ds_read2_b32 a[34:35], v14 offset0:98 offset1:99
    s_waitcnt lgkmcnt(11)
    v_mfma_f32_32x32x16_bf16 a[16:31], a[40:43], a[56:59], a[16:31]
    ds_read_b128 a[72:75], v11 offset:3312
    ds_read2_b32 a[36:37], v14 offset0:104 offset1:105
    ds_read2_b32 a[38:39], v14 offset0:106 offset1:107
    s_waitcnt lgkmcnt(11)
    v_mfma_f32_32x32x16_bf16 a[16:31], a[44:47], a[60:63], a[16:31]
    ds_read_b128 a[76:79], v11 offset:3280
    ds_read2_b32 a[40:41], v14 offset0:112 offset1:113
    ds_read2_b32 a[42:43], v14 offset0:114 offset1:115
    s_waitcnt lgkmcnt(11)
    v_mfma_f32_32x32x16_bf16 a[16:31], a[48:51], a[64:67], a[16:31]
    ds_read_b128 a[80:83], v11 offset:3232
    ds_read2_b32 a[44:45], v14 offset0:120 offset1:121
    ds_read2_b32 a[46:47], v14 offset0:122 offset1:123
    s_waitcnt lgkmcnt(11)
    v_mfma_f32_32x32x16_bf16 a[16:31], a[52:55], a[68:71], a[16:31]
    ds_read_b128 a[84:87], v11 offset:3200
    ds_read2_b32 a[48:49], v14 offset0:128 offset1:129
    ds_read2_b32 a[50:51], v14 offset0:130 offset1:131
    s_waitcnt lgkmcnt(11)
    v_mfma_f32_32x32x16_bf16 a[16:31], a[32:35], a[72:75], a[16:31]
    ds_read_b128 a[56:59], v11 offset:3152
    ds_read2_b32 a[52:53], v14 offset0:136 offset1:137
    ds_read2_b32 a[54:55], v14 offset0:138 offset1:139
    s_waitcnt lgkmcnt(11)
    v_mfma_f32_32x32x16_bf16 a[16:31], a[36:39], a[76:79], a[16:31]
    ds_read_b128 a[60:63], v11 offset:3120
    ds_read2_b32 a[32:33], v14 offset0:144 offset1:145
    ds_read2_b32 a[34:35], v14 offset0:146 offset1:147
    s_waitcnt lgkmcnt(11)
    v_mfma_f32_32x32x16_bf16 a[16:31], a[40:43], a[80:83], a[16:31]
    ds_read_b128 a[64:67], v11 offset:3072
    ds_read2_b32 a[36:37], v14 offset0:152 offset1:153
    ds_read2_b32 a[38:39], v14 offset0:154 offset1:155
    s_waitcnt lgkmcnt(11)
    v_mfma_f32_32x32x16_bf16 a[16:31], a[44:47], a[84:87], a[16:31]
    ds_read_b128 a[68:71], v11 offset:3040
    ds_read2_b32 a[40:41], v14 offset0:160 offset1:161
    ds_read2_b32 a[42:43], v14 offset0:162 offset1:163
    s_waitcnt lgkmcnt(11)
    v_mfma_f32_32x32x16_bf16 a[16:31], a[48:51], a[56:59], a[16:31]
    ds_read_b128 a[72:75], v11 offset:2992
    ds_read2_b32 a[44:45], v14 offset0:168 offset1:169
    ds_read2_b32 a[46:47], v14 offset0:170 offset1:171
    s_waitcnt lgkmcnt(11)
    v_mfma_f32_32x32x16_bf16 a[16:31], a[52:55], a[60:63], a[16:31]
    ds_read_b128 a[76:79], v11 offset:2960
    ds_read2_b32 a[48:49], v14 offset0:176 offset1:177
    ds_read2_b32 a[50:51], v14 offset0:178 offset1:179
    s_waitcnt lgkmcnt(11)
    v_mfma_f32_32x32x16_bf16 a[16:31], a[32:35], a[64:67], a[16:31]
    ds_read_b128 a[80:83], v11 offset:2912
    ds_read2_b32 a[52:53], v14 offset0:184 offset1:185
    ds_read2_b32 a[54:55], v14 offset0:186 offset1:187
    s_waitcnt lgkmcnt(11)
    v_mfma_f32_32x32x16_bf16 a[16:31], a[36:39], a[68:71], a[16:31]
    ds_read_b128 a[84:87], v11 offset:2880
    ds_read2_b32 a[32:33], v14 offset0:192 offset1:193
    ds_read2_b32 a[34:35], v14 offset0:194 offset1:195
    s_waitcnt lgkmcnt(11)
    v_mfma_f32_32x32x16_bf16 a[16:31], a[40:43], a[72:75], a[16:31]
    ds_read_b128 a[56:59], v11 offset:2832
    ds_read2_b32 a[36:37], v14 offset0:200 offset1:201
    ds_read2_b32 a[38:39], v14 offset0:202 offset1:203
    s_waitcnt lgkmcnt(11)
    v_mfma_f32_32x32x16_bf16 a[16:31], a[44:47], a[76:79], a[16:31]
    ds_read_b128 a[60:63], v11 offset:2800
    ds_read2_b32 a[40:41], v14 offset0:208 offset1:209
    ds_read2_b32 a[42:43], v14 offset0:210 offset1:211
    s_waitcnt lgkmcnt(11)
    v_mfma_f32_32x32x16_bf16 a[16:31], a[48:51], a[80:83], a[16:31]
    ds_read_b128 a[64:67], v11 offset:2752
    ds_read2_b32 a[44:45], v14 offset0:216 offset1:217
    ds_read2_b32 a[46:47], v14 offset0:218 offset1:219
    s_waitcnt lgkmcnt(11)
    v_mfma_f32_32x32x16_bf16 a[16:31], a[52:55], a[84:87], a[16:31]
    ds_read_b128 a[68:71], v11 offset:2720
    ds_read2_b32 a[48:49], v14 offset0:224 offset1:225
    ds_read2_b32 a[50:51], v14 offset0:226 offset1:227
    s_waitcnt lgkmcnt(11)
    v_mfma_f32_32x32x16_bf16 a[16:31], a[32:35], a[56:59], a[16:31]
    ds_read_b128 a[72:75], v11 offset:2672
    ds_read2_b32 a[52:53], v14 offset0:232 offset1:233
    ds_read2_b32 a[54:55], v14 offset0:234 offset1:235
    s_waitcnt lgkmcnt(11)
    v_mfma_f32_32x32x16_bf16 a[16:31], a[36:39], a[60:63], a[16:31]
    ds_read_b128 a[76:79], v11 offset:2640
    ds_read2_b32 a[32:33], v14 offset0:240 offset1:241
    ds_read2_b32 a[34:35], v14 offset0:242 offset1:243
    s_waitcnt lgkmcnt(11)
    v_mfma_f32_32x32x16_bf16 a[16:31], a[40:43], a[64:67], a[16:31]
    ds_read_b128 a[80:83], v11 offset:2592
    ds_read2_b32 a[36:37], v14 offset0:248 offset1:249
    ds_read2_b32 a[38:39], v14 offset0:250 offset1:251
    v_add_u32 v14, 1024, v14
    s_waitcnt lgkmcnt(11)
    v_mfma_f32_32x32x16_bf16 a[16:31], a[44:47], a[68:71], a[16:31]
    ds_read_b128 a[84:87], v11 offset:2560
    s_waitcnt lgkmcnt(9)
    v_mfma_f32_32x32x16_bf16 a[16:31], a[48:51], a[72:75], a[16:31]
    s_waitcnt lgkmcnt(6)
    v_mfma_f32_32x32x16_bf16 a[16:31], a[52:55], a[76:79], a[16:31]
    s_waitcnt lgkmcnt(3)
    v_mfma_f32_32x32x16_bf16 a[16:31], a[32:35], a[80:83], a[16:31]
    s_waitcnt lgkmcnt(0)
    v_mfma_f32_32x32x16_bf16 a[16:31], a[36:39], a[84:87], a[16:31]
    v_accvgpr_read_b32 v220, a0
    v_accvgpr_read_b32 v221, a1
    v_accvgpr_read_b32 v222, a2
    v_accvgpr_read_b32 v223, a3
    v_accvgpr_read_b32 v224, a4
    v_accvgpr_read_b32 v225, a5
    v_accvgpr_read_b32 v226, a6
    v_accvgpr_read_b32 v227, a7
    v_accvgpr_read_b32 v228, a8
    v_accvgpr_read_b32 v229, a9
    v_accvgpr_read_b32 v230, a10
    v_accvgpr_read_b32 v231, a11
    v_accvgpr_read_b32 v232, a12
    v_accvgpr_read_b32 v233, a13
    v_accvgpr_read_b32 v234, a14
    v_accvgpr_read_b32 v235, a15
    v_cvt_pk_bf16_f32 v236, v220, v221
    v_cvt_pk_bf16_f32 v237, v222, v223
    v_cvt_pk_bf16_f32 v238, v224, v225
    v_cvt_pk_bf16_f32 v239, v226, v227
    v_cvt_pk_bf16_f32 v240, v228, v229
    v_cvt_pk_bf16_f32 v241, v230, v231
    v_cvt_pk_bf16_f32 v242, v232, v233
    v_cvt_pk_bf16_f32 v243, v234, v235
    s_nop 0
    v_permlane32_swap_b32 v236, v238
    v_permlane32_swap_b32 v237, v239
    v_permlane32_swap_b32 v240, v242
    v_permlane32_swap_b32 v241, v243
    buffer_store_dwordx4 v[236:239], v2, s[8:11], s7 offen offset:0 sc1
    buffer_store_dwordx4 v[240:243], v2, s[8:11], s7 offen offset:1024 sc1
    v_accvgpr_read_b32 v220, a16
    v_accvgpr_read_b32 v221, a17
    v_accvgpr_read_b32 v222, a18
    v_accvgpr_read_b32 v223, a19
    v_accvgpr_read_b32 v224, a20
    v_accvgpr_read_b32 v225, a21
    v_accvgpr_read_b32 v226, a22
    v_accvgpr_read_b32 v227, a23
    v_accvgpr_read_b32 v228, a24
    v_accvgpr_read_b32 v229, a25
    v_accvgpr_read_b32 v230, a26
    v_accvgpr_read_b32 v231, a27
    v_accvgpr_read_b32 v232, a28
    v_accvgpr_read_b32 v233, a29
    v_accvgpr_read_b32 v234, a30
    v_accvgpr_read_b32 v235, a31
    v_cvt_pk_bf16_f32 v236, v220, v221
    v_cvt_pk_bf16_f32 v237, v222, v223
    v_cvt_pk_bf16_f32 v238, v224, v225
    v_cvt_pk_bf16_f32 v239, v226, v227
    v_cvt_pk_bf16_f32 v240, v228, v229
    v_cvt_pk_bf16_f32 v241, v230, v231
    v_cvt_pk_bf16_f32 v242, v232, v233
    v_cvt_pk_bf16_f32 v243, v234, v235
    s_nop 0
    v_permlane32_swap_b32 v236, v238
    v_permlane32_swap_b32 v237, v239
    v_permlane32_swap_b32 v240, v242
    v_permlane32_swap_b32 v241, v243
    buffer_store_dwordx4 v[236:239], v2, s[8:11], s7 offen offset:2048 sc1
    buffer_store_dwordx4 v[240:243], v2, s[8:11], s7 offen offset:3072 sc1
    v_add_u32 v11, 30720, v11
    s_add_u32 s64, s64, 1
    s_cmp_lt_u32 s64, 4
    s_waitcnt vmcnt(4)
    s_cbranch_scc1 .chan_194
    s_waitcnt vmcnt(0)
    s_barrier
    s_cmp_lg_u32 s24, 0
    s_cbranch_scc1 .sg_199
    s_mov_b64 exec, 1
    v_mov_b32 v4, 1
    v_mov_b32 v5, 0
    buffer_atomic_add v4, v5, s[20:23], 0 offen offset:192 sc1
    s_mov_b64 exec, -1
.sg_199:
    s_cmp_eq_u32 s98, 3
    s_cbranch_scc1 .ph2_191
.qkv_192:
    s_lshl_b32 s4, s98, 3
    s_add_u32 s4, s4, 64
    s_load_dwordx2 s[40:41], s[0:1], 0
    s_load_dwordx2 s[42:43], s[0:1], s4
    s_lshl_b32 s4, s99, 8
    s_lshl_b32 s5, s24, 6
    s_add_u32 s4, s4, s5
    s_lshl_b32 s6, s24, 14
    v_bfe_u32 v254, v1, 2, 4
    v_mul_u32_u24 v240, 8192, v254
    v_bfe_u32 v254, v1, 0, 2
    v_mul_u32_u24 v254, 16, v254
    v_add_u32 v240, v240, v254
    v_add_u32 v240, s4, v240
    v_bfe_u32 v254, v1, 4, 2
    v_mul_u32_u24 v242, 512, v254
    v_bfe_u32 v254, v1, 2, 2
    v_mul_u32_u24 v254, 64, v254
    v_add_u32 v242, v242, v254
    v_bfe_u32 v254, v1, 0, 2
    v_mul_u32_u24 v254, 16, v254
    v_add_u32 v242, v242, v254
    v_add_u32 v242, s6, v242
    v_add_u32 v243, 0x10000, v242
    s_waitcnt lgkmcnt(0)
    s_mov_b32 s12, s40
    s_and_b32 s13, s41, 0xffff
    s_mov_b32 s14, 0x400000
    s_mov_b32 s15, 0x00020000
    s_mov_b32 s16, s42
    s_and_b32 s17, s43, 0xffff
    s_mov_b32 s18, 0x800000
    s_mov_b32 s19, 0x00020000
    s_add_u32 m0, s6, 0
    s_mov_b32 s5, 0
    buffer_load_dwordx4 v240, s[16:19], s5 offen nt lds
    s_add_u32 m0, s6, 1024
    s_mov_b32 s5, 131072
    buffer_load_dwordx4 v240, s[16:19], s5 offen nt lds
    s_add_u32 m0, s6, 2048
    s_mov_b32 s5, 262144
    buffer_load_dwordx4 v240, s[16:19], s5 offen nt lds
    s_add_u32 m0, s6, 3072
    s_mov_b32 s5, 393216
    buffer_load_dwordx4 v240, s[16:19], s5 offen nt lds
    s_add_u32 m0, s6, 4096
    s_mov_b32 s5, 524288
    buffer_load_dwordx4 v240, s[16:19], s5 offen nt lds
    s_add_u32 m0, s6, 5120
    s_mov_b32 s5, 655360
    buffer_load_dwordx4 v240, s[16:19], s5 offen nt lds
    s_add_u32 m0, s6, 6144
    s_mov_b32 s5, 786432
    buffer_load_dwordx4 v240, s[16:19], s5 offen nt lds
    s_add_u32 m0, s6, 7168
    s_mov_b32 s5, 917504
    buffer_load_dwordx4 v240, s[16:19], s5 offen nt lds
    s_add_u32 m0, s6, 8192
    s_mov_b32 s5, 1048576
    buffer_load_dwordx4 v240, s[16:19], s5 offen nt lds
    s_add_u32 m0, s6, 9216
    s_mov_b32 s5, 1179648
    buffer_load_dwordx4 v240, s[16:19], s5 offen nt lds
    s_add_u32 m0, s6, 10240
    s_mov_b32 s5, 1310720
    buffer_load_dwordx4 v240, s[16:19], s5 offen nt lds
    s_add_u32 m0, s6, 11264
    s_mov_b32 s5, 1441792
    buffer_load_dwordx4 v240, s[16:19], s5 offen nt lds
    s_add_u32 m0, s6, 12288
    s_mov_b32 s5, 1572864
    buffer_load_dwordx4 v240, s[16:19], s5 offen nt lds
    s_add_u32 m0, s6, 13312
    s_mov_b32 s5, 1703936
    buffer_load_dwordx4 v240, s[16:19], s5 offen nt lds
    s_add_u32 m0, s6, 14336
    s_mov_b32 s5, 1835008
    buffer_load_dwordx4 v240, s[16:19], s5 offen nt lds
    s_add_u32 m0, s6, 15360
    s_mov_b32 s5, 1966080
    buffer_load_dwordx4 v240, s[16:19], s5 offen nt lds
    s_add_u32 m0, s6, 65536
    s_mov_b32 s5, 2097152
    buffer_load_dwordx4 v240, s[16:19], s5 offen nt lds
    s_add_u32 m0, s6, 66560
    s_mov_b32 s5, 2228224
    buffer_load_dwordx4 v240, s[16:19], s5 offen nt lds
    s_add_u32 m0, s6, 67584
    s_mov_b32 s5, 2359296
    buffer_load_dwordx4 v240, s[16:19], s5 offen nt lds
    s_add_u32 m0, s6, 68608
    s_mov_b32 s5, 2490368
    buffer_load_dwordx4 v240, s[16:19], s5 offen nt lds
    s_add_u32 m0, s6, 69632
    s_mov_b32 s5, 2621440
    buffer_load_dwordx4 v240, s[16:19], s5 offen nt lds
    s_add_u32 m0, s6, 70656
    s_mov_b32 s5, 2752512
    buffer_load_dwordx4 v240, s[16:19], s5 offen nt lds
    s_add_u32 m0, s6, 71680
    s_mov_b32 s5, 2883584
    buffer_load_dwordx4 v240, s[16:19], s5 offen nt lds
    s_add_u32 m0, s6, 72704
    s_mov_b32 s5, 3014656
    buffer_load_dwordx4 v240, s[16:19], s5 offen nt lds
    s_add_u32 m0, s6, 73728
    s_mov_b32 s5, 3145728
    buffer_load_dwordx4 v240, s[16:19], s5 offen nt lds
    s_add_u32 m0, s6, 74752
    s_mov_b32 s5, 3276800
    buffer_load_dwordx4 v240, s[16:19], s5 offen nt lds
    s_add_u32 m0, s6, 75776
    s_mov_b32 s5, 3407872
    buffer_load_dwordx4 v240, s[16:19], s5 offen nt lds
    s_add_u32 m0, s6, 76800
    s_mov_b32 s5, 3538944
    buffer_load_dwordx4 v240, s[16:19], s5 offen nt lds
    s_add_u32 m0, s6, 77824
    s_mov_b32 s5, 3670016
    buffer_load_dwordx4 v240, s[16:19], s5 offen nt lds
    s_add_u32 m0, s6, 78848
    s_mov_b32 s5, 3801088
    buffer_load_dwordx4 v240, s[16:19], s5 offen nt lds
    s_add_u32 m0, s6, 79872
    s_mov_b32 s5, 3932160
    buffer_load_dwordx4 v240, s[16:19], s5 offen nt lds
    s_add_u32 m0, s6, 80896
    s_mov_b32 s5, 4063232
    buffer_load_dwordx4 v240, s[16:19], s5 offen nt lds
    v_and_b32 v2, 15, v1
    v_lshrrev_b32 v3, 4, v1
    v_lshlrev_b32 v4, 11, v2
    v_add_u32 v5, 0, v3
    v_xor_b32 v5, v5, v2
    v_lshl_add_u32 v8, v5, 4, v4
    v_add_u32 v12, 0x10000, v8
    v_add_u32 v5, 4, v3
    v_xor_b32 v5, v5, v2
    v_lshl_add_u32 v9, v5, 4, v4
    v_add_u32 v13, 0x10000, v9
    v_add_u32 v5, 8, v3
    v_xor_b32 v5, v5, v2
    v_lshl_add_u32 v10, v5, 4, v4
    v_add_u32 v14, 0x10000, v10
    v_add_u32 v5, 12, v3
    v_xor_b32 v5, v5, v2
    v_lshl_add_u32 v11, v5, 4, v4
    v_add_u32 v15, 0x10000, v11
    s_lshl_b32 s4, s24, 3
    s_and_b32 s4, s4, 8
    s_add_u32 s5, s4, 0
    v_xor_b32 v5, s5, v1
    s_add_u32 s5, s6, 0
    v_lshlrev_b32 v5, 4, v5
    v_add_u32 v16, s5, v5
    s_add_u32 s5, s4, 1
    v_xor_b32 v5, s5, v1
    s_add_u32 s5, s6, 0
    v_lshlrev_b32 v5, 4, v5
    v_add_u32 v17, s5, v5
    s_add_u32 s5, s4, 2
    v_xor_b32 v5, s5, v1
    s_add_u32 s5, s6, 4096
    v_lshlrev_b32 v5, 4, v5
    v_add_u32 v18, s5, v5
    s_add_u32 s5, s4, 3
    v_xor_b32 v5, s5, v1
    s_add_u32 s5, s6, 4096
    v_lshlrev_b32 v5, 4, v5
    v_add_u32 v19, s5, v5
    s_add_u32 s5, s4, 4
    v_xor_b32 v5, s5, v1
    s_add_u32 s5, s6, 8192
    v_lshlrev_b32 v5, 4, v5
    v_add_u32 v20, s5, v5
    s_add_u32 s5, s4, 5
    v_xor_b32 v5, s5, v1
    s_add_u32 s5, s6, 8192
    v_lshlrev_b32 v5, 4, v5
    v_add_u32 v21, s5, v5
    s_add_u32 s5, s4, 6
    v_xor_b32 v5, s5, v1
    s_add_u32 s5, s6, 12288
    v_lshlrev_b32 v5, 4, v5
    v_add_u32 v22, s5, v5
    s_add_u32 s5, s4, 7
    v_xor_b32 v5, s5, v1
    s_add_u32 s5, s6, 12288
    v_lshlrev_b32 v5, 4, v5
    v_add_u32 v23, s5, v5
    s_cmp_eq_u32 s98, 2
    s_cselect_b32 s4, 11, 10
    s_cselect_b32 s5, 1, 4
    s_lshl_b32 s5, s5, 10
    s_lshl_b32 s4, s24, s4
    v_lshlrev_b32 v24, 4, v1
    v_add_u32 v24, s4, v24
    v_add_u32 v25, s5, v24
    v_mov_b32 v26, 0
    s_and_b32 s4, s99, 7
    s_lshl_b32 s4, s4, 13
    s_lshl_b32 s5, s24, 11
    s_add_u32 s4, s4, s5
    s_add_u32 s4, s4, 196608
    v_lshlrev_b32 v28, 5, v1
    v_add_u32 v28, s4, v28
    s_lshl_b32 s31, s98, 24
    s_lshl_b32 s4, s99, 13
    s_add_u32 s31, s31, s4
    s_mov_b32 s30, 75497472
    s_mov_b32 s28, 0
    s_mov_b32 s29, 0
    s_waitcnt vmcnt(16)
    ds_read_b64_tr_b16 a[0:1], v242 offset:0
    ds_read_b64_tr_b16 a[2:3], v242 offset:256
    ds_read_b64_tr_b16 a[4:5], v242 offset:8
    ds_read_b64_tr_b16 a[6:7], v242 offset:264
    ds_read_b64_tr_b16 a[8:9], v242 offset:2048
    ds_read_b64_tr_b16 a[10:11], v242 offset:2304
    ds_read_b64_tr_b16 a[12:13], v242 offset:2056
    ds_read_b64_tr_b16 a[14:15], v242 offset:2312
    ds_read_b64_tr_b16 a[16:17], v242 offset:4096
    ds_read_b64_tr_b16 a[18:19], v242 offset:4352
    ds_read_b64_tr_b16 a[20:21], v242 offset:4104
    ds_read_b64_tr_b16 a[22:23], v242 offset:4360
    ds_read_b64_tr_b16 a[24:25], v242 offset:6144
    ds_read_b64_tr_b16 a[26:27], v242 offset:6400
    ds_read_b64_tr_b16 a[28:29], v242 offset:6152
    ds_read_b64_tr_b16 a[30:31], v242 offset:6408
    ds_read_b64_tr_b16 a[32:33], v242 offset:8192
    ds_read_b64_tr_b16 a[34:35], v242 offset:8448
    ds_read_b64_tr_b16 a[36:37], v242 offset:8200
    ds_read_b64_tr_b16 a[38:39], v242 offset:8456
    ds_read_b64_tr_b16 a[40:41], v242 offset:10240
    ds_read_b64_tr_b16 a[42:43], v242 offset:10496
    ds_read_b64_tr_b16 a[44:45], v242 offset:10248
    ds_read_b64_tr_b16 a[46:47], v242 offset:10504
    ds_read_b64_tr_b16 a[48:49], v242 offset:12288
    ds_read_b64_tr_b16 a[50:51], v242 offset:12544
    ds_read_b64_tr_b16 a[52:53], v242 offset:12296
    ds_read_b64_tr_b16 a[54:55], v242 offset:12552
    ds_read_b64_tr_b16 a[56:57], v242 offset:14336
    ds_read_b64_tr_b16 a[58:59], v242 offset:14592
    ds_read_b64_tr_b16 a[60:61], v242 offset:14344
    ds_read_b64_tr_b16 a[62:63], v242 offset:14600
    s_waitcnt lgkmcnt(0)
    s_add_u32 m0, s6, 0
    s_mov_b32 s5, 4194304
    buffer_load_dwordx4 v240, s[16:19], s5 offen nt lds
    s_add_u32 m0, s6, 1024
    s_mov_b32 s5, 4325376
    buffer_load_dwordx4 v240, s[16:19], s5 offen nt lds
    s_add_u32 m0, s6, 2048
    s_mov_b32 s5, 4456448
    buffer_load_dwordx4 v240, s[16:19], s5 offen nt lds
    s_add_u32 m0, s6, 3072
    s_mov_b32 s5, 4587520
    buffer_load_dwordx4 v240, s[16:19], s5 offen nt lds
    s_add_u32 m0, s6, 4096
    s_mov_b32 s5, 4718592
    buffer_load_dwordx4 v240, s[16:19], s5 offen nt lds
    s_add_u32 m0, s6, 5120
    s_mov_b32 s5, 4849664
    buffer_load_dwordx4 v240, s[16:19], s5 offen nt lds
    s_add_u32 m0, s6, 6144
    s_mov_b32 s5, 4980736
    buffer_load_dwordx4 v240, s[16:19], s5 offen nt lds
    s_add_u32 m0, s6, 7168
    s_mov_b32 s5, 5111808
    buffer_load_dwordx4 v240, s[16:19], s5 offen nt lds
    s_add_u32 m0, s6, 8192
    s_mov_b32 s5, 5242880
    buffer_load_dwordx4 v240, s[16:19], s5 offen nt lds
    s_add_u32 m0, s6, 9216
    s_mov_b32 s5, 5373952
    buffer_load_dwordx4 v240, s[16:19], s5 offen nt lds
    s_add_u32 m0, s6, 10240
    s_mov_b32 s5, 5505024
    buffer_load_dwordx4 v240, s[16:19], s5 offen nt lds
    s_add_u32 m0, s6, 11264
    s_mov_b32 s5, 5636096
    buffer_load_dwordx4 v240, s[16:19], s5 offen nt lds
    s_add_u32 m0, s6, 12288
    s_mov_b32 s5, 5767168
    buffer_load_dwordx4 v240, s[16:19], s5 offen nt lds
    s_add_u32 m0, s6, 13312
    s_mov_b32 s5, 5898240
    buffer_load_dwordx4 v240, s[16:19], s5 offen nt lds
    s_add_u32 m0, s6, 14336
    s_mov_b32 s5, 6029312
    buffer_load_dwordx4 v240, s[16:19], s5 offen nt lds
    s_add_u32 m0, s6, 15360
    s_mov_b32 s5, 6160384
    buffer_load_dwordx4 v240, s[16:19], s5 offen nt lds
    s_waitcnt vmcnt(16)
    s_lshl_b32 s4, s99, 7
    s_lshl_b32 s5, s24, 2
    s_add_u32 s4, s4, s5
    s_lshl_b32 s5, s98, 12
    s_add_u32 s4, s4, s5
    s_add_u32 s94, s4, 92274688
    ds_read_b64_tr_b16 a[64:65], v243 offset:0
    ds_read_b64_tr_b16 a[66:67], v243 offset:256
    ds_read_b64_tr_b16 a[68:69], v243 offset:8
    ds_read_b64_tr_b16 a[70:71], v243 offset:264
    ds_read_b64_tr_b16 a[72:73], v243 offset:2048
    ds_read_b64_tr_b16 a[74:75], v243 offset:2304
    ds_read_b64_tr_b16 a[76:77], v243 offset:2056
    ds_read_b64_tr_b16 a[78:79], v243 offset:2312
    ds_read_b64_tr_b16 a[80:81], v243 offset:4096
    ds_read_b64_tr_b16 a[82:83], v243 offset:4352
    ds_read_b64_tr_b16 a[84:85], v243 offset:4104
    ds_read_b64_tr_b16 a[86:87], v243 offset:4360
    ds_read_b64_tr_b16 a[88:89], v243 offset:6144
    ds_read_b64_tr_b16 a[90:91], v243 offset:6400
    ds_read_b64_tr_b16 a[92:93], v243 offset:6152
    ds_read_b64_tr_b16 a[94:95], v243 offset:6408
    ds_read_b64_tr_b16 a[96:97], v243 offset:8192
    ds_read_b64_tr_b16 a[98:99], v243 offset:8448
    ds_read_b64_tr_b16 a[100:101], v243 offset:8200
    ds_read_b64_tr_b16 a[102:103], v243 offset:8456
    ds_read_b64_tr_b16 a[104:105], v243 offset:10240
    ds_read_b64_tr_b16 a[106:107], v243 offset:10496
    ds_read_b64_tr_b16 a[108:109], v243 offset:10248
    ds_read_b64_tr_b16 a[110:111], v243 offset:10504
    ds_read_b64_tr_b16 a[112:113], v243 offset:12288
    ds_read_b64_tr_b16 a[114:115], v243 offset:12544
    ds_read_b64_tr_b16 a[116:117], v243 offset:12296
    ds_read_b64_tr_b16 a[118:119], v243 offset:12552
    ds_read_b64_tr_b16 a[120:121], v243 offset:14336
    ds_read_b64_tr_b16 a[122:123], v243 offset:14592
    ds_read_b64_tr_b16 a[124:125], v243 offset:14344
    ds_read_b64_tr_b16 a[126:127], v243 offset:14600
    s_waitcnt lgkmcnt(0)
    v_lshlrev_b32 v239, 2, v1
    buffer_load_dword v238, v239, s[20:23], 0 offen sc1
    s_add_u32 m0, s6, 65536
    s_mov_b32 s5, 6291456
    buffer_load_dwordx4 v240, s[16:19], s5 offen nt lds
    s_add_u32 m0, s6, 66560
    s_mov_b32 s5, 6422528
    buffer_load_dwordx4 v240, s[16:19], s5 offen nt lds
    s_add_u32 m0, s6, 67584
    s_mov_b32 s5, 6553600
    buffer_load_dwordx4 v240, s[16:19], s5 offen nt lds
    s_add_u32 m0, s6, 68608
    s_mov_b32 s5, 6684672
    buffer_load_dwordx4 v240, s[16:19], s5 offen nt lds
    s_add_u32 m0, s6, 69632
    s_mov_b32 s5, 6815744
    buffer_load_dwordx4 v240, s[16:19], s5 offen nt lds
    s_add_u32 m0, s6, 70656
    s_mov_b32 s5, 6946816
    buffer_load_dwordx4 v240, s[16:19], s5 offen nt lds
    s_add_u32 m0, s6, 71680
    s_mov_b32 s5, 7077888
    buffer_load_dwordx4 v240, s[16:19], s5 offen nt lds
    s_add_u32 m0, s6, 72704
    s_mov_b32 s5, 7208960
    buffer_load_dwordx4 v240, s[16:19], s5 offen nt lds
    s_add_u32 m0, s6, 73728
    s_mov_b32 s5, 7340032
    buffer_load_dwordx4 v240, s[16:19], s5 offen nt lds
    s_add_u32 m0, s6, 74752
    s_mov_b32 s5, 7471104
    buffer_load_dwordx4 v240, s[16:19], s5 offen nt lds
    s_add_u32 m0, s6, 75776
    s_mov_b32 s5, 7602176
    buffer_load_dwordx4 v240, s[16:19], s5 offen nt lds
    s_add_u32 m0, s6, 76800
    s_mov_b32 s5, 7733248
    buffer_load_dwordx4 v240, s[16:19], s5 offen nt lds
    s_add_u32 m0, s6, 77824
    s_mov_b32 s5, 7864320
    buffer_load_dwordx4 v240, s[16:19], s5 offen nt lds
    s_add_u32 m0, s6, 78848
    s_mov_b32 s5, 7995392
    buffer_load_dwordx4 v240, s[16:19], s5 offen nt lds
    s_add_u32 m0, s6, 79872
    s_mov_b32 s5, 8126464
    buffer_load_dwordx4 v240, s[16:19], s5 offen nt lds
    s_add_u32 m0, s6, 80896
    s_mov_b32 s5, 8257536
    buffer_load_dwordx4 v240, s[16:19], s5 offen nt lds
    s_waitcnt vmcnt(16)
    s_cmp_lg_u32 s27, 0
    s_cbranch_scc1 .vd_201
    s_mov_b32 s62, 0
.vp_200:
    v_readlane_b32 s4, v238, 8
    s_cmp_ge_u32 s4, 256
    s_cbranch_scc1 .va_202
    s_add_u32 s62, s62, 1
    s_cmp_gt_u32 s62, 0x100000
    s_cbranch_scc1 .mg_end_1
    s_sleep 16
    buffer_load_dword v238, v239, s[20:23], 0 offen sc1
    s_waitcnt vmcnt(0)
    s_branch .vp_200
.va_202:
    v_cmp_ne_u32 vcc, 32, v238
    s_and_b32 s4, vcc_lo, 0xff
    s_cbranch_scc0 .vd_201
    s_lshr_b32 s25, s2, 5
    s_and_b32 s26, s2, 31
    s_mov_b32 s27, 1
    s_waitcnt vmcnt(0) lgkmcnt(0)
    s_barrier
    s_branch .mg_role_3
.vd_201:
    ds_read_b64_tr_b16 a[128:129], v242 offset:0
    ds_read_b64_tr_b16 a[130:131], v242 offset:256
    ds_read_b64_tr_b16 a[132:133], v242 offset:8
    ds_read_b64_tr_b16 a[134:135], v242 offset:264
    ds_read_b64_tr_b16 a[136:137], v242 offset:2048
    ds_read_b64_tr_b16 a[138:139], v242 offset:2304
    ds_read_b64_tr_b16 a[140:141], v242 offset:2056
    ds_read_b64_tr_b16 a[142:143], v242 offset:2312
    ds_read_b64_tr_b16 a[144:145], v242 offset:4096
    ds_read_b64_tr_b16 a[146:147], v242 offset:4352
    ds_read_b64_tr_b16 a[148:149], v242 offset:4104
    ds_read_b64_tr_b16 a[150:151], v242 offset:4360
    ds_read_b64_tr_b16 a[152:153], v242 offset:6144
    ds_read_b64_tr_b16 a[154:155], v242 offset:6400
    ds_read_b64_tr_b16 a[156:157], v242 offset:6152
    ds_read_b64_tr_b16 a[158:159], v242 offset:6408
    ds_read_b64_tr_b16 a[160:161], v242 offset:8192
    ds_read_b64_tr_b16 a[162:163], v242 offset:8448
    ds_read_b64_tr_b16 a[164:165], v242 offset:8200
    ds_read_b64_tr_b16 a[166:167], v242 offset:8456
    ds_read_b64_tr_b16 a[168:169], v242 offset:10240
    ds_read_b64_tr_b16 a[170:171], v242 offset:10496
    ds_read_b64_tr_b16 a[172:173], v242 offset:10248
    ds_read_b64_tr_b16 a[174:175], v242 offset:10504
    ds_read_b64_tr_b16 a[176:177], v242 offset:12288
    ds_read_b64_tr_b16 a[178:179], v242 offset:12544
    ds_read_b64_tr_b16 a[180:181], v242 offset:12296
    ds_read_b64_tr_b16 a[182:183], v242 offset:12552
    ds_read_b64_tr_b16 a[184:185], v242 offset:14336
    ds_read_b64_tr_b16 a[186:187], v242 offset:14592
    ds_read_b64_tr_b16 a[188:189], v242 offset:14344
    ds_read_b64_tr_b16 a[190:191], v242 offset:14600
    s_waitcnt lgkmcnt(0)
    s_barrier
    s_add_u32 m0, s6, 0
    s_nop 0
    buffer_load_dwordx4 v16, s[12:15], s29 offen offset:0 lds
    buffer_load_dwordx4 v16, s[12:15], s29 offen offset:1024 lds
    buffer_load_dwordx4 v17, s[12:15], s29 offen offset:2048 lds
    buffer_load_dwordx4 v17, s[12:15], s29 offen offset:3072 lds
    s_add_u32 m0, s6, 4096
    s_nop 0
    buffer_load_dwordx4 v18, s[12:15], s29 offen offset:0 lds
    buffer_load_dwordx4 v18, s[12:15], s29 offen offset:1024 lds
    buffer_load_dwordx4 v19, s[12:15], s29 offen offset:2048 lds
    buffer_load_dwordx4 v19, s[12:15], s29 offen offset:3072 lds
    s_add_u32 m0, s6, 8192
    s_nop 0
    buffer_load_dwordx4 v20, s[12:15], s29 offen offset:0 lds
    buffer_load_dwordx4 v20, s[12:15], s29 offen offset:1024 lds
    buffer_load_dwordx4 v21, s[12:15], s29 offen offset:2048 lds
    buffer_load_dwordx4 v21, s[12:15], s29 offen offset:3072 lds
    s_add_u32 m0, s6, 12288
    s_nop 0
    buffer_load_dwordx4 v22, s[12:15], s29 offen offset:0 lds
    buffer_load_dwordx4 v22, s[12:15], s29 offen offset:1024 lds
    buffer_load_dwordx4 v23, s[12:15], s29 offen offset:2048 lds
    buffer_load_dwordx4 v23, s[12:15], s29 offen offset:3072 lds
    s_waitcnt vmcnt(16)
    ds_read_b64_tr_b16 a[192:193], v243 offset:0
    ds_read_b64_tr_b16 a[194:195], v243 offset:256
    ds_read_b64_tr_b16 a[196:197], v243 offset:8
    ds_read_b64_tr_b16 a[198:199], v243 offset:264
    ds_read_b64_tr_b16 a[200:201], v243 offset:2048
    ds_read_b64_tr_b16 a[202:203], v243 offset:2304
    ds_read_b64_tr_b16 a[204:205], v243 offset:2056
    ds_read_b64_tr_b16 a[206:207], v243 offset:2312
    ds_read_b64_tr_b16 a[208:209], v243 offset:4096
    ds_read_b64_tr_b16 a[210:211], v243 offset:4352
    ds_read_b64_tr_b16 a[212:213], v243 offset:4104
    ds_read_b64_tr_b16 a[214:215], v243 offset:4360
    ds_read_b64_tr_b16 a[216:217], v243 offset:6144
    ds_read_b64_tr_b16 a[218:219], v243 offset:6400
    ds_read_b64_tr_b16 a[220:221], v243 offset:6152
    ds_read_b64_tr_b16 a[222:223], v243 offset:6408
    ds_read_b64_tr_b16 a[224:225], v243 offset:8192
    ds_read_b64_tr_b16 a[226:227], v243 offset:8448
    ds_read_b64_tr_b16 a[228:229], v243 offset:8200
    ds_read_b64_tr_b16 a[230:231], v243 offset:8456
    ds_read_b64_tr_b16 a[232:233], v243 offset:10240
    ds_read_b64_tr_b16 a[234:235], v243 offset:10496
    ds_read_b64_tr_b16 a[236:237], v243 offset:10248
    ds_read_b64_tr_b16 a[238:239], v243 offset:10504
    ds_read_b64_tr_b16 a[240:241], v243 offset:12288
    ds_read_b64_tr_b16 a[242:243], v243 offset:12544
    ds_read_b64_tr_b16 a[244:245], v243 offset:12296
    ds_read_b64_tr_b16 a[246:247], v243 offset:12552
    ds_read_b64_tr_b16 a[248:249], v243 offset:14336
    ds_read_b64_tr_b16 a[250:251], v243 offset:14592
    ds_read_b64_tr_b16 a[252:253], v243 offset:14344
    ds_read_b64_tr_b16 a[254:255], v243 offset:14600
    s_waitcnt lgkmcnt(0)
    s_waitcnt vmcnt(0)
    s_barrier
    s_mov_b32 s29, 0x10000
    ds_read_b128 v[64:67], v8 offset:0
    ds_read_b128 v[68:71], v8 offset:32768
    ds_read_b128 v[72:75], v9 offset:0
    ds_read_b128 v[76:79], v9 offset:32768
    ds_read_b128 v[80:83], v10 offset:0
    ds_read_b128 v[84:87], v10 offset:32768
    ds_read_b128 v[88:91], v11 offset:0
    ds_read_b128 v[92:95], v11 offset:32768
    ds_read_b128 v[96:99], v8 offset:256
    ds_read_b128 v[100:103], v8 offset:33024
    ds_read_b128 v[104:107], v9 offset:256
    ds_read_b128 v[108:111], v9 offset:33024
    ds_read_b128 v[112:115], v10 offset:256
    ds_read_b128 v[116:119], v10 offset:33024
    ds_read_b128 v[120:123], v11 offset:256
    ds_read_b128 v[124:127], v11 offset:33024
    s_add_u32 m0, s6, 65536
    s_nop 0
    buffer_load_dwordx4 v16, s[12:15], s29 offen offset:0 lds
    buffer_load_dwordx4 v16, s[12:15], s29 offen offset:1024 lds
    buffer_load_dwordx4 v17, s[12:15], s29 offen offset:2048 lds
    buffer_load_dwordx4 v17, s[12:15], s29 offen offset:3072 lds
    s_add_u32 m0, s6, 69632
    s_nop 0
    buffer_load_dwordx4 v18, s[12:15], s29 offen offset:0 lds
    buffer_load_dwordx4 v18, s[12:15], s29 offen offset:1024 lds
    s_cmp_eq_u32 s98, 0
    s_cbranch_scc1 .qa_203
    s_cmp_eq_u32 s98, 2
    s_cbranch_scc1 .vt_204
.p2align 6
.ql_206:
    s_waitcnt lgkmcnt(12)
    v_mfma_f32_16x16x32_bf16 v[192:195], a[0:3], v[64:67], 0
    ds_read_b128 v[128:131], v8 offset:512
    v_mfma_f32_16x16x32_bf16 v[196:199], a[4:7], v[64:67], 0
    v_mfma_f32_16x16x32_bf16 v[200:203], a[0:3], v[68:71], 0
    ds_read_b128 v[132:135], v8 offset:33280
    v_mfma_f32_16x16x32_bf16 v[204:207], a[4:7], v[68:71], 0
    buffer_load_dwordx4 v19, s[12:15], s29 offen offset:2048 lds
    v_mfma_f32_16x16x32_bf16 v[192:195], a[8:11], v[72:75], v[192:195]
    ds_read_b128 v[136:139], v9 offset:512
    v_mfma_f32_16x16x32_bf16 v[196:199], a[12:15], v[72:75], v[196:199]
    v_cvt_pk_bf16_f32 v224, v208, v209
    v_cvt_pk_bf16_f32 v225, v210, v211
    v_mfma_f32_16x16x32_bf16 v[200:203], a[8:11], v[76:79], v[200:203]
    ds_read_b128 v[140:143], v9 offset:33280
    v_mfma_f32_16x16x32_bf16 v[204:207], a[12:15], v[76:79], v[204:207]
    buffer_load_dwordx4 v19, s[12:15], s29 offen offset:3072 lds
    s_waitcnt lgkmcnt(12)
    v_mfma_f32_16x16x32_bf16 v[192:195], a[16:19], v[80:83], v[192:195]
    ds_read_b128 v[144:147], v10 offset:512
    v_mfma_f32_16x16x32_bf16 v[196:199], a[20:23], v[80:83], v[196:199]
    s_add_u32 m0, s6, 73728
    v_cvt_pk_bf16_f32 v226, v212, v213
    v_cvt_pk_bf16_f32 v227, v214, v215
    v_mfma_f32_16x16x32_bf16 v[200:203], a[16:19], v[84:87], v[200:203]
    ds_read_b128 v[148:151], v10 offset:33280
    v_mfma_f32_16x16x32_bf16 v[204:207], a[20:23], v[84:87], v[204:207]
    buffer_load_dwordx4 v20, s[12:15], s29 offen offset:0 lds
    v_mfma_f32_16x16x32_bf16 v[192:195], a[24:27], v[88:91], v[192:195]
    ds_read_b128 v[152:155], v11 offset:512
    v_cvt_pk_bf16_f32 v228, v216, v217
    v_mfma_f32_16x16x32_bf16 v[196:199], a[28:31], v[88:91], v[196:199]
    buffer_store_dwordx4 v[224:227], v24, s[8:11], s30 offen sc1
    v_mfma_f32_16x16x32_bf16 v[200:203], a[24:27], v[92:95], v[200:203]
    ds_read_b128 v[156:159], v11 offset:33280
    v_cvt_pk_bf16_f32 v229, v218, v219
    v_mfma_f32_16x16x32_bf16 v[204:207], a[28:31], v[92:95], v[204:207]
    buffer_load_dwordx4 v20, s[12:15], s29 offen offset:1024 lds
    s_waitcnt lgkmcnt(12)
    v_mfma_f32_16x16x32_bf16 v[192:195], a[32:35], v[96:99], v[192:195]
    ds_read_b128 v[160:163], v8 offset:768
    v_mfma_f32_16x16x32_bf16 v[196:199], a[36:39], v[96:99], v[196:199]
    v_cvt_pk_bf16_f32 v230, v220, v221
    v_cvt_pk_bf16_f32 v231, v222, v223
    v_mfma_f32_16x16x32_bf16 v[200:203], a[32:35], v[100:103], v[200:203]
    ds_read_b128 v[164:167], v8 offset:33536
    v_mfma_f32_16x16x32_bf16 v[204:207], a[36:39], v[100:103], v[204:207]
    buffer_load_dwordx4 v21, s[12:15], s29 offen offset:2048 lds
    v_mfma_f32_16x16x32_bf16 v[192:195], a[40:43], v[104:107], v[192:195]
    ds_read_b128 v[168:171], v9 offset:768
    v_mfma_f32_16x16x32_bf16 v[196:199], a[44:47], v[104:107], v[196:199]
    buffer_store_dwordx4 v[228:231], v25, s[8:11], s30 offen sc1
    v_mfma_f32_16x16x32_bf16 v[200:203], a[40:43], v[108:111], v[200:203]
    ds_read_b128 v[172:175], v9 offset:33536
    v_mfma_f32_16x16x32_bf16 v[204:207], a[44:47], v[108:111], v[204:207]
    buffer_load_dwordx4 v21, s[12:15], s29 offen offset:3072 lds
    s_waitcnt lgkmcnt(12)
    v_mfma_f32_16x16x32_bf16 v[192:195], a[48:51], v[112:115], v[192:195]
    ds_read_b128 v[176:179], v10 offset:768
    v_mfma_f32_16x16x32_bf16 v[196:199], a[52:55], v[112:115], v[196:199]
    s_add_u32 m0, s6, 77824
    s_mov_b32 s30, s31
    v_mfma_f32_16x16x32_bf16 v[200:203], a[48:51], v[116:119], v[200:203]
    ds_read_b128 v[180:183], v10 offset:33536
    v_mfma_f32_16x16x32_bf16 v[204:207], a[52:55], v[116:119], v[204:207]
    buffer_load_dwordx4 v22, s[12:15], s29 offen offset:0 lds
    v_mfma_f32_16x16x32_bf16 v[192:195], a[56:59], v[120:123], v[192:195]
    ds_read_b128 v[184:187], v11 offset:768
    v_mfma_f32_16x16x32_bf16 v[196:199], a[60:63], v[120:123], v[196:199]
    s_add_u32 s31, s31, 262144
    v_mfma_f32_16x16x32_bf16 v[200:203], a[56:59], v[124:127], v[200:203]
    ds_read_b128 v[188:191], v11 offset:33536
    v_mfma_f32_16x16x32_bf16 v[204:207], a[60:63], v[124:127], v[204:207]
    buffer_load_dwordx4 v22, s[12:15], s29 offen offset:1024 lds
    s_waitcnt lgkmcnt(12)
    v_mfma_f32_16x16x32_bf16 v[192:195], a[64:67], v[128:131], v[192:195]
    ds_read_b128 v[64:67], v8 offset:1024
    v_mfma_f32_16x16x32_bf16 v[196:199], a[68:71], v[128:131], v[196:199]
    v_mfma_f32_16x16x32_bf16 v[200:203], a[64:67], v[132:135], v[200:203]
    ds_read_b128 v[68:71], v8 offset:33792
    v_mfma_f32_16x16x32_bf16 v[204:207], a[68:71], v[132:135], v[204:207]
    buffer_load_dwordx4 v23, s[12:15], s29 offen offset:2048 lds
    v_mfma_f32_16x16x32_bf16 v[192:195], a[72:75], v[136:139], v[192:195]
    ds_read_b128 v[72:75], v9 offset:1024
    v_mfma_f32_16x16x32_bf16 v[196:199], a[76:79], v[136:139], v[196:199]
    v_mfma_f32_16x16x32_bf16 v[200:203], a[72:75], v[140:143], v[200:203]
    ds_read_b128 v[76:79], v9 offset:33792
    v_mfma_f32_16x16x32_bf16 v[204:207], a[76:79], v[140:143], v[204:207]
    buffer_load_dwordx4 v23, s[12:15], s29 offen offset:3072 lds
    s_waitcnt lgkmcnt(12)
    v_mfma_f32_16x16x32_bf16 v[192:195], a[80:83], v[144:147], v[192:195]
    ds_read_b128 v[80:83], v10 offset:1024
    v_mfma_f32_16x16x32_bf16 v[196:199], a[84:87], v[144:147], v[196:199]
    v_mfma_f32_16x16x32_bf16 v[200:203], a[80:83], v[148:151], v[200:203]
    ds_read_b128 v[84:87], v10 offset:33792
    v_mfma_f32_16x16x32_bf16 v[204:207], a[84:87], v[148:151], v[204:207]
    buffer_load_dword v29, v28, s[12:15], s29 offen
    v_mfma_f32_16x16x32_bf16 v[192:195], a[88:91], v[152:155], v[192:195]
    ds_read_b128 v[88:91], v11 offset:1024
    v_mfma_f32_16x16x32_bf16 v[196:199], a[92:95], v[152:155], v[196:199]
    v_mfma_f32_16x16x32_bf16 v[200:203], a[88:91], v[156:159], v[200:203]
    ds_read_b128 v[92:95], v11 offset:33792
    v_mfma_f32_16x16x32_bf16 v[204:207], a[92:95], v[156:159], v[204:207]
    s_waitcnt lgkmcnt(12)
    v_mfma_f32_16x16x32_bf16 v[192:195], a[96:99], v[160:163], v[192:195]
    ds_read_b128 v[96:99], v8 offset:1280
    v_mfma_f32_16x16x32_bf16 v[196:199], a[100:103], v[160:163], v[196:199]
    v_mfma_f32_16x16x32_bf16 v[200:203], a[96:99], v[164:167], v[200:203]
    ds_read_b128 v[100:103], v8 offset:34048
    v_mfma_f32_16x16x32_bf16 v[204:207], a[100:103], v[164:167], v[204:207]
    v_mfma_f32_16x16x32_bf16 v[192:195], a[104:107], v[168:171], v[192:195]
    ds_read_b128 v[104:107], v9 offset:1280
    v_mfma_f32_16x16x32_bf16 v[196:199], a[108:111], v[168:171], v[196:199]
    v_mfma_f32_16x16x32_bf16 v[200:203], a[104:107], v[172:175], v[200:203]
    ds_read_b128 v[108:111], v9 offset:34048
    v_mfma_f32_16x16x32_bf16 v[204:207], a[108:111], v[172:175], v[204:207]
    s_waitcnt lgkmcnt(12)
    v_mfma_f32_16x16x32_bf16 v[192:195], a[112:115], v[176:179], v[192:195]
    ds_read_b128 v[112:115], v10 offset:1280
    v_mfma_f32_16x16x32_bf16 v[196:199], a[116:119], v[176:179], v[196:199]
    v_mfma_f32_16x16x32_bf16 v[200:203], a[112:115], v[180:183], v[200:203]
    ds_read_b128 v[116:119], v10 offset:34048
    v_mfma_f32_16x16x32_bf16 v[204:207], a[116:119], v[180:183], v[204:207]
    v_mfma_f32_16x16x32_bf16 v[192:195], a[120:123], v[184:187], v[192:195]
    ds_read_b128 v[120:123], v11 offset:1280
    v_mfma_f32_16x16x32_bf16 v[196:199], a[124:127], v[184:187], v[196:199]
    v_mfma_f32_16x16x32_bf16 v[200:203], a[120:123], v[188:191], v[200:203]
    ds_read_b128 v[124:127], v11 offset:34048
    v_mfma_f32_16x16x32_bf16 v[204:207], a[124:127], v[188:191], v[204:207]
    s_waitcnt lgkmcnt(12)
    v_mfma_f32_16x16x32_bf16 v[192:195], a[128:131], v[64:67], v[192:195]
    ds_read_b128 v[128:131], v8 offset:1536
    v_mfma_f32_16x16x32_bf16 v[196:199], a[132:135], v[64:67], v[196:199]
    v_mfma_f32_16x16x32_bf16 v[200:203], a[128:131], v[68:71], v[200:203]
    ds_read_b128 v[132:135], v8 offset:34304
    v_mfma_f32_16x16x32_bf16 v[204:207], a[132:135], v[68:71], v[204:207]
    v_mfma_f32_16x16x32_bf16 v[192:195], a[136:139], v[72:75], v[192:195]
    ds_read_b128 v[136:139], v9 offset:1536
    v_mfma_f32_16x16x32_bf16 v[196:199], a[140:143], v[72:75], v[196:199]
    v_mfma_f32_16x16x32_bf16 v[200:203], a[136:139], v[76:79], v[200:203]
    ds_read_b128 v[140:143], v9 offset:34304
    v_mfma_f32_16x16x32_bf16 v[204:207], a[140:143], v[76:79], v[204:207]
    s_waitcnt lgkmcnt(12)
    v_mfma_f32_16x16x32_bf16 v[192:195], a[144:147], v[80:83], v[192:195]
    ds_read_b128 v[144:147], v10 offset:1536
    v_mfma_f32_16x16x32_bf16 v[196:199], a[148:151], v[80:83], v[196:199]
    v_mfma_f32_16x16x32_bf16 v[200:203], a[144:147], v[84:87], v[200:203]
    ds_read_b128 v[148:151], v10 offset:34304
    v_mfma_f32_16x16x32_bf16 v[204:207], a[148:151], v[84:87], v[204:207]
    v_mfma_f32_16x16x32_bf16 v[192:195], a[152:155], v[88:91], v[192:195]
    ds_read_b128 v[152:155], v11 offset:1536
    v_mfma_f32_16x16x32_bf16 v[196:199], a[156:159], v[88:91], v[196:199]
    v_mfma_f32_16x16x32_bf16 v[200:203], a[152:155], v[92:95], v[200:203]
    ds_read_b128 v[156:159], v11 offset:34304
    v_mfma_f32_16x16x32_bf16 v[204:207], a[156:159], v[92:95], v[204:207]
    s_waitcnt lgkmcnt(12)
    v_mfma_f32_16x16x32_bf16 v[192:195], a[160:163], v[96:99], v[192:195]
    ds_read_b128 v[160:163], v8 offset:1792
    v_mfma_f32_16x16x32_bf16 v[196:199], a[164:167], v[96:99], v[196:199]
    v_mfma_f32_16x16x32_bf16 v[200:203], a[160:163], v[100:103], v[200:203]
    ds_read_b128 v[164:167], v8 offset:34560
    v_mfma_f32_16x16x32_bf16 v[204:207], a[164:167], v[100:103], v[204:207]
    v_mfma_f32_16x16x32_bf16 v[192:195], a[168:171], v[104:107], v[192:195]
    ds_read_b128 v[168:171], v9 offset:1792
    v_mfma_f32_16x16x32_bf16 v[196:199], a[172:175], v[104:107], v[196:199]
    v_mfma_f32_16x16x32_bf16 v[200:203], a[168:171], v[108:111], v[200:203]
    ds_read_b128 v[172:175], v9 offset:34560
    v_mfma_f32_16x16x32_bf16 v[204:207], a[172:175], v[108:111], v[204:207]
    s_waitcnt lgkmcnt(12)
    v_mfma_f32_16x16x32_bf16 v[192:195], a[176:179], v[112:115], v[192:195]
    ds_read_b128 v[176:179], v10 offset:1792
    v_mfma_f32_16x16x32_bf16 v[196:199], a[180:183], v[112:115], v[196:199]
    s_waitcnt vmcnt(6)
    v_mov_b32 v27, s28
    s_mov_b64 exec, 1
    buffer_store_dword v27, v26, s[8:11], s94 offen sc1
    s_mov_b64 exec, -1
    v_mfma_f32_16x16x32_bf16 v[200:203], a[176:179], v[116:119], v[200:203]
    ds_read_b128 v[180:183], v10 offset:34560
    v_mfma_f32_16x16x32_bf16 v[204:207], a[180:183], v[116:119], v[204:207]
    v_mfma_f32_16x16x32_bf16 v[192:195], a[184:187], v[120:123], v[192:195]
    ds_read_b128 v[184:187], v11 offset:1792
    v_mfma_f32_16x16x32_bf16 v[196:199], a[188:191], v[120:123], v[196:199]
    s_add_u32 s28, s28, 1
    v_mfma_f32_16x16x32_bf16 v[200:203], a[184:187], v[124:127], v[200:203]
    ds_read_b128 v[188:191], v11 offset:34560
    v_mfma_f32_16x16x32_bf16 v[204:207], a[188:191], v[124:127], v[204:207]
    s_waitcnt lgkmcnt(12)
    v_mfma_f32_16x16x32_bf16 v[192:195], a[192:195], v[128:131], v[192:195]
    v_mfma_f32_16x16x32_bf16 v[196:199], a[196:199], v[128:131], v[196:199]
    v_mfma_f32_16x16x32_bf16 v[200:203], a[192:195], v[132:135], v[200:203]
    v_mfma_f32_16x16x32_bf16 v[204:207], a[196:199], v[132:135], v[204:207]
    v_mfma_f32_16x16x32_bf16 v[192:195], a[200:203], v[136:139], v[192:195]
    v_mfma_f32_16x16x32_bf16 v[196:199], a[204:207], v[136:139], v[196:199]
    s_add_u32 s29, s29, 0x10000
    s_min_u32 s29, s29, 0x3f0000
    v_mfma_f32_16x16x32_bf16 v[200:203], a[200:203], v[140:143], v[200:203]
    v_mfma_f32_16x16x32_bf16 v[204:207], a[204:207], v[140:143], v[204:207]
    s_waitcnt vmcnt(2) lgkmcnt(0)
    s_barrier
    v_mfma_f32_16x16x32_bf16 v[192:195], a[208:211], v[144:147], v[192:195]
    ds_read_b128 v[64:67], v12 offset:0
    ds_read_b128 v[68:71], v12 offset:32768
    v_mfma_f32_16x16x32_bf16 v[196:199], a[212:215], v[144:147], v[196:199]
    s_add_u32 m0, s6, 0
    v_mfma_f32_16x16x32_bf16 v[200:203], a[208:211], v[148:151], v[200:203]
    ds_read_b128 v[72:75], v13 offset:0
    ds_read_b128 v[76:79], v13 offset:32768
    v_mfma_f32_16x16x32_bf16 v[204:207], a[212:215], v[148:151], v[204:207]
    buffer_load_dwordx4 v16, s[12:15], s29 offen offset:0 lds
    v_mfma_f32_16x16x32_bf16 v[192:195], a[216:219], v[152:155], v[192:195]
    ds_read_b128 v[80:83], v14 offset:0
    ds_read_b128 v[84:87], v14 offset:32768
    v_mfma_f32_16x16x32_bf16 v[196:199], a[220:223], v[152:155], v[196:199]
    v_mfma_f32_16x16x32_bf16 v[200:203], a[216:219], v[156:159], v[200:203]
    ds_read_b128 v[88:91], v15 offset:0
    ds_read_b128 v[92:95], v15 offset:32768
    v_mfma_f32_16x16x32_bf16 v[204:207], a[220:223], v[156:159], v[204:207]
    buffer_load_dwordx4 v16, s[12:15], s29 offen offset:1024 lds
    v_mfma_f32_16x16x32_bf16 v[192:195], a[224:227], v[160:163], v[192:195]
    ds_read_b128 v[96:99], v12 offset:256
    v_mfma_f32_16x16x32_bf16 v[196:199], a[228:231], v[160:163], v[196:199]
    v_mfma_f32_16x16x32_bf16 v[200:203], a[224:227], v[164:167], v[200:203]
    ds_read_b128 v[100:103], v12 offset:33024
    v_mfma_f32_16x16x32_bf16 v[204:207], a[228:231], v[164:167], v[204:207]
    buffer_load_dwordx4 v17, s[12:15], s29 offen offset:2048 lds
    v_mfma_f32_16x16x32_bf16 v[192:195], a[232:235], v[168:171], v[192:195]
    ds_read_b128 v[104:107], v13 offset:256
    v_mfma_f32_16x16x32_bf16 v[196:199], a[236:239], v[168:171], v[196:199]
    v_mfma_f32_16x16x32_bf16 v[200:203], a[232:235], v[172:175], v[200:203]
    ds_read_b128 v[108:111], v13 offset:33024
    v_mfma_f32_16x16x32_bf16 v[204:207], a[236:239], v[172:175], v[204:207]
    buffer_load_dwordx4 v17, s[12:15], s29 offen offset:3072 lds
    v_mfma_f32_16x16x32_bf16 v[192:195], a[240:243], v[176:179], v[192:195]
    ds_read_b128 v[112:115], v14 offset:256
    v_mfma_f32_16x16x32_bf16 v[196:199], a[244:247], v[176:179], v[196:199]
    s_add_u32 m0, s6, 4096
    v_mfma_f32_16x16x32_bf16 v[200:203], a[240:243], v[180:183], v[200:203]
    ds_read_b128 v[116:119], v14 offset:33024
    v_mfma_f32_16x16x32_bf16 v[204:207], a[244:247], v[180:183], v[204:207]
    buffer_load_dwordx4 v18, s[12:15], s29 offen offset:0 lds
    v_mfma_f32_16x16x32_bf16 v[192:195], a[248:251], v[184:187], v[192:195]
    ds_read_b128 v[120:123], v15 offset:256
    v_mfma_f32_16x16x32_bf16 v[196:199], a[252:255], v[184:187], v[196:199]
    v_mfma_f32_16x16x32_bf16 v[200:203], a[248:251], v[188:191], v[200:203]
    ds_read_b128 v[124:127], v15 offset:33024
    v_mfma_f32_16x16x32_bf16 v[204:207], a[252:255], v[188:191], v[204:207]
    buffer_load_dwordx4 v18, s[12:15], s29 offen offset:1024 lds
    s_waitcnt lgkmcnt(12)
    v_mfma_f32_16x16x32_bf16 v[208:211], a[0:3], v[64:67], 0
    ds_read_b128 v[128:131], v12 offset:512
    v_mfma_f32_16x16x32_bf16 v[212:215], a[4:7], v[64:67], 0
    v_mfma_f32_16x16x32_bf16 v[216:219], a[0:3], v[68:71], 0
    ds_read_b128 v[132:135], v12 offset:33280
    v_mfma_f32_16x16x32_bf16 v[220:223], a[4:7], v[68:71], 0
    buffer_load_dwordx4 v19, s[12:15], s29 offen offset:2048 lds
    v_mfma_f32_16x16x32_bf16 v[208:211], a[8:11], v[72:75], v[208:211]
    ds_read_b128 v[136:139], v13 offset:512
    v_mfma_f32_16x16x32_bf16 v[212:215], a[12:15], v[72:75], v[212:215]
    v_cvt_pk_bf16_f32 v224, v192, v193
    v_cvt_pk_bf16_f32 v225, v194, v195
    v_mfma_f32_16x16x32_bf16 v[216:219], a[8:11], v[76:79], v[216:219]
    ds_read_b128 v[140:143], v13 offset:33280
    v_mfma_f32_16x16x32_bf16 v[220:223], a[12:15], v[76:79], v[220:223]
    buffer_load_dwordx4 v19, s[12:15], s29 offen offset:3072 lds
    s_waitcnt lgkmcnt(12)
    v_mfma_f32_16x16x32_bf16 v[208:211], a[16:19], v[80:83], v[208:211]
    ds_read_b128 v[144:147], v14 offset:512
    v_mfma_f32_16x16x32_bf16 v[212:215], a[20:23], v[80:83], v[212:215]
    s_add_u32 m0, s6, 8192
    v_cvt_pk_bf16_f32 v226, v196, v197
    v_cvt_pk_bf16_f32 v227, v198, v199
    v_mfma_f32_16x16x32_bf16 v[216:219], a[16:19], v[84:87], v[216:219]
    ds_read_b128 v[148:151], v14 offset:33280
    v_mfma_f32_16x16x32_bf16 v[220:223], a[20:23], v[84:87], v[220:223]
    buffer_load_dwordx4 v20, s[12:15], s29 offen offset:0 lds
    v_mfma_f32_16x16x32_bf16 v[208:211], a[24:27], v[88:91], v[208:211]
    ds_read_b128 v[152:155], v15 offset:512
    v_cvt_pk_bf16_f32 v228, v200, v201
    v_mfma_f32_16x16x32_bf16 v[212:215], a[28:31], v[88:91], v[212:215]
    buffer_store_dwordx4 v[224:227], v24, s[8:11], s30 offen sc1
    v_mfma_f32_16x16x32_bf16 v[216:219], a[24:27], v[92:95], v[216:219]
    ds_read_b128 v[156:159], v15 offset:33280
    v_cvt_pk_bf16_f32 v229, v202, v203
    v_mfma_f32_16x16x32_bf16 v[220:223], a[28:31], v[92:95], v[220:223]
    buffer_load_dwordx4 v20, s[12:15], s29 offen offset:1024 lds
    s_waitcnt lgkmcnt(12)
    v_mfma_f32_16x16x32_bf16 v[208:211], a[32:35], v[96:99], v[208:211]
    ds_read_b128 v[160:163], v12 offset:768
    v_mfma_f32_16x16x32_bf16 v[212:215], a[36:39], v[96:99], v[212:215]
    v_cvt_pk_bf16_f32 v230, v204, v205
    v_cvt_pk_bf16_f32 v231, v206, v207
    v_mfma_f32_16x16x32_bf16 v[216:219], a[32:35], v[100:103], v[216:219]
    ds_read_b128 v[164:167], v12 offset:33536
    v_mfma_f32_16x16x32_bf16 v[220:223], a[36:39], v[100:103], v[220:223]
    buffer_load_dwordx4 v21, s[12:15], s29 offen offset:2048 lds
    v_mfma_f32_16x16x32_bf16 v[208:211], a[40:43], v[104:107], v[208:211]
    ds_read_b128 v[168:171], v13 offset:768
    v_mfma_f32_16x16x32_bf16 v[212:215], a[44:47], v[104:107], v[212:215]
    buffer_store_dwordx4 v[228:231], v25, s[8:11], s30 offen sc1
    v_mfma_f32_16x16x32_bf16 v[216:219], a[40:43], v[108:111], v[216:219]
    ds_read_b128 v[172:175], v13 offset:33536
    v_mfma_f32_16x16x32_bf16 v[220:223], a[44:47], v[108:111], v[220:223]
    buffer_load_dwordx4 v21, s[12:15], s29 offen offset:3072 lds
    s_waitcnt lgkmcnt(12)
    v_mfma_f32_16x16x32_bf16 v[208:211], a[48:51], v[112:115], v[208:211]
    ds_read_b128 v[176:179], v14 offset:768
    v_mfma_f32_16x16x32_bf16 v[212:215], a[52:55], v[112:115], v[212:215]
    s_add_u32 m0, s6, 12288
    s_mov_b32 s30, s31
    v_mfma_f32_16x16x32_bf16 v[216:219], a[48:51], v[116:119], v[216:219]
    ds_read_b128 v[180:183], v14 offset:33536
    v_mfma_f32_16x16x32_bf16 v[220:223], a[52:55], v[116:119], v[220:223]
    buffer_load_dwordx4 v22, s[12:15], s29 offen offset:0 lds
    v_mfma_f32_16x16x32_bf16 v[208:211], a[56:59], v[120:123], v[208:211]
    ds_read_b128 v[184:187], v15 offset:768
    v_mfma_f32_16x16x32_bf16 v[212:215], a[60:63], v[120:123], v[212:215]
    s_add_u32 s31, s31, 262144
    v_mfma_f32_16x16x32_bf16 v[216:219], a[56:59], v[124:127], v[216:219]
    ds_read_b128 v[188:191], v15 offset:33536
    v_mfma_f32_16x16x32_bf16 v[220:223], a[60:63], v[124:127], v[220:223]
    buffer_load_dwordx4 v22, s[12:15], s29 offen offset:1024 lds
    s_waitcnt lgkmcnt(12)
    v_mfma_f32_16x16x32_bf16 v[208:211], a[64:67], v[128:131], v[208:211]
    ds_read_b128 v[64:67], v12 offset:1024
    v_mfma_f32_16x16x32_bf16 v[212:215], a[68:71], v[128:131], v[212:215]
    v_mfma_f32_16x16x32_bf16 v[216:219], a[64:67], v[132:135], v[216:219]
    ds_read_b128 v[68:71], v12 offset:33792
    v_mfma_f32_16x16x32_bf16 v[220:223], a[68:71], v[132:135], v[220:223]
    buffer_load_dwordx4 v23, s[12:15], s29 offen offset:2048 lds
    v_mfma_f32_16x16x32_bf16 v[208:211], a[72:75], v[136:139], v[208:211]
    ds_read_b128 v[72:75], v13 offset:1024
    v_mfma_f32_16x16x32_bf16 v[212:215], a[76:79], v[136:139], v[212:215]
    v_mfma_f32_16x16x32_bf16 v[216:219], a[72:75], v[140:143], v[216:219]
    ds_read_b128 v[76:79], v13 offset:33792
    v_mfma_f32_16x16x32_bf16 v[220:223], a[76:79], v[140:143], v[220:223]
    buffer_load_dwordx4 v23, s[12:15], s29 offen offset:3072 lds
    s_waitcnt lgkmcnt(12)
    v_mfma_f32_16x16x32_bf16 v[208:211], a[80:83], v[144:147], v[208:211]
    ds_read_b128 v[80:83], v14 offset:1024
    v_mfma_f32_16x16x32_bf16 v[212:215], a[84:87], v[144:147], v[212:215]
    v_mfma_f32_16x16x32_bf16 v[216:219], a[80:83], v[148:151], v[216:219]
    ds_read_b128 v[84:87], v14 offset:33792
    v_mfma_f32_16x16x32_bf16 v[220:223], a[84:87], v[148:151], v[220:223]
    buffer_load_dword v29, v28, s[12:15], s29 offen
    v_mfma_f32_16x16x32_bf16 v[208:211], a[88:91], v[152:155], v[208:211]
    ds_read_b128 v[88:91], v15 offset:1024
    v_mfma_f32_16x16x32_bf16 v[212:215], a[92:95], v[152:155], v[212:215]
    v_mfma_f32_16x16x32_bf16 v[216:219], a[88:91], v[156:159], v[216:219]
    ds_read_b128 v[92:95], v15 offset:33792
    v_mfma_f32_16x16x32_bf16 v[220:223], a[92:95], v[156:159], v[220:223]
    s_waitcnt lgkmcnt(12)
    v_mfma_f32_16x16x32_bf16 v[208:211], a[96:99], v[160:163], v[208:211]
    ds_read_b128 v[96:99], v12 offset:1280
    v_mfma_f32_16x16x32_bf16 v[212:215], a[100:103], v[160:163], v[212:215]
    v_mfma_f32_16x16x32_bf16 v[216:219], a[96:99], v[164:167], v[216:219]
    ds_read_b128 v[100:103], v12 offset:34048
    v_mfma_f32_16x16x32_bf16 v[220:223], a[100:103], v[164:167], v[220:223]
    v_mfma_f32_16x16x32_bf16 v[208:211], a[104:107], v[168:171], v[208:211]
    ds_read_b128 v[104:107], v13 offset:1280
    v_mfma_f32_16x16x32_bf16 v[212:215], a[108:111], v[168:171], v[212:215]
    v_mfma_f32_16x16x32_bf16 v[216:219], a[104:107], v[172:175], v[216:219]
    ds_read_b128 v[108:111], v13 offset:34048
    v_mfma_f32_16x16x32_bf16 v[220:223], a[108:111], v[172:175], v[220:223]
    s_waitcnt lgkmcnt(12)
    v_mfma_f32_16x16x32_bf16 v[208:211], a[112:115], v[176:179], v[208:211]
    ds_read_b128 v[112:115], v14 offset:1280
    v_mfma_f32_16x16x32_bf16 v[212:215], a[116:119], v[176:179], v[212:215]
    v_mfma_f32_16x16x32_bf16 v[216:219], a[112:115], v[180:183], v[216:219]
    ds_read_b128 v[116:119], v14 offset:34048
    v_mfma_f32_16x16x32_bf16 v[220:223], a[116:119], v[180:183], v[220:223]
    v_mfma_f32_16x16x32_bf16 v[208:211], a[120:123], v[184:187], v[208:211]
    ds_read_b128 v[120:123], v15 offset:1280
    v_mfma_f32_16x16x32_bf16 v[212:215], a[124:127], v[184:187], v[212:215]
    v_mfma_f32_16x16x32_bf16 v[216:219], a[120:123], v[188:191], v[216:219]
    ds_read_b128 v[124:127], v15 offset:34048
    v_mfma_f32_16x16x32_bf16 v[220:223], a[124:127], v[188:191], v[220:223]
    s_waitcnt lgkmcnt(12)
    v_mfma_f32_16x16x32_bf16 v[208:211], a[128:131], v[64:67], v[208:211]
    ds_read_b128 v[128:131], v12 offset:1536
    v_mfma_f32_16x16x32_bf16 v[212:215], a[132:135], v[64:67], v[212:215]
    v_mfma_f32_16x16x32_bf16 v[216:219], a[128:131], v[68:71], v[216:219]
    ds_read_b128 v[132:135], v12 offset:34304
    v_mfma_f32_16x16x32_bf16 v[220:223], a[132:135], v[68:71], v[220:223]
    v_mfma_f32_16x16x32_bf16 v[208:211], a[136:139], v[72:75], v[208:211]
    ds_read_b128 v[136:139], v13 offset:1536
    v_mfma_f32_16x16x32_bf16 v[212:215], a[140:143], v[72:75], v[212:215]
    v_mfma_f32_16x16x32_bf16 v[216:219], a[136:139], v[76:79], v[216:219]
    ds_read_b128 v[140:143], v13 offset:34304
    v_mfma_f32_16x16x32_bf16 v[220:223], a[140:143], v[76:79], v[220:223]
    s_waitcnt lgkmcnt(12)
    v_mfma_f32_16x16x32_bf16 v[208:211], a[144:147], v[80:83], v[208:211]
    ds_read_b128 v[144:147], v14 offset:1536
    v_mfma_f32_16x16x32_bf16 v[212:215], a[148:151], v[80:83], v[212:215]
    v_mfma_f32_16x16x32_bf16 v[216:219], a[144:147], v[84:87], v[216:219]
    ds_read_b128 v[148:151], v14 offset:34304
    v_mfma_f32_16x16x32_bf16 v[220:223], a[148:151], v[84:87], v[220:223]
    v_mfma_f32_16x16x32_bf16 v[208:211], a[152:155], v[88:91], v[208:211]
    ds_read_b128 v[152:155], v15 offset:1536
    v_mfma_f32_16x16x32_bf16 v[212:215], a[156:159], v[88:91], v[212:215]
    v_mfma_f32_16x16x32_bf16 v[216:219], a[152:155], v[92:95], v[216:219]
    ds_read_b128 v[156:159], v15 offset:34304
    v_mfma_f32_16x16x32_bf16 v[220:223], a[156:159], v[92:95], v[220:223]
    s_waitcnt lgkmcnt(12)
    v_mfma_f32_16x16x32_bf16 v[208:211], a[160:163], v[96:99], v[208:211]
    ds_read_b128 v[160:163], v12 offset:1792
    v_mfma_f32_16x16x32_bf16 v[212:215], a[164:167], v[96:99], v[212:215]
    v_mfma_f32_16x16x32_bf16 v[216:219], a[160:163], v[100:103], v[216:219]
    ds_read_b128 v[164:167], v12 offset:34560
    v_mfma_f32_16x16x32_bf16 v[220:223], a[164:167], v[100:103], v[220:223]
    v_mfma_f32_16x16x32_bf16 v[208:211], a[168:171], v[104:107], v[208:211]
    ds_read_b128 v[168:171], v13 offset:1792
    v_mfma_f32_16x16x32_bf16 v[212:215], a[172:175], v[104:107], v[212:215]
    v_mfma_f32_16x16x32_bf16 v[216:219], a[168:171], v[108:111], v[216:219]
    ds_read_b128 v[172:175], v13 offset:34560
    v_mfma_f32_16x16x32_bf16 v[220:223], a[172:175], v[108:111], v[220:223]
    s_waitcnt lgkmcnt(12)
    v_mfma_f32_16x16x32_bf16 v[208:211], a[176:179], v[112:115], v[208:211]
    ds_read_b128 v[176:179], v14 offset:1792
    v_mfma_f32_16x16x32_bf16 v[212:215], a[180:183], v[112:115], v[212:215]
    s_waitcnt vmcnt(6)
    v_mov_b32 v27, s28
    s_mov_b64 exec, 1
    buffer_store_dword v27, v26, s[8:11], s94 offen sc1
    s_mov_b64 exec, -1
    v_mfma_f32_16x16x32_bf16 v[216:219], a[176:179], v[116:119], v[216:219]
    ds_read_b128 v[180:183], v14 offset:34560
    v_mfma_f32_16x16x32_bf16 v[220:223], a[180:183], v[116:119], v[220:223]
    v_mfma_f32_16x16x32_bf16 v[208:211], a[184:187], v[120:123], v[208:211]
    ds_read_b128 v[184:187], v15 offset:1792
    v_mfma_f32_16x16x32_bf16 v[212:215], a[188:191], v[120:123], v[212:215]
    s_add_u32 s28, s28, 1
    v_mfma_f32_16x16x32_bf16 v[216:219], a[184:187], v[124:127], v[216:219]
    ds_read_b128 v[188:191], v15 offset:34560
    v_mfma_f32_16x16x32_bf16 v[220:223], a[188:191], v[124:127], v[220:223]
    s_waitcnt lgkmcnt(12)
    v_mfma_f32_16x16x32_bf16 v[208:211], a[192:195], v[128:131], v[208:211]
    v_mfma_f32_16x16x32_bf16 v[212:215], a[196:199], v[128:131], v[212:215]
    v_mfma_f32_16x16x32_bf16 v[216:219], a[192:195], v[132:135], v[216:219]
    v_mfma_f32_16x16x32_bf16 v[220:223], a[196:199], v[132:135], v[220:223]
    v_mfma_f32_16x16x32_bf16 v[208:211], a[200:203], v[136:139], v[208:211]
    v_mfma_f32_16x16x32_bf16 v[212:215], a[204:207], v[136:139], v[212:215]
    s_add_u32 s29, s29, 0x10000
    s_min_u32 s29, s29, 0x3f0000
    v_mfma_f32_16x16x32_bf16 v[216:219], a[200:203], v[140:143], v[216:219]
    v_mfma_f32_16x16x32_bf16 v[220:223], a[204:207], v[140:143], v[220:223]
    s_waitcnt vmcnt(2) lgkmcnt(0)
    s_barrier
    v_mfma_f32_16x16x32_bf16 v[208:211], a[208:211], v[144:147], v[208:211]
    ds_read_b128 v[64:67], v8 offset:0
    ds_read_b128 v[68:71], v8 offset:32768
    v_mfma_f32_16x16x32_bf16 v[212:215], a[212:215], v[144:147], v[212:215]
    s_add_u32 m0, s6, 65536
    v_mfma_f32_16x16x32_bf16 v[216:219], a[208:211], v[148:151], v[216:219]
    ds_read_b128 v[72:75], v9 offset:0
    ds_read_b128 v[76:79], v9 offset:32768
    v_mfma_f32_16x16x32_bf16 v[220:223], a[212:215], v[148:151], v[220:223]
    buffer_load_dwordx4 v16, s[12:15], s29 offen offset:0 lds
    v_mfma_f32_16x16x32_bf16 v[208:211], a[216:219], v[152:155], v[208:211]
    ds_read_b128 v[80:83], v10 offset:0
    ds_read_b128 v[84:87], v10 offset:32768
    v_mfma_f32_16x16x32_bf16 v[212:215], a[220:223], v[152:155], v[212:215]
    v_mfma_f32_16x16x32_bf16 v[216:219], a[216:219], v[156:159], v[216:219]
    ds_read_b128 v[88:91], v11 offset:0
    ds_read_b128 v[92:95], v11 offset:32768
    v_mfma_f32_16x16x32_bf16 v[220:223], a[220:223], v[156:159], v[220:223]
    buffer_load_dwordx4 v16, s[12:15], s29 offen offset:1024 lds
    v_mfma_f32_16x16x32_bf16 v[208:211], a[224:227], v[160:163], v[208:211]
    ds_read_b128 v[96:99], v8 offset:256
    v_mfma_f32_16x16x32_bf16 v[212:215], a[228:231], v[160:163], v[212:215]
    v_mfma_f32_16x16x32_bf16 v[216:219], a[224:227], v[164:167], v[216:219]
    ds_read_b128 v[100:103], v8 offset:33024
    v_mfma_f32_16x16x32_bf16 v[220:223], a[228:231], v[164:167], v[220:223]
    buffer_load_dwordx4 v17, s[12:15], s29 offen offset:2048 lds
    v_mfma_f32_16x16x32_bf16 v[208:211], a[232:235], v[168:171], v[208:211]
    ds_read_b128 v[104:107], v9 offset:256
    v_mfma_f32_16x16x32_bf16 v[212:215], a[236:239], v[168:171], v[212:215]
    v_mfma_f32_16x16x32_bf16 v[216:219], a[232:235], v[172:175], v[216:219]
    ds_read_b128 v[108:111], v9 offset:33024
    v_mfma_f32_16x16x32_bf16 v[220:223], a[236:239], v[172:175], v[220:223]
    buffer_load_dwordx4 v17, s[12:15], s29 offen offset:3072 lds
    v_mfma_f32_16x16x32_bf16 v[208:211], a[240:243], v[176:179], v[208:211]
    ds_read_b128 v[112:115], v10 offset:256
    v_mfma_f32_16x16x32_bf16 v[212:215], a[244:247], v[176:179], v[212:215]
    s_add_u32 m0, s6, 69632
    v_mfma_f32_16x16x32_bf16 v[216:219], a[240:243], v[180:183], v[216:219]
    ds_read_b128 v[116:119], v10 offset:33024
    v_mfma_f32_16x16x32_bf16 v[220:223], a[244:247], v[180:183], v[220:223]
    buffer_load_dwordx4 v18, s[12:15], s29 offen offset:0 lds
    v_mfma_f32_16x16x32_bf16 v[208:211], a[248:251], v[184:187], v[208:211]
    ds_read_b128 v[120:123], v11 offset:256
    v_mfma_f32_16x16x32_bf16 v[212:215], a[252:255], v[184:187], v[212:215]
    v_mfma_f32_16x16x32_bf16 v[216:219], a[248:251], v[188:191], v[216:219]
    ds_read_b128 v[124:127], v11 offset:33024
    v_mfma_f32_16x16x32_bf16 v[220:223], a[252:255], v[188:191], v[220:223]
    buffer_load_dwordx4 v18, s[12:15], s29 offen offset:1024 lds
    s_cmp_lt_u32 s28, 64
    s_cbranch_scc1 .ql_206
    s_branch .qe_205
.vt_204:
.p2align 6
.ql_207:
    s_waitcnt lgkmcnt(12)
    v_mfma_f32_16x16x32_bf16 v[192:195], v[64:67], a[0:3], 0
    ds_read_b128 v[128:131], v8 offset:512
    v_mfma_f32_16x16x32_bf16 v[200:203], v[64:67], a[4:7], 0
    v_mfma_f32_16x16x32_bf16 v[196:199], v[68:71], a[0:3], 0
    ds_read_b128 v[132:135], v8 offset:33280
    v_mfma_f32_16x16x32_bf16 v[204:207], v[68:71], a[4:7], 0
    buffer_load_dwordx4 v19, s[12:15], s29 offen offset:2048 lds
    v_mfma_f32_16x16x32_bf16 v[192:195], v[72:75], a[8:11], v[192:195]
    ds_read_b128 v[136:139], v9 offset:512
    v_mfma_f32_16x16x32_bf16 v[200:203], v[72:75], a[12:15], v[200:203]
    v_cvt_pk_bf16_f32 v224, v208, v209
    v_cvt_pk_bf16_f32 v225, v210, v211
    v_mfma_f32_16x16x32_bf16 v[196:199], v[76:79], a[8:11], v[196:199]
    ds_read_b128 v[140:143], v9 offset:33280
    v_mfma_f32_16x16x32_bf16 v[204:207], v[76:79], a[12:15], v[204:207]
    buffer_load_dwordx4 v19, s[12:15], s29 offen offset:3072 lds
    s_waitcnt lgkmcnt(12)
    v_mfma_f32_16x16x32_bf16 v[192:195], v[80:83], a[16:19], v[192:195]
    ds_read_b128 v[144:147], v10 offset:512
    v_mfma_f32_16x16x32_bf16 v[200:203], v[80:83], a[20:23], v[200:203]
    s_add_u32 m0, s6, 73728
    v_cvt_pk_bf16_f32 v226, v212, v213
    v_cvt_pk_bf16_f32 v227, v214, v215
    v_mfma_f32_16x16x32_bf16 v[196:199], v[84:87], a[16:19], v[196:199]
    ds_read_b128 v[148:151], v10 offset:33280
    v_mfma_f32_16x16x32_bf16 v[204:207], v[84:87], a[20:23], v[204:207]
    buffer_load_dwordx4 v20, s[12:15], s29 offen offset:0 lds
    v_mfma_f32_16x16x32_bf16 v[192:195], v[88:91], a[24:27], v[192:195]
    ds_read_b128 v[152:155], v11 offset:512
    v_cvt_pk_bf16_f32 v228, v216, v217
    v_mfma_f32_16x16x32_bf16 v[200:203], v[88:91], a[28:31], v[200:203]
    buffer_store_dwordx4 v[224:227], v24, s[8:11], s30 offen sc1
    v_mfma_f32_16x16x32_bf16 v[196:199], v[92:95], a[24:27], v[196:199]
    ds_read_b128 v[156:159], v11 offset:33280
    v_cvt_pk_bf16_f32 v229, v218, v219
    v_mfma_f32_16x16x32_bf16 v[204:207], v[92:95], a[28:31], v[204:207]
    buffer_load_dwordx4 v20, s[12:15], s29 offen offset:1024 lds
    s_waitcnt lgkmcnt(12)
    v_mfma_f32_16x16x32_bf16 v[192:195], v[96:99], a[32:35], v[192:195]
    ds_read_b128 v[160:163], v8 offset:768
    v_mfma_f32_16x16x32_bf16 v[200:203], v[96:99], a[36:39], v[200:203]
    v_cvt_pk_bf16_f32 v230, v220, v221
    v_cvt_pk_bf16_f32 v231, v222, v223
    v_mfma_f32_16x16x32_bf16 v[196:199], v[100:103], a[32:35], v[196:199]
    ds_read_b128 v[164:167], v8 offset:33536
    v_mfma_f32_16x16x32_bf16 v[204:207], v[100:103], a[36:39], v[204:207]
    buffer_load_dwordx4 v21, s[12:15], s29 offen offset:2048 lds
    v_mfma_f32_16x16x32_bf16 v[192:195], v[104:107], a[40:43], v[192:195]
    ds_read_b128 v[168:171], v9 offset:768
    v_mfma_f32_16x16x32_bf16 v[200:203], v[104:107], a[44:47], v[200:203]
    buffer_store_dwordx4 v[228:231], v25, s[8:11], s30 offen sc1
    v_mfma_f32_16x16x32_bf16 v[196:199], v[108:111], a[40:43], v[196:199]
    ds_read_b128 v[172:175], v9 offset:33536
    v_mfma_f32_16x16x32_bf16 v[204:207], v[108:111], a[44:47], v[204:207]
    buffer_load_dwordx4 v21, s[12:15], s29 offen offset:3072 lds
    s_waitcnt lgkmcnt(12)
    v_mfma_f32_16x16x32_bf16 v[192:195], v[112:115], a[48:51], v[192:195]
    ds_read_b128 v[176:179], v10 offset:768
    v_mfma_f32_16x16x32_bf16 v[200:203], v[112:115], a[52:55], v[200:203]
    s_add_u32 m0, s6, 77824
    s_mov_b32 s30, s31
    v_mfma_f32_16x16x32_bf16 v[196:199], v[116:119], a[48:51], v[196:199]
    ds_read_b128 v[180:183], v10 offset:33536
    v_mfma_f32_16x16x32_bf16 v[204:207], v[116:119], a[52:55], v[204:207]
    buffer_load_dwordx4 v22, s[12:15], s29 offen offset:0 lds
    v_mfma_f32_16x16x32_bf16 v[192:195], v[120:123], a[56:59], v[192:195]
    ds_read_b128 v[184:187], v11 offset:768
    v_mfma_f32_16x16x32_bf16 v[200:203], v[120:123], a[60:63], v[200:203]
    s_add_u32 s31, s31, 262144
    v_mfma_f32_16x16x32_bf16 v[196:199], v[124:127], a[56:59], v[196:199]
    ds_read_b128 v[188:191], v11 offset:33536
    v_mfma_f32_16x16x32_bf16 v[204:207], v[124:127], a[60:63], v[204:207]
    buffer_load_dwordx4 v22, s[12:15], s29 offen offset:1024 lds
    s_waitcnt lgkmcnt(12)
    v_mfma_f32_16x16x32_bf16 v[192:195], v[128:131], a[64:67], v[192:195]
    ds_read_b128 v[64:67], v8 offset:1024
    v_mfma_f32_16x16x32_bf16 v[200:203], v[128:131], a[68:71], v[200:203]
    v_mfma_f32_16x16x32_bf16 v[196:199], v[132:135], a[64:67], v[196:199]
    ds_read_b128 v[68:71], v8 offset:33792
    v_mfma_f32_16x16x32_bf16 v[204:207], v[132:135], a[68:71], v[204:207]
    buffer_load_dwordx4 v23, s[12:15], s29 offen offset:2048 lds
    v_mfma_f32_16x16x32_bf16 v[192:195], v[136:139], a[72:75], v[192:195]
    ds_read_b128 v[72:75], v9 offset:1024
    v_mfma_f32_16x16x32_bf16 v[200:203], v[136:139], a[76:79], v[200:203]
    v_mfma_f32_16x16x32_bf16 v[196:199], v[140:143], a[72:75], v[196:199]
    ds_read_b128 v[76:79], v9 offset:33792
    v_mfma_f32_16x16x32_bf16 v[204:207], v[140:143], a[76:79], v[204:207]
    buffer_load_dwordx4 v23, s[12:15], s29 offen offset:3072 lds
    s_waitcnt lgkmcnt(12)
    v_mfma_f32_16x16x32_bf16 v[192:195], v[144:147], a[80:83], v[192:195]
    ds_read_b128 v[80:83], v10 offset:1024
    v_mfma_f32_16x16x32_bf16 v[200:203], v[144:147], a[84:87], v[200:203]
    v_mfma_f32_16x16x32_bf16 v[196:199], v[148:151], a[80:83], v[196:199]
    ds_read_b128 v[84:87], v10 offset:33792
    v_mfma_f32_16x16x32_bf16 v[204:207], v[148:151], a[84:87], v[204:207]
    buffer_load_dword v29, v28, s[12:15], s29 offen
    v_mfma_f32_16x16x32_bf16 v[192:195], v[152:155], a[88:91], v[192:195]
    ds_read_b128 v[88:91], v11 offset:1024
    v_mfma_f32_16x16x32_bf16 v[200:203], v[152:155], a[92:95], v[200:203]
    v_mfma_f32_16x16x32_bf16 v[196:199], v[156:159], a[88:91], v[196:199]
    ds_read_b128 v[92:95], v11 offset:33792
    v_mfma_f32_16x16x32_bf16 v[204:207], v[156:159], a[92:95], v[204:207]
    s_waitcnt lgkmcnt(12)
    v_mfma_f32_16x16x32_bf16 v[192:195], v[160:163], a[96:99], v[192:195]
    ds_read_b128 v[96:99], v8 offset:1280
    v_mfma_f32_16x16x32_bf16 v[200:203], v[160:163], a[100:103], v[200:203]
    v_mfma_f32_16x16x32_bf16 v[196:199], v[164:167], a[96:99], v[196:199]
    ds_read_b128 v[100:103], v8 offset:34048
    v_mfma_f32_16x16x32_bf16 v[204:207], v[164:167], a[100:103], v[204:207]
    v_mfma_f32_16x16x32_bf16 v[192:195], v[168:171], a[104:107], v[192:195]
    ds_read_b128 v[104:107], v9 offset:1280
    v_mfma_f32_16x16x32_bf16 v[200:203], v[168:171], a[108:111], v[200:203]
    v_mfma_f32_16x16x32_bf16 v[196:199], v[172:175], a[104:107], v[196:199]
    ds_read_b128 v[108:111], v9 offset:34048
    v_mfma_f32_16x16x32_bf16 v[204:207], v[172:175], a[108:111], v[204:207]
    s_waitcnt lgkmcnt(12)
    v_mfma_f32_16x16x32_bf16 v[192:195], v[176:179], a[112:115], v[192:195]
    ds_read_b128 v[112:115], v10 offset:1280
    v_mfma_f32_16x16x32_bf16 v[200:203], v[176:179], a[116:119], v[200:203]
    v_mfma_f32_16x16x32_bf16 v[196:199], v[180:183], a[112:115], v[196:199]
    ds_read_b128 v[116:119], v10 offset:34048
    v_mfma_f32_16x16x32_bf16 v[204:207], v[180:183], a[116:119], v[204:207]
    v_mfma_f32_16x16x32_bf16 v[192:195], v[184:187], a[120:123], v[192:195]
    ds_read_b128 v[120:123], v11 offset:1280
    v_mfma_f32_16x16x32_bf16 v[200:203], v[184:187], a[124:127], v[200:203]
    v_mfma_f32_16x16x32_bf16 v[196:199], v[188:191], a[120:123], v[196:199]
    ds_read_b128 v[124:127], v11 offset:34048
    v_mfma_f32_16x16x32_bf16 v[204:207], v[188:191], a[124:127], v[204:207]
    s_waitcnt lgkmcnt(12)
    v_mfma_f32_16x16x32_bf16 v[192:195], v[64:67], a[128:131], v[192:195]
    ds_read_b128 v[128:131], v8 offset:1536
    v_mfma_f32_16x16x32_bf16 v[200:203], v[64:67], a[132:135], v[200:203]
    v_mfma_f32_16x16x32_bf16 v[196:199], v[68:71], a[128:131], v[196:199]
    ds_read_b128 v[132:135], v8 offset:34304
    v_mfma_f32_16x16x32_bf16 v[204:207], v[68:71], a[132:135], v[204:207]
    v_mfma_f32_16x16x32_bf16 v[192:195], v[72:75], a[136:139], v[192:195]
    ds_read_b128 v[136:139], v9 offset:1536
    v_mfma_f32_16x16x32_bf16 v[200:203], v[72:75], a[140:143], v[200:203]
    v_mfma_f32_16x16x32_bf16 v[196:199], v[76:79], a[136:139], v[196:199]
    ds_read_b128 v[140:143], v9 offset:34304
    v_mfma_f32_16x16x32_bf16 v[204:207], v[76:79], a[140:143], v[204:207]
    s_waitcnt lgkmcnt(12)
    v_mfma_f32_16x16x32_bf16 v[192:195], v[80:83], a[144:147], v[192:195]
    ds_read_b128 v[144:147], v10 offset:1536
    v_mfma_f32_16x16x32_bf16 v[200:203], v[80:83], a[148:151], v[200:203]
    v_mfma_f32_16x16x32_bf16 v[196:199], v[84:87], a[144:147], v[196:199]
    ds_read_b128 v[148:151], v10 offset:34304
    v_mfma_f32_16x16x32_bf16 v[204:207], v[84:87], a[148:151], v[204:207]
    v_mfma_f32_16x16x32_bf16 v[192:195], v[88:91], a[152:155], v[192:195]
    ds_read_b128 v[152:155], v11 offset:1536
    v_mfma_f32_16x16x32_bf16 v[200:203], v[88:91], a[156:159], v[200:203]
    v_mfma_f32_16x16x32_bf16 v[196:199], v[92:95], a[152:155], v[196:199]
    ds_read_b128 v[156:159], v11 offset:34304
    v_mfma_f32_16x16x32_bf16 v[204:207], v[92:95], a[156:159], v[204:207]
    s_waitcnt lgkmcnt(12)
    v_mfma_f32_16x16x32_bf16 v[192:195], v[96:99], a[160:163], v[192:195]
    ds_read_b128 v[160:163], v8 offset:1792
    v_mfma_f32_16x16x32_bf16 v[200:203], v[96:99], a[164:167], v[200:203]
    v_mfma_f32_16x16x32_bf16 v[196:199], v[100:103], a[160:163], v[196:199]
    ds_read_b128 v[164:167], v8 offset:34560
    v_mfma_f32_16x16x32_bf16 v[204:207], v[100:103], a[164:167], v[204:207]
    v_mfma_f32_16x16x32_bf16 v[192:195], v[104:107], a[168:171], v[192:195]
    ds_read_b128 v[168:171], v9 offset:1792
    v_mfma_f32_16x16x32_bf16 v[200:203], v[104:107], a[172:175], v[200:203]
    v_mfma_f32_16x16x32_bf16 v[196:199], v[108:111], a[168:171], v[196:199]
    ds_read_b128 v[172:175], v9 offset:34560
    v_mfma_f32_16x16x32_bf16 v[204:207], v[108:111], a[172:175], v[204:207]
    s_waitcnt lgkmcnt(12)
    v_mfma_f32_16x16x32_bf16 v[192:195], v[112:115], a[176:179], v[192:195]
    ds_read_b128 v[176:179], v10 offset:1792
    v_mfma_f32_16x16x32_bf16 v[200:203], v[112:115], a[180:183], v[200:203]
    s_waitcnt vmcnt(6)
    v_mov_b32 v27, s28
    s_mov_b64 exec, 1
    buffer_store_dword v27, v26, s[8:11], s94 offen sc1
    s_mov_b64 exec, -1
    v_mfma_f32_16x16x32_bf16 v[196:199], v[116:119], a[176:179], v[196:199]
    ds_read_b128 v[180:183], v10 offset:34560
    v_mfma_f32_16x16x32_bf16 v[204:207], v[116:119], a[180:183], v[204:207]
    v_mfma_f32_16x16x32_bf16 v[192:195], v[120:123], a[184:187], v[192:195]
    ds_read_b128 v[184:187], v11 offset:1792
    v_mfma_f32_16x16x32_bf16 v[200:203], v[120:123], a[188:191], v[200:203]
    s_add_u32 s28, s28, 1
    v_mfma_f32_16x16x32_bf16 v[196:199], v[124:127], a[184:187], v[196:199]
    ds_read_b128 v[188:191], v11 offset:34560
    v_mfma_f32_16x16x32_bf16 v[204:207], v[124:127], a[188:191], v[204:207]
    s_waitcnt lgkmcnt(12)
    v_mfma_f32_16x16x32_bf16 v[192:195], v[128:131], a[192:195], v[192:195]
    v_mfma_f32_16x16x32_bf16 v[200:203], v[128:131], a[196:199], v[200:203]
    v_mfma_f32_16x16x32_bf16 v[196:199], v[132:135], a[192:195], v[196:199]
    v_mfma_f32_16x16x32_bf16 v[204:207], v[132:135], a[196:199], v[204:207]
    v_mfma_f32_16x16x32_bf16 v[192:195], v[136:139], a[200:203], v[192:195]
    v_mfma_f32_16x16x32_bf16 v[200:203], v[136:139], a[204:207], v[200:203]
    s_add_u32 s29, s29, 0x10000
    s_min_u32 s29, s29, 0x3f0000
    v_mfma_f32_16x16x32_bf16 v[196:199], v[140:143], a[200:203], v[196:199]
    v_mfma_f32_16x16x32_bf16 v[204:207], v[140:143], a[204:207], v[204:207]
    s_waitcnt vmcnt(2) lgkmcnt(0)
    s_barrier
    v_mfma_f32_16x16x32_bf16 v[192:195], v[144:147], a[208:211], v[192:195]
    ds_read_b128 v[64:67], v12 offset:0
    ds_read_b128 v[68:71], v12 offset:32768
    v_mfma_f32_16x16x32_bf16 v[200:203], v[144:147], a[212:215], v[200:203]
    s_add_u32 m0, s6, 0
    v_mfma_f32_16x16x32_bf16 v[196:199], v[148:151], a[208:211], v[196:199]
    ds_read_b128 v[72:75], v13 offset:0
    ds_read_b128 v[76:79], v13 offset:32768
    v_mfma_f32_16x16x32_bf16 v[204:207], v[148:151], a[212:215], v[204:207]
    buffer_load_dwordx4 v16, s[12:15], s29 offen offset:0 lds
    v_mfma_f32_16x16x32_bf16 v[192:195], v[152:155], a[216:219], v[192:195]
    ds_read_b128 v[80:83], v14 offset:0
    ds_read_b128 v[84:87], v14 offset:32768
    v_mfma_f32_16x16x32_bf16 v[200:203], v[152:155], a[220:223], v[200:203]
    v_mfma_f32_16x16x32_bf16 v[196:199], v[156:159], a[216:219], v[196:199]
    ds_read_b128 v[88:91], v15 offset:0
    ds_read_b128 v[92:95], v15 offset:32768
    v_mfma_f32_16x16x32_bf16 v[204:207], v[156:159], a[220:223], v[204:207]
    buffer_load_dwordx4 v16, s[12:15], s29 offen offset:1024 lds
    v_mfma_f32_16x16x32_bf16 v[192:195], v[160:163], a[224:227], v[192:195]
    ds_read_b128 v[96:99], v12 offset:256
    v_mfma_f32_16x16x32_bf16 v[200:203], v[160:163], a[228:231], v[200:203]
    v_mfma_f32_16x16x32_bf16 v[196:199], v[164:167], a[224:227], v[196:199]
    ds_read_b128 v[100:103], v12 offset:33024
    v_mfma_f32_16x16x32_bf16 v[204:207], v[164:167], a[228:231], v[204:207]
    buffer_load_dwordx4 v17, s[12:15], s29 offen offset:2048 lds
    v_mfma_f32_16x16x32_bf16 v[192:195], v[168:171], a[232:235], v[192:195]
    ds_read_b128 v[104:107], v13 offset:256
    v_mfma_f32_16x16x32_bf16 v[200:203], v[168:171], a[236:239], v[200:203]
    v_mfma_f32_16x16x32_bf16 v[196:199], v[172:175], a[232:235], v[196:199]
    ds_read_b128 v[108:111], v13 offset:33024
    v_mfma_f32_16x16x32_bf16 v[204:207], v[172:175], a[236:239], v[204:207]
    buffer_load_dwordx4 v17, s[12:15], s29 offen offset:3072 lds
    v_mfma_f32_16x16x32_bf16 v[192:195], v[176:179], a[240:243], v[192:195]
    ds_read_b128 v[112:115], v14 offset:256
    v_mfma_f32_16x16x32_bf16 v[200:203], v[176:179], a[244:247], v[200:203]
    s_add_u32 m0, s6, 4096
    v_mfma_f32_16x16x32_bf16 v[196:199], v[180:183], a[240:243], v[196:199]
    ds_read_b128 v[116:119], v14 offset:33024
    v_mfma_f32_16x16x32_bf16 v[204:207], v[180:183], a[244:247], v[204:207]
    buffer_load_dwordx4 v18, s[12:15], s29 offen offset:0 lds
    v_mfma_f32_16x16x32_bf16 v[192:195], v[184:187], a[248:251], v[192:195]
    ds_read_b128 v[120:123], v15 offset:256
    v_mfma_f32_16x16x32_bf16 v[200:203], v[184:187], a[252:255], v[200:203]
    v_mfma_f32_16x16x32_bf16 v[196:199], v[188:191], a[248:251], v[196:199]
    ds_read_b128 v[124:127], v15 offset:33024
    v_mfma_f32_16x16x32_bf16 v[204:207], v[188:191], a[252:255], v[204:207]
    buffer_load_dwordx4 v18, s[12:15], s29 offen offset:1024 lds
    s_waitcnt lgkmcnt(12)
    v_mfma_f32_16x16x32_bf16 v[208:211], v[64:67], a[0:3], 0
    ds_read_b128 v[128:131], v12 offset:512
    v_mfma_f32_16x16x32_bf16 v[216:219], v[64:67], a[4:7], 0
    v_mfma_f32_16x16x32_bf16 v[212:215], v[68:71], a[0:3], 0
    ds_read_b128 v[132:135], v12 offset:33280
    v_mfma_f32_16x16x32_bf16 v[220:223], v[68:71], a[4:7], 0
    buffer_load_dwordx4 v19, s[12:15], s29 offen offset:2048 lds
    v_mfma_f32_16x16x32_bf16 v[208:211], v[72:75], a[8:11], v[208:211]
    ds_read_b128 v[136:139], v13 offset:512
    v_mfma_f32_16x16x32_bf16 v[216:219], v[72:75], a[12:15], v[216:219]
    v_cvt_pk_bf16_f32 v224, v192, v193
    v_cvt_pk_bf16_f32 v225, v194, v195
    v_mfma_f32_16x16x32_bf16 v[212:215], v[76:79], a[8:11], v[212:215]
    ds_read_b128 v[140:143], v13 offset:33280
    v_mfma_f32_16x16x32_bf16 v[220:223], v[76:79], a[12:15], v[220:223]
    buffer_load_dwordx4 v19, s[12:15], s29 offen offset:3072 lds
    s_waitcnt lgkmcnt(12)
    v_mfma_f32_16x16x32_bf16 v[208:211], v[80:83], a[16:19], v[208:211]
    ds_read_b128 v[144:147], v14 offset:512
    v_mfma_f32_16x16x32_bf16 v[216:219], v[80:83], a[20:23], v[216:219]
    s_add_u32 m0, s6, 8192
    v_cvt_pk_bf16_f32 v226, v196, v197
    v_cvt_pk_bf16_f32 v227, v198, v199
    v_mfma_f32_16x16x32_bf16 v[212:215], v[84:87], a[16:19], v[212:215]
    ds_read_b128 v[148:151], v14 offset:33280
    v_mfma_f32_16x16x32_bf16 v[220:223], v[84:87], a[20:23], v[220:223]
    buffer_load_dwordx4 v20, s[12:15], s29 offen offset:0 lds
    v_mfma_f32_16x16x32_bf16 v[208:211], v[88:91], a[24:27], v[208:211]
    ds_read_b128 v[152:155], v15 offset:512
    v_cvt_pk_bf16_f32 v228, v200, v201
    v_mfma_f32_16x16x32_bf16 v[216:219], v[88:91], a[28:31], v[216:219]
    buffer_store_dwordx4 v[224:227], v24, s[8:11], s30 offen sc1
    v_mfma_f32_16x16x32_bf16 v[212:215], v[92:95], a[24:27], v[212:215]
    ds_read_b128 v[156:159], v15 offset:33280
    v_cvt_pk_bf16_f32 v229, v202, v203
    v_mfma_f32_16x16x32_bf16 v[220:223], v[92:95], a[28:31], v[220:223]
    buffer_load_dwordx4 v20, s[12:15], s29 offen offset:1024 lds
    s_waitcnt lgkmcnt(12)
    v_mfma_f32_16x16x32_bf16 v[208:211], v[96:99], a[32:35], v[208:211]
    ds_read_b128 v[160:163], v12 offset:768
    v_mfma_f32_16x16x32_bf16 v[216:219], v[96:99], a[36:39], v[216:219]
    v_cvt_pk_bf16_f32 v230, v204, v205
    v_cvt_pk_bf16_f32 v231, v206, v207
    v_mfma_f32_16x16x32_bf16 v[212:215], v[100:103], a[32:35], v[212:215]
    ds_read_b128 v[164:167], v12 offset:33536
    v_mfma_f32_16x16x32_bf16 v[220:223], v[100:103], a[36:39], v[220:223]
    buffer_load_dwordx4 v21, s[12:15], s29 offen offset:2048 lds
    v_mfma_f32_16x16x32_bf16 v[208:211], v[104:107], a[40:43], v[208:211]
    ds_read_b128 v[168:171], v13 offset:768
    v_mfma_f32_16x16x32_bf16 v[216:219], v[104:107], a[44:47], v[216:219]
    buffer_store_dwordx4 v[228:231], v25, s[8:11], s30 offen sc1
    v_mfma_f32_16x16x32_bf16 v[212:215], v[108:111], a[40:43], v[212:215]
    ds_read_b128 v[172:175], v13 offset:33536
    v_mfma_f32_16x16x32_bf16 v[220:223], v[108:111], a[44:47], v[220:223]
    buffer_load_dwordx4 v21, s[12:15], s29 offen offset:3072 lds
    s_waitcnt lgkmcnt(12)
    v_mfma_f32_16x16x32_bf16 v[208:211], v[112:115], a[48:51], v[208:211]
    ds_read_b128 v[176:179], v14 offset:768
    v_mfma_f32_16x16x32_bf16 v[216:219], v[112:115], a[52:55], v[216:219]
    s_add_u32 m0, s6, 12288
    s_mov_b32 s30, s31
    v_mfma_f32_16x16x32_bf16 v[212:215], v[116:119], a[48:51], v[212:215]
    ds_read_b128 v[180:183], v14 offset:33536
    v_mfma_f32_16x16x32_bf16 v[220:223], v[116:119], a[52:55], v[220:223]
    buffer_load_dwordx4 v22, s[12:15], s29 offen offset:0 lds
    v_mfma_f32_16x16x32_bf16 v[208:211], v[120:123], a[56:59], v[208:211]
    ds_read_b128 v[184:187], v15 offset:768
    v_mfma_f32_16x16x32_bf16 v[216:219], v[120:123], a[60:63], v[216:219]
    s_add_u32 s31, s31, 262144
    v_mfma_f32_16x16x32_bf16 v[212:215], v[124:127], a[56:59], v[212:215]
    ds_read_b128 v[188:191], v15 offset:33536
    v_mfma_f32_16x16x32_bf16 v[220:223], v[124:127], a[60:63], v[220:223]
    buffer_load_dwordx4 v22, s[12:15], s29 offen offset:1024 lds
    s_waitcnt lgkmcnt(12)
    v_mfma_f32_16x16x32_bf16 v[208:211], v[128:131], a[64:67], v[208:211]
    ds_read_b128 v[64:67], v12 offset:1024
    v_mfma_f32_16x16x32_bf16 v[216:219], v[128:131], a[68:71], v[216:219]
    v_mfma_f32_16x16x32_bf16 v[212:215], v[132:135], a[64:67], v[212:215]
    ds_read_b128 v[68:71], v12 offset:33792
    v_mfma_f32_16x16x32_bf16 v[220:223], v[132:135], a[68:71], v[220:223]
    buffer_load_dwordx4 v23, s[12:15], s29 offen offset:2048 lds
    v_mfma_f32_16x16x32_bf16 v[208:211], v[136:139], a[72:75], v[208:211]
    ds_read_b128 v[72:75], v13 offset:1024
    v_mfma_f32_16x16x32_bf16 v[216:219], v[136:139], a[76:79], v[216:219]
    v_mfma_f32_16x16x32_bf16 v[212:215], v[140:143], a[72:75], v[212:215]
    ds_read_b128 v[76:79], v13 offset:33792
    v_mfma_f32_16x16x32_bf16 v[220:223], v[140:143], a[76:79], v[220:223]
    buffer_load_dwordx4 v23, s[12:15], s29 offen offset:3072 lds
    s_waitcnt lgkmcnt(12)
    v_mfma_f32_16x16x32_bf16 v[208:211], v[144:147], a[80:83], v[208:211]
    ds_read_b128 v[80:83], v14 offset:1024
    v_mfma_f32_16x16x32_bf16 v[216:219], v[144:147], a[84:87], v[216:219]
    v_mfma_f32_16x16x32_bf16 v[212:215], v[148:151], a[80:83], v[212:215]
    ds_read_b128 v[84:87], v14 offset:33792
    v_mfma_f32_16x16x32_bf16 v[220:223], v[148:151], a[84:87], v[220:223]
    buffer_load_dword v29, v28, s[12:15], s29 offen
    v_mfma_f32_16x16x32_bf16 v[208:211], v[152:155], a[88:91], v[208:211]
    ds_read_b128 v[88:91], v15 offset:1024
    v_mfma_f32_16x16x32_bf16 v[216:219], v[152:155], a[92:95], v[216:219]
    v_mfma_f32_16x16x32_bf16 v[212:215], v[156:159], a[88:91], v[212:215]
    ds_read_b128 v[92:95], v15 offset:33792
    v_mfma_f32_16x16x32_bf16 v[220:223], v[156:159], a[92:95], v[220:223]
    s_waitcnt lgkmcnt(12)
    v_mfma_f32_16x16x32_bf16 v[208:211], v[160:163], a[96:99], v[208:211]
    ds_read_b128 v[96:99], v12 offset:1280
    v_mfma_f32_16x16x32_bf16 v[216:219], v[160:163], a[100:103], v[216:219]
    v_mfma_f32_16x16x32_bf16 v[212:215], v[164:167], a[96:99], v[212:215]
    ds_read_b128 v[100:103], v12 offset:34048
    v_mfma_f32_16x16x32_bf16 v[220:223], v[164:167], a[100:103], v[220:223]
    v_mfma_f32_16x16x32_bf16 v[208:211], v[168:171], a[104:107], v[208:211]
    ds_read_b128 v[104:107], v13 offset:1280
    v_mfma_f32_16x16x32_bf16 v[216:219], v[168:171], a[108:111], v[216:219]
    v_mfma_f32_16x16x32_bf16 v[212:215], v[172:175], a[104:107], v[212:215]
    ds_read_b128 v[108:111], v13 offset:34048
    v_mfma_f32_16x16x32_bf16 v[220:223], v[172:175], a[108:111], v[220:223]
    s_waitcnt lgkmcnt(12)
    v_mfma_f32_16x16x32_bf16 v[208:211], v[176:179], a[112:115], v[208:211]
    ds_read_b128 v[112:115], v14 offset:1280
    v_mfma_f32_16x16x32_bf16 v[216:219], v[176:179], a[116:119], v[216:219]
    v_mfma_f32_16x16x32_bf16 v[212:215], v[180:183], a[112:115], v[212:215]
    ds_read_b128 v[116:119], v14 offset:34048
    v_mfma_f32_16x16x32_bf16 v[220:223], v[180:183], a[116:119], v[220:223]
    v_mfma_f32_16x16x32_bf16 v[208:211], v[184:187], a[120:123], v[208:211]
    ds_read_b128 v[120:123], v15 offset:1280
    v_mfma_f32_16x16x32_bf16 v[216:219], v[184:187], a[124:127], v[216:219]
    v_mfma_f32_16x16x32_bf16 v[212:215], v[188:191], a[120:123], v[212:215]
    ds_read_b128 v[124:127], v15 offset:34048
    v_mfma_f32_16x16x32_bf16 v[220:223], v[188:191], a[124:127], v[220:223]
    s_waitcnt lgkmcnt(12)
    v_mfma_f32_16x16x32_bf16 v[208:211], v[64:67], a[128:131], v[208:211]
    ds_read_b128 v[128:131], v12 offset:1536
    v_mfma_f32_16x16x32_bf16 v[216:219], v[64:67], a[132:135], v[216:219]
    v_mfma_f32_16x16x32_bf16 v[212:215], v[68:71], a[128:131], v[212:215]
    ds_read_b128 v[132:135], v12 offset:34304
    v_mfma_f32_16x16x32_bf16 v[220:223], v[68:71], a[132:135], v[220:223]
    v_mfma_f32_16x16x32_bf16 v[208:211], v[72:75], a[136:139], v[208:211]
    ds_read_b128 v[136:139], v13 offset:1536
    v_mfma_f32_16x16x32_bf16 v[216:219], v[72:75], a[140:143], v[216:219]
    v_mfma_f32_16x16x32_bf16 v[212:215], v[76:79], a[136:139], v[212:215]
    ds_read_b128 v[140:143], v13 offset:34304
    v_mfma_f32_16x16x32_bf16 v[220:223], v[76:79], a[140:143], v[220:223]
    s_waitcnt lgkmcnt(12)
    v_mfma_f32_16x16x32_bf16 v[208:211], v[80:83], a[144:147], v[208:211]
    ds_read_b128 v[144:147], v14 offset:1536
    v_mfma_f32_16x16x32_bf16 v[216:219], v[80:83], a[148:151], v[216:219]
    v_mfma_f32_16x16x32_bf16 v[212:215], v[84:87], a[144:147], v[212:215]
    ds_read_b128 v[148:151], v14 offset:34304
    v_mfma_f32_16x16x32_bf16 v[220:223], v[84:87], a[148:151], v[220:223]
    v_mfma_f32_16x16x32_bf16 v[208:211], v[88:91], a[152:155], v[208:211]
    ds_read_b128 v[152:155], v15 offset:1536
    v_mfma_f32_16x16x32_bf16 v[216:219], v[88:91], a[156:159], v[216:219]
    v_mfma_f32_16x16x32_bf16 v[212:215], v[92:95], a[152:155], v[212:215]
    ds_read_b128 v[156:159], v15 offset:34304
    v_mfma_f32_16x16x32_bf16 v[220:223], v[92:95], a[156:159], v[220:223]
    s_waitcnt lgkmcnt(12)
    v_mfma_f32_16x16x32_bf16 v[208:211], v[96:99], a[160:163], v[208:211]
    ds_read_b128 v[160:163], v12 offset:1792
    v_mfma_f32_16x16x32_bf16 v[216:219], v[96:99], a[164:167], v[216:219]
    v_mfma_f32_16x16x32_bf16 v[212:215], v[100:103], a[160:163], v[212:215]
    ds_read_b128 v[164:167], v12 offset:34560
    v_mfma_f32_16x16x32_bf16 v[220:223], v[100:103], a[164:167], v[220:223]
    v_mfma_f32_16x16x32_bf16 v[208:211], v[104:107], a[168:171], v[208:211]
    ds_read_b128 v[168:171], v13 offset:1792
    v_mfma_f32_16x16x32_bf16 v[216:219], v[104:107], a[172:175], v[216:219]
    v_mfma_f32_16x16x32_bf16 v[212:215], v[108:111], a[168:171], v[212:215]
    ds_read_b128 v[172:175], v13 offset:34560
    v_mfma_f32_16x16x32_bf16 v[220:223], v[108:111], a[172:175], v[220:223]
    s_waitcnt lgkmcnt(12)
    v_mfma_f32_16x16x32_bf16 v[208:211], v[112:115], a[176:179], v[208:211]
    ds_read_b128 v[176:179], v14 offset:1792
    v_mfma_f32_16x16x32_bf16 v[216:219], v[112:115], a[180:183], v[216:219]
    s_waitcnt vmcnt(6)
    v_mov_b32 v27, s28
    s_mov_b64 exec, 1
    buffer_store_dword v27, v26, s[8:11], s94 offen sc1
    s_mov_b64 exec, -1
    v_mfma_f32_16x16x32_bf16 v[212:215], v[116:119], a[176:179], v[212:215]
    ds_read_b128 v[180:183], v14 offset:34560
    v_mfma_f32_16x16x32_bf16 v[220:223], v[116:119], a[180:183], v[220:223]
    v_mfma_f32_16x16x32_bf16 v[208:211], v[120:123], a[184:187], v[208:211]
    ds_read_b128 v[184:187], v15 offset:1792
    v_mfma_f32_16x16x32_bf16 v[216:219], v[120:123], a[188:191], v[216:219]
    s_add_u32 s28, s28, 1
    v_mfma_f32_16x16x32_bf16 v[212:215], v[124:127], a[184:187], v[212:215]
    ds_read_b128 v[188:191], v15 offset:34560
    v_mfma_f32_16x16x32_bf16 v[220:223], v[124:127], a[188:191], v[220:223]
    s_waitcnt lgkmcnt(12)
    v_mfma_f32_16x16x32_bf16 v[208:211], v[128:131], a[192:195], v[208:211]
    v_mfma_f32_16x16x32_bf16 v[216:219], v[128:131], a[196:199], v[216:219]
    v_mfma_f32_16x16x32_bf16 v[212:215], v[132:135], a[192:195], v[212:215]
    v_mfma_f32_16x16x32_bf16 v[220:223], v[132:135], a[196:199], v[220:223]
    v_mfma_f32_16x16x32_bf16 v[208:211], v[136:139], a[200:203], v[208:211]
    v_mfma_f32_16x16x32_bf16 v[216:219], v[136:139], a[204:207], v[216:219]
    s_add_u32 s29, s29, 0x10000
    s_min_u32 s29, s29, 0x3f0000
    v_mfma_f32_16x16x32_bf16 v[212:215], v[140:143], a[200:203], v[212:215]
    v_mfma_f32_16x16x32_bf16 v[220:223], v[140:143], a[204:207], v[220:223]
    s_waitcnt vmcnt(2) lgkmcnt(0)
    s_barrier
    v_mfma_f32_16x16x32_bf16 v[208:211], v[144:147], a[208:211], v[208:211]
    ds_read_b128 v[64:67], v8 offset:0
    ds_read_b128 v[68:71], v8 offset:32768
    v_mfma_f32_16x16x32_bf16 v[216:219], v[144:147], a[212:215], v[216:219]
    s_add_u32 m0, s6, 65536
    v_mfma_f32_16x16x32_bf16 v[212:215], v[148:151], a[208:211], v[212:215]
    ds_read_b128 v[72:75], v9 offset:0
    ds_read_b128 v[76:79], v9 offset:32768
    v_mfma_f32_16x16x32_bf16 v[220:223], v[148:151], a[212:215], v[220:223]
    buffer_load_dwordx4 v16, s[12:15], s29 offen offset:0 lds
    v_mfma_f32_16x16x32_bf16 v[208:211], v[152:155], a[216:219], v[208:211]
    ds_read_b128 v[80:83], v10 offset:0
    ds_read_b128 v[84:87], v10 offset:32768
    v_mfma_f32_16x16x32_bf16 v[216:219], v[152:155], a[220:223], v[216:219]
    v_mfma_f32_16x16x32_bf16 v[212:215], v[156:159], a[216:219], v[212:215]
    ds_read_b128 v[88:91], v11 offset:0
    ds_read_b128 v[92:95], v11 offset:32768
    v_mfma_f32_16x16x32_bf16 v[220:223], v[156:159], a[220:223], v[220:223]
    buffer_load_dwordx4 v16, s[12:15], s29 offen offset:1024 lds
    v_mfma_f32_16x16x32_bf16 v[208:211], v[160:163], a[224:227], v[208:211]
    ds_read_b128 v[96:99], v8 offset:256
    v_mfma_f32_16x16x32_bf16 v[216:219], v[160:163], a[228:231], v[216:219]
    v_mfma_f32_16x16x32_bf16 v[212:215], v[164:167], a[224:227], v[212:215]
    ds_read_b128 v[100:103], v8 offset:33024
    v_mfma_f32_16x16x32_bf16 v[220:223], v[164:167], a[228:231], v[220:223]
    buffer_load_dwordx4 v17, s[12:15], s29 offen offset:2048 lds
    v_mfma_f32_16x16x32_bf16 v[208:211], v[168:171], a[232:235], v[208:211]
    ds_read_b128 v[104:107], v9 offset:256
    v_mfma_f32_16x16x32_bf16 v[216:219], v[168:171], a[236:239], v[216:219]
    v_mfma_f32_16x16x32_bf16 v[212:215], v[172:175], a[232:235], v[212:215]
    ds_read_b128 v[108:111], v9 offset:33024
    v_mfma_f32_16x16x32_bf16 v[220:223], v[172:175], a[236:239], v[220:223]
    buffer_load_dwordx4 v17, s[12:15], s29 offen offset:3072 lds
    v_mfma_f32_16x16x32_bf16 v[208:211], v[176:179], a[240:243], v[208:211]
    ds_read_b128 v[112:115], v10 offset:256
    v_mfma_f32_16x16x32_bf16 v[216:219], v[176:179], a[244:247], v[216:219]
    s_add_u32 m0, s6, 69632
    v_mfma_f32_16x16x32_bf16 v[212:215], v[180:183], a[240:243], v[212:215]
    ds_read_b128 v[116:119], v10 offset:33024
    v_mfma_f32_16x16x32_bf16 v[220:223], v[180:183], a[244:247], v[220:223]
    buffer_load_dwordx4 v18, s[12:15], s29 offen offset:0 lds
    v_mfma_f32_16x16x32_bf16 v[208:211], v[184:187], a[248:251], v[208:211]
    ds_read_b128 v[120:123], v11 offset:256
    v_mfma_f32_16x16x32_bf16 v[216:219], v[184:187], a[252:255], v[216:219]
    v_mfma_f32_16x16x32_bf16 v[212:215], v[188:191], a[248:251], v[212:215]
    ds_read_b128 v[124:127], v11 offset:33024
    v_mfma_f32_16x16x32_bf16 v[220:223], v[188:191], a[252:255], v[220:223]
    buffer_load_dwordx4 v18, s[12:15], s29 offen offset:1024 lds
    s_cmp_lt_u32 s28, 64
    s_cbranch_scc1 .ql_207
.qe_205:
    s_nop 7
    v_cvt_pk_bf16_f32 v224, v208, v209
    v_cvt_pk_bf16_f32 v225, v210, v211
    v_cvt_pk_bf16_f32 v226, v212, v213
    v_cvt_pk_bf16_f32 v227, v214, v215
    v_cvt_pk_bf16_f32 v228, v216, v217
    v_cvt_pk_bf16_f32 v229, v218, v219
    v_cvt_pk_bf16_f32 v230, v220, v221
    v_cvt_pk_bf16_f32 v231, v222, v223
    buffer_store_dwordx4 v[224:227], v24, s[8:11], s30 offen sc1
    buffer_store_dwordx4 v[228:231], v25, s[8:11], s30 offen sc1
    s_waitcnt vmcnt(0) lgkmcnt(0)
    v_mov_b32 v27, s28
    s_mov_b64 exec, 1
    buffer_store_dword v27, v26, s[8:11], s94 offen sc1
    s_mov_b64 exec, -1
    s_branch .ph2_191
.qa_203:
    s_and_b32 s34, s24, 1
    s_lshr_b32 s35, s24, 1
    s_lshl_b32 s4, s35, 10
    s_add_u32 s4, s4, 2048
    v_lshlrev_b32 v2, 4, v1
    s_lshl_b32 s5, s24, 10
    s_add_u32 s5, s5, 131072
    v_add_u32 v24, s5, v2
    s_lshl_b32 s5, s34, 12
    s_add_u32 s5, s5, 131072
    v_add_u32 v25, s5, v2
    v_add_u32 v31, 139264, v2
    s_lshl_b32 s5, s35, 12
    v_add_u32 v5, s5, v31
    s_lshl_b32 s43, s24, 11
    v_bfe_u32 v254, v1, 4, 2
    v_mul_u32_u24 v3, 128, v254
    v_bfe_u32 v254, v1, 2, 2
    v_mul_u32_u24 v254, 32, v254
    v_add_u32 v3, v3, v254
    v_bfe_u32 v254, v1, 0, 1
    v_mul_u32_u24 v254, 16, v254
    v_add_u32 v3, v3, v254
    v_add_u32 v3, 155648, v3
    v_bfe_u32 v254, v1, 2, 2
    v_mul_u32_u24 v6, 128, v254
    v_bfe_u32 v254, v1, 0, 2
    v_mul_u32_u24 v254, 16, v254
    v_add_u32 v6, v6, v254
    v_bfe_u32 v254, v1, 4, 2
    v_mul_u32_u24 v254, 4, v254
    v_add_u32 v6, v6, v254
    v_add_u32 v6, 155648, v6
    v_add_u32 v6, s4, v6
    s_lshl_b32 s4, s99, 7
    s_add_u32 s4, s4, 92274688
    v_bfe_u32 v254, v1, 0, 2
    v_mul_u32_u24 v7, 4, v254
    v_add_u32 v7, s4, v7
    v_mov_b32 v232, 0
    v_mov_b32 v233, 0
    v_mov_b32 v234, 0
    v_mov_b32 v235, 0
    v_mov_b32 v236, 0
    v_mov_b32 v237, 0
    v_mov_b32 v238, 0
    v_mov_b32 v239, 0
    v_mov_b32 v240, 0
    v_mov_b32 v241, 0
    v_mov_b32 v40, 0
    v_mov_b32 v44, 0x3f803f80
    v_mov_b32 v41, 0
    v_mov_b32 v45, 0x3f803f80
    v_mov_b32 v42, 0
    v_mov_b32 v46, 0x3f803f80
    v_mov_b32 v43, 0
    v_mov_b32 v47, 0x3f803f80
    s_lshl_b32 s4, s34, 4
    v_and_b32 v48, 15, v1
    v_add_u32 v48, s4, v48
    v_lshrrev_b32 v49, 4, v1
    v_lshlrev_b32 v49, 2, v49
    v_mov_b32 v51, 0xff800000
    v_add_u32 v50, 0, v49
    v_cmp_le_u32 vcc, v50, v48
    s_nop 1
    v_cndmask_b32 v32, v51, v40, vcc
    v_add_u32 v50, 1, v49
    v_cmp_le_u32 vcc, v50, v48
    s_nop 1
    v_cndmask_b32 v33, v51, v40, vcc
    v_add_u32 v50, 2, v49
    v_cmp_le_u32 vcc, v50, v48
    s_nop 1
    v_cndmask_b32 v34, v51, v40, vcc
    v_add_u32 v50, 3, v49
    v_cmp_le_u32 vcc, v50, v48
    s_nop 1
    v_cndmask_b32 v35, v51, v40, vcc
    v_add_u32 v50, 16, v49
    v_cmp_le_u32 vcc, v50, v48
    s_nop 1
    v_cndmask_b32 v36, v51, v40, vcc
    v_add_u32 v50, 17, v49
    v_cmp_le_u32 vcc, v50, v48
    s_nop 1
    v_cndmask_b32 v37, v51, v40, vcc
    v_add_u32 v50, 18, v49
    v_cmp_le_u32 vcc, v50, v48
    s_nop 1
    v_cndmask_b32 v38, v51, v40, vcc
    v_add_u32 v50, 19, v49
    v_cmp_le_u32 vcc, v50, v48
    s_nop 1
    v_cndmask_b32 v39, v51, v40, vcc
    s_lshl_b32 s4, s99, 7
    s_add_u32 s94, s4, 92286976
    s_movk_i32 s46, 4096
    s_movk_i32 s47, 8192
    s_mov_b32 s30, -1
    s_mov_b32 s32, 0
    s_mov_b32 s33, 0
    s_mov_b32 s41, 0
    s_mov_b32 s45, 0x3e0293ee
    s_lshl_b32 s36, s99, 13
    s_add_u32 s36, s36, s43
    s_add_u32 s36, s36, 16777216
    s_add_u32 s43, s43, 139264
    s_sub_u32 s37, s36, 0x40000
    v_and_b32 v255, 15, v1
    v_bfe_u32 v254, v1, 4, 1
    v_lshlrev_b32 v255, 7, v255
    v_lshl_add_u32 v255, v254, 24, v255
    s_lshl_b32 s39, s99, 12
    s_lshl_b32 s4, s34, 17
    s_add_u32 s40, s39, s4
    s_lshl_b32 s4, s35, 11
    s_add_u32 s40, s40, s4
    s_add_u32 s40, s40, 50331648
    s_add_u32 s39, s39, 67108864
    s_lshl_b32 s52, s24, 10
    s_add_u32 s39, s39, s52
    s_add_u32 s52, s52, 155648
    s_mov_b32 s31, 2
    s_cmp_gt_u32 s32, 0
    s_cbranch_scc1 .ndd_209
    s_mov_b32 s62, 0
.nd_208:
    buffer_load_dword v4, v7, s[8:11], s46 offen sc1
    buffer_load_dword v30, v7, s[8:11], s47 offen sc1
    s_add_u32 s62, s62, 1
    s_cmp_gt_u32 s62, 0x200000
    s_cbranch_scc1 .mg_end_1
    s_waitcnt vmcnt(0)
    v_min_u32 v4, v4, v30
    s_nop 1
    v_min_u32_dpp v4, v4, v4 quad_perm:[1,0,3,2] row_mask:0xf bank_mask:0xf
    s_nop 1
    v_min_u32_dpp v4, v4, v4 quad_perm:[2,3,0,1] row_mask:0xf bank_mask:0xf
    s_nop 1
    v_readfirstlane_b32 s32, v4
    s_cmp_gt_u32 s32, 0
    s_cbranch_scc1 .ndd_209
    s_sleep 4
    s_branch .nd_208
.ndd_209:
    buffer_load_dwordx4 v19, s[12:15], s29 offen offset:2048 lds
    buffer_load_dwordx4 v19, s[12:15], s29 offen offset:3072 lds
    s_waitcnt lgkmcnt(0)
.p2align 6
.ql_210:
    v_mfma_f32_16x16x32_bf16 v[192:195], a[0:3], v[64:67], 0
    ds_read_b128 v[112:115], v10 offset:256
    s_add_u32 m0, s6, 73728
    v_mfma_f32_16x16x32_bf16 v[196:199], a[4:7], v[64:67], 0
    buffer_load_dwordx4 v20, s[12:15], s29 offen offset:0 lds
    v_mfma_f32_16x16x32_bf16 v[200:203], a[0:3], v[68:71], 0
    ds_read_b128 v[116:119], v10 offset:33024
    v_mfma_f32_16x16x32_bf16 v[204:207], a[4:7], v[68:71], 0
    v_mfma_f32_16x16x32_bf16 v[192:195], a[8:11], v[72:75], v[192:195]
    ds_read_b128 v[120:123], v11 offset:256
    v_cvt_pk_bf16_f32 v224, v208, v209
    v_cvt_pk_bf16_f32 v225, v210, v211
    v_mfma_f32_16x16x32_bf16 v[196:199], a[12:15], v[72:75], v[196:199]
    buffer_load_dwordx4 v20, s[12:15], s29 offen offset:1024 lds
    v_mfma_f32_16x16x32_bf16 v[200:203], a[8:11], v[76:79], v[200:203]
    ds_read_b128 v[124:127], v11 offset:33024
    v_mfma_f32_16x16x32_bf16 v[204:207], a[12:15], v[76:79], v[204:207]
    v_mfma_f32_16x16x32_bf16 v[192:195], a[16:19], v[80:83], v[192:195]
    ds_read_b128 v[64:67], v8 offset:512
    v_cvt_pk_bf16_f32 v226, v212, v213
    v_cvt_pk_bf16_f32 v227, v214, v215
    v_mfma_f32_16x16x32_bf16 v[196:199], a[20:23], v[80:83], v[196:199]
    buffer_load_dwordx4 v21, s[12:15], s29 offen offset:2048 lds
    v_mfma_f32_16x16x32_bf16 v[200:203], a[16:19], v[84:87], v[200:203]
    ds_read_b128 v[68:71], v8 offset:33280
    v_mfma_f32_16x16x32_bf16 v[204:207], a[20:23], v[84:87], v[204:207]
    v_mfma_f32_16x16x32_bf16 v[192:195], a[24:27], v[88:91], v[192:195]
    ds_read_b128 v[72:75], v9 offset:512
    ds_write_b128 v24, v[224:227] offset:0
    v_mfma_f32_16x16x32_bf16 v[196:199], a[28:31], v[88:91], v[196:199]
    buffer_load_dwordx4 v21, s[12:15], s29 offen offset:3072 lds
    v_mfma_f32_16x16x32_bf16 v[200:203], a[24:27], v[92:95], v[200:203]
    ds_read_b128 v[76:79], v9 offset:33280
    v_mfma_f32_16x16x32_bf16 v[204:207], a[28:31], v[92:95], v[204:207]
    v_mfma_f32_16x16x32_bf16 v[192:195], a[32:35], v[96:99], v[192:195]
    ds_read_b128 v[80:83], v10 offset:512
    s_add_u32 m0, s6, 77824
    v_cvt_pk_bf16_f32 v228, v216, v217
    v_cvt_pk_bf16_f32 v229, v218, v219
    v_mfma_f32_16x16x32_bf16 v[196:199], a[36:39], v[96:99], v[196:199]
    buffer_load_dwordx4 v22, s[12:15], s29 offen offset:0 lds
    v_mfma_f32_16x16x32_bf16 v[200:203], a[32:35], v[100:103], v[200:203]
    ds_read_b128 v[84:87], v10 offset:33280
    v_mfma_f32_16x16x32_bf16 v[204:207], a[36:39], v[100:103], v[204:207]
    v_mfma_f32_16x16x32_bf16 v[192:195], a[40:43], v[104:107], v[192:195]
    ds_read_b128 v[88:91], v11 offset:512
    v_cvt_pk_bf16_f32 v230, v220, v221
    v_cvt_pk_bf16_f32 v231, v222, v223
    v_mfma_f32_16x16x32_bf16 v[196:199], a[44:47], v[104:107], v[196:199]
    buffer_load_dwordx4 v22, s[12:15], s29 offen offset:1024 lds
    v_mfma_f32_16x16x32_bf16 v[200:203], a[40:43], v[108:111], v[200:203]
    ds_read_b128 v[92:95], v11 offset:33280
    v_mfma_f32_16x16x32_bf16 v[204:207], a[44:47], v[108:111], v[204:207]
    s_waitcnt lgkmcnt(11)
    v_mfma_f32_16x16x32_bf16 v[192:195], a[48:51], v[112:115], v[192:195]
    ds_read_b128 v[96:99], v8 offset:768
    ds_write_b128 v24, v[228:231] offset:4096
    v_mfma_f32_16x16x32_bf16 v[196:199], a[52:55], v[112:115], v[196:199]
    buffer_load_dwordx4 v23, s[12:15], s29 offen offset:2048 lds
    v_mfma_f32_16x16x32_bf16 v[200:203], a[48:51], v[116:119], v[200:203]
    ds_read_b128 v[100:103], v8 offset:33536
    v_mfma_f32_16x16x32_bf16 v[204:207], a[52:55], v[116:119], v[204:207]
    s_waitcnt lgkmcnt(12)
    v_mfma_f32_16x16x32_bf16 v[192:195], a[56:59], v[120:123], v[192:195]
    ds_read_b128 v[104:107], v9 offset:768
    v_mfma_f32_16x16x32_bf16 v[196:199], a[60:63], v[120:123], v[196:199]
    buffer_load_dwordx4 v23, s[12:15], s29 offen offset:3072 lds
    v_mfma_f32_16x16x32_bf16 v[200:203], a[56:59], v[124:127], v[200:203]
    ds_read_b128 v[108:111], v9 offset:33536
    v_mfma_f32_16x16x32_bf16 v[204:207], a[60:63], v[124:127], v[204:207]
    s_waitcnt lgkmcnt(12)
    v_mfma_f32_16x16x32_bf16 v[192:195], a[64:67], v[64:67], v[192:195]
    ds_read_b128 v[112:115], v10 offset:768
    v_mfma_f32_16x16x32_bf16 v[196:199], a[68:71], v[64:67], v[196:199]
    buffer_load_dword v4, v7, s[8:11], 0 offen sc1
    v_mfma_f32_16x16x32_bf16 v[200:203], a[64:67], v[68:71], v[200:203]
    ds_read_b128 v[116:119], v10 offset:33536
    v_mfma_f32_16x16x32_bf16 v[204:207], a[68:71], v[68:71], v[204:207]
    s_cmp_lg_u32 s31, 1
    s_cbranch_scc1 .w9_215
    s_add_u32 m0, s52, 0
    s_nop 0
    buffer_load_dwordx4 v2, s[8:11], s48 offen lds
.w9_215:
    s_waitcnt lgkmcnt(11)
    v_mfma_f32_16x16x32_bf16 v[192:195], a[72:75], v[72:75], v[192:195]
    ds_read_b128 v[120:123], v11 offset:768
    v_mfma_f32_16x16x32_bf16 v[196:199], a[76:79], v[72:75], v[196:199]
    v_mfma_f32_16x16x32_bf16 v[200:203], a[72:75], v[76:79], v[200:203]
    ds_read_b128 v[124:127], v11 offset:33536
    v_mfma_f32_16x16x32_bf16 v[204:207], a[76:79], v[76:79], v[204:207]
    buffer_load_dword v29, v28, s[12:15], s29 offen
    s_waitcnt lgkmcnt(11)
    v_mfma_f32_16x16x32_bf16 v[192:195], a[80:83], v[80:83], v[192:195]
    ds_read_b128 v[64:67], v8 offset:1024
    s_add_u32 s4, s30, 3
    s_min_u32 s4, s4, s32
    v_mfma_f32_16x16x32_bf16 v[196:199], a[84:87], v[80:83], v[196:199]
    s_lshl_b32 s4, s4, 18
    v_mfma_f32_16x16x32_bf16 v[200:203], a[80:83], v[84:87], v[200:203]
    ds_read_b128 v[68:71], v8 offset:33792
    s_add_u32 s4, s4, s37
    v_mfma_f32_16x16x32_bf16 v[204:207], a[84:87], v[84:87], v[204:207]
    buffer_load_dword v29, v255, s[8:11], s4 offen
    s_waitcnt lgkmcnt(11)
    v_mfma_f32_16x16x32_bf16 v[192:195], a[88:91], v[88:91], v[192:195]
    ds_read_b128 v[72:75], v9 offset:1024
    v_mfma_f32_16x16x32_bf16 v[196:199], a[92:95], v[88:91], v[196:199]
    v_mfma_f32_16x16x32_bf16 v[200:203], a[88:91], v[92:95], v[200:203]
    ds_read_b128 v[76:79], v9 offset:33792
    v_mfma_f32_16x16x32_bf16 v[204:207], a[92:95], v[92:95], v[204:207]
    s_waitcnt lgkmcnt(10)
    v_mfma_f32_16x16x32_bf16 v[192:195], a[96:99], v[96:99], v[192:195]
    ds_read_b128 v[80:83], v10 offset:1024
    v_mfma_f32_16x16x32_bf16 v[196:199], a[100:103], v[96:99], v[196:199]
    v_mfma_f32_16x16x32_bf16 v[200:203], a[96:99], v[100:103], v[200:203]
    ds_read_b128 v[84:87], v10 offset:33792
    v_mfma_f32_16x16x32_bf16 v[204:207], a[100:103], v[100:103], v[204:207]
    s_waitcnt lgkmcnt(10)
    v_mfma_f32_16x16x32_bf16 v[192:195], a[104:107], v[104:107], v[192:195]
    ds_read_b128 v[88:91], v11 offset:1024
    v_mfma_f32_16x16x32_bf16 v[196:199], a[108:111], v[104:107], v[196:199]
    v_mfma_f32_16x16x32_bf16 v[200:203], a[104:107], v[108:111], v[200:203]
    ds_read_b128 v[92:95], v11 offset:33792
    v_mfma_f32_16x16x32_bf16 v[204:207], a[108:111], v[108:111], v[204:207]
    s_waitcnt lgkmcnt(10)
    v_mfma_f32_16x16x32_bf16 v[192:195], a[112:115], v[112:115], v[192:195]
    ds_read_b128 v[96:99], v8 offset:1280
    v_mfma_f32_16x16x32_bf16 v[196:199], a[116:119], v[112:115], v[196:199]
    v_mfma_f32_16x16x32_bf16 v[200:203], a[112:115], v[116:119], v[200:203]
    ds_read_b128 v[100:103], v8 offset:34048
    v_mfma_f32_16x16x32_bf16 v[204:207], a[116:119], v[116:119], v[204:207]
    s_waitcnt lgkmcnt(10)
    v_mfma_f32_16x16x32_bf16 v[192:195], a[120:123], v[120:123], v[192:195]
    ds_read_b128 v[104:107], v9 offset:1280
    v_mfma_f32_16x16x32_bf16 v[196:199], a[124:127], v[120:123], v[196:199]
    v_mfma_f32_16x16x32_bf16 v[200:203], a[120:123], v[124:127], v[200:203]
    ds_read_b128 v[108:111], v9 offset:34048
    v_mfma_f32_16x16x32_bf16 v[204:207], a[124:127], v[124:127], v[204:207]
    s_waitcnt lgkmcnt(10)
    v_mfma_f32_16x16x32_bf16 v[192:195], a[128:131], v[64:67], v[192:195]
    ds_read_b128 v[112:115], v10 offset:1280
    v_mfma_f32_16x16x32_bf16 v[196:199], a[132:135], v[64:67], v[196:199]
    v_mfma_f32_16x16x32_bf16 v[200:203], a[128:131], v[68:71], v[200:203]
    ds_read_b128 v[116:119], v10 offset:34048
    v_mfma_f32_16x16x32_bf16 v[204:207], a[132:135], v[68:71], v[204:207]
    s_waitcnt lgkmcnt(10)
    v_mfma_f32_16x16x32_bf16 v[192:195], a[136:139], v[72:75], v[192:195]
    ds_read_b128 v[120:123], v11 offset:1280
    v_mfma_f32_16x16x32_bf16 v[196:199], a[140:143], v[72:75], v[196:199]
    v_mfma_f32_16x16x32_bf16 v[200:203], a[136:139], v[76:79], v[200:203]
    ds_read_b128 v[124:127], v11 offset:34048
    v_mfma_f32_16x16x32_bf16 v[204:207], a[140:143], v[76:79], v[204:207]
    s_waitcnt lgkmcnt(10)
    v_mfma_f32_16x16x32_bf16 v[192:195], a[144:147], v[80:83], v[192:195]
    ds_read_b128 v[64:67], v8 offset:1536
    v_mfma_f32_16x16x32_bf16 v[196:199], a[148:151], v[80:83], v[196:199]
    v_mfma_f32_16x16x32_bf16 v[200:203], a[144:147], v[84:87], v[200:203]
    ds_read_b128 v[68:71], v8 offset:34304
    v_mfma_f32_16x16x32_bf16 v[204:207], a[148:151], v[84:87], v[204:207]
    s_waitcnt lgkmcnt(10)
    v_mfma_f32_16x16x32_bf16 v[192:195], a[152:155], v[88:91], v[192:195]
    ds_read_b128 v[72:75], v9 offset:1536
    v_mfma_f32_16x16x32_bf16 v[196:199], a[156:159], v[88:91], v[196:199]
    v_mfma_f32_16x16x32_bf16 v[200:203], a[152:155], v[92:95], v[200:203]
    ds_read_b128 v[76:79], v9 offset:34304
    v_mfma_f32_16x16x32_bf16 v[204:207], a[156:159], v[92:95], v[204:207]
    s_waitcnt lgkmcnt(10)
    v_mfma_f32_16x16x32_bf16 v[192:195], a[160:163], v[96:99], v[192:195]
    ds_read_b128 v[80:83], v10 offset:1536
    v_mfma_f32_16x16x32_bf16 v[196:199], a[164:167], v[96:99], v[196:199]
    v_mfma_f32_16x16x32_bf16 v[200:203], a[160:163], v[100:103], v[200:203]
    ds_read_b128 v[84:87], v10 offset:34304
    v_mfma_f32_16x16x32_bf16 v[204:207], a[164:167], v[100:103], v[204:207]
    s_cmp_lg_u32 s31, 0
    s_cbranch_scc1 .nm_216
    s_waitcnt vmcnt(2)
    v_min_u32_dpp v4, v4, v4 quad_perm:[1,0,3,2] row_mask:0xf bank_mask:0xf
    s_nop 1
    v_min_u32_dpp v4, v4, v4 quad_perm:[2,3,0,1] row_mask:0xf bank_mask:0xf
    s_nop 1
    v_readfirstlane_b32 s33, v4
    s_cmp_gt_u32 s33, s30
    s_cbranch_scc0 .nm_216
    s_mov_b32 s31, 1
    s_add_u32 m0, s52, 0
    s_nop 0
    buffer_load_dwordx4 v2, s[8:11], s48 offen lds
.nm_216:
    s_waitcnt lgkmcnt(10)
    v_mfma_f32_16x16x32_bf16 v[192:195], a[168:171], v[104:107], v[192:195]
    ds_read_b128 v[88:91], v11 offset:1536
    v_mfma_f32_16x16x32_bf16 v[196:199], a[172:175], v[104:107], v[196:199]
    v_mfma_f32_16x16x32_bf16 v[200:203], a[168:171], v[108:111], v[200:203]
    ds_read_b128 v[92:95], v11 offset:34304
    v_mfma_f32_16x16x32_bf16 v[204:207], a[172:175], v[108:111], v[204:207]
    s_waitcnt lgkmcnt(10)
    v_mfma_f32_16x16x32_bf16 v[192:195], a[176:179], v[112:115], v[192:195]
    ds_read_b128 v[96:99], v8 offset:1792
    v_mfma_f32_16x16x32_bf16 v[196:199], a[180:183], v[112:115], v[196:199]
    v_mfma_f32_16x16x32_bf16 v[200:203], a[176:179], v[116:119], v[200:203]
    ds_read_b128 v[100:103], v8 offset:34560
    ds_read_b128 v[104:107], v9 offset:1792
    v_mfma_f32_16x16x32_bf16 v[204:207], a[180:183], v[116:119], v[204:207]
    s_waitcnt lgkmcnt(11)
    v_mfma_f32_16x16x32_bf16 v[192:195], a[184:187], v[120:123], v[192:195]
    ds_read_b128 v[108:111], v9 offset:34560
    ds_read_b128 v[112:115], v10 offset:1792
    v_mfma_f32_16x16x32_bf16 v[196:199], a[188:191], v[120:123], v[196:199]
    s_add_u32 s28, s28, 1
    v_mfma_f32_16x16x32_bf16 v[200:203], a[184:187], v[124:127], v[200:203]
    ds_read_b128 v[116:119], v10 offset:34560
    ds_read_b128 v[120:123], v11 offset:1792
    v_mfma_f32_16x16x32_bf16 v[204:207], a[188:191], v[124:127], v[204:207]
    s_waitcnt lgkmcnt(13)
    v_mfma_f32_16x16x32_bf16 v[192:195], a[192:195], v[64:67], v[192:195]
    ds_read_b128 v[124:127], v11 offset:34560
    v_mfma_f32_16x16x32_bf16 v[196:199], a[196:199], v[64:67], v[196:199]
    v_mfma_f32_16x16x32_bf16 v[200:203], a[192:195], v[68:71], v[200:203]
    v_mfma_f32_16x16x32_bf16 v[204:207], a[196:199], v[68:71], v[204:207]
    s_waitcnt lgkmcnt(12)
    v_mfma_f32_16x16x32_bf16 v[192:195], a[200:203], v[72:75], v[192:195]
    v_mfma_f32_16x16x32_bf16 v[196:199], a[204:207], v[72:75], v[196:199]
    s_add_u32 s29, s29, 0x10000
    s_min_u32 s29, s29, 0x3f0000
    v_mfma_f32_16x16x32_bf16 v[200:203], a[200:203], v[76:79], v[200:203]
    v_mfma_f32_16x16x32_bf16 v[204:207], a[204:207], v[76:79], v[204:207]
    s_waitcnt vmcnt(3) lgkmcnt(0)
    s_barrier
    v_mfma_f32_16x16x32_bf16 v[192:195], a[208:211], v[80:83], v[192:195]
    ds_read_b128 v[208:211], v25 offset:0
    v_mfma_f32_16x16x32_bf16 v[196:199], a[212:215], v[80:83], v[196:199]
    ds_read_b128 v[128:131], v31 offset:0
    v_mfma_f32_16x16x32_bf16 v[200:203], a[208:211], v[84:87], v[200:203]
    ds_read_b128 v[144:147], v31 offset:4096
    s_add_u32 m0, s6, 0
    v_mfma_f32_16x16x32_bf16 v[204:207], a[212:215], v[84:87], v[204:207]
    buffer_load_dwordx4 v16, s[12:15], s29 offen offset:0 lds
    v_mfma_f32_16x16x32_bf16 v[192:195], a[216:219], v[88:91], v[192:195]
    ds_read_b128 v[212:215], v25 offset:1024
    s_cmp_lg_u32 s24, 0
    s_cbranch_scc1 .of_217
    v_mov_b32 v27, s41
    s_mov_b64 exec, 1
    buffer_store_dword v27, v26, s[8:11], s94 offen sc1
    s_mov_b64 exec, -1
.of_217:
    v_mfma_f32_16x16x32_bf16 v[196:199], a[220:223], v[88:91], v[196:199]
    ds_read_b128 v[132:135], v31 offset:1024
    v_mfma_f32_16x16x32_bf16 v[200:203], a[216:219], v[92:95], v[200:203]
    ds_read_b128 v[148:151], v31 offset:5120
    v_mfma_f32_16x16x32_bf16 v[204:207], a[220:223], v[92:95], v[204:207]
    buffer_load_dwordx4 v16, s[12:15], s29 offen offset:1024 lds
    v_mfma_f32_16x16x32_bf16 v[192:195], a[224:227], v[96:99], v[192:195]
    ds_read_b128 v[216:219], v25 offset:2048
    v_mfma_f32_16x16x32_bf16 v[196:199], a[228:231], v[96:99], v[196:199]
    ds_read_b128 v[136:139], v31 offset:2048
    v_mfma_f32_16x16x32_bf16 v[200:203], a[224:227], v[100:103], v[200:203]
    ds_read_b128 v[152:155], v31 offset:6144
    v_mfma_f32_16x16x32_bf16 v[204:207], a[228:231], v[100:103], v[204:207]
    buffer_load_dwordx4 v17, s[12:15], s29 offen offset:2048 lds
    v_mfma_f32_16x16x32_bf16 v[192:195], a[232:235], v[104:107], v[192:195]
    ds_read_b128 v[220:223], v25 offset:3072
    v_mfma_f32_16x16x32_bf16 v[196:199], a[236:239], v[104:107], v[196:199]
    ds_read_b128 v[140:143], v31 offset:3072
    v_mfma_f32_16x16x32_bf16 v[200:203], a[232:235], v[108:111], v[200:203]
    ds_read_b128 v[156:159], v31 offset:7168
    v_mfma_f32_16x16x32_bf16 v[204:207], a[236:239], v[108:111], v[204:207]
    buffer_load_dwordx4 v17, s[12:15], s29 offen offset:3072 lds
    v_mfma_f32_16x16x32_bf16 v[192:195], a[240:243], v[112:115], v[192:195]
    ds_read_b128 v[160:163], v5 offset:8192
    v_mfma_f32_16x16x32_bf16 v[196:199], a[244:247], v[112:115], v[196:199]
    ds_read_b128 v[164:167], v5 offset:9216
    v_mfma_f32_16x16x32_bf16 v[200:203], a[240:243], v[116:119], v[200:203]
    ds_read_b128 v[168:171], v5 offset:10240
    s_add_u32 m0, s6, 4096
    v_mfma_f32_16x16x32_bf16 v[204:207], a[244:247], v[116:119], v[204:207]
    buffer_load_dwordx4 v18, s[12:15], s29 offen offset:0 lds
    v_mfma_f32_16x16x32_bf16 v[192:195], a[248:251], v[120:123], v[192:195]
    ds_read_b128 v[172:175], v5 offset:11264
    v_mfma_f32_16x16x32_bf16 v[196:199], a[252:255], v[120:123], v[196:199]
    v_mfma_f32_16x16x32_bf16 v[200:203], a[248:251], v[124:127], v[200:203]
    v_mfma_f32_16x16x32_bf16 v[204:207], a[252:255], v[124:127], v[204:207]
    buffer_load_dwordx4 v18, s[12:15], s29 offen offset:1024 lds
    s_cmp_lt_i32 s30, 0
    s_cbranch_scc1 .fi_214
.a0_211:
    s_cmp_lg_u32 s31, 0
    s_cbranch_scc1 .hm_218
    s_cmp_gt_u32 s33, s30
    s_cbranch_scc1 .ndd_220
    s_mov_b32 s62, 0
.nd_219:
    buffer_load_dword v4, v7, s[8:11], 0 offen sc1
    s_add_u32 s62, s62, 1
    s_cmp_gt_u32 s62, 0x200000
    s_cbranch_scc1 .mg_end_1
    s_waitcnt vmcnt(0)
    v_min_u32_dpp v4, v4, v4 quad_perm:[1,0,3,2] row_mask:0xf bank_mask:0xf
    s_nop 1
    v_min_u32_dpp v4, v4, v4 quad_perm:[2,3,0,1] row_mask:0xf bank_mask:0xf
    s_nop 1
    v_readfirstlane_b32 s33, v4
    s_cmp_gt_u32 s33, s30
    s_cbranch_scc1 .ndd_220
    s_sleep 4
    s_branch .nd_219
.ndd_220:
    s_add_u32 m0, s52, 0
    s_nop 0
    buffer_load_dwordx4 v2, s[8:11], s48 offen lds
    s_waitcnt vmcnt(0)
.hm_218:
    s_waitcnt vmcnt(6) lgkmcnt(0)
    s_barrier
    s_add_u32 m0, s6, 4096
    ds_read_b128 v[176:179], v3 offset:0
    ds_read_b128 v[180:183], v3 offset:512
    ds_read_b128 v[184:187], v3 offset:1024
    ds_read_b128 v[188:191], v3 offset:1536
    v_mfma_f32_16x16x32_bf16 v[48:51], v[128:131], v[208:211], v[32:35]
    ds_read_b32 v232, v6 offset:0
    buffer_load_dwordx4 v19, s[12:15], s29 offen offset:2048 lds
    v_mfma_f32_16x16x32_bf16 v[52:55], v[144:147], v[208:211], v[36:39]
    v_min_u32_dpp v4, v4, v4 quad_perm:[1,0,3,2] row_mask:0xf bank_mask:0xf
    s_nop 1
    v_mfma_f32_16x16x32_bf16 v[48:51], v[132:135], v[212:215], v[48:51]
    ds_read_b32 v234, v6 offset:64
    v_mfma_f32_16x16x32_bf16 v[52:55], v[148:151], v[212:215], v[52:55]
    v_min_u32_dpp v4, v4, v4 quad_perm:[2,3,0,1] row_mask:0xf bank_mask:0xf
    s_nop 1
    v_mfma_f32_16x16x32_bf16 v[48:51], v[136:139], v[216:219], v[48:51]
    ds_read_b32 v236, v6 offset:512
    buffer_load_dwordx4 v19, s[12:15], s29 offen offset:3072 lds
    v_mfma_f32_16x16x32_bf16 v[52:55], v[152:155], v[216:219], v[52:55]
    v_readfirstlane_b32 s33, v4
    v_mfma_f32_16x16x32_bf16 v[48:51], v[140:143], v[220:223], v[48:51]
    ds_read_b32 v238, v6 offset:576
    v_mfma_f32_16x16x32_bf16 v[52:55], v[156:159], v[220:223], v[52:55]
    s_waitcnt lgkmcnt(4)
    v_mfma_f32_16x16x32_bf16 v[56:59], v[176:179], v[208:211], 0
    ds_read_b128 v[64:67], v12 offset:0
    ds_read_b128 v[68:71], v12 offset:32768
    ds_read_b128 v[72:75], v13 offset:0
    v_mfma_f32_16x16x32_bf16 v[56:59], v[180:183], v[212:215], v[56:59]
    ds_read_b128 v[76:79], v13 offset:32768
    ds_read_b128 v[80:83], v14 offset:0
    ds_read_b128 v[84:87], v14 offset:32768
    v_mfma_f32_16x16x32_bf16 v[56:59], v[184:187], v[216:219], v[56:59]
    ds_read_b128 v[88:91], v15 offset:0
    ds_read_b128 v[92:95], v15 offset:32768
    ds_read_b128 v[96:99], v12 offset:256
    v_mfma_f32_16x16x32_bf16 v[56:59], v[188:191], v[220:223], v[56:59]
    ds_read_b128 v[100:103], v12 offset:33024
    ds_read_b128 v[104:107], v13 offset:256
    ds_read_b128 v[108:111], v13 offset:33024
    s_add_u32 s42, s30, 1
    s_min_u32 s42, s42, 63
    s_cmp_gt_u32 s32, s42
    s_cbranch_scc1 .ndd_222
    s_mov_b32 s62, 0
.nd_221:
    buffer_load_dword v4, v7, s[8:11], s46 offen sc1
    buffer_load_dword v30, v7, s[8:11], s47 offen sc1
    s_add_u32 s62, s62, 1
    s_cmp_gt_u32 s62, 0x200000
    s_cbranch_scc1 .mg_end_1
    s_waitcnt vmcnt(0)
    v_min_u32 v4, v4, v30
    s_nop 1
    v_min_u32_dpp v4, v4, v4 quad_perm:[1,0,3,2] row_mask:0xf bank_mask:0xf
    s_nop 1
    v_min_u32_dpp v4, v4, v4 quad_perm:[2,3,0,1] row_mask:0xf bank_mask:0xf
    s_nop 1
    v_readfirstlane_b32 s32, v4
    s_cmp_gt_u32 s32, s42
    s_cbranch_scc1 .ndd_222
    s_sleep 4
    s_branch .nd_221
.ndd_222:
    s_lshl_b32 s4, s42, 18
    s_mov_b32 m0, s43
    s_add_u32 s49, s36, s4
    s_add_u32 s50, s49, 16777216
    buffer_load_dwordx4 v2, s[8:11], s49 offen lds
    v_max3_f32 v248, v48, v49, v50
    v_max3_f32 v248, v248, v51, v52
    v_max3_f32 v249, v53, v54, v55
    v_max3_f32 v248, v248, v56, v57
    v_max_f32 v30, v248, v249
    v_max_f32 v249, v248, v249
    s_nop 1
    v_permlane16_swap_b32 v249, v30
    v_max_f32 v248, v249, v30
    v_max_f32 v249, v249, v30
    buffer_load_dwordx4 v2, s[8:11], s49 offen offset:1024 lds
    s_add_u32 m0, s43, 8192
    s_nop 0
    v_permlane32_swap_b32 v248, v249
    v_max_f32 v248, v248, v249
    v_mul_f32 v248, s45, v248
    v_fma_f32 v60, v48, s45, -v248
    v_fma_f32 v61, v49, s45, -v248
    v_fma_f32 v62, v50, s45, -v248
    v_fma_f32 v63, v51, s45, -v248
    v_fma_f32 v242, v52, s45, -v248
    v_fma_f32 v243, v53, s45, -v248
    v_fma_f32 v244, v54, s45, -v248
    v_fma_f32 v245, v55, s45, -v248
    v_fma_f32 v246, v56, s45, -v248
    v_fma_f32 v247, v57, s45, -v248
    v_exp_f32 v60, v60
    v_exp_f32 v61, v61
    v_exp_f32 v62, v62
    v_exp_f32 v63, v63
    v_exp_f32 v242, v242
    v_exp_f32 v243, v243
    buffer_load_dwordx4 v2, s[8:11], s50 offen lds
    v_exp_f32 v244, v244
    v_exp_f32 v245, v245
    v_exp_f32 v246, v246
    v_exp_f32 v247, v247
    v_cvt_pk_bf16_f32 v48, v60, v61
    v_cvt_pk_bf16_f32 v49, v62, v63
    v_cvt_pk_bf16_f32 v50, v242, v243
    v_cvt_pk_bf16_f32 v51, v244, v245
    v_cvt_pk_bf16_f32 v40, v246, v247
    s_waitcnt lgkmcnt(0)
    v_mfma_f32_16x16x32_bf16 v[52:55], v[44:47], v[48:51], 0
    v_mfma_f32_16x16x32_bf16 v[52:55], v[44:47], v[40:43], v[52:55]
    v_mfma_f32_16x16x32_bf16 v[208:211], v[160:163], v[48:51], 0
    v_mfma_f32_16x16x32_bf16 v[208:211], v[232:235], v[40:43], v[208:211]
    v_mfma_f32_16x16x32_bf16 v[212:215], v[164:167], v[48:51], 0
    v_mfma_f32_16x16x32_bf16 v[212:215], v[234:237], v[40:43], v[212:215]
    buffer_load_dwordx4 v2, s[8:11], s50 offen offset:1024 lds
    v_mfma_f32_16x16x32_bf16 v[216:219], v[168:171], v[48:51], 0
    v_mfma_f32_16x16x32_bf16 v[216:219], v[236:239], v[40:43], v[216:219]
    v_mfma_f32_16x16x32_bf16 v[220:223], v[172:175], v[48:51], 0
    v_mfma_f32_16x16x32_bf16 v[220:223], v[238:241], v[40:43], v[220:223]
    v_rcp_f32 v248, v52
    s_nop 0
    v_mul_f32 v208, v248, v208
    v_mul_f32 v209, v248, v209
    v_mul_f32 v210, v248, v210
    v_mul_f32 v211, v248, v211
    v_cvt_pk_bf16_f32 v224, v208, v209
    v_cvt_pk_bf16_f32 v225, v210, v211
    v_mul_f32 v212, v248, v212
    v_mul_f32 v213, v248, v213
    v_mul_f32 v214, v248, v214
    v_mul_f32 v215, v248, v215
    v_cvt_pk_bf16_f32 v226, v212, v213
    v_cvt_pk_bf16_f32 v227, v214, v215
    buffer_store_dwordx4 v[224:227], v2, s[8:11], s53 offen offset:0 sc1
    v_mul_f32 v216, v248, v216
    v_mul_f32 v217, v248, v217
    v_mul_f32 v218, v248, v218
    v_mul_f32 v219, v248, v219
    v_cvt_pk_bf16_f32 v228, v216, v217
    v_cvt_pk_bf16_f32 v229, v218, v219
    v_mul_f32 v220, v248, v220
    v_mul_f32 v221, v248, v221
    v_mul_f32 v222, v248, v222
    v_mul_f32 v223, v248, v223
    v_cvt_pk_bf16_f32 v230, v220, v221
    v_cvt_pk_bf16_f32 v231, v222, v223
    buffer_store_dwordx4 v[228:231], v2, s[8:11], s53 offen offset:1024 sc1
    s_add_u32 s41, s30, 1
    s_cmp_eq_u32 s41, 64
    s_cbranch_scc1 .qd_213
.sk_212:
    s_mov_b32 s30, s41
    s_lshl_b32 s4, s30, 18
    s_add_u32 s53, s40, s4
    s_lshr_b32 s4, s4, 1
    s_add_u32 s48, s39, s4
    s_cmp_gt_u32 s33, s30
    s_cselect_b32 s31, 1, 0
    v_mfma_f32_16x16x32_bf16 v[208:211], a[0:3], v[64:67], 0
    ds_read_b128 v[112:115], v14 offset:256
    s_add_u32 m0, s6, 8192
    v_mfma_f32_16x16x32_bf16 v[212:215], a[4:7], v[64:67], 0
    buffer_load_dwordx4 v20, s[12:15], s29 offen offset:0 lds
    v_mfma_f32_16x16x32_bf16 v[216:219], a[0:3], v[68:71], 0
    ds_read_b128 v[116:119], v14 offset:33024
    v_mfma_f32_16x16x32_bf16 v[220:223], a[4:7], v[68:71], 0
    v_mfma_f32_16x16x32_bf16 v[208:211], a[8:11], v[72:75], v[208:211]
    ds_read_b128 v[120:123], v15 offset:256
    v_cvt_pk_bf16_f32 v224, v192, v193
    v_cvt_pk_bf16_f32 v225, v194, v195
    v_mfma_f32_16x16x32_bf16 v[212:215], a[12:15], v[72:75], v[212:215]
    buffer_load_dwordx4 v20, s[12:15], s29 offen offset:1024 lds
    v_mfma_f32_16x16x32_bf16 v[216:219], a[8:11], v[76:79], v[216:219]
    ds_read_b128 v[124:127], v15 offset:33024
    v_mfma_f32_16x16x32_bf16 v[220:223], a[12:15], v[76:79], v[220:223]
    v_mfma_f32_16x16x32_bf16 v[208:211], a[16:19], v[80:83], v[208:211]
    ds_read_b128 v[64:67], v12 offset:512
    v_cvt_pk_bf16_f32 v226, v196, v197
    v_cvt_pk_bf16_f32 v227, v198, v199
    v_mfma_f32_16x16x32_bf16 v[212:215], a[20:23], v[80:83], v[212:215]
    buffer_load_dwordx4 v21, s[12:15], s29 offen offset:2048 lds
    v_mfma_f32_16x16x32_bf16 v[216:219], a[16:19], v[84:87], v[216:219]
    ds_read_b128 v[68:71], v12 offset:33280
    v_mfma_f32_16x16x32_bf16 v[220:223], a[20:23], v[84:87], v[220:223]
    v_mfma_f32_16x16x32_bf16 v[208:211], a[24:27], v[88:91], v[208:211]
    ds_read_b128 v[72:75], v13 offset:512
    ds_write_b128 v24, v[224:227] offset:0
    v_mfma_f32_16x16x32_bf16 v[212:215], a[28:31], v[88:91], v[212:215]
    buffer_load_dwordx4 v21, s[12:15], s29 offen offset:3072 lds
    v_mfma_f32_16x16x32_bf16 v[216:219], a[24:27], v[92:95], v[216:219]
    ds_read_b128 v[76:79], v13 offset:33280
    v_mfma_f32_16x16x32_bf16 v[220:223], a[28:31], v[92:95], v[220:223]
    v_mfma_f32_16x16x32_bf16 v[208:211], a[32:35], v[96:99], v[208:211]
    ds_read_b128 v[80:83], v14 offset:512
    s_add_u32 m0, s6, 12288
    v_cvt_pk_bf16_f32 v228, v200, v201
    v_cvt_pk_bf16_f32 v229, v202, v203
    v_mfma_f32_16x16x32_bf16 v[212:215], a[36:39], v[96:99], v[212:215]
    buffer_load_dwordx4 v22, s[12:15], s29 offen offset:0 lds
    v_mfma_f32_16x16x32_bf16 v[216:219], a[32:35], v[100:103], v[216:219]
    ds_read_b128 v[84:87], v14 offset:33280
    v_mfma_f32_16x16x32_bf16 v[220:223], a[36:39], v[100:103], v[220:223]
    v_mfma_f32_16x16x32_bf16 v[208:211], a[40:43], v[104:107], v[208:211]
    ds_read_b128 v[88:91], v15 offset:512
    v_cvt_pk_bf16_f32 v230, v204, v205
    v_cvt_pk_bf16_f32 v231, v206, v207
    v_mfma_f32_16x16x32_bf16 v[212:215], a[44:47], v[104:107], v[212:215]
    buffer_load_dwordx4 v22, s[12:15], s29 offen offset:1024 lds
    v_mfma_f32_16x16x32_bf16 v[216:219], a[40:43], v[108:111], v[216:219]
    ds_read_b128 v[92:95], v15 offset:33280
    v_mfma_f32_16x16x32_bf16 v[220:223], a[44:47], v[108:111], v[220:223]
    s_waitcnt lgkmcnt(11)
    v_mfma_f32_16x16x32_bf16 v[208:211], a[48:51], v[112:115], v[208:211]
    ds_read_b128 v[96:99], v12 offset:768
    ds_write_b128 v24, v[228:231] offset:4096
    v_mfma_f32_16x16x32_bf16 v[212:215], a[52:55], v[112:115], v[212:215]
    buffer_load_dwordx4 v23, s[12:15], s29 offen offset:2048 lds
    v_mfma_f32_16x16x32_bf16 v[216:219], a[48:51], v[116:119], v[216:219]
    ds_read_b128 v[100:103], v12 offset:33536
    v_mfma_f32_16x16x32_bf16 v[220:223], a[52:55], v[116:119], v[220:223]
    s_waitcnt lgkmcnt(12)
    v_mfma_f32_16x16x32_bf16 v[208:211], a[56:59], v[120:123], v[208:211]
    ds_read_b128 v[104:107], v13 offset:768
    v_mfma_f32_16x16x32_bf16 v[212:215], a[60:63], v[120:123], v[212:215]
    buffer_load_dwordx4 v23, s[12:15], s29 offen offset:3072 lds
    v_mfma_f32_16x16x32_bf16 v[216:219], a[56:59], v[124:127], v[216:219]
    ds_read_b128 v[108:111], v13 offset:33536
    v_mfma_f32_16x16x32_bf16 v[220:223], a[60:63], v[124:127], v[220:223]
    s_waitcnt lgkmcnt(12)
    v_mfma_f32_16x16x32_bf16 v[208:211], a[64:67], v[64:67], v[208:211]
    ds_read_b128 v[112:115], v14 offset:768
    v_mfma_f32_16x16x32_bf16 v[212:215], a[68:71], v[64:67], v[212:215]
    buffer_load_dword v4, v7, s[8:11], 0 offen sc1
    v_mfma_f32_16x16x32_bf16 v[216:219], a[64:67], v[68:71], v[216:219]
    ds_read_b128 v[116:119], v14 offset:33536
    v_mfma_f32_16x16x32_bf16 v[220:223], a[68:71], v[68:71], v[220:223]
    s_cmp_lg_u32 s31, 1
    s_cbranch_scc1 .w9_223
    s_add_u32 m0, s52, 4096
    s_nop 0
    buffer_load_dwordx4 v2, s[8:11], s48 offen lds
.w9_223:
    s_waitcnt lgkmcnt(11)
    v_mfma_f32_16x16x32_bf16 v[208:211], a[72:75], v[72:75], v[208:211]
    ds_read_b128 v[120:123], v15 offset:768
    v_mfma_f32_16x16x32_bf16 v[212:215], a[76:79], v[72:75], v[212:215]
    v_mfma_f32_16x16x32_bf16 v[216:219], a[72:75], v[76:79], v[216:219]
    ds_read_b128 v[124:127], v15 offset:33536
    v_mfma_f32_16x16x32_bf16 v[220:223], a[76:79], v[76:79], v[220:223]
    buffer_load_dword v29, v28, s[12:15], s29 offen
    s_waitcnt lgkmcnt(11)
    v_mfma_f32_16x16x32_bf16 v[208:211], a[80:83], v[80:83], v[208:211]
    ds_read_b128 v[64:67], v12 offset:1024
    s_add_u32 s4, s30, 3
    s_min_u32 s4, s4, s32
    v_mfma_f32_16x16x32_bf16 v[212:215], a[84:87], v[80:83], v[212:215]
    s_lshl_b32 s4, s4, 18
    v_mfma_f32_16x16x32_bf16 v[216:219], a[80:83], v[84:87], v[216:219]
    ds_read_b128 v[68:71], v12 offset:33792
    s_add_u32 s4, s4, s37
    v_mfma_f32_16x16x32_bf16 v[220:223], a[84:87], v[84:87], v[220:223]
    buffer_load_dword v29, v255, s[8:11], s4 offen
    s_waitcnt lgkmcnt(11)
    v_mfma_f32_16x16x32_bf16 v[208:211], a[88:91], v[88:91], v[208:211]
    ds_read_b128 v[72:75], v13 offset:1024
    v_mfma_f32_16x16x32_bf16 v[212:215], a[92:95], v[88:91], v[212:215]
    v_mfma_f32_16x16x32_bf16 v[216:219], a[88:91], v[92:95], v[216:219]
    ds_read_b128 v[76:79], v13 offset:33792
    v_mfma_f32_16x16x32_bf16 v[220:223], a[92:95], v[92:95], v[220:223]
    s_waitcnt lgkmcnt(10)
    v_mfma_f32_16x16x32_bf16 v[208:211], a[96:99], v[96:99], v[208:211]
    ds_read_b128 v[80:83], v14 offset:1024
    v_mfma_f32_16x16x32_bf16 v[212:215], a[100:103], v[96:99], v[212:215]
    v_mfma_f32_16x16x32_bf16 v[216:219], a[96:99], v[100:103], v[216:219]
    ds_read_b128 v[84:87], v14 offset:33792
    v_mfma_f32_16x16x32_bf16 v[220:223], a[100:103], v[100:103], v[220:223]
    s_waitcnt lgkmcnt(10)
    v_mfma_f32_16x16x32_bf16 v[208:211], a[104:107], v[104:107], v[208:211]
    ds_read_b128 v[88:91], v15 offset:1024
    v_mfma_f32_16x16x32_bf16 v[212:215], a[108:111], v[104:107], v[212:215]
    v_mfma_f32_16x16x32_bf16 v[216:219], a[104:107], v[108:111], v[216:219]
    ds_read_b128 v[92:95], v15 offset:33792
    v_mfma_f32_16x16x32_bf16 v[220:223], a[108:111], v[108:111], v[220:223]
    s_waitcnt lgkmcnt(10)
    v_mfma_f32_16x16x32_bf16 v[208:211], a[112:115], v[112:115], v[208:211]
    ds_read_b128 v[96:99], v12 offset:1280
    v_mfma_f32_16x16x32_bf16 v[212:215], a[116:119], v[112:115], v[212:215]
    v_mfma_f32_16x16x32_bf16 v[216:219], a[112:115], v[116:119], v[216:219]
    ds_read_b128 v[100:103], v12 offset:34048
    v_mfma_f32_16x16x32_bf16 v[220:223], a[116:119], v[116:119], v[220:223]
    s_waitcnt lgkmcnt(10)
    v_mfma_f32_16x16x32_bf16 v[208:211], a[120:123], v[120:123], v[208:211]
    ds_read_b128 v[104:107], v13 offset:1280
    v_mfma_f32_16x16x32_bf16 v[212:215], a[124:127], v[120:123], v[212:215]
    v_mfma_f32_16x16x32_bf16 v[216:219], a[120:123], v[124:127], v[216:219]
    ds_read_b128 v[108:111], v13 offset:34048
    v_mfma_f32_16x16x32_bf16 v[220:223], a[124:127], v[124:127], v[220:223]
    s_waitcnt lgkmcnt(10)
    v_mfma_f32_16x16x32_bf16 v[208:211], a[128:131], v[64:67], v[208:211]
    ds_read_b128 v[112:115], v14 offset:1280
    v_mfma_f32_16x16x32_bf16 v[212:215], a[132:135], v[64:67], v[212:215]
    v_mfma_f32_16x16x32_bf16 v[216:219], a[128:131], v[68:71], v[216:219]
    ds_read_b128 v[116:119], v14 offset:34048
    v_mfma_f32_16x16x32_bf16 v[220:223], a[132:135], v[68:71], v[220:223]
    s_waitcnt lgkmcnt(10)
    v_mfma_f32_16x16x32_bf16 v[208:211], a[136:139], v[72:75], v[208:211]
    ds_read_b128 v[120:123], v15 offset:1280
    v_mfma_f32_16x16x32_bf16 v[212:215], a[140:143], v[72:75], v[212:215]
    v_mfma_f32_16x16x32_bf16 v[216:219], a[136:139], v[76:79], v[216:219]
    ds_read_b128 v[124:127], v15 offset:34048
    v_mfma_f32_16x16x32_bf16 v[220:223], a[140:143], v[76:79], v[220:223]
    s_waitcnt lgkmcnt(10)
    v_mfma_f32_16x16x32_bf16 v[208:211], a[144:147], v[80:83], v[208:211]
    ds_read_b128 v[64:67], v12 offset:1536
    v_mfma_f32_16x16x32_bf16 v[212:215], a[148:151], v[80:83], v[212:215]
    v_mfma_f32_16x16x32_bf16 v[216:219], a[144:147], v[84:87], v[216:219]
    ds_read_b128 v[68:71], v12 offset:34304
    v_mfma_f32_16x16x32_bf16 v[220:223], a[148:151], v[84:87], v[220:223]
    s_waitcnt lgkmcnt(10)
    v_mfma_f32_16x16x32_bf16 v[208:211], a[152:155], v[88:91], v[208:211]
    ds_read_b128 v[72:75], v13 offset:1536
    v_mfma_f32_16x16x32_bf16 v[212:215], a[156:159], v[88:91], v[212:215]
    v_mfma_f32_16x16x32_bf16 v[216:219], a[152:155], v[92:95], v[216:219]
    ds_read_b128 v[76:79], v13 offset:34304
    v_mfma_f32_16x16x32_bf16 v[220:223], a[156:159], v[92:95], v[220:223]
    s_waitcnt lgkmcnt(10)
    v_mfma_f32_16x16x32_bf16 v[208:211], a[160:163], v[96:99], v[208:211]
    ds_read_b128 v[80:83], v14 offset:1536
    v_mfma_f32_16x16x32_bf16 v[212:215], a[164:167], v[96:99], v[212:215]
    v_mfma_f32_16x16x32_bf16 v[216:219], a[160:163], v[100:103], v[216:219]
    ds_read_b128 v[84:87], v14 offset:34304
    v_mfma_f32_16x16x32_bf16 v[220:223], a[164:167], v[100:103], v[220:223]
    s_cmp_lg_u32 s31, 0
    s_cbranch_scc1 .nm_224
    s_waitcnt vmcnt(2)
    v_min_u32_dpp v4, v4, v4 quad_perm:[1,0,3,2] row_mask:0xf bank_mask:0xf
    s_nop 1
    v_min_u32_dpp v4, v4, v4 quad_perm:[2,3,0,1] row_mask:0xf bank_mask:0xf
    s_nop 1
    v_readfirstlane_b32 s33, v4
    s_cmp_gt_u32 s33, s30
    s_cbranch_scc0 .nm_224
    s_mov_b32 s31, 1
    s_add_u32 m0, s52, 4096
    s_nop 0
    buffer_load_dwordx4 v2, s[8:11], s48 offen lds
.nm_224:
    s_waitcnt lgkmcnt(10)
    v_mfma_f32_16x16x32_bf16 v[208:211], a[168:171], v[104:107], v[208:211]
    ds_read_b128 v[88:91], v15 offset:1536
    v_mfma_f32_16x16x32_bf16 v[212:215], a[172:175], v[104:107], v[212:215]
    v_mfma_f32_16x16x32_bf16 v[216:219], a[168:171], v[108:111], v[216:219]
    ds_read_b128 v[92:95], v15 offset:34304
    v_mfma_f32_16x16x32_bf16 v[220:223], a[172:175], v[108:111], v[220:223]
    s_waitcnt lgkmcnt(10)
    v_mfma_f32_16x16x32_bf16 v[208:211], a[176:179], v[112:115], v[208:211]
    ds_read_b128 v[96:99], v12 offset:1792
    v_mfma_f32_16x16x32_bf16 v[212:215], a[180:183], v[112:115], v[212:215]
    v_mfma_f32_16x16x32_bf16 v[216:219], a[176:179], v[116:119], v[216:219]
    ds_read_b128 v[100:103], v12 offset:34560
    ds_read_b128 v[104:107], v13 offset:1792
    v_mfma_f32_16x16x32_bf16 v[220:223], a[180:183], v[116:119], v[220:223]
    s_waitcnt lgkmcnt(11)
    v_mfma_f32_16x16x32_bf16 v[208:211], a[184:187], v[120:123], v[208:211]
    ds_read_b128 v[108:111], v13 offset:34560
    ds_read_b128 v[112:115], v14 offset:1792
    v_mfma_f32_16x16x32_bf16 v[212:215], a[188:191], v[120:123], v[212:215]
    s_add_u32 s28, s28, 1
    v_mfma_f32_16x16x32_bf16 v[216:219], a[184:187], v[124:127], v[216:219]
    ds_read_b128 v[116:119], v14 offset:34560
    ds_read_b128 v[120:123], v15 offset:1792
    v_mfma_f32_16x16x32_bf16 v[220:223], a[188:191], v[124:127], v[220:223]
    s_waitcnt lgkmcnt(13)
    v_mfma_f32_16x16x32_bf16 v[208:211], a[192:195], v[64:67], v[208:211]
    ds_read_b128 v[124:127], v15 offset:34560
    v_mfma_f32_16x16x32_bf16 v[212:215], a[196:199], v[64:67], v[212:215]
    v_mfma_f32_16x16x32_bf16 v[216:219], a[192:195], v[68:71], v[216:219]
    v_mfma_f32_16x16x32_bf16 v[220:223], a[196:199], v[68:71], v[220:223]
    s_waitcnt lgkmcnt(12)
    v_mfma_f32_16x16x32_bf16 v[208:211], a[200:203], v[72:75], v[208:211]
    v_mfma_f32_16x16x32_bf16 v[212:215], a[204:207], v[72:75], v[212:215]
    s_add_u32 s29, s29, 0x10000
    s_min_u32 s29, s29, 0x3f0000
    v_mfma_f32_16x16x32_bf16 v[216:219], a[200:203], v[76:79], v[216:219]
    v_mfma_f32_16x16x32_bf16 v[220:223], a[204:207], v[76:79], v[220:223]
    s_waitcnt vmcnt(3) lgkmcnt(0)
    s_barrier
    v_mfma_f32_16x16x32_bf16 v[208:211], a[208:211], v[80:83], v[208:211]
    ds_read_b128 v[192:195], v25 offset:0
    v_mfma_f32_16x16x32_bf16 v[212:215], a[212:215], v[80:83], v[212:215]
    ds_read_b128 v[128:131], v31 offset:0
    v_mfma_f32_16x16x32_bf16 v[216:219], a[208:211], v[84:87], v[216:219]
    ds_read_b128 v[144:147], v31 offset:4096
    s_add_u32 m0, s6, 65536
    v_mfma_f32_16x16x32_bf16 v[220:223], a[212:215], v[84:87], v[220:223]
    buffer_load_dwordx4 v16, s[12:15], s29 offen offset:0 lds
    v_mfma_f32_16x16x32_bf16 v[208:211], a[216:219], v[88:91], v[208:211]
    ds_read_b128 v[196:199], v25 offset:1024
    s_cmp_lg_u32 s24, 0
    s_cbranch_scc1 .of_225
    v_mov_b32 v27, s41
    s_mov_b64 exec, 1
    buffer_store_dword v27, v26, s[8:11], s94 offen sc1
    s_mov_b64 exec, -1
.of_225:
    v_mfma_f32_16x16x32_bf16 v[212:215], a[220:223], v[88:91], v[212:215]
    ds_read_b128 v[132:135], v31 offset:1024
    v_mfma_f32_16x16x32_bf16 v[216:219], a[216:219], v[92:95], v[216:219]
    ds_read_b128 v[148:151], v31 offset:5120
    v_mfma_f32_16x16x32_bf16 v[220:223], a[220:223], v[92:95], v[220:223]
    buffer_load_dwordx4 v16, s[12:15], s29 offen offset:1024 lds
    v_mfma_f32_16x16x32_bf16 v[208:211], a[224:227], v[96:99], v[208:211]
    ds_read_b128 v[200:203], v25 offset:2048
    v_mfma_f32_16x16x32_bf16 v[212:215], a[228:231], v[96:99], v[212:215]
    ds_read_b128 v[136:139], v31 offset:2048
    v_mfma_f32_16x16x32_bf16 v[216:219], a[224:227], v[100:103], v[216:219]
    ds_read_b128 v[152:155], v31 offset:6144
    v_mfma_f32_16x16x32_bf16 v[220:223], a[228:231], v[100:103], v[220:223]
    buffer_load_dwordx4 v17, s[12:15], s29 offen offset:2048 lds
    v_mfma_f32_16x16x32_bf16 v[208:211], a[232:235], v[104:107], v[208:211]
    ds_read_b128 v[204:207], v25 offset:3072
    v_mfma_f32_16x16x32_bf16 v[212:215], a[236:239], v[104:107], v[212:215]
    ds_read_b128 v[140:143], v31 offset:3072
    v_mfma_f32_16x16x32_bf16 v[216:219], a[232:235], v[108:111], v[216:219]
    ds_read_b128 v[156:159], v31 offset:7168
    v_mfma_f32_16x16x32_bf16 v[220:223], a[236:239], v[108:111], v[220:223]
    buffer_load_dwordx4 v17, s[12:15], s29 offen offset:3072 lds
    v_mfma_f32_16x16x32_bf16 v[208:211], a[240:243], v[112:115], v[208:211]
    ds_read_b128 v[160:163], v5 offset:8192
    v_mfma_f32_16x16x32_bf16 v[212:215], a[244:247], v[112:115], v[212:215]
    ds_read_b128 v[164:167], v5 offset:9216
    v_mfma_f32_16x16x32_bf16 v[216:219], a[240:243], v[116:119], v[216:219]
    ds_read_b128 v[168:171], v5 offset:10240
    s_add_u32 m0, s6, 69632
    v_mfma_f32_16x16x32_bf16 v[220:223], a[244:247], v[116:119], v[220:223]
    buffer_load_dwordx4 v18, s[12:15], s29 offen offset:0 lds
    v_mfma_f32_16x16x32_bf16 v[208:211], a[248:251], v[120:123], v[208:211]
    ds_read_b128 v[172:175], v5 offset:11264
    v_mfma_f32_16x16x32_bf16 v[212:215], a[252:255], v[120:123], v[212:215]
    v_mfma_f32_16x16x32_bf16 v[216:219], a[248:251], v[124:127], v[216:219]
    v_mfma_f32_16x16x32_bf16 v[220:223], a[252:255], v[124:127], v[220:223]
    buffer_load_dwordx4 v18, s[12:15], s29 offen offset:1024 lds
    s_cmp_lg_u32 s31, 0
    s_cbranch_scc1 .hm_226
    s_cmp_gt_u32 s33, s30
    s_cbranch_scc1 .ndd_228
    s_mov_b32 s62, 0
.nd_227:
    buffer_load_dword v4, v7, s[8:11], 0 offen sc1
    s_add_u32 s62, s62, 1
    s_cmp_gt_u32 s62, 0x200000
    s_cbranch_scc1 .mg_end_1
    s_waitcnt vmcnt(0)
    v_min_u32_dpp v4, v4, v4 quad_perm:[1,0,3,2] row_mask:0xf bank_mask:0xf
    s_nop 1
    v_min_u32_dpp v4, v4, v4 quad_perm:[2,3,0,1] row_mask:0xf bank_mask:0xf
    s_nop 1
    v_readfirstlane_b32 s33, v4
    s_cmp_gt_u32 s33, s30
    s_cbranch_scc1 .ndd_228
    s_sleep 4
    s_branch .nd_227
.ndd_228:
    s_add_u32 m0, s52, 4096
    s_nop 0
    buffer_load_dwordx4 v2, s[8:11], s48 offen lds
    s_waitcnt vmcnt(0)
.hm_226:
    s_waitcnt vmcnt(6) lgkmcnt(0)
    s_barrier
    s_add_u32 m0, s6, 69632
    ds_read_b128 v[176:179], v3 offset:4096
    ds_read_b128 v[180:183], v3 offset:4608
    ds_read_b128 v[184:187], v3 offset:5120
    ds_read_b128 v[188:191], v3 offset:5632
    v_mfma_f32_16x16x32_bf16 v[48:51], v[128:131], v[192:195], v[32:35]
    ds_read_b32 v232, v6 offset:4096
    buffer_load_dwordx4 v19, s[12:15], s29 offen offset:2048 lds
    v_mfma_f32_16x16x32_bf16 v[52:55], v[144:147], v[192:195], v[36:39]
    v_min_u32_dpp v4, v4, v4 quad_perm:[1,0,3,2] row_mask:0xf bank_mask:0xf
    s_nop 1
    v_mfma_f32_16x16x32_bf16 v[48:51], v[132:135], v[196:199], v[48:51]
    ds_read_b32 v234, v6 offset:4160
    v_mfma_f32_16x16x32_bf16 v[52:55], v[148:151], v[196:199], v[52:55]
    v_min_u32_dpp v4, v4, v4 quad_perm:[2,3,0,1] row_mask:0xf bank_mask:0xf
    s_nop 1
    v_mfma_f32_16x16x32_bf16 v[48:51], v[136:139], v[200:203], v[48:51]
    ds_read_b32 v236, v6 offset:4608
    buffer_load_dwordx4 v19, s[12:15], s29 offen offset:3072 lds
    v_mfma_f32_16x16x32_bf16 v[52:55], v[152:155], v[200:203], v[52:55]
    v_readfirstlane_b32 s33, v4
    v_mfma_f32_16x16x32_bf16 v[48:51], v[140:143], v[204:207], v[48:51]
    ds_read_b32 v238, v6 offset:4672
    v_mfma_f32_16x16x32_bf16 v[52:55], v[156:159], v[204:207], v[52:55]
    s_waitcnt lgkmcnt(4)
    v_mfma_f32_16x16x32_bf16 v[56:59], v[176:179], v[192:195], 0
    ds_read_b128 v[64:67], v8 offset:0
    ds_read_b128 v[68:71], v8 offset:32768
    ds_read_b128 v[72:75], v9 offset:0
    v_mfma_f32_16x16x32_bf16 v[56:59], v[180:183], v[196:199], v[56:59]
    ds_read_b128 v[76:79], v9 offset:32768
    ds_read_b128 v[80:83], v10 offset:0
    ds_read_b128 v[84:87], v10 offset:32768
    v_mfma_f32_16x16x32_bf16 v[56:59], v[184:187], v[200:203], v[56:59]
    ds_read_b128 v[88:91], v11 offset:0
    ds_read_b128 v[92:95], v11 offset:32768
    ds_read_b128 v[96:99], v8 offset:256
    v_mfma_f32_16x16x32_bf16 v[56:59], v[188:191], v[204:207], v[56:59]
    ds_read_b128 v[100:103], v8 offset:33024
    ds_read_b128 v[104:107], v9 offset:256
    ds_read_b128 v[108:111], v9 offset:33024
    s_add_u32 s42, s30, 1
    s_min_u32 s42, s42, 63
    s_cmp_gt_u32 s32, s42
    s_cbranch_scc1 .ndd_230
    s_mov_b32 s62, 0
.nd_229:
    buffer_load_dword v4, v7, s[8:11], s46 offen sc1
    buffer_load_dword v30, v7, s[8:11], s47 offen sc1
    s_add_u32 s62, s62, 1
    s_cmp_gt_u32 s62, 0x200000
    s_cbranch_scc1 .mg_end_1
    s_waitcnt vmcnt(0)
    v_min_u32 v4, v4, v30
    s_nop 1
    v_min_u32_dpp v4, v4, v4 quad_perm:[1,0,3,2] row_mask:0xf bank_mask:0xf
    s_nop 1
    v_min_u32_dpp v4, v4, v4 quad_perm:[2,3,0,1] row_mask:0xf bank_mask:0xf
    s_nop 1
    v_readfirstlane_b32 s32, v4
    s_cmp_gt_u32 s32, s42
    s_cbranch_scc1 .ndd_230
    s_sleep 4
    s_branch .nd_229
.ndd_230:
    s_lshl_b32 s4, s42, 18
    s_mov_b32 m0, s43
    s_add_u32 s49, s36, s4
    s_add_u32 s50, s49, 16777216
    buffer_load_dwordx4 v2, s[8:11], s49 offen lds
    v_max3_f32 v248, v48, v49, v50
    v_max3_f32 v248, v248, v51, v52
    v_max3_f32 v249, v53, v54, v55
    v_max3_f32 v248, v248, v56, v57
    v_max_f32 v30, v248, v249
    v_max_f32 v249, v248, v249
    s_nop 1
    v_permlane16_swap_b32 v249, v30
    v_max_f32 v248, v249, v30
    v_max_f32 v249, v249, v30
    buffer_load_dwordx4 v2, s[8:11], s49 offen offset:1024 lds
    s_add_u32 m0, s43, 8192
    s_nop 0
    v_permlane32_swap_b32 v248, v249
    v_max_f32 v248, v248, v249
    v_mul_f32 v248, s45, v248
    v_fma_f32 v60, v48, s45, -v248
    v_fma_f32 v61, v49, s45, -v248
    v_fma_f32 v62, v50, s45, -v248
    v_fma_f32 v63, v51, s45, -v248
    v_fma_f32 v242, v52, s45, -v248
    v_fma_f32 v243, v53, s45, -v248
    v_fma_f32 v244, v54, s45, -v248
    v_fma_f32 v245, v55, s45, -v248
    v_fma_f32 v246, v56, s45, -v248
    v_fma_f32 v247, v57, s45, -v248
    v_exp_f32 v60, v60
    v_exp_f32 v61, v61
    v_exp_f32 v62, v62
    v_exp_f32 v63, v63
    v_exp_f32 v242, v242
    v_exp_f32 v243, v243
    buffer_load_dwordx4 v2, s[8:11], s50 offen lds
    v_exp_f32 v244, v244
    v_exp_f32 v245, v245
    v_exp_f32 v246, v246
    v_exp_f32 v247, v247
    v_cvt_pk_bf16_f32 v48, v60, v61
    v_cvt_pk_bf16_f32 v49, v62, v63
    v_cvt_pk_bf16_f32 v50, v242, v243
    v_cvt_pk_bf16_f32 v51, v244, v245
    v_cvt_pk_bf16_f32 v40, v246, v247
    s_waitcnt lgkmcnt(0)
    v_mfma_f32_16x16x32_bf16 v[52:55], v[44:47], v[48:51], 0
    v_mfma_f32_16x16x32_bf16 v[52:55], v[44:47], v[40:43], v[52:55]
    v_mfma_f32_16x16x32_bf16 v[192:195], v[160:163], v[48:51], 0
    v_mfma_f32_16x16x32_bf16 v[192:195], v[232:235], v[40:43], v[192:195]
    v_mfma_f32_16x16x32_bf16 v[196:199], v[164:167], v[48:51], 0
    v_mfma_f32_16x16x32_bf16 v[196:199], v[234:237], v[40:43], v[196:199]
    buffer_load_dwordx4 v2, s[8:11], s50 offen offset:1024 lds
    v_mfma_f32_16x16x32_bf16 v[200:203], v[168:171], v[48:51], 0
    v_mfma_f32_16x16x32_bf16 v[200:203], v[236:239], v[40:43], v[200:203]
    v_mfma_f32_16x16x32_bf16 v[204:207], v[172:175], v[48:51], 0
    v_mfma_f32_16x16x32_bf16 v[204:207], v[238:241], v[40:43], v[204:207]
    v_rcp_f32 v248, v52
    s_nop 0
    v_mul_f32 v192, v248, v192
    v_mul_f32 v193, v248, v193
    v_mul_f32 v194, v248, v194
    v_mul_f32 v195, v248, v195
    v_cvt_pk_bf16_f32 v224, v192, v193
    v_cvt_pk_bf16_f32 v225, v194, v195
    v_mul_f32 v196, v248, v196
    v_mul_f32 v197, v248, v197
    v_mul_f32 v198, v248, v198
    v_mul_f32 v199, v248, v199
    v_cvt_pk_bf16_f32 v226, v196, v197
    v_cvt_pk_bf16_f32 v227, v198, v199
    buffer_store_dwordx4 v[224:227], v2, s[8:11], s53 offen offset:0 sc1
    v_mul_f32 v200, v248, v200
    v_mul_f32 v201, v248, v201
    v_mul_f32 v202, v248, v202
    v_mul_f32 v203, v248, v203
    v_cvt_pk_bf16_f32 v228, v200, v201
    v_cvt_pk_bf16_f32 v229, v202, v203
    v_mul_f32 v204, v248, v204
    v_mul_f32 v205, v248, v205
    v_mul_f32 v206, v248, v206
    v_mul_f32 v207, v248, v207
    v_cvt_pk_bf16_f32 v230, v204, v205
    v_cvt_pk_bf16_f32 v231, v206, v207
    buffer_store_dwordx4 v[228:231], v2, s[8:11], s53 offen offset:1024 sc1
    s_add_u32 s41, s30, 1
    s_mov_b32 s30, s41
    s_lshl_b32 s4, s30, 18
    s_add_u32 s53, s40, s4
    s_lshr_b32 s4, s4, 1
    s_add_u32 s48, s39, s4
    s_cmp_gt_u32 s33, s30
    s_cselect_b32 s31, 1, 0
    s_cmp_lt_u32 s28, 64
    s_cbranch_scc1 .ql_210
    v_cvt_pk_bf16_f32 v224, v208, v209
    v_cvt_pk_bf16_f32 v225, v210, v211
    v_cvt_pk_bf16_f32 v226, v212, v213
    v_cvt_pk_bf16_f32 v227, v214, v215
    v_cvt_pk_bf16_f32 v228, v216, v217
    v_cvt_pk_bf16_f32 v229, v218, v219
    v_cvt_pk_bf16_f32 v230, v220, v221
    v_cvt_pk_bf16_f32 v231, v222, v223
    ds_write_b128 v24, v[224:227] offset:0
    ds_write_b128 v24, v[228:231] offset:4096
    s_mov_b32 s31, 0
    s_waitcnt vmcnt(0) lgkmcnt(0)
    v_mov_b32 v4, s33
    s_barrier
    ds_read_b128 v[208:211], v25 offset:0
    ds_read_b128 v[128:131], v31 offset:0
    ds_read_b128 v[144:147], v31 offset:4096
    ds_read_b128 v[212:215], v25 offset:1024
    ds_read_b128 v[132:135], v31 offset:1024
    ds_read_b128 v[148:151], v31 offset:5120
    ds_read_b128 v[216:219], v25 offset:2048
    ds_read_b128 v[136:139], v31 offset:2048
    ds_read_b128 v[152:155], v31 offset:6144
    ds_read_b128 v[220:223], v25 offset:3072
    ds_read_b128 v[140:143], v31 offset:3072
    ds_read_b128 v[156:159], v31 offset:7168
    ds_read_b128 v[160:163], v5 offset:8192
    ds_read_b128 v[164:167], v5 offset:9216
    ds_read_b128 v[168:171], v5 offset:10240
    ds_read_b128 v[172:175], v5 offset:11264
    s_cmp_lg_u32 s24, 0
    s_cbranch_scc1 .of_231
    v_mov_b32 v27, s41
    s_mov_b64 exec, 1
    buffer_store_dword v27, v26, s[8:11], s94 offen sc1
    s_mov_b64 exec, -1
.of_231:
    s_branch .a0_211
.fi_214:
    buffer_load_dwordx4 v19, s[12:15], s29 offen offset:2048 lds
    buffer_load_dwordx4 v19, s[12:15], s29 offen offset:3072 lds
    ds_read_b128 v[64:67], v12 offset:0
    ds_read_b128 v[68:71], v12 offset:32768
    ds_read_b128 v[72:75], v13 offset:0
    ds_read_b128 v[76:79], v13 offset:32768
    ds_read_b128 v[80:83], v14 offset:0
    ds_read_b128 v[84:87], v14 offset:32768
    ds_read_b128 v[88:91], v15 offset:0
    ds_read_b128 v[92:95], v15 offset:32768
    ds_read_b128 v[96:99], v12 offset:256
    ds_read_b128 v[100:103], v12 offset:33024
    ds_read_b128 v[104:107], v13 offset:256
    ds_read_b128 v[108:111], v13 offset:33024
    s_add_u32 s42, s30, 1
    s_min_u32 s42, s42, 63
    s_cmp_gt_u32 s32, s42
    s_cbranch_scc1 .ndd_233
    s_mov_b32 s62, 0
.nd_232:
    buffer_load_dword v4, v7, s[8:11], s46 offen sc1
    buffer_load_dword v30, v7, s[8:11], s47 offen sc1
    s_add_u32 s62, s62, 1
    s_cmp_gt_u32 s62, 0x200000
    s_cbranch_scc1 .mg_end_1
    s_waitcnt vmcnt(0)
    v_min_u32 v4, v4, v30
    s_nop 1
    v_min_u32_dpp v4, v4, v4 quad_perm:[1,0,3,2] row_mask:0xf bank_mask:0xf
    s_nop 1
    v_min_u32_dpp v4, v4, v4 quad_perm:[2,3,0,1] row_mask:0xf bank_mask:0xf
    s_nop 1
    v_readfirstlane_b32 s32, v4
    s_cmp_gt_u32 s32, s42
    s_cbranch_scc1 .ndd_233
    s_sleep 4
    s_branch .nd_232
.ndd_233:
    s_lshl_b32 s4, s42, 18
    s_mov_b32 m0, s43
    s_add_u32 s49, s36, s4
    s_add_u32 s50, s49, 16777216
    buffer_load_dwordx4 v2, s[8:11], s49 offen lds
    buffer_load_dwordx4 v2, s[8:11], s49 offen offset:1024 lds
    s_add_u32 m0, s43, 8192
    s_nop 0
    buffer_load_dwordx4 v2, s[8:11], s50 offen lds
    buffer_load_dwordx4 v2, s[8:11], s50 offen offset:1024 lds
    s_waitcnt lgkmcnt(0)
    s_branch .sk_212
.qd_213:
    s_waitcnt vmcnt(0)
    s_barrier
    s_cmp_lg_u32 s24, 0
    s_cbranch_scc1 .of_234
    v_mov_b32 v27, s41
    s_mov_b64 exec, 1
    buffer_store_dword v27, v26, s[8:11], s94 offen sc1
    s_mov_b64 exec, -1
.of_234:
    s_endpgm
.ph2_191:
    s_load_dwordx2 s[42:43], s[0:1], 88
    s_load_dwordx2 s[44:45], s[0:1], 112
    s_load_dwordx2 s[40:41], s[0:1], 0
    s_lshl_b32 s4, s99, 6
    s_lshl_b32 s5, s24, 21
    s_add_u32 s4, s4, s5
    s_lshl_b32 s6, s24, 14
    v_bfe_u32 v254, v1, 2, 4
    v_mul_u32_u24 v240, 2048, v254
    v_bfe_u32 v254, v1, 0, 2
    v_mul_u32_u24 v254, 16, v254
    v_add_u32 v240, v240, v254
    v_add_u32 v240, s4, v240
    v_bfe_u32 v254, v1, 4, 2
    v_mul_u32_u24 v242, 512, v254
    v_bfe_u32 v254, v1, 2, 2
    v_mul_u32_u24 v254, 64, v254
    v_add_u32 v242, v242, v254
    v_bfe_u32 v254, v1, 0, 2
    v_mul_u32_u24 v254, 16, v254
    v_add_u32 v242, v242, v254
    v_add_u32 v242, s6, v242
    v_add_u32 v243, 0x10000, v242
    s_waitcnt lgkmcnt(0)
    s_barrier
    s_mov_b32 s16, s42
    s_and_b32 s17, s43, 0xffff
    s_mov_b32 s18, 0x800000
    s_mov_b32 s19, 0x00020000
    s_mov_b32 s84, s44
    s_and_b32 s85, s45, 0xffff
    s_mov_b32 s86, 0x400000
    s_mov_b32 s87, 0x00020000
    s_mov_b32 s12, s40
    s_and_b32 s13, s41, 0xffff
    s_mov_b32 s14, 0x400000
    s_mov_b32 s15, 0x00020000
    s_add_u32 m0, s6, 0
    s_mov_b32 s5, 0
    buffer_load_dwordx4 v240, s[16:19], s5 offen nt lds
    s_add_u32 m0, s6, 1024
    s_mov_b32 s5, 32768
    buffer_load_dwordx4 v240, s[16:19], s5 offen nt lds
    s_add_u32 m0, s6, 2048
    s_mov_b32 s5, 65536
    buffer_load_dwordx4 v240, s[16:19], s5 offen nt lds
    s_add_u32 m0, s6, 3072
    s_mov_b32 s5, 98304
    buffer_load_dwordx4 v240, s[16:19], s5 offen nt lds
    s_add_u32 m0, s6, 4096
    s_mov_b32 s5, 131072
    buffer_load_dwordx4 v240, s[16:19], s5 offen nt lds
    s_add_u32 m0, s6, 5120
    s_mov_b32 s5, 163840
    buffer_load_dwordx4 v240, s[16:19], s5 offen nt lds
    s_add_u32 m0, s6, 6144
    s_mov_b32 s5, 196608
    buffer_load_dwordx4 v240, s[16:19], s5 offen nt lds
    s_add_u32 m0, s6, 7168
    s_mov_b32 s5, 229376
    buffer_load_dwordx4 v240, s[16:19], s5 offen nt lds
    s_add_u32 m0, s6, 8192
    s_mov_b32 s5, 262144
    buffer_load_dwordx4 v240, s[16:19], s5 offen nt lds
    s_add_u32 m0, s6, 9216
    s_mov_b32 s5, 294912
    buffer_load_dwordx4 v240, s[16:19], s5 offen nt lds
    s_add_u32 m0, s6, 10240
    s_mov_b32 s5, 327680
    buffer_load_dwordx4 v240, s[16:19], s5 offen nt lds
    s_add_u32 m0, s6, 11264
    s_mov_b32 s5, 360448
    buffer_load_dwordx4 v240, s[16:19], s5 offen nt lds
    s_add_u32 m0, s6, 12288
    s_mov_b32 s5, 393216
    buffer_load_dwordx4 v240, s[16:19], s5 offen nt lds
    s_add_u32 m0, s6, 13312
    s_mov_b32 s5, 425984
    buffer_load_dwordx4 v240, s[16:19], s5 offen nt lds
    s_add_u32 m0, s6, 14336
    s_mov_b32 s5, 458752
    buffer_load_dwordx4 v240, s[16:19], s5 offen nt lds
    s_add_u32 m0, s6, 15360
    s_mov_b32 s5, 491520
    buffer_load_dwordx4 v240, s[16:19], s5 offen nt lds
    s_add_u32 m0, s6, 65536
    s_mov_b32 s5, 524288
    buffer_load_dwordx4 v240, s[16:19], s5 offen nt lds
    s_add_u32 m0, s6, 66560
    s_mov_b32 s5, 557056
    buffer_load_dwordx4 v240, s[16:19], s5 offen nt lds
    s_add_u32 m0, s6, 67584
    s_mov_b32 s5, 589824
    buffer_load_dwordx4 v240, s[16:19], s5 offen nt lds
    s_add_u32 m0, s6, 68608
    s_mov_b32 s5, 622592
    buffer_load_dwordx4 v240, s[16:19], s5 offen nt lds
    s_add_u32 m0, s6, 69632
    s_mov_b32 s5, 655360
    buffer_load_dwordx4 v240, s[16:19], s5 offen nt lds
    s_add_u32 m0, s6, 70656
    s_mov_b32 s5, 688128
    buffer_load_dwordx4 v240, s[16:19], s5 offen nt lds
    s_add_u32 m0, s6, 71680
    s_mov_b32 s5, 720896
    buffer_load_dwordx4 v240, s[16:19], s5 offen nt lds
    s_add_u32 m0, s6, 72704
    s_mov_b32 s5, 753664
    buffer_load_dwordx4 v240, s[16:19], s5 offen nt lds
    s_add_u32 m0, s6, 73728
    s_mov_b32 s5, 786432
    buffer_load_dwordx4 v240, s[16:19], s5 offen nt lds
    s_add_u32 m0, s6, 74752
    s_mov_b32 s5, 819200
    buffer_load_dwordx4 v240, s[16:19], s5 offen nt lds
    s_add_u32 m0, s6, 75776
    s_mov_b32 s5, 851968
    buffer_load_dwordx4 v240, s[16:19], s5 offen nt lds
    s_add_u32 m0, s6, 76800
    s_mov_b32 s5, 884736
    buffer_load_dwordx4 v240, s[16:19], s5 offen nt lds
    s_add_u32 m0, s6, 77824
    s_mov_b32 s5, 917504
    buffer_load_dwordx4 v240, s[16:19], s5 offen nt lds
    s_add_u32 m0, s6, 78848
    s_mov_b32 s5, 950272
    buffer_load_dwordx4 v240, s[16:19], s5 offen nt lds
    s_add_u32 m0, s6, 79872
    s_mov_b32 s5, 983040
    buffer_load_dwordx4 v240, s[16:19], s5 offen nt lds
    s_add_u32 m0, s6, 80896
    s_mov_b32 s5, 1015808
    buffer_load_dwordx4 v240, s[16:19], s5 offen nt lds
    s_and_b32 s34, s24, 1
    s_lshr_b32 s35, s24, 1
    v_lshlrev_b32 v2, 4, v1
    s_lshl_b32 s4, s24, 10
    s_add_u32 s4, s4, 92286976
    v_bfe_u32 v254, v1, 0, 3
    v_mul_u32_u24 v8, 128, v254
    v_add_u32 v8, s4, v8
    s_lshl_b32 s4, s24, 15
    v_add_u32 v9, s4, v2
    v_add_u32 v10, 0x20000, v9
    s_lshl_b32 s4, s24, 12
    v_add_u32 v11, s4, v2
    s_lshl_b32 s4, s35, 11
    s_lshl_b32 s5, s34, 7
    s_add_u32 s4, s4, s5
    v_bfe_u32 v254, v1, 0, 1
    v_mul_u32_u24 v12, 1024, v254
    v_bfe_u32 v254, v1, 1, 2
    v_mul_u32_u24 v254, 256, v254
    v_add_u32 v12, v12, v254
    v_bfe_u32 v254, v1, 3, 3
    v_mul_u32_u24 v254, 16, v254
    v_add_u32 v12, v12, v254
    v_add_u32 v12, s4, v12
    s_lshl_b32 s4, s24, 14
    s_lshl_b32 s5, s99, 6
    s_add_u32 s4, s4, s5
    v_bfe_u32 v254, v1, 3, 3
    v_mul_u32_u24 v13, 2048, v254
    v_bfe_u32 v254, v1, 0, 3
    v_mul_u32_u24 v254, 8, v254
    v_add_u32 v13, v13, v254
    v_add_u32 v13, s4, v13
    s_lshl_b32 s4, s99, 17
    s_lshl_b32 s5, s24, 9
    s_add_u32 s4, s4, s5
    v_bfe_u32 v254, v1, 0, 3
    v_mul_u32_u24 v14, 16384, v254
    v_bfe_u32 v254, v1, 3, 3
    v_mul_u32_u24 v254, 2, v254
    v_add_u32 v14, v14, v254
    v_add_u32 v14, s4, v14
    v_add_u32 v15, 4096, v14
    v_add_u32 v16, 8192, v14
    v_add_u32 v17, 12288, v14
    s_lshl_b32 s4, s24, 5
    v_bfe_u32 v254, v1, 3, 3
    v_mul_u32_u24 v18, 4, v254
    v_add_u32 v18, s4, v18
    s_and_b32 s4, s99, 7
    s_lshl_b32 s4, s4, 12
    s_lshl_b32 s5, s24, 15
    s_add_u32 s4, s4, s5
    s_add_u32 s4, s4, 50331648
    v_bfe_u32 v254, v1, 0, 5
    v_mul_u32_u24 v19, 128, v254
    v_bfe_u32 v254, v1, 5, 1
    v_mul_u32_u24 v254, 131072, v254
    v_add_u32 v19, v19, v254
    v_add_u32 v19, s4, v19
    s_lshl_b32 s4, s24, 8
    s_add_u32 s4, s4, 0x8000
    v_lshlrev_b32 v21, 2, v1
    v_add_u32 v21, s4, v21
    v_mov_b32 v22, 0x8000
    v_mov_b32 v23, 0
    s_lshl_b32 s4, s99, 7
    s_add_u32 s94, s4, 92291072
    s_mov_b32 s33, 0
    s_waitcnt vmcnt(16)
    ds_read_b64_tr_b16 a[0:1], v242 offset:0
    ds_read_b64_tr_b16 a[2:3], v242 offset:256
    ds_read_b64_tr_b16 a[4:5], v242 offset:8
    ds_read_b64_tr_b16 a[6:7], v242 offset:264
    ds_read_b64_tr_b16 a[8:9], v242 offset:2048
    ds_read_b64_tr_b16 a[10:11], v242 offset:2304
    ds_read_b64_tr_b16 a[12:13], v242 offset:2056
    ds_read_b64_tr_b16 a[14:15], v242 offset:2312
    ds_read_b64_tr_b16 a[16:17], v242 offset:4096
    ds_read_b64_tr_b16 a[18:19], v242 offset:4352
    ds_read_b64_tr_b16 a[20:21], v242 offset:4104
    ds_read_b64_tr_b16 a[22:23], v242 offset:4360
    ds_read_b64_tr_b16 a[24:25], v242 offset:6144
    ds_read_b64_tr_b16 a[26:27], v242 offset:6400
    ds_read_b64_tr_b16 a[28:29], v242 offset:6152
    ds_read_b64_tr_b16 a[30:31], v242 offset:6408
    ds_read_b64_tr_b16 a[32:33], v242 offset:8192
    ds_read_b64_tr_b16 a[34:35], v242 offset:8448
    ds_read_b64_tr_b16 a[36:37], v242 offset:8200
    ds_read_b64_tr_b16 a[38:39], v242 offset:8456
    ds_read_b64_tr_b16 a[40:41], v242 offset:10240
    ds_read_b64_tr_b16 a[42:43], v242 offset:10496
    ds_read_b64_tr_b16 a[44:45], v242 offset:10248
    ds_read_b64_tr_b16 a[46:47], v242 offset:10504
    ds_read_b64_tr_b16 a[48:49], v242 offset:12288
    ds_read_b64_tr_b16 a[50:51], v242 offset:12544
    ds_read_b64_tr_b16 a[52:53], v242 offset:12296
    ds_read_b64_tr_b16 a[54:55], v242 offset:12552
    ds_read_b64_tr_b16 a[56:57], v242 offset:14336
    ds_read_b64_tr_b16 a[58:59], v242 offset:14592
    ds_read_b64_tr_b16 a[60:61], v242 offset:14344
    ds_read_b64_tr_b16 a[62:63], v242 offset:14600
    s_waitcnt lgkmcnt(0)
    s_add_u32 m0, s6, 0
    s_mov_b32 s5, 1048576
    buffer_load_dwordx4 v240, s[16:19], s5 offen nt lds
    s_add_u32 m0, s6, 1024
    s_mov_b32 s5, 1081344
    buffer_load_dwordx4 v240, s[16:19], s5 offen nt lds
    s_add_u32 m0, s6, 2048
    s_mov_b32 s5, 1114112
    buffer_load_dwordx4 v240, s[16:19], s5 offen nt lds
    s_add_u32 m0, s6, 3072
    s_mov_b32 s5, 1146880
    buffer_load_dwordx4 v240, s[16:19], s5 offen nt lds
    s_add_u32 m0, s6, 4096
    s_mov_b32 s5, 1179648
    buffer_load_dwordx4 v240, s[16:19], s5 offen nt lds
    s_add_u32 m0, s6, 5120
    s_mov_b32 s5, 1212416
    buffer_load_dwordx4 v240, s[16:19], s5 offen nt lds
    s_add_u32 m0, s6, 6144
    s_mov_b32 s5, 1245184
    buffer_load_dwordx4 v240, s[16:19], s5 offen nt lds
    s_add_u32 m0, s6, 7168
    s_mov_b32 s5, 1277952
    buffer_load_dwordx4 v240, s[16:19], s5 offen nt lds
    s_add_u32 m0, s6, 8192
    s_mov_b32 s5, 1310720
    buffer_load_dwordx4 v240, s[16:19], s5 offen nt lds
    s_add_u32 m0, s6, 9216
    s_mov_b32 s5, 1343488
    buffer_load_dwordx4 v240, s[16:19], s5 offen nt lds
    s_add_u32 m0, s6, 10240
    s_mov_b32 s5, 1376256
    buffer_load_dwordx4 v240, s[16:19], s5 offen nt lds
    s_add_u32 m0, s6, 11264
    s_mov_b32 s5, 1409024
    buffer_load_dwordx4 v240, s[16:19], s5 offen nt lds
    s_add_u32 m0, s6, 12288
    s_mov_b32 s5, 1441792
    buffer_load_dwordx4 v240, s[16:19], s5 offen nt lds
    s_add_u32 m0, s6, 13312
    s_mov_b32 s5, 1474560
    buffer_load_dwordx4 v240, s[16:19], s5 offen nt lds
    s_add_u32 m0, s6, 14336
    s_mov_b32 s5, 1507328
    buffer_load_dwordx4 v240, s[16:19], s5 offen nt lds
    s_add_u32 m0, s6, 15360
    s_mov_b32 s5, 1540096
    buffer_load_dwordx4 v240, s[16:19], s5 offen nt lds
    s_waitcnt vmcnt(16)
    ds_read_b64_tr_b16 a[64:65], v243 offset:0
    ds_read_b64_tr_b16 a[66:67], v243 offset:256
    ds_read_b64_tr_b16 a[68:69], v243 offset:8
    ds_read_b64_tr_b16 a[70:71], v243 offset:264
    ds_read_b64_tr_b16 a[72:73], v243 offset:2048
    ds_read_b64_tr_b16 a[74:75], v243 offset:2304
    ds_read_b64_tr_b16 a[76:77], v243 offset:2056
    ds_read_b64_tr_b16 a[78:79], v243 offset:2312
    ds_read_b64_tr_b16 a[80:81], v243 offset:4096
    ds_read_b64_tr_b16 a[82:83], v243 offset:4352
    ds_read_b64_tr_b16 a[84:85], v243 offset:4104
    ds_read_b64_tr_b16 a[86:87], v243 offset:4360
    ds_read_b64_tr_b16 a[88:89], v243 offset:6144
    ds_read_b64_tr_b16 a[90:91], v243 offset:6400
    ds_read_b64_tr_b16 a[92:93], v243 offset:6152
    ds_read_b64_tr_b16 a[94:95], v243 offset:6408
    ds_read_b64_tr_b16 a[96:97], v243 offset:8192
    ds_read_b64_tr_b16 a[98:99], v243 offset:8448
    ds_read_b64_tr_b16 a[100:101], v243 offset:8200
    ds_read_b64_tr_b16 a[102:103], v243 offset:8456
    ds_read_b64_tr_b16 a[104:105], v243 offset:10240
    ds_read_b64_tr_b16 a[106:107], v243 offset:10496
    ds_read_b64_tr_b16 a[108:109], v243 offset:10248
    ds_read_b64_tr_b16 a[110:111], v243 offset:10504
    ds_read_b64_tr_b16 a[112:113], v243 offset:12288
    ds_read_b64_tr_b16 a[114:115], v243 offset:12544
    ds_read_b64_tr_b16 a[116:117], v243 offset:12296
    ds_read_b64_tr_b16 a[118:119], v243 offset:12552
    ds_read_b64_tr_b16 a[120:121], v243 offset:14336
    ds_read_b64_tr_b16 a[122:123], v243 offset:14592
    ds_read_b64_tr_b16 a[124:125], v243 offset:14344
    ds_read_b64_tr_b16 a[126:127], v243 offset:14600
    s_waitcnt lgkmcnt(0)
    s_add_u32 m0, s6, 65536
    s_mov_b32 s5, 1572864
    buffer_load_dwordx4 v240, s[16:19], s5 offen nt lds
    s_add_u32 m0, s6, 66560
    s_mov_b32 s5, 1605632
    buffer_load_dwordx4 v240, s[16:19], s5 offen nt lds
    s_add_u32 m0, s6, 67584
    s_mov_b32 s5, 1638400
    buffer_load_dwordx4 v240, s[16:19], s5 offen nt lds
    s_add_u32 m0, s6, 68608
    s_mov_b32 s5, 1671168
    buffer_load_dwordx4 v240, s[16:19], s5 offen nt lds
    s_add_u32 m0, s6, 69632
    s_mov_b32 s5, 1703936
    buffer_load_dwordx4 v240, s[16:19], s5 offen nt lds
    s_add_u32 m0, s6, 70656
    s_mov_b32 s5, 1736704
    buffer_load_dwordx4 v240, s[16:19], s5 offen nt lds
    s_add_u32 m0, s6, 71680
    s_mov_b32 s5, 1769472
    buffer_load_dwordx4 v240, s[16:19], s5 offen nt lds
    s_add_u32 m0, s6, 72704
    s_mov_b32 s5, 1802240
    buffer_load_dwordx4 v240, s[16:19], s5 offen nt lds
    s_add_u32 m0, s6, 73728
    s_mov_b32 s5, 1835008
    buffer_load_dwordx4 v240, s[16:19], s5 offen nt lds
    s_add_u32 m0, s6, 74752
    s_mov_b32 s5, 1867776
    buffer_load_dwordx4 v240, s[16:19], s5 offen nt lds
    s_add_u32 m0, s6, 75776
    s_mov_b32 s5, 1900544
    buffer_load_dwordx4 v240, s[16:19], s5 offen nt lds
    s_add_u32 m0, s6, 76800
    s_mov_b32 s5, 1933312
    buffer_load_dwordx4 v240, s[16:19], s5 offen nt lds
    s_add_u32 m0, s6, 77824
    s_mov_b32 s5, 1966080
    buffer_load_dwordx4 v240, s[16:19], s5 offen nt lds
    s_add_u32 m0, s6, 78848
    s_mov_b32 s5, 1998848
    buffer_load_dwordx4 v240, s[16:19], s5 offen nt lds
    s_add_u32 m0, s6, 79872
    s_mov_b32 s5, 2031616
    buffer_load_dwordx4 v240, s[16:19], s5 offen nt lds
    s_add_u32 m0, s6, 80896
    s_mov_b32 s5, 2064384
    buffer_load_dwordx4 v240, s[16:19], s5 offen nt lds
    s_waitcnt vmcnt(16)
    ds_read_b64_tr_b16 a[128:129], v242 offset:0
    ds_read_b64_tr_b16 a[130:131], v242 offset:256
    ds_read_b64_tr_b16 a[132:133], v242 offset:8
    ds_read_b64_tr_b16 a[134:135], v242 offset:264
    ds_read_b64_tr_b16 a[136:137], v242 offset:2048
    ds_read_b64_tr_b16 a[138:139], v242 offset:2304
    ds_read_b64_tr_b16 a[140:141], v242 offset:2056
    ds_read_b64_tr_b16 a[142:143], v242 offset:2312
    ds_read_b64_tr_b16 a[144:145], v242 offset:4096
    ds_read_b64_tr_b16 a[146:147], v242 offset:4352
    ds_read_b64_tr_b16 a[148:149], v242 offset:4104
    ds_read_b64_tr_b16 a[150:151], v242 offset:4360
    ds_read_b64_tr_b16 a[152:153], v242 offset:6144
    ds_read_b64_tr_b16 a[154:155], v242 offset:6400
    ds_read_b64_tr_b16 a[156:157], v242 offset:6152
    ds_read_b64_tr_b16 a[158:159], v242 offset:6408
    ds_read_b64_tr_b16 a[160:161], v242 offset:8192
    ds_read_b64_tr_b16 a[162:163], v242 offset:8448
    ds_read_b64_tr_b16 a[164:165], v242 offset:8200
    ds_read_b64_tr_b16 a[166:167], v242 offset:8456
    ds_read_b64_tr_b16 a[168:169], v242 offset:10240
    ds_read_b64_tr_b16 a[170:171], v242 offset:10496
    ds_read_b64_tr_b16 a[172:173], v242 offset:10248
    ds_read_b64_tr_b16 a[174:175], v242 offset:10504
    ds_read_b64_tr_b16 a[176:177], v242 offset:12288
    ds_read_b64_tr_b16 a[178:179], v242 offset:12544
    ds_read_b64_tr_b16 a[180:181], v242 offset:12296
    ds_read_b64_tr_b16 a[182:183], v242 offset:12552
    ds_read_b64_tr_b16 a[184:185], v242 offset:14336
    ds_read_b64_tr_b16 a[186:187], v242 offset:14592
    ds_read_b64_tr_b16 a[188:189], v242 offset:14344
    ds_read_b64_tr_b16 a[190:191], v242 offset:14600
    s_waitcnt lgkmcnt(0)
    s_waitcnt vmcnt(0)
    ds_read_b64_tr_b16 a[192:193], v243 offset:0
    ds_read_b64_tr_b16 a[194:195], v243 offset:256
    ds_read_b64_tr_b16 a[196:197], v243 offset:8
    ds_read_b64_tr_b16 a[198:199], v243 offset:264
    ds_read_b64_tr_b16 a[200:201], v243 offset:2048
    ds_read_b64_tr_b16 a[202:203], v243 offset:2304
    ds_read_b64_tr_b16 a[204:205], v243 offset:2056
    ds_read_b64_tr_b16 a[206:207], v243 offset:2312
    ds_read_b64_tr_b16 a[208:209], v243 offset:4096
    ds_read_b64_tr_b16 a[210:211], v243 offset:4352
    ds_read_b64_tr_b16 a[212:213], v243 offset:4104
    ds_read_b64_tr_b16 a[214:215], v243 offset:4360
    ds_read_b64_tr_b16 a[216:217], v243 offset:6144
    ds_read_b64_tr_b16 a[218:219], v243 offset:6400
    ds_read_b64_tr_b16 a[220:221], v243 offset:6152
    ds_read_b64_tr_b16 a[222:223], v243 offset:6408
    ds_read_b64_tr_b16 a[224:225], v243 offset:8192
    ds_read_b64_tr_b16 a[226:227], v243 offset:8448
    ds_read_b64_tr_b16 a[228:229], v243 offset:8200
    ds_read_b64_tr_b16 a[230:231], v243 offset:8456
    ds_read_b64_tr_b16 a[232:233], v243 offset:10240
    ds_read_b64_tr_b16 a[234:235], v243 offset:10496
    ds_read_b64_tr_b16 a[236:237], v243 offset:10248
    ds_read_b64_tr_b16 a[238:239], v243 offset:10504
    ds_read_b64_tr_b16 a[240:241], v243 offset:12288
    ds_read_b64_tr_b16 a[242:243], v243 offset:12544
    ds_read_b64_tr_b16 a[244:245], v243 offset:12296
    ds_read_b64_tr_b16 a[246:247], v243 offset:12552
    ds_read_b64_tr_b16 a[248:249], v243 offset:14336
    ds_read_b64_tr_b16 a[250:251], v243 offset:14592
    ds_read_b64_tr_b16 a[252:253], v243 offset:14344
    ds_read_b64_tr_b16 a[254:255], v243 offset:14600
    s_waitcnt lgkmcnt(0)
    s_mov_b32 s62, 0
    v_mov_b32 v5, 0
.wc_235:
    buffer_load_dword v4, v5, s[20:23], 0 offen offset:192 sc1
    s_add_u32 s62, s62, 1
    s_cmp_gt_u32 s62, 0x200000
    s_cbranch_scc1 .mg_end_1
    s_waitcnt vmcnt(0)
    v_readfirstlane_b32 s4, v4
    s_cmp_ge_u32 s4, 64
    s_cbranch_scc1 .wd_236
    s_sleep 8
    s_branch .wc_235
.wd_236:
    s_mov_b64 exec, 1
    s_cmp_lg_u32 s24, 0
    s_cbranch_scc1 .dr_237
    v_mov_b32 v20, 2
    buffer_atomic_add v20, v23, s[8:11], s94 offen sc0 sc1
    s_branch .drd_238
.dr_237:
    buffer_load_dword v20, v23, s[16:19], 0 offen
.drd_238:
    s_mov_b64 exec, -1
    s_barrier
    s_waitcnt vmcnt(0)
    ds_write_b32 v21, v20 offset:0x4000
    s_waitcnt lgkmcnt(0)
    s_barrier
    ds_read_b32 v20, v22 offset:0x4000
    s_waitcnt lgkmcnt(0)
    v_readfirstlane_b32 s31, v20
    s_add_u32 s30, s31, 1
    s_cmp_ge_u32 s31, 64
    s_cbranch_scc1 .gx_239
.cold_240:
    s_mov_b32 s62, 0
.gp_243:
    buffer_load_dword v4, v8, s[8:11], 0 offen sc1
    s_add_u32 s62, s62, 1
    s_cmp_gt_u32 s62, 0x200000
    s_cbranch_scc1 .mg_end_1
    s_waitcnt vmcnt(0)
    v_min_u32_dpp v4, v4, v4 quad_perm:[1,0,3,2] row_mask:0xf bank_mask:0xf
    s_nop 1
    v_min_u32_dpp v4, v4, v4 quad_perm:[2,3,0,1] row_mask:0xf bank_mask:0xf
    s_nop 1
    v_min_u32_dpp v4, v4, v4 row_half_mirror row_mask:0xf bank_mask:0xf
    s_nop 1
    v_readfirstlane_b32 s33, v4
    s_cmp_gt_u32 s33, s31
    s_cbranch_scc1 .gd_244
    s_sleep 4
    s_cmp_eq_u32 s33, s31
    s_cbranch_scc1 .gp_243
    s_sleep 24
    s_branch .gp_243
.gd_244:
    s_lshl_b32 s57, s31, 16
    s_and_b32 s4, s31, 31
    s_lshl_b32 s4, s4, 4
    s_lshr_b32 s5, s31, 5
    s_lshl_b32 s5, s5, 11
    s_add_u32 s58, s4, s5
    s_add_u32 s58, s58, 130023424
    s_lshl_b32 s59, s31, 7
    s_add_u32 s59, s59, 121634816
    s_lshl_b32 s48, s31, 18
    s_add_u32 s4, s31, 4
    s_min_u32 s4, s4, s33
    s_sub_u32 s4, s4, 1
    s_lshl_b32 s4, s4, 18
    buffer_load_dword v6, v19, s[8:11], s48 offen
    buffer_load_dword v7, v19, s[8:11], s4 offen
    buffer_load_dword v4, v8, s[8:11], 0 offen sc1
    buffer_load_dwordx2 v[208:209], v13, s[12:15], s57 offen
    buffer_load_dword v214, v18, s[8:11], s59 offen
    s_add_u32 s48, s48, 50331648
    buffer_load_ushort v210, v14, s[8:11], s58 offen
    buffer_load_ushort v211, v15, s[8:11], s58 offen
    buffer_load_ushort v212, v16, s[8:11], s58 offen
    buffer_load_ushort v213, v17, s[8:11], s58 offen
    s_mov_b64 exec, 1
    s_cmp_lg_u32 s24, 0
    s_cbranch_scc1 .dr_245
    v_mov_b32 v20, 1
    buffer_atomic_add v20, v23, s[8:11], s94 offen sc0 sc1
    s_branch .drd_246
.dr_245:
    buffer_load_dword v20, v23, s[16:19], 0 offen
.drd_246:
    s_mov_b64 exec, -1
    s_add_u32 s49, s48, 4096
    s_add_u32 s50, s48, 8192
    s_add_u32 s51, s48, 12288
    s_add_u32 s52, s48, 16384
    s_add_u32 s53, s48, 20480
    s_add_u32 s54, s48, 24576
    s_add_u32 s55, s48, 28672
    buffer_load_dwordx4 v[64:67], v9, s[8:11], s48 offen offset:0
    buffer_load_dwordx4 v[68:71], v10, s[8:11], s48 offen offset:0
    buffer_load_dwordx4 v[72:75], v9, s[8:11], s48 offen offset:1024
    buffer_load_dwordx4 v[76:79], v10, s[8:11], s48 offen offset:1024
    buffer_load_dwordx4 v[80:83], v9, s[8:11], s48 offen offset:2048
    buffer_load_dwordx4 v[84:87], v10, s[8:11], s48 offen offset:2048
    buffer_load_dwordx4 v[88:91], v9, s[8:11], s48 offen offset:3072
    buffer_load_dwordx4 v[92:95], v10, s[8:11], s48 offen offset:3072
    buffer_load_dwordx4 v[96:99], v9, s[8:11], s49 offen offset:0
    buffer_load_dwordx4 v[100:103], v10, s[8:11], s49 offen offset:0
    buffer_load_dwordx4 v[104:107], v9, s[8:11], s49 offen offset:1024
    buffer_load_dwordx4 v[108:111], v10, s[8:11], s49 offen offset:1024
    buffer_load_dwordx4 v[112:115], v9, s[8:11], s49 offen offset:2048
    buffer_load_dwordx4 v[116:119], v10, s[8:11], s49 offen offset:2048
    buffer_load_dwordx4 v[120:123], v9, s[8:11], s49 offen offset:3072
    buffer_load_dwordx4 v[124:127], v10, s[8:11], s49 offen offset:3072
    buffer_load_dwordx4 v[128:131], v9, s[8:11], s50 offen offset:0
    buffer_load_dwordx4 v[132:135], v10, s[8:11], s50 offen offset:0
    buffer_load_dwordx4 v[136:139], v9, s[8:11], s50 offen offset:1024
    buffer_load_dwordx4 v[140:143], v10, s[8:11], s50 offen offset:1024
    buffer_load_dwordx4 v[144:147], v9, s[8:11], s50 offen offset:2048
    buffer_load_dwordx4 v[148:151], v10, s[8:11], s50 offen offset:2048
    buffer_load_dwordx4 v[152:155], v9, s[8:11], s50 offen offset:3072
    buffer_load_dwordx4 v[156:159], v10, s[8:11], s50 offen offset:3072
    buffer_load_dwordx4 v[160:163], v9, s[8:11], s51 offen offset:0
    buffer_load_dwordx4 v[164:167], v10, s[8:11], s51 offen offset:0
    buffer_load_dwordx4 v[168:171], v9, s[8:11], s51 offen offset:1024
    buffer_load_dwordx4 v[172:175], v10, s[8:11], s51 offen offset:1024
    buffer_load_dwordx4 v[176:179], v9, s[8:11], s51 offen offset:2048
    buffer_load_dwordx4 v[180:183], v10, s[8:11], s51 offen offset:2048
    buffer_load_dwordx4 v[184:187], v9, s[8:11], s51 offen offset:3072
    buffer_load_dwordx4 v[188:191], v10, s[8:11], s51 offen offset:3072
.main_241:
    s_waitcnt vmcnt(31)
    v_mfma_f32_16x16x32_bf16 v[192:195], a[0:3], v[64:67], 0
    v_mfma_f32_16x16x32_bf16 v[196:199], a[4:7], v[64:67], 0
    buffer_load_dwordx4 v[64:67], v9, s[8:11], s52 offen offset:0
    v_lshlrev_b32 v216, 16, v208
    s_waitcnt vmcnt(31)
    v_mfma_f32_16x16x32_bf16 v[200:203], a[0:3], v[68:71], 0
    v_mfma_f32_16x16x32_bf16 v[204:207], a[4:7], v[68:71], 0
    buffer_load_dwordx4 v[68:71], v10, s[8:11], s52 offen offset:0
    v_and_b32 v217, 0xffff0000, v208
    s_waitcnt vmcnt(31)
    v_mfma_f32_16x16x32_bf16 v[192:195], a[8:11], v[72:75], v[192:195]
    v_mfma_f32_16x16x32_bf16 v[196:199], a[12:15], v[72:75], v[196:199]
    buffer_load_dwordx4 v[72:75], v9, s[8:11], s52 offen offset:1024
    v_lshlrev_b32 v218, 16, v209
    s_waitcnt vmcnt(31)
    v_mfma_f32_16x16x32_bf16 v[200:203], a[8:11], v[76:79], v[200:203]
    v_mfma_f32_16x16x32_bf16 v[204:207], a[12:15], v[76:79], v[204:207]
    buffer_load_dwordx4 v[76:79], v10, s[8:11], s52 offen offset:1024
    v_and_b32 v219, 0xffff0000, v209
    s_waitcnt vmcnt(31)
    v_mfma_f32_16x16x32_bf16 v[192:195], a[16:19], v[80:83], v[192:195]
    v_mfma_f32_16x16x32_bf16 v[196:199], a[20:23], v[80:83], v[196:199]
    buffer_load_dwordx4 v[80:83], v9, s[8:11], s52 offen offset:2048
    v_lshlrev_b32 v210, 16, v210
    s_waitcnt vmcnt(31)
    v_mfma_f32_16x16x32_bf16 v[200:203], a[16:19], v[84:87], v[200:203]
    v_mfma_f32_16x16x32_bf16 v[204:207], a[20:23], v[84:87], v[204:207]
    buffer_load_dwordx4 v[84:87], v10, s[8:11], s52 offen offset:2048
    v_lshlrev_b32 v211, 16, v211
    s_waitcnt vmcnt(31)
    v_mfma_f32_16x16x32_bf16 v[192:195], a[24:27], v[88:91], v[192:195]
    v_mfma_f32_16x16x32_bf16 v[196:199], a[28:31], v[88:91], v[196:199]
    buffer_load_dwordx4 v[88:91], v9, s[8:11], s52 offen offset:3072
    v_lshlrev_b32 v212, 16, v212
    s_waitcnt vmcnt(31)
    v_mfma_f32_16x16x32_bf16 v[200:203], a[24:27], v[92:95], v[200:203]
    v_mfma_f32_16x16x32_bf16 v[204:207], a[28:31], v[92:95], v[204:207]
    buffer_load_dwordx4 v[92:95], v10, s[8:11], s52 offen offset:3072
    v_lshlrev_b32 v213, 16, v213
    s_waitcnt vmcnt(31)
    v_mfma_f32_16x16x32_bf16 v[192:195], a[32:35], v[96:99], v[192:195]
    v_mfma_f32_16x16x32_bf16 v[196:199], a[36:39], v[96:99], v[196:199]
    buffer_load_dwordx4 v[96:99], v9, s[8:11], s53 offen offset:0
    v_mul_f32 v216, v216, v210
    s_waitcnt vmcnt(31)
    v_mfma_f32_16x16x32_bf16 v[200:203], a[32:35], v[100:103], v[200:203]
    v_mfma_f32_16x16x32_bf16 v[204:207], a[36:39], v[100:103], v[204:207]
    buffer_load_dwordx4 v[100:103], v10, s[8:11], s53 offen offset:0
    v_mul_f32 v217, v217, v211
    s_waitcnt vmcnt(31)
    v_mfma_f32_16x16x32_bf16 v[192:195], a[40:43], v[104:107], v[192:195]
    v_mfma_f32_16x16x32_bf16 v[196:199], a[44:47], v[104:107], v[196:199]
    buffer_load_dwordx4 v[104:107], v9, s[8:11], s53 offen offset:1024
    v_mul_f32 v218, v218, v212
    s_waitcnt vmcnt(31)
    v_mfma_f32_16x16x32_bf16 v[200:203], a[40:43], v[108:111], v[200:203]
    v_mfma_f32_16x16x32_bf16 v[204:207], a[44:47], v[108:111], v[204:207]
    buffer_load_dwordx4 v[108:111], v10, s[8:11], s53 offen offset:1024
    v_mul_f32 v219, v219, v213
    s_waitcnt vmcnt(31)
    v_mfma_f32_16x16x32_bf16 v[192:195], a[48:51], v[112:115], v[192:195]
    v_mfma_f32_16x16x32_bf16 v[196:199], a[52:55], v[112:115], v[196:199]
    buffer_load_dwordx4 v[112:115], v9, s[8:11], s53 offen offset:2048
    v_mul_f32 v216, v216, v214
    s_waitcnt vmcnt(31)
    v_mfma_f32_16x16x32_bf16 v[200:203], a[48:51], v[116:119], v[200:203]
    v_mfma_f32_16x16x32_bf16 v[204:207], a[52:55], v[116:119], v[204:207]
    buffer_load_dwordx4 v[116:119], v10, s[8:11], s53 offen offset:2048
    v_mul_f32 v217, v217, v214
    s_waitcnt vmcnt(31)
    v_mfma_f32_16x16x32_bf16 v[192:195], a[56:59], v[120:123], v[192:195]
    v_mfma_f32_16x16x32_bf16 v[196:199], a[60:63], v[120:123], v[196:199]
    buffer_load_dwordx4 v[120:123], v9, s[8:11], s53 offen offset:3072
    v_mul_f32 v218, v218, v214
    s_waitcnt vmcnt(31)
    v_mfma_f32_16x16x32_bf16 v[200:203], a[56:59], v[124:127], v[200:203]
    v_mfma_f32_16x16x32_bf16 v[204:207], a[60:63], v[124:127], v[204:207]
    buffer_load_dwordx4 v[124:127], v10, s[8:11], s53 offen offset:3072
    v_mul_f32 v219, v219, v214
    s_waitcnt vmcnt(31)
    v_mfma_f32_16x16x32_bf16 v[192:195], a[64:67], v[128:131], v[192:195]
    v_mfma_f32_16x16x32_bf16 v[196:199], a[68:71], v[128:131], v[196:199]
    buffer_load_dwordx4 v[128:131], v9, s[8:11], s54 offen offset:0
    v_sub_f32 v220, 1.0, v214
    s_waitcnt vmcnt(31)
    v_mfma_f32_16x16x32_bf16 v[200:203], a[64:67], v[132:135], v[200:203]
    v_mfma_f32_16x16x32_bf16 v[204:207], a[68:71], v[132:135], v[204:207]
    buffer_load_dwordx4 v[132:135], v10, s[8:11], s54 offen offset:0
    s_mov_b32 s56, s57
    s_waitcnt vmcnt(31)
    v_mfma_f32_16x16x32_bf16 v[192:195], a[72:75], v[136:139], v[192:195]
    v_mfma_f32_16x16x32_bf16 v[196:199], a[76:79], v[136:139], v[196:199]
    buffer_load_dwordx4 v[136:139], v9, s[8:11], s54 offen offset:1024
    ds_write_b32 v21, v20
    s_waitcnt vmcnt(31)
    v_mfma_f32_16x16x32_bf16 v[200:203], a[72:75], v[140:143], v[200:203]
    v_mfma_f32_16x16x32_bf16 v[204:207], a[76:79], v[140:143], v[204:207]
    buffer_load_dwordx4 v[140:143], v10, s[8:11], s54 offen offset:1024
    s_waitcnt vmcnt(31)
    v_mfma_f32_16x16x32_bf16 v[192:195], a[80:83], v[144:147], v[192:195]
    v_mfma_f32_16x16x32_bf16 v[196:199], a[84:87], v[144:147], v[196:199]
    buffer_load_dwordx4 v[144:147], v9, s[8:11], s54 offen offset:2048
    s_waitcnt vmcnt(31)
    v_mfma_f32_16x16x32_bf16 v[200:203], a[80:83], v[148:151], v[200:203]
    v_mfma_f32_16x16x32_bf16 v[204:207], a[84:87], v[148:151], v[204:207]
    buffer_load_dwordx4 v[148:151], v10, s[8:11], s54 offen offset:2048
    s_waitcnt vmcnt(31)
    v_mfma_f32_16x16x32_bf16 v[192:195], a[88:91], v[152:155], v[192:195]
    v_mfma_f32_16x16x32_bf16 v[196:199], a[92:95], v[152:155], v[196:199]
    buffer_load_dwordx4 v[152:155], v9, s[8:11], s54 offen offset:3072
    s_waitcnt vmcnt(31)
    v_mfma_f32_16x16x32_bf16 v[200:203], a[88:91], v[156:159], v[200:203]
    v_mfma_f32_16x16x32_bf16 v[204:207], a[92:95], v[156:159], v[204:207]
    buffer_load_dwordx4 v[156:159], v10, s[8:11], s54 offen offset:3072
    s_waitcnt vmcnt(31)
    v_mfma_f32_16x16x32_bf16 v[192:195], a[96:99], v[160:163], v[192:195]
    v_mfma_f32_16x16x32_bf16 v[196:199], a[100:103], v[160:163], v[196:199]
    buffer_load_dwordx4 v[160:163], v9, s[8:11], s55 offen offset:0
    v_min_u32_dpp v4, v4, v4 quad_perm:[1,0,3,2] row_mask:0xf bank_mask:0xf
    s_nop 1
    v_min_u32_dpp v4, v4, v4 quad_perm:[2,3,0,1] row_mask:0xf bank_mask:0xf
    s_nop 1
    v_min_u32_dpp v4, v4, v4 row_half_mirror row_mask:0xf bank_mask:0xf
    s_nop 1
    v_readfirstlane_b32 s33, v4
    s_waitcnt vmcnt(31)
    v_mfma_f32_16x16x32_bf16 v[200:203], a[96:99], v[164:167], v[200:203]
    v_mfma_f32_16x16x32_bf16 v[204:207], a[100:103], v[164:167], v[204:207]
    buffer_load_dwordx4 v[164:167], v10, s[8:11], s55 offen offset:0
    s_waitcnt vmcnt(31)
    v_mfma_f32_16x16x32_bf16 v[192:195], a[104:107], v[168:171], v[192:195]
    v_mfma_f32_16x16x32_bf16 v[196:199], a[108:111], v[168:171], v[196:199]
    buffer_load_dwordx4 v[168:171], v9, s[8:11], s55 offen offset:1024
    s_waitcnt vmcnt(31)
    v_mfma_f32_16x16x32_bf16 v[200:203], a[104:107], v[172:175], v[200:203]
    v_mfma_f32_16x16x32_bf16 v[204:207], a[108:111], v[172:175], v[204:207]
    buffer_load_dwordx4 v[172:175], v10, s[8:11], s55 offen offset:1024
    s_waitcnt vmcnt(31)
    v_mfma_f32_16x16x32_bf16 v[192:195], a[112:115], v[176:179], v[192:195]
    v_mfma_f32_16x16x32_bf16 v[196:199], a[116:119], v[176:179], v[196:199]
    buffer_load_dwordx4 v[176:179], v9, s[8:11], s55 offen offset:2048
    s_waitcnt vmcnt(31)
    v_mfma_f32_16x16x32_bf16 v[200:203], a[112:115], v[180:183], v[200:203]
    v_mfma_f32_16x16x32_bf16 v[204:207], a[116:119], v[180:183], v[204:207]
    buffer_load_dwordx4 v[180:183], v10, s[8:11], s55 offen offset:2048
    s_waitcnt vmcnt(31)
    v_mfma_f32_16x16x32_bf16 v[192:195], a[120:123], v[184:187], v[192:195]
    v_mfma_f32_16x16x32_bf16 v[196:199], a[124:127], v[184:187], v[196:199]
    buffer_load_dwordx4 v[184:187], v9, s[8:11], s55 offen offset:3072
    s_waitcnt vmcnt(31)
    v_mfma_f32_16x16x32_bf16 v[200:203], a[120:123], v[188:191], v[200:203]
    v_mfma_f32_16x16x32_bf16 v[204:207], a[124:127], v[188:191], v[204:207]
    buffer_load_dwordx4 v[188:191], v10, s[8:11], s55 offen offset:3072
    s_cmp_gt_u32 s33, s30
    s_cbranch_scc0 .drain_242
    s_lshl_b32 s57, s30, 16
    s_and_b32 s4, s30, 31
    s_lshl_b32 s4, s4, 4
    s_lshr_b32 s5, s30, 5
    s_lshl_b32 s5, s5, 11
    s_add_u32 s58, s4, s5
    s_add_u32 s58, s58, 130023424
    s_lshl_b32 s59, s30, 7
    s_add_u32 s59, s59, 121634816
    s_lshl_b32 s48, s30, 18
    s_add_u32 s4, s30, 4
    s_min_u32 s4, s4, s33
    s_sub_u32 s4, s4, 1
    s_lshl_b32 s4, s4, 18
    buffer_load_dword v6, v19, s[8:11], s48 offen
    buffer_load_dword v7, v19, s[8:11], s4 offen
    buffer_load_dword v4, v8, s[8:11], 0 offen sc1
    buffer_load_dwordx2 v[208:209], v13, s[12:15], s57 offen
    buffer_load_dword v214, v18, s[8:11], s59 offen
    s_add_u32 s48, s48, 50331648
    buffer_load_ushort v210, v14, s[8:11], s58 offen
    buffer_load_ushort v211, v15, s[8:11], s58 offen
    buffer_load_ushort v212, v16, s[8:11], s58 offen
    buffer_load_ushort v213, v17, s[8:11], s58 offen
    s_mov_b64 exec, 1
    s_cmp_lg_u32 s24, 0
    s_cbranch_scc1 .dr_247
    v_mov_b32 v20, 1
    buffer_atomic_add v20, v23, s[8:11], s94 offen sc0 sc1
    s_branch .drd_248
.dr_247:
    buffer_load_dword v20, v23, s[16:19], 0 offen
.drd_248:
    s_mov_b64 exec, -1
    s_add_u32 s49, s48, 4096
    s_add_u32 s50, s48, 8192
    s_add_u32 s51, s48, 12288
    s_add_u32 s52, s48, 16384
    s_add_u32 s53, s48, 20480
    s_add_u32 s54, s48, 24576
    s_add_u32 s55, s48, 28672
    s_waitcnt vmcnt(41)
    v_mfma_f32_16x16x32_bf16 v[192:195], a[128:131], v[64:67], v[192:195]
    v_mfma_f32_16x16x32_bf16 v[196:199], a[132:135], v[64:67], v[196:199]
    buffer_load_dwordx4 v[64:67], v9, s[8:11], s48 offen offset:0
    s_waitcnt vmcnt(41)
    v_mfma_f32_16x16x32_bf16 v[200:203], a[128:131], v[68:71], v[200:203]
    v_mfma_f32_16x16x32_bf16 v[204:207], a[132:135], v[68:71], v[204:207]
    buffer_load_dwordx4 v[68:71], v10, s[8:11], s48 offen offset:0
    s_waitcnt vmcnt(41)
    v_mfma_f32_16x16x32_bf16 v[192:195], a[136:139], v[72:75], v[192:195]
    v_mfma_f32_16x16x32_bf16 v[196:199], a[140:143], v[72:75], v[196:199]
    buffer_load_dwordx4 v[72:75], v9, s[8:11], s48 offen offset:1024
    s_waitcnt vmcnt(41)
    v_mfma_f32_16x16x32_bf16 v[200:203], a[136:139], v[76:79], v[200:203]
    v_mfma_f32_16x16x32_bf16 v[204:207], a[140:143], v[76:79], v[204:207]
    buffer_load_dwordx4 v[76:79], v10, s[8:11], s48 offen offset:1024
    s_waitcnt vmcnt(41)
    v_mfma_f32_16x16x32_bf16 v[192:195], a[144:147], v[80:83], v[192:195]
    v_mfma_f32_16x16x32_bf16 v[196:199], a[148:151], v[80:83], v[196:199]
    buffer_load_dwordx4 v[80:83], v9, s[8:11], s48 offen offset:2048
    s_waitcnt vmcnt(41)
    v_mfma_f32_16x16x32_bf16 v[200:203], a[144:147], v[84:87], v[200:203]
    v_mfma_f32_16x16x32_bf16 v[204:207], a[148:151], v[84:87], v[204:207]
    buffer_load_dwordx4 v[84:87], v10, s[8:11], s48 offen offset:2048
    s_waitcnt vmcnt(41)
    v_mfma_f32_16x16x32_bf16 v[192:195], a[152:155], v[88:91], v[192:195]
    v_mfma_f32_16x16x32_bf16 v[196:199], a[156:159], v[88:91], v[196:199]
    buffer_load_dwordx4 v[88:91], v9, s[8:11], s48 offen offset:3072
    s_waitcnt vmcnt(41)
    v_mfma_f32_16x16x32_bf16 v[200:203], a[152:155], v[92:95], v[200:203]
    v_mfma_f32_16x16x32_bf16 v[204:207], a[156:159], v[92:95], v[204:207]
    buffer_load_dwordx4 v[92:95], v10, s[8:11], s48 offen offset:3072
    s_waitcnt vmcnt(41)
    v_mfma_f32_16x16x32_bf16 v[192:195], a[160:163], v[96:99], v[192:195]
    v_mfma_f32_16x16x32_bf16 v[196:199], a[164:167], v[96:99], v[196:199]
    buffer_load_dwordx4 v[96:99], v9, s[8:11], s49 offen offset:0
    s_waitcnt vmcnt(41)
    v_mfma_f32_16x16x32_bf16 v[200:203], a[160:163], v[100:103], v[200:203]
    v_mfma_f32_16x16x32_bf16 v[204:207], a[164:167], v[100:103], v[204:207]
    buffer_load_dwordx4 v[100:103], v10, s[8:11], s49 offen offset:0
    s_waitcnt vmcnt(41)
    v_mfma_f32_16x16x32_bf16 v[192:195], a[168:171], v[104:107], v[192:195]
    v_mfma_f32_16x16x32_bf16 v[196:199], a[172:175], v[104:107], v[196:199]
    buffer_load_dwordx4 v[104:107], v9, s[8:11], s49 offen offset:1024
    s_waitcnt vmcnt(41)
    v_mfma_f32_16x16x32_bf16 v[200:203], a[168:171], v[108:111], v[200:203]
    v_mfma_f32_16x16x32_bf16 v[204:207], a[172:175], v[108:111], v[204:207]
    buffer_load_dwordx4 v[108:111], v10, s[8:11], s49 offen offset:1024
    s_waitcnt vmcnt(41)
    v_mfma_f32_16x16x32_bf16 v[192:195], a[176:179], v[112:115], v[192:195]
    v_mfma_f32_16x16x32_bf16 v[196:199], a[180:183], v[112:115], v[196:199]
    buffer_load_dwordx4 v[112:115], v9, s[8:11], s49 offen offset:2048
    s_waitcnt vmcnt(41)
    v_mfma_f32_16x16x32_bf16 v[200:203], a[176:179], v[116:119], v[200:203]
    v_mfma_f32_16x16x32_bf16 v[204:207], a[180:183], v[116:119], v[204:207]
    buffer_load_dwordx4 v[116:119], v10, s[8:11], s49 offen offset:2048
    s_waitcnt vmcnt(41)
    v_mfma_f32_16x16x32_bf16 v[192:195], a[184:187], v[120:123], v[192:195]
    v_mfma_f32_16x16x32_bf16 v[196:199], a[188:191], v[120:123], v[196:199]
    buffer_load_dwordx4 v[120:123], v9, s[8:11], s49 offen offset:3072
    s_waitcnt vmcnt(41)
    v_mfma_f32_16x16x32_bf16 v[200:203], a[184:187], v[124:127], v[200:203]
    v_mfma_f32_16x16x32_bf16 v[204:207], a[188:191], v[124:127], v[204:207]
    buffer_load_dwordx4 v[124:127], v10, s[8:11], s49 offen offset:3072
    s_waitcnt vmcnt(41)
    v_mfma_f32_16x16x32_bf16 v[192:195], a[192:195], v[128:131], v[192:195]
    v_mfma_f32_16x16x32_bf16 v[196:199], a[196:199], v[128:131], v[196:199]
    buffer_load_dwordx4 v[128:131], v9, s[8:11], s50 offen offset:0
    s_waitcnt vmcnt(41)
    v_mfma_f32_16x16x32_bf16 v[200:203], a[192:195], v[132:135], v[200:203]
    v_mfma_f32_16x16x32_bf16 v[204:207], a[196:199], v[132:135], v[204:207]
    buffer_load_dwordx4 v[132:135], v10, s[8:11], s50 offen offset:0
    s_waitcnt vmcnt(41)
    v_mfma_f32_16x16x32_bf16 v[192:195], a[200:203], v[136:139], v[192:195]
    v_mfma_f32_16x16x32_bf16 v[196:199], a[204:207], v[136:139], v[196:199]
    buffer_load_dwordx4 v[136:139], v9, s[8:11], s50 offen offset:1024
    s_waitcnt vmcnt(41)
    v_mfma_f32_16x16x32_bf16 v[200:203], a[200:203], v[140:143], v[200:203]
    v_mfma_f32_16x16x32_bf16 v[204:207], a[204:207], v[140:143], v[204:207]
    buffer_load_dwordx4 v[140:143], v10, s[8:11], s50 offen offset:1024
    s_waitcnt vmcnt(41)
    v_mfma_f32_16x16x32_bf16 v[192:195], a[208:211], v[144:147], v[192:195]
    v_mfma_f32_16x16x32_bf16 v[196:199], a[212:215], v[144:147], v[196:199]
    buffer_load_dwordx4 v[144:147], v9, s[8:11], s50 offen offset:2048
    s_waitcnt vmcnt(41)
    v_mfma_f32_16x16x32_bf16 v[200:203], a[208:211], v[148:151], v[200:203]
    v_mfma_f32_16x16x32_bf16 v[204:207], a[212:215], v[148:151], v[204:207]
    buffer_load_dwordx4 v[148:151], v10, s[8:11], s50 offen offset:2048
    s_waitcnt vmcnt(41)
    v_mfma_f32_16x16x32_bf16 v[192:195], a[216:219], v[152:155], v[192:195]
    v_mfma_f32_16x16x32_bf16 v[196:199], a[220:223], v[152:155], v[196:199]
    buffer_load_dwordx4 v[152:155], v9, s[8:11], s50 offen offset:3072
    s_waitcnt vmcnt(41)
    v_mfma_f32_16x16x32_bf16 v[200:203], a[216:219], v[156:159], v[200:203]
    v_mfma_f32_16x16x32_bf16 v[204:207], a[220:223], v[156:159], v[204:207]
    buffer_load_dwordx4 v[156:159], v10, s[8:11], s50 offen offset:3072
    s_waitcnt vmcnt(41)
    v_mfma_f32_16x16x32_bf16 v[192:195], a[224:227], v[160:163], v[192:195]
    v_mfma_f32_16x16x32_bf16 v[196:199], a[228:231], v[160:163], v[196:199]
    buffer_load_dwordx4 v[160:163], v9, s[8:11], s51 offen offset:0
    s_waitcnt vmcnt(41)
    v_mfma_f32_16x16x32_bf16 v[200:203], a[224:227], v[164:167], v[200:203]
    v_mfma_f32_16x16x32_bf16 v[204:207], a[228:231], v[164:167], v[204:207]
    buffer_load_dwordx4 v[164:167], v10, s[8:11], s51 offen offset:0
    s_waitcnt vmcnt(41)
    v_mfma_f32_16x16x32_bf16 v[192:195], a[232:235], v[168:171], v[192:195]
    v_mfma_f32_16x16x32_bf16 v[196:199], a[236:239], v[168:171], v[196:199]
    buffer_load_dwordx4 v[168:171], v9, s[8:11], s51 offen offset:1024
    s_waitcnt vmcnt(41)
    v_mfma_f32_16x16x32_bf16 v[200:203], a[232:235], v[172:175], v[200:203]
    v_mfma_f32_16x16x32_bf16 v[204:207], a[236:239], v[172:175], v[204:207]
    buffer_load_dwordx4 v[172:175], v10, s[8:11], s51 offen offset:1024
    s_waitcnt vmcnt(41)
    v_mfma_f32_16x16x32_bf16 v[192:195], a[240:243], v[176:179], v[192:195]
    v_mfma_f32_16x16x32_bf16 v[196:199], a[244:247], v[176:179], v[196:199]
    buffer_load_dwordx4 v[176:179], v9, s[8:11], s51 offen offset:2048
    s_waitcnt vmcnt(41)
    v_mfma_f32_16x16x32_bf16 v[200:203], a[240:243], v[180:183], v[200:203]
    v_mfma_f32_16x16x32_bf16 v[204:207], a[244:247], v[180:183], v[204:207]
    buffer_load_dwordx4 v[180:183], v10, s[8:11], s51 offen offset:2048
    s_waitcnt vmcnt(41)
    v_mfma_f32_16x16x32_bf16 v[192:195], a[248:251], v[184:187], v[192:195]
    v_mfma_f32_16x16x32_bf16 v[196:199], a[252:255], v[184:187], v[196:199]
    buffer_load_dwordx4 v[184:187], v9, s[8:11], s51 offen offset:3072
    s_waitcnt vmcnt(41)
    v_mfma_f32_16x16x32_bf16 v[200:203], a[248:251], v[188:191], v[200:203]
    v_mfma_f32_16x16x32_bf16 v[204:207], a[252:255], v[188:191], v[204:207]
    buffer_load_dwordx4 v[188:191], v10, s[8:11], s51 offen offset:3072
    s_nop 5
    ds_write_b128 v11, v[192:195] offset:0
    ds_write_b128 v11, v[196:199] offset:1024
    ds_write_b128 v11, v[200:203] offset:2048
    ds_write_b128 v11, v[204:207] offset:3072
    s_waitcnt lgkmcnt(0)
    s_barrier
    ds_read_b32 v24, v22
    ds_read_b128 v[224:227], v12 offset:0
    ds_read_b128 v[228:231], v12 offset:4096
    ds_read_b128 v[232:235], v12 offset:8192
    ds_read_b128 v[236:239], v12 offset:12288
    v_xor_b32 v11, 0x4000, v11
    v_xor_b32 v12, 0x4000, v12
    v_xor_b32 v21, 0x4000, v21
    v_xor_b32 v22, 0x4000, v22
    s_waitcnt lgkmcnt(2)
    v_add_f32 v224, v224, v228
    v_add_f32 v225, v225, v229
    v_add_f32 v226, v226, v230
    v_add_f32 v227, v227, v231
    s_waitcnt lgkmcnt(0)
    v_add_f32 v232, v232, v236
    v_add_f32 v233, v233, v237
    v_add_f32 v234, v234, v238
    v_add_f32 v235, v235, v239
    v_add_f32 v224, v224, v232
    v_add_f32 v225, v225, v233
    v_add_f32 v226, v226, v234
    v_add_f32 v227, v227, v235
    v_fma_f32 v224, v224, v220, v216
    v_fma_f32 v225, v225, v220, v217
    v_fma_f32 v226, v226, v220, v218
    v_fma_f32 v227, v227, v220, v219
    v_cvt_pk_bf16_f32 v228, v224, v225
    v_cvt_pk_bf16_f32 v229, v226, v227
    buffer_store_dwordx2 v[228:229], v13, s[84:87], s56 offen
    s_mov_b32 s31, s30
    v_readfirstlane_b32 s30, v24
    s_branch .main_241
.drain_242:
    s_waitcnt vmcnt(31)
    v_mfma_f32_16x16x32_bf16 v[192:195], a[128:131], v[64:67], v[192:195]
    v_mfma_f32_16x16x32_bf16 v[196:199], a[132:135], v[64:67], v[196:199]
    s_waitcnt vmcnt(30)
    v_mfma_f32_16x16x32_bf16 v[200:203], a[128:131], v[68:71], v[200:203]
    v_mfma_f32_16x16x32_bf16 v[204:207], a[132:135], v[68:71], v[204:207]
    s_waitcnt vmcnt(29)
    v_mfma_f32_16x16x32_bf16 v[192:195], a[136:139], v[72:75], v[192:195]
    v_mfma_f32_16x16x32_bf16 v[196:199], a[140:143], v[72:75], v[196:199]
    s_waitcnt vmcnt(28)
    v_mfma_f32_16x16x32_bf16 v[200:203], a[136:139], v[76:79], v[200:203]
    v_mfma_f32_16x16x32_bf16 v[204:207], a[140:143], v[76:79], v[204:207]
    s_waitcnt vmcnt(27)
    v_mfma_f32_16x16x32_bf16 v[192:195], a[144:147], v[80:83], v[192:195]
    v_mfma_f32_16x16x32_bf16 v[196:199], a[148:151], v[80:83], v[196:199]
    s_waitcnt vmcnt(26)
    v_mfma_f32_16x16x32_bf16 v[200:203], a[144:147], v[84:87], v[200:203]
    v_mfma_f32_16x16x32_bf16 v[204:207], a[148:151], v[84:87], v[204:207]
    s_waitcnt vmcnt(25)
    v_mfma_f32_16x16x32_bf16 v[192:195], a[152:155], v[88:91], v[192:195]
    v_mfma_f32_16x16x32_bf16 v[196:199], a[156:159], v[88:91], v[196:199]
    s_waitcnt vmcnt(24)
    v_mfma_f32_16x16x32_bf16 v[200:203], a[152:155], v[92:95], v[200:203]
    v_mfma_f32_16x16x32_bf16 v[204:207], a[156:159], v[92:95], v[204:207]
    s_waitcnt vmcnt(23)
    v_mfma_f32_16x16x32_bf16 v[192:195], a[160:163], v[96:99], v[192:195]
    v_mfma_f32_16x16x32_bf16 v[196:199], a[164:167], v[96:99], v[196:199]
    s_waitcnt vmcnt(22)
    v_mfma_f32_16x16x32_bf16 v[200:203], a[160:163], v[100:103], v[200:203]
    v_mfma_f32_16x16x32_bf16 v[204:207], a[164:167], v[100:103], v[204:207]
    s_waitcnt vmcnt(21)
    v_mfma_f32_16x16x32_bf16 v[192:195], a[168:171], v[104:107], v[192:195]
    v_mfma_f32_16x16x32_bf16 v[196:199], a[172:175], v[104:107], v[196:199]
    s_waitcnt vmcnt(20)
    v_mfma_f32_16x16x32_bf16 v[200:203], a[168:171], v[108:111], v[200:203]
    v_mfma_f32_16x16x32_bf16 v[204:207], a[172:175], v[108:111], v[204:207]
    s_waitcnt vmcnt(19)
    v_mfma_f32_16x16x32_bf16 v[192:195], a[176:179], v[112:115], v[192:195]
    v_mfma_f32_16x16x32_bf16 v[196:199], a[180:183], v[112:115], v[196:199]
    s_waitcnt vmcnt(18)
    v_mfma_f32_16x16x32_bf16 v[200:203], a[176:179], v[116:119], v[200:203]
    v_mfma_f32_16x16x32_bf16 v[204:207], a[180:183], v[116:119], v[204:207]
    s_waitcnt vmcnt(17)
    v_mfma_f32_16x16x32_bf16 v[192:195], a[184:187], v[120:123], v[192:195]
    v_mfma_f32_16x16x32_bf16 v[196:199], a[188:191], v[120:123], v[196:199]
    s_waitcnt vmcnt(16)
    v_mfma_f32_16x16x32_bf16 v[200:203], a[184:187], v[124:127], v[200:203]
    v_mfma_f32_16x16x32_bf16 v[204:207], a[188:191], v[124:127], v[204:207]
    s_waitcnt vmcnt(15)
    v_mfma_f32_16x16x32_bf16 v[192:195], a[192:195], v[128:131], v[192:195]
    v_mfma_f32_16x16x32_bf16 v[196:199], a[196:199], v[128:131], v[196:199]
    s_waitcnt vmcnt(14)
    v_mfma_f32_16x16x32_bf16 v[200:203], a[192:195], v[132:135], v[200:203]
    v_mfma_f32_16x16x32_bf16 v[204:207], a[196:199], v[132:135], v[204:207]
    s_waitcnt vmcnt(13)
    v_mfma_f32_16x16x32_bf16 v[192:195], a[200:203], v[136:139], v[192:195]
    v_mfma_f32_16x16x32_bf16 v[196:199], a[204:207], v[136:139], v[196:199]
    s_waitcnt vmcnt(12)
    v_mfma_f32_16x16x32_bf16 v[200:203], a[200:203], v[140:143], v[200:203]
    v_mfma_f32_16x16x32_bf16 v[204:207], a[204:207], v[140:143], v[204:207]
    s_waitcnt vmcnt(11)
    v_mfma_f32_16x16x32_bf16 v[192:195], a[208:211], v[144:147], v[192:195]
    v_mfma_f32_16x16x32_bf16 v[196:199], a[212:215], v[144:147], v[196:199]
    s_waitcnt vmcnt(10)
    v_mfma_f32_16x16x32_bf16 v[200:203], a[208:211], v[148:151], v[200:203]
    v_mfma_f32_16x16x32_bf16 v[204:207], a[212:215], v[148:151], v[204:207]
    s_waitcnt vmcnt(9)
    v_mfma_f32_16x16x32_bf16 v[192:195], a[216:219], v[152:155], v[192:195]
    v_mfma_f32_16x16x32_bf16 v[196:199], a[220:223], v[152:155], v[196:199]
    s_waitcnt vmcnt(8)
    v_mfma_f32_16x16x32_bf16 v[200:203], a[216:219], v[156:159], v[200:203]
    v_mfma_f32_16x16x32_bf16 v[204:207], a[220:223], v[156:159], v[204:207]
    s_waitcnt vmcnt(7)
    v_mfma_f32_16x16x32_bf16 v[192:195], a[224:227], v[160:163], v[192:195]
    v_mfma_f32_16x16x32_bf16 v[196:199], a[228:231], v[160:163], v[196:199]
    s_waitcnt vmcnt(6)
    v_mfma_f32_16x16x32_bf16 v[200:203], a[224:227], v[164:167], v[200:203]
    v_mfma_f32_16x16x32_bf16 v[204:207], a[228:231], v[164:167], v[204:207]
    s_waitcnt vmcnt(5)
    v_mfma_f32_16x16x32_bf16 v[192:195], a[232:235], v[168:171], v[192:195]
    v_mfma_f32_16x16x32_bf16 v[196:199], a[236:239], v[168:171], v[196:199]
    s_waitcnt vmcnt(4)
    v_mfma_f32_16x16x32_bf16 v[200:203], a[232:235], v[172:175], v[200:203]
    v_mfma_f32_16x16x32_bf16 v[204:207], a[236:239], v[172:175], v[204:207]
    s_waitcnt vmcnt(3)
    v_mfma_f32_16x16x32_bf16 v[192:195], a[240:243], v[176:179], v[192:195]
    v_mfma_f32_16x16x32_bf16 v[196:199], a[244:247], v[176:179], v[196:199]
    s_waitcnt vmcnt(2)
    v_mfma_f32_16x16x32_bf16 v[200:203], a[240:243], v[180:183], v[200:203]
    v_mfma_f32_16x16x32_bf16 v[204:207], a[244:247], v[180:183], v[204:207]
    s_waitcnt vmcnt(1)
    v_mfma_f32_16x16x32_bf16 v[192:195], a[248:251], v[184:187], v[192:195]
    v_mfma_f32_16x16x32_bf16 v[196:199], a[252:255], v[184:187], v[196:199]
    s_waitcnt vmcnt(0)
    v_mfma_f32_16x16x32_bf16 v[200:203], a[248:251], v[188:191], v[200:203]
    v_mfma_f32_16x16x32_bf16 v[204:207], a[252:255], v[188:191], v[204:207]
    s_nop 5
    ds_write_b128 v11, v[192:195] offset:0
    ds_write_b128 v11, v[196:199] offset:1024
    ds_write_b128 v11, v[200:203] offset:2048
    ds_write_b128 v11, v[204:207] offset:3072
    s_waitcnt lgkmcnt(0)
    s_barrier
    ds_read_b32 v24, v22
    ds_read_b128 v[224:227], v12 offset:0
    ds_read_b128 v[228:231], v12 offset:4096
    ds_read_b128 v[232:235], v12 offset:8192
    ds_read_b128 v[236:239], v12 offset:12288
    v_xor_b32 v11, 0x4000, v11
    v_xor_b32 v12, 0x4000, v12
    v_xor_b32 v21, 0x4000, v21
    v_xor_b32 v22, 0x4000, v22
    s_waitcnt lgkmcnt(2)
    v_add_f32 v224, v224, v228
    v_add_f32 v225, v225, v229
    v_add_f32 v226, v226, v230
    v_add_f32 v227, v227, v231
    s_waitcnt lgkmcnt(0)
    v_add_f32 v232, v232, v236
    v_add_f32 v233, v233, v237
    v_add_f32 v234, v234, v238
    v_add_f32 v235, v235, v239
    v_add_f32 v224, v224, v232
    v_add_f32 v225, v225, v233
    v_add_f32 v226, v226, v234
    v_add_f32 v227, v227, v235
    v_fma_f32 v224, v224, v220, v216
    v_fma_f32 v225, v225, v220, v217
    v_fma_f32 v226, v226, v220, v218
    v_fma_f32 v227, v227, v220, v219
    v_cvt_pk_bf16_f32 v228, v224, v225
    v_cvt_pk_bf16_f32 v229, v226, v227
    buffer_store_dwordx2 v[228:229], v13, s[84:87], s56 offen
    s_mov_b32 s31, s30
    v_readfirstlane_b32 s30, v24
    s_cmp_lt_u32 s31, 64
    s_cbranch_scc1 .cold_240
.gx_239:
    s_endpgm
.mg_end_1:
    s_endpgm
.section .rodata,"a"
.p2align 6
.amdhsa_kernel mega_kernel
  .amdhsa_next_free_vgpr 512
  .amdhsa_next_free_sgpr 102
  .amdhsa_accum_offset 256
  .amdhsa_group_segment_fixed_size 0
  .amdhsa_kernarg_size 136
  .amdhsa_user_sgpr_count 2
  .amdhsa_user_sgpr_kernarg_segment_ptr 1
  .amdhsa_system_sgpr_workgroup_id_x 1
.end_amdhsa_kernel
```

```asm
; @launch kernel=mega_kernel grid=(256,1,1) block=(256,1,1) lds=163840
.amdgcn_target "amdgcn-amd-amdhsa--gfx950"
.text
.globl mega_kernel
.p2align 8
.type mega_kernel,@function
mega_kernel:
    s_cmp_ge_u32 s2, 256
    s_cbranch_scc1 .mg_end_1
    s_load_dwordx4 s[52:55], s[0:1], 120
    s_load_dwordx2 s[40:41], s[0:1], 56
    s_getreg_b32 s3, hwreg(HW_REG_XCC_ID)
    v_and_b32 v1, 63, v0
    v_lshrrev_b32 v4, 6, v0
    s_and_b32 s3, s3, 7
    v_readfirstlane_b32 s24, v4
    s_waitcnt lgkmcnt(0)
    s_mov_b32 s8, s54
    s_and_b32 s9, s55, 0xffff
    s_mov_b32 s10, 0x10000000
    s_mov_b32 s11, 0x00020000
    s_mov_b32 s20, s52
    s_and_b32 s21, s53, 0xffff
    s_mov_b32 s22, 0x100
    s_mov_b32 s23, 0x00020000
    s_mov_b32 s100, s54
    v_mov_b32 v7, 163832
    s_cmp_lg_u32 s24, 0
    s_cbranch_scc1 .noat_4
    s_mov_b64 exec, 1
    v_mov_b32 v5, 1
    s_lshl_b32 s4, s3, 2
    v_mov_b32 v6, s4
    buffer_atomic_add v5, v6, s[20:23], 0 offen sc0 sc1
    s_mov_b64 exec, -1
.noat_4:
    s_sub_u32 s101, 0, s100
    s_and_b32 s101, s101, 0x1fffff
    s_add_u32 s101, s101, 100663296
    s_lshl_b32 s4, s2, 2
    s_add_u32 s4, s4, s24
    s_lshl_b32 s5, s4, 11
    s_add_u32 s5, s5, s101
    v_lshlrev_b32 v8, 4, v1
    v_mov_b32 v20, -1
    v_mov_b32 v21, -1
    v_mov_b32 v22, -1
    v_mov_b32 v23, -1
    s_cmp_ge_u32 s4, 64
    s_cbranch_scc1 .m0_5
    s_mov_b32 s12, s40
    s_and_b32 s13, s41, 0xffff
    s_mov_b32 s14, 0x4000
    s_mov_b32 s15, 0x00020000
    s_and_b32 s6, s4, 15
    s_lshl_b32 s6, s6, 7
    v_bfe_u32 v254, v1, 0, 3
    v_mul_u32_u24 v9, 2048, v254
    v_bfe_u32 v254, v1, 3, 2
    v_mul_u32_u24 v254, 16, v254
    v_add_u32 v9, v9, v254
    v_bfe_u32 v254, v1, 5, 1
    v_mul_u32_u24 v254, 64, v254
    v_add_u32 v9, v9, v254
    buffer_load_dwordx4 v[24:27], v9, s[12:15], s6 offen
.m0_5:
    buffer_store_dwordx4 v[20:23], v8, s[8:11], s5 offen sc1
    buffer_store_dwordx4 v[20:23], v8, s[8:11], s5 offen offset:1024 sc1
    s_lshl_b32 s5, s4, 10
    s_sub_u32 s6, s4, 64
    s_cmp_ge_u32 s6, 20
    s_cbranch_scc1 .nf_7
    v_mov_b32 v24, 0
    v_mov_b32 v25, 0
    v_mov_b32 v26, 0
    v_mov_b32 v27, 0
    s_add_u32 s6, s5, 92209152
    buffer_store_dwordx4 v[24:27], v8, s[8:11], s6 offen sc1
.nf_7:
    s_add_u32 s5, s5, 83886080
    s_cmp_ge_u32 s4, 64
    s_cbranch_scc1 .m1_6
    s_waitcnt vmcnt(2)
    v_mov_b32 v20, v24
    v_min_u32 v21, 0xfffffffe, v25
    v_mov_b32 v22, v26
    v_min_u32 v23, 0xfffffffe, v27
.m1_6:
    buffer_store_dwordx4 v[20:23], v8, s[8:11], s5 offen sc1
    s_waitcnt vmcnt(0)
    s_cmp_lg_u32 s24, 0
    s_cbranch_scc1 .nw_9
    s_mov_b64 exec, 1
    ds_write_b32 v7, v5
    s_waitcnt lgkmcnt(0)
    s_mov_b64 exec, -1
.nw_9:
    s_barrier
    ds_read_b32 v5, v7
    s_cmp_lg_u32 s24, 1
    s_cbranch_scc1 .ns_8
    s_mov_b64 exec, 1
    v_mov_b32 v6, 1
    buffer_atomic_add v6, v8, s[20:23], 0 offen offset:32 sc1
    s_mov_b64 exec, -1
.ns_8:
    s_waitcnt lgkmcnt(0)
    v_readfirstlane_b32 s26, v5
    s_mov_b32 s25, s3
    s_mov_b32 s27, 0
    s_and_b32 s26, s26, 31
.mg_role_3:
    s_cmp_ge_u32 s25, 4
    s_cbranch_scc1 .mg_bg_2
    s_load_dwordx8 s[84:91], s[0:1], 64
    v_and_b32 v1, 63, v0
    s_lshl_b32 s4, s25, 3
    s_and_b32 s5, s26, 4
    s_or_b32 s4, s4, s5
    s_cbranch_scc1 .nocal_10
    s_cmp_lg_u32 s24, 3
    s_cbranch_scc1 .calb_11
    s_lshr_b32 s4, s26, 1
    s_and_b32 s4, s4, 12
    s_and_b32 s5, s26, 3
    s_or_b32 s4, s4, s5
    s_lshl_b32 s5, s4, 11
    s_add_u32 s5, s5, s101
    s_mov_b64 exec, 1
    v_mov_b32 v4, -1
    v_mov_b32 v5, 0
    s_mov_b32 s7, 0xffff
    s_memtime s[72:73]
    s_waitcnt lgkmcnt(0)
    buffer_store_dword v4, v5, s[8:11], s5 offen sc1
    s_waitcnt vmcnt(0)
    s_memtime s[74:75]
    s_waitcnt lgkmcnt(0)
    s_sub_u32 s74, s74, s72
    s_min_u32 s7, s7, s74
    s_memtime s[72:73]
    s_waitcnt lgkmcnt(0)
    buffer_store_dword v4, v5, s[8:11], s5 offen sc1
    s_waitcnt vmcnt(0)
    s_memtime s[74:75]
    s_waitcnt lgkmcnt(0)
    s_sub_u32 s74, s74, s72
    s_min_u32 s7, s7, s74
    s_memtime s[72:73]
    s_waitcnt lgkmcnt(0)
    buffer_store_dword v4, v5, s[8:11], s5 offen sc1
    s_waitcnt vmcnt(0)
    s_memtime s[74:75]
    s_waitcnt lgkmcnt(0)
    s_sub_u32 s74, s74, s72
    s_min_u32 s7, s7, s74
    s_lshl_b32 s5, s4, 1
    s_add_u32 s5, s5, 128
    v_mov_b32 v4, s7
    buffer_store_short v4, v5, s[20:23], s5 offen sc1
    s_mov_b64 exec, -1
.calb_11:
    s_barrier
.nocal_10:
    s_lshl_b32 s4, s25, 11
    s_lshl_b32 s5, s26, 6
    s_add_u32 s4, s4, s5
    s_lshl_b32 s6, s24, 21
    s_add_u32 s4, s4, s6
    s_lshl_b32 s7, s25, 21
    s_lshl_b32 s6, s24, 19
    s_add_u32 s7, s7, s6
    s_add_u32 s7, s7, s5
    s_lshl_b32 s6, s24, 15
    v_bfe_u32 v4, v1, 4, 1
    v_lshlrev_b32 v4, 1, v4
    v_and_b32 v5, 3, v1
    v_xor_b32 v4, v4, v5
    v_lshlrev_b32 v4, 4, v4
    v_bfe_u32 v254, v1, 2, 1
    v_mul_u32_u24 v5, 1, v254
    v_bfe_u32 v254, v1, 3, 1
    v_mul_u32_u24 v254, 8, v254
    v_add_u32 v5, v5, v254
    v_bfe_u32 v254, v1, 4, 1
    v_mul_u32_u24 v254, 4, v254
    v_add_u32 v5, v5, v254
    v_bfe_u32 v254, v1, 5, 1
    v_mul_u32_u24 v254, 2, v254
    v_add_u32 v5, v5, v254
    v_lshlrev_b32 v6, 13, v5
    v_add_u32 v6, v6, v4
    v_add_u32 v240, s4, v6
    v_lshlrev_b32 v6, 11, v5
    v_add_u32 v6, v6, v4
    v_add_u32 v241, s7, v6
    v_xor_b32 v241, 256, v241
    v_bfe_u32 v254, v1, 2, 2
    v_mul_u32_u24 v242, 64, v254
    v_bfe_u32 v254, v1, 4, 1
    v_mul_u32_u24 v254, 288, v254
    v_add_u32 v242, v242, v254
    v_bfe_u32 v254, v1, 5, 1
    v_mul_u32_u24 v254, 1024, v254
    v_add_u32 v242, v242, v254
    v_bfe_u32 v254, v1, 0, 2
    v_mul_u32_u24 v254, 8, v254
    v_add_u32 v242, v242, v254
    v_add_u32 v242, s6, v242
    v_xor_b32 v243, 32, v242
    s_waitcnt lgkmcnt(0)
    s_mov_b32 s16, s84
    s_and_b32 s17, s85, 0xffff
    s_mov_b32 s18, 0x800000
    s_mov_b32 s19, 0x00020000
    v_xor_b32 v240, 512, v240
    s_and_b32 s4, s26, 1
    s_lshl_b32 s98, s4, 11
    s_lshl_b32 s99, s4, 18
    s_add_u32 s98, s98, s6
    s_xor_b32 m0, s98, 0
    s_xor_b32 s5, s99, 0
    buffer_load_dwordx4 v240, s[16:19], s5 offen nt lds
    s_xor_b32 m0, s98, 1024
    s_xor_b32 s5, s99, 131072
    buffer_load_dwordx4 v240, s[16:19], s5 offen nt lds
    s_xor_b32 m0, s98, 2048
    s_xor_b32 s5, s99, 262144
    buffer_load_dwordx4 v240, s[16:19], s5 offen nt lds
    s_xor_b32 m0, s98, 3072
    s_xor_b32 s5, s99, 393216
    buffer_load_dwordx4 v240, s[16:19], s5 offen nt lds
    s_xor_b32 m0, s98, 4096
    s_xor_b32 s5, s99, 524288
    buffer_load_dwordx4 v240, s[16:19], s5 offen nt lds
    s_xor_b32 m0, s98, 5120
    s_xor_b32 s5, s99, 655360
    buffer_load_dwordx4 v240, s[16:19], s5 offen nt lds
    s_xor_b32 m0, s98, 6144
    s_xor_b32 s5, s99, 786432
    buffer_load_dwordx4 v240, s[16:19], s5 offen nt lds
    s_xor_b32 m0, s98, 7168
    s_xor_b32 s5, s99, 917504
    buffer_load_dwordx4 v240, s[16:19], s5 offen nt lds
    s_xor_b32 m0, s98, 8192
    s_xor_b32 s5, s99, 1048576
    buffer_load_dwordx4 v240, s[16:19], s5 offen nt lds
    s_xor_b32 m0, s98, 9216
    s_xor_b32 s5, s99, 1179648
    buffer_load_dwordx4 v240, s[16:19], s5 offen nt lds
    s_xor_b32 m0, s98, 10240
    s_xor_b32 s5, s99, 1310720
    buffer_load_dwordx4 v240, s[16:19], s5 offen nt lds
    s_xor_b32 m0, s98, 11264
    s_xor_b32 s5, s99, 1441792
    buffer_load_dwordx4 v240, s[16:19], s5 offen nt lds
    s_xor_b32 m0, s98, 12288
    s_xor_b32 s5, s99, 1572864
    buffer_load_dwordx4 v240, s[16:19], s5 offen nt lds
    s_xor_b32 m0, s98, 13312
    s_xor_b32 s5, s99, 1703936
    buffer_load_dwordx4 v240, s[16:19], s5 offen nt lds
    s_xor_b32 m0, s98, 14336
    s_xor_b32 s5, s99, 1835008
    buffer_load_dwordx4 v240, s[16:19], s5 offen nt lds
    s_xor_b32 m0, s98, 15360
    s_xor_b32 s5, s99, 1966080
    buffer_load_dwordx4 v240, s[16:19], s5 offen nt lds
    s_mov_b32 s16, s86
    s_and_b32 s17, s87, 0xffff
    s_mov_b32 s18, 0x800000
    s_mov_b32 s19, 0x00020000
    v_xor_b32 v240, 640, v240
    s_and_b32 s4, s26, 1
    s_lshl_b32 s98, s4, 11
    s_lshl_b32 s99, s4, 18
    s_add_u32 s98, s98, s6
    s_xor_b32 m0, s98, 16384
    s_xor_b32 s5, s99, 0
    buffer_load_dwordx4 v240, s[16:19], s5 offen nt lds
    s_xor_b32 m0, s98, 17408
    s_xor_b32 s5, s99, 131072
    buffer_load_dwordx4 v240, s[16:19], s5 offen nt lds
    s_xor_b32 m0, s98, 18432
    s_xor_b32 s5, s99, 262144
    buffer_load_dwordx4 v240, s[16:19], s5 offen nt lds
    s_xor_b32 m0, s98, 19456
    s_xor_b32 s5, s99, 393216
    buffer_load_dwordx4 v240, s[16:19], s5 offen nt lds
    s_xor_b32 m0, s98, 20480
    s_xor_b32 s5, s99, 524288
    buffer_load_dwordx4 v240, s[16:19], s5 offen nt lds
    s_xor_b32 m0, s98, 21504
    s_xor_b32 s5, s99, 655360
    buffer_load_dwordx4 v240, s[16:19], s5 offen nt lds
    s_xor_b32 m0, s98, 22528
    s_xor_b32 s5, s99, 786432
    buffer_load_dwordx4 v240, s[16:19], s5 offen nt lds
    s_xor_b32 m0, s98, 23552
    s_xor_b32 s5, s99, 917504
    buffer_load_dwordx4 v240, s[16:19], s5 offen nt lds
    s_xor_b32 m0, s98, 24576
    s_xor_b32 s5, s99, 1048576
    buffer_load_dwordx4 v240, s[16:19], s5 offen nt lds
    s_xor_b32 m0, s98, 25600
    s_xor_b32 s5, s99, 1179648
    buffer_load_dwordx4 v240, s[16:19], s5 offen nt lds
    s_xor_b32 m0, s98, 26624
    s_xor_b32 s5, s99, 1310720
    buffer_load_dwordx4 v240, s[16:19], s5 offen nt lds
    s_xor_b32 m0, s98, 27648
    s_xor_b32 s5, s99, 1441792
    buffer_load_dwordx4 v240, s[16:19], s5 offen nt lds
    s_xor_b32 m0, s98, 28672
    s_xor_b32 s5, s99, 1572864
    buffer_load_dwordx4 v240, s[16:19], s5 offen nt lds
    s_xor_b32 m0, s98, 29696
    s_xor_b32 s5, s99, 1703936
    buffer_load_dwordx4 v240, s[16:19], s5 offen nt lds
    s_xor_b32 m0, s98, 30720
    s_xor_b32 s5, s99, 1835008
    buffer_load_dwordx4 v240, s[16:19], s5 offen nt lds
    s_xor_b32 m0, s98, 31744
    s_xor_b32 s5, s99, 1966080
    buffer_load_dwordx4 v240, s[16:19], s5 offen nt lds
    s_lshr_b32 s52, s26, 2
    s_and_b32 s53, s26, 3
    s_lshl_b32 s54, s25, 14
    s_lshl_b32 s55, s26, 9
    s_add_u32 s55, s55, s54
    s_lshl_b32 s56, s25, 3
    s_add_u32 s56, s56, s52
    s_lshl_b32 s57, s56, 12
    s_lshl_b32 s58, s53, 9
    s_add_u32 s58, s58, s57
    s_mov_b32 s48, 0x00ff00ff
    s_mov_b32 s49, 0x00ff00ff
    s_mov_b32 s50, 0xff00ff00
    s_mov_b32 s51, 0xff00ff00
    v_mov_b32 v2, 0x4444
    v_mov_b32 v4, 0xeeee
    s_lshl_b32 s4, s24, 12
    s_add_u32 s4, s4, s54
    v_cndmask_b32 v2, v4, v2, s[48:49]
    v_bfe_u32 v254, v1, 0, 6
    v_mul_u32_u24 v3, 16, v254
    v_add_u32 v3, s4, v3
    v_add_u32 v4, 0x10000, v3
    s_mul_i32 s4, s24, 1152
    v_bfe_u32 v254, v1, 4, 1
    v_mul_u32_u24 v5, 576, v254
    v_bfe_u32 v254, v1, 5, 1
    v_mul_u32_u24 v254, 64, v254
    v_add_u32 v5, v5, v254
    v_bfe_u32 v254, v1, 0, 4
    v_mul_u32_u24 v254, 4, v254
    v_add_u32 v5, v5, v254
    v_add_u32 v5, s4, v5
    v_add_u32 v6, 4608, v5
    v_add_u32 v7, 9216, v5
    s_lshl_b32 s4, s24, 10
    v_bfe_u32 v254, v1, 0, 6
    v_mul_u32_u24 v8, 16, v254
    v_add_u32 v8, 13824, v8
    v_add_u32 v8, s4, v8
    s_and_b32 s4, s24, 1
    s_lshr_b32 s5, s24, 1
    s_lshl_b32 s59, s4, 6
    s_mul_i32 s60, s5, 4608
    s_add_u32 s59, s59, s60
    s_lshl_b32 s4, s4, 8
    s_add_u32 s60, s58, s4
    s_lshl_b32 s5, s5, 11
    s_add_u32 s61, s60, s5
    s_cmp_lt_u32 s24, 2
    s_cselect_b32 s5, 8, 1
    s_lshl_b32 s5, s5, 10
    s_xor_b32 s61, s61, s5
    v_bfe_u32 v254, v1, 2, 3
    v_mul_u32_u24 v9, 144, v254
    v_bfe_u32 v254, v1, 5, 1
    v_mul_u32_u24 v254, 32, v254
    v_add_u32 v9, v9, v254
    v_bfe_u32 v254, v1, 0, 2
    v_mul_u32_u24 v254, 8, v254
    v_add_u32 v9, v9, v254
    v_add_u32 v9, s59, v9
    v_bfe_u32 v254, v1, 0, 6
    v_mul_u32_u24 v10, 4, v254
    v_add_u32 v10, 131072, v10
    v_add_u32 v10, s61, v10
    v_bfe_u32 v254, v1, 0, 6
    v_mul_u32_u24 v11, 4, v254
    v_add_u32 v11, 17920, v11
    v_add_u32 v11, s4, v11
    v_mov_b32 v20, -1
    v_mov_b32 v21, -1
    v_mov_b32 v22, -1
    v_mov_b32 v23, -1
    v_mov_b32 v40, 0
    v_mov_b32 v41, 0
    v_mov_b32 v42, 0
    v_mov_b32 v43, 0
    v_mov_b32 v44, 0
    v_mov_b32 v45, 0
    v_mov_b32 v46, 0
    v_mov_b32 v47, 0
    v_mov_b32 v48, 0
    v_mov_b32 v49, 0
    v_mov_b32 v50, 0
    v_mov_b32 v51, 0
    v_mov_b32 v52, 0
    v_mov_b32 v53, 0
    v_mov_b32 v54, 0
    v_mov_b32 v55, 0
    v_mov_b32 v56, 0
    v_mov_b32 v57, 0
    v_mov_b32 v58, 0
    v_mov_b32 v59, 0
    v_mov_b32 v60, 0
    v_mov_b32 v61, 0
    v_mov_b32 v62, 0
    v_mov_b32 v63, 0
    v_mov_b32 v64, 0
    v_mov_b32 v65, 0
    v_mov_b32 v66, 0
    v_mov_b32 v67, 0
    v_mov_b32 v68, 0
    v_mov_b32 v69, 0
    v_mov_b32 v70, 0
    v_mov_b32 v71, 0
    v_bfe_u32 v254, v1, 0, 5
    v_mul_u32_u24 v244, 16, v254
    v_bfe_u32 v254, v1, 5, 1
    v_mul_u32_u24 v254, 2048, v254
    v_add_u32 v244, v244, v254
    v_add_u32 v244, 131072, v244
    v_add_u32 v244, s58, v244
    v_bfe_u32 v254, v1, 0, 5
    v_mul_u32_u24 v245, 16, v254
    v_bfe_u32 v254, v1, 5, 1
    v_mul_u32_u24 v254, 65536, v254
    v_add_u32 v245, v245, v254
    v_add_u32 v245, s55, v245
    s_waitcnt vmcnt(16)
    ds_read_b64_tr_b16 a[0:1], v242 offset:0
    ds_read_b64_tr_b16 a[2:3], v242 offset:512
    ds_read_b64_tr_b16 a[4:5], v242 offset:2048
    ds_read_b64_tr_b16 a[6:7], v242 offset:2560
    ds_read_b64_tr_b16 a[8:9], v242 offset:4096
    ds_read_b64_tr_b16 a[10:11], v242 offset:4608
    ds_read_b64_tr_b16 a[12:13], v242 offset:6144
    ds_read_b64_tr_b16 a[14:15], v242 offset:6656
    ds_read_b64_tr_b16 a[16:17], v242 offset:8192
    ds_read_b64_tr_b16 a[18:19], v242 offset:8704
    ds_read_b64_tr_b16 a[20:21], v242 offset:10240
    ds_read_b64_tr_b16 a[22:23], v242 offset:10752
    ds_read_b64_tr_b16 a[24:25], v242 offset:12288
    ds_read_b64_tr_b16 a[26:27], v242 offset:12800
    ds_read_b64_tr_b16 a[28:29], v242 offset:14336
    ds_read_b64_tr_b16 a[30:31], v242 offset:14848
    ds_read_b64_tr_b16 a[32:33], v243 offset:0
    ds_read_b64_tr_b16 a[34:35], v243 offset:512
    ds_read_b64_tr_b16 a[36:37], v243 offset:2048
    ds_read_b64_tr_b16 a[38:39], v243 offset:2560
    ds_read_b64_tr_b16 a[40:41], v243 offset:4096
    ds_read_b64_tr_b16 a[42:43], v243 offset:4608
    ds_read_b64_tr_b16 a[44:45], v243 offset:6144
    ds_read_b64_tr_b16 a[46:47], v243 offset:6656
    ds_read_b64_tr_b16 a[48:49], v243 offset:8192
    ds_read_b64_tr_b16 a[50:51], v243 offset:8704
    ds_read_b64_tr_b16 a[52:53], v243 offset:10240
    ds_read_b64_tr_b16 a[54:55], v243 offset:10752
    ds_read_b64_tr_b16 a[56:57], v243 offset:12288
    ds_read_b64_tr_b16 a[58:59], v243 offset:12800
    ds_read_b64_tr_b16 a[60:61], v243 offset:14336
    ds_read_b64_tr_b16 a[62:63], v243 offset:14848
    s_waitcnt lgkmcnt(0)
    s_mov_b32 s16, s88
    s_and_b32 s17, s89, 0xffff
    s_mov_b32 s18, 0x800000
    s_mov_b32 s19, 0x00020000
    v_xor_b32 v240, 128, v240
    s_and_b32 s4, s26, 1
    s_lshl_b32 s98, s4, 11
    s_lshl_b32 s99, s4, 18
    s_add_u32 s98, s98, s6
    s_xor_b32 m0, s98, 0
    s_xor_b32 s5, s99, 0
    buffer_load_dwordx4 v240, s[16:19], s5 offen nt lds
    s_xor_b32 m0, s98, 1024
    s_xor_b32 s5, s99, 131072
    buffer_load_dwordx4 v240, s[16:19], s5 offen nt lds
    s_xor_b32 m0, s98, 2048
    s_xor_b32 s5, s99, 262144
    buffer_load_dwordx4 v240, s[16:19], s5 offen nt lds
    s_xor_b32 m0, s98, 3072
    s_xor_b32 s5, s99, 393216
    buffer_load_dwordx4 v240, s[16:19], s5 offen nt lds
    s_xor_b32 m0, s98, 4096
    s_xor_b32 s5, s99, 524288
    buffer_load_dwordx4 v240, s[16:19], s5 offen nt lds
    s_xor_b32 m0, s98, 5120
    s_xor_b32 s5, s99, 655360
    buffer_load_dwordx4 v240, s[16:19], s5 offen nt lds
    s_xor_b32 m0, s98, 6144
    s_xor_b32 s5, s99, 786432
    buffer_load_dwordx4 v240, s[16:19], s5 offen nt lds
    s_xor_b32 m0, s98, 7168
    s_xor_b32 s5, s99, 917504
    buffer_load_dwordx4 v240, s[16:19], s5 offen nt lds
    s_xor_b32 m0, s98, 8192
    s_xor_b32 s5, s99, 1048576
    buffer_load_dwordx4 v240, s[16:19], s5 offen nt lds
    s_xor_b32 m0, s98, 9216
    s_xor_b32 s5, s99, 1179648
    buffer_load_dwordx4 v240, s[16:19], s5 offen nt lds
    s_xor_b32 m0, s98, 10240
    s_xor_b32 s5, s99, 1310720
    buffer_load_dwordx4 v240, s[16:19], s5 offen nt lds
    s_xor_b32 m0, s98, 11264
    s_xor_b32 s5, s99, 1441792
    buffer_load_dwordx4 v240, s[16:19], s5 offen nt lds
    s_xor_b32 m0, s98, 12288
    s_xor_b32 s5, s99, 1572864
    buffer_load_dwordx4 v240, s[16:19], s5 offen nt lds
    s_xor_b32 m0, s98, 13312
    s_xor_b32 s5, s99, 1703936
    buffer_load_dwordx4 v240, s[16:19], s5 offen nt lds
    s_xor_b32 m0, s98, 14336
    s_xor_b32 s5, s99, 1835008
    buffer_load_dwordx4 v240, s[16:19], s5 offen nt lds
    s_xor_b32 m0, s98, 15360
    s_xor_b32 s5, s99, 1966080
    buffer_load_dwordx4 v240, s[16:19], s5 offen nt lds
    s_waitcnt vmcnt(16)
    ds_read_b64_tr_b16 a[64:65], v242 offset:16384
    ds_read_b64_tr_b16 a[66:67], v242 offset:16896
    ds_read_b64_tr_b16 a[68:69], v242 offset:18432
    ds_read_b64_tr_b16 a[70:71], v242 offset:18944
    ds_read_b64_tr_b16 a[72:73], v242 offset:20480
    ds_read_b64_tr_b16 a[74:75], v242 offset:20992
    ds_read_b64_tr_b16 a[76:77], v242 offset:22528
    ds_read_b64_tr_b16 a[78:79], v242 offset:23040
    ds_read_b64_tr_b16 a[80:81], v242 offset:24576
    ds_read_b64_tr_b16 a[82:83], v242 offset:25088
    ds_read_b64_tr_b16 a[84:85], v242 offset:26624
    ds_read_b64_tr_b16 a[86:87], v242 offset:27136
    ds_read_b64_tr_b16 a[88:89], v242 offset:28672
    ds_read_b64_tr_b16 a[90:91], v242 offset:29184
    ds_read_b64_tr_b16 a[92:93], v242 offset:30720
    ds_read_b64_tr_b16 a[94:95], v242 offset:31232
    ds_read_b64_tr_b16 a[96:97], v243 offset:16384
    ds_read_b64_tr_b16 a[98:99], v243 offset:16896
    ds_read_b64_tr_b16 a[100:101], v243 offset:18432
    ds_read_b64_tr_b16 a[102:103], v243 offset:18944
    ds_read_b64_tr_b16 a[104:105], v243 offset:20480
    ds_read_b64_tr_b16 a[106:107], v243 offset:20992
    ds_read_b64_tr_b16 a[108:109], v243 offset:22528
    ds_read_b64_tr_b16 a[110:111], v243 offset:23040
    ds_read_b64_tr_b16 a[112:113], v243 offset:24576
    ds_read_b64_tr_b16 a[114:115], v243 offset:25088
    ds_read_b64_tr_b16 a[116:117], v243 offset:26624
    ds_read_b64_tr_b16 a[118:119], v243 offset:27136
    ds_read_b64_tr_b16 a[120:121], v243 offset:28672
    ds_read_b64_tr_b16 a[122:123], v243 offset:29184
    ds_read_b64_tr_b16 a[124:125], v243 offset:30720
    ds_read_b64_tr_b16 a[126:127], v243 offset:31232
    s_waitcnt lgkmcnt(0)
    v_lshlrev_b32 v239, 2, v1
    buffer_load_dword v238, v239, s[20:23], 0 offen sc1
    s_mov_b32 s16, s90
    s_and_b32 s17, s91, 0xffff
    s_mov_b32 s18, 0x800000
    s_mov_b32 s19, 0x00020000
    s_and_b32 s4, s26, 1
    s_lshl_b32 s98, s4, 11
    s_lshl_b32 s99, s4, 16
    s_add_u32 s98, s98, s6
    s_xor_b32 m0, s98, 16384
    s_xor_b32 s5, s99, 0
    buffer_load_dwordx4 v241, s[16:19], s5 offen nt lds
    s_xor_b32 m0, s98, 17408
    s_xor_b32 s5, s99, 32768
    buffer_load_dwordx4 v241, s[16:19], s5 offen nt lds
    s_xor_b32 m0, s98, 18432
    s_xor_b32 s5, s99, 65536
    buffer_load_dwordx4 v241, s[16:19], s5 offen nt lds
    s_xor_b32 m0, s98, 19456
    s_xor_b32 s5, s99, 98304
    buffer_load_dwordx4 v241, s[16:19], s5 offen nt lds
    s_xor_b32 m0, s98, 20480
    s_xor_b32 s5, s99, 131072
    buffer_load_dwordx4 v241, s[16:19], s5 offen nt lds
    s_xor_b32 m0, s98, 21504
    s_xor_b32 s5, s99, 163840
    buffer_load_dwordx4 v241, s[16:19], s5 offen nt lds
    s_xor_b32 m0, s98, 22528
    s_xor_b32 s5, s99, 196608
    buffer_load_dwordx4 v241, s[16:19], s5 offen nt lds
    s_xor_b32 m0, s98, 23552
    s_xor_b32 s5, s99, 229376
    buffer_load_dwordx4 v241, s[16:19], s5 offen nt lds
    s_xor_b32 m0, s98, 24576
    s_xor_b32 s5, s99, 262144
    buffer_load_dwordx4 v241, s[16:19], s5 offen nt lds
    s_xor_b32 m0, s98, 25600
    s_xor_b32 s5, s99, 294912
    buffer_load_dwordx4 v241, s[16:19], s5 offen nt lds
    s_xor_b32 m0, s98, 26624
    s_xor_b32 s5, s99, 327680
    buffer_load_dwordx4 v241, s[16:19], s5 offen nt lds
    s_xor_b32 m0, s98, 27648
    s_xor_b32 s5, s99, 360448
    buffer_load_dwordx4 v241, s[16:19], s5 offen nt lds
    s_xor_b32 m0, s98, 28672
    s_xor_b32 s5, s99, 393216
    buffer_load_dwordx4 v241, s[16:19], s5 offen nt lds
    s_xor_b32 m0, s98, 29696
    s_xor_b32 s5, s99, 425984
    buffer_load_dwordx4 v241, s[16:19], s5 offen nt lds
    s_xor_b32 m0, s98, 30720
    s_xor_b32 s5, s99, 458752
    buffer_load_dwordx4 v241, s[16:19], s5 offen nt lds
    s_xor_b32 m0, s98, 31744
    s_xor_b32 s5, s99, 491520
    buffer_load_dwordx4 v241, s[16:19], s5 offen nt lds
    s_waitcnt vmcnt(16)
    s_cmp_lg_u32 s27, 0
    s_cbranch_scc1 .vd_13
    s_mov_b32 s62, 0
.vp_12:
    v_readlane_b32 s4, v238, 8
    s_cmp_ge_u32 s4, 256
    s_cbranch_scc1 .va_14
    s_add_u32 s62, s62, 1
    s_cmp_gt_u32 s62, 0x100000
    s_cbranch_scc1 .mg_end_1
    s_sleep 16
    buffer_load_dword v238, v239, s[20:23], 0 offen sc1
    s_waitcnt vmcnt(0)
    s_branch .vp_12
.va_14:
    v_cmp_ne_u32 vcc, 32, v238
    s_and_b32 s4, vcc_lo, 0xff
    s_cbranch_scc0 .vd_13
    s_lshr_b32 s25, s2, 5
    s_and_b32 s26, s2, 31
    s_mov_b32 s27, 1
    s_waitcnt vmcnt(0) lgkmcnt(0)
    s_barrier
    s_branch .mg_role_3
.vd_13:
    ds_read_b64_tr_b16 a[128:129], v242 offset:0
    ds_read_b64_tr_b16 a[130:131], v242 offset:512
    ds_read_b64_tr_b16 a[132:133], v242 offset:2048
    ds_read_b64_tr_b16 a[134:135], v242 offset:2560
    ds_read_b64_tr_b16 a[136:137], v242 offset:4096
    ds_read_b64_tr_b16 a[138:139], v242 offset:4608
    ds_read_b64_tr_b16 a[140:141], v242 offset:6144
    ds_read_b64_tr_b16 a[142:143], v242 offset:6656
    ds_read_b64_tr_b16 a[144:145], v242 offset:8192
    ds_read_b64_tr_b16 a[146:147], v242 offset:8704
    ds_read_b64_tr_b16 a[148:149], v242 offset:10240
    ds_read_b64_tr_b16 a[150:151], v242 offset:10752
    ds_read_b64_tr_b16 a[152:153], v242 offset:12288
    ds_read_b64_tr_b16 a[154:155], v242 offset:12800
    ds_read_b64_tr_b16 a[156:157], v242 offset:14336
    ds_read_b64_tr_b16 a[158:159], v242 offset:14848
    ds_read_b64_tr_b16 a[160:161], v243 offset:0
    ds_read_b64_tr_b16 a[162:163], v243 offset:512
    ds_read_b64_tr_b16 a[164:165], v243 offset:2048
    ds_read_b64_tr_b16 a[166:167], v243 offset:2560
    ds_read_b64_tr_b16 a[168:169], v243 offset:4096
    ds_read_b64_tr_b16 a[170:171], v243 offset:4608
    ds_read_b64_tr_b16 a[172:173], v243 offset:6144
    ds_read_b64_tr_b16 a[174:175], v243 offset:6656
    ds_read_b64_tr_b16 a[176:177], v243 offset:8192
    ds_read_b64_tr_b16 a[178:179], v243 offset:8704
    ds_read_b64_tr_b16 a[180:181], v243 offset:10240
    ds_read_b64_tr_b16 a[182:183], v243 offset:10752
    ds_read_b64_tr_b16 a[184:185], v243 offset:12288
    ds_read_b64_tr_b16 a[186:187], v243 offset:12800
    ds_read_b64_tr_b16 a[188:189], v243 offset:14336
    ds_read_b64_tr_b16 a[190:191], v243 offset:14848
    s_waitcnt lgkmcnt(0)
    s_mov_b32 s47, 0
    s_cmp_lg_u32 s27, 0
    s_cbranch_scc1 .cd_16
    s_mov_b32 s62, 0
.cp_15:
    v_and_b32 v18, 0xffff, v238
    v_lshrrev_b32 v19, 16, v238
    v_min_u32 v17, v18, v19
    v_cmp_eq_u32 vcc, 0, v17
    s_and_b32 s4, vcc_hi, 0xff
    s_cbranch_scc0 .cg_17
    s_add_u32 s62, s62, 1
    s_cmp_gt_u32 s62, 0x100000
    s_cbranch_scc1 .mg_end_1
    s_sleep 16
    buffer_load_dword v238, v239, s[20:23], 0 offen sc1
    s_waitcnt vmcnt(0)
    s_branch .cp_15
.cg_17:
    v_readlane_b32 s66, v18, 32
    v_readlane_b32 s67, v19, 32
    v_readlane_b32 s68, v18, 33
    v_readlane_b32 s69, v19, 33
    v_readlane_b32 s70, v18, 34
    v_readlane_b32 s71, v19, 34
    v_readlane_b32 s72, v18, 35
    v_readlane_b32 s73, v19, 35
    v_readlane_b32 s74, v18, 36
    v_readlane_b32 s75, v19, 36
    v_readlane_b32 s76, v18, 37
    v_readlane_b32 s77, v19, 37
    v_readlane_b32 s78, v18, 38
    v_readlane_b32 s79, v19, 38
    v_readlane_b32 s80, v18, 39
    v_readlane_b32 s81, v19, 39
    s_nop 3
    s_add_u32 s4, s66, s67
    s_add_u32 s4, s4, s68
    s_add_u32 s4, s4, s69
    s_add_u32 s4, s4, s74
    s_add_u32 s4, s4, s75
    s_add_u32 s4, s4, s76
    s_add_u32 s4, s4, s77
    s_add_u32 s5, s70, s71
    s_add_u32 s5, s5, s72
    s_add_u32 s5, s5, s73
    s_add_u32 s5, s5, s78
    s_add_u32 s5, s5, s79
    s_add_u32 s5, s5, s80
    s_add_u32 s5, s5, s81
    s_cmp_lt_u32 s5, s4
    s_cselect_b32 s47, 0x2000, 0
    s_cselect_b32 s66, s70, s66
    s_cselect_b32 s67, s71, s67
    s_cselect_b32 s68, s72, s68
    s_cselect_b32 s69, s73, s69
    s_cselect_b32 s74, s78, s74
    s_cselect_b32 s75, s79, s75
    s_cselect_b32 s76, s80, s76
    s_cselect_b32 s77, s81, s77
    s_add_u32 s4, s66, s68
    s_add_u32 s4, s4, s74
    s_add_u32 s4, s4, s76
    s_add_u32 s5, s67, s69
    s_add_u32 s5, s5, s75
    s_add_u32 s5, s5, s77
    s_cmp_lt_u32 s5, s4
    s_cselect_b32 s4, 2048, 0
    s_or_b32 s47, s47, s4
    s_add_u32 s4, s66, s67
    s_add_u32 s4, s4, s74
    s_add_u32 s4, s4, s75
    s_add_u32 s5, s68, s69
    s_add_u32 s5, s5, s76
    s_add_u32 s5, s5, s77
    s_cmp_lt_u32 s5, s4
    s_cselect_b32 s4, 4096, 0
    s_or_b32 s47, s47, s4
    s_add_u32 s4, s66, s67
    s_add_u32 s4, s4, s68
    s_add_u32 s4, s4, s69
    s_add_u32 s5, s74, s75
    s_add_u32 s5, s5, s76
    s_add_u32 s5, s5, s77
    s_cmp_lt_u32 s5, s4
    s_cselect_b32 s4, 16384, 0
    s_or_b32 s47, s47, s4
.cd_16:
    s_cmp_lg_u32 s27, 0
    s_cbranch_scc1 .slowv_18
    s_mov_b32 s28, 0
    s_mov_b32 s30, 83886080
    s_mov_b32 s31, 84148224
    s_mov_b32 s32, 84410368
    s_mov_b32 s33, 84672512
    s_mov_b32 s41, 66977792
    s_lshl_b32 s42, s56, 13
    s_lshl_b32 s4, s53, 11
    s_add_u32 s44, s42, s4
    s_add_u32 s44, s44, 33554432
    s_add_u32 s42, s42, 16777216
    s_add_u32 s43, s42, 4096
    s_add_u32 s96, s44, 524288
    s_sub_u32 s95, s96, 16777216
    s_mov_b32 s62, 0
    s_mov_b32 s45, 0x3e0293ee
    s_mov_b32 s46, 0
    s_and_b32 s4, s25, 1
    s_lshl_b32 s4, s4, 14
    s_lshr_b32 s5, s25, 1
    s_lshl_b32 s5, s5, 12
    s_or_b32 s4, s4, s5
    s_xor_b32 s47, s47, s4
    s_and_b32 s5, s26, 1
    s_lshl_b32 s5, s5, 10
    s_lshr_b32 s4, s26, 1
    s_lshl_b32 s4, s4, 15
    s_or_b32 s5, s5, s4
    s_bfe_u32 s4, s26, 0x10004
    s_lshl_b32 s4, s4, 11
    s_xor_b32 s5, s5, s4
    s_xor_b32 s34, s5, s47
    s_xor_b32 s35, s34, 0x84000
    s_xor_b32 s36, s34, 0x101000
    s_xor_b32 s37, s34, 0x185000
    s_cmp_eq_u32 s24, 1
    s_cbranch_scc1 .w1_20
    s_cmp_eq_u32 s24, 2
    s_cbranch_scc1 .w2_21
    s_cmp_eq_u32 s24, 3
    s_cbranch_scc1 .w3_22
.w0_19:
    v_bfe_u32 v254, v1, 4, 2
    v_mul_u32_u24 v12, 128, v254
    v_bfe_u32 v254, v1, 0, 3
    v_mul_u32_u24 v254, 16, v254
    v_add_u32 v12, v12, v254
    v_add_u32 v12, 131072, v12
    v_add_u32 v12, s57, v12
    v_bfe_u32 v254, v1, 4, 2
    v_mul_u32_u24 v13, 128, v254
    v_bfe_u32 v254, v1, 2, 2
    v_mul_u32_u24 v254, 32, v254
    v_add_u32 v13, v13, v254
    v_bfe_u32 v254, v1, 0, 1
    v_mul_u32_u24 v254, 16, v254
    v_add_u32 v13, v13, v254
    v_add_u32 v13, 133120, v13
    v_add_u32 v13, s57, v13
    v_bfe_u32 v254, v1, 4, 2
    v_mul_u32_u24 v14, 128, v254
    v_bfe_u32 v254, v1, 0, 4
    v_mul_u32_u24 v254, 16, v254
    v_add_u32 v14, v14, v254
    v_add_u32 v14, 65536, v14
    v_add_u32 v14, s55, v14
    v_bfe_u32 v254, v1, 0, 6
    v_mul_u32_u24 v15, 16, v254
    v_bfe_u32 v254, v1, 2, 2
    v_mul_u32_u24 v16, 128, v254
    v_bfe_u32 v254, v1, 0, 2
    v_mul_u32_u24 v254, 16, v254
    v_add_u32 v16, v16, v254
    v_bfe_u32 v254, v1, 4, 2
    v_mul_u32_u24 v254, 4, v254
    v_add_u32 v16, v16, v254
    v_add_u32 v16, 18432, v16
    v_mov_b32 v144, 0
    v_mov_b32 v145, 0
    v_mov_b32 v146, 0
    v_mov_b32 v147, 0
    v_mov_b32 v148, 0
    v_mov_b32 v149, 0
    v_mov_b32 v150, 0
    v_mov_b32 v151, 0
    v_mov_b32 v152, 0
    v_mov_b32 v153, 0
    v_mov_b32 v154, 0
    v_mov_b32 v155, 0
    v_mov_b32 v156, 0
    v_mov_b32 v157, 0
    v_mov_b32 v158, 0
    v_mov_b32 v159, 0
    v_mov_b32 v160, 0
    v_mov_b32 v161, 0
    v_mov_b32 v162, 0
    v_mov_b32 v163, 0
    v_mov_b32 v164, 0
    v_mov_b32 v165, 0
    v_mov_b32 v166, 0
    v_mov_b32 v167, 0
    v_mov_b32 v168, 0
    v_mov_b32 v169, 0
    v_mov_b32 v170, 0
    v_mov_b32 v171, 0
    v_mov_b32 v172, 0
    v_mov_b32 v173, 0
    v_mov_b32 v174, 0
    v_mov_b32 v175, 0
    v_mov_b32 v208, 0
    v_mov_b32 v209, 0
    v_mov_b32 v210, 0
    v_mov_b32 v211, 0
    v_mov_b32 v212, 0
    v_mov_b32 v213, 0
    v_mov_b32 v214, 0
    v_mov_b32 v215, 0
    v_mov_b32 v216, 0
    v_mov_b32 v217, 0
    v_mov_b32 v218, 0
    v_mov_b32 v219, 0
    v_mov_b32 v18, 0xff800000
    v_cndmask_b32 v200, v18, 0, s[48:49]
    v_mov_b32 v220, 0x3f803f80
    v_cndmask_b32 v201, v18, 0, s[48:49]
    v_mov_b32 v221, 0x3f803f80
    v_cndmask_b32 v202, v18, 0, s[48:49]
    v_mov_b32 v222, 0x3f803f80
    v_cndmask_b32 v203, v18, 0, s[48:49]
    v_mov_b32 v223, 0x3f803f80
    s_waitcnt vmcnt(0)
    ds_read_b64_tr_b16 a[192:193], v242 offset:16384
    ds_read_b64_tr_b16 a[194:195], v242 offset:16896
    ds_read_b64_tr_b16 a[196:197], v242 offset:18432
    ds_read_b64_tr_b16 a[198:199], v242 offset:18944
    ds_read_b64_tr_b16 a[200:201], v242 offset:20480
    ds_read_b64_tr_b16 a[202:203], v242 offset:20992
    ds_read_b64_tr_b16 a[204:205], v242 offset:22528
    ds_read_b64_tr_b16 a[206:207], v242 offset:23040
    ds_read_b64_tr_b16 a[208:209], v242 offset:24576
    ds_read_b64_tr_b16 a[210:211], v242 offset:25088
    ds_read_b64_tr_b16 a[212:213], v242 offset:26624
    ds_read_b64_tr_b16 a[214:215], v242 offset:27136
    ds_read_b64_tr_b16 a[216:217], v242 offset:28672
    ds_read_b64_tr_b16 a[218:219], v242 offset:29184
    ds_read_b64_tr_b16 a[220:221], v242 offset:30720
    ds_read_b64_tr_b16 a[222:223], v242 offset:31232
    ds_read_b64_tr_b16 a[224:225], v243 offset:16384
    ds_read_b64_tr_b16 a[226:227], v243 offset:16896
    ds_read_b64_tr_b16 a[228:229], v243 offset:18432
    ds_read_b64_tr_b16 a[230:231], v243 offset:18944
    ds_read_b64_tr_b16 a[232:233], v243 offset:20480
    ds_read_b64_tr_b16 a[234:235], v243 offset:20992
    ds_read_b64_tr_b16 a[236:237], v243 offset:22528
    ds_read_b64_tr_b16 a[238:239], v243 offset:23040
    ds_read_b64_tr_b16 a[240:241], v243 offset:24576
    ds_read_b64_tr_b16 a[242:243], v243 offset:25088
    ds_read_b64_tr_b16 a[244:245], v243 offset:26624
    ds_read_b64_tr_b16 a[246:247], v243 offset:27136
    ds_read_b64_tr_b16 a[248:249], v243 offset:28672
    ds_read_b64_tr_b16 a[250:251], v243 offset:29184
    ds_read_b64_tr_b16 a[252:253], v243 offset:30720
    ds_read_b64_tr_b16 a[254:255], v243 offset:31232
    s_waitcnt lgkmcnt(0)
    s_barrier
    buffer_load_dwordx4 v[104:107], v15, s[8:11], s42 offen offset:0
    buffer_load_dwordx4 v[108:111], v15, s[8:11], s42 offen offset:1024
    buffer_load_dwordx4 v[112:115], v15, s[8:11], s42 offen offset:2048
    buffer_load_dwordx4 v[116:119], v15, s[8:11], s42 offen offset:3072
    buffer_load_dwordx4 v[120:123], v15, s[8:11], s43 offen offset:0
    buffer_load_dwordx4 v[124:127], v15, s[8:11], s43 offen offset:1024
    buffer_load_dwordx4 v[128:131], v15, s[8:11], s43 offen offset:2048
    buffer_load_dwordx4 v[132:135], v15, s[8:11], s43 offen offset:3072
    buffer_load_dwordx4 v[136:139], v15, s[8:11], s44 offen offset:0
    buffer_load_dwordx4 v[140:143], v15, s[8:11], s44 offen offset:1024
    s_add_u32 s42, s42, 262144
    s_add_u32 s43, s43, 262144
    s_add_u32 s44, s44, 262144
.p2align 6
.step_23:
    s_barrier
    s_setprio 3
    buffer_load_dwordx4 v[24:27], v3, s[8:11], s30 offen offset:0 sc1
    s_setprio 2
    buffer_load_dwordx4 v[28:31], v3, s[8:11], s30 offen offset:1024 sc1
    s_setprio 1
    buffer_load_dwordx4 v[32:35], v3, s[8:11], s30 offen offset:2048 sc1
    s_setprio 0
    buffer_load_dwordx4 v[36:39], v3, s[8:11], s30 offen offset:3072 sc1
    s_waitcnt vmcnt(3)
    v_max_u32 v18, v25, v27
    v_cmp_eq_u32 vcc, -1, v18
    s_cbranch_vccnz .gs_25
.gr_26:
    v_smfmac_f32_16x16x64_bf16 v[40:43], v[24:27], a[0:7], v2
    v_smfmac_f32_16x16x64_bf16 v[44:47], v[24:27], a[32:39], v2
    s_waitcnt vmcnt(2)
    v_max_u32 v18, v29, v31
    v_cmp_eq_u32 vcc, -1, v18
    v_smfmac_f32_16x16x64_bf16 v[48:51], v[24:27], a[64:71], v2
    s_cbranch_vccnz .gs_27
.gr_28:
    v_smfmac_f32_16x16x64_bf16 v[40:43], v[28:31], a[8:15], v2
    v_smfmac_f32_16x16x64_bf16 v[44:47], v[28:31], a[40:47], v2
    v_smfmac_f32_16x16x64_bf16 v[52:55], v[24:27], a[96:103], v2
    s_waitcnt vmcnt(1)
    v_max_u32 v18, v33, v35
    v_cmp_eq_u32 vcc, -1, v18
    v_smfmac_f32_16x16x64_bf16 v[48:51], v[28:31], a[72:79], v2
    s_cbranch_vccnz .gs_29
.gr_30:
    v_smfmac_f32_16x16x64_bf16 v[40:43], v[32:35], a[16:23], v2
    v_smfmac_f32_16x16x64_bf16 v[44:47], v[32:35], a[48:55], v2
    v_smfmac_f32_16x16x64_bf16 v[52:55], v[28:31], a[104:111], v2
    s_waitcnt vmcnt(0)
    v_max_u32 v18, v37, v39
    v_cmp_eq_u32 vcc, -1, v18
    v_smfmac_f32_16x16x64_bf16 v[48:51], v[32:35], a[80:87], v2
    s_cbranch_vccnz .gs_31
.gr_32:
    v_smfmac_f32_16x16x64_bf16 v[40:43], v[36:39], a[24:31], v2
    v_smfmac_f32_16x16x64_bf16 v[44:47], v[36:39], a[56:63], v2
    v_smfmac_f32_16x16x64_bf16 v[52:55], v[32:35], a[112:119], v2
    v_smfmac_f32_16x16x64_bf16 v[48:51], v[36:39], a[88:95], v2
    v_permlane32_swap_b32 v40, v44
    v_permlane32_swap_b32 v41, v45
    v_smfmac_f32_16x16x64_bf16 v[52:55], v[36:39], a[120:127], v2
    v_permlane32_swap_b32 v42, v46
    v_permlane32_swap_b32 v43, v47
    v_add_f32 v40, v40, v44
    v_add_f32 v41, v41, v45
    v_add_f32 v42, v42, v46
    v_add_f32 v43, v43, v47
    ds_write2_b32 v5, v40, v41 offset0:0 offset1:36
    ds_write2_b32 v5, v42, v43 offset0:72 offset1:108
    v_permlane32_swap_b32 v48, v52
    v_permlane32_swap_b32 v49, v53
    v_permlane32_swap_b32 v50, v54
    v_permlane32_swap_b32 v51, v55
    v_add_f32 v48, v48, v52
    v_add_f32 v49, v49, v53
    v_add_f32 v50, v50, v54
    v_add_f32 v51, v51, v55
    ds_write2_b32 v6, v48, v49 offset0:0 offset1:36
    ds_write2_b32 v6, v50, v51 offset0:72 offset1:108
    s_waitcnt lgkmcnt(2)
    s_barrier
    ds_read_b64 v[72:73], v9 offset:0
    ds_read_b64 v[74:75], v9 offset:1152
    ds_read_b64 v[76:77], v9 offset:2304
    ds_read_b64 v[78:79], v9 offset:3456
    s_waitcnt lgkmcnt(4)
    s_barrier
    s_waitcnt lgkmcnt(2)
    v_add_f32 v72, v72, v74
    v_add_f32 v73, v73, v75
    s_waitcnt lgkmcnt(0)
    v_add_f32 v76, v76, v78
    v_add_f32 v77, v77, v79
    v_add_f32 v72, v72, v76
    v_add_f32 v73, v73, v77
    v_cvt_pk_bf16_f32 v72, v72, v73
    v_min_u32 v72, 0xfffffffe, v72
    buffer_store_dword v72, v10, s[8:11], s30 offen
    v_smfmac_f32_16x16x64_bf16 v[56:59], v[24:27], a[128:135], v2
    v_smfmac_f32_16x16x64_bf16 v[60:63], v[24:27], a[160:167], v2
    v_smfmac_f32_16x16x64_bf16 v[56:59], v[28:31], a[136:143], v2
    v_smfmac_f32_16x16x64_bf16 v[60:63], v[28:31], a[168:175], v2
    v_smfmac_f32_16x16x64_bf16 v[56:59], v[32:35], a[144:151], v2
    v_smfmac_f32_16x16x64_bf16 v[60:63], v[32:35], a[176:183], v2
    v_smfmac_f32_16x16x64_bf16 v[56:59], v[36:39], a[152:159], v2
    v_smfmac_f32_16x16x64_bf16 v[60:63], v[36:39], a[184:191], v2
    v_mov_b32 v40, 0
    v_mov_b32 v41, 0
    v_mov_b32 v42, 0
    v_mov_b32 v43, 0
    v_mov_b32 v44, 0
    v_mov_b32 v45, 0
    v_mov_b32 v46, 0
    v_mov_b32 v47, 0
    v_permlane32_swap_b32 v56, v60
    v_permlane32_swap_b32 v57, v61
    v_permlane32_swap_b32 v58, v62
    v_permlane32_swap_b32 v59, v63
    v_add_f32 v56, v56, v60
    v_add_f32 v57, v57, v61
    v_add_f32 v58, v58, v62
    v_add_f32 v59, v59, v63
    ds_write_b128 v8, v[56:59]
    s_cmp_eq_u32 s28, 63
    s_cbranch_scc1 .fin_24
    s_waitcnt vmcnt(0)
    s_mov_b64 exec, s[48:49]
    buffer_load_dwordx4 v[144:147], v12, s[8:11], s30 offen offset:0 sc1
    buffer_load_dwordx4 v[148:151], v12, s[8:11], s30 offen offset:512 sc1
    buffer_load_dwordx4 v[152:155], v12, s[8:11], s30 offen offset:1024 sc1
    buffer_load_dwordx4 v[156:159], v12, s[8:11], s30 offen offset:1536 sc1
    s_mov_b64 exec, s[50:51]
    buffer_load_dwordx4 v[160:163], v12, s[8:11], s30 offen offset:0 sc1
    buffer_load_dwordx4 v[164:167], v12, s[8:11], s30 offen offset:512 sc1
    buffer_load_dwordx4 v[168:171], v12, s[8:11], s30 offen offset:1024 sc1
    buffer_load_dwordx4 v[172:175], v12, s[8:11], s30 offen offset:1536 sc1
    s_mov_b64 exec, -1
    buffer_load_dwordx4 v[176:179], v13, s[8:11], s30 offen offset:0 sc1
    buffer_load_dwordx4 v[180:183], v13, s[8:11], s30 offen offset:512 sc1
    buffer_load_dwordx4 v[184:187], v13, s[8:11], s30 offen offset:1024 sc1
    buffer_load_dwordx4 v[188:191], v13, s[8:11], s30 offen offset:1536 sc1
    s_waitcnt lgkmcnt(0)
    s_barrier
.mf_33:
    s_waitcnt vmcnt(11)
    v_mfma_f32_16x16x32_bf16 v[192:195], v[104:107], v[144:147], 0
    v_max3_u32 v18, v144, v145, v146
    v_max_u32 v18, v18, v147
    s_waitcnt vmcnt(10)
    v_mfma_f32_16x16x32_bf16 v[192:195], v[108:111], v[148:151], v[192:195]
    v_max3_u32 v18, v18, v148, v149
    v_max3_u32 v18, v18, v150, v151
    s_waitcnt vmcnt(9)
    v_mfma_f32_16x16x32_bf16 v[192:195], v[112:115], v[152:155], v[192:195]
    v_max3_u32 v18, v18, v152, v153
    v_max3_u32 v18, v18, v154, v155
    s_waitcnt vmcnt(8)
    v_mfma_f32_16x16x32_bf16 v[192:195], v[116:119], v[156:159], v[192:195]
    v_max3_u32 v18, v18, v156, v157
    v_max3_u32 v18, v18, v158, v159
    s_waitcnt vmcnt(7)
    v_mfma_f32_16x16x32_bf16 v[192:195], v[120:123], v[160:163], v[192:195]
    v_cmp_eq_u32 vcc, -1, v18
    s_waitcnt vmcnt(6)
    v_mfma_f32_16x16x32_bf16 v[192:195], v[124:127], v[164:167], v[192:195]
    s_cbranch_vccnz .re_34
    s_waitcnt vmcnt(5)
    v_mfma_f32_16x16x32_bf16 v[192:195], v[128:131], v[168:171], v[192:195]
    s_waitcnt vmcnt(4)
    v_mfma_f32_16x16x32_bf16 v[192:195], v[132:135], v[172:175], v[192:195]
.mk_35:
    s_waitcnt vmcnt(3)
    v_mfma_f32_16x16x32_bf16 v[196:199], v[176:179], v[144:147], v[200:203]
    v_max3_u32 v18, v176, v177, v178
    v_max_u32 v18, v18, v179
    s_waitcnt vmcnt(2)
    v_mfma_f32_16x16x32_bf16 v[196:199], v[180:183], v[148:151], v[196:199]
    v_max3_u32 v18, v18, v180, v181
    v_max3_u32 v18, v18, v182, v183
    s_waitcnt vmcnt(1)
    v_mfma_f32_16x16x32_bf16 v[196:199], v[184:187], v[152:155], v[196:199]
    v_max3_u32 v18, v18, v184, v185
    v_max3_u32 v18, v18, v186, v187
    s_waitcnt vmcnt(0)
    v_mfma_f32_16x16x32_bf16 v[196:199], v[188:191], v[156:159], v[196:199]
    v_max3_u32 v18, v18, v188, v189
    v_max3_u32 v18, v18, v190, v191
    v_cmp_eq_u32 vcc, -1, v18
    v_max3_f32 v19, v192, v193, v194
    s_cbranch_vccnz .rk_36
    s_barrier
    ds_read_b32 v212, v16
    ds_read_b32 v216, v16 offset:64
    v_max3_f32 v18, v195, v196, v197
    v_max_f32 v18, v18, v19
    s_nop 1
    v_max_f32_dpp v19, v18, v18 row_ror:8 row_mask:0xf bank_mask:0xf
    v_max_f32_dpp v17, v18, v18 row_ror:8 row_mask:0xf bank_mask:0xf
    s_nop 1
    v_permlane16_swap_b32 v19, v17
    v_max_f32 v18, v19, v17
    v_max_f32 v19, v19, v17
    s_nop 1
    v_permlane32_swap_b32 v18, v19
    v_max_f32 v18, v18, v19
    v_mul_f32 v18, s45, v18
    v_fma_f32 v240, v192, s45, -v18
    v_fma_f32 v241, v193, s45, -v18
    v_fma_f32 v242, v194, s45, -v18
    v_fma_f32 v243, v195, s45, -v18
    v_fma_f32 v244, v196, s45, -v18
    v_fma_f32 v245, v197, s45, -v18
    v_exp_f32 v240, v240
    v_exp_f32 v241, v241
    v_exp_f32 v242, v242
    v_exp_f32 v243, v243
    v_exp_f32 v244, v244
    v_exp_f32 v245, v245
    v_cvt_pk_bf16_f32 v204, v240, v241
    v_cvt_pk_bf16_f32 v205, v242, v243
    v_cvt_pk_bf16_f32 v208, v244, v245
    s_waitcnt lgkmcnt(0)
    v_mov_b32_dpp v206, v204 row_ror:8 row_mask:0xf bank_mask:0xf
    v_mov_b32_dpp v207, v205 row_ror:8 row_mask:0xf bank_mask:0xf
    v_mfma_f32_16x16x32_bf16 v[224:227], v[220:223], v[208:211], 0
    v_mfma_f32_16x16x32_bf16 v[224:227], v[220:223], v[204:207], v[224:227]
    v_mfma_f32_16x16x32_bf16 v[228:231], v[212:215], v[208:211], 0
    v_mfma_f32_16x16x32_bf16 v[228:231], v[136:139], v[204:207], v[228:231]
    v_mfma_f32_16x16x32_bf16 v[232:235], v[216:219], v[208:211], 0
    v_rcp_f32 v18, v224
    v_mfma_f32_16x16x32_bf16 v[232:235], v[140:143], v[204:207], v[232:235]
    s_mov_b64 exec, s[48:49]
    v_mul_f32 v228, v18, v228
    v_mul_f32 v229, v18, v229
    v_mul_f32 v230, v18, v230
    v_mul_f32 v231, v18, v231
    v_cvt_pk_bf16_f32 v236, v228, v229
    v_cvt_pk_bf16_f32 v237, v230, v231
    s_nop 1
    v_mul_f32 v232, v18, v232
    v_mul_f32 v233, v18, v233
    v_mul_f32 v234, v18, v234
    v_mul_f32 v235, v18, v235
    v_cvt_pk_bf16_f32 v238, v232, v233
    v_cvt_pk_bf16_f32 v239, v234, v235
    v_min_u32 v239, 0xfffffffe, v239
    buffer_store_dwordx4 v[236:239], v14, s[8:11], s30 offen
    s_mov_b64 exec, -1
    v_mov_b32 v48, 0
    v_mov_b32 v49, 0
    v_mov_b32 v50, 0
    v_mov_b32 v51, 0
    v_mov_b32 v52, 0
    v_mov_b32 v53, 0
    v_mov_b32 v54, 0
    v_mov_b32 v55, 0
    v_mov_b32 v56, 0
    v_mov_b32 v57, 0
    v_mov_b32 v58, 0
    v_mov_b32 v59, 0
    v_mov_b32 v60, 0
    v_mov_b32 v61, 0
    v_mov_b32 v62, 0
    v_mov_b32 v63, 0
    s_waitcnt vmcnt(0)
    s_barrier
    s_setprio 3
    buffer_load_dwordx4 v[24:27], v4, s[8:11], s30 offen offset:0 sc1
    s_setprio 2
    buffer_load_dwordx4 v[28:31], v4, s[8:11], s30 offen offset:1024 sc1
    s_setprio 1
    buffer_load_dwordx4 v[32:35], v4, s[8:11], s30 offen offset:2048 sc1
    s_setprio 0
    buffer_load_dwordx4 v[36:39], v4, s[8:11], s30 offen offset:3072 sc1
    s_waitcnt vmcnt(3)
    v_cmp_eq_u32 vcc, -1, v27
    s_cbranch_vccnz .gs_37
.gr_38:
    v_smfmac_f32_16x16x64_bf16 v[64:67], v[24:27], a[192:199], v2
    v_smfmac_f32_16x16x64_bf16 v[68:71], v[24:27], a[224:231], v2
    s_waitcnt vmcnt(2)
    v_cmp_eq_u32 vcc, -1, v31
    s_cbranch_vccnz .gs_39
.gr_40:
    v_smfmac_f32_16x16x64_bf16 v[64:67], v[28:31], a[200:207], v2
    v_smfmac_f32_16x16x64_bf16 v[68:71], v[28:31], a[232:239], v2
    s_waitcnt vmcnt(1)
    v_cmp_eq_u32 vcc, -1, v35
    s_cbranch_vccnz .gs_41
.gr_42:
    v_smfmac_f32_16x16x64_bf16 v[64:67], v[32:35], a[208:215], v2
    v_smfmac_f32_16x16x64_bf16 v[68:71], v[32:35], a[240:247], v2
    s_waitcnt vmcnt(0)
    v_cmp_eq_u32 vcc, -1, v39
    s_cbranch_vccnz .gs_43
.gr_44:
    v_smfmac_f32_16x16x64_bf16 v[64:67], v[36:39], a[216:223], v2
    v_smfmac_f32_16x16x64_bf16 v[68:71], v[36:39], a[248:255], v2
    s_nop 7
    v_permlane32_swap_b32 v64, v68
    v_permlane32_swap_b32 v65, v69
    v_permlane32_swap_b32 v66, v70
    v_permlane32_swap_b32 v67, v71
    v_add_f32 v64, v64, v68
    v_add_f32 v65, v65, v69
    v_add_f32 v66, v66, v70
    v_add_f32 v67, v67, v71
    ds_write2_b32 v7, v64, v65 offset0:0 offset1:36
    ds_write2_b32 v7, v66, v67 offset0:72 offset1:108
    s_waitcnt lgkmcnt(0)
    s_barrier
    buffer_load_dwordx4 v[104:107], v15, s[8:11], s42 offen offset:0
    buffer_load_dwordx4 v[108:111], v15, s[8:11], s42 offen offset:1024
    buffer_load_dwordx4 v[112:115], v15, s[8:11], s42 offen offset:2048
    buffer_load_dwordx4 v[116:119], v15, s[8:11], s42 offen offset:3072
    buffer_load_dwordx4 v[120:123], v15, s[8:11], s43 offen offset:0
    buffer_load_dwordx4 v[124:127], v15, s[8:11], s43 offen offset:1024
    buffer_load_dwordx4 v[128:131], v15, s[8:11], s43 offen offset:2048
    buffer_load_dwordx4 v[132:135], v15, s[8:11], s43 offen offset:3072
    buffer_load_dwordx4 v[136:139], v15, s[8:11], s44 offen offset:0
    buffer_load_dwordx4 v[140:143], v15, s[8:11], s44 offen offset:1024
    s_add_u32 s42, s42, 262144
    s_add_u32 s43, s43, 262144
    s_add_u32 s44, s44, 262144
    v_mov_b32 v64, 0
    v_mov_b32 v65, 0
    v_mov_b32 v66, 0
    v_mov_b32 v67, 0
    v_mov_b32 v68, 0
    v_mov_b32 v69, 0
    v_mov_b32 v70, 0
    v_mov_b32 v71, 0
    s_mov_b32 s4, s30
    s_mov_b32 s30, s31
    s_mov_b32 s31, s32
    s_mov_b32 s32, s33
    s_mov_b32 s33, s4
    s_add_u32 s28, s28, 1
    s_mov_b32 s62, 0
    s_branch .step_23
.fin_24:
    s_waitcnt lgkmcnt(0)
    s_barrier
    s_barrier
    s_endpgm
.gs_25:
    buffer_load_dwordx4 v[24:27], v3, s[8:11], s30 offen offset:0 sc1
    buffer_load_dwordx4 v[28:31], v3, s[8:11], s30 offen offset:1024 sc1
    buffer_load_dwordx4 v[32:35], v3, s[8:11], s30 offen offset:2048 sc1
    buffer_load_dwordx4 v[36:39], v3, s[8:11], s30 offen offset:3072 sc1
    s_add_u32 s62, s62, 1
    s_cmp_gt_u32 s62, 0x100000
    s_cbranch_scc1 .mg_end_1
    s_waitcnt vmcnt(3)
    v_max_u32 v18, v25, v27
    v_cmp_eq_u32 vcc, -1, v18
    s_cbranch_vccz .gr_26
    s_branch .gs_25
.gs_27:
    buffer_load_dwordx4 v[28:31], v3, s[8:11], s30 offen offset:1024 sc1
    buffer_load_dwordx4 v[32:35], v3, s[8:11], s30 offen offset:2048 sc1
    buffer_load_dwordx4 v[36:39], v3, s[8:11], s30 offen offset:3072 sc1
    s_add_u32 s62, s62, 1
    s_cmp_gt_u32 s62, 0x100000
    s_cbranch_scc1 .mg_end_1
    s_waitcnt vmcnt(2)
    v_max_u32 v18, v29, v31
    v_cmp_eq_u32 vcc, -1, v18
    s_cbranch_vccz .gr_28
    s_branch .gs_27
.gs_29:
    buffer_load_dwordx4 v[32:35], v3, s[8:11], s30 offen offset:2048 sc1
    buffer_load_dwordx4 v[36:39], v3, s[8:11], s30 offen offset:3072 sc1
    s_add_u32 s62, s62, 1
    s_cmp_gt_u32 s62, 0x100000
    s_cbranch_scc1 .mg_end_1
    s_waitcnt vmcnt(1)
    v_max_u32 v18, v33, v35
    v_cmp_eq_u32 vcc, -1, v18
    s_cbranch_vccz .gr_30
    s_branch .gs_29
.gs_31:
    buffer_load_dwordx4 v[36:39], v3, s[8:11], s30 offen offset:3072 sc1
    s_add_u32 s62, s62, 1
    s_cmp_gt_u32 s62, 0x100000
    s_cbranch_scc1 .mg_end_1
    s_waitcnt vmcnt(0)
    v_max_u32 v18, v37, v39
    v_cmp_eq_u32 vcc, -1, v18
    s_cbranch_vccz .gr_32
    s_branch .gs_31
.re_34:
    s_mov_b64 exec, s[48:49]
    buffer_load_dwordx4 v[144:147], v12, s[8:11], s30 offen offset:0 sc1
    buffer_load_dwordx4 v[148:151], v12, s[8:11], s30 offen offset:512 sc1
    buffer_load_dwordx4 v[152:155], v12, s[8:11], s30 offen offset:1024 sc1
    buffer_load_dwordx4 v[156:159], v12, s[8:11], s30 offen offset:1536 sc1
    s_mov_b64 exec, s[50:51]
    buffer_load_dwordx4 v[160:163], v12, s[8:11], s30 offen offset:0 sc1
    buffer_load_dwordx4 v[164:167], v12, s[8:11], s30 offen offset:512 sc1
    buffer_load_dwordx4 v[168:171], v12, s[8:11], s30 offen offset:1024 sc1
    buffer_load_dwordx4 v[172:175], v12, s[8:11], s30 offen offset:1536 sc1
    s_mov_b64 exec, -1
    buffer_load_dwordx4 v[176:179], v13, s[8:11], s30 offen offset:0 sc1
    buffer_load_dwordx4 v[180:183], v13, s[8:11], s30 offen offset:512 sc1
    buffer_load_dwordx4 v[184:187], v13, s[8:11], s30 offen offset:1024 sc1
    buffer_load_dwordx4 v[188:191], v13, s[8:11], s30 offen offset:1536 sc1
    s_add_u32 s62, s62, 1
    s_cmp_gt_u32 s62, 0x100000
    s_cbranch_scc1 .mg_end_1
    s_branch .mf_33
.rk_36:
    buffer_load_dwordx4 v[176:179], v13, s[8:11], s30 offen offset:0 sc1
    buffer_load_dwordx4 v[180:183], v13, s[8:11], s30 offen offset:512 sc1
    buffer_load_dwordx4 v[184:187], v13, s[8:11], s30 offen offset:1024 sc1
    buffer_load_dwordx4 v[188:191], v13, s[8:11], s30 offen offset:1536 sc1
    s_add_u32 s62, s62, 1
    s_cmp_gt_u32 s62, 0x100000
    s_cbranch_scc1 .mg_end_1
    s_branch .mk_35
.gs_37:
    buffer_load_dwordx4 v[24:27], v4, s[8:11], s30 offen offset:0 sc1
    buffer_load_dwordx4 v[28:31], v4, s[8:11], s30 offen offset:1024 sc1
    buffer_load_dwordx4 v[32:35], v4, s[8:11], s30 offen offset:2048 sc1
    buffer_load_dwordx4 v[36:39], v4, s[8:11], s30 offen offset:3072 sc1
    s_add_u32 s62, s62, 1
    s_cmp_gt_u32 s62, 0x100000
    s_cbranch_scc1 .mg_end_1
    s_waitcnt vmcnt(3)
    v_cmp_eq_u32 vcc, -1, v27
    s_cbranch_vccz .gr_38
    s_branch .gs_37
.gs_39:
    buffer_load_dwordx4 v[28:31], v4, s[8:11], s30 offen offset:1024 sc1
    buffer_load_dwordx4 v[32:35], v4, s[8:11], s30 offen offset:2048 sc1
    buffer_load_dwordx4 v[36:39], v4, s[8:11], s30 offen offset:3072 sc1
    s_add_u32 s62, s62, 1
    s_cmp_gt_u32 s62, 0x100000
    s_cbranch_scc1 .mg_end_1
    s_waitcnt vmcnt(2)
    v_cmp_eq_u32 vcc, -1, v31
    s_cbranch_vccz .gr_40
    s_branch .gs_39
.gs_41:
    buffer_load_dwordx4 v[32:35], v4, s[8:11], s30 offen offset:2048 sc1
    buffer_load_dwordx4 v[36:39], v4, s[8:11], s30 offen offset:3072 sc1
    s_add_u32 s62, s62, 1
    s_cmp_gt_u32 s62, 0x100000
    s_cbranch_scc1 .mg_end_1
    s_waitcnt vmcnt(1)
    v_cmp_eq_u32 vcc, -1, v35
    s_cbranch_vccz .gr_42
    s_branch .gs_41
.gs_43:
    buffer_load_dwordx4 v[36:39], v4, s[8:11], s30 offen offset:3072 sc1
    s_add_u32 s62, s62, 1
    s_cmp_gt_u32 s62, 0x100000
    s_cbranch_scc1 .mg_end_1
    s_waitcnt vmcnt(0)
    v_cmp_eq_u32 vcc, -1, v39
    s_cbranch_vccz .gr_44
    s_branch .gs_43
.w1_20:
    v_bfe_u32 v254, v1, 1, 3
    v_mul_u32_u24 v12, 144, v254
    v_bfe_u32 v254, v1, 4, 2
    v_mul_u32_u24 v254, 32, v254
    v_add_u32 v12, v12, v254
    v_bfe_u32 v254, v1, 0, 1
    v_mul_u32_u24 v254, 16, v254
    v_add_u32 v12, v12, v254
    v_add_u32 v12, 9216, v12
    v_bfe_u32 v254, v1, 0, 6
    v_mul_u32_u24 v13, 16, v254
    v_add_u32 v13, s101, v13
    v_bfe_u32 v254, v1, 0, 6
    v_mul_u32_u24 v14, 8, v254
    v_add_u32 v14, s55, v14
    v_xor_b32 v14, 2048, v14
    s_waitcnt vmcnt(0)
    ds_read_b64_tr_b16 a[192:193], v242 offset:16384
    ds_read_b64_tr_b16 a[194:195], v242 offset:16896
    ds_read_b64_tr_b16 a[196:197], v242 offset:18432
    ds_read_b64_tr_b16 a[198:199], v242 offset:18944
    ds_read_b64_tr_b16 a[200:201], v242 offset:20480
    ds_read_b64_tr_b16 a[202:203], v242 offset:20992
    ds_read_b64_tr_b16 a[204:205], v242 offset:22528
    ds_read_b64_tr_b16 a[206:207], v242 offset:23040
    ds_read_b64_tr_b16 a[208:209], v242 offset:24576
    ds_read_b64_tr_b16 a[210:211], v242 offset:25088
    ds_read_b64_tr_b16 a[212:213], v242 offset:26624
    ds_read_b64_tr_b16 a[214:215], v242 offset:27136
    ds_read_b64_tr_b16 a[216:217], v242 offset:28672
    ds_read_b64_tr_b16 a[218:219], v242 offset:29184
    ds_read_b64_tr_b16 a[220:221], v242 offset:30720
    ds_read_b64_tr_b16 a[222:223], v242 offset:31232
    ds_read_b64_tr_b16 a[224:225], v243 offset:16384
    ds_read_b64_tr_b16 a[226:227], v243 offset:16896
    ds_read_b64_tr_b16 a[228:229], v243 offset:18432
    ds_read_b64_tr_b16 a[230:231], v243 offset:18944
    ds_read_b64_tr_b16 a[232:233], v243 offset:20480
    ds_read_b64_tr_b16 a[234:235], v243 offset:20992
    ds_read_b64_tr_b16 a[236:237], v243 offset:22528
    ds_read_b64_tr_b16 a[238:239], v243 offset:23040
    ds_read_b64_tr_b16 a[240:241], v243 offset:24576
    ds_read_b64_tr_b16 a[242:243], v243 offset:25088
    ds_read_b64_tr_b16 a[244:245], v243 offset:26624
    ds_read_b64_tr_b16 a[246:247], v243 offset:27136
    ds_read_b64_tr_b16 a[248:249], v243 offset:28672
    ds_read_b64_tr_b16 a[250:251], v243 offset:29184
    ds_read_b64_tr_b16 a[252:253], v243 offset:30720
    ds_read_b64_tr_b16 a[254:255], v243 offset:31232
    s_waitcnt lgkmcnt(0)
    s_barrier
.p2align 6
.step_45:
    s_waitcnt vmcnt(0)
    s_barrier
    s_setprio 3
    buffer_load_dwordx4 v[24:27], v3, s[8:11], s30 offen offset:0 sc1
    s_setprio 2
    buffer_load_dwordx4 v[28:31], v3, s[8:11], s30 offen offset:1024 sc1
    s_setprio 1
    buffer_load_dwordx4 v[32:35], v3, s[8:11], s30 offen offset:2048 sc1
    s_setprio 0
    buffer_load_dwordx4 v[36:39], v3, s[8:11], s30 offen offset:3072 sc1
    s_waitcnt vmcnt(3)
    v_max_u32 v18, v25, v27
    v_cmp_eq_u32 vcc, -1, v18
    s_cbranch_vccnz .gs_47
.gr_48:
    v_smfmac_f32_16x16x64_bf16 v[40:43], v[24:27], a[0:7], v2
    v_smfmac_f32_16x16x64_bf16 v[44:47], v[24:27], a[32:39], v2
    s_waitcnt vmcnt(2)
    v_max_u32 v18, v29, v31
    v_cmp_eq_u32 vcc, -1, v18
    v_smfmac_f32_16x16x64_bf16 v[48:51], v[24:27], a[64:71], v2
    s_cbranch_vccnz .gs_49
.gr_50:
    v_smfmac_f32_16x16x64_bf16 v[40:43], v[28:31], a[8:15], v2
    v_smfmac_f32_16x16x64_bf16 v[44:47], v[28:31], a[40:47], v2
    v_smfmac_f32_16x16x64_bf16 v[52:55], v[24:27], a[96:103], v2
    s_waitcnt vmcnt(1)
    v_max_u32 v18, v33, v35
    v_cmp_eq_u32 vcc, -1, v18
    v_smfmac_f32_16x16x64_bf16 v[48:51], v[28:31], a[72:79], v2
    s_cbranch_vccnz .gs_51
.gr_52:
    v_smfmac_f32_16x16x64_bf16 v[40:43], v[32:35], a[16:23], v2
    v_smfmac_f32_16x16x64_bf16 v[44:47], v[32:35], a[48:55], v2
    v_smfmac_f32_16x16x64_bf16 v[52:55], v[28:31], a[104:111], v2
    s_waitcnt vmcnt(0)
    v_max_u32 v18, v37, v39
    v_cmp_eq_u32 vcc, -1, v18
    v_smfmac_f32_16x16x64_bf16 v[48:51], v[32:35], a[80:87], v2
    s_cbranch_vccnz .gs_53
.gr_54:
    v_smfmac_f32_16x16x64_bf16 v[40:43], v[36:39], a[24:31], v2
    v_smfmac_f32_16x16x64_bf16 v[44:47], v[36:39], a[56:63], v2
    v_smfmac_f32_16x16x64_bf16 v[52:55], v[32:35], a[112:119], v2
    v_smfmac_f32_16x16x64_bf16 v[48:51], v[36:39], a[88:95], v2
    v_permlane32_swap_b32 v40, v44
    v_permlane32_swap_b32 v41, v45
    v_smfmac_f32_16x16x64_bf16 v[52:55], v[36:39], a[120:127], v2
    v_permlane32_swap_b32 v42, v46
    v_permlane32_swap_b32 v43, v47
    v_add_f32 v40, v40, v44
    v_add_f32 v41, v41, v45
    v_add_f32 v42, v42, v46
    v_add_f32 v43, v43, v47
    ds_write2_b32 v5, v40, v41 offset0:0 offset1:36
    ds_write2_b32 v5, v42, v43 offset0:72 offset1:108
    v_permlane32_swap_b32 v48, v52
    v_permlane32_swap_b32 v49, v53
    v_permlane32_swap_b32 v50, v54
    v_permlane32_swap_b32 v51, v55
    v_add_f32 v48, v48, v52
    v_add_f32 v49, v49, v53
    v_add_f32 v50, v50, v54
    v_add_f32 v51, v51, v55
    ds_write2_b32 v6, v48, v49 offset0:0 offset1:36
    ds_write2_b32 v6, v50, v51 offset0:72 offset1:108
    s_waitcnt lgkmcnt(2)
    s_barrier
    ds_read_b64 v[72:73], v9 offset:0
    ds_read_b64 v[74:75], v9 offset:1152
    ds_read_b64 v[76:77], v9 offset:2304
    ds_read_b64 v[78:79], v9 offset:3456
    s_waitcnt lgkmcnt(4)
    s_barrier
    s_waitcnt lgkmcnt(2)
    v_add_f32 v72, v72, v74
    v_add_f32 v73, v73, v75
    s_waitcnt lgkmcnt(0)
    v_add_f32 v76, v76, v78
    v_add_f32 v77, v77, v79
    v_add_f32 v72, v72, v76
    v_add_f32 v73, v73, v77
    v_cvt_pk_bf16_f32 v72, v72, v73
    v_min_u32 v72, 0xfffffffe, v72
    buffer_store_dword v72, v10, s[8:11], s30 offen
    v_smfmac_f32_16x16x64_bf16 v[56:59], v[24:27], a[128:135], v2
    v_smfmac_f32_16x16x64_bf16 v[60:63], v[24:27], a[160:167], v2
    v_smfmac_f32_16x16x64_bf16 v[56:59], v[28:31], a[136:143], v2
    v_smfmac_f32_16x16x64_bf16 v[60:63], v[28:31], a[168:175], v2
    v_smfmac_f32_16x16x64_bf16 v[56:59], v[32:35], a[144:151], v2
    v_smfmac_f32_16x16x64_bf16 v[60:63], v[32:35], a[176:183], v2
    v_smfmac_f32_16x16x64_bf16 v[56:59], v[36:39], a[152:159], v2
    v_smfmac_f32_16x16x64_bf16 v[60:63], v[36:39], a[184:191], v2
    v_mov_b32 v40, 0
    v_mov_b32 v41, 0
    v_mov_b32 v42, 0
    v_mov_b32 v43, 0
    v_mov_b32 v44, 0
    v_mov_b32 v45, 0
    v_mov_b32 v46, 0
    v_mov_b32 v47, 0
    v_permlane32_swap_b32 v56, v60
    v_permlane32_swap_b32 v57, v61
    v_permlane32_swap_b32 v58, v62
    v_permlane32_swap_b32 v59, v63
    v_add_f32 v56, v56, v60
    v_add_f32 v57, v57, v61
    v_add_f32 v58, v58, v62
    v_add_f32 v59, v59, v63
    ds_write_b128 v8, v[56:59]
    s_waitcnt lgkmcnt(0)
    s_barrier
    s_barrier
    s_cmp_eq_u32 s28, 63
    s_cbranch_scc1 .fin_46
    s_xor_b32 s38, s34, 0x4000
    s_xor_b32 s39, s34, 0x1000
    s_xor_b32 s40, s34, 0x5000
    v_mov_b32 v48, 0
    v_mov_b32 v49, 0
    v_mov_b32 v50, 0
    v_mov_b32 v51, 0
    v_mov_b32 v52, 0
    v_mov_b32 v53, 0
    v_mov_b32 v54, 0
    v_mov_b32 v55, 0
    v_mov_b32 v56, 0
    v_mov_b32 v57, 0
    v_mov_b32 v58, 0
    v_mov_b32 v59, 0
    v_mov_b32 v60, 0
    v_mov_b32 v61, 0
    v_mov_b32 v62, 0
    v_mov_b32 v63, 0
    s_barrier
    s_setprio 3
    buffer_load_dwordx4 v[24:27], v4, s[8:11], s30 offen offset:0 sc1
    s_setprio 2
    buffer_load_dwordx4 v[28:31], v4, s[8:11], s30 offen offset:1024 sc1
    s_setprio 1
    buffer_load_dwordx4 v[32:35], v4, s[8:11], s30 offen offset:2048 sc1
    s_setprio 0
    buffer_load_dwordx4 v[36:39], v4, s[8:11], s30 offen offset:3072 sc1
    s_waitcnt vmcnt(3)
    v_cmp_eq_u32 vcc, -1, v27
    s_cbranch_vccnz .gs_55
.gr_56:
    v_smfmac_f32_16x16x64_bf16 v[64:67], v[24:27], a[192:199], v2
    v_smfmac_f32_16x16x64_bf16 v[68:71], v[24:27], a[224:231], v2
    s_waitcnt vmcnt(2)
    v_cmp_eq_u32 vcc, -1, v31
    s_cbranch_vccnz .gs_57
.gr_58:
    v_smfmac_f32_16x16x64_bf16 v[64:67], v[28:31], a[200:207], v2
    v_smfmac_f32_16x16x64_bf16 v[68:71], v[28:31], a[232:239], v2
    s_waitcnt vmcnt(1)
    v_cmp_eq_u32 vcc, -1, v35
    s_cbranch_vccnz .gs_59
.gr_60:
    v_smfmac_f32_16x16x64_bf16 v[64:67], v[32:35], a[208:215], v2
    v_smfmac_f32_16x16x64_bf16 v[68:71], v[32:35], a[240:247], v2
    s_waitcnt vmcnt(0)
    v_cmp_eq_u32 vcc, -1, v39
    s_cbranch_vccnz .gs_61
.gr_62:
    v_smfmac_f32_16x16x64_bf16 v[64:67], v[36:39], a[216:223], v2
    v_smfmac_f32_16x16x64_bf16 v[68:71], v[36:39], a[248:255], v2
    s_nop 7
    v_permlane32_swap_b32 v64, v68
    v_permlane32_swap_b32 v65, v69
    v_permlane32_swap_b32 v66, v70
    v_permlane32_swap_b32 v67, v71
    v_add_f32 v64, v64, v68
    v_add_f32 v65, v65, v69
    v_add_f32 v66, v66, v70
    v_add_f32 v67, v67, v71
    ds_write2_b32 v7, v64, v65 offset0:0 offset1:36
    ds_write2_b32 v7, v66, v67 offset0:72 offset1:108
    s_waitcnt lgkmcnt(0)
    s_barrier
    ds_read_b128 v[72:75], v12 offset:0
    ds_read_b128 v[76:79], v12 offset:1152
    ds_read_b128 v[80:83], v12 offset:2304
    ds_read_b128 v[84:87], v12 offset:3456
    s_waitcnt lgkmcnt(2)
    v_add_f32 v72, v72, v76
    v_add_f32 v73, v73, v77
    v_add_f32 v74, v74, v78
    v_add_f32 v75, v75, v79
    s_waitcnt lgkmcnt(0)
    v_add_f32 v80, v80, v84
    v_add_f32 v81, v81, v85
    v_add_f32 v82, v82, v86
    v_add_f32 v83, v83, v87
    v_add_f32 v72, v72, v80
    v_add_f32 v73, v73, v81
    v_add_f32 v74, v74, v82
    v_add_f32 v75, v75, v83
    v_min_u32 v75, 0xfffffffe, v75
    buffer_store_dwordx4 v[72:75], v13, s[8:11], s34 offen sc1
    v_mov_b32 v64, 0
    v_mov_b32 v65, 0
    v_mov_b32 v66, 0
    v_mov_b32 v67, 0
    v_mov_b32 v68, 0
    v_mov_b32 v69, 0
    v_mov_b32 v70, 0
    v_mov_b32 v71, 0
    s_waitcnt vmcnt(0)
.pl_63:
    buffer_load_dwordx4 v[76:79], v13, s[8:11], s38 offen sc1
    buffer_load_dwordx4 v[80:83], v13, s[8:11], s39 offen sc1
    buffer_load_dwordx4 v[84:87], v13, s[8:11], s40 offen sc1
    s_waitcnt vmcnt(2)
    v_add_f32 v88, v72, v76
    v_add_f32 v89, v73, v77
    v_add_f32 v90, v74, v78
    v_add_f32 v91, v75, v79
    s_waitcnt vmcnt(0)
    v_max3_u32 v18, v79, v83, v87
    v_cmp_eq_u32 vcc, -1, v18
    v_add_f32 v80, v80, v84
    v_add_f32 v81, v81, v85
    v_add_f32 v82, v82, v86
    v_add_f32 v83, v83, v87
    v_add_f32 v88, v88, v80
    v_add_f32 v89, v89, v81
    v_add_f32 v90, v90, v82
    v_add_f32 v91, v91, v83
    v_cvt_pk_bf16_f32 v92, v88, v89
    v_cvt_pk_bf16_f32 v93, v90, v91
    v_min_u32 v93, 0xfffffffe, v93
    s_cbranch_vccnz .pr_64
    buffer_store_dwordx2 v[92:93], v14, s[8:11], s31 offen
    s_mov_b32 s4, s30
    s_mov_b32 s30, s31
    s_mov_b32 s31, s32
    s_mov_b32 s32, s33
    s_mov_b32 s33, s4
    s_add_u32 s28, s28, 1
    s_mov_b32 s62, 0
    s_mov_b32 s4, s34
    s_mov_b32 s34, s35
    s_mov_b32 s35, s36
    s_mov_b32 s36, s37
    s_mov_b32 s37, s4
    s_branch .step_45
.fin_46:
    s_endpgm
.gs_47:
    buffer_load_dwordx4 v[24:27], v3, s[8:11], s30 offen offset:0 sc1
    buffer_load_dwordx4 v[28:31], v3, s[8:11], s30 offen offset:1024 sc1
    buffer_load_dwordx4 v[32:35], v3, s[8:11], s30 offen offset:2048 sc1
    buffer_load_dwordx4 v[36:39], v3, s[8:11], s30 offen offset:3072 sc1
    s_add_u32 s62, s62, 1
    s_cmp_gt_u32 s62, 0x100000
    s_cbranch_scc1 .mg_end_1
    s_waitcnt vmcnt(3)
    v_max_u32 v18, v25, v27
    v_cmp_eq_u32 vcc, -1, v18
    s_cbranch_vccz .gr_48
    s_branch .gs_47
.gs_49:
    buffer_load_dwordx4 v[28:31], v3, s[8:11], s30 offen offset:1024 sc1
    buffer_load_dwordx4 v[32:35], v3, s[8:11], s30 offen offset:2048 sc1
    buffer_load_dwordx4 v[36:39], v3, s[8:11], s30 offen offset:3072 sc1
    s_add_u32 s62, s62, 1
    s_cmp_gt_u32 s62, 0x100000
    s_cbranch_scc1 .mg_end_1
    s_waitcnt vmcnt(2)
    v_max_u32 v18, v29, v31
    v_cmp_eq_u32 vcc, -1, v18
    s_cbranch_vccz .gr_50
    s_branch .gs_49
.gs_51:
    buffer_load_dwordx4 v[32:35], v3, s[8:11], s30 offen offset:2048 sc1
    buffer_load_dwordx4 v[36:39], v3, s[8:11], s30 offen offset:3072 sc1
    s_add_u32 s62, s62, 1
    s_cmp_gt_u32 s62, 0x100000
    s_cbranch_scc1 .mg_end_1
    s_waitcnt vmcnt(1)
    v_max_u32 v18, v33, v35
    v_cmp_eq_u32 vcc, -1, v18
    s_cbranch_vccz .gr_52
    s_branch .gs_51
.gs_53:
    buffer_load_dwordx4 v[36:39], v3, s[8:11], s30 offen offset:3072 sc1
    s_add_u32 s62, s62, 1
    s_cmp_gt_u32 s62, 0x100000
    s_cbranch_scc1 .mg_end_1
    s_waitcnt vmcnt(0)
    v_max_u32 v18, v37, v39
    v_cmp_eq_u32 vcc, -1, v18
    s_cbranch_vccz .gr_54
    s_branch .gs_53
.gs_55:
    buffer_load_dwordx4 v[24:27], v4, s[8:11], s30 offen offset:0 sc1
    buffer_load_dwordx4 v[28:31], v4, s[8:11], s30 offen offset:1024 sc1
    buffer_load_dwordx4 v[32:35], v4, s[8:11], s30 offen offset:2048 sc1
    buffer_load_dwordx4 v[36:39], v4, s[8:11], s30 offen offset:3072 sc1
    s_add_u32 s62, s62, 1
    s_cmp_gt_u32 s62, 0x100000
    s_cbranch_scc1 .mg_end_1
    s_waitcnt vmcnt(3)
    v_cmp_eq_u32 vcc, -1, v27
    s_cbranch_vccz .gr_56
    s_branch .gs_55
.gs_57:
    buffer_load_dwordx4 v[28:31], v4, s[8:11], s30 offen offset:1024 sc1
    buffer_load_dwordx4 v[32:35], v4, s[8:11], s30 offen offset:2048 sc1
    buffer_load_dwordx4 v[36:39], v4, s[8:11], s30 offen offset:3072 sc1
    s_add_u32 s62, s62, 1
    s_cmp_gt_u32 s62, 0x100000
    s_cbranch_scc1 .mg_end_1
    s_waitcnt vmcnt(2)
    v_cmp_eq_u32 vcc, -1, v31
    s_cbranch_vccz .gr_58
    s_branch .gs_57
.gs_59:
    buffer_load_dwordx4 v[32:35], v4, s[8:11], s30 offen offset:2048 sc1
    buffer_load_dwordx4 v[36:39], v4, s[8:11], s30 offen offset:3072 sc1
    s_add_u32 s62, s62, 1
    s_cmp_gt_u32 s62, 0x100000
    s_cbranch_scc1 .mg_end_1
    s_waitcnt vmcnt(1)
    v_cmp_eq_u32 vcc, -1, v35
    s_cbranch_vccz .gr_60
    s_branch .gs_59
.gs_61:
    buffer_load_dwordx4 v[36:39], v4, s[8:11], s30 offen offset:3072 sc1
    s_add_u32 s62, s62, 1
    s_cmp_gt_u32 s62, 0x100000
    s_cbranch_scc1 .mg_end_1
    s_waitcnt vmcnt(0)
    v_cmp_eq_u32 vcc, -1, v39
    s_cbranch_vccz .gr_62
    s_branch .gs_61
.pr_64:
    s_add_u32 s62, s62, 1
    s_cmp_gt_u32 s62, 0x100000
    s_cbranch_scc1 .mg_end_1
    s_branch .pl_63
.w2_21:
    s_lshl_b32 s4, s56, 7
    s_lshl_b32 s5, s53, 2
    s_add_u32 s4, s4, s5
    s_add_u32 s4, s4, 92274688
    v_mov_b32 v14, s4
    v_bfe_u32 v254, v1, 0, 6
    v_mul_u32_u24 v12, 16, v254
    v_add_u32 v12, 17920, v12
    s_mov_b32 exec_hi, 0
    v_xor_b32 v244, 1024, v244
    s_mov_b32 exec_hi, -1
    s_waitcnt vmcnt(0)
    ds_read_b64_tr_b16 a[192:193], v242 offset:16384
    ds_read_b64_tr_b16 a[194:195], v242 offset:16896
    ds_read_b64_tr_b16 a[196:197], v242 offset:18432
    ds_read_b64_tr_b16 a[198:199], v242 offset:18944
    ds_read_b64_tr_b16 a[200:201], v242 offset:20480
    ds_read_b64_tr_b16 a[202:203], v242 offset:20992
    ds_read_b64_tr_b16 a[204:205], v242 offset:22528
    ds_read_b64_tr_b16 a[206:207], v242 offset:23040
    ds_read_b64_tr_b16 a[208:209], v242 offset:24576
    ds_read_b64_tr_b16 a[210:211], v242 offset:25088
    ds_read_b64_tr_b16 a[212:213], v242 offset:26624
    ds_read_b64_tr_b16 a[214:215], v242 offset:27136
    ds_read_b64_tr_b16 a[216:217], v242 offset:28672
    ds_read_b64_tr_b16 a[218:219], v242 offset:29184
    ds_read_b64_tr_b16 a[220:221], v242 offset:30720
    ds_read_b64_tr_b16 a[222:223], v242 offset:31232
    ds_read_b64_tr_b16 a[224:225], v243 offset:16384
    ds_read_b64_tr_b16 a[226:227], v243 offset:16896
    ds_read_b64_tr_b16 a[228:229], v243 offset:18432
    ds_read_b64_tr_b16 a[230:231], v243 offset:18944
    ds_read_b64_tr_b16 a[232:233], v243 offset:20480
    ds_read_b64_tr_b16 a[234:235], v243 offset:20992
    ds_read_b64_tr_b16 a[236:237], v243 offset:22528
    ds_read_b64_tr_b16 a[238:239], v243 offset:23040
    ds_read_b64_tr_b16 a[240:241], v243 offset:24576
    ds_read_b64_tr_b16 a[242:243], v243 offset:25088
    ds_read_b64_tr_b16 a[244:245], v243 offset:26624
    ds_read_b64_tr_b16 a[246:247], v243 offset:27136
    ds_read_b64_tr_b16 a[248:249], v243 offset:28672
    ds_read_b64_tr_b16 a[250:251], v243 offset:29184
    ds_read_b64_tr_b16 a[252:253], v243 offset:30720
    ds_read_b64_tr_b16 a[254:255], v243 offset:31232
    s_waitcnt lgkmcnt(0)
    s_barrier
.p2align 6
.step_65:
    s_barrier
    s_setprio 3
    buffer_load_dwordx4 v[24:27], v3, s[8:11], s30 offen offset:0 sc1
    s_setprio 2
    buffer_load_dwordx4 v[28:31], v3, s[8:11], s30 offen offset:1024 sc1
    s_setprio 1
    buffer_load_dwordx4 v[32:35], v3, s[8:11], s30 offen offset:2048 sc1
    s_setprio 0
    buffer_load_dwordx4 v[36:39], v3, s[8:11], s30 offen offset:3072 sc1
    s_waitcnt vmcnt(3)
    v_max_u32 v18, v25, v27
    v_cmp_eq_u32 vcc, -1, v18
    s_cbranch_vccnz .gs_67
.gr_68:
    v_smfmac_f32_16x16x64_bf16 v[40:43], v[24:27], a[0:7], v2
    v_smfmac_f32_16x16x64_bf16 v[44:47], v[24:27], a[32:39], v2
    s_waitcnt vmcnt(2)
    v_max_u32 v18, v29, v31
    v_cmp_eq_u32 vcc, -1, v18
    v_smfmac_f32_16x16x64_bf16 v[48:51], v[24:27], a[64:71], v2
    s_cbranch_vccnz .gs_69
.gr_70:
    v_smfmac_f32_16x16x64_bf16 v[40:43], v[28:31], a[8:15], v2
    v_smfmac_f32_16x16x64_bf16 v[44:47], v[28:31], a[40:47], v2
    v_smfmac_f32_16x16x64_bf16 v[52:55], v[24:27], a[96:103], v2
    s_waitcnt vmcnt(1)
    v_max_u32 v18, v33, v35
    v_cmp_eq_u32 vcc, -1, v18
    v_smfmac_f32_16x16x64_bf16 v[48:51], v[28:31], a[72:79], v2
    s_cbranch_vccnz .gs_71
.gr_72:
    v_smfmac_f32_16x16x64_bf16 v[40:43], v[32:35], a[16:23], v2
    v_smfmac_f32_16x16x64_bf16 v[44:47], v[32:35], a[48:55], v2
    v_smfmac_f32_16x16x64_bf16 v[52:55], v[28:31], a[104:111], v2
    s_waitcnt vmcnt(0)
    v_max_u32 v18, v37, v39
    v_cmp_eq_u32 vcc, -1, v18
    v_smfmac_f32_16x16x64_bf16 v[48:51], v[32:35], a[80:87], v2
    s_cbranch_vccnz .gs_73
.gr_74:
    v_smfmac_f32_16x16x64_bf16 v[40:43], v[36:39], a[24:31], v2
    v_smfmac_f32_16x16x64_bf16 v[44:47], v[36:39], a[56:63], v2
    v_smfmac_f32_16x16x64_bf16 v[52:55], v[32:35], a[112:119], v2
    v_smfmac_f32_16x16x64_bf16 v[48:51], v[36:39], a[88:95], v2
    v_permlane32_swap_b32 v40, v44
    v_permlane32_swap_b32 v41, v45
    v_smfmac_f32_16x16x64_bf16 v[52:55], v[36:39], a[120:127], v2
    v_permlane32_swap_b32 v42, v46
    v_permlane32_swap_b32 v43, v47
    v_add_f32 v40, v40, v44
    v_add_f32 v41, v41, v45
    v_add_f32 v42, v42, v46
    v_add_f32 v43, v43, v47
    ds_write2_b32 v5, v40, v41 offset0:0 offset1:36
    ds_write2_b32 v5, v42, v43 offset0:72 offset1:108
    v_permlane32_swap_b32 v48, v52
    v_permlane32_swap_b32 v49, v53
    v_permlane32_swap_b32 v50, v54
    v_permlane32_swap_b32 v51, v55
    v_add_f32 v48, v48, v52
    v_add_f32 v49, v49, v53
    v_add_f32 v50, v50, v54
    v_add_f32 v51, v51, v55
    ds_write2_b32 v6, v48, v49 offset0:0 offset1:36
    ds_write2_b32 v6, v50, v51 offset0:72 offset1:108
    s_waitcnt lgkmcnt(2)
    s_barrier
    s_waitcnt lgkmcnt(0)
    s_barrier
    ds_read_b64 v[72:73], v9 offset:0
    ds_read_b64 v[74:75], v9 offset:1152
    ds_read_b64 v[76:77], v9 offset:2304
    ds_read_b64 v[78:79], v9 offset:3456
    s_waitcnt lgkmcnt(2)
    v_add_f32 v72, v72, v74
    v_add_f32 v73, v73, v75
    s_waitcnt lgkmcnt(0)
    v_add_f32 v76, v76, v78
    v_add_f32 v77, v77, v79
    v_add_f32 v72, v72, v76
    v_add_f32 v73, v73, v77
    v_cvt_pk_bf16_f32 v72, v72, v73
    v_min_u32 v72, 0xfffffffe, v72
    buffer_store_dword v72, v10, s[8:11], s30 offen
    v_smfmac_f32_16x16x64_bf16 v[56:59], v[24:27], a[128:135], v2
    v_smfmac_f32_16x16x64_bf16 v[60:63], v[24:27], a[160:167], v2
    v_smfmac_f32_16x16x64_bf16 v[56:59], v[28:31], a[136:143], v2
    v_smfmac_f32_16x16x64_bf16 v[60:63], v[28:31], a[168:175], v2
    v_smfmac_f32_16x16x64_bf16 v[56:59], v[32:35], a[144:151], v2
    v_smfmac_f32_16x16x64_bf16 v[60:63], v[32:35], a[176:183], v2
    v_smfmac_f32_16x16x64_bf16 v[56:59], v[36:39], a[152:159], v2
    v_smfmac_f32_16x16x64_bf16 v[60:63], v[36:39], a[184:191], v2
    ds_write_b32 v11, v72
    v_mov_b32 v40, 0
    v_mov_b32 v41, 0
    v_mov_b32 v42, 0
    v_mov_b32 v43, 0
    v_mov_b32 v44, 0
    v_mov_b32 v45, 0
    v_mov_b32 v46, 0
    v_mov_b32 v47, 0
    v_permlane32_swap_b32 v56, v60
    v_permlane32_swap_b32 v57, v61
    v_permlane32_swap_b32 v58, v62
    v_permlane32_swap_b32 v59, v63
    v_add_f32 v56, v56, v60
    v_add_f32 v57, v57, v61
    v_add_f32 v58, v58, v62
    v_add_f32 v59, v59, v63
    ds_write_b128 v8, v[56:59]
    s_waitcnt lgkmcnt(0)
    s_barrier
    s_barrier
    ds_read_b128 v[72:75], v12
    s_cmp_eq_u32 s28, 63
    s_cbranch_scc1 .fin_66
    s_waitcnt lgkmcnt(0)
    buffer_store_dwordx4 v[72:75], v244, s[8:11], s41 offen sc1
    v_mov_b32 v48, 0
    v_mov_b32 v49, 0
    v_mov_b32 v50, 0
    v_mov_b32 v51, 0
    v_mov_b32 v52, 0
    v_mov_b32 v53, 0
    v_mov_b32 v54, 0
    v_mov_b32 v55, 0
    v_mov_b32 v56, 0
    v_mov_b32 v57, 0
    v_mov_b32 v58, 0
    v_mov_b32 v59, 0
    v_mov_b32 v60, 0
    v_mov_b32 v61, 0
    v_mov_b32 v62, 0
    v_mov_b32 v63, 0
    s_barrier
    s_setprio 3
    buffer_load_dwordx4 v[24:27], v4, s[8:11], s30 offen offset:0 sc1
    s_setprio 2
    buffer_load_dwordx4 v[28:31], v4, s[8:11], s30 offen offset:1024 sc1
    s_setprio 1
    buffer_load_dwordx4 v[32:35], v4, s[8:11], s30 offen offset:2048 sc1
    s_setprio 0
    buffer_load_dwordx4 v[36:39], v4, s[8:11], s30 offen offset:3072 sc1
    s_waitcnt vmcnt(3)
    v_cmp_eq_u32 vcc, -1, v27
    s_cbranch_vccnz .gs_75
.gr_76:
    v_smfmac_f32_16x16x64_bf16 v[64:67], v[24:27], a[192:199], v2
    v_smfmac_f32_16x16x64_bf16 v[68:71], v[24:27], a[224:231], v2
    s_waitcnt vmcnt(2)
    v_cmp_eq_u32 vcc, -1, v31
    s_cbranch_vccnz .gs_77
.gr_78:
    v_smfmac_f32_16x16x64_bf16 v[64:67], v[28:31], a[200:207], v2
    v_smfmac_f32_16x16x64_bf16 v[68:71], v[28:31], a[232:239], v2
    s_waitcnt vmcnt(1)
    v_cmp_eq_u32 vcc, -1, v35
    s_cbranch_vccnz .gs_79
.gr_80:
    v_smfmac_f32_16x16x64_bf16 v[64:67], v[32:35], a[208:215], v2
    v_smfmac_f32_16x16x64_bf16 v[68:71], v[32:35], a[240:247], v2
    s_waitcnt vmcnt(0)
    v_cmp_eq_u32 vcc, -1, v39
    s_cbranch_vccnz .gs_81
.gr_82:
    v_smfmac_f32_16x16x64_bf16 v[64:67], v[36:39], a[216:223], v2
    v_smfmac_f32_16x16x64_bf16 v[68:71], v[36:39], a[248:255], v2
    s_nop 7
    v_permlane32_swap_b32 v64, v68
    v_permlane32_swap_b32 v65, v69
    v_permlane32_swap_b32 v66, v70
    v_permlane32_swap_b32 v67, v71
    v_add_f32 v64, v64, v68
    v_add_f32 v65, v65, v69
    v_add_f32 v66, v66, v70
    v_add_f32 v67, v67, v71
    ds_write2_b32 v7, v64, v65 offset0:0 offset1:36
    ds_write2_b32 v7, v66, v67 offset0:72 offset1:108
    s_waitcnt lgkmcnt(0)
    s_barrier
    v_mov_b32 v18, s28
    v_add_u32 v18, 1, v18
    s_mov_b64 exec, 1
    buffer_store_dword v18, v14, s[8:11], 0 offen sc1
    s_mov_b64 exec, -1
    v_mov_b32 v64, 0
    v_mov_b32 v65, 0
    v_mov_b32 v66, 0
    v_mov_b32 v67, 0
    v_mov_b32 v68, 0
    v_mov_b32 v69, 0
    v_mov_b32 v70, 0
    v_mov_b32 v71, 0
    s_mov_b32 s4, s30
    s_mov_b32 s30, s31
    s_mov_b32 s31, s32
    s_mov_b32 s32, s33
    s_mov_b32 s33, s4
    s_add_u32 s28, s28, 1
    s_mov_b32 s62, 0
    s_add_u32 s41, s41, 0x20000
    s_branch .step_65
.fin_66:
    s_waitcnt lgkmcnt(0)
    buffer_store_dwordx4 v[72:75], v244, s[8:11], s41 offen sc1
    s_waitcnt vmcnt(0)
    v_mov_b32 v18, 64
    s_mov_b64 exec, 1
    buffer_store_dword v18, v14, s[8:11], 0 offen sc1
    s_mov_b64 exec, -1
    s_endpgm
.gs_67:
    buffer_load_dwordx4 v[24:27], v3, s[8:11], s30 offen offset:0 sc1
    buffer_load_dwordx4 v[28:31], v3, s[8:11], s30 offen offset:1024 sc1
    buffer_load_dwordx4 v[32:35], v3, s[8:11], s30 offen offset:2048 sc1
    buffer_load_dwordx4 v[36:39], v3, s[8:11], s30 offen offset:3072 sc1
    s_add_u32 s62, s62, 1
    s_cmp_gt_u32 s62, 0x100000
    s_cbranch_scc1 .mg_end_1
    s_waitcnt vmcnt(3)
    v_max_u32 v18, v25, v27
    v_cmp_eq_u32 vcc, -1, v18
    s_cbranch_vccz .gr_68
    s_branch .gs_67
.gs_69:
    buffer_load_dwordx4 v[28:31], v3, s[8:11], s30 offen offset:1024 sc1
    buffer_load_dwordx4 v[32:35], v3, s[8:11], s30 offen offset:2048 sc1
    buffer_load_dwordx4 v[36:39], v3, s[8:11], s30 offen offset:3072 sc1
    s_add_u32 s62, s62, 1
    s_cmp_gt_u32 s62, 0x100000
    s_cbranch_scc1 .mg_end_1
    s_waitcnt vmcnt(2)
    v_max_u32 v18, v29, v31
    v_cmp_eq_u32 vcc, -1, v18
    s_cbranch_vccz .gr_70
    s_branch .gs_69
.gs_71:
    buffer_load_dwordx4 v[32:35], v3, s[8:11], s30 offen offset:2048 sc1
    buffer_load_dwordx4 v[36:39], v3, s[8:11], s30 offen offset:3072 sc1
    s_add_u32 s62, s62, 1
    s_cmp_gt_u32 s62, 0x100000
    s_cbranch_scc1 .mg_end_1
    s_waitcnt vmcnt(1)
    v_max_u32 v18, v33, v35
    v_cmp_eq_u32 vcc, -1, v18
    s_cbranch_vccz .gr_72
    s_branch .gs_71
.gs_73:
    buffer_load_dwordx4 v[36:39], v3, s[8:11], s30 offen offset:3072 sc1
    s_add_u32 s62, s62, 1
    s_cmp_gt_u32 s62, 0x100000
    s_cbranch_scc1 .mg_end_1
    s_waitcnt vmcnt(0)
    v_max_u32 v18, v37, v39
    v_cmp_eq_u32 vcc, -1, v18
    s_cbranch_vccz .gr_74
    s_branch .gs_73
.gs_75:
    buffer_load_dwordx4 v[24:27], v4, s[8:11], s30 offen offset:0 sc1
    buffer_load_dwordx4 v[28:31], v4, s[8:11], s30 offen offset:1024 sc1
    buffer_load_dwordx4 v[32:35], v4, s[8:11], s30 offen offset:2048 sc1
    buffer_load_dwordx4 v[36:39], v4, s[8:11], s30 offen offset:3072 sc1
    s_add_u32 s62, s62, 1
    s_cmp_gt_u32 s62, 0x100000
    s_cbranch_scc1 .mg_end_1
    s_waitcnt vmcnt(3)
    v_cmp_eq_u32 vcc, -1, v27
    s_cbranch_vccz .gr_76
    s_branch .gs_75
.gs_77:
    buffer_load_dwordx4 v[28:31], v4, s[8:11], s30 offen offset:1024 sc1
    buffer_load_dwordx4 v[32:35], v4, s[8:11], s30 offen offset:2048 sc1
    buffer_load_dwordx4 v[36:39], v4, s[8:11], s30 offen offset:3072 sc1
    s_add_u32 s62, s62, 1
    s_cmp_gt_u32 s62, 0x100000
    s_cbranch_scc1 .mg_end_1
    s_waitcnt vmcnt(2)
    v_cmp_eq_u32 vcc, -1, v31
    s_cbranch_vccz .gr_78
    s_branch .gs_77
.gs_79:
    buffer_load_dwordx4 v[32:35], v4, s[8:11], s30 offen offset:2048 sc1
    buffer_load_dwordx4 v[36:39], v4, s[8:11], s30 offen offset:3072 sc1
    s_add_u32 s62, s62, 1
    s_cmp_gt_u32 s62, 0x100000
    s_cbranch_scc1 .mg_end_1
    s_waitcnt vmcnt(1)
    v_cmp_eq_u32 vcc, -1, v35
    s_cbranch_vccz .gr_80
    s_branch .gs_79
.gs_81:
    buffer_load_dwordx4 v[36:39], v4, s[8:11], s30 offen offset:3072 sc1
    s_add_u32 s62, s62, 1
    s_cmp_gt_u32 s62, 0x100000
    s_cbranch_scc1 .mg_end_1
    s_waitcnt vmcnt(0)
    v_cmp_eq_u32 vcc, -1, v39
    s_cbranch_vccz .gr_82
    s_branch .gs_81
.w3_22:
    v_bfe_u32 v254, v1, 3, 1
    v_mul_u32_u24 v12, 512, v254
    v_bfe_u32 v254, v1, 5, 1
    v_mul_u32_u24 v254, 256, v254
    v_add_u32 v12, v12, v254
    v_bfe_u32 v254, v1, 2, 1
    v_mul_u32_u24 v254, 128, v254
    v_add_u32 v12, v12, v254
    v_bfe_u32 v254, v1, 0, 2
    v_mul_u32_u24 v254, 16, v254
    v_add_u32 v12, v12, v254
    v_bfe_u32 v254, v1, 4, 1
    v_mul_u32_u24 v254, 8, v254
    v_add_u32 v12, v12, v254
    v_add_u32 v12, 13824, v12
    v_bfe_u32 v254, v1, 2, 2
    v_mul_u32_u24 v14, 128, v254
    v_bfe_u32 v254, v1, 0, 2
    v_mul_u32_u24 v254, 16, v254
    v_add_u32 v14, v14, v254
    v_bfe_u32 v254, v1, 4, 2
    v_mul_u32_u24 v254, 4, v254
    v_add_u32 v14, v14, v254
    v_add_u32 v14, 18432, v14
    v_bfe_u32 v254, v1, 0, 6
    v_mul_u32_u24 v15, 16, v254
    v_add_u32 v15, s101, v15
    s_lshl_b32 s4, s56, 7
    s_add_u32 s4, s4, 92278784
    v_bfe_u32 v254, v1, 0, 2
    v_mul_u32_u24 v13, 4, v254
    v_bfe_u32 v254, v1, 2, 1
    v_mul_u32_u24 v254, 4096, v254
    v_add_u32 v13, v13, v254
    v_add_u32 v13, s4, v13
    s_waitcnt vmcnt(0)
    ds_read_b64_tr_b16 a[192:193], v242 offset:16384
    ds_read_b64_tr_b16 a[194:195], v242 offset:16896
    ds_read_b64_tr_b16 a[196:197], v242 offset:18432
    ds_read_b64_tr_b16 a[198:199], v242 offset:18944
    ds_read_b64_tr_b16 a[200:201], v242 offset:20480
    ds_read_b64_tr_b16 a[202:203], v242 offset:20992
    ds_read_b64_tr_b16 a[204:205], v242 offset:22528
    ds_read_b64_tr_b16 a[206:207], v242 offset:23040
    ds_read_b64_tr_b16 a[208:209], v242 offset:24576
    ds_read_b64_tr_b16 a[210:211], v242 offset:25088
    ds_read_b64_tr_b16 a[212:213], v242 offset:26624
    ds_read_b64_tr_b16 a[214:215], v242 offset:27136
    ds_read_b64_tr_b16 a[216:217], v242 offset:28672
    ds_read_b64_tr_b16 a[218:219], v242 offset:29184
    ds_read_b64_tr_b16 a[220:221], v242 offset:30720
    ds_read_b64_tr_b16 a[222:223], v242 offset:31232
    ds_read_b64_tr_b16 a[224:225], v243 offset:16384
    ds_read_b64_tr_b16 a[226:227], v243 offset:16896
    ds_read_b64_tr_b16 a[228:229], v243 offset:18432
    ds_read_b64_tr_b16 a[230:231], v243 offset:18944
    ds_read_b64_tr_b16 a[232:233], v243 offset:20480
    ds_read_b64_tr_b16 a[234:235], v243 offset:20992
    ds_read_b64_tr_b16 a[236:237], v243 offset:22528
    ds_read_b64_tr_b16 a[238:239], v243 offset:23040
    ds_read_b64_tr_b16 a[240:241], v243 offset:24576
    ds_read_b64_tr_b16 a[242:243], v243 offset:25088
    ds_read_b64_tr_b16 a[244:245], v243 offset:26624
    ds_read_b64_tr_b16 a[246:247], v243 offset:27136
    ds_read_b64_tr_b16 a[248:249], v243 offset:28672
    ds_read_b64_tr_b16 a[250:251], v243 offset:29184
    ds_read_b64_tr_b16 a[252:253], v243 offset:30720
    ds_read_b64_tr_b16 a[254:255], v243 offset:31232
    s_waitcnt lgkmcnt(0)
    s_cmp_ge_u32 s46, 1
    s_cbranch_scc1 .kvd_84
    s_mov_b32 s62, 0
.kv_83:
    buffer_load_dword v18, v13, s[8:11], 0 offen sc1
    s_add_u32 s62, s62, 1
    s_cmp_gt_u32 s62, 0x100000
    s_cbranch_scc1 .mg_end_1
    s_waitcnt vmcnt(0)
    v_min_u32_dpp v18, v18, v18 quad_perm:[1,0,3,2] row_mask:0xf bank_mask:0xf
    s_nop 1
    v_min_u32_dpp v18, v18, v18 quad_perm:[2,3,0,1] row_mask:0xf bank_mask:0xf
    s_nop 1
    v_min_u32_dpp v18, v18, v18 row_half_mirror row_mask:0xf bank_mask:0xf
    s_nop 0
    v_readfirstlane_b32 s46, v18
    s_cmp_lt_u32 s46, 1
    s_cbranch_scc1 .kv_83
.kvd_84:
    s_barrier
.p2align 6
.step_85:
    s_barrier
    s_setprio 3
    buffer_load_dwordx4 v[24:27], v3, s[8:11], s30 offen offset:0 sc1
    s_setprio 2
    buffer_load_dwordx4 v[28:31], v3, s[8:11], s30 offen offset:1024 sc1
    s_setprio 1
    buffer_load_dwordx4 v[32:35], v3, s[8:11], s30 offen offset:2048 sc1
    s_setprio 0
    buffer_load_dwordx4 v[36:39], v3, s[8:11], s30 offen offset:3072 sc1
    s_waitcnt vmcnt(3)
    v_max_u32 v18, v25, v27
    v_cmp_eq_u32 vcc, -1, v18
    s_cbranch_vccnz .gs_87
.gr_88:
    v_smfmac_f32_16x16x64_bf16 v[40:43], v[24:27], a[0:7], v2
    v_smfmac_f32_16x16x64_bf16 v[44:47], v[24:27], a[32:39], v2
    s_waitcnt vmcnt(2)
    v_max_u32 v18, v29, v31
    v_cmp_eq_u32 vcc, -1, v18
    v_smfmac_f32_16x16x64_bf16 v[48:51], v[24:27], a[64:71], v2
    s_cbranch_vccnz .gs_89
.gr_90:
    v_smfmac_f32_16x16x64_bf16 v[40:43], v[28:31], a[8:15], v2
    v_smfmac_f32_16x16x64_bf16 v[44:47], v[28:31], a[40:47], v2
    v_smfmac_f32_16x16x64_bf16 v[52:55], v[24:27], a[96:103], v2
    s_waitcnt vmcnt(1)
    v_max_u32 v18, v33, v35
    v_cmp_eq_u32 vcc, -1, v18
    v_smfmac_f32_16x16x64_bf16 v[48:51], v[28:31], a[72:79], v2
    s_cbranch_vccnz .gs_91
.gr_92:
    v_smfmac_f32_16x16x64_bf16 v[40:43], v[32:35], a[16:23], v2
    v_smfmac_f32_16x16x64_bf16 v[44:47], v[32:35], a[48:55], v2
    v_smfmac_f32_16x16x64_bf16 v[52:55], v[28:31], a[104:111], v2
    s_waitcnt vmcnt(0)
    v_max_u32 v18, v37, v39
    v_cmp_eq_u32 vcc, -1, v18
    v_smfmac_f32_16x16x64_bf16 v[48:51], v[32:35], a[80:87], v2
    s_cbranch_vccnz .gs_93
.gr_94:
    v_smfmac_f32_16x16x64_bf16 v[40:43], v[36:39], a[24:31], v2
    v_smfmac_f32_16x16x64_bf16 v[44:47], v[36:39], a[56:63], v2
    v_smfmac_f32_16x16x64_bf16 v[52:55], v[32:35], a[112:119], v2
    v_smfmac_f32_16x16x64_bf16 v[48:51], v[36:39], a[88:95], v2
    v_permlane32_swap_b32 v40, v44
    v_permlane32_swap_b32 v41, v45
    v_smfmac_f32_16x16x64_bf16 v[52:55], v[36:39], a[120:127], v2
    v_permlane32_swap_b32 v42, v46
    v_permlane32_swap_b32 v43, v47
    v_add_f32 v40, v40, v44
    v_add_f32 v41, v41, v45
    v_add_f32 v42, v42, v46
    v_add_f32 v43, v43, v47
    ds_write2_b32 v5, v40, v41 offset0:0 offset1:36
    ds_write2_b32 v5, v42, v43 offset0:72 offset1:108
    v_permlane32_swap_b32 v48, v52
    v_permlane32_swap_b32 v49, v53
    v_permlane32_swap_b32 v50, v54
    v_permlane32_swap_b32 v51, v55
    v_add_f32 v48, v48, v52
    v_add_f32 v49, v49, v53
    v_add_f32 v50, v50, v54
    v_add_f32 v51, v51, v55
    ds_write2_b32 v6, v48, v49 offset0:0 offset1:36
    ds_write2_b32 v6, v50, v51 offset0:72 offset1:108
    s_waitcnt lgkmcnt(2)
    s_barrier
    s_waitcnt lgkmcnt(0)
    s_barrier
    ds_read_b64 v[72:73], v9 offset:0
    ds_read_b64 v[74:75], v9 offset:1152
    ds_read_b64 v[76:77], v9 offset:2304
    ds_read_b64 v[78:79], v9 offset:3456
    s_waitcnt lgkmcnt(2)
    v_add_f32 v72, v72, v74
    v_add_f32 v73, v73, v75
    s_waitcnt lgkmcnt(0)
    v_add_f32 v76, v76, v78
    v_add_f32 v77, v77, v79
    v_add_f32 v72, v72, v76
    v_add_f32 v73, v73, v77
    v_cvt_pk_bf16_f32 v72, v72, v73
    v_min_u32 v72, 0xfffffffe, v72
    buffer_store_dword v72, v10, s[8:11], s30 offen
    v_smfmac_f32_16x16x64_bf16 v[56:59], v[24:27], a[128:135], v2
    v_smfmac_f32_16x16x64_bf16 v[60:63], v[24:27], a[160:167], v2
    v_smfmac_f32_16x16x64_bf16 v[56:59], v[28:31], a[136:143], v2
    v_smfmac_f32_16x16x64_bf16 v[60:63], v[28:31], a[168:175], v2
    v_smfmac_f32_16x16x64_bf16 v[56:59], v[32:35], a[144:151], v2
    v_smfmac_f32_16x16x64_bf16 v[60:63], v[32:35], a[176:183], v2
    v_smfmac_f32_16x16x64_bf16 v[56:59], v[36:39], a[152:159], v2
    v_smfmac_f32_16x16x64_bf16 v[60:63], v[36:39], a[184:191], v2
    ds_write_b32 v11, v72
    v_mov_b32 v40, 0
    v_mov_b32 v41, 0
    v_mov_b32 v42, 0
    v_mov_b32 v43, 0
    v_mov_b32 v44, 0
    v_mov_b32 v45, 0
    v_mov_b32 v46, 0
    v_mov_b32 v47, 0
    v_permlane32_swap_b32 v56, v60
    v_permlane32_swap_b32 v57, v61
    v_permlane32_swap_b32 v58, v62
    v_permlane32_swap_b32 v59, v63
    v_add_f32 v56, v56, v60
    v_add_f32 v57, v57, v61
    v_add_f32 v58, v58, v62
    v_add_f32 v59, v59, v63
    ds_write_b128 v8, v[56:59]
    s_waitcnt lgkmcnt(0)
    s_barrier
    ds_read_b64 v[72:73], v12 offset:0
    ds_read_b64 v[74:75], v12 offset:1024
    ds_read_b64 v[76:77], v12 offset:2048
    ds_read_b64 v[78:79], v12 offset:3072
    ds_read_b64 v[80:81], v12 offset:64
    ds_read_b64 v[82:83], v12 offset:1088
    ds_read_b64 v[84:85], v12 offset:2112
    ds_read_b64 v[86:87], v12 offset:3136
    s_waitcnt lgkmcnt(4)
    v_add_f32 v72, v72, v74
    v_add_f32 v73, v73, v75
    v_add_f32 v76, v76, v78
    v_add_f32 v77, v77, v79
    v_add_f32 v72, v72, v76
    v_add_f32 v73, v73, v77
    v_cvt_pk_bf16_f32 v72, v72, v73
    s_waitcnt lgkmcnt(0)
    v_add_f32 v80, v80, v82
    v_add_f32 v81, v81, v83
    v_add_f32 v84, v84, v86
    v_add_f32 v85, v85, v87
    v_add_f32 v80, v80, v84
    v_add_f32 v81, v81, v85
    v_cvt_pk_bf16_f32 v80, v80, v81
    ds_write_b32 v14, v72
    ds_write_b32 v14, v80 offset:64
    s_waitcnt lgkmcnt(0)
    s_barrier
    s_cmp_eq_u32 s28, 63
    s_cbranch_scc1 .fin_86
    s_add_u32 s5, s28, 2
    s_cmp_ge_u32 s46, s5
    s_cbranch_scc1 .kvd_96
    s_mov_b32 s62, 0
.kv_95:
    buffer_load_dword v18, v13, s[8:11], 0 offen sc1
    s_add_u32 s62, s62, 1
    s_cmp_gt_u32 s62, 0x100000
    s_cbranch_scc1 .mg_end_1
    s_waitcnt vmcnt(0)
    v_min_u32_dpp v18, v18, v18 quad_perm:[1,0,3,2] row_mask:0xf bank_mask:0xf
    s_nop 1
    v_min_u32_dpp v18, v18, v18 quad_perm:[2,3,0,1] row_mask:0xf bank_mask:0xf
    s_nop 1
    v_min_u32_dpp v18, v18, v18 row_half_mirror row_mask:0xf bank_mask:0xf
    s_nop 0
    v_readfirstlane_b32 s46, v18
    s_cmp_lt_u32 s46, s5
    s_cbranch_scc1 .kv_95
.kvd_96:
    v_mov_b32 v48, 0
    v_mov_b32 v49, 0
    v_mov_b32 v50, 0
    v_mov_b32 v51, 0
    v_mov_b32 v52, 0
    v_mov_b32 v53, 0
    v_mov_b32 v54, 0
    v_mov_b32 v55, 0
    v_mov_b32 v56, 0
    v_mov_b32 v57, 0
    v_mov_b32 v58, 0
    v_mov_b32 v59, 0
    v_mov_b32 v60, 0
    v_mov_b32 v61, 0
    v_mov_b32 v62, 0
    v_mov_b32 v63, 0
    s_barrier
    s_setprio 3
    buffer_load_dwordx4 v[24:27], v4, s[8:11], s30 offen offset:0 sc1
    s_setprio 2
    buffer_load_dwordx4 v[28:31], v4, s[8:11], s30 offen offset:1024 sc1
    s_setprio 1
    buffer_load_dwordx4 v[32:35], v4, s[8:11], s30 offen offset:2048 sc1
    s_setprio 0
    buffer_load_dwordx4 v[36:39], v4, s[8:11], s30 offen offset:3072 sc1
    s_waitcnt vmcnt(3)
    v_cmp_eq_u32 vcc, -1, v27
    s_cbranch_vccnz .gs_97
.gr_98:
    v_smfmac_f32_16x16x64_bf16 v[64:67], v[24:27], a[192:199], v2
    v_smfmac_f32_16x16x64_bf16 v[68:71], v[24:27], a[224:231], v2
    s_waitcnt vmcnt(2)
    v_cmp_eq_u32 vcc, -1, v31
    s_cbranch_vccnz .gs_99
.gr_100:
    v_smfmac_f32_16x16x64_bf16 v[64:67], v[28:31], a[200:207], v2
    v_smfmac_f32_16x16x64_bf16 v[68:71], v[28:31], a[232:239], v2
    s_waitcnt vmcnt(1)
    v_cmp_eq_u32 vcc, -1, v35
    s_cbranch_vccnz .gs_101
.gr_102:
    v_smfmac_f32_16x16x64_bf16 v[64:67], v[32:35], a[208:215], v2
    v_smfmac_f32_16x16x64_bf16 v[68:71], v[32:35], a[240:247], v2
    s_waitcnt vmcnt(0)
    v_cmp_eq_u32 vcc, -1, v39
    s_cbranch_vccnz .gs_103
.gr_104:
    v_smfmac_f32_16x16x64_bf16 v[64:67], v[36:39], a[216:223], v2
    v_smfmac_f32_16x16x64_bf16 v[68:71], v[36:39], a[248:255], v2
    s_nop 7
    v_permlane32_swap_b32 v64, v68
    v_permlane32_swap_b32 v65, v69
    v_permlane32_swap_b32 v66, v70
    v_permlane32_swap_b32 v67, v71
    v_add_f32 v64, v64, v68
    v_add_f32 v65, v65, v69
    v_add_f32 v66, v66, v70
    v_add_f32 v67, v67, v71
    ds_write2_b32 v7, v64, v65 offset0:0 offset1:36
    ds_write2_b32 v7, v66, v67 offset0:72 offset1:108
    s_waitcnt lgkmcnt(0)
    s_barrier
    buffer_store_dwordx4 v[20:23], v15, s[8:11], s36 offen sc1
    buffer_store_dwordx4 v[20:23], v244, s[8:11], s32 offen
    buffer_store_dwordx4 v[20:23], v245, s[8:11], s32 offen
    s_add_u32 s5, s28, 3
    s_min_u32 s5, s5, 64
    s_cmp_ge_u32 s46, s5
    s_cbranch_scc1 .kvd_106
    s_mov_b32 s62, 0
.kv_105:
    buffer_load_dword v18, v13, s[8:11], 0 offen sc1
    s_add_u32 s62, s62, 1
    s_cmp_gt_u32 s62, 0x100000
    s_cbranch_scc1 .mg_end_1
    s_waitcnt vmcnt(0)
    v_min_u32_dpp v18, v18, v18 quad_perm:[1,0,3,2] row_mask:0xf bank_mask:0xf
    s_nop 1
    v_min_u32_dpp v18, v18, v18 quad_perm:[2,3,0,1] row_mask:0xf bank_mask:0xf
    s_nop 1
    v_min_u32_dpp v18, v18, v18 row_half_mirror row_mask:0xf bank_mask:0xf
    s_nop 0
    v_readfirstlane_b32 s46, v18
.kvd_106:
    v_mov_b32 v64, 0
    v_mov_b32 v65, 0
    v_mov_b32 v66, 0
    v_mov_b32 v67, 0
    v_mov_b32 v68, 0
    v_mov_b32 v69, 0
    v_mov_b32 v70, 0
    v_mov_b32 v71, 0
    s_mov_b32 s4, s30
    s_mov_b32 s30, s31
    s_mov_b32 s31, s32
    s_mov_b32 s32, s33
    s_mov_b32 s33, s4
    s_add_u32 s28, s28, 1
    s_mov_b32 s62, 0
    s_mov_b32 s4, s34
    s_mov_b32 s34, s35
    s_mov_b32 s35, s36
    s_mov_b32 s36, s37
    s_mov_b32 s37, s4
    s_add_u32 s41, s41, 0x20000
    s_branch .step_85
.fin_86:
    s_endpgm
.gs_87:
    buffer_load_dwordx4 v[24:27], v3, s[8:11], s30 offen offset:0 sc1
    buffer_load_dwordx4 v[28:31], v3, s[8:11], s30 offen offset:1024 sc1
    buffer_load_dwordx4 v[32:35], v3, s[8:11], s30 offen offset:2048 sc1
    buffer_load_dwordx4 v[36:39], v3, s[8:11], s30 offen offset:3072 sc1
    s_add_u32 s62, s62, 1
    s_cmp_gt_u32 s62, 0x100000
    s_cbranch_scc1 .mg_end_1
    s_waitcnt vmcnt(3)
    v_max_u32 v18, v25, v27
    v_cmp_eq_u32 vcc, -1, v18
    s_cbranch_vccz .gr_88
    s_branch .gs_87
.gs_89:
    buffer_load_dwordx4 v[28:31], v3, s[8:11], s30 offen offset:1024 sc1
    buffer_load_dwordx4 v[32:35], v3, s[8:11], s30 offen offset:2048 sc1
    buffer_load_dwordx4 v[36:39], v3, s[8:11], s30 offen offset:3072 sc1
    s_add_u32 s62, s62, 1
    s_cmp_gt_u32 s62, 0x100000
    s_cbranch_scc1 .mg_end_1
    s_waitcnt vmcnt(2)
    v_max_u32 v18, v29, v31
    v_cmp_eq_u32 vcc, -1, v18
    s_cbranch_vccz .gr_90
    s_branch .gs_89
.gs_91:
    buffer_load_dwordx4 v[32:35], v3, s[8:11], s30 offen offset:2048 sc1
    buffer_load_dwordx4 v[36:39], v3, s[8:11], s30 offen offset:3072 sc1
    s_add_u32 s62, s62, 1
    s_cmp_gt_u32 s62, 0x100000
    s_cbranch_scc1 .mg_end_1
    s_waitcnt vmcnt(1)
    v_max_u32 v18, v33, v35
    v_cmp_eq_u32 vcc, -1, v18
    s_cbranch_vccz .gr_92
    s_branch .gs_91
.gs_93:
    buffer_load_dwordx4 v[36:39], v3, s[8:11], s30 offen offset:3072 sc1
    s_add_u32 s62, s62, 1
    s_cmp_gt_u32 s62, 0x100000
    s_cbranch_scc1 .mg_end_1
    s_waitcnt vmcnt(0)
    v_max_u32 v18, v37, v39
    v_cmp_eq_u32 vcc, -1, v18
    s_cbranch_vccz .gr_94
    s_branch .gs_93
.gs_97:
    buffer_load_dwordx4 v[24:27], v4, s[8:11], s30 offen offset:0 sc1
    buffer_load_dwordx4 v[28:31], v4, s[8:11], s30 offen offset:1024 sc1
    buffer_load_dwordx4 v[32:35], v4, s[8:11], s30 offen offset:2048 sc1
    buffer_load_dwordx4 v[36:39], v4, s[8:11], s30 offen offset:3072 sc1
    s_add_u32 s62, s62, 1
    s_cmp_gt_u32 s62, 0x100000
    s_cbranch_scc1 .mg_end_1
    s_waitcnt vmcnt(3)
    v_cmp_eq_u32 vcc, -1, v27
    s_cbranch_vccz .gr_98
    s_branch .gs_97
.gs_99:
    buffer_load_dwordx4 v[28:31], v4, s[8:11], s30 offen offset:1024 sc1
    buffer_load_dwordx4 v[32:35], v4, s[8:11], s30 offen offset:2048 sc1
    buffer_load_dwordx4 v[36:39], v4, s[8:11], s30 offen offset:3072 sc1
    s_add_u32 s62, s62, 1
    s_cmp_gt_u32 s62, 0x100000
    s_cbranch_scc1 .mg_end_1
    s_waitcnt vmcnt(2)
    v_cmp_eq_u32 vcc, -1, v31
    s_cbranch_vccz .gr_100
    s_branch .gs_99
.gs_101:
    buffer_load_dwordx4 v[32:35], v4, s[8:11], s30 offen offset:2048 sc1
    buffer_load_dwordx4 v[36:39], v4, s[8:11], s30 offen offset:3072 sc1
    s_add_u32 s62, s62, 1
    s_cmp_gt_u32 s62, 0x100000
    s_cbranch_scc1 .mg_end_1
    s_waitcnt vmcnt(1)
    v_cmp_eq_u32 vcc, -1, v35
    s_cbranch_vccz .gr_102
    s_branch .gs_101
.gs_103:
    buffer_load_dwordx4 v[36:39], v4, s[8:11], s30 offen offset:3072 sc1
    s_add_u32 s62, s62, 1
    s_cmp_gt_u32 s62, 0x100000
    s_cbranch_scc1 .mg_end_1
    s_waitcnt vmcnt(0)
    v_cmp_eq_u32 vcc, -1, v39
    s_cbranch_vccz .gr_104
    s_branch .gs_103
.slowv_18:
    s_mov_b32 s28, 0
    s_mov_b32 s30, 83886080
    s_mov_b32 s31, 84148224
    s_mov_b32 s32, 84410368
    s_mov_b32 s33, 84672512
    s_mov_b32 s41, 66977792
    s_lshl_b32 s42, s56, 13
    s_lshl_b32 s4, s53, 11
    s_add_u32 s44, s42, s4
    s_add_u32 s44, s44, 33554432
    s_add_u32 s42, s42, 16777216
    s_add_u32 s43, s42, 4096
    s_add_u32 s96, s44, 524288
    s_sub_u32 s95, s96, 16777216
    s_mov_b32 s62, 0
    s_mov_b32 s45, 0x3e0293ee
    s_mov_b32 s46, 0
    s_and_b32 s4, s25, 1
    s_lshl_b32 s4, s4, 14
    s_lshr_b32 s5, s25, 1
    s_lshl_b32 s5, s5, 12
    s_or_b32 s4, s4, s5
    s_xor_b32 s47, s47, s4
    s_and_b32 s5, s26, 1
    s_lshl_b32 s5, s5, 10
    s_lshr_b32 s4, s26, 1
    s_lshl_b32 s4, s4, 15
    s_or_b32 s5, s5, s4
    s_bfe_u32 s4, s26, 0x10004
    s_lshl_b32 s4, s4, 11
    s_xor_b32 s5, s5, s4
    s_xor_b32 s34, s5, s47
    s_xor_b32 s35, s34, 0x84000
    s_xor_b32 s36, s34, 0x101000
    s_xor_b32 s37, s34, 0x185000
    s_cmp_eq_u32 s24, 1
    s_cbranch_scc1 .w1_108
    s_cmp_eq_u32 s24, 2
    s_cbranch_scc1 .w2_109
    s_cmp_eq_u32 s24, 3
    s_cbranch_scc1 .w3_110
.w0_107:
    v_bfe_u32 v254, v1, 4, 2
    v_mul_u32_u24 v12, 128, v254
    v_bfe_u32 v254, v1, 0, 3
    v_mul_u32_u24 v254, 16, v254
    v_add_u32 v12, v12, v254
    v_add_u32 v12, 131072, v12
    v_add_u32 v12, s57, v12
    v_bfe_u32 v254, v1, 4, 2
    v_mul_u32_u24 v13, 128, v254
    v_bfe_u32 v254, v1, 2, 2
    v_mul_u32_u24 v254, 32, v254
    v_add_u32 v13, v13, v254
    v_bfe_u32 v254, v1, 0, 1
    v_mul_u32_u24 v254, 16, v254
    v_add_u32 v13, v13, v254
    v_add_u32 v13, 133120, v13
    v_add_u32 v13, s57, v13
    v_bfe_u32 v254, v1, 4, 2
    v_mul_u32_u24 v14, 128, v254
    v_bfe_u32 v254, v1, 0, 4
    v_mul_u32_u24 v254, 16, v254
    v_add_u32 v14, v14, v254
    v_add_u32 v14, 65536, v14
    v_add_u32 v14, s55, v14
    v_bfe_u32 v254, v1, 0, 6
    v_mul_u32_u24 v15, 16, v254
    v_bfe_u32 v254, v1, 2, 2
    v_mul_u32_u24 v16, 128, v254
    v_bfe_u32 v254, v1, 0, 2
    v_mul_u32_u24 v254, 16, v254
    v_add_u32 v16, v16, v254
    v_bfe_u32 v254, v1, 4, 2
    v_mul_u32_u24 v254, 4, v254
    v_add_u32 v16, v16, v254
    v_add_u32 v16, 18432, v16
    v_mov_b32 v144, 0
    v_mov_b32 v145, 0
    v_mov_b32 v146, 0
    v_mov_b32 v147, 0
    v_mov_b32 v148, 0
    v_mov_b32 v149, 0
    v_mov_b32 v150, 0
    v_mov_b32 v151, 0
    v_mov_b32 v152, 0
    v_mov_b32 v153, 0
    v_mov_b32 v154, 0
    v_mov_b32 v155, 0
    v_mov_b32 v156, 0
    v_mov_b32 v157, 0
    v_mov_b32 v158, 0
    v_mov_b32 v159, 0
    v_mov_b32 v160, 0
    v_mov_b32 v161, 0
    v_mov_b32 v162, 0
    v_mov_b32 v163, 0
    v_mov_b32 v164, 0
    v_mov_b32 v165, 0
    v_mov_b32 v166, 0
    v_mov_b32 v167, 0
    v_mov_b32 v168, 0
    v_mov_b32 v169, 0
    v_mov_b32 v170, 0
    v_mov_b32 v171, 0
    v_mov_b32 v172, 0
    v_mov_b32 v173, 0
    v_mov_b32 v174, 0
    v_mov_b32 v175, 0
    v_mov_b32 v208, 0
    v_mov_b32 v209, 0
    v_mov_b32 v210, 0
    v_mov_b32 v211, 0
    v_mov_b32 v212, 0
    v_mov_b32 v213, 0
    v_mov_b32 v214, 0
    v_mov_b32 v215, 0
    v_mov_b32 v216, 0
    v_mov_b32 v217, 0
    v_mov_b32 v218, 0
    v_mov_b32 v219, 0
    v_mov_b32 v18, 0xff800000
    v_cndmask_b32 v200, v18, 0, s[48:49]
    v_mov_b32 v220, 0x3f803f80
    v_cndmask_b32 v201, v18, 0, s[48:49]
    v_mov_b32 v221, 0x3f803f80
    v_cndmask_b32 v202, v18, 0, s[48:49]
    v_mov_b32 v222, 0x3f803f80
    v_cndmask_b32 v203, v18, 0, s[48:49]
    v_mov_b32 v223, 0x3f803f80
    s_waitcnt vmcnt(0)
    ds_read_b64_tr_b16 a[192:193], v242 offset:16384
    ds_read_b64_tr_b16 a[194:195], v242 offset:16896
    ds_read_b64_tr_b16 a[196:197], v242 offset:18432
    ds_read_b64_tr_b16 a[198:199], v242 offset:18944
    ds_read_b64_tr_b16 a[200:201], v242 offset:20480
    ds_read_b64_tr_b16 a[202:203], v242 offset:20992
    ds_read_b64_tr_b16 a[204:205], v242 offset:22528
    ds_read_b64_tr_b16 a[206:207], v242 offset:23040
    ds_read_b64_tr_b16 a[208:209], v242 offset:24576
    ds_read_b64_tr_b16 a[210:211], v242 offset:25088
    ds_read_b64_tr_b16 a[212:213], v242 offset:26624
    ds_read_b64_tr_b16 a[214:215], v242 offset:27136
    ds_read_b64_tr_b16 a[216:217], v242 offset:28672
    ds_read_b64_tr_b16 a[218:219], v242 offset:29184
    ds_read_b64_tr_b16 a[220:221], v242 offset:30720
    ds_read_b64_tr_b16 a[222:223], v242 offset:31232
    ds_read_b64_tr_b16 a[224:225], v243 offset:16384
    ds_read_b64_tr_b16 a[226:227], v243 offset:16896
    ds_read_b64_tr_b16 a[228:229], v243 offset:18432
    ds_read_b64_tr_b16 a[230:231], v243 offset:18944
    ds_read_b64_tr_b16 a[232:233], v243 offset:20480
    ds_read_b64_tr_b16 a[234:235], v243 offset:20992
    ds_read_b64_tr_b16 a[236:237], v243 offset:22528
    ds_read_b64_tr_b16 a[238:239], v243 offset:23040
    ds_read_b64_tr_b16 a[240:241], v243 offset:24576
    ds_read_b64_tr_b16 a[242:243], v243 offset:25088
    ds_read_b64_tr_b16 a[244:245], v243 offset:26624
    ds_read_b64_tr_b16 a[246:247], v243 offset:27136
    ds_read_b64_tr_b16 a[248:249], v243 offset:28672
    ds_read_b64_tr_b16 a[250:251], v243 offset:29184
    ds_read_b64_tr_b16 a[252:253], v243 offset:30720
    ds_read_b64_tr_b16 a[254:255], v243 offset:31232
    s_waitcnt lgkmcnt(0)
    s_barrier
    buffer_load_dwordx4 v[104:107], v15, s[8:11], s42 offen offset:0
    buffer_load_dwordx4 v[108:111], v15, s[8:11], s42 offen offset:1024
    buffer_load_dwordx4 v[112:115], v15, s[8:11], s42 offen offset:2048
    buffer_load_dwordx4 v[116:119], v15, s[8:11], s42 offen offset:3072
    buffer_load_dwordx4 v[120:123], v15, s[8:11], s43 offen offset:0
    buffer_load_dwordx4 v[124:127], v15, s[8:11], s43 offen offset:1024
    buffer_load_dwordx4 v[128:131], v15, s[8:11], s43 offen offset:2048
    buffer_load_dwordx4 v[132:135], v15, s[8:11], s43 offen offset:3072
    buffer_load_dwordx4 v[136:139], v15, s[8:11], s44 offen offset:0
    buffer_load_dwordx4 v[140:143], v15, s[8:11], s44 offen offset:1024
    s_add_u32 s42, s42, 262144
    s_add_u32 s43, s43, 262144
    s_add_u32 s44, s44, 262144
.p2align 6
.step_111:
    s_barrier
    s_setprio 3
    buffer_load_dwordx4 v[24:27], v3, s[8:11], s30 offen offset:0 sc1
    s_setprio 2
    buffer_load_dwordx4 v[28:31], v3, s[8:11], s30 offen offset:1024 sc1
    s_setprio 1
    buffer_load_dwordx4 v[32:35], v3, s[8:11], s30 offen offset:2048 sc1
    s_setprio 0
    buffer_load_dwordx4 v[36:39], v3, s[8:11], s30 offen offset:3072 sc1
    s_waitcnt vmcnt(3)
    v_max_u32 v18, v25, v27
    v_cmp_eq_u32 vcc, -1, v18
    s_cbranch_vccnz .gs_113
.gr_114:
    v_smfmac_f32_16x16x64_bf16 v[40:43], v[24:27], a[0:7], v2
    v_smfmac_f32_16x16x64_bf16 v[44:47], v[24:27], a[32:39], v2
    s_waitcnt vmcnt(2)
    v_max_u32 v18, v29, v31
    v_cmp_eq_u32 vcc, -1, v18
    v_smfmac_f32_16x16x64_bf16 v[48:51], v[24:27], a[64:71], v2
    s_cbranch_vccnz .gs_115
.gr_116:
    v_smfmac_f32_16x16x64_bf16 v[40:43], v[28:31], a[8:15], v2
    v_smfmac_f32_16x16x64_bf16 v[44:47], v[28:31], a[40:47], v2
    v_smfmac_f32_16x16x64_bf16 v[52:55], v[24:27], a[96:103], v2
    s_waitcnt vmcnt(1)
    v_max_u32 v18, v33, v35
    v_cmp_eq_u32 vcc, -1, v18
    v_smfmac_f32_16x16x64_bf16 v[48:51], v[28:31], a[72:79], v2
    s_cbranch_vccnz .gs_117
.gr_118:
    v_smfmac_f32_16x16x64_bf16 v[40:43], v[32:35], a[16:23], v2
    v_smfmac_f32_16x16x64_bf16 v[44:47], v[32:35], a[48:55], v2
    v_smfmac_f32_16x16x64_bf16 v[52:55], v[28:31], a[104:111], v2
    s_waitcnt vmcnt(0)
    v_max_u32 v18, v37, v39
    v_cmp_eq_u32 vcc, -1, v18
    v_smfmac_f32_16x16x64_bf16 v[48:51], v[32:35], a[80:87], v2
    s_cbranch_vccnz .gs_119
.gr_120:
    v_smfmac_f32_16x16x64_bf16 v[40:43], v[36:39], a[24:31], v2
    v_smfmac_f32_16x16x64_bf16 v[44:47], v[36:39], a[56:63], v2
    v_smfmac_f32_16x16x64_bf16 v[52:55], v[32:35], a[112:119], v2
    v_smfmac_f32_16x16x64_bf16 v[48:51], v[36:39], a[88:95], v2
    v_permlane32_swap_b32 v40, v44
    v_permlane32_swap_b32 v41, v45
    v_smfmac_f32_16x16x64_bf16 v[52:55], v[36:39], a[120:127], v2
    v_permlane32_swap_b32 v42, v46
    v_permlane32_swap_b32 v43, v47
    v_add_f32 v40, v40, v44
    v_add_f32 v41, v41, v45
    v_add_f32 v42, v42, v46
    v_add_f32 v43, v43, v47
    ds_write2_b32 v5, v40, v41 offset0:0 offset1:36
    ds_write2_b32 v5, v42, v43 offset0:72 offset1:108
    v_permlane32_swap_b32 v48, v52
    v_permlane32_swap_b32 v49, v53
    v_permlane32_swap_b32 v50, v54
    v_permlane32_swap_b32 v51, v55
    v_add_f32 v48, v48, v52
    v_add_f32 v49, v49, v53
    v_add_f32 v50, v50, v54
    v_add_f32 v51, v51, v55
    ds_write2_b32 v6, v48, v49 offset0:0 offset1:36
    ds_write2_b32 v6, v50, v51 offset0:72 offset1:108
    s_waitcnt lgkmcnt(2)
    s_barrier
    ds_read_b64 v[72:73], v9 offset:0
    ds_read_b64 v[74:75], v9 offset:1152
    ds_read_b64 v[76:77], v9 offset:2304
    ds_read_b64 v[78:79], v9 offset:3456
    s_waitcnt lgkmcnt(4)
    s_barrier
    s_waitcnt lgkmcnt(2)
    v_add_f32 v72, v72, v74
    v_add_f32 v73, v73, v75
    s_waitcnt lgkmcnt(0)
    v_add_f32 v76, v76, v78
    v_add_f32 v77, v77, v79
    v_add_f32 v72, v72, v76
    v_add_f32 v73, v73, v77
    v_cvt_pk_bf16_f32 v72, v72, v73
    v_min_u32 v72, 0xfffffffe, v72
    buffer_store_dword v72, v10, s[8:11], s30 offen sc1
    v_smfmac_f32_16x16x64_bf16 v[56:59], v[24:27], a[128:135], v2
    v_smfmac_f32_16x16x64_bf16 v[60:63], v[24:27], a[160:167], v2
    v_smfmac_f32_16x16x64_bf16 v[56:59], v[28:31], a[136:143], v2
    v_smfmac_f32_16x16x64_bf16 v[60:63], v[28:31], a[168:175], v2
    v_smfmac_f32_16x16x64_bf16 v[56:59], v[32:35], a[144:151], v2
    v_smfmac_f32_16x16x64_bf16 v[60:63], v[32:35], a[176:183], v2
    v_smfmac_f32_16x16x64_bf16 v[56:59], v[36:39], a[152:159], v2
    v_smfmac_f32_16x16x64_bf16 v[60:63], v[36:39], a[184:191], v2
    v_mov_b32 v40, 0
    v_mov_b32 v41, 0
    v_mov_b32 v42, 0
    v_mov_b32 v43, 0
    v_mov_b32 v44, 0
    v_mov_b32 v45, 0
    v_mov_b32 v46, 0
    v_mov_b32 v47, 0
    v_permlane32_swap_b32 v56, v60
    v_permlane32_swap_b32 v57, v61
    v_permlane32_swap_b32 v58, v62
    v_permlane32_swap_b32 v59, v63
    v_add_f32 v56, v56, v60
    v_add_f32 v57, v57, v61
    v_add_f32 v58, v58, v62
    v_add_f32 v59, v59, v63
    ds_write_b128 v8, v[56:59]
    s_cmp_eq_u32 s28, 63
    s_cbranch_scc1 .fin_112
    s_waitcnt vmcnt(0)
    s_mov_b64 exec, s[48:49]
    buffer_load_dwordx4 v[144:147], v12, s[8:11], s30 offen offset:0 sc1
    buffer_load_dwordx4 v[148:151], v12, s[8:11], s30 offen offset:512 sc1
    buffer_load_dwordx4 v[152:155], v12, s[8:11], s30 offen offset:1024 sc1
    buffer_load_dwordx4 v[156:159], v12, s[8:11], s30 offen offset:1536 sc1
    s_mov_b64 exec, s[50:51]
    buffer_load_dwordx4 v[160:163], v12, s[8:11], s30 offen offset:0 sc1
    buffer_load_dwordx4 v[164:167], v12, s[8:11], s30 offen offset:512 sc1
    buffer_load_dwordx4 v[168:171], v12, s[8:11], s30 offen offset:1024 sc1
    buffer_load_dwordx4 v[172:175], v12, s[8:11], s30 offen offset:1536 sc1
    s_mov_b64 exec, -1
    buffer_load_dwordx4 v[176:179], v13, s[8:11], s30 offen offset:0 sc1
    buffer_load_dwordx4 v[180:183], v13, s[8:11], s30 offen offset:512 sc1
    buffer_load_dwordx4 v[184:187], v13, s[8:11], s30 offen offset:1024 sc1
    buffer_load_dwordx4 v[188:191], v13, s[8:11], s30 offen offset:1536 sc1
    s_waitcnt lgkmcnt(0)
    s_barrier
.mf_121:
    s_waitcnt vmcnt(11)
    v_mfma_f32_16x16x32_bf16 v[192:195], v[104:107], v[144:147], 0
    v_max3_u32 v18, v144, v145, v146
    v_max_u32 v18, v18, v147
    s_waitcnt vmcnt(10)
    v_mfma_f32_16x16x32_bf16 v[192:195], v[108:111], v[148:151], v[192:195]
    v_max3_u32 v18, v18, v148, v149
    v_max3_u32 v18, v18, v150, v151
    s_waitcnt vmcnt(9)
    v_mfma_f32_16x16x32_bf16 v[192:195], v[112:115], v[152:155], v[192:195]
    v_max3_u32 v18, v18, v152, v153
    v_max3_u32 v18, v18, v154, v155
    s_waitcnt vmcnt(8)
    v_mfma_f32_16x16x32_bf16 v[192:195], v[116:119], v[156:159], v[192:195]
    v_max3_u32 v18, v18, v156, v157
    v_max3_u32 v18, v18, v158, v159
    s_waitcnt vmcnt(7)
    v_mfma_f32_16x16x32_bf16 v[192:195], v[120:123], v[160:163], v[192:195]
    v_cmp_eq_u32 vcc, -1, v18
    s_waitcnt vmcnt(6)
    v_mfma_f32_16x16x32_bf16 v[192:195], v[124:127], v[164:167], v[192:195]
    s_cbranch_vccnz .re_122
    s_waitcnt vmcnt(5)
    v_mfma_f32_16x16x32_bf16 v[192:195], v[128:131], v[168:171], v[192:195]
    s_waitcnt vmcnt(4)
    v_mfma_f32_16x16x32_bf16 v[192:195], v[132:135], v[172:175], v[192:195]
.mk_123:
    s_waitcnt vmcnt(3)
    v_mfma_f32_16x16x32_bf16 v[196:199], v[176:179], v[144:147], v[200:203]
    v_max3_u32 v18, v176, v177, v178
    v_max_u32 v18, v18, v179
    s_waitcnt vmcnt(2)
    v_mfma_f32_16x16x32_bf16 v[196:199], v[180:183], v[148:151], v[196:199]
    v_max3_u32 v18, v18, v180, v181
    v_max3_u32 v18, v18, v182, v183
    s_waitcnt vmcnt(1)
    v_mfma_f32_16x16x32_bf16 v[196:199], v[184:187], v[152:155], v[196:199]
    v_max3_u32 v18, v18, v184, v185
    v_max3_u32 v18, v18, v186, v187
    s_waitcnt vmcnt(0)
    v_mfma_f32_16x16x32_bf16 v[196:199], v[188:191], v[156:159], v[196:199]
    v_max3_u32 v18, v18, v188, v189
    v_max3_u32 v18, v18, v190, v191
    v_cmp_eq_u32 vcc, -1, v18
    v_max3_f32 v19, v192, v193, v194
    s_cbranch_vccnz .rk_124
    s_barrier
    ds_read_b32 v212, v16
    ds_read_b32 v216, v16 offset:64
    v_max3_f32 v18, v195, v196, v197
    v_max_f32 v18, v18, v19
    s_nop 1
    v_max_f32_dpp v19, v18, v18 row_ror:8 row_mask:0xf bank_mask:0xf
    v_max_f32_dpp v17, v18, v18 row_ror:8 row_mask:0xf bank_mask:0xf
    s_nop 1
    v_permlane16_swap_b32 v19, v17
    v_max_f32 v18, v19, v17
    v_max_f32 v19, v19, v17
    s_nop 1
    v_permlane32_swap_b32 v18, v19
    v_max_f32 v18, v18, v19
    v_mul_f32 v18, s45, v18
    v_fma_f32 v240, v192, s45, -v18
    v_fma_f32 v241, v193, s45, -v18
    v_fma_f32 v242, v194, s45, -v18
    v_fma_f32 v243, v195, s45, -v18
    v_fma_f32 v244, v196, s45, -v18
    v_fma_f32 v245, v197, s45, -v18
    v_exp_f32 v240, v240
    v_exp_f32 v241, v241
    v_exp_f32 v242, v242
    v_exp_f32 v243, v243
    v_exp_f32 v244, v244
    v_exp_f32 v245, v245
    v_cvt_pk_bf16_f32 v204, v240, v241
    v_cvt_pk_bf16_f32 v205, v242, v243
    v_cvt_pk_bf16_f32 v208, v244, v245
    s_waitcnt lgkmcnt(0)
    v_mov_b32_dpp v206, v204 row_ror:8 row_mask:0xf bank_mask:0xf
    v_mov_b32_dpp v207, v205 row_ror:8 row_mask:0xf bank_mask:0xf
    v_mfma_f32_16x16x32_bf16 v[224:227], v[220:223], v[208:211], 0
    v_mfma_f32_16x16x32_bf16 v[224:227], v[220:223], v[204:207], v[224:227]
    v_mfma_f32_16x16x32_bf16 v[228:231], v[212:215], v[208:211], 0
    v_mfma_f32_16x16x32_bf16 v[228:231], v[136:139], v[204:207], v[228:231]
    v_mfma_f32_16x16x32_bf16 v[232:235], v[216:219], v[208:211], 0
    v_rcp_f32 v18, v224
    v_mfma_f32_16x16x32_bf16 v[232:235], v[140:143], v[204:207], v[232:235]
    s_mov_b64 exec, s[48:49]
    v_mul_f32 v228, v18, v228
    v_mul_f32 v229, v18, v229
    v_mul_f32 v230, v18, v230
    v_mul_f32 v231, v18, v231
    v_cvt_pk_bf16_f32 v236, v228, v229
    v_cvt_pk_bf16_f32 v237, v230, v231
    s_nop 1
    v_mul_f32 v232, v18, v232
    v_mul_f32 v233, v18, v233
    v_mul_f32 v234, v18, v234
    v_mul_f32 v235, v18, v235
    v_cvt_pk_bf16_f32 v238, v232, v233
    v_cvt_pk_bf16_f32 v239, v234, v235
    v_min_u32 v239, 0xfffffffe, v239
    buffer_store_dwordx4 v[236:239], v14, s[8:11], s30 offen sc1
    s_mov_b64 exec, -1
    v_mov_b32 v48, 0
    v_mov_b32 v49, 0
    v_mov_b32 v50, 0
    v_mov_b32 v51, 0
    v_mov_b32 v52, 0
    v_mov_b32 v53, 0
    v_mov_b32 v54, 0
    v_mov_b32 v55, 0
    v_mov_b32 v56, 0
    v_mov_b32 v57, 0
    v_mov_b32 v58, 0
    v_mov_b32 v59, 0
    v_mov_b32 v60, 0
    v_mov_b32 v61, 0
    v_mov_b32 v62, 0
    v_mov_b32 v63, 0
    s_waitcnt vmcnt(0)
    s_barrier
    s_setprio 3
    buffer_load_dwordx4 v[24:27], v4, s[8:11], s30 offen offset:0 sc1
    s_setprio 2
    buffer_load_dwordx4 v[28:31], v4, s[8:11], s30 offen offset:1024 sc1
    s_setprio 1
    buffer_load_dwordx4 v[32:35], v4, s[8:11], s30 offen offset:2048 sc1
    s_setprio 0
    buffer_load_dwordx4 v[36:39], v4, s[8:11], s30 offen offset:3072 sc1
    s_waitcnt vmcnt(3)
    v_cmp_eq_u32 vcc, -1, v27
    s_cbranch_vccnz .gs_125
.gr_126:
    v_smfmac_f32_16x16x64_bf16 v[64:67], v[24:27], a[192:199], v2
    v_smfmac_f32_16x16x64_bf16 v[68:71], v[24:27], a[224:231], v2
    s_waitcnt vmcnt(2)
    v_cmp_eq_u32 vcc, -1, v31
    s_cbranch_vccnz .gs_127
.gr_128:
    v_smfmac_f32_16x16x64_bf16 v[64:67], v[28:31], a[200:207], v2
    v_smfmac_f32_16x16x64_bf16 v[68:71], v[28:31], a[232:239], v2
    s_waitcnt vmcnt(1)
    v_cmp_eq_u32 vcc, -1, v35
    s_cbranch_vccnz .gs_129
.gr_130:
    v_smfmac_f32_16x16x64_bf16 v[64:67], v[32:35], a[208:215], v2
    v_smfmac_f32_16x16x64_bf16 v[68:71], v[32:35], a[240:247], v2
    s_waitcnt vmcnt(0)
    v_cmp_eq_u32 vcc, -1, v39
    s_cbranch_vccnz .gs_131
.gr_132:
    v_smfmac_f32_16x16x64_bf16 v[64:67], v[36:39], a[216:223], v2
    v_smfmac_f32_16x16x64_bf16 v[68:71], v[36:39], a[248:255], v2
    s_nop 7
    v_permlane32_swap_b32 v64, v68
    v_permlane32_swap_b32 v65, v69
    v_permlane32_swap_b32 v66, v70
    v_permlane32_swap_b32 v67, v71
    v_add_f32 v64, v64, v68
    v_add_f32 v65, v65, v69
    v_add_f32 v66, v66, v70
    v_add_f32 v67, v67, v71
    ds_write2_b32 v7, v64, v65 offset0:0 offset1:36
    ds_write2_b32 v7, v66, v67 offset0:72 offset1:108
    s_waitcnt lgkmcnt(0)
    s_barrier
    buffer_load_dwordx4 v[104:107], v15, s[8:11], s42 offen offset:0
    buffer_load_dwordx4 v[108:111], v15, s[8:11], s42 offen offset:1024
    buffer_load_dwordx4 v[112:115], v15, s[8:11], s42 offen offset:2048
    buffer_load_dwordx4 v[116:119], v15, s[8:11], s42 offen offset:3072
    buffer_load_dwordx4 v[120:123], v15, s[8:11], s43 offen offset:0
    buffer_load_dwordx4 v[124:127], v15, s[8:11], s43 offen offset:1024
    buffer_load_dwordx4 v[128:131], v15, s[8:11], s43 offen offset:2048
    buffer_load_dwordx4 v[132:135], v15, s[8:11], s43 offen offset:3072
    buffer_load_dwordx4 v[136:139], v15, s[8:11], s44 offen offset:0
    buffer_load_dwordx4 v[140:143], v15, s[8:11], s44 offen offset:1024
    s_add_u32 s42, s42, 262144
    s_add_u32 s43, s43, 262144
    s_add_u32 s44, s44, 262144
    v_mov_b32 v64, 0
    v_mov_b32 v65, 0
    v_mov_b32 v66, 0
    v_mov_b32 v67, 0
    v_mov_b32 v68, 0
    v_mov_b32 v69, 0
    v_mov_b32 v70, 0
    v_mov_b32 v71, 0
    s_mov_b32 s4, s30
    s_mov_b32 s30, s31
    s_mov_b32 s31, s32
    s_mov_b32 s32, s33
    s_mov_b32 s33, s4
    s_add_u32 s28, s28, 1
    s_mov_b32 s62, 0
    s_branch .step_111
.fin_112:
    s_waitcnt lgkmcnt(0)
    s_barrier
    s_barrier
    s_endpgm
.gs_113:
    buffer_load_dwordx4 v[24:27], v3, s[8:11], s30 offen offset:0 sc1
    buffer_load_dwordx4 v[28:31], v3, s[8:11], s30 offen offset:1024 sc1
    buffer_load_dwordx4 v[32:35], v3, s[8:11], s30 offen offset:2048 sc1
    buffer_load_dwordx4 v[36:39], v3, s[8:11], s30 offen offset:3072 sc1
    s_add_u32 s62, s62, 1
    s_cmp_gt_u32 s62, 0x100000
    s_cbranch_scc1 .mg_end_1
    s_waitcnt vmcnt(3)
    v_max_u32 v18, v25, v27
    v_cmp_eq_u32 vcc, -1, v18
    s_cbranch_vccz .gr_114
    s_branch .gs_113
.gs_115:
    buffer_load_dwordx4 v[28:31], v3, s[8:11], s30 offen offset:1024 sc1
    buffer_load_dwordx4 v[32:35], v3, s[8:11], s30 offen offset:2048 sc1
    buffer_load_dwordx4 v[36:39], v3, s[8:11], s30 offen offset:3072 sc1
    s_add_u32 s62, s62, 1
    s_cmp_gt_u32 s62, 0x100000
    s_cbranch_scc1 .mg_end_1
    s_waitcnt vmcnt(2)
    v_max_u32 v18, v29, v31
    v_cmp_eq_u32 vcc, -1, v18
    s_cbranch_vccz .gr_116
    s_branch .gs_115
.gs_117:
    buffer_load_dwordx4 v[32:35], v3, s[8:11], s30 offen offset:2048 sc1
    buffer_load_dwordx4 v[36:39], v3, s[8:11], s30 offen offset:3072 sc1
    s_add_u32 s62, s62, 1
    s_cmp_gt_u32 s62, 0x100000
    s_cbranch_scc1 .mg_end_1
    s_waitcnt vmcnt(1)
    v_max_u32 v18, v33, v35
    v_cmp_eq_u32 vcc, -1, v18
    s_cbranch_vccz .gr_118
    s_branch .gs_117
.gs_119:
    buffer_load_dwordx4 v[36:39], v3, s[8:11], s30 offen offset:3072 sc1
    s_add_u32 s62, s62, 1
    s_cmp_gt_u32 s62, 0x100000
    s_cbranch_scc1 .mg_end_1
    s_waitcnt vmcnt(0)
    v_max_u32 v18, v37, v39
    v_cmp_eq_u32 vcc, -1, v18
    s_cbranch_vccz .gr_120
    s_branch .gs_119
.re_122:
    s_mov_b64 exec, s[48:49]
    buffer_load_dwordx4 v[144:147], v12, s[8:11], s30 offen offset:0 sc1
    buffer_load_dwordx4 v[148:151], v12, s[8:11], s30 offen offset:512 sc1
    buffer_load_dwordx4 v[152:155], v12, s[8:11], s30 offen offset:1024 sc1
    buffer_load_dwordx4 v[156:159], v12, s[8:11], s30 offen offset:1536 sc1
    s_mov_b64 exec, s[50:51]
    buffer_load_dwordx4 v[160:163], v12, s[8:11], s30 offen offset:0 sc1
    buffer_load_dwordx4 v[164:167], v12, s[8:11], s30 offen offset:512 sc1
    buffer_load_dwordx4 v[168:171], v12, s[8:11], s30 offen offset:1024 sc1
    buffer_load_dwordx4 v[172:175], v12, s[8:11], s30 offen offset:1536 sc1
    s_mov_b64 exec, -1
    buffer_load_dwordx4 v[176:179], v13, s[8:11], s30 offen offset:0 sc1
    buffer_load_dwordx4 v[180:183], v13, s[8:11], s30 offen offset:512 sc1
    buffer_load_dwordx4 v[184:187], v13, s[8:11], s30 offen offset:1024 sc1
    buffer_load_dwordx4 v[188:191], v13, s[8:11], s30 offen offset:1536 sc1
    s_add_u32 s62, s62, 1
    s_cmp_gt_u32 s62, 0x100000
    s_cbranch_scc1 .mg_end_1
    s_branch .mf_121
.rk_124:
    buffer_load_dwordx4 v[176:179], v13, s[8:11], s30 offen offset:0 sc1
    buffer_load_dwordx4 v[180:183], v13, s[8:11], s30 offen offset:512 sc1
    buffer_load_dwordx4 v[184:187], v13, s[8:11], s30 offen offset:1024 sc1
    buffer_load_dwordx4 v[188:191], v13, s[8:11], s30 offen offset:1536 sc1
    s_add_u32 s62, s62, 1
    s_cmp_gt_u32 s62, 0x100000
    s_cbranch_scc1 .mg_end_1
    s_branch .mk_123
.gs_125:
    buffer_load_dwordx4 v[24:27], v4, s[8:11], s30 offen offset:0 sc1
    buffer_load_dwordx4 v[28:31], v4, s[8:11], s30 offen offset:1024 sc1
    buffer_load_dwordx4 v[32:35], v4, s[8:11], s30 offen offset:2048 sc1
    buffer_load_dwordx4 v[36:39], v4, s[8:11], s30 offen offset:3072 sc1
    s_add_u32 s62, s62, 1
    s_cmp_gt_u32 s62, 0x100000
    s_cbranch_scc1 .mg_end_1
    s_waitcnt vmcnt(3)
    v_cmp_eq_u32 vcc, -1, v27
    s_cbranch_vccz .gr_126
    s_branch .gs_125
.gs_127:
    buffer_load_dwordx4 v[28:31], v4, s[8:11], s30 offen offset:1024 sc1
    buffer_load_dwordx4 v[32:35], v4, s[8:11], s30 offen offset:2048 sc1
    buffer_load_dwordx4 v[36:39], v4, s[8:11], s30 offen offset:3072 sc1
    s_add_u32 s62, s62, 1
    s_cmp_gt_u32 s62, 0x100000
    s_cbranch_scc1 .mg_end_1
    s_waitcnt vmcnt(2)
    v_cmp_eq_u32 vcc, -1, v31
    s_cbranch_vccz .gr_128
    s_branch .gs_127
.gs_129:
    buffer_load_dwordx4 v[32:35], v4, s[8:11], s30 offen offset:2048 sc1
    buffer_load_dwordx4 v[36:39], v4, s[8:11], s30 offen offset:3072 sc1
    s_add_u32 s62, s62, 1
    s_cmp_gt_u32 s62, 0x100000
    s_cbranch_scc1 .mg_end_1
    s_waitcnt vmcnt(1)
    v_cmp_eq_u32 vcc, -1, v35
    s_cbranch_vccz .gr_130
    s_branch .gs_129
.gs_131:
    buffer_load_dwordx4 v[36:39], v4, s[8:11], s30 offen offset:3072 sc1
    s_add_u32 s62, s62, 1
    s_cmp_gt_u32 s62, 0x100000
    s_cbranch_scc1 .mg_end_1
    s_waitcnt vmcnt(0)
    v_cmp_eq_u32 vcc, -1, v39
    s_cbranch_vccz .gr_132
    s_branch .gs_131
.w1_108:
    v_bfe_u32 v254, v1, 1, 3
    v_mul_u32_u24 v12, 144, v254
    v_bfe_u32 v254, v1, 4, 2
    v_mul_u32_u24 v254, 32, v254
    v_add_u32 v12, v12, v254
    v_bfe_u32 v254, v1, 0, 1
    v_mul_u32_u24 v254, 16, v254
    v_add_u32 v12, v12, v254
    v_add_u32 v12, 9216, v12
    v_bfe_u32 v254, v1, 0, 6
    v_mul_u32_u24 v13, 16, v254
    v_add_u32 v13, s101, v13
    v_bfe_u32 v254, v1, 0, 6
    v_mul_u32_u24 v14, 8, v254
    v_add_u32 v14, s55, v14
    v_xor_b32 v14, 2048, v14
    s_waitcnt vmcnt(0)
    ds_read_b64_tr_b16 a[192:193], v242 offset:16384
    ds_read_b64_tr_b16 a[194:195], v242 offset:16896
    ds_read_b64_tr_b16 a[196:197], v242 offset:18432
    ds_read_b64_tr_b16 a[198:199], v242 offset:18944
    ds_read_b64_tr_b16 a[200:201], v242 offset:20480
    ds_read_b64_tr_b16 a[202:203], v242 offset:20992
    ds_read_b64_tr_b16 a[204:205], v242 offset:22528
    ds_read_b64_tr_b16 a[206:207], v242 offset:23040
    ds_read_b64_tr_b16 a[208:209], v242 offset:24576
    ds_read_b64_tr_b16 a[210:211], v242 offset:25088
    ds_read_b64_tr_b16 a[212:213], v242 offset:26624
    ds_read_b64_tr_b16 a[214:215], v242 offset:27136
    ds_read_b64_tr_b16 a[216:217], v242 offset:28672
    ds_read_b64_tr_b16 a[218:219], v242 offset:29184
    ds_read_b64_tr_b16 a[220:221], v242 offset:30720
    ds_read_b64_tr_b16 a[222:223], v242 offset:31232
    ds_read_b64_tr_b16 a[224:225], v243 offset:16384
    ds_read_b64_tr_b16 a[226:227], v243 offset:16896
    ds_read_b64_tr_b16 a[228:229], v243 offset:18432
    ds_read_b64_tr_b16 a[230:231], v243 offset:18944
    ds_read_b64_tr_b16 a[232:233], v243 offset:20480
    ds_read_b64_tr_b16 a[234:235], v243 offset:20992
    ds_read_b64_tr_b16 a[236:237], v243 offset:22528
    ds_read_b64_tr_b16 a[238:239], v243 offset:23040
    ds_read_b64_tr_b16 a[240:241], v243 offset:24576
    ds_read_b64_tr_b16 a[242:243], v243 offset:25088
    ds_read_b64_tr_b16 a[244:245], v243 offset:26624
    ds_read_b64_tr_b16 a[246:247], v243 offset:27136
    ds_read_b64_tr_b16 a[248:249], v243 offset:28672
    ds_read_b64_tr_b16 a[250:251], v243 offset:29184
    ds_read_b64_tr_b16 a[252:253], v243 offset:30720
    ds_read_b64_tr_b16 a[254:255], v243 offset:31232
    s_waitcnt lgkmcnt(0)
    s_barrier
.p2align 6
.step_133:
    s_waitcnt vmcnt(0)
    s_barrier
    s_setprio 3
    buffer_load_dwordx4 v[24:27], v3, s[8:11], s30 offen offset:0 sc1
    s_setprio 2
    buffer_load_dwordx4 v[28:31], v3, s[8:11], s30 offen offset:1024 sc1
    s_setprio 1
    buffer_load_dwordx4 v[32:35], v3, s[8:11], s30 offen offset:2048 sc1
    s_setprio 0
    buffer_load_dwordx4 v[36:39], v3, s[8:11], s30 offen offset:3072 sc1
    s_waitcnt vmcnt(3)
    v_max_u32 v18, v25, v27
    v_cmp_eq_u32 vcc, -1, v18
    s_cbranch_vccnz .gs_135
.gr_136:
    v_smfmac_f32_16x16x64_bf16 v[40:43], v[24:27], a[0:7], v2
    v_smfmac_f32_16x16x64_bf16 v[44:47], v[24:27], a[32:39], v2
    s_waitcnt vmcnt(2)
    v_max_u32 v18, v29, v31
    v_cmp_eq_u32 vcc, -1, v18
    v_smfmac_f32_16x16x64_bf16 v[48:51], v[24:27], a[64:71], v2
    s_cbranch_vccnz .gs_137
.gr_138:
    v_smfmac_f32_16x16x64_bf16 v[40:43], v[28:31], a[8:15], v2
    v_smfmac_f32_16x16x64_bf16 v[44:47], v[28:31], a[40:47], v2
    v_smfmac_f32_16x16x64_bf16 v[52:55], v[24:27], a[96:103], v2
    s_waitcnt vmcnt(1)
    v_max_u32 v18, v33, v35
    v_cmp_eq_u32 vcc, -1, v18
    v_smfmac_f32_16x16x64_bf16 v[48:51], v[28:31], a[72:79], v2
    s_cbranch_vccnz .gs_139
.gr_140:
    v_smfmac_f32_16x16x64_bf16 v[40:43], v[32:35], a[16:23], v2
    v_smfmac_f32_16x16x64_bf16 v[44:47], v[32:35], a[48:55], v2
    v_smfmac_f32_16x16x64_bf16 v[52:55], v[28:31], a[104:111], v2
    s_waitcnt vmcnt(0)
    v_max_u32 v18, v37, v39
    v_cmp_eq_u32 vcc, -1, v18
    v_smfmac_f32_16x16x64_bf16 v[48:51], v[32:35], a[80:87], v2
    s_cbranch_vccnz .gs_141
.gr_142:
    v_smfmac_f32_16x16x64_bf16 v[40:43], v[36:39], a[24:31], v2
    v_smfmac_f32_16x16x64_bf16 v[44:47], v[36:39], a[56:63], v2
    v_smfmac_f32_16x16x64_bf16 v[52:55], v[32:35], a[112:119], v2
    v_smfmac_f32_16x16x64_bf16 v[48:51], v[36:39], a[88:95], v2
    v_permlane32_swap_b32 v40, v44
    v_permlane32_swap_b32 v41, v45
    v_smfmac_f32_16x16x64_bf16 v[52:55], v[36:39], a[120:127], v2
    v_permlane32_swap_b32 v42, v46
    v_permlane32_swap_b32 v43, v47
    v_add_f32 v40, v40, v44
    v_add_f32 v41, v41, v45
    v_add_f32 v42, v42, v46
    v_add_f32 v43, v43, v47
    ds_write2_b32 v5, v40, v41 offset0:0 offset1:36
    ds_write2_b32 v5, v42, v43 offset0:72 offset1:108
    v_permlane32_swap_b32 v48, v52
    v_permlane32_swap_b32 v49, v53
    v_permlane32_swap_b32 v50, v54
    v_permlane32_swap_b32 v51, v55
    v_add_f32 v48, v48, v52
    v_add_f32 v49, v49, v53
    v_add_f32 v50, v50, v54
    v_add_f32 v51, v51, v55
    ds_write2_b32 v6, v48, v49 offset0:0 offset1:36
    ds_write2_b32 v6, v50, v51 offset0:72 offset1:108
    s_waitcnt lgkmcnt(2)
    s_barrier
    ds_read_b64 v[72:73], v9 offset:0
    ds_read_b64 v[74:75], v9 offset:1152
    ds_read_b64 v[76:77], v9 offset:2304
    ds_read_b64 v[78:79], v9 offset:3456
    s_waitcnt lgkmcnt(4)
    s_barrier
    s_waitcnt lgkmcnt(2)
    v_add_f32 v72, v72, v74
    v_add_f32 v73, v73, v75
    s_waitcnt lgkmcnt(0)
    v_add_f32 v76, v76, v78
    v_add_f32 v77, v77, v79
    v_add_f32 v72, v72, v76
    v_add_f32 v73, v73, v77
    v_cvt_pk_bf16_f32 v72, v72, v73
    v_min_u32 v72, 0xfffffffe, v72
    buffer_store_dword v72, v10, s[8:11], s30 offen sc1
    v_smfmac_f32_16x16x64_bf16 v[56:59], v[24:27], a[128:135], v2
    v_smfmac_f32_16x16x64_bf16 v[60:63], v[24:27], a[160:167], v2
    v_smfmac_f32_16x16x64_bf16 v[56:59], v[28:31], a[136:143], v2
    v_smfmac_f32_16x16x64_bf16 v[60:63], v[28:31], a[168:175], v2
    v_smfmac_f32_16x16x64_bf16 v[56:59], v[32:35], a[144:151], v2
    v_smfmac_f32_16x16x64_bf16 v[60:63], v[32:35], a[176:183], v2
    v_smfmac_f32_16x16x64_bf16 v[56:59], v[36:39], a[152:159], v2
    v_smfmac_f32_16x16x64_bf16 v[60:63], v[36:39], a[184:191], v2
    v_mov_b32 v40, 0
    v_mov_b32 v41, 0
    v_mov_b32 v42, 0
    v_mov_b32 v43, 0
    v_mov_b32 v44, 0
    v_mov_b32 v45, 0
    v_mov_b32 v46, 0
    v_mov_b32 v47, 0
    v_permlane32_swap_b32 v56, v60
    v_permlane32_swap_b32 v57, v61
    v_permlane32_swap_b32 v58, v62
    v_permlane32_swap_b32 v59, v63
    v_add_f32 v56, v56, v60
    v_add_f32 v57, v57, v61
    v_add_f32 v58, v58, v62
    v_add_f32 v59, v59, v63
    ds_write_b128 v8, v[56:59]
    s_waitcnt lgkmcnt(0)
    s_barrier
    s_barrier
    s_cmp_eq_u32 s28, 63
    s_cbranch_scc1 .fin_134
    s_xor_b32 s38, s34, 0x4000
    s_xor_b32 s39, s34, 0x1000
    s_xor_b32 s40, s34, 0x5000
    v_mov_b32 v48, 0
    v_mov_b32 v49, 0
    v_mov_b32 v50, 0
    v_mov_b32 v51, 0
    v_mov_b32 v52, 0
    v_mov_b32 v53, 0
    v_mov_b32 v54, 0
    v_mov_b32 v55, 0
    v_mov_b32 v56, 0
    v_mov_b32 v57, 0
    v_mov_b32 v58, 0
    v_mov_b32 v59, 0
    v_mov_b32 v60, 0
    v_mov_b32 v61, 0
    v_mov_b32 v62, 0
    v_mov_b32 v63, 0
    s_barrier
    s_setprio 3
    buffer_load_dwordx4 v[24:27], v4, s[8:11], s30 offen offset:0 sc1
    s_setprio 2
    buffer_load_dwordx4 v[28:31], v4, s[8:11], s30 offen offset:1024 sc1
    s_setprio 1
    buffer_load_dwordx4 v[32:35], v4, s[8:11], s30 offen offset:2048 sc1
    s_setprio 0
    buffer_load_dwordx4 v[36:39], v4, s[8:11], s30 offen offset:3072 sc1
    s_waitcnt vmcnt(3)
    v_cmp_eq_u32 vcc, -1, v27
    s_cbranch_vccnz .gs_143
.gr_144:
    v_smfmac_f32_16x16x64_bf16 v[64:67], v[24:27], a[192:199], v2
    v_smfmac_f32_16x16x64_bf16 v[68:71], v[24:27], a[224:231], v2
    s_waitcnt vmcnt(2)
    v_cmp_eq_u32 vcc, -1, v31
    s_cbranch_vccnz .gs_145
.gr_146:
    v_smfmac_f32_16x16x64_bf16 v[64:67], v[28:31], a[200:207], v2
    v_smfmac_f32_16x16x64_bf16 v[68:71], v[28:31], a[232:239], v2
    s_waitcnt vmcnt(1)
    v_cmp_eq_u32 vcc, -1, v35
    s_cbranch_vccnz .gs_147
.gr_148:
    v_smfmac_f32_16x16x64_bf16 v[64:67], v[32:35], a[208:215], v2
    v_smfmac_f32_16x16x64_bf16 v[68:71], v[32:35], a[240:247], v2
    s_waitcnt vmcnt(0)
    v_cmp_eq_u32 vcc, -1, v39
    s_cbranch_vccnz .gs_149
.gr_150:
    v_smfmac_f32_16x16x64_bf16 v[64:67], v[36:39], a[216:223], v2
    v_smfmac_f32_16x16x64_bf16 v[68:71], v[36:39], a[248:255], v2
    s_nop 7
    v_permlane32_swap_b32 v64, v68
    v_permlane32_swap_b32 v65, v69
    v_permlane32_swap_b32 v66, v70
    v_permlane32_swap_b32 v67, v71
    v_add_f32 v64, v64, v68
    v_add_f32 v65, v65, v69
    v_add_f32 v66, v66, v70
    v_add_f32 v67, v67, v71
    ds_write2_b32 v7, v64, v65 offset0:0 offset1:36
    ds_write2_b32 v7, v66, v67 offset0:72 offset1:108
    s_waitcnt lgkmcnt(0)
    s_barrier
    ds_read_b128 v[72:75], v12 offset:0
    ds_read_b128 v[76:79], v12 offset:1152
    ds_read_b128 v[80:83], v12 offset:2304
    ds_read_b128 v[84:87], v12 offset:3456
    s_waitcnt lgkmcnt(2)
    v_add_f32 v72, v72, v76
    v_add_f32 v73, v73, v77
    v_add_f32 v74, v74, v78
    v_add_f32 v75, v75, v79
    s_waitcnt lgkmcnt(0)
    v_add_f32 v80, v80, v84
    v_add_f32 v81, v81, v85
    v_add_f32 v82, v82, v86
    v_add_f32 v83, v83, v87
    v_add_f32 v72, v72, v80
    v_add_f32 v73, v73, v81
    v_add_f32 v74, v74, v82
    v_add_f32 v75, v75, v83
    v_min_u32 v75, 0xfffffffe, v75
    buffer_store_dwordx4 v[72:75], v13, s[8:11], s34 offen sc1
    v_mov_b32 v64, 0
    v_mov_b32 v65, 0
    v_mov_b32 v66, 0
    v_mov_b32 v67, 0
    v_mov_b32 v68, 0
    v_mov_b32 v69, 0
    v_mov_b32 v70, 0
    v_mov_b32 v71, 0
    s_waitcnt vmcnt(0)
.pl_151:
    buffer_load_dwordx4 v[76:79], v13, s[8:11], s38 offen sc1
    buffer_load_dwordx4 v[80:83], v13, s[8:11], s39 offen sc1
    buffer_load_dwordx4 v[84:87], v13, s[8:11], s40 offen sc1
    s_waitcnt vmcnt(2)
    v_add_f32 v88, v72, v76
    v_add_f32 v89, v73, v77
    v_add_f32 v90, v74, v78
    v_add_f32 v91, v75, v79
    s_waitcnt vmcnt(0)
    v_max3_u32 v18, v79, v83, v87
    v_cmp_eq_u32 vcc, -1, v18
    v_add_f32 v80, v80, v84
    v_add_f32 v81, v81, v85
    v_add_f32 v82, v82, v86
    v_add_f32 v83, v83, v87
    v_add_f32 v88, v88, v80
    v_add_f32 v89, v89, v81
    v_add_f32 v90, v90, v82
    v_add_f32 v91, v91, v83
    v_cvt_pk_bf16_f32 v92, v88, v89
    v_cvt_pk_bf16_f32 v93, v90, v91
    v_min_u32 v93, 0xfffffffe, v93
    s_cbranch_vccnz .pr_152
    buffer_store_dwordx2 v[92:93], v14, s[8:11], s31 offen sc1
    s_mov_b32 s4, s30
    s_mov_b32 s30, s31
    s_mov_b32 s31, s32
    s_mov_b32 s32, s33
    s_mov_b32 s33, s4
    s_add_u32 s28, s28, 1
    s_mov_b32 s62, 0
    s_mov_b32 s4, s34
    s_mov_b32 s34, s35
    s_mov_b32 s35, s36
    s_mov_b32 s36, s37
    s_mov_b32 s37, s4
    s_branch .step_133
.fin_134:
    s_endpgm
.gs_135:
    buffer_load_dwordx4 v[24:27], v3, s[8:11], s30 offen offset:0 sc1
    buffer_load_dwordx4 v[28:31], v3, s[8:11], s30 offen offset:1024 sc1
    buffer_load_dwordx4 v[32:35], v3, s[8:11], s30 offen offset:2048 sc1
    buffer_load_dwordx4 v[36:39], v3, s[8:11], s30 offen offset:3072 sc1
    s_add_u32 s62, s62, 1
    s_cmp_gt_u32 s62, 0x100000
    s_cbranch_scc1 .mg_end_1
    s_waitcnt vmcnt(3)
    v_max_u32 v18, v25, v27
    v_cmp_eq_u32 vcc, -1, v18
    s_cbranch_vccz .gr_136
    s_branch .gs_135
.gs_137:
    buffer_load_dwordx4 v[28:31], v3, s[8:11], s30 offen offset:1024 sc1
    buffer_load_dwordx4 v[32:35], v3, s[8:11], s30 offen offset:2048 sc1
    buffer_load_dwordx4 v[36:39], v3, s[8:11], s30 offen offset:3072 sc1
    s_add_u32 s62, s62, 1
    s_cmp_gt_u32 s62, 0x100000
    s_cbranch_scc1 .mg_end_1
    s_waitcnt vmcnt(2)
    v_max_u32 v18, v29, v31
    v_cmp_eq_u32 vcc, -1, v18
    s_cbranch_vccz .gr_138
    s_branch .gs_137
.gs_139:
    buffer_load_dwordx4 v[32:35], v3, s[8:11], s30 offen offset:2048 sc1
    buffer_load_dwordx4 v[36:39], v3, s[8:11], s30 offen offset:3072 sc1
    s_add_u32 s62, s62, 1
    s_cmp_gt_u32 s62, 0x100000
    s_cbranch_scc1 .mg_end_1
    s_waitcnt vmcnt(1)
    v_max_u32 v18, v33, v35
    v_cmp_eq_u32 vcc, -1, v18
    s_cbranch_vccz .gr_140
    s_branch .gs_139
.gs_141:
    buffer_load_dwordx4 v[36:39], v3, s[8:11], s30 offen offset:3072 sc1
    s_add_u32 s62, s62, 1
    s_cmp_gt_u32 s62, 0x100000
    s_cbranch_scc1 .mg_end_1
    s_waitcnt vmcnt(0)
    v_max_u32 v18, v37, v39
    v_cmp_eq_u32 vcc, -1, v18
    s_cbranch_vccz .gr_142
    s_branch .gs_141
.gs_143:
    buffer_load_dwordx4 v[24:27], v4, s[8:11], s30 offen offset:0 sc1
    buffer_load_dwordx4 v[28:31], v4, s[8:11], s30 offen offset:1024 sc1
    buffer_load_dwordx4 v[32:35], v4, s[8:11], s30 offen offset:2048 sc1
    buffer_load_dwordx4 v[36:39], v4, s[8:11], s30 offen offset:3072 sc1
    s_add_u32 s62, s62, 1
    s_cmp_gt_u32 s62, 0x100000
    s_cbranch_scc1 .mg_end_1
    s_waitcnt vmcnt(3)
    v_cmp_eq_u32 vcc, -1, v27
    s_cbranch_vccz .gr_144
    s_branch .gs_143
.gs_145:
    buffer_load_dwordx4 v[28:31], v4, s[8:11], s30 offen offset:1024 sc1
    buffer_load_dwordx4 v[32:35], v4, s[8:11], s30 offen offset:2048 sc1
    buffer_load_dwordx4 v[36:39], v4, s[8:11], s30 offen offset:3072 sc1
    s_add_u32 s62, s62, 1
    s_cmp_gt_u32 s62, 0x100000
    s_cbranch_scc1 .mg_end_1
    s_waitcnt vmcnt(2)
    v_cmp_eq_u32 vcc, -1, v31
    s_cbranch_vccz .gr_146
    s_branch .gs_145
.gs_147:
    buffer_load_dwordx4 v[32:35], v4, s[8:11], s30 offen offset:2048 sc1
    buffer_load_dwordx4 v[36:39], v4, s[8:11], s30 offen offset:3072 sc1
    s_add_u32 s62, s62, 1
    s_cmp_gt_u32 s62, 0x100000
    s_cbranch_scc1 .mg_end_1
    s_waitcnt vmcnt(1)
    v_cmp_eq_u32 vcc, -1, v35
    s_cbranch_vccz .gr_148
    s_branch .gs_147
.gs_149:
    buffer_load_dwordx4 v[36:39], v4, s[8:11], s30 offen offset:3072 sc1
    s_add_u32 s62, s62, 1
    s_cmp_gt_u32 s62, 0x100000
    s_cbranch_scc1 .mg_end_1
    s_waitcnt vmcnt(0)
    v_cmp_eq_u32 vcc, -1, v39
    s_cbranch_vccz .gr_150
    s_branch .gs_149
.pr_152:
    s_add_u32 s62, s62, 1
    s_cmp_gt_u32 s62, 0x100000
    s_cbranch_scc1 .mg_end_1
    s_branch .pl_151
.w2_109:
    s_lshl_b32 s4, s56, 7
    s_lshl_b32 s5, s53, 2
    s_add_u32 s4, s4, s5
    s_add_u32 s4, s4, 92274688
    v_mov_b32 v14, s4
    v_bfe_u32 v254, v1, 0, 6
    v_mul_u32_u24 v12, 16, v254
    v_add_u32 v12, 17920, v12
    s_mov_b32 exec_hi, 0
    v_xor_b32 v244, 1024, v244
    s_mov_b32 exec_hi, -1
    s_waitcnt vmcnt(0)
    ds_read_b64_tr_b16 a[192:193], v242 offset:16384
    ds_read_b64_tr_b16 a[194:195], v242 offset:16896
    ds_read_b64_tr_b16 a[196:197], v242 offset:18432
    ds_read_b64_tr_b16 a[198:199], v242 offset:18944
    ds_read_b64_tr_b16 a[200:201], v242 offset:20480
    ds_read_b64_tr_b16 a[202:203], v242 offset:20992
    ds_read_b64_tr_b16 a[204:205], v242 offset:22528
    ds_read_b64_tr_b16 a[206:207], v242 offset:23040
    ds_read_b64_tr_b16 a[208:209], v242 offset:24576
    ds_read_b64_tr_b16 a[210:211], v242 offset:25088
    ds_read_b64_tr_b16 a[212:213], v242 offset:26624
    ds_read_b64_tr_b16 a[214:215], v242 offset:27136
    ds_read_b64_tr_b16 a[216:217], v242 offset:28672
    ds_read_b64_tr_b16 a[218:219], v242 offset:29184
    ds_read_b64_tr_b16 a[220:221], v242 offset:30720
    ds_read_b64_tr_b16 a[222:223], v242 offset:31232
    ds_read_b64_tr_b16 a[224:225], v243 offset:16384
    ds_read_b64_tr_b16 a[226:227], v243 offset:16896
    ds_read_b64_tr_b16 a[228:229], v243 offset:18432
    ds_read_b64_tr_b16 a[230:231], v243 offset:18944
    ds_read_b64_tr_b16 a[232:233], v243 offset:20480
    ds_read_b64_tr_b16 a[234:235], v243 offset:20992
    ds_read_b64_tr_b16 a[236:237], v243 offset:22528
    ds_read_b64_tr_b16 a[238:239], v243 offset:23040
    ds_read_b64_tr_b16 a[240:241], v243 offset:24576
    ds_read_b64_tr_b16 a[242:243], v243 offset:25088
    ds_read_b64_tr_b16 a[244:245], v243 offset:26624
    ds_read_b64_tr_b16 a[246:247], v243 offset:27136
    ds_read_b64_tr_b16 a[248:249], v243 offset:28672
    ds_read_b64_tr_b16 a[250:251], v243 offset:29184
    ds_read_b64_tr_b16 a[252:253], v243 offset:30720
    ds_read_b64_tr_b16 a[254:255], v243 offset:31232
    s_waitcnt lgkmcnt(0)
    s_barrier
.p2align 6
.step_153:
    s_barrier
    s_setprio 3
    buffer_load_dwordx4 v[24:27], v3, s[8:11], s30 offen offset:0 sc1
    s_setprio 2
    buffer_load_dwordx4 v[28:31], v3, s[8:11], s30 offen offset:1024 sc1
    s_setprio 1
    buffer_load_dwordx4 v[32:35], v3, s[8:11], s30 offen offset:2048 sc1
    s_setprio 0
    buffer_load_dwordx4 v[36:39], v3, s[8:11], s30 offen offset:3072 sc1
    s_waitcnt vmcnt(3)
    v_max_u32 v18, v25, v27
    v_cmp_eq_u32 vcc, -1, v18
    s_cbranch_vccnz .gs_155
.gr_156:
    v_smfmac_f32_16x16x64_bf16 v[40:43], v[24:27], a[0:7], v2
    v_smfmac_f32_16x16x64_bf16 v[44:47], v[24:27], a[32:39], v2
    s_waitcnt vmcnt(2)
    v_max_u32 v18, v29, v31
    v_cmp_eq_u32 vcc, -1, v18
    v_smfmac_f32_16x16x64_bf16 v[48:51], v[24:27], a[64:71], v2
    s_cbranch_vccnz .gs_157
.gr_158:
    v_smfmac_f32_16x16x64_bf16 v[40:43], v[28:31], a[8:15], v2
    v_smfmac_f32_16x16x64_bf16 v[44:47], v[28:31], a[40:47], v2
    v_smfmac_f32_16x16x64_bf16 v[52:55], v[24:27], a[96:103], v2
    s_waitcnt vmcnt(1)
    v_max_u32 v18, v33, v35
    v_cmp_eq_u32 vcc, -1, v18
    v_smfmac_f32_16x16x64_bf16 v[48:51], v[28:31], a[72:79], v2
    s_cbranch_vccnz .gs_159
.gr_160:
    v_smfmac_f32_16x16x64_bf16 v[40:43], v[32:35], a[16:23], v2
    v_smfmac_f32_16x16x64_bf16 v[44:47], v[32:35], a[48:55], v2
    v_smfmac_f32_16x16x64_bf16 v[52:55], v[28:31], a[104:111], v2
    s_waitcnt vmcnt(0)
    v_max_u32 v18, v37, v39
    v_cmp_eq_u32 vcc, -1, v18
    v_smfmac_f32_16x16x64_bf16 v[48:51], v[32:35], a[80:87], v2
    s_cbranch_vccnz .gs_161
.gr_162:
    v_smfmac_f32_16x16x64_bf16 v[40:43], v[36:39], a[24:31], v2
    v_smfmac_f32_16x16x64_bf16 v[44:47], v[36:39], a[56:63], v2
    v_smfmac_f32_16x16x64_bf16 v[52:55], v[32:35], a[112:119], v2
    v_smfmac_f32_16x16x64_bf16 v[48:51], v[36:39], a[88:95], v2
    v_permlane32_swap_b32 v40, v44
    v_permlane32_swap_b32 v41, v45
    v_smfmac_f32_16x16x64_bf16 v[52:55], v[36:39], a[120:127], v2
    v_permlane32_swap_b32 v42, v46
    v_permlane32_swap_b32 v43, v47
    v_add_f32 v40, v40, v44
    v_add_f32 v41, v41, v45
    v_add_f32 v42, v42, v46
    v_add_f32 v43, v43, v47
    ds_write2_b32 v5, v40, v41 offset0:0 offset1:36
    ds_write2_b32 v5, v42, v43 offset0:72 offset1:108
    v_permlane32_swap_b32 v48, v52
    v_permlane32_swap_b32 v49, v53
    v_permlane32_swap_b32 v50, v54
    v_permlane32_swap_b32 v51, v55
    v_add_f32 v48, v48, v52
    v_add_f32 v49, v49, v53
    v_add_f32 v50, v50, v54
    v_add_f32 v51, v51, v55
    ds_write2_b32 v6, v48, v49 offset0:0 offset1:36
    ds_write2_b32 v6, v50, v51 offset0:72 offset1:108
    s_waitcnt lgkmcnt(2)
    s_barrier
    s_waitcnt lgkmcnt(0)
    s_barrier
    ds_read_b64 v[72:73], v9 offset:0
    ds_read_b64 v[74:75], v9 offset:1152
    ds_read_b64 v[76:77], v9 offset:2304
    ds_read_b64 v[78:79], v9 offset:3456
    s_waitcnt lgkmcnt(2)
    v_add_f32 v72, v72, v74
    v_add_f32 v73, v73, v75
    s_waitcnt lgkmcnt(0)
    v_add_f32 v76, v76, v78
    v_add_f32 v77, v77, v79
    v_add_f32 v72, v72, v76
    v_add_f32 v73, v73, v77
    v_cvt_pk_bf16_f32 v72, v72, v73
    v_min_u32 v72, 0xfffffffe, v72
    buffer_store_dword v72, v10, s[8:11], s30 offen sc1
    v_smfmac_f32_16x16x64_bf16 v[56:59], v[24:27], a[128:135], v2
    v_smfmac_f32_16x16x64_bf16 v[60:63], v[24:27], a[160:167], v2
    v_smfmac_f32_16x16x64_bf16 v[56:59], v[28:31], a[136:143], v2
    v_smfmac_f32_16x16x64_bf16 v[60:63], v[28:31], a[168:175], v2
    v_smfmac_f32_16x16x64_bf16 v[56:59], v[32:35], a[144:151], v2
    v_smfmac_f32_16x16x64_bf16 v[60:63], v[32:35], a[176:183], v2
    v_smfmac_f32_16x16x64_bf16 v[56:59], v[36:39], a[152:159], v2
    v_smfmac_f32_16x16x64_bf16 v[60:63], v[36:39], a[184:191], v2
    ds_write_b32 v11, v72
    v_mov_b32 v40, 0
    v_mov_b32 v41, 0
    v_mov_b32 v42, 0
    v_mov_b32 v43, 0
    v_mov_b32 v44, 0
    v_mov_b32 v45, 0
    v_mov_b32 v46, 0
    v_mov_b32 v47, 0
    v_permlane32_swap_b32 v56, v60
    v_permlane32_swap_b32 v57, v61
    v_permlane32_swap_b32 v58, v62
    v_permlane32_swap_b32 v59, v63
    v_add_f32 v56, v56, v60
    v_add_f32 v57, v57, v61
    v_add_f32 v58, v58, v62
    v_add_f32 v59, v59, v63
    ds_write_b128 v8, v[56:59]
    s_waitcnt lgkmcnt(0)
    s_barrier
    s_barrier
    ds_read_b128 v[72:75], v12
    s_cmp_eq_u32 s28, 63
    s_cbranch_scc1 .fin_154
    s_waitcnt lgkmcnt(0)
    buffer_store_dwordx4 v[72:75], v244, s[8:11], s41 offen sc1
    v_mov_b32 v48, 0
    v_mov_b32 v49, 0
    v_mov_b32 v50, 0
    v_mov_b32 v51, 0
    v_mov_b32 v52, 0
    v_mov_b32 v53, 0
    v_mov_b32 v54, 0
    v_mov_b32 v55, 0
    v_mov_b32 v56, 0
    v_mov_b32 v57, 0
    v_mov_b32 v58, 0
    v_mov_b32 v59, 0
    v_mov_b32 v60, 0
    v_mov_b32 v61, 0
    v_mov_b32 v62, 0
    v_mov_b32 v63, 0
    s_barrier
    s_setprio 3
    buffer_load_dwordx4 v[24:27], v4, s[8:11], s30 offen offset:0 sc1
    s_setprio 2
    buffer_load_dwordx4 v[28:31], v4, s[8:11], s30 offen offset:1024 sc1
    s_setprio 1
    buffer_load_dwordx4 v[32:35], v4, s[8:11], s30 offen offset:2048 sc1
    s_setprio 0
    buffer_load_dwordx4 v[36:39], v4, s[8:11], s30 offen offset:3072 sc1
    s_waitcnt vmcnt(3)
    v_cmp_eq_u32 vcc, -1, v27
    s_cbranch_vccnz .gs_163
.gr_164:
    v_smfmac_f32_16x16x64_bf16 v[64:67], v[24:27], a[192:199], v2
    v_smfmac_f32_16x16x64_bf16 v[68:71], v[24:27], a[224:231], v2
    s_waitcnt vmcnt(2)
    v_cmp_eq_u32 vcc, -1, v31
    s_cbranch_vccnz .gs_165
.gr_166:
    v_smfmac_f32_16x16x64_bf16 v[64:67], v[28:31], a[200:207], v2
    v_smfmac_f32_16x16x64_bf16 v[68:71], v[28:31], a[232:239], v2
    s_waitcnt vmcnt(1)
    v_cmp_eq_u32 vcc, -1, v35
    s_cbranch_vccnz .gs_167
.gr_168:
    v_smfmac_f32_16x16x64_bf16 v[64:67], v[32:35], a[208:215], v2
    v_smfmac_f32_16x16x64_bf16 v[68:71], v[32:35], a[240:247], v2
    s_waitcnt vmcnt(0)
    v_cmp_eq_u32 vcc, -1, v39
    s_cbranch_vccnz .gs_169
.gr_170:
    v_smfmac_f32_16x16x64_bf16 v[64:67], v[36:39], a[216:223], v2
    v_smfmac_f32_16x16x64_bf16 v[68:71], v[36:39], a[248:255], v2
    s_nop 7
    v_permlane32_swap_b32 v64, v68
    v_permlane32_swap_b32 v65, v69
    v_permlane32_swap_b32 v66, v70
    v_permlane32_swap_b32 v67, v71
    v_add_f32 v64, v64, v68
    v_add_f32 v65, v65, v69
    v_add_f32 v66, v66, v70
    v_add_f32 v67, v67, v71
    ds_write2_b32 v7, v64, v65 offset0:0 offset1:36
    ds_write2_b32 v7, v66, v67 offset0:72 offset1:108
    s_waitcnt lgkmcnt(0)
    s_barrier
    v_mov_b32 v18, s28
    v_add_u32 v18, 1, v18
    s_mov_b64 exec, 1
    buffer_store_dword v18, v14, s[8:11], 0 offen sc1
    s_mov_b64 exec, -1
    v_mov_b32 v64, 0
    v_mov_b32 v65, 0
    v_mov_b32 v66, 0
    v_mov_b32 v67, 0
    v_mov_b32 v68, 0
    v_mov_b32 v69, 0
    v_mov_b32 v70, 0
    v_mov_b32 v71, 0
    s_mov_b32 s4, s30
    s_mov_b32 s30, s31
    s_mov_b32 s31, s32
    s_mov_b32 s32, s33
    s_mov_b32 s33, s4
    s_add_u32 s28, s28, 1
    s_mov_b32 s62, 0
    s_add_u32 s41, s41, 0x20000
    s_branch .step_153
.fin_154:
    s_waitcnt lgkmcnt(0)
    buffer_store_dwordx4 v[72:75], v244, s[8:11], s41 offen sc1
    s_waitcnt vmcnt(0)
    v_mov_b32 v18, 64
    s_mov_b64 exec, 1
    buffer_store_dword v18, v14, s[8:11], 0 offen sc1
    s_mov_b64 exec, -1
    s_endpgm
.gs_155:
    buffer_load_dwordx4 v[24:27], v3, s[8:11], s30 offen offset:0 sc1
    buffer_load_dwordx4 v[28:31], v3, s[8:11], s30 offen offset:1024 sc1
    buffer_load_dwordx4 v[32:35], v3, s[8:11], s30 offen offset:2048 sc1
    buffer_load_dwordx4 v[36:39], v3, s[8:11], s30 offen offset:3072 sc1
    s_add_u32 s62, s62, 1
    s_cmp_gt_u32 s62, 0x100000
    s_cbranch_scc1 .mg_end_1
    s_waitcnt vmcnt(3)
    v_max_u32 v18, v25, v27
    v_cmp_eq_u32 vcc, -1, v18
    s_cbranch_vccz .gr_156
    s_branch .gs_155
.gs_157:
    buffer_load_dwordx4 v[28:31], v3, s[8:11], s30 offen offset:1024 sc1
    buffer_load_dwordx4 v[32:35], v3, s[8:11], s30 offen offset:2048 sc1
    buffer_load_dwordx4 v[36:39], v3, s[8:11], s30 offen offset:3072 sc1
    s_add_u32 s62, s62, 1
    s_cmp_gt_u32 s62, 0x100000
    s_cbranch_scc1 .mg_end_1
    s_waitcnt vmcnt(2)
    v_max_u32 v18, v29, v31
    v_cmp_eq_u32 vcc, -1, v18
    s_cbranch_vccz .gr_158
    s_branch .gs_157
.gs_159:
    buffer_load_dwordx4 v[32:35], v3, s[8:11], s30 offen offset:2048 sc1
    buffer_load_dwordx4 v[36:39], v3, s[8:11], s30 offen offset:3072 sc1
    s_add_u32 s62, s62, 1
    s_cmp_gt_u32 s62, 0x100000
    s_cbranch_scc1 .mg_end_1
    s_waitcnt vmcnt(1)
    v_max_u32 v18, v33, v35
    v_cmp_eq_u32 vcc, -1, v18
    s_cbranch_vccz .gr_160
    s_branch .gs_159
.gs_161:
    buffer_load_dwordx4 v[36:39], v3, s[8:11], s30 offen offset:3072 sc1
    s_add_u32 s62, s62, 1
    s_cmp_gt_u32 s62, 0x100000
    s_cbranch_scc1 .mg_end_1
    s_waitcnt vmcnt(0)
    v_max_u32 v18, v37, v39
    v_cmp_eq_u32 vcc, -1, v18
    s_cbranch_vccz .gr_162
    s_branch .gs_161
.gs_163:
    buffer_load_dwordx4 v[24:27], v4, s[8:11], s30 offen offset:0 sc1
    buffer_load_dwordx4 v[28:31], v4, s[8:11], s30 offen offset:1024 sc1
    buffer_load_dwordx4 v[32:35], v4, s[8:11], s30 offen offset:2048 sc1
    buffer_load_dwordx4 v[36:39], v4, s[8:11], s30 offen offset:3072 sc1
    s_add_u32 s62, s62, 1
    s_cmp_gt_u32 s62, 0x100000
    s_cbranch_scc1 .mg_end_1
    s_waitcnt vmcnt(3)
    v_cmp_eq_u32 vcc, -1, v27
    s_cbranch_vccz .gr_164
    s_branch .gs_163
.gs_165:
    buffer_load_dwordx4 v[28:31], v4, s[8:11], s30 offen offset:1024 sc1
    buffer_load_dwordx4 v[32:35], v4, s[8:11], s30 offen offset:2048 sc1
    buffer_load_dwordx4 v[36:39], v4, s[8:11], s30 offen offset:3072 sc1
    s_add_u32 s62, s62, 1
    s_cmp_gt_u32 s62, 0x100000
    s_cbranch_scc1 .mg_end_1
    s_waitcnt vmcnt(2)
    v_cmp_eq_u32 vcc, -1, v31
    s_cbranch_vccz .gr_166
    s_branch .gs_165
.gs_167:
    buffer_load_dwordx4 v[32:35], v4, s[8:11], s30 offen offset:2048 sc1
    buffer_load_dwordx4 v[36:39], v4, s[8:11], s30 offen offset:3072 sc1
    s_add_u32 s62, s62, 1
    s_cmp_gt_u32 s62, 0x100000
    s_cbranch_scc1 .mg_end_1
    s_waitcnt vmcnt(1)
    v_cmp_eq_u32 vcc, -1, v35
    s_cbranch_vccz .gr_168
    s_branch .gs_167
.gs_169:
    buffer_load_dwordx4 v[36:39], v4, s[8:11], s30 offen offset:3072 sc1
    s_add_u32 s62, s62, 1
    s_cmp_gt_u32 s62, 0x100000
    s_cbranch_scc1 .mg_end_1
    s_waitcnt vmcnt(0)
    v_cmp_eq_u32 vcc, -1, v39
    s_cbranch_vccz .gr_170
    s_branch .gs_169
.w3_110:
    v_bfe_u32 v254, v1, 3, 1
    v_mul_u32_u24 v12, 512, v254
    v_bfe_u32 v254, v1, 5, 1
    v_mul_u32_u24 v254, 256, v254
    v_add_u32 v12, v12, v254
    v_bfe_u32 v254, v1, 2, 1
    v_mul_u32_u24 v254, 128, v254
    v_add_u32 v12, v12, v254
    v_bfe_u32 v254, v1, 0, 2
    v_mul_u32_u24 v254, 16, v254
    v_add_u32 v12, v12, v254
    v_bfe_u32 v254, v1, 4, 1
    v_mul_u32_u24 v254, 8, v254
    v_add_u32 v12, v12, v254
    v_add_u32 v12, 13824, v12
    v_bfe_u32 v254, v1, 2, 2
    v_mul_u32_u24 v14, 128, v254
    v_bfe_u32 v254, v1, 0, 2
    v_mul_u32_u24 v254, 16, v254
    v_add_u32 v14, v14, v254
    v_bfe_u32 v254, v1, 4, 2
    v_mul_u32_u24 v254, 4, v254
    v_add_u32 v14, v14, v254
    v_add_u32 v14, 18432, v14
    v_bfe_u32 v254, v1, 0, 6
    v_mul_u32_u24 v15, 16, v254
    v_add_u32 v15, s101, v15
    s_lshl_b32 s4, s56, 7
    s_add_u32 s4, s4, 92278784
    v_bfe_u32 v254, v1, 0, 2
    v_mul_u32_u24 v13, 4, v254
    v_bfe_u32 v254, v1, 2, 1
    v_mul_u32_u24 v254, 4096, v254
    v_add_u32 v13, v13, v254
    v_add_u32 v13, s4, v13
    s_waitcnt vmcnt(0)
    ds_read_b64_tr_b16 a[192:193], v242 offset:16384
    ds_read_b64_tr_b16 a[194:195], v242 offset:16896
    ds_read_b64_tr_b16 a[196:197], v242 offset:18432
    ds_read_b64_tr_b16 a[198:199], v242 offset:18944
    ds_read_b64_tr_b16 a[200:201], v242 offset:20480
    ds_read_b64_tr_b16 a[202:203], v242 offset:20992
    ds_read_b64_tr_b16 a[204:205], v242 offset:22528
    ds_read_b64_tr_b16 a[206:207], v242 offset:23040
    ds_read_b64_tr_b16 a[208:209], v242 offset:24576
    ds_read_b64_tr_b16 a[210:211], v242 offset:25088
    ds_read_b64_tr_b16 a[212:213], v242 offset:26624
    ds_read_b64_tr_b16 a[214:215], v242 offset:27136
    ds_read_b64_tr_b16 a[216:217], v242 offset:28672
    ds_read_b64_tr_b16 a[218:219], v242 offset:29184
    ds_read_b64_tr_b16 a[220:221], v242 offset:30720
    ds_read_b64_tr_b16 a[222:223], v242 offset:31232
    ds_read_b64_tr_b16 a[224:225], v243 offset:16384
    ds_read_b64_tr_b16 a[226:227], v243 offset:16896
    ds_read_b64_tr_b16 a[228:229], v243 offset:18432
    ds_read_b64_tr_b16 a[230:231], v243 offset:18944
    ds_read_b64_tr_b16 a[232:233], v243 offset:20480
    ds_read_b64_tr_b16 a[234:235], v243 offset:20992
    ds_read_b64_tr_b16 a[236:237], v243 offset:22528
    ds_read_b64_tr_b16 a[238:239], v243 offset:23040
    ds_read_b64_tr_b16 a[240:241], v243 offset:24576
    ds_read_b64_tr_b16 a[242:243], v243 offset:25088
    ds_read_b64_tr_b16 a[244:245], v243 offset:26624
    ds_read_b64_tr_b16 a[246:247], v243 offset:27136
    ds_read_b64_tr_b16 a[248:249], v243 offset:28672
    ds_read_b64_tr_b16 a[250:251], v243 offset:29184
    ds_read_b64_tr_b16 a[252:253], v243 offset:30720
    ds_read_b64_tr_b16 a[254:255], v243 offset:31232
    s_waitcnt lgkmcnt(0)
    s_cmp_ge_u32 s46, 1
    s_cbranch_scc1 .kvd_172
    s_mov_b32 s62, 0
.kv_171:
    buffer_load_dword v18, v13, s[8:11], 0 offen sc1
    s_add_u32 s62, s62, 1
    s_cmp_gt_u32 s62, 0x100000
    s_cbranch_scc1 .mg_end_1
    s_waitcnt vmcnt(0)
    v_min_u32_dpp v18, v18, v18 quad_perm:[1,0,3,2] row_mask:0xf bank_mask:0xf
    s_nop 1
    v_min_u32_dpp v18, v18, v18 quad_perm:[2,3,0,1] row_mask:0xf bank_mask:0xf
    s_nop 1
    v_min_u32_dpp v18, v18, v18 row_half_mirror row_mask:0xf bank_mask:0xf
    s_nop 0
    v_readfirstlane_b32 s46, v18
    s_cmp_lt_u32 s46, 1
    s_cbranch_scc1 .kv_171
.kvd_172:
    s_barrier
.p2align 6
.step_173:
    s_barrier
    s_setprio 3
    buffer_load_dwordx4 v[24:27], v3, s[8:11], s30 offen offset:0 sc1
    s_setprio 2
    buffer_load_dwordx4 v[28:31], v3, s[8:11], s30 offen offset:1024 sc1
    s_setprio 1
    buffer_load_dwordx4 v[32:35], v3, s[8:11], s30 offen offset:2048 sc1
    s_setprio 0
    buffer_load_dwordx4 v[36:39], v3, s[8:11], s30 offen offset:3072 sc1
    s_waitcnt vmcnt(3)
    v_max_u32 v18, v25, v27
    v_cmp_eq_u32 vcc, -1, v18
    s_cbranch_vccnz .gs_175
.gr_176:
    v_smfmac_f32_16x16x64_bf16 v[40:43], v[24:27], a[0:7], v2
    v_smfmac_f32_16x16x64_bf16 v[44:47], v[24:27], a[32:39], v2
    s_waitcnt vmcnt(2)
    v_max_u32 v18, v29, v31
    v_cmp_eq_u32 vcc, -1, v18
    v_smfmac_f32_16x16x64_bf16 v[48:51], v[24:27], a[64:71], v2
    s_cbranch_vccnz .gs_177
.gr_178:
    v_smfmac_f32_16x16x64_bf16 v[40:43], v[28:31], a[8:15], v2
    v_smfmac_f32_16x16x64_bf16 v[44:47], v[28:31], a[40:47], v2
    v_smfmac_f32_16x16x64_bf16 v[52:55], v[24:27], a[96:103], v2
    s_waitcnt vmcnt(1)
    v_max_u32 v18, v33, v35
    v_cmp_eq_u32 vcc, -1, v18
    v_smfmac_f32_16x16x64_bf16 v[48:51], v[28:31], a[72:79], v2
    s_cbranch_vccnz .gs_179
.gr_180:
    v_smfmac_f32_16x16x64_bf16 v[40:43], v[32:35], a[16:23], v2
    v_smfmac_f32_16x16x64_bf16 v[44:47], v[32:35], a[48:55], v2
    v_smfmac_f32_16x16x64_bf16 v[52:55], v[28:31], a[104:111], v2
    s_waitcnt vmcnt(0)
    v_max_u32 v18, v37, v39
    v_cmp_eq_u32 vcc, -1, v18
    v_smfmac_f32_16x16x64_bf16 v[48:51], v[32:35], a[80:87], v2
    s_cbranch_vccnz .gs_181
.gr_182:
    v_smfmac_f32_16x16x64_bf16 v[40:43], v[36:39], a[24:31], v2
    v_smfmac_f32_16x16x64_bf16 v[44:47], v[36:39], a[56:63], v2
    v_smfmac_f32_16x16x64_bf16 v[52:55], v[32:35], a[112:119], v2
    v_smfmac_f32_16x16x64_bf16 v[48:51], v[36:39], a[88:95], v2
    v_permlane32_swap_b32 v40, v44
    v_permlane32_swap_b32 v41, v45
    v_smfmac_f32_16x16x64_bf16 v[52:55], v[36:39], a[120:127], v2
    v_permlane32_swap_b32 v42, v46
    v_permlane32_swap_b32 v43, v47
    v_add_f32 v40, v40, v44
    v_add_f32 v41, v41, v45
    v_add_f32 v42, v42, v46
    v_add_f32 v43, v43, v47
    ds_write2_b32 v5, v40, v41 offset0:0 offset1:36
    ds_write2_b32 v5, v42, v43 offset0:72 offset1:108
    v_permlane32_swap_b32 v48, v52
    v_permlane32_swap_b32 v49, v53
    v_permlane32_swap_b32 v50, v54
    v_permlane32_swap_b32 v51, v55
    v_add_f32 v48, v48, v52
    v_add_f32 v49, v49, v53
    v_add_f32 v50, v50, v54
    v_add_f32 v51, v51, v55
    ds_write2_b32 v6, v48, v49 offset0:0 offset1:36
    ds_write2_b32 v6, v50, v51 offset0:72 offset1:108
    s_waitcnt lgkmcnt(2)
    s_barrier
    s_waitcnt lgkmcnt(0)
    s_barrier
    ds_read_b64 v[72:73], v9 offset:0
    ds_read_b64 v[74:75], v9 offset:1152
    ds_read_b64 v[76:77], v9 offset:2304
    ds_read_b64 v[78:79], v9 offset:3456
    s_waitcnt lgkmcnt(2)
    v_add_f32 v72, v72, v74
    v_add_f32 v73, v73, v75
    s_waitcnt lgkmcnt(0)
    v_add_f32 v76, v76, v78
    v_add_f32 v77, v77, v79
    v_add_f32 v72, v72, v76
    v_add_f32 v73, v73, v77
    v_cvt_pk_bf16_f32 v72, v72, v73
    v_min_u32 v72, 0xfffffffe, v72
    buffer_store_dword v72, v10, s[8:11], s30 offen sc1
    v_smfmac_f32_16x16x64_bf16 v[56:59], v[24:27], a[128:135], v2
    v_smfmac_f32_16x16x64_bf16 v[60:63], v[24:27], a[160:167], v2
    v_smfmac_f32_16x16x64_bf16 v[56:59], v[28:31], a[136:143], v2
    v_smfmac_f32_16x16x64_bf16 v[60:63], v[28:31], a[168:175], v2
    v_smfmac_f32_16x16x64_bf16 v[56:59], v[32:35], a[144:151], v2
    v_smfmac_f32_16x16x64_bf16 v[60:63], v[32:35], a[176:183], v2
    v_smfmac_f32_16x16x64_bf16 v[56:59], v[36:39], a[152:159], v2
    v_smfmac_f32_16x16x64_bf16 v[60:63], v[36:39], a[184:191], v2
    ds_write_b32 v11, v72
    v_mov_b32 v40, 0
    v_mov_b32 v41, 0
    v_mov_b32 v42, 0
    v_mov_b32 v43, 0
    v_mov_b32 v44, 0
    v_mov_b32 v45, 0
    v_mov_b32 v46, 0
    v_mov_b32 v47, 0
    v_permlane32_swap_b32 v56, v60
    v_permlane32_swap_b32 v57, v61
    v_permlane32_swap_b32 v58, v62
    v_permlane32_swap_b32 v59, v63
    v_add_f32 v56, v56, v60
    v_add_f32 v57, v57, v61
    v_add_f32 v58, v58, v62
    v_add_f32 v59, v59, v63
    ds_write_b128 v8, v[56:59]
    s_waitcnt lgkmcnt(0)
    s_barrier
    ds_read_b64 v[72:73], v12 offset:0
    ds_read_b64 v[74:75], v12 offset:1024
    ds_read_b64 v[76:77], v12 offset:2048
    ds_read_b64 v[78:79], v12 offset:3072
    ds_read_b64 v[80:81], v12 offset:64
    ds_read_b64 v[82:83], v12 offset:1088
    ds_read_b64 v[84:85], v12 offset:2112
    ds_read_b64 v[86:87], v12 offset:3136
    s_waitcnt lgkmcnt(4)
    v_add_f32 v72, v72, v74
    v_add_f32 v73, v73, v75
    v_add_f32 v76, v76, v78
    v_add_f32 v77, v77, v79
    v_add_f32 v72, v72, v76
    v_add_f32 v73, v73, v77
    v_cvt_pk_bf16_f32 v72, v72, v73
    s_waitcnt lgkmcnt(0)
    v_add_f32 v80, v80, v82
    v_add_f32 v81, v81, v83
    v_add_f32 v84, v84, v86
    v_add_f32 v85, v85, v87
    v_add_f32 v80, v80, v84
    v_add_f32 v81, v81, v85
    v_cvt_pk_bf16_f32 v80, v80, v81
    ds_write_b32 v14, v72
    ds_write_b32 v14, v80 offset:64
    s_waitcnt lgkmcnt(0)
    s_barrier
    s_cmp_eq_u32 s28, 63
    s_cbranch_scc1 .fin_174
    s_add_u32 s5, s28, 2
    s_cmp_ge_u32 s46, s5
    s_cbranch_scc1 .kvd_184
    s_mov_b32 s62, 0
.kv_183:
    buffer_load_dword v18, v13, s[8:11], 0 offen sc1
    s_add_u32 s62, s62, 1
    s_cmp_gt_u32 s62, 0x100000
    s_cbranch_scc1 .mg_end_1
    s_waitcnt vmcnt(0)
    v_min_u32_dpp v18, v18, v18 quad_perm:[1,0,3,2] row_mask:0xf bank_mask:0xf
    s_nop 1
    v_min_u32_dpp v18, v18, v18 quad_perm:[2,3,0,1] row_mask:0xf bank_mask:0xf
    s_nop 1
    v_min_u32_dpp v18, v18, v18 row_half_mirror row_mask:0xf bank_mask:0xf
    s_nop 0
    v_readfirstlane_b32 s46, v18
    s_cmp_lt_u32 s46, s5
    s_cbranch_scc1 .kv_183
.kvd_184:
    v_mov_b32 v48, 0
    v_mov_b32 v49, 0
    v_mov_b32 v50, 0
    v_mov_b32 v51, 0
    v_mov_b32 v52, 0
    v_mov_b32 v53, 0
    v_mov_b32 v54, 0
    v_mov_b32 v55, 0
    v_mov_b32 v56, 0
    v_mov_b32 v57, 0
    v_mov_b32 v58, 0
    v_mov_b32 v59, 0
    v_mov_b32 v60, 0
    v_mov_b32 v61, 0
    v_mov_b32 v62, 0
    v_mov_b32 v63, 0
    s_barrier
    s_setprio 3
    buffer_load_dwordx4 v[24:27], v4, s[8:11], s30 offen offset:0 sc1
    s_setprio 2
    buffer_load_dwordx4 v[28:31], v4, s[8:11], s30 offen offset:1024 sc1
    s_setprio 1
    buffer_load_dwordx4 v[32:35], v4, s[8:11], s30 offen offset:2048 sc1
    s_setprio 0
    buffer_load_dwordx4 v[36:39], v4, s[8:11], s30 offen offset:3072 sc1
    s_waitcnt vmcnt(3)
    v_cmp_eq_u32 vcc, -1, v27
    s_cbranch_vccnz .gs_185
.gr_186:
    v_smfmac_f32_16x16x64_bf16 v[64:67], v[24:27], a[192:199], v2
    v_smfmac_f32_16x16x64_bf16 v[68:71], v[24:27], a[224:231], v2
    s_waitcnt vmcnt(2)
    v_cmp_eq_u32 vcc, -1, v31
    s_cbranch_vccnz .gs_187
.gr_188:
    v_smfmac_f32_16x16x64_bf16 v[64:67], v[28:31], a[200:207], v2
    v_smfmac_f32_16x16x64_bf16 v[68:71], v[28:31], a[232:239], v2
    s_waitcnt vmcnt(1)
    v_cmp_eq_u32 vcc, -1, v35
    s_cbranch_vccnz .gs_189
.gr_190:
    v_smfmac_f32_16x16x64_bf16 v[64:67], v[32:35], a[208:215], v2
    v_smfmac_f32_16x16x64_bf16 v[68:71], v[32:35], a[240:247], v2
    s_waitcnt vmcnt(0)
    v_cmp_eq_u32 vcc, -1, v39
    s_cbranch_vccnz .gs_191
.gr_192:
    v_smfmac_f32_16x16x64_bf16 v[64:67], v[36:39], a[216:223], v2
    v_smfmac_f32_16x16x64_bf16 v[68:71], v[36:39], a[248:255], v2
    s_nop 7
    v_permlane32_swap_b32 v64, v68
    v_permlane32_swap_b32 v65, v69
    v_permlane32_swap_b32 v66, v70
    v_permlane32_swap_b32 v67, v71
    v_add_f32 v64, v64, v68
    v_add_f32 v65, v65, v69
    v_add_f32 v66, v66, v70
    v_add_f32 v67, v67, v71
    ds_write2_b32 v7, v64, v65 offset0:0 offset1:36
    ds_write2_b32 v7, v66, v67 offset0:72 offset1:108
    s_waitcnt lgkmcnt(0)
    s_barrier
    buffer_store_dwordx4 v[20:23], v15, s[8:11], s36 offen sc1
    buffer_store_dwordx4 v[20:23], v244, s[8:11], s32 offen sc1
    buffer_store_dwordx4 v[20:23], v245, s[8:11], s32 offen sc1
    s_add_u32 s5, s28, 3
    s_min_u32 s5, s5, 64
    s_cmp_ge_u32 s46, s5
    s_cbranch_scc1 .kvd_194
    s_mov_b32 s62, 0
.kv_193:
    buffer_load_dword v18, v13, s[8:11], 0 offen sc1
    s_add_u32 s62, s62, 1
    s_cmp_gt_u32 s62, 0x100000
    s_cbranch_scc1 .mg_end_1
    s_waitcnt vmcnt(0)
    v_min_u32_dpp v18, v18, v18 quad_perm:[1,0,3,2] row_mask:0xf bank_mask:0xf
    s_nop 1
    v_min_u32_dpp v18, v18, v18 quad_perm:[2,3,0,1] row_mask:0xf bank_mask:0xf
    s_nop 1
    v_min_u32_dpp v18, v18, v18 row_half_mirror row_mask:0xf bank_mask:0xf
    s_nop 0
    v_readfirstlane_b32 s46, v18
.kvd_194:
    v_mov_b32 v64, 0
    v_mov_b32 v65, 0
    v_mov_b32 v66, 0
    v_mov_b32 v67, 0
    v_mov_b32 v68, 0
    v_mov_b32 v69, 0
    v_mov_b32 v70, 0
    v_mov_b32 v71, 0
    s_mov_b32 s4, s30
    s_mov_b32 s30, s31
    s_mov_b32 s31, s32
    s_mov_b32 s32, s33
    s_mov_b32 s33, s4
    s_add_u32 s28, s28, 1
    s_mov_b32 s62, 0
    s_mov_b32 s4, s34
    s_mov_b32 s34, s35
    s_mov_b32 s35, s36
    s_mov_b32 s36, s37
    s_mov_b32 s37, s4
    s_add_u32 s41, s41, 0x20000
    s_branch .step_173
.fin_174:
    s_endpgm
.gs_175:
    buffer_load_dwordx4 v[24:27], v3, s[8:11], s30 offen offset:0 sc1
    buffer_load_dwordx4 v[28:31], v3, s[8:11], s30 offen offset:1024 sc1
    buffer_load_dwordx4 v[32:35], v3, s[8:11], s30 offen offset:2048 sc1
    buffer_load_dwordx4 v[36:39], v3, s[8:11], s30 offen offset:3072 sc1
    s_add_u32 s62, s62, 1
    s_cmp_gt_u32 s62, 0x100000
    s_cbranch_scc1 .mg_end_1
    s_waitcnt vmcnt(3)
    v_max_u32 v18, v25, v27
    v_cmp_eq_u32 vcc, -1, v18
    s_cbranch_vccz .gr_176
    s_branch .gs_175
.gs_177:
    buffer_load_dwordx4 v[28:31], v3, s[8:11], s30 offen offset:1024 sc1
    buffer_load_dwordx4 v[32:35], v3, s[8:11], s30 offen offset:2048 sc1
    buffer_load_dwordx4 v[36:39], v3, s[8:11], s30 offen offset:3072 sc1
    s_add_u32 s62, s62, 1
    s_cmp_gt_u32 s62, 0x100000
    s_cbranch_scc1 .mg_end_1
    s_waitcnt vmcnt(2)
    v_max_u32 v18, v29, v31
    v_cmp_eq_u32 vcc, -1, v18
    s_cbranch_vccz .gr_178
    s_branch .gs_177
.gs_179:
    buffer_load_dwordx4 v[32:35], v3, s[8:11], s30 offen offset:2048 sc1
    buffer_load_dwordx4 v[36:39], v3, s[8:11], s30 offen offset:3072 sc1
    s_add_u32 s62, s62, 1
    s_cmp_gt_u32 s62, 0x100000
    s_cbranch_scc1 .mg_end_1
    s_waitcnt vmcnt(1)
    v_max_u32 v18, v33, v35
    v_cmp_eq_u32 vcc, -1, v18
    s_cbranch_vccz .gr_180
    s_branch .gs_179
.gs_181:
    buffer_load_dwordx4 v[36:39], v3, s[8:11], s30 offen offset:3072 sc1
    s_add_u32 s62, s62, 1
    s_cmp_gt_u32 s62, 0x100000
    s_cbranch_scc1 .mg_end_1
    s_waitcnt vmcnt(0)
    v_max_u32 v18, v37, v39
    v_cmp_eq_u32 vcc, -1, v18
    s_cbranch_vccz .gr_182
    s_branch .gs_181
.gs_185:
    buffer_load_dwordx4 v[24:27], v4, s[8:11], s30 offen offset:0 sc1
    buffer_load_dwordx4 v[28:31], v4, s[8:11], s30 offen offset:1024 sc1
    buffer_load_dwordx4 v[32:35], v4, s[8:11], s30 offen offset:2048 sc1
    buffer_load_dwordx4 v[36:39], v4, s[8:11], s30 offen offset:3072 sc1
    s_add_u32 s62, s62, 1
    s_cmp_gt_u32 s62, 0x100000
    s_cbranch_scc1 .mg_end_1
    s_waitcnt vmcnt(3)
    v_cmp_eq_u32 vcc, -1, v27
    s_cbranch_vccz .gr_186
    s_branch .gs_185
.gs_187:
    buffer_load_dwordx4 v[28:31], v4, s[8:11], s30 offen offset:1024 sc1
    buffer_load_dwordx4 v[32:35], v4, s[8:11], s30 offen offset:2048 sc1
    buffer_load_dwordx4 v[36:39], v4, s[8:11], s30 offen offset:3072 sc1
    s_add_u32 s62, s62, 1
    s_cmp_gt_u32 s62, 0x100000
    s_cbranch_scc1 .mg_end_1
    s_waitcnt vmcnt(2)
    v_cmp_eq_u32 vcc, -1, v31
    s_cbranch_vccz .gr_188
    s_branch .gs_187
.gs_189:
    buffer_load_dwordx4 v[32:35], v4, s[8:11], s30 offen offset:2048 sc1
    buffer_load_dwordx4 v[36:39], v4, s[8:11], s30 offen offset:3072 sc1
    s_add_u32 s62, s62, 1
    s_cmp_gt_u32 s62, 0x100000
    s_cbranch_scc1 .mg_end_1
    s_waitcnt vmcnt(1)
    v_cmp_eq_u32 vcc, -1, v35
    s_cbranch_vccz .gr_190
    s_branch .gs_189
.gs_191:
    buffer_load_dwordx4 v[36:39], v4, s[8:11], s30 offen offset:3072 sc1
    s_add_u32 s62, s62, 1
    s_cmp_gt_u32 s62, 0x100000
    s_cbranch_scc1 .mg_end_1
    s_waitcnt vmcnt(0)
    v_cmp_eq_u32 vcc, -1, v39
    s_cbranch_vccz .gr_192
    s_branch .gs_191
.mg_bg_2:
    s_lshr_b32 s98, s26, 3
    s_add_u32 s98, s98, 1
    s_and_b32 s98, s98, 3
    s_and_b32 s99, s25, 3
    s_lshl_b32 s99, s99, 3
    s_and_b32 s4, s26, 7
    s_add_u32 s99, s99, s4
    s_mov_b32 s96, 0
    v_and_b32 v1, 63, v0
    v_mov_b32 v250, 0
    v_mov_b32 v251, 0
    s_bitcmp0_b32 s26, 4
    s_cbranch_scc1 .qkv_196
    s_bfe_u32 s95, s26, 0x10003
    s_load_dwordx8 s[40:47], s[0:1], 0
    s_load_dwordx4 s[48:51], s[0:1], 32
    s_load_dwordx2 s[52:53], s[0:1], 104
    s_mul_i32 s6, s24, 8320
    s_add_u32 s6, s6, 122880
    s_lshl_b32 s97, s95, 5
    s_add_u32 s97, s97, s99
    s_lshl_b32 s4, s97, 16
    s_lshl_b32 s5, s24, 14
    s_add_u32 s4, s4, s5
    v_lshlrev_b32 v2, 4, v1
    v_bfe_u32 v254, v1, 0, 3
    v_mul_u32_u24 v3, 2048, v254
    v_bfe_u32 v254, v1, 4, 2
    v_mul_u32_u24 v254, 16, v254
    v_add_u32 v3, v3, v254
    v_add_u32 v3, s4, v3
    v_bfe_u32 v254, v1, 4, 2
    v_mul_u32_u24 v4, 16, v254
    v_add_u32 v4, s6, v4
    s_waitcnt lgkmcnt(0)
    s_mov_b32 s12, s40
    s_and_b32 s13, s41, 0xffff
    s_mov_b32 s14, 0x400000
    s_mov_b32 s15, 0x00020000
    s_mov_b32 s16, s42
    s_and_b32 s17, s43, 0xffff
    s_mov_b32 s18, 0x400000
    s_mov_b32 s19, 0x00020000
    s_mov_b32 s28, s44
    s_and_b32 s29, s45, 0xffff
    s_mov_b32 s30, 0x400000
    s_mov_b32 s31, 0x00020000
    s_mov_b32 s32, s46
    s_and_b32 s33, s47, 0xffff
    s_mov_b32 s34, 0x2000
    s_mov_b32 s35, 0x00020000
    s_mov_b32 s36, s48
    s_and_b32 s37, s49, 0xffff
    s_mov_b32 s38, 0x400000
    s_mov_b32 s39, 0x00020000
    s_mov_b32 s56, s52
    s_and_b32 s57, s53, 0xffff
    s_mov_b32 s58, 0x800
    s_mov_b32 s59, 0x00020000
    s_mov_b32 m0, s6
    s_lshl_b32 s60, s97, 4
    buffer_load_dwordx4 v2, s[56:59], 0 offen lds
    buffer_load_dwordx4 v2, s[56:59], 0 offen offset:1024 lds
    s_add_u32 s61, s60, s24
    v_subrev_u32 v5, 4, v2
    buffer_load_dwordx4 a[0:3], v3, s[12:15], 0 offen offset:0
    buffer_load_dwordx4 a[4:7], v3, s[12:15], 0 offen offset:64
    buffer_load_dwordx4 a[8:11], v3, s[12:15], 0 offen offset:128
    buffer_load_dwordx4 a[12:15], v3, s[12:15], 0 offen offset:192
    buffer_load_dwordx4 a[16:19], v3, s[12:15], 0 offen offset:256
    buffer_load_dwordx4 a[20:23], v3, s[12:15], 0 offen offset:320
    buffer_load_dwordx4 a[24:27], v3, s[12:15], 0 offen offset:384
    buffer_load_dwordx4 a[28:31], v3, s[12:15], 0 offen offset:448
    buffer_load_dwordx4 a[32:35], v3, s[12:15], 0 offen offset:512
    buffer_load_dwordx4 a[36:39], v3, s[12:15], 0 offen offset:576
    buffer_load_dwordx4 a[40:43], v3, s[12:15], 0 offen offset:640
    buffer_load_dwordx4 a[44:47], v3, s[12:15], 0 offen offset:704
    buffer_load_dwordx4 a[48:51], v3, s[12:15], 0 offen offset:768
    buffer_load_dwordx4 a[52:55], v3, s[12:15], 0 offen offset:832
    buffer_load_dwordx4 a[56:59], v3, s[12:15], 0 offen offset:896
    buffer_load_dwordx4 a[60:63], v3, s[12:15], 0 offen offset:960
    buffer_load_dwordx4 a[64:67], v3, s[12:15], 0 offen offset:1024
    buffer_load_dwordx4 a[68:71], v3, s[12:15], 0 offen offset:1088
    buffer_load_dwordx4 a[72:75], v3, s[12:15], 0 offen offset:1152
    buffer_load_dwordx4 a[76:79], v3, s[12:15], 0 offen offset:1216
    buffer_load_dwordx4 a[80:83], v3, s[12:15], 0 offen offset:1280
    buffer_load_dwordx4 a[84:87], v3, s[12:15], 0 offen offset:1344
    buffer_load_dwordx4 a[88:91], v3, s[12:15], 0 offen offset:1408
    buffer_load_dwordx4 a[92:95], v3, s[12:15], 0 offen offset:1472
    buffer_load_dwordx4 a[96:99], v3, s[12:15], 0 offen offset:1536
    buffer_load_dwordx4 a[100:103], v3, s[12:15], 0 offen offset:1600
    buffer_load_dwordx4 a[104:107], v3, s[12:15], 0 offen offset:1664
    buffer_load_dwordx4 a[108:111], v3, s[12:15], 0 offen offset:1728
    buffer_load_dwordx4 a[112:115], v3, s[12:15], 0 offen offset:1792
    buffer_load_dwordx4 a[116:119], v3, s[12:15], 0 offen offset:1856
    buffer_load_dwordx4 a[120:123], v3, s[12:15], 0 offen offset:1920
    buffer_load_dwordx4 a[124:127], v3, s[12:15], 0 offen offset:1984
    s_lshl_b32 s4, s24, 19
    s_lshl_b32 s5, s97, 5
    s_add_u32 s4, s4, s5
    v_bfe_u32 v254, v1, 1, 5
    v_mul_u32_u24 v7, 16384, v254
    v_bfe_u32 v254, v1, 0, 1
    v_mul_u32_u24 v254, 16, v254
    v_add_u32 v7, v7, v254
    v_add_u32 v7, s4, v7
    s_waitcnt vmcnt(32)
    ds_read_b128 a[128:131], v4 offset:0
    ds_read_b128 a[132:135], v4 offset:64
    ds_read_b128 a[136:139], v4 offset:128
    ds_read_b128 a[140:143], v4 offset:192
    ds_read_b128 a[144:147], v4 offset:256
    ds_read_b128 a[148:151], v4 offset:320
    ds_read_b128 a[152:155], v4 offset:384
    ds_read_b128 a[156:159], v4 offset:448
    ds_read_b128 a[160:163], v4 offset:512
    ds_read_b128 a[164:167], v4 offset:576
    ds_read_b128 a[168:171], v4 offset:640
    ds_read_b128 a[172:175], v4 offset:704
    ds_read_b128 a[176:179], v4 offset:768
    ds_read_b128 a[180:183], v4 offset:832
    ds_read_b128 a[184:187], v4 offset:896
    ds_read_b128 a[188:191], v4 offset:960
    ds_read_b128 a[192:195], v4 offset:1024
    ds_read_b128 a[196:199], v4 offset:1088
    ds_read_b128 a[200:203], v4 offset:1152
    ds_read_b128 a[204:207], v4 offset:1216
    ds_read_b128 a[208:211], v4 offset:1280
    ds_read_b128 a[212:215], v4 offset:1344
    ds_read_b128 a[216:219], v4 offset:1408
    ds_read_b128 a[220:223], v4 offset:1472
    ds_read_b128 a[224:227], v4 offset:1536
    ds_read_b128 a[228:231], v4 offset:1600
    ds_read_b128 a[232:235], v4 offset:1664
    ds_read_b128 a[236:239], v4 offset:1728
    ds_read_b128 a[240:243], v4 offset:1792
    ds_read_b128 a[244:247], v4 offset:1856
    ds_read_b128 a[248:251], v4 offset:1920
    ds_read_b128 a[252:255], v4 offset:1984
    v_subrev_u32 v8, 6144, v7
    buffer_load_dwordx4 v[32:35], v8, s[16:19], 0 offen
    v_subrev_u32 v8, 4096, v7
    buffer_load_dwordx4 v[36:39], v8, s[16:19], 0 offen
    v_subrev_u32 v8, 2048, v7
    buffer_load_dwordx4 v[40:43], v8, s[16:19], 0 offen
    s_mov_b32 s4, 0
    buffer_load_dwordx4 v[44:47], v7, s[16:19], s4 offen offset:0
    buffer_load_dwordx4 v[76:79], v7, s[28:31], s4 offen offset:0
    buffer_load_dwordx4 v[48:51], v7, s[16:19], s4 offen offset:2048
    buffer_load_dwordx4 v[80:83], v7, s[28:31], s4 offen offset:2048
    s_mov_b32 s4, 4096
    buffer_load_dwordx4 v[52:55], v7, s[16:19], s4 offen offset:0
    buffer_load_dwordx4 v[84:87], v7, s[28:31], s4 offen offset:0
    buffer_load_dwordx4 v[56:59], v7, s[16:19], s4 offen offset:2048
    buffer_load_dwordx4 v[88:91], v7, s[28:31], s4 offen offset:2048
    s_mov_b32 s4, 8192
    buffer_load_dwordx4 v[60:63], v7, s[16:19], s4 offen offset:0
    buffer_load_dwordx4 v[92:95], v7, s[28:31], s4 offen offset:0
    buffer_load_dwordx4 v[64:67], v7, s[16:19], s4 offen offset:2048
    buffer_load_dwordx4 v[96:99], v7, s[28:31], s4 offen offset:2048
    s_mov_b32 s4, 12288
    buffer_load_dwordx4 v[68:71], v7, s[16:19], s4 offen offset:0
    buffer_load_dwordx4 v[100:103], v7, s[28:31], s4 offen offset:0
    buffer_load_dwordx4 v[72:75], v7, s[16:19], s4 offen offset:2048
    buffer_load_dwordx4 v[104:107], v7, s[28:31], s4 offen offset:2048
    v_add_u32 v9, s6, v2
    v_and_b32 v12, 31, v1
    v_lshrrev_b32 v13, 5, v1
    v_lshlrev_b32 v14, 3, v13
    v_sub_u32 v14, v12, v14
    v_add_u32 v15, 10, v14
    v_and_b32 v10, 1, v15
    v_xor_b32 v10, 1, v10
    v_mul_u32_u24 v10, 4160, v10
    v_lshrrev_b32 v15, 1, v15
    v_lshl_add_u32 v10, v15, 2, v10
    v_add_u32 v10, s6, v10
    v_mul_u32_u24 v11, 80, v12
    v_lshl_add_u32 v11, v13, 4, v11
    s_mul_i32 s4, s24, 7680
    s_sub_u32 s4, s4, 2480
    v_add_u32 v11, s4, v11
    v_cmp_eq_u32 vcc, 7, v14
    v_mov_b32 v15, 0xffff
    s_nop 0
    v_cndmask_b32 v24, 0, v15, vcc
    v_cmp_eq_u32 vcc, 6, v14
    v_mov_b32 v15, 0xffff0000
    s_nop 0
    v_cndmask_b32 v24, v24, v15, vcc
    v_cmp_eq_u32 vcc, 5, v14
    v_mov_b32 v15, 0xffff
    s_nop 0
    v_cndmask_b32 v25, 0, v15, vcc
    v_cmp_eq_u32 vcc, 4, v14
    v_mov_b32 v15, 0xffff0000
    s_nop 0
    v_cndmask_b32 v25, v25, v15, vcc
    v_cmp_eq_u32 vcc, 3, v14
    v_mov_b32 v15, 0xffff
    s_nop 0
    v_cndmask_b32 v26, 0, v15, vcc
    v_cmp_eq_u32 vcc, 2, v14
    v_mov_b32 v15, 0xffff0000
    s_nop 0
    v_cndmask_b32 v26, v26, v15, vcc
    v_cmp_eq_u32 vcc, 1, v14
    v_mov_b32 v15, 0xffff
    s_nop 0
    v_cndmask_b32 v27, 0, v15, vcc
    v_cmp_eq_u32 vcc, 0, v14
    v_mov_b32 v15, 0xffff0000
    s_nop 0
    v_cndmask_b32 v27, v27, v15, vcc
    v_cmp_eq_u32 vcc, 23, v14
    v_mov_b32 v15, 0xffff
    s_nop 0
    v_cndmask_b32 v28, 0, v15, vcc
    v_cmp_eq_u32 vcc, 22, v14
    v_mov_b32 v15, 0xffff0000
    s_nop 0
    v_cndmask_b32 v28, v28, v15, vcc
    v_cmp_eq_u32 vcc, 21, v14
    v_mov_b32 v15, 0xffff
    s_nop 0
    v_cndmask_b32 v29, 0, v15, vcc
    v_cmp_eq_u32 vcc, 20, v14
    v_mov_b32 v15, 0xffff0000
    s_nop 0
    v_cndmask_b32 v29, v29, v15, vcc
    v_cmp_eq_u32 vcc, 19, v14
    v_mov_b32 v15, 0xffff
    s_nop 0
    v_cndmask_b32 v30, 0, v15, vcc
    v_cmp_eq_u32 vcc, 18, v14
    v_mov_b32 v15, 0xffff0000
    s_nop 0
    v_cndmask_b32 v30, v30, v15, vcc
    v_cmp_eq_u32 vcc, 17, v14
    v_mov_b32 v15, 0xffff
    s_nop 0
    v_cndmask_b32 v31, 0, v15, vcc
    v_cmp_eq_u32 vcc, 16, v14
    v_mov_b32 v15, 0xffff0000
    s_nop 0
    v_cndmask_b32 v31, v31, v15, vcc
    s_waitcnt lgkmcnt(0)
    s_waitcnt vmcnt(50)
    v_mfma_f32_16x16x32_bf16 v[216:219], a[128:131], a[0:3], 0
    s_waitcnt vmcnt(49)
    v_mfma_f32_16x16x32_bf16 v[216:219], a[132:135], a[4:7], v[216:219]
    s_waitcnt vmcnt(48)
    v_mfma_f32_16x16x32_bf16 v[216:219], a[136:139], a[8:11], v[216:219]
    s_waitcnt vmcnt(47)
    v_mfma_f32_16x16x32_bf16 v[216:219], a[140:143], a[12:15], v[216:219]
    s_waitcnt vmcnt(46)
    v_mfma_f32_16x16x32_bf16 v[216:219], a[144:147], a[16:19], v[216:219]
    s_waitcnt vmcnt(45)
    v_mfma_f32_16x16x32_bf16 v[216:219], a[148:151], a[20:23], v[216:219]
    s_waitcnt vmcnt(44)
    v_mfma_f32_16x16x32_bf16 v[216:219], a[152:155], a[24:27], v[216:219]
    s_waitcnt vmcnt(43)
    v_mfma_f32_16x16x32_bf16 v[216:219], a[156:159], a[28:31], v[216:219]
    s_waitcnt vmcnt(42)
    v_mfma_f32_16x16x32_bf16 v[216:219], a[160:163], a[32:35], v[216:219]
    s_waitcnt vmcnt(41)
    v_mfma_f32_16x16x32_bf16 v[216:219], a[164:167], a[36:39], v[216:219]
    s_waitcnt vmcnt(40)
    v_mfma_f32_16x16x32_bf16 v[216:219], a[168:171], a[40:43], v[216:219]
    s_waitcnt vmcnt(39)
    v_mfma_f32_16x16x32_bf16 v[216:219], a[172:175], a[44:47], v[216:219]
    s_waitcnt vmcnt(38)
    v_mfma_f32_16x16x32_bf16 v[216:219], a[176:179], a[48:51], v[216:219]
    s_waitcnt vmcnt(37)
    v_mfma_f32_16x16x32_bf16 v[216:219], a[180:183], a[52:55], v[216:219]
    s_waitcnt vmcnt(36)
    v_mfma_f32_16x16x32_bf16 v[216:219], a[184:187], a[56:59], v[216:219]
    s_waitcnt vmcnt(35)
    v_mfma_f32_16x16x32_bf16 v[216:219], a[188:191], a[60:63], v[216:219]
    s_waitcnt vmcnt(34)
    v_mfma_f32_16x16x32_bf16 v[216:219], a[192:195], a[64:67], v[216:219]
    s_waitcnt vmcnt(33)
    v_mfma_f32_16x16x32_bf16 v[216:219], a[196:199], a[68:71], v[216:219]
    s_waitcnt vmcnt(32)
    v_mfma_f32_16x16x32_bf16 v[216:219], a[200:203], a[72:75], v[216:219]
    s_waitcnt vmcnt(31)
    v_mfma_f32_16x16x32_bf16 v[216:219], a[204:207], a[76:79], v[216:219]
    s_waitcnt vmcnt(30)
    v_mfma_f32_16x16x32_bf16 v[216:219], a[208:211], a[80:83], v[216:219]
    s_waitcnt vmcnt(29)
    v_mfma_f32_16x16x32_bf16 v[216:219], a[212:215], a[84:87], v[216:219]
    s_waitcnt vmcnt(28)
    v_mfma_f32_16x16x32_bf16 v[216:219], a[216:219], a[88:91], v[216:219]
    s_waitcnt vmcnt(27)
    v_mfma_f32_16x16x32_bf16 v[216:219], a[220:223], a[92:95], v[216:219]
    s_waitcnt vmcnt(26)
    v_mfma_f32_16x16x32_bf16 v[216:219], a[224:227], a[96:99], v[216:219]
    s_waitcnt vmcnt(25)
    v_mfma_f32_16x16x32_bf16 v[216:219], a[228:231], a[100:103], v[216:219]
    s_waitcnt vmcnt(24)
    v_mfma_f32_16x16x32_bf16 v[216:219], a[232:235], a[104:107], v[216:219]
    s_waitcnt vmcnt(23)
    v_mfma_f32_16x16x32_bf16 v[216:219], a[236:239], a[108:111], v[216:219]
    s_waitcnt vmcnt(22)
    v_mfma_f32_16x16x32_bf16 v[216:219], a[240:243], a[112:115], v[216:219]
    s_waitcnt vmcnt(21)
    v_mfma_f32_16x16x32_bf16 v[216:219], a[244:247], a[116:119], v[216:219]
    s_waitcnt vmcnt(20)
    v_mfma_f32_16x16x32_bf16 v[216:219], a[248:251], a[120:123], v[216:219]
    s_waitcnt vmcnt(19)
    v_mfma_f32_16x16x32_bf16 v[216:219], a[252:255], a[124:127], v[216:219]
    v_add_u32 v7, 2097152, v7
    v_subrev_u32 v8, 6144, v7
    buffer_load_dwordx4 v[108:111], v8, s[16:19], 0 offen
    v_subrev_u32 v8, 4096, v7
    buffer_load_dwordx4 v[112:115], v8, s[16:19], 0 offen
    v_subrev_u32 v8, 2048, v7
    buffer_load_dwordx4 v[116:119], v8, s[16:19], 0 offen
    s_mov_b32 s4, 0
    buffer_load_dwordx4 v[120:123], v7, s[16:19], s4 offen offset:0
    buffer_load_dwordx4 v[152:155], v7, s[28:31], s4 offen offset:0
    buffer_load_dwordx4 v[124:127], v7, s[16:19], s4 offen offset:2048
    buffer_load_dwordx4 v[156:159], v7, s[28:31], s4 offen offset:2048
    s_mov_b32 s4, 4096
    buffer_load_dwordx4 v[128:131], v7, s[16:19], s4 offen offset:0
    buffer_load_dwordx4 v[160:163], v7, s[28:31], s4 offen offset:0
    buffer_load_dwordx4 v[132:135], v7, s[16:19], s4 offen offset:2048
    buffer_load_dwordx4 v[164:167], v7, s[28:31], s4 offen offset:2048
    s_mov_b32 s4, 8192
    buffer_load_dwordx4 v[136:139], v7, s[16:19], s4 offen offset:0
    buffer_load_dwordx4 v[168:171], v7, s[28:31], s4 offen offset:0
    buffer_load_dwordx4 v[140:143], v7, s[16:19], s4 offen offset:2048
    buffer_load_dwordx4 v[172:175], v7, s[28:31], s4 offen offset:2048
    s_mov_b32 s4, 12288
    buffer_load_dwordx4 v[144:147], v7, s[16:19], s4 offen offset:0
    buffer_load_dwordx4 v[176:179], v7, s[28:31], s4 offen offset:0
    buffer_load_dwordx4 v[148:151], v7, s[16:19], s4 offen offset:2048
    buffer_load_dwordx4 v[180:183], v7, s[28:31], s4 offen offset:2048
    v_cvt_pk_bf16_f32 v216, v216, v216
    v_lshlrev_b32 v216, 16, v216
    v_mul_f32 v216, 0xbfb8aa3b, v216
    v_exp_f32 v216, v216
    s_lshl_b32 s4, s97, 7
    v_add_f32 v216, 1.0, v216
    v_rcp_f32 v216, v216
    s_lshl_b32 s5, s24, 5
    v_cvt_pk_bf16_f32 v216, v216, v216
    v_lshlrev_b32 v216, 16, v216
    s_add_u32 s4, s4, s5
    s_add_u32 s4, s4, 121634816
    v_lshlrev_b32 v15, 2, v1
    s_mov_b64 exec, 0xff
    buffer_store_dword v216, v15, s[8:11], s4 offen sc1
    s_mov_b64 exec, -1
    v_mov_b32 v220, 0
    v_mov_b32 v221, 0
    v_mov_b32 v222, 0
    v_mov_b32 v223, 0
    s_mul_i32 s4, s24, 7680
    v_add_u32 v15, s4, v2
    ds_write_b128 v15, v[220:223] offset:0
    ds_write_b128 v15, v[220:223] offset:1024
    ds_write_b128 v15, v[220:223] offset:1536
    v_add_u32 v15, 30720, v15
    ds_write_b128 v15, v[220:223] offset:0
    ds_write_b128 v15, v[220:223] offset:1024
    ds_write_b128 v15, v[220:223] offset:1536
    v_add_u32 v15, 30720, v15
    ds_write_b128 v15, v[220:223] offset:0
    ds_write_b128 v15, v[220:223] offset:1024
    ds_write_b128 v15, v[220:223] offset:1536
    v_add_u32 v15, 30720, v15
    ds_write_b128 v15, v[220:223] offset:0
    ds_write_b128 v15, v[220:223] offset:1024
    ds_write_b128 v15, v[220:223] offset:1536
    v_add_u32 v15, 30720, v15
    s_mov_b64 exec, 0xf
    ds_write_b128 v9, v[220:223]
    ds_write_b128 v9, v[220:223] offset:4160
    s_mov_b64 exec, -1
    s_mul_i32 s4, s24, 640
    s_add_u32 s4, s4, 2560
    v_bfe_u32 v254, v1, 0, 1
    v_mul_u32_u24 v12, 61440, v254
    v_bfe_u32 v254, v1, 3, 3
    v_mul_u32_u24 v254, 80, v254
    v_add_u32 v12, v12, v254
    v_bfe_u32 v254, v1, 1, 2
    v_mul_u32_u24 v254, 16, v254
    v_add_u32 v12, v12, v254
    v_add_u32 v12, s4, v12
    s_lshl_b32 s4, s97, 7
    v_bfe_u32 v254, v1, 0, 1
    v_mul_u32_u24 v13, 64, v254
    v_add_u32 v13, s4, v13
    buffer_load_dwordx4 v[216:219], v13, s[32:35], 0 offen offset:0
    buffer_load_dwordx4 v[220:223], v13, s[32:35], 0 offen offset:16
    buffer_load_dwordx4 v[224:227], v13, s[32:35], 0 offen offset:32
    buffer_load_dwordx4 v[228:231], v13, s[32:35], 0 offen offset:48
    v_lshlrev_b32 v239, 2, v1
    buffer_load_dword v238, v239, s[20:23], 0 offen sc1
    s_waitcnt vmcnt(0)
    s_cmp_lg_u32 s27, 0
    s_cbranch_scc1 .vd_201
    s_mov_b32 s62, 0
.vp_200:
    v_readlane_b32 s4, v238, 8
    s_cmp_ge_u32 s4, 256
    s_cbranch_scc1 .va_202
    s_add_u32 s62, s62, 1
    s_cmp_gt_u32 s62, 0x100000
    s_cbranch_scc1 .mg_end_1
    s_sleep 16
    buffer_load_dword v238, v239, s[20:23], 0 offen sc1
    s_waitcnt vmcnt(0)
    s_branch .vp_200
.va_202:
    v_cmp_ne_u32 vcc, 32, v238
    s_and_b32 s4, vcc_lo, 0xff
    s_cbranch_scc0 .vd_201
    s_lshr_b32 s25, s2, 5
    s_and_b32 s26, s2, 31
    s_mov_b32 s27, 1
    s_waitcnt vmcnt(0) lgkmcnt(0)
    s_barrier
    s_branch .mg_role_3
.vd_201:
    v_lshlrev_b32 v184, 16, v216
    v_lshlrev_b32 v185, 16, v218
    v_and_b32 v186, 0xffff0000, v216
    v_and_b32 v187, 0xffff0000, v218
    v_lshlrev_b32 v188, 16, v217
    v_lshlrev_b32 v189, 16, v219
    v_and_b32 v190, 0xffff0000, v217
    v_and_b32 v191, 0xffff0000, v219
    v_lshlrev_b32 v192, 16, v220
    v_lshlrev_b32 v193, 16, v222
    v_and_b32 v194, 0xffff0000, v220
    v_and_b32 v195, 0xffff0000, v222
    v_lshlrev_b32 v196, 16, v221
    v_lshlrev_b32 v197, 16, v223
    v_and_b32 v198, 0xffff0000, v221
    v_and_b32 v199, 0xffff0000, v223
    v_lshlrev_b32 v200, 16, v224
    v_lshlrev_b32 v201, 16, v226
    v_and_b32 v202, 0xffff0000, v224
    v_and_b32 v203, 0xffff0000, v226
    v_lshlrev_b32 v204, 16, v225
    v_lshlrev_b32 v205, 16, v227
    v_and_b32 v206, 0xffff0000, v225
    v_and_b32 v207, 0xffff0000, v227
    v_lshlrev_b32 v208, 16, v228
    v_lshlrev_b32 v209, 16, v230
    v_and_b32 v210, 0xffff0000, v228
    v_and_b32 v211, 0xffff0000, v230
    v_lshlrev_b32 v212, 16, v229
    v_lshlrev_b32 v213, 16, v231
    v_and_b32 v214, 0xffff0000, v229
    v_and_b32 v215, 0xffff0000, v231
    v_lshlrev_b32 v216, 16, v32
    v_and_b32 v217, 0xffff0000, v32
    v_lshlrev_b32 v218, 16, v36
    v_and_b32 v219, 0xffff0000, v36
    v_lshlrev_b32 v220, 16, v40
    v_and_b32 v221, 0xffff0000, v40
    v_lshlrev_b32 v222, 16, v44
    v_and_b32 v223, 0xffff0000, v44
    v_lshlrev_b32 v224, 16, v48
    v_and_b32 v225, 0xffff0000, v48
    v_lshlrev_b32 v226, 16, v52
    v_and_b32 v227, 0xffff0000, v52
    v_lshlrev_b32 v228, 16, v56
    v_and_b32 v229, 0xffff0000, v56
    v_lshlrev_b32 v230, 16, v60
    v_and_b32 v231, 0xffff0000, v60
    v_lshlrev_b32 v232, 16, v64
    v_and_b32 v233, 0xffff0000, v64
    v_lshlrev_b32 v234, 16, v68
    v_and_b32 v235, 0xffff0000, v68
    v_lshlrev_b32 v236, 16, v72
    v_and_b32 v237, 0xffff0000, v72
    v_pk_mul_f32 v[216:217], v[216:217], v[190:191]
    v_lshlrev_b32 v238, 16, v76
    v_pk_fma_f32 v[216:217], v[218:219], v[188:189], v[216:217]
    v_and_b32 v239, 0xffff0000, v76
    v_pk_fma_f32 v[216:217], v[220:221], v[186:187], v[216:217]
    v_pk_fma_f32 v[216:217], v[222:223], v[184:185], v[216:217]
    v_pk_mul_f32 v[216:217], v[216:217], v[238:239]
    v_pk_mul_f32 v[218:219], v[218:219], v[190:191]
    v_lshlrev_b32 v240, 16, v80
    v_pk_fma_f32 v[218:219], v[220:221], v[188:189], v[218:219]
    v_and_b32 v241, 0xffff0000, v80
    v_pk_fma_f32 v[218:219], v[222:223], v[186:187], v[218:219]
    v_pk_fma_f32 v[218:219], v[224:225], v[184:185], v[218:219]
    v_pk_mul_f32 v[218:219], v[218:219], v[240:241]
    v_pk_mul_f32 v[220:221], v[220:221], v[190:191]
    v_lshlrev_b32 v238, 16, v84
    v_pk_fma_f32 v[220:221], v[222:223], v[188:189], v[220:221]
    v_and_b32 v239, 0xffff0000, v84
    v_pk_fma_f32 v[220:221], v[224:225], v[186:187], v[220:221]
    v_pk_fma_f32 v[220:221], v[226:227], v[184:185], v[220:221]
    v_pk_mul_f32 v[220:221], v[220:221], v[238:239]
    v_pk_mul_f32 v[222:223], v[222:223], v[190:191]
    v_lshlrev_b32 v240, 16, v88
    v_pk_fma_f32 v[222:223], v[224:225], v[188:189], v[222:223]
    v_and_b32 v241, 0xffff0000, v88
    v_pk_fma_f32 v[222:223], v[226:227], v[186:187], v[222:223]
    v_pk_fma_f32 v[222:223], v[228:229], v[184:185], v[222:223]
    v_pk_mul_f32 v[222:223], v[222:223], v[240:241]
    v_pk_mul_f32 v[224:225], v[224:225], v[190:191]
    v_lshlrev_b32 v238, 16, v92
    v_pk_fma_f32 v[224:225], v[226:227], v[188:189], v[224:225]
    v_and_b32 v239, 0xffff0000, v92
    v_pk_fma_f32 v[224:225], v[228:229], v[186:187], v[224:225]
    v_pk_fma_f32 v[224:225], v[230:231], v[184:185], v[224:225]
    v_pk_mul_f32 v[224:225], v[224:225], v[238:239]
    v_pk_mul_f32 v[226:227], v[226:227], v[190:191]
    v_lshlrev_b32 v240, 16, v96
    v_pk_fma_f32 v[226:227], v[228:229], v[188:189], v[226:227]
    v_and_b32 v241, 0xffff0000, v96
    v_pk_fma_f32 v[226:227], v[230:231], v[186:187], v[226:227]
    v_pk_fma_f32 v[226:227], v[232:233], v[184:185], v[226:227]
    v_pk_mul_f32 v[226:227], v[226:227], v[240:241]
    v_pk_mul_f32 v[228:229], v[228:229], v[190:191]
    v_lshlrev_b32 v238, 16, v100
    v_pk_fma_f32 v[228:229], v[230:231], v[188:189], v[228:229]
    v_and_b32 v239, 0xffff0000, v100
    v_pk_fma_f32 v[228:229], v[232:233], v[186:187], v[228:229]
    v_pk_fma_f32 v[228:229], v[234:235], v[184:185], v[228:229]
    v_pk_mul_f32 v[228:229], v[228:229], v[238:239]
    v_pk_mul_f32 v[230:231], v[230:231], v[190:191]
    v_lshlrev_b32 v240, 16, v104
    v_pk_fma_f32 v[230:231], v[232:233], v[188:189], v[230:231]
    v_and_b32 v241, 0xffff0000, v104
    v_pk_fma_f32 v[230:231], v[234:235], v[186:187], v[230:231]
    v_pk_fma_f32 v[230:231], v[236:237], v[184:185], v[230:231]
    v_pk_mul_f32 v[230:231], v[230:231], v[240:241]
    v_cvt_pk_bf16_f32 v242, v230, v228
    v_cvt_pk_bf16_f32 v243, v226, v224
    v_cvt_pk_bf16_f32 v244, v222, v220
    v_cvt_pk_bf16_f32 v245, v218, v216
    ds_write_b128 v12, v[242:245] offset:0
    v_cvt_pk_bf16_f32 v246, v231, v229
    v_cvt_pk_bf16_f32 v247, v227, v225
    v_cvt_pk_bf16_f32 v248, v223, v221
    v_cvt_pk_bf16_f32 v249, v219, v217
    ds_write_b128 v12, v[246:249] offset:7680
    v_lshlrev_b32 v216, 16, v33
    v_and_b32 v217, 0xffff0000, v33
    v_lshlrev_b32 v218, 16, v37
    v_and_b32 v219, 0xffff0000, v37
    v_lshlrev_b32 v220, 16, v41
    v_and_b32 v221, 0xffff0000, v41
    v_lshlrev_b32 v222, 16, v45
    v_and_b32 v223, 0xffff0000, v45
    v_lshlrev_b32 v224, 16, v49
    v_and_b32 v225, 0xffff0000, v49
    v_lshlrev_b32 v226, 16, v53
    v_and_b32 v227, 0xffff0000, v53
    v_lshlrev_b32 v228, 16, v57
    v_and_b32 v229, 0xffff0000, v57
    v_lshlrev_b32 v230, 16, v61
    v_and_b32 v231, 0xffff0000, v61
    v_lshlrev_b32 v232, 16, v65
    v_and_b32 v233, 0xffff0000, v65
    v_lshlrev_b32 v234, 16, v69
    v_and_b32 v235, 0xffff0000, v69
    v_lshlrev_b32 v236, 16, v73
    v_and_b32 v237, 0xffff0000, v73
    v_pk_mul_f32 v[216:217], v[216:217], v[198:199]
    v_lshlrev_b32 v238, 16, v77
    v_pk_fma_f32 v[216:217], v[218:219], v[196:197], v[216:217]
    v_and_b32 v239, 0xffff0000, v77
    v_pk_fma_f32 v[216:217], v[220:221], v[194:195], v[216:217]
    v_pk_fma_f32 v[216:217], v[222:223], v[192:193], v[216:217]
    v_pk_mul_f32 v[216:217], v[216:217], v[238:239]
    v_pk_mul_f32 v[218:219], v[218:219], v[198:199]
    v_lshlrev_b32 v240, 16, v81
    v_pk_fma_f32 v[218:219], v[220:221], v[196:197], v[218:219]
    v_and_b32 v241, 0xffff0000, v81
    v_pk_fma_f32 v[218:219], v[222:223], v[194:195], v[218:219]
    v_pk_fma_f32 v[218:219], v[224:225], v[192:193], v[218:219]
    v_pk_mul_f32 v[218:219], v[218:219], v[240:241]
    v_pk_mul_f32 v[220:221], v[220:221], v[198:199]
    v_lshlrev_b32 v238, 16, v85
    v_pk_fma_f32 v[220:221], v[222:223], v[196:197], v[220:221]
    v_and_b32 v239, 0xffff0000, v85
    v_pk_fma_f32 v[220:221], v[224:225], v[194:195], v[220:221]
    v_pk_fma_f32 v[220:221], v[226:227], v[192:193], v[220:221]
    v_pk_mul_f32 v[220:221], v[220:221], v[238:239]
    v_pk_mul_f32 v[222:223], v[222:223], v[198:199]
    v_lshlrev_b32 v240, 16, v89
    v_pk_fma_f32 v[222:223], v[224:225], v[196:197], v[222:223]
    v_and_b32 v241, 0xffff0000, v89
    v_pk_fma_f32 v[222:223], v[226:227], v[194:195], v[222:223]
    v_pk_fma_f32 v[222:223], v[228:229], v[192:193], v[222:223]
    v_pk_mul_f32 v[222:223], v[222:223], v[240:241]
    v_pk_mul_f32 v[224:225], v[224:225], v[198:199]
    v_lshlrev_b32 v238, 16, v93
    v_pk_fma_f32 v[224:225], v[226:227], v[196:197], v[224:225]
    v_and_b32 v239, 0xffff0000, v93
    v_pk_fma_f32 v[224:225], v[228:229], v[194:195], v[224:225]
    v_pk_fma_f32 v[224:225], v[230:231], v[192:193], v[224:225]
    v_pk_mul_f32 v[224:225], v[224:225], v[238:239]
    v_pk_mul_f32 v[226:227], v[226:227], v[198:199]
    v_lshlrev_b32 v240, 16, v97
    v_pk_fma_f32 v[226:227], v[228:229], v[196:197], v[226:227]
    v_and_b32 v241, 0xffff0000, v97
    v_pk_fma_f32 v[226:227], v[230:231], v[194:195], v[226:227]
    v_pk_fma_f32 v[226:227], v[232:233], v[192:193], v[226:227]
    v_pk_mul_f32 v[226:227], v[226:227], v[240:241]
    v_pk_mul_f32 v[228:229], v[228:229], v[198:199]
    v_lshlrev_b32 v238, 16, v101
    v_pk_fma_f32 v[228:229], v[230:231], v[196:197], v[228:229]
    v_and_b32 v239, 0xffff0000, v101
    v_pk_fma_f32 v[228:229], v[232:233], v[194:195], v[228:229]
    v_pk_fma_f32 v[228:229], v[234:235], v[192:193], v[228:229]
    v_pk_mul_f32 v[228:229], v[228:229], v[238:239]
    v_pk_mul_f32 v[230:231], v[230:231], v[198:199]
    v_lshlrev_b32 v240, 16, v105
    v_pk_fma_f32 v[230:231], v[232:233], v[196:197], v[230:231]
    v_and_b32 v241, 0xffff0000, v105
    v_pk_fma_f32 v[230:231], v[234:235], v[194:195], v[230:231]
    v_pk_fma_f32 v[230:231], v[236:237], v[192:193], v[230:231]
    v_pk_mul_f32 v[230:231], v[230:231], v[240:241]
    v_cvt_pk_bf16_f32 v242, v230, v228
    v_cvt_pk_bf16_f32 v243, v226, v224
    v_cvt_pk_bf16_f32 v244, v222, v220
    v_cvt_pk_bf16_f32 v245, v218, v216
    ds_write_b128 v12, v[242:245] offset:15360
    v_cvt_pk_bf16_f32 v246, v231, v229
    v_cvt_pk_bf16_f32 v247, v227, v225
    v_cvt_pk_bf16_f32 v248, v223, v221
    v_cvt_pk_bf16_f32 v249, v219, v217
    ds_write_b128 v12, v[246:249] offset:23040
    v_lshlrev_b32 v216, 16, v34
    v_and_b32 v217, 0xffff0000, v34
    v_lshlrev_b32 v218, 16, v38
    v_and_b32 v219, 0xffff0000, v38
    v_lshlrev_b32 v220, 16, v42
    v_and_b32 v221, 0xffff0000, v42
    v_lshlrev_b32 v222, 16, v46
    v_and_b32 v223, 0xffff0000, v46
    v_lshlrev_b32 v224, 16, v50
    v_and_b32 v225, 0xffff0000, v50
    v_lshlrev_b32 v226, 16, v54
    v_and_b32 v227, 0xffff0000, v54
    v_lshlrev_b32 v228, 16, v58
    v_and_b32 v229, 0xffff0000, v58
    v_lshlrev_b32 v230, 16, v62
    v_and_b32 v231, 0xffff0000, v62
    v_lshlrev_b32 v232, 16, v66
    v_and_b32 v233, 0xffff0000, v66
    v_lshlrev_b32 v234, 16, v70
    v_and_b32 v235, 0xffff0000, v70
    v_lshlrev_b32 v236, 16, v74
    v_and_b32 v237, 0xffff0000, v74
    v_pk_mul_f32 v[216:217], v[216:217], v[206:207]
    v_lshlrev_b32 v238, 16, v78
    v_pk_fma_f32 v[216:217], v[218:219], v[204:205], v[216:217]
    v_and_b32 v239, 0xffff0000, v78
    v_pk_fma_f32 v[216:217], v[220:221], v[202:203], v[216:217]
    v_pk_fma_f32 v[216:217], v[222:223], v[200:201], v[216:217]
    v_pk_mul_f32 v[216:217], v[216:217], v[238:239]
    v_pk_mul_f32 v[218:219], v[218:219], v[206:207]
    v_lshlrev_b32 v240, 16, v82
    v_pk_fma_f32 v[218:219], v[220:221], v[204:205], v[218:219]
    v_and_b32 v241, 0xffff0000, v82
    v_pk_fma_f32 v[218:219], v[222:223], v[202:203], v[218:219]
    v_pk_fma_f32 v[218:219], v[224:225], v[200:201], v[218:219]
    v_pk_mul_f32 v[218:219], v[218:219], v[240:241]
    v_pk_mul_f32 v[220:221], v[220:221], v[206:207]
    v_lshlrev_b32 v238, 16, v86
    v_pk_fma_f32 v[220:221], v[222:223], v[204:205], v[220:221]
    v_and_b32 v239, 0xffff0000, v86
    v_pk_fma_f32 v[220:221], v[224:225], v[202:203], v[220:221]
    v_pk_fma_f32 v[220:221], v[226:227], v[200:201], v[220:221]
    v_pk_mul_f32 v[220:221], v[220:221], v[238:239]
    v_pk_mul_f32 v[222:223], v[222:223], v[206:207]
    v_lshlrev_b32 v240, 16, v90
    v_pk_fma_f32 v[222:223], v[224:225], v[204:205], v[222:223]
    v_and_b32 v241, 0xffff0000, v90
    v_pk_fma_f32 v[222:223], v[226:227], v[202:203], v[222:223]
    v_pk_fma_f32 v[222:223], v[228:229], v[200:201], v[222:223]
    v_pk_mul_f32 v[222:223], v[222:223], v[240:241]
    v_pk_mul_f32 v[224:225], v[224:225], v[206:207]
    v_lshlrev_b32 v238, 16, v94
    v_pk_fma_f32 v[224:225], v[226:227], v[204:205], v[224:225]
    v_and_b32 v239, 0xffff0000, v94
    v_pk_fma_f32 v[224:225], v[228:229], v[202:203], v[224:225]
    v_pk_fma_f32 v[224:225], v[230:231], v[200:201], v[224:225]
    v_pk_mul_f32 v[224:225], v[224:225], v[238:239]
    v_pk_mul_f32 v[226:227], v[226:227], v[206:207]
    v_lshlrev_b32 v240, 16, v98
    v_pk_fma_f32 v[226:227], v[228:229], v[204:205], v[226:227]
    v_and_b32 v241, 0xffff0000, v98
    v_pk_fma_f32 v[226:227], v[230:231], v[202:203], v[226:227]
    v_pk_fma_f32 v[226:227], v[232:233], v[200:201], v[226:227]
    v_pk_mul_f32 v[226:227], v[226:227], v[240:241]
    v_pk_mul_f32 v[228:229], v[228:229], v[206:207]
    v_lshlrev_b32 v238, 16, v102
    v_pk_fma_f32 v[228:229], v[230:231], v[204:205], v[228:229]
    v_and_b32 v239, 0xffff0000, v102
    v_pk_fma_f32 v[228:229], v[232:233], v[202:203], v[228:229]
    v_pk_fma_f32 v[228:229], v[234:235], v[200:201], v[228:229]
    v_pk_mul_f32 v[228:229], v[228:229], v[238:239]
    v_pk_mul_f32 v[230:231], v[230:231], v[206:207]
    v_lshlrev_b32 v240, 16, v106
    v_pk_fma_f32 v[230:231], v[232:233], v[204:205], v[230:231]
    v_and_b32 v241, 0xffff0000, v106
    v_pk_fma_f32 v[230:231], v[234:235], v[202:203], v[230:231]
    v_pk_fma_f32 v[230:231], v[236:237], v[200:201], v[230:231]
    v_pk_mul_f32 v[230:231], v[230:231], v[240:241]
    v_cvt_pk_bf16_f32 v242, v230, v228
    v_cvt_pk_bf16_f32 v243, v226, v224
    v_cvt_pk_bf16_f32 v244, v222, v220
    v_cvt_pk_bf16_f32 v245, v218, v216
    ds_write_b128 v12, v[242:245] offset:30720
    v_cvt_pk_bf16_f32 v246, v231, v229
    v_cvt_pk_bf16_f32 v247, v227, v225
    v_cvt_pk_bf16_f32 v248, v223, v221
    v_cvt_pk_bf16_f32 v249, v219, v217
    ds_write_b128 v12, v[246:249] offset:38400
    v_lshlrev_b32 v216, 16, v35
    v_and_b32 v217, 0xffff0000, v35
    v_lshlrev_b32 v218, 16, v39
    v_and_b32 v219, 0xffff0000, v39
    v_lshlrev_b32 v220, 16, v43
    v_and_b32 v221, 0xffff0000, v43
    v_lshlrev_b32 v222, 16, v47
    v_and_b32 v223, 0xffff0000, v47
    v_lshlrev_b32 v224, 16, v51
    v_and_b32 v225, 0xffff0000, v51
    v_lshlrev_b32 v226, 16, v55
    v_and_b32 v227, 0xffff0000, v55
    v_lshlrev_b32 v228, 16, v59
    v_and_b32 v229, 0xffff0000, v59
    v_lshlrev_b32 v230, 16, v63
    v_and_b32 v231, 0xffff0000, v63
    v_lshlrev_b32 v232, 16, v67
    v_and_b32 v233, 0xffff0000, v67
    v_lshlrev_b32 v234, 16, v71
    v_and_b32 v235, 0xffff0000, v71
    v_lshlrev_b32 v236, 16, v75
    v_and_b32 v237, 0xffff0000, v75
    v_pk_mul_f32 v[216:217], v[216:217], v[214:215]
    v_lshlrev_b32 v238, 16, v79
    v_pk_fma_f32 v[216:217], v[218:219], v[212:213], v[216:217]
    v_and_b32 v239, 0xffff0000, v79
    v_pk_fma_f32 v[216:217], v[220:221], v[210:211], v[216:217]
    v_pk_fma_f32 v[216:217], v[222:223], v[208:209], v[216:217]
    v_pk_mul_f32 v[216:217], v[216:217], v[238:239]
    v_pk_mul_f32 v[218:219], v[218:219], v[214:215]
    v_lshlrev_b32 v240, 16, v83
    v_pk_fma_f32 v[218:219], v[220:221], v[212:213], v[218:219]
    v_and_b32 v241, 0xffff0000, v83
    v_pk_fma_f32 v[218:219], v[222:223], v[210:211], v[218:219]
    v_pk_fma_f32 v[218:219], v[224:225], v[208:209], v[218:219]
    v_pk_mul_f32 v[218:219], v[218:219], v[240:241]
    v_pk_mul_f32 v[220:221], v[220:221], v[214:215]
    v_lshlrev_b32 v238, 16, v87
    v_pk_fma_f32 v[220:221], v[222:223], v[212:213], v[220:221]
    v_and_b32 v239, 0xffff0000, v87
    v_pk_fma_f32 v[220:221], v[224:225], v[210:211], v[220:221]
    v_pk_fma_f32 v[220:221], v[226:227], v[208:209], v[220:221]
    v_pk_mul_f32 v[220:221], v[220:221], v[238:239]
    v_pk_mul_f32 v[222:223], v[222:223], v[214:215]
    v_lshlrev_b32 v240, 16, v91
    v_pk_fma_f32 v[222:223], v[224:225], v[212:213], v[222:223]
    v_and_b32 v241, 0xffff0000, v91
    v_pk_fma_f32 v[222:223], v[226:227], v[210:211], v[222:223]
    v_pk_fma_f32 v[222:223], v[228:229], v[208:209], v[222:223]
    v_pk_mul_f32 v[222:223], v[222:223], v[240:241]
    v_pk_mul_f32 v[224:225], v[224:225], v[214:215]
    v_lshlrev_b32 v238, 16, v95
    v_pk_fma_f32 v[224:225], v[226:227], v[212:213], v[224:225]
    v_and_b32 v239, 0xffff0000, v95
    v_pk_fma_f32 v[224:225], v[228:229], v[210:211], v[224:225]
    v_pk_fma_f32 v[224:225], v[230:231], v[208:209], v[224:225]
    v_pk_mul_f32 v[224:225], v[224:225], v[238:239]
    v_pk_mul_f32 v[226:227], v[226:227], v[214:215]
    v_lshlrev_b32 v240, 16, v99
    v_pk_fma_f32 v[226:227], v[228:229], v[212:213], v[226:227]
    v_and_b32 v241, 0xffff0000, v99
    v_pk_fma_f32 v[226:227], v[230:231], v[210:211], v[226:227]
    v_pk_fma_f32 v[226:227], v[232:233], v[208:209], v[226:227]
    v_pk_mul_f32 v[226:227], v[226:227], v[240:241]
    v_pk_mul_f32 v[228:229], v[228:229], v[214:215]
    v_lshlrev_b32 v238, 16, v103
    v_pk_fma_f32 v[228:229], v[230:231], v[212:213], v[228:229]
    v_and_b32 v239, 0xffff0000, v103
    v_pk_fma_f32 v[228:229], v[232:233], v[210:211], v[228:229]
    v_pk_fma_f32 v[228:229], v[234:235], v[208:209], v[228:229]
    v_pk_mul_f32 v[228:229], v[228:229], v[238:239]
    v_pk_mul_f32 v[230:231], v[230:231], v[214:215]
    v_lshlrev_b32 v240, 16, v107
    v_pk_fma_f32 v[230:231], v[232:233], v[212:213], v[230:231]
    v_and_b32 v241, 0xffff0000, v107
    v_pk_fma_f32 v[230:231], v[234:235], v[210:211], v[230:231]
    v_pk_fma_f32 v[230:231], v[236:237], v[208:209], v[230:231]
    v_pk_mul_f32 v[230:231], v[230:231], v[240:241]
    v_cvt_pk_bf16_f32 v242, v230, v228
    v_cvt_pk_bf16_f32 v243, v226, v224
    v_cvt_pk_bf16_f32 v244, v222, v220
    v_cvt_pk_bf16_f32 v245, v218, v216
    ds_write_b128 v12, v[242:245] offset:46080
    v_cvt_pk_bf16_f32 v246, v231, v229
    v_cvt_pk_bf16_f32 v247, v227, v225
    v_cvt_pk_bf16_f32 v248, v223, v221
    v_cvt_pk_bf16_f32 v249, v219, v217
    ds_write_b128 v12, v[246:249] offset:53760
    v_lshlrev_b32 v216, 16, v108
    v_and_b32 v217, 0xffff0000, v108
    v_lshlrev_b32 v218, 16, v112
    v_and_b32 v219, 0xffff0000, v112
    v_lshlrev_b32 v220, 16, v116
    v_and_b32 v221, 0xffff0000, v116
    v_lshlrev_b32 v222, 16, v120
    v_and_b32 v223, 0xffff0000, v120
    v_lshlrev_b32 v224, 16, v124
    v_and_b32 v225, 0xffff0000, v124
    v_lshlrev_b32 v226, 16, v128
    v_and_b32 v227, 0xffff0000, v128
    v_lshlrev_b32 v228, 16, v132
    v_and_b32 v229, 0xffff0000, v132
    v_lshlrev_b32 v230, 16, v136
    v_and_b32 v231, 0xffff0000, v136
    v_lshlrev_b32 v232, 16, v140
    v_and_b32 v233, 0xffff0000, v140
    v_lshlrev_b32 v234, 16, v144
    v_and_b32 v235, 0xffff0000, v144
    v_lshlrev_b32 v236, 16, v148
    v_and_b32 v237, 0xffff0000, v148
    v_pk_mul_f32 v[216:217], v[216:217], v[190:191]
    v_lshlrev_b32 v238, 16, v152
    v_pk_fma_f32 v[216:217], v[218:219], v[188:189], v[216:217]
    v_and_b32 v239, 0xffff0000, v152
    v_pk_fma_f32 v[216:217], v[220:221], v[186:187], v[216:217]
    v_pk_fma_f32 v[216:217], v[222:223], v[184:185], v[216:217]
    v_pk_mul_f32 v[216:217], v[216:217], v[238:239]
    v_pk_mul_f32 v[218:219], v[218:219], v[190:191]
    v_lshlrev_b32 v240, 16, v156
    v_pk_fma_f32 v[218:219], v[220:221], v[188:189], v[218:219]
    v_and_b32 v241, 0xffff0000, v156
    v_pk_fma_f32 v[218:219], v[222:223], v[186:187], v[218:219]
    v_pk_fma_f32 v[218:219], v[224:225], v[184:185], v[218:219]
    v_pk_mul_f32 v[218:219], v[218:219], v[240:241]
    v_pk_mul_f32 v[220:221], v[220:221], v[190:191]
    v_lshlrev_b32 v238, 16, v160
    v_pk_fma_f32 v[220:221], v[222:223], v[188:189], v[220:221]
    v_and_b32 v239, 0xffff0000, v160
    v_pk_fma_f32 v[220:221], v[224:225], v[186:187], v[220:221]
    v_pk_fma_f32 v[220:221], v[226:227], v[184:185], v[220:221]
    v_pk_mul_f32 v[220:221], v[220:221], v[238:239]
    v_pk_mul_f32 v[222:223], v[222:223], v[190:191]
    v_lshlrev_b32 v240, 16, v164
    v_pk_fma_f32 v[222:223], v[224:225], v[188:189], v[222:223]
    v_and_b32 v241, 0xffff0000, v164
    v_pk_fma_f32 v[222:223], v[226:227], v[186:187], v[222:223]
    v_pk_fma_f32 v[222:223], v[228:229], v[184:185], v[222:223]
    v_pk_mul_f32 v[222:223], v[222:223], v[240:241]
    v_pk_mul_f32 v[224:225], v[224:225], v[190:191]
    v_lshlrev_b32 v238, 16, v168
    v_pk_fma_f32 v[224:225], v[226:227], v[188:189], v[224:225]
    v_and_b32 v239, 0xffff0000, v168
    v_pk_fma_f32 v[224:225], v[228:229], v[186:187], v[224:225]
    v_pk_fma_f32 v[224:225], v[230:231], v[184:185], v[224:225]
    v_pk_mul_f32 v[224:225], v[224:225], v[238:239]
    v_pk_mul_f32 v[226:227], v[226:227], v[190:191]
    v_lshlrev_b32 v240, 16, v172
    v_pk_fma_f32 v[226:227], v[228:229], v[188:189], v[226:227]
    v_and_b32 v241, 0xffff0000, v172
    v_pk_fma_f32 v[226:227], v[230:231], v[186:187], v[226:227]
    v_pk_fma_f32 v[226:227], v[232:233], v[184:185], v[226:227]
    v_pk_mul_f32 v[226:227], v[226:227], v[240:241]
    v_pk_mul_f32 v[228:229], v[228:229], v[190:191]
    v_lshlrev_b32 v238, 16, v176
    v_pk_fma_f32 v[228:229], v[230:231], v[188:189], v[228:229]
    v_and_b32 v239, 0xffff0000, v176
    v_pk_fma_f32 v[228:229], v[232:233], v[186:187], v[228:229]
    v_pk_fma_f32 v[228:229], v[234:235], v[184:185], v[228:229]
    v_pk_mul_f32 v[228:229], v[228:229], v[238:239]
    v_pk_mul_f32 v[230:231], v[230:231], v[190:191]
    v_lshlrev_b32 v240, 16, v180
    v_pk_fma_f32 v[230:231], v[232:233], v[188:189], v[230:231]
    v_and_b32 v241, 0xffff0000, v180
    v_pk_fma_f32 v[230:231], v[234:235], v[186:187], v[230:231]
    v_pk_fma_f32 v[230:231], v[236:237], v[184:185], v[230:231]
    v_pk_mul_f32 v[230:231], v[230:231], v[240:241]
    v_cvt_pk_bf16_f32 v242, v230, v228
    v_cvt_pk_bf16_f32 v243, v226, v224
    v_cvt_pk_bf16_f32 v244, v222, v220
    v_cvt_pk_bf16_f32 v245, v218, v216
    ds_write_b128 v12, v[242:245] offset:2560
    v_cvt_pk_bf16_f32 v246, v231, v229
    v_cvt_pk_bf16_f32 v247, v227, v225
    v_cvt_pk_bf16_f32 v248, v223, v221
    v_cvt_pk_bf16_f32 v249, v219, v217
    ds_write_b128 v12, v[246:249] offset:10240
    v_lshlrev_b32 v216, 16, v109
    v_and_b32 v217, 0xffff0000, v109
    v_lshlrev_b32 v218, 16, v113
    v_and_b32 v219, 0xffff0000, v113
    v_lshlrev_b32 v220, 16, v117
    v_and_b32 v221, 0xffff0000, v117
    v_lshlrev_b32 v222, 16, v121
    v_and_b32 v223, 0xffff0000, v121
    v_lshlrev_b32 v224, 16, v125
    v_and_b32 v225, 0xffff0000, v125
    v_lshlrev_b32 v226, 16, v129
    v_and_b32 v227, 0xffff0000, v129
    v_lshlrev_b32 v228, 16, v133
    v_and_b32 v229, 0xffff0000, v133
    v_lshlrev_b32 v230, 16, v137
    v_and_b32 v231, 0xffff0000, v137
    v_lshlrev_b32 v232, 16, v141
    v_and_b32 v233, 0xffff0000, v141
    v_lshlrev_b32 v234, 16, v145
    v_and_b32 v235, 0xffff0000, v145
    v_lshlrev_b32 v236, 16, v149
    v_and_b32 v237, 0xffff0000, v149
    v_pk_mul_f32 v[216:217], v[216:217], v[198:199]
    v_lshlrev_b32 v238, 16, v153
    v_pk_fma_f32 v[216:217], v[218:219], v[196:197], v[216:217]
    v_and_b32 v239, 0xffff0000, v153
    v_pk_fma_f32 v[216:217], v[220:221], v[194:195], v[216:217]
    v_pk_fma_f32 v[216:217], v[222:223], v[192:193], v[216:217]
    v_pk_mul_f32 v[216:217], v[216:217], v[238:239]
    v_pk_mul_f32 v[218:219], v[218:219], v[198:199]
    v_lshlrev_b32 v240, 16, v157
    v_pk_fma_f32 v[218:219], v[220:221], v[196:197], v[218:219]
    v_and_b32 v241, 0xffff0000, v157
    v_pk_fma_f32 v[218:219], v[222:223], v[194:195], v[218:219]
    v_pk_fma_f32 v[218:219], v[224:225], v[192:193], v[218:219]
    v_pk_mul_f32 v[218:219], v[218:219], v[240:241]
    v_pk_mul_f32 v[220:221], v[220:221], v[198:199]
    v_lshlrev_b32 v238, 16, v161
    v_pk_fma_f32 v[220:221], v[222:223], v[196:197], v[220:221]
    v_and_b32 v239, 0xffff0000, v161
    v_pk_fma_f32 v[220:221], v[224:225], v[194:195], v[220:221]
    v_pk_fma_f32 v[220:221], v[226:227], v[192:193], v[220:221]
    v_pk_mul_f32 v[220:221], v[220:221], v[238:239]
    v_pk_mul_f32 v[222:223], v[222:223], v[198:199]
    v_lshlrev_b32 v240, 16, v165
    v_pk_fma_f32 v[222:223], v[224:225], v[196:197], v[222:223]
    v_and_b32 v241, 0xffff0000, v165
    v_pk_fma_f32 v[222:223], v[226:227], v[194:195], v[222:223]
    v_pk_fma_f32 v[222:223], v[228:229], v[192:193], v[222:223]
    v_pk_mul_f32 v[222:223], v[222:223], v[240:241]
    v_pk_mul_f32 v[224:225], v[224:225], v[198:199]
    v_lshlrev_b32 v238, 16, v169
    v_pk_fma_f32 v[224:225], v[226:227], v[196:197], v[224:225]
    v_and_b32 v239, 0xffff0000, v169
    v_pk_fma_f32 v[224:225], v[228:229], v[194:195], v[224:225]
    v_pk_fma_f32 v[224:225], v[230:231], v[192:193], v[224:225]
    v_pk_mul_f32 v[224:225], v[224:225], v[238:239]
    v_pk_mul_f32 v[226:227], v[226:227], v[198:199]
    v_lshlrev_b32 v240, 16, v173
    v_pk_fma_f32 v[226:227], v[228:229], v[196:197], v[226:227]
    v_and_b32 v241, 0xffff0000, v173
    v_pk_fma_f32 v[226:227], v[230:231], v[194:195], v[226:227]
    v_pk_fma_f32 v[226:227], v[232:233], v[192:193], v[226:227]
    v_pk_mul_f32 v[226:227], v[226:227], v[240:241]
    v_pk_mul_f32 v[228:229], v[228:229], v[198:199]
    v_lshlrev_b32 v238, 16, v177
    v_pk_fma_f32 v[228:229], v[230:231], v[196:197], v[228:229]
    v_and_b32 v239, 0xffff0000, v177
    v_pk_fma_f32 v[228:229], v[232:233], v[194:195], v[228:229]
    v_pk_fma_f32 v[228:229], v[234:235], v[192:193], v[228:229]
    v_pk_mul_f32 v[228:229], v[228:229], v[238:239]
    v_pk_mul_f32 v[230:231], v[230:231], v[198:199]
    v_lshlrev_b32 v240, 16, v181
    v_pk_fma_f32 v[230:231], v[232:233], v[196:197], v[230:231]
    v_and_b32 v241, 0xffff0000, v181
    v_pk_fma_f32 v[230:231], v[234:235], v[194:195], v[230:231]
    v_pk_fma_f32 v[230:231], v[236:237], v[192:193], v[230:231]
    v_pk_mul_f32 v[230:231], v[230:231], v[240:241]
    v_cvt_pk_bf16_f32 v242, v230, v228
    v_cvt_pk_bf16_f32 v243, v226, v224
    v_cvt_pk_bf16_f32 v244, v222, v220
    v_cvt_pk_bf16_f32 v245, v218, v216
    ds_write_b128 v12, v[242:245] offset:17920
    v_cvt_pk_bf16_f32 v246, v231, v229
    v_cvt_pk_bf16_f32 v247, v227, v225
    v_cvt_pk_bf16_f32 v248, v223, v221
    v_cvt_pk_bf16_f32 v249, v219, v217
    ds_write_b128 v12, v[246:249] offset:25600
    v_lshlrev_b32 v216, 16, v110
    v_and_b32 v217, 0xffff0000, v110
    v_lshlrev_b32 v218, 16, v114
    v_and_b32 v219, 0xffff0000, v114
    v_lshlrev_b32 v220, 16, v118
    v_and_b32 v221, 0xffff0000, v118
    v_lshlrev_b32 v222, 16, v122
    v_and_b32 v223, 0xffff0000, v122
    v_lshlrev_b32 v224, 16, v126
    v_and_b32 v225, 0xffff0000, v126
    v_lshlrev_b32 v226, 16, v130
    v_and_b32 v227, 0xffff0000, v130
    v_lshlrev_b32 v228, 16, v134
    v_and_b32 v229, 0xffff0000, v134
    v_lshlrev_b32 v230, 16, v138
    v_and_b32 v231, 0xffff0000, v138
    v_lshlrev_b32 v232, 16, v142
    v_and_b32 v233, 0xffff0000, v142
    v_lshlrev_b32 v234, 16, v146
    v_and_b32 v235, 0xffff0000, v146
    v_lshlrev_b32 v236, 16, v150
    v_and_b32 v237, 0xffff0000, v150
    v_pk_mul_f32 v[216:217], v[216:217], v[206:207]
    v_lshlrev_b32 v238, 16, v154
    v_pk_fma_f32 v[216:217], v[218:219], v[204:205], v[216:217]
    v_and_b32 v239, 0xffff0000, v154
    v_pk_fma_f32 v[216:217], v[220:221], v[202:203], v[216:217]
    v_pk_fma_f32 v[216:217], v[222:223], v[200:201], v[216:217]
    v_pk_mul_f32 v[216:217], v[216:217], v[238:239]
    v_pk_mul_f32 v[218:219], v[218:219], v[206:207]
    v_lshlrev_b32 v240, 16, v158
    v_pk_fma_f32 v[218:219], v[220:221], v[204:205], v[218:219]
    v_and_b32 v241, 0xffff0000, v158
    v_pk_fma_f32 v[218:219], v[222:223], v[202:203], v[218:219]
    v_pk_fma_f32 v[218:219], v[224:225], v[200:201], v[218:219]
    v_pk_mul_f32 v[218:219], v[218:219], v[240:241]
    v_pk_mul_f32 v[220:221], v[220:221], v[206:207]
    v_lshlrev_b32 v238, 16, v162
    v_pk_fma_f32 v[220:221], v[222:223], v[204:205], v[220:221]
    v_and_b32 v239, 0xffff0000, v162
    v_pk_fma_f32 v[220:221], v[224:225], v[202:203], v[220:221]
    v_pk_fma_f32 v[220:221], v[226:227], v[200:201], v[220:221]
    v_pk_mul_f32 v[220:221], v[220:221], v[238:239]
    v_pk_mul_f32 v[222:223], v[222:223], v[206:207]
    v_lshlrev_b32 v240, 16, v166
    v_pk_fma_f32 v[222:223], v[224:225], v[204:205], v[222:223]
    v_and_b32 v241, 0xffff0000, v166
    v_pk_fma_f32 v[222:223], v[226:227], v[202:203], v[222:223]
    v_pk_fma_f32 v[222:223], v[228:229], v[200:201], v[222:223]
    v_pk_mul_f32 v[222:223], v[222:223], v[240:241]
    v_pk_mul_f32 v[224:225], v[224:225], v[206:207]
    v_lshlrev_b32 v238, 16, v170
    v_pk_fma_f32 v[224:225], v[226:227], v[204:205], v[224:225]
    v_and_b32 v239, 0xffff0000, v170
    v_pk_fma_f32 v[224:225], v[228:229], v[202:203], v[224:225]
    v_pk_fma_f32 v[224:225], v[230:231], v[200:201], v[224:225]
    v_pk_mul_f32 v[224:225], v[224:225], v[238:239]
    v_pk_mul_f32 v[226:227], v[226:227], v[206:207]
    v_lshlrev_b32 v240, 16, v174
    v_pk_fma_f32 v[226:227], v[228:229], v[204:205], v[226:227]
    v_and_b32 v241, 0xffff0000, v174
    v_pk_fma_f32 v[226:227], v[230:231], v[202:203], v[226:227]
    v_pk_fma_f32 v[226:227], v[232:233], v[200:201], v[226:227]
    v_pk_mul_f32 v[226:227], v[226:227], v[240:241]
    v_pk_mul_f32 v[228:229], v[228:229], v[206:207]
    v_lshlrev_b32 v238, 16, v178
    v_pk_fma_f32 v[228:229], v[230:231], v[204:205], v[228:229]
    v_and_b32 v239, 0xffff0000, v178
    v_pk_fma_f32 v[228:229], v[232:233], v[202:203], v[228:229]
    v_pk_fma_f32 v[228:229], v[234:235], v[200:201], v[228:229]
    v_pk_mul_f32 v[228:229], v[228:229], v[238:239]
    v_pk_mul_f32 v[230:231], v[230:231], v[206:207]
    v_lshlrev_b32 v240, 16, v182
    v_pk_fma_f32 v[230:231], v[232:233], v[204:205], v[230:231]
    v_and_b32 v241, 0xffff0000, v182
    v_pk_fma_f32 v[230:231], v[234:235], v[202:203], v[230:231]
    v_pk_fma_f32 v[230:231], v[236:237], v[200:201], v[230:231]
    v_pk_mul_f32 v[230:231], v[230:231], v[240:241]
    v_cvt_pk_bf16_f32 v242, v230, v228
    v_cvt_pk_bf16_f32 v243, v226, v224
    v_cvt_pk_bf16_f32 v244, v222, v220
    v_cvt_pk_bf16_f32 v245, v218, v216
    ds_write_b128 v12, v[242:245] offset:33280
    v_cvt_pk_bf16_f32 v246, v231, v229
    v_cvt_pk_bf16_f32 v247, v227, v225
    v_cvt_pk_bf16_f32 v248, v223, v221
    v_cvt_pk_bf16_f32 v249, v219, v217
    ds_write_b128 v12, v[246:249] offset:40960
    v_lshlrev_b32 v216, 16, v111
    v_and_b32 v217, 0xffff0000, v111
    v_lshlrev_b32 v218, 16, v115
    v_and_b32 v219, 0xffff0000, v115
    v_lshlrev_b32 v220, 16, v119
    v_and_b32 v221, 0xffff0000, v119
    v_lshlrev_b32 v222, 16, v123
    v_and_b32 v223, 0xffff0000, v123
    v_lshlrev_b32 v224, 16, v127
    v_and_b32 v225, 0xffff0000, v127
    v_lshlrev_b32 v226, 16, v131
    v_and_b32 v227, 0xffff0000, v131
    v_lshlrev_b32 v228, 16, v135
    v_and_b32 v229, 0xffff0000, v135
    v_lshlrev_b32 v230, 16, v139
    v_and_b32 v231, 0xffff0000, v139
    v_lshlrev_b32 v232, 16, v143
    v_and_b32 v233, 0xffff0000, v143
    v_lshlrev_b32 v234, 16, v147
    v_and_b32 v235, 0xffff0000, v147
    v_lshlrev_b32 v236, 16, v151
    v_and_b32 v237, 0xffff0000, v151
    v_pk_mul_f32 v[216:217], v[216:217], v[214:215]
    v_lshlrev_b32 v238, 16, v155
    v_pk_fma_f32 v[216:217], v[218:219], v[212:213], v[216:217]
    v_and_b32 v239, 0xffff0000, v155
    v_pk_fma_f32 v[216:217], v[220:221], v[210:211], v[216:217]
    v_pk_fma_f32 v[216:217], v[222:223], v[208:209], v[216:217]
    v_pk_mul_f32 v[216:217], v[216:217], v[238:239]
    v_pk_mul_f32 v[218:219], v[218:219], v[214:215]
    v_lshlrev_b32 v240, 16, v159
    v_pk_fma_f32 v[218:219], v[220:221], v[212:213], v[218:219]
    v_and_b32 v241, 0xffff0000, v159
    v_pk_fma_f32 v[218:219], v[222:223], v[210:211], v[218:219]
    v_pk_fma_f32 v[218:219], v[224:225], v[208:209], v[218:219]
    v_pk_mul_f32 v[218:219], v[218:219], v[240:241]
    v_pk_mul_f32 v[220:221], v[220:221], v[214:215]
    v_lshlrev_b32 v238, 16, v163
    v_pk_fma_f32 v[220:221], v[222:223], v[212:213], v[220:221]
    v_and_b32 v239, 0xffff0000, v163
    v_pk_fma_f32 v[220:221], v[224:225], v[210:211], v[220:221]
    v_pk_fma_f32 v[220:221], v[226:227], v[208:209], v[220:221]
    v_pk_mul_f32 v[220:221], v[220:221], v[238:239]
    v_pk_mul_f32 v[222:223], v[222:223], v[214:215]
    v_lshlrev_b32 v240, 16, v167
    v_pk_fma_f32 v[222:223], v[224:225], v[212:213], v[222:223]
    v_and_b32 v241, 0xffff0000, v167
    v_pk_fma_f32 v[222:223], v[226:227], v[210:211], v[222:223]
    v_pk_fma_f32 v[222:223], v[228:229], v[208:209], v[222:223]
    v_pk_mul_f32 v[222:223], v[222:223], v[240:241]
    v_pk_mul_f32 v[224:225], v[224:225], v[214:215]
    v_lshlrev_b32 v238, 16, v171
    v_pk_fma_f32 v[224:225], v[226:227], v[212:213], v[224:225]
    v_and_b32 v239, 0xffff0000, v171
    v_pk_fma_f32 v[224:225], v[228:229], v[210:211], v[224:225]
    v_pk_fma_f32 v[224:225], v[230:231], v[208:209], v[224:225]
    v_pk_mul_f32 v[224:225], v[224:225], v[238:239]
    v_pk_mul_f32 v[226:227], v[226:227], v[214:215]
    v_lshlrev_b32 v240, 16, v175
    v_pk_fma_f32 v[226:227], v[228:229], v[212:213], v[226:227]
    v_and_b32 v241, 0xffff0000, v175
    v_pk_fma_f32 v[226:227], v[230:231], v[210:211], v[226:227]
    v_pk_fma_f32 v[226:227], v[232:233], v[208:209], v[226:227]
    v_pk_mul_f32 v[226:227], v[226:227], v[240:241]
    v_pk_mul_f32 v[228:229], v[228:229], v[214:215]
    v_lshlrev_b32 v238, 16, v179
    v_pk_fma_f32 v[228:229], v[230:231], v[212:213], v[228:229]
    v_and_b32 v239, 0xffff0000, v179
    v_pk_fma_f32 v[228:229], v[232:233], v[210:211], v[228:229]
    v_pk_fma_f32 v[228:229], v[234:235], v[208:209], v[228:229]
    v_pk_mul_f32 v[228:229], v[228:229], v[238:239]
    v_pk_mul_f32 v[230:231], v[230:231], v[214:215]
    v_lshlrev_b32 v240, 16, v183
    v_pk_fma_f32 v[230:231], v[232:233], v[212:213], v[230:231]
    v_and_b32 v241, 0xffff0000, v183
    v_pk_fma_f32 v[230:231], v[234:235], v[210:211], v[230:231]
    v_pk_fma_f32 v[230:231], v[236:237], v[208:209], v[230:231]
    v_pk_mul_f32 v[230:231], v[230:231], v[240:241]
    v_cvt_pk_bf16_f32 v242, v230, v228
    v_cvt_pk_bf16_f32 v243, v226, v224
    v_cvt_pk_bf16_f32 v244, v222, v220
    v_cvt_pk_bf16_f32 v245, v218, v216
    ds_write_b128 v12, v[242:245] offset:48640
    v_cvt_pk_bf16_f32 v246, v231, v229
    v_cvt_pk_bf16_f32 v247, v227, v225
    v_cvt_pk_bf16_f32 v248, v223, v221
    v_cvt_pk_bf16_f32 v249, v219, v217
    ds_write_b128 v12, v[246:249] offset:56320
    s_lshl_b32 s4, s61, 12
    v_add_u32 v6, s4, v5
    buffer_load_dwordx4 v[184:187], v2, s[36:39], s4 offen offset:0
    buffer_load_dwordx4 v[188:191], v2, s[36:39], s4 offen offset:1024
    buffer_load_dwordx4 v[192:195], v2, s[36:39], s4 offen offset:2048
    buffer_load_dwordx4 v[196:199], v2, s[36:39], s4 offen offset:3072
    buffer_load_dword v200, v6, s[36:39], 0 offen
    buffer_load_dword v201, v2, s[36:39], s4 offen offset:1020
    buffer_load_dword v202, v2, s[36:39], s4 offen offset:2044
    buffer_load_dword v203, v2, s[36:39], s4 offen offset:3068
    s_waitcnt vmcnt(0)
    s_waitcnt lgkmcnt(0)
    s_barrier
    s_mov_b32 s64, 0
.chan_198:
    s_lshr_b32 s4, s61, 1
    s_lshl_b32 s4, s4, 2
    s_load_dword s65, s[50:51], s4
    s_lshl_b32 s7, s61, 12
    s_add_u32 s7, s7, 130023424
    v_writelane_b32 v200, 0, 0
    ds_write_b128 v9, v[184:187] offset:64
    v_alignbit_b32 v204, v184, v200, 16
    v_alignbit_b32 v205, v185, v184, 16
    v_alignbit_b32 v206, v186, v185, 16
    v_alignbit_b32 v207, v187, v186, 16
    ds_write_b128 v9, v[204:207] offset:4224
    ds_write_b128 v9, v[188:191] offset:1088
    v_alignbit_b32 v208, v188, v201, 16
    v_alignbit_b32 v209, v189, v188, 16
    v_alignbit_b32 v210, v190, v189, 16
    v_alignbit_b32 v211, v191, v190, 16
    ds_write_b128 v9, v[208:211] offset:5248
    ds_write_b128 v9, v[192:195] offset:2112
    v_alignbit_b32 v212, v192, v202, 16
    v_alignbit_b32 v213, v193, v192, 16
    v_alignbit_b32 v214, v194, v193, 16
    v_alignbit_b32 v215, v195, v194, 16
    ds_write_b128 v9, v[212:215] offset:6272
    ds_write_b128 v9, v[196:199] offset:3136
    v_alignbit_b32 v216, v196, v203, 16
    v_alignbit_b32 v217, v197, v196, 16
    v_alignbit_b32 v218, v198, v197, 16
    v_alignbit_b32 v219, v199, v198, 16
    ds_write_b128 v9, v[216:219] offset:7296
    s_and_b32 s4, s61, 1
    s_lshl_b32 s4, s4, 4
    s_waitcnt lgkmcnt(0)
    s_lshr_b32 s65, s65, s4
    s_pack_ll_b32_b16 s65, s65, s65
    s_add_u32 s61, s61, 4
    s_cmp_eq_u32 s64, 3
    s_cbranch_scc1 .chan_198_ns
    s_lshl_b32 s4, s61, 12
    v_add_u32 v6, s4, v5
    buffer_load_dwordx4 v[184:187], v2, s[36:39], s4 offen offset:0
    buffer_load_dwordx4 v[188:191], v2, s[36:39], s4 offen offset:1024
    buffer_load_dwordx4 v[192:195], v2, s[36:39], s4 offen offset:2048
    buffer_load_dwordx4 v[196:199], v2, s[36:39], s4 offen offset:3072
    buffer_load_dword v200, v6, s[36:39], 0 offen
    buffer_load_dword v201, v2, s[36:39], s4 offen offset:1020
    buffer_load_dword v202, v2, s[36:39], s4 offen offset:2044
    buffer_load_dword v203, v2, s[36:39], s4 offen offset:3068
.chan_198_ns:
    v_and_b32 v16, s65, v24
    v_and_b32 v17, s65, v25
    v_and_b32 v18, s65, v26
    v_and_b32 v19, s65, v27
    v_and_b32 v20, s65, v28
    v_and_b32 v21, s65, v29
    v_and_b32 v22, s65, v30
    v_and_b32 v23, s65, v31
    v_mov_b32 v14, v10
    ds_read2_b32 a[32:33], v14 offset0:0 offset1:1
    ds_read2_b32 a[34:35], v14 offset0:2 offset1:3
    ds_read_b128 a[56:59], v11 offset:7632
    ds_read_b128 a[60:63], v11 offset:5072
    ds_read2_b32 a[36:37], v14 offset0:8 offset1:9
    ds_read2_b32 a[38:39], v14 offset0:10 offset1:11
    ds_read_b128 a[64:67], v11 offset:7600
    ds_read_b128 a[68:71], v11 offset:5040
    ds_read2_b32 a[40:41], v14 offset0:16 offset1:17
    ds_read2_b32 a[42:43], v14 offset0:18 offset1:19
    ds_read_b128 a[72:75], v11 offset:7552
    ds_read_b128 a[76:79], v11 offset:4992
    s_waitcnt lgkmcnt(9)
    v_mfma_f32_32x32x16_bf16 a[16:31], a[32:35], a[56:59], 0
    v_mfma_f32_32x32x16_bf16 a[16:31], v[20:23], a[56:59], a[16:31]
    ds_read2_b32 a[44:45], v14 offset0:24 offset1:25
    ds_read2_b32 a[46:47], v14 offset0:26 offset1:27
    s_waitcnt lgkmcnt(10)
    v_mfma_f32_32x32x16_bf16 a[0:15], a[32:35], a[60:63], 0
    v_mfma_f32_32x32x16_bf16 a[0:15], v[20:23], a[60:63], a[0:15]
    ds_read_b128 a[80:83], v11 offset:7520
    ds_read_b128 a[84:87], v11 offset:4960
    s_waitcnt lgkmcnt(9)
    v_mfma_f32_32x32x16_bf16 a[16:31], a[36:39], a[64:67], a[16:31]
    v_mfma_f32_32x32x16_bf16 a[16:31], v[16:19], a[64:67], a[16:31]
    ds_read2_b32 a[48:49], v14 offset0:32 offset1:33
    ds_read2_b32 a[50:51], v14 offset0:34 offset1:35
    s_waitcnt lgkmcnt(10)
    v_mfma_f32_32x32x16_bf16 a[0:15], a[36:39], a[68:71], a[0:15]
    v_mfma_f32_32x32x16_bf16 a[0:15], v[16:19], a[68:71], a[0:15]
    ds_read_b128 a[56:59], v11 offset:7472
    ds_read_b128 a[60:63], v11 offset:4912
    s_waitcnt lgkmcnt(9)
    v_mfma_f32_32x32x16_bf16 a[16:31], a[40:43], a[72:75], a[16:31]
    ds_read2_b32 a[52:53], v14 offset0:40 offset1:41
    ds_read2_b32 a[54:55], v14 offset0:42 offset1:43
    s_waitcnt lgkmcnt(10)
    v_mfma_f32_32x32x16_bf16 a[0:15], a[40:43], a[76:79], a[0:15]
    ds_read_b128 a[64:67], v11 offset:7440
    ds_read_b128 a[68:71], v11 offset:4880
    s_waitcnt lgkmcnt(9)
    v_mfma_f32_32x32x16_bf16 a[16:31], a[44:47], a[80:83], a[16:31]
    ds_read2_b32 a[32:33], v14 offset0:48 offset1:49
    ds_read2_b32 a[34:35], v14 offset0:50 offset1:51
    s_waitcnt lgkmcnt(10)
    v_mfma_f32_32x32x16_bf16 a[0:15], a[44:47], a[84:87], a[0:15]
    ds_read_b128 a[72:75], v11 offset:7392
    ds_read_b128 a[76:79], v11 offset:4832
    s_waitcnt lgkmcnt(9)
    v_mfma_f32_32x32x16_bf16 a[16:31], a[48:51], a[56:59], a[16:31]
    ds_read2_b32 a[36:37], v14 offset0:56 offset1:57
    ds_read2_b32 a[38:39], v14 offset0:58 offset1:59
    s_waitcnt lgkmcnt(10)
    v_mfma_f32_32x32x16_bf16 a[0:15], a[48:51], a[60:63], a[0:15]
    ds_read_b128 a[80:83], v11 offset:7360
    ds_read_b128 a[84:87], v11 offset:4800
    s_waitcnt lgkmcnt(9)
    v_mfma_f32_32x32x16_bf16 a[16:31], a[52:55], a[64:67], a[16:31]
    ds_read2_b32 a[40:41], v14 offset0:64 offset1:65
    ds_read2_b32 a[42:43], v14 offset0:66 offset1:67
    s_waitcnt lgkmcnt(10)
    v_mfma_f32_32x32x16_bf16 a[0:15], a[52:55], a[68:71], a[0:15]
    ds_read_b128 a[56:59], v11 offset:7312
    ds_read_b128 a[60:63], v11 offset:4752
    s_waitcnt lgkmcnt(9)
    v_mfma_f32_32x32x16_bf16 a[16:31], a[32:35], a[72:75], a[16:31]
    ds_read2_b32 a[44:45], v14 offset0:72 offset1:73
    ds_read2_b32 a[46:47], v14 offset0:74 offset1:75
    s_waitcnt lgkmcnt(10)
    v_mfma_f32_32x32x16_bf16 a[0:15], a[32:35], a[76:79], a[0:15]
    ds_read_b128 a[64:67], v11 offset:7280
    ds_read_b128 a[68:71], v11 offset:4720
    s_waitcnt lgkmcnt(9)
    v_mfma_f32_32x32x16_bf16 a[16:31], a[36:39], a[80:83], a[16:31]
    ds_read2_b32 a[48:49], v14 offset0:80 offset1:81
    ds_read2_b32 a[50:51], v14 offset0:82 offset1:83
    s_waitcnt lgkmcnt(10)
    v_mfma_f32_32x32x16_bf16 a[0:15], a[36:39], a[84:87], a[0:15]
    ds_read_b128 a[72:75], v11 offset:7232
    ds_read_b128 a[76:79], v11 offset:4672
    s_waitcnt lgkmcnt(9)
    v_mfma_f32_32x32x16_bf16 a[16:31], a[40:43], a[56:59], a[16:31]
    ds_read2_b32 a[52:53], v14 offset0:88 offset1:89
    ds_read2_b32 a[54:55], v14 offset0:90 offset1:91
    s_waitcnt lgkmcnt(10)
    v_mfma_f32_32x32x16_bf16 a[0:15], a[40:43], a[60:63], a[0:15]
    ds_read_b128 a[80:83], v11 offset:7200
    ds_read_b128 a[84:87], v11 offset:4640
    s_waitcnt lgkmcnt(9)
    v_mfma_f32_32x32x16_bf16 a[16:31], a[44:47], a[64:67], a[16:31]
    ds_read2_b32 a[32:33], v14 offset0:96 offset1:97
    ds_read2_b32 a[34:35], v14 offset0:98 offset1:99
    s_waitcnt lgkmcnt(10)
    v_mfma_f32_32x32x16_bf16 a[0:15], a[44:47], a[68:71], a[0:15]
    ds_read_b128 a[56:59], v11 offset:7152
    ds_read_b128 a[60:63], v11 offset:4592
    s_waitcnt lgkmcnt(9)
    v_mfma_f32_32x32x16_bf16 a[16:31], a[48:51], a[72:75], a[16:31]
    ds_read2_b32 a[36:37], v14 offset0:104 offset1:105
    ds_read2_b32 a[38:39], v14 offset0:106 offset1:107
    s_waitcnt lgkmcnt(10)
    v_mfma_f32_32x32x16_bf16 a[0:15], a[48:51], a[76:79], a[0:15]
    ds_read_b128 a[64:67], v11 offset:7120
    ds_read_b128 a[68:71], v11 offset:4560
    s_waitcnt lgkmcnt(9)
    v_mfma_f32_32x32x16_bf16 a[16:31], a[52:55], a[80:83], a[16:31]
    ds_read2_b32 a[40:41], v14 offset0:112 offset1:113
    ds_read2_b32 a[42:43], v14 offset0:114 offset1:115
    s_waitcnt lgkmcnt(10)
    v_mfma_f32_32x32x16_bf16 a[0:15], a[52:55], a[84:87], a[0:15]
    ds_read_b128 a[72:75], v11 offset:7072
    ds_read_b128 a[76:79], v11 offset:4512
    s_waitcnt lgkmcnt(9)
    v_mfma_f32_32x32x16_bf16 a[16:31], a[32:35], a[56:59], a[16:31]
    ds_read2_b32 a[44:45], v14 offset0:120 offset1:121
    ds_read2_b32 a[46:47], v14 offset0:122 offset1:123
    s_waitcnt lgkmcnt(10)
    v_mfma_f32_32x32x16_bf16 a[0:15], a[32:35], a[60:63], a[0:15]
    ds_read_b128 a[80:83], v11 offset:7040
    ds_read_b128 a[84:87], v11 offset:4480
    s_waitcnt lgkmcnt(9)
    v_mfma_f32_32x32x16_bf16 a[16:31], a[36:39], a[64:67], a[16:31]
    ds_read2_b32 a[48:49], v14 offset0:128 offset1:129
    ds_read2_b32 a[50:51], v14 offset0:130 offset1:131
    s_waitcnt lgkmcnt(10)
    v_mfma_f32_32x32x16_bf16 a[0:15], a[36:39], a[68:71], a[0:15]
    ds_read_b128 a[56:59], v11 offset:6992
    ds_read_b128 a[60:63], v11 offset:4432
    s_waitcnt lgkmcnt(9)
    v_mfma_f32_32x32x16_bf16 a[16:31], a[40:43], a[72:75], a[16:31]
    ds_read2_b32 a[52:53], v14 offset0:136 offset1:137
    ds_read2_b32 a[54:55], v14 offset0:138 offset1:139
    s_waitcnt lgkmcnt(10)
    v_mfma_f32_32x32x16_bf16 a[0:15], a[40:43], a[76:79], a[0:15]
    ds_read_b128 a[64:67], v11 offset:6960
    ds_read_b128 a[68:71], v11 offset:4400
    s_waitcnt lgkmcnt(9)
    v_mfma_f32_32x32x16_bf16 a[16:31], a[44:47], a[80:83], a[16:31]
    ds_read2_b32 a[32:33], v14 offset0:144 offset1:145
    ds_read2_b32 a[34:35], v14 offset0:146 offset1:147
    s_waitcnt lgkmcnt(10)
    v_mfma_f32_32x32x16_bf16 a[0:15], a[44:47], a[84:87], a[0:15]
    ds_read_b128 a[72:75], v11 offset:6912
    ds_read_b128 a[76:79], v11 offset:4352
    s_waitcnt lgkmcnt(9)
    v_mfma_f32_32x32x16_bf16 a[16:31], a[48:51], a[56:59], a[16:31]
    ds_read2_b32 a[36:37], v14 offset0:152 offset1:153
    ds_read2_b32 a[38:39], v14 offset0:154 offset1:155
    s_waitcnt lgkmcnt(10)
    v_mfma_f32_32x32x16_bf16 a[0:15], a[48:51], a[60:63], a[0:15]
    ds_read_b128 a[80:83], v11 offset:6880
    ds_read_b128 a[84:87], v11 offset:4320
    s_waitcnt lgkmcnt(9)
    v_mfma_f32_32x32x16_bf16 a[16:31], a[52:55], a[64:67], a[16:31]
    ds_read2_b32 a[40:41], v14 offset0:160 offset1:161
    ds_read2_b32 a[42:43], v14 offset0:162 offset1:163
    s_waitcnt lgkmcnt(10)
    v_mfma_f32_32x32x16_bf16 a[0:15], a[52:55], a[68:71], a[0:15]
    ds_read_b128 a[56:59], v11 offset:6832
    ds_read_b128 a[60:63], v11 offset:4272
    s_waitcnt lgkmcnt(9)
    v_mfma_f32_32x32x16_bf16 a[16:31], a[32:35], a[72:75], a[16:31]
    ds_read2_b32 a[44:45], v14 offset0:168 offset1:169
    ds_read2_b32 a[46:47], v14 offset0:170 offset1:171
    s_waitcnt lgkmcnt(10)
    v_mfma_f32_32x32x16_bf16 a[0:15], a[32:35], a[76:79], a[0:15]
    ds_read_b128 a[64:67], v11 offset:6800
    ds_read_b128 a[68:71], v11 offset:4240
    s_waitcnt lgkmcnt(9)
    v_mfma_f32_32x32x16_bf16 a[16:31], a[36:39], a[80:83], a[16:31]
    ds_read2_b32 a[48:49], v14 offset0:176 offset1:177
    ds_read2_b32 a[50:51], v14 offset0:178 offset1:179
    s_waitcnt lgkmcnt(10)
    v_mfma_f32_32x32x16_bf16 a[0:15], a[36:39], a[84:87], a[0:15]
    ds_read_b128 a[72:75], v11 offset:6752
    ds_read_b128 a[76:79], v11 offset:4192
    s_waitcnt lgkmcnt(9)
    v_mfma_f32_32x32x16_bf16 a[16:31], a[40:43], a[56:59], a[16:31]
    ds_read2_b32 a[52:53], v14 offset0:184 offset1:185
    ds_read2_b32 a[54:55], v14 offset0:186 offset1:187
    s_waitcnt lgkmcnt(10)
    v_mfma_f32_32x32x16_bf16 a[0:15], a[40:43], a[60:63], a[0:15]
    ds_read_b128 a[80:83], v11 offset:6720
    ds_read_b128 a[84:87], v11 offset:4160
    s_waitcnt lgkmcnt(9)
    v_mfma_f32_32x32x16_bf16 a[16:31], a[44:47], a[64:67], a[16:31]
    ds_read2_b32 a[32:33], v14 offset0:192 offset1:193
    ds_read2_b32 a[34:35], v14 offset0:194 offset1:195
    s_waitcnt lgkmcnt(10)
    v_mfma_f32_32x32x16_bf16 a[0:15], a[44:47], a[68:71], a[0:15]
    ds_read_b128 a[56:59], v11 offset:6672
    ds_read_b128 a[60:63], v11 offset:4112
    s_waitcnt lgkmcnt(9)
    v_mfma_f32_32x32x16_bf16 a[16:31], a[48:51], a[72:75], a[16:31]
    ds_read2_b32 a[36:37], v14 offset0:200 offset1:201
    ds_read2_b32 a[38:39], v14 offset0:202 offset1:203
    s_waitcnt lgkmcnt(10)
    v_mfma_f32_32x32x16_bf16 a[0:15], a[48:51], a[76:79], a[0:15]
    ds_read_b128 a[64:67], v11 offset:6640
    ds_read_b128 a[68:71], v11 offset:4080
    s_waitcnt lgkmcnt(9)
    v_mfma_f32_32x32x16_bf16 a[16:31], a[52:55], a[80:83], a[16:31]
    ds_read2_b32 a[40:41], v14 offset0:208 offset1:209
    ds_read2_b32 a[42:43], v14 offset0:210 offset1:211
    s_waitcnt lgkmcnt(10)
    v_mfma_f32_32x32x16_bf16 a[0:15], a[52:55], a[84:87], a[0:15]
    ds_read_b128 a[72:75], v11 offset:6592
    ds_read_b128 a[76:79], v11 offset:4032
    s_waitcnt lgkmcnt(9)
    v_mfma_f32_32x32x16_bf16 a[16:31], a[32:35], a[56:59], a[16:31]
    ds_read2_b32 a[44:45], v14 offset0:216 offset1:217
    ds_read2_b32 a[46:47], v14 offset0:218 offset1:219
    s_waitcnt lgkmcnt(10)
    v_mfma_f32_32x32x16_bf16 a[0:15], a[32:35], a[60:63], a[0:15]
    ds_read_b128 a[80:83], v11 offset:6560
    ds_read_b128 a[84:87], v11 offset:4000
    s_waitcnt lgkmcnt(9)
    v_mfma_f32_32x32x16_bf16 a[16:31], a[36:39], a[64:67], a[16:31]
    ds_read2_b32 a[48:49], v14 offset0:224 offset1:225
    ds_read2_b32 a[50:51], v14 offset0:226 offset1:227
    s_waitcnt lgkmcnt(10)
    v_mfma_f32_32x32x16_bf16 a[0:15], a[36:39], a[68:71], a[0:15]
    ds_read_b128 a[56:59], v11 offset:6512
    ds_read_b128 a[60:63], v11 offset:3952
    s_waitcnt lgkmcnt(9)
    v_mfma_f32_32x32x16_bf16 a[16:31], a[40:43], a[72:75], a[16:31]
    ds_read2_b32 a[52:53], v14 offset0:232 offset1:233
    ds_read2_b32 a[54:55], v14 offset0:234 offset1:235
    s_waitcnt lgkmcnt(10)
    v_mfma_f32_32x32x16_bf16 a[0:15], a[40:43], a[76:79], a[0:15]
    ds_read_b128 a[64:67], v11 offset:6480
    ds_read_b128 a[68:71], v11 offset:3920
    s_waitcnt lgkmcnt(9)
    v_mfma_f32_32x32x16_bf16 a[16:31], a[44:47], a[80:83], a[16:31]
    ds_read2_b32 a[32:33], v14 offset0:240 offset1:241
    ds_read2_b32 a[34:35], v14 offset0:242 offset1:243
    s_waitcnt lgkmcnt(10)
    v_mfma_f32_32x32x16_bf16 a[0:15], a[44:47], a[84:87], a[0:15]
    ds_read_b128 a[72:75], v11 offset:6432
    ds_read_b128 a[76:79], v11 offset:3872
    s_waitcnt lgkmcnt(9)
    v_mfma_f32_32x32x16_bf16 a[16:31], a[48:51], a[56:59], a[16:31]
    ds_read2_b32 a[36:37], v14 offset0:248 offset1:249
    ds_read2_b32 a[38:39], v14 offset0:250 offset1:251
    v_add_u32 v14, 1024, v14
    s_waitcnt lgkmcnt(10)
    v_mfma_f32_32x32x16_bf16 a[0:15], a[48:51], a[60:63], a[0:15]
    ds_read_b128 a[80:83], v11 offset:6400
    ds_read_b128 a[84:87], v11 offset:3840
    s_waitcnt lgkmcnt(9)
    v_mfma_f32_32x32x16_bf16 a[16:31], a[52:55], a[64:67], a[16:31]
    ds_read2_b32 a[40:41], v14 offset0:0 offset1:1
    ds_read2_b32 a[42:43], v14 offset0:2 offset1:3
    s_waitcnt lgkmcnt(10)
    v_mfma_f32_32x32x16_bf16 a[0:15], a[52:55], a[68:71], a[0:15]
    ds_read_b128 a[56:59], v11 offset:6352
    ds_read_b128 a[60:63], v11 offset:3792
    s_waitcnt lgkmcnt(9)
    v_mfma_f32_32x32x16_bf16 a[16:31], a[32:35], a[72:75], a[16:31]
    ds_read2_b32 a[44:45], v14 offset0:8 offset1:9
    ds_read2_b32 a[46:47], v14 offset0:10 offset1:11
    s_waitcnt lgkmcnt(10)
    v_mfma_f32_32x32x16_bf16 a[0:15], a[32:35], a[76:79], a[0:15]
    ds_read_b128 a[64:67], v11 offset:6320
    ds_read_b128 a[68:71], v11 offset:3760
    s_waitcnt lgkmcnt(9)
    v_mfma_f32_32x32x16_bf16 a[16:31], a[36:39], a[80:83], a[16:31]
    ds_read2_b32 a[48:49], v14 offset0:16 offset1:17
    ds_read2_b32 a[50:51], v14 offset0:18 offset1:19
    s_waitcnt lgkmcnt(10)
    v_mfma_f32_32x32x16_bf16 a[0:15], a[36:39], a[84:87], a[0:15]
    ds_read_b128 a[72:75], v11 offset:6272
    ds_read_b128 a[76:79], v11 offset:3712
    s_waitcnt lgkmcnt(9)
    v_mfma_f32_32x32x16_bf16 a[16:31], a[40:43], a[56:59], a[16:31]
    ds_read2_b32 a[52:53], v14 offset0:24 offset1:25
    ds_read2_b32 a[54:55], v14 offset0:26 offset1:27
    s_waitcnt lgkmcnt(10)
    v_mfma_f32_32x32x16_bf16 a[0:15], a[40:43], a[60:63], a[0:15]
    ds_read_b128 a[80:83], v11 offset:6240
    ds_read_b128 a[84:87], v11 offset:3680
    s_waitcnt lgkmcnt(9)
    v_mfma_f32_32x32x16_bf16 a[16:31], a[44:47], a[64:67], a[16:31]
    ds_read2_b32 a[32:33], v14 offset0:32 offset1:33
    ds_read2_b32 a[34:35], v14 offset0:34 offset1:35
    s_waitcnt lgkmcnt(10)
    v_mfma_f32_32x32x16_bf16 a[0:15], a[44:47], a[68:71], a[0:15]
    ds_read_b128 a[56:59], v11 offset:6192
    ds_read_b128 a[60:63], v11 offset:3632
    s_waitcnt lgkmcnt(9)
    v_mfma_f32_32x32x16_bf16 a[16:31], a[48:51], a[72:75], a[16:31]
    ds_read2_b32 a[36:37], v14 offset0:40 offset1:41
    ds_read2_b32 a[38:39], v14 offset0:42 offset1:43
    s_waitcnt lgkmcnt(10)
    v_mfma_f32_32x32x16_bf16 a[0:15], a[48:51], a[76:79], a[0:15]
    ds_read_b128 a[64:67], v11 offset:6160
    ds_read_b128 a[68:71], v11 offset:3600
    s_waitcnt lgkmcnt(9)
    v_mfma_f32_32x32x16_bf16 a[16:31], a[52:55], a[80:83], a[16:31]
    ds_read2_b32 a[40:41], v14 offset0:48 offset1:49
    ds_read2_b32 a[42:43], v14 offset0:50 offset1:51
    s_waitcnt lgkmcnt(10)
    v_mfma_f32_32x32x16_bf16 a[0:15], a[52:55], a[84:87], a[0:15]
    ds_read_b128 a[72:75], v11 offset:6112
    ds_read_b128 a[76:79], v11 offset:3552
    s_waitcnt lgkmcnt(9)
    v_mfma_f32_32x32x16_bf16 a[16:31], a[32:35], a[56:59], a[16:31]
    ds_read2_b32 a[44:45], v14 offset0:56 offset1:57
    ds_read2_b32 a[46:47], v14 offset0:58 offset1:59
    s_waitcnt lgkmcnt(10)
    v_mfma_f32_32x32x16_bf16 a[0:15], a[32:35], a[60:63], a[0:15]
    ds_read_b128 a[80:83], v11 offset:6080
    ds_read_b128 a[84:87], v11 offset:3520
    s_waitcnt lgkmcnt(9)
    v_mfma_f32_32x32x16_bf16 a[16:31], a[36:39], a[64:67], a[16:31]
    ds_read2_b32 a[48:49], v14 offset0:64 offset1:65
    ds_read2_b32 a[50:51], v14 offset0:66 offset1:67
    s_waitcnt lgkmcnt(10)
    v_mfma_f32_32x32x16_bf16 a[0:15], a[36:39], a[68:71], a[0:15]
    ds_read_b128 a[56:59], v11 offset:6032
    ds_read_b128 a[60:63], v11 offset:3472
    s_waitcnt lgkmcnt(9)
    v_mfma_f32_32x32x16_bf16 a[16:31], a[40:43], a[72:75], a[16:31]
    ds_read2_b32 a[52:53], v14 offset0:72 offset1:73
    ds_read2_b32 a[54:55], v14 offset0:74 offset1:75
    s_waitcnt lgkmcnt(10)
    v_mfma_f32_32x32x16_bf16 a[0:15], a[40:43], a[76:79], a[0:15]
    ds_read_b128 a[64:67], v11 offset:6000
    ds_read_b128 a[68:71], v11 offset:3440
    s_waitcnt lgkmcnt(9)
    v_mfma_f32_32x32x16_bf16 a[16:31], a[44:47], a[80:83], a[16:31]
    ds_read2_b32 a[32:33], v14 offset0:80 offset1:81
    ds_read2_b32 a[34:35], v14 offset0:82 offset1:83
    s_waitcnt lgkmcnt(10)
    v_mfma_f32_32x32x16_bf16 a[0:15], a[44:47], a[84:87], a[0:15]
    ds_read_b128 a[72:75], v11 offset:5952
    ds_read_b128 a[76:79], v11 offset:3392
    s_waitcnt lgkmcnt(9)
    v_mfma_f32_32x32x16_bf16 a[16:31], a[48:51], a[56:59], a[16:31]
    ds_read2_b32 a[36:37], v14 offset0:88 offset1:89
    ds_read2_b32 a[38:39], v14 offset0:90 offset1:91
    s_waitcnt lgkmcnt(10)
    v_mfma_f32_32x32x16_bf16 a[0:15], a[48:51], a[60:63], a[0:15]
    ds_read_b128 a[80:83], v11 offset:5920
    ds_read_b128 a[84:87], v11 offset:3360
    s_waitcnt lgkmcnt(9)
    v_mfma_f32_32x32x16_bf16 a[16:31], a[52:55], a[64:67], a[16:31]
    ds_read2_b32 a[40:41], v14 offset0:96 offset1:97
    ds_read2_b32 a[42:43], v14 offset0:98 offset1:99
    s_waitcnt lgkmcnt(10)
    v_mfma_f32_32x32x16_bf16 a[0:15], a[52:55], a[68:71], a[0:15]
    ds_read_b128 a[56:59], v11 offset:5872
    ds_read_b128 a[60:63], v11 offset:3312
    s_waitcnt lgkmcnt(9)
    v_mfma_f32_32x32x16_bf16 a[16:31], a[32:35], a[72:75], a[16:31]
    ds_read2_b32 a[44:45], v14 offset0:104 offset1:105
    ds_read2_b32 a[46:47], v14 offset0:106 offset1:107
    s_waitcnt lgkmcnt(10)
    v_mfma_f32_32x32x16_bf16 a[0:15], a[32:35], a[76:79], a[0:15]
    ds_read_b128 a[64:67], v11 offset:5840
    ds_read_b128 a[68:71], v11 offset:3280
    s_waitcnt lgkmcnt(9)
    v_mfma_f32_32x32x16_bf16 a[16:31], a[36:39], a[80:83], a[16:31]
    ds_read2_b32 a[48:49], v14 offset0:112 offset1:113
    ds_read2_b32 a[50:51], v14 offset0:114 offset1:115
    s_waitcnt lgkmcnt(10)
    v_mfma_f32_32x32x16_bf16 a[0:15], a[36:39], a[84:87], a[0:15]
    ds_read_b128 a[72:75], v11 offset:5792
    ds_read_b128 a[76:79], v11 offset:3232
    s_waitcnt lgkmcnt(9)
    v_mfma_f32_32x32x16_bf16 a[16:31], a[40:43], a[56:59], a[16:31]
    ds_read2_b32 a[52:53], v14 offset0:120 offset1:121
    ds_read2_b32 a[54:55], v14 offset0:122 offset1:123
    s_waitcnt lgkmcnt(10)
    v_mfma_f32_32x32x16_bf16 a[0:15], a[40:43], a[60:63], a[0:15]
    ds_read_b128 a[80:83], v11 offset:5760
    ds_read_b128 a[84:87], v11 offset:3200
    s_waitcnt lgkmcnt(9)
    v_mfma_f32_32x32x16_bf16 a[16:31], a[44:47], a[64:67], a[16:31]
    ds_read2_b32 a[32:33], v14 offset0:128 offset1:129
    ds_read2_b32 a[34:35], v14 offset0:130 offset1:131
    s_waitcnt lgkmcnt(10)
    v_mfma_f32_32x32x16_bf16 a[0:15], a[44:47], a[68:71], a[0:15]
    ds_read_b128 a[56:59], v11 offset:5712
    ds_read_b128 a[60:63], v11 offset:3152
    s_waitcnt lgkmcnt(9)
    v_mfma_f32_32x32x16_bf16 a[16:31], a[48:51], a[72:75], a[16:31]
    ds_read2_b32 a[36:37], v14 offset0:136 offset1:137
    ds_read2_b32 a[38:39], v14 offset0:138 offset1:139
    s_waitcnt lgkmcnt(10)
    v_mfma_f32_32x32x16_bf16 a[0:15], a[48:51], a[76:79], a[0:15]
    ds_read_b128 a[64:67], v11 offset:5680
    ds_read_b128 a[68:71], v11 offset:3120
    s_waitcnt lgkmcnt(9)
    v_mfma_f32_32x32x16_bf16 a[16:31], a[52:55], a[80:83], a[16:31]
    ds_read2_b32 a[40:41], v14 offset0:144 offset1:145
    ds_read2_b32 a[42:43], v14 offset0:146 offset1:147
    s_waitcnt lgkmcnt(10)
    v_mfma_f32_32x32x16_bf16 a[0:15], a[52:55], a[84:87], a[0:15]
    ds_read_b128 a[72:75], v11 offset:5632
    ds_read_b128 a[76:79], v11 offset:3072
    s_waitcnt lgkmcnt(9)
    v_mfma_f32_32x32x16_bf16 a[16:31], a[32:35], a[56:59], a[16:31]
    ds_read2_b32 a[44:45], v14 offset0:152 offset1:153
    ds_read2_b32 a[46:47], v14 offset0:154 offset1:155
    s_waitcnt lgkmcnt(10)
    v_mfma_f32_32x32x16_bf16 a[0:15], a[32:35], a[60:63], a[0:15]
    ds_read_b128 a[80:83], v11 offset:5600
    ds_read_b128 a[84:87], v11 offset:3040
    s_waitcnt lgkmcnt(9)
    v_mfma_f32_32x32x16_bf16 a[16:31], a[36:39], a[64:67], a[16:31]
    ds_read2_b32 a[48:49], v14 offset0:160 offset1:161
    ds_read2_b32 a[50:51], v14 offset0:162 offset1:163
    s_waitcnt lgkmcnt(10)
    v_mfma_f32_32x32x16_bf16 a[0:15], a[36:39], a[68:71], a[0:15]
    ds_read_b128 a[56:59], v11 offset:5552
    ds_read_b128 a[60:63], v11 offset:2992
    s_waitcnt lgkmcnt(9)
    v_mfma_f32_32x32x16_bf16 a[16:31], a[40:43], a[72:75], a[16:31]
    ds_read2_b32 a[52:53], v14 offset0:168 offset1:169
    ds_read2_b32 a[54:55], v14 offset0:170 offset1:171
    s_waitcnt lgkmcnt(10)
    v_mfma_f32_32x32x16_bf16 a[0:15], a[40:43], a[76:79], a[0:15]
    ds_read_b128 a[64:67], v11 offset:5520
    ds_read_b128 a[68:71], v11 offset:2960
    s_waitcnt lgkmcnt(9)
    v_mfma_f32_32x32x16_bf16 a[16:31], a[44:47], a[80:83], a[16:31]
    ds_read2_b32 a[32:33], v14 offset0:176 offset1:177
    ds_read2_b32 a[34:35], v14 offset0:178 offset1:179
    s_waitcnt lgkmcnt(10)
    v_mfma_f32_32x32x16_bf16 a[0:15], a[44:47], a[84:87], a[0:15]
    ds_read_b128 a[72:75], v11 offset:5472
    ds_read_b128 a[76:79], v11 offset:2912
    s_waitcnt lgkmcnt(9)
    v_mfma_f32_32x32x16_bf16 a[16:31], a[48:51], a[56:59], a[16:31]
    ds_read2_b32 a[36:37], v14 offset0:184 offset1:185
    ds_read2_b32 a[38:39], v14 offset0:186 offset1:187
    s_waitcnt lgkmcnt(10)
    v_mfma_f32_32x32x16_bf16 a[0:15], a[48:51], a[60:63], a[0:15]
    ds_read_b128 a[80:83], v11 offset:5440
    ds_read_b128 a[84:87], v11 offset:2880
    s_waitcnt lgkmcnt(9)
    v_mfma_f32_32x32x16_bf16 a[16:31], a[52:55], a[64:67], a[16:31]
    ds_read2_b32 a[40:41], v14 offset0:192 offset1:193
    ds_read2_b32 a[42:43], v14 offset0:194 offset1:195
    s_waitcnt lgkmcnt(10)
    v_mfma_f32_32x32x16_bf16 a[0:15], a[52:55], a[68:71], a[0:15]
    ds_read_b128 a[56:59], v11 offset:5392
    ds_read_b128 a[60:63], v11 offset:2832
    s_waitcnt lgkmcnt(9)
    v_mfma_f32_32x32x16_bf16 a[16:31], a[32:35], a[72:75], a[16:31]
    ds_read2_b32 a[44:45], v14 offset0:200 offset1:201
    ds_read2_b32 a[46:47], v14 offset0:202 offset1:203
    s_waitcnt lgkmcnt(10)
    v_mfma_f32_32x32x16_bf16 a[0:15], a[32:35], a[76:79], a[0:15]
    ds_read_b128 a[64:67], v11 offset:5360
    ds_read_b128 a[68:71], v11 offset:2800
    s_waitcnt lgkmcnt(9)
    v_mfma_f32_32x32x16_bf16 a[16:31], a[36:39], a[80:83], a[16:31]
    ds_read2_b32 a[48:49], v14 offset0:208 offset1:209
    ds_read2_b32 a[50:51], v14 offset0:210 offset1:211
    s_waitcnt lgkmcnt(10)
    v_mfma_f32_32x32x16_bf16 a[0:15], a[36:39], a[84:87], a[0:15]
    ds_read_b128 a[72:75], v11 offset:5312
    ds_read_b128 a[76:79], v11 offset:2752
    s_waitcnt lgkmcnt(9)
    v_mfma_f32_32x32x16_bf16 a[16:31], a[40:43], a[56:59], a[16:31]
    ds_read2_b32 a[52:53], v14 offset0:216 offset1:217
    ds_read2_b32 a[54:55], v14 offset0:218 offset1:219
    s_waitcnt lgkmcnt(10)
    v_mfma_f32_32x32x16_bf16 a[0:15], a[40:43], a[60:63], a[0:15]
    ds_read_b128 a[80:83], v11 offset:5280
    ds_read_b128 a[84:87], v11 offset:2720
    s_waitcnt lgkmcnt(9)
    v_mfma_f32_32x32x16_bf16 a[16:31], a[44:47], a[64:67], a[16:31]
    ds_read2_b32 a[32:33], v14 offset0:224 offset1:225
    ds_read2_b32 a[34:35], v14 offset0:226 offset1:227
    s_waitcnt lgkmcnt(10)
    v_mfma_f32_32x32x16_bf16 a[0:15], a[44:47], a[68:71], a[0:15]
    ds_read_b128 a[56:59], v11 offset:5232
    ds_read_b128 a[60:63], v11 offset:2672
    s_waitcnt lgkmcnt(9)
    v_mfma_f32_32x32x16_bf16 a[16:31], a[48:51], a[72:75], a[16:31]
    ds_read2_b32 a[36:37], v14 offset0:232 offset1:233
    ds_read2_b32 a[38:39], v14 offset0:234 offset1:235
    s_waitcnt lgkmcnt(10)
    v_mfma_f32_32x32x16_bf16 a[0:15], a[48:51], a[76:79], a[0:15]
    ds_read_b128 a[64:67], v11 offset:5200
    ds_read_b128 a[68:71], v11 offset:2640
    s_waitcnt lgkmcnt(9)
    v_mfma_f32_32x32x16_bf16 a[16:31], a[52:55], a[80:83], a[16:31]
    ds_read2_b32 a[40:41], v14 offset0:240 offset1:241
    ds_read2_b32 a[42:43], v14 offset0:242 offset1:243
    s_waitcnt lgkmcnt(10)
    v_mfma_f32_32x32x16_bf16 a[0:15], a[52:55], a[84:87], a[0:15]
    ds_read_b128 a[72:75], v11 offset:5152
    ds_read_b128 a[76:79], v11 offset:2592
    s_waitcnt lgkmcnt(9)
    v_mfma_f32_32x32x16_bf16 a[16:31], a[32:35], a[56:59], a[16:31]
    ds_read2_b32 a[44:45], v14 offset0:248 offset1:249
    ds_read2_b32 a[46:47], v14 offset0:250 offset1:251
    v_add_u32 v14, 1024, v14
    s_waitcnt lgkmcnt(10)
    v_mfma_f32_32x32x16_bf16 a[0:15], a[32:35], a[60:63], a[0:15]
    ds_read_b128 a[80:83], v11 offset:5120
    ds_read_b128 a[84:87], v11 offset:2560
    s_waitcnt lgkmcnt(9)
    v_mfma_f32_32x32x16_bf16 a[16:31], a[36:39], a[64:67], a[16:31]
    ds_read2_b32 a[48:49], v14 offset0:0 offset1:1
    ds_read2_b32 a[50:51], v14 offset0:2 offset1:3
    s_waitcnt lgkmcnt(10)
    v_mfma_f32_32x32x16_bf16 a[0:15], a[36:39], a[68:71], a[0:15]
    ds_read_b128 a[56:59], v11 offset:5072
    ds_read2_b32 a[52:53], v14 offset0:8 offset1:9
    ds_read2_b32 a[54:55], v14 offset0:10 offset1:11
    s_waitcnt lgkmcnt(10)
    v_mfma_f32_32x32x16_bf16 a[16:31], a[40:43], a[72:75], a[16:31]
    ds_read_b128 a[60:63], v11 offset:5040
    s_waitcnt lgkmcnt(10)
    v_mfma_f32_32x32x16_bf16 a[0:15], a[40:43], a[76:79], a[0:15]
    ds_read2_b32 a[32:33], v14 offset0:16 offset1:17
    ds_read2_b32 a[34:35], v14 offset0:18 offset1:19
    ds_read_b128 a[64:67], v11 offset:4992
    s_waitcnt lgkmcnt(10)
    v_mfma_f32_32x32x16_bf16 a[16:31], a[44:47], a[80:83], a[16:31]
    ds_read2_b32 a[36:37], v14 offset0:24 offset1:25
    ds_read2_b32 a[38:39], v14 offset0:26 offset1:27
    s_waitcnt lgkmcnt(11)
    v_mfma_f32_32x32x16_bf16 a[0:15], a[44:47], a[84:87], a[0:15]
    ds_read_b128 a[68:71], v11 offset:4960
    ds_read2_b32 a[40:41], v14 offset0:32 offset1:33
    ds_read2_b32 a[42:43], v14 offset0:34 offset1:35
    s_waitcnt lgkmcnt(11)
    v_mfma_f32_32x32x16_bf16 a[16:31], a[48:51], a[56:59], a[16:31]
    ds_read_b128 a[72:75], v11 offset:4912
    ds_read2_b32 a[44:45], v14 offset0:40 offset1:41
    ds_read2_b32 a[46:47], v14 offset0:42 offset1:43
    s_waitcnt lgkmcnt(11)
    v_mfma_f32_32x32x16_bf16 a[16:31], a[52:55], a[60:63], a[16:31]
    ds_read_b128 a[76:79], v11 offset:4880
    ds_read2_b32 a[48:49], v14 offset0:48 offset1:49
    ds_read2_b32 a[50:51], v14 offset0:50 offset1:51
    s_waitcnt lgkmcnt(11)
    v_mfma_f32_32x32x16_bf16 a[16:31], a[32:35], a[64:67], a[16:31]
    ds_read_b128 a[80:83], v11 offset:4832
    ds_read2_b32 a[52:53], v14 offset0:56 offset1:57
    ds_read2_b32 a[54:55], v14 offset0:58 offset1:59
    s_waitcnt lgkmcnt(11)
    v_mfma_f32_32x32x16_bf16 a[16:31], a[36:39], a[68:71], a[16:31]
    ds_read_b128 a[84:87], v11 offset:4800
    ds_read2_b32 a[32:33], v14 offset0:64 offset1:65
    ds_read2_b32 a[34:35], v14 offset0:66 offset1:67
    s_waitcnt lgkmcnt(11)
    v_mfma_f32_32x32x16_bf16 a[16:31], a[40:43], a[72:75], a[16:31]
    ds_read_b128 a[56:59], v11 offset:4752
    ds_read2_b32 a[36:37], v14 offset0:72 offset1:73
    ds_read2_b32 a[38:39], v14 offset0:74 offset1:75
    s_waitcnt lgkmcnt(11)
    v_mfma_f32_32x32x16_bf16 a[16:31], a[44:47], a[76:79], a[16:31]
    ds_read_b128 a[60:63], v11 offset:4720
    ds_read2_b32 a[40:41], v14 offset0:80 offset1:81
    ds_read2_b32 a[42:43], v14 offset0:82 offset1:83
    s_waitcnt lgkmcnt(11)
    v_mfma_f32_32x32x16_bf16 a[16:31], a[48:51], a[80:83], a[16:31]
    ds_read_b128 a[64:67], v11 offset:4672
    ds_read2_b32 a[44:45], v14 offset0:88 offset1:89
    ds_read2_b32 a[46:47], v14 offset0:90 offset1:91
    s_waitcnt lgkmcnt(11)
    v_mfma_f32_32x32x16_bf16 a[16:31], a[52:55], a[84:87], a[16:31]
    ds_read_b128 a[68:71], v11 offset:4640
    ds_read2_b32 a[48:49], v14 offset0:96 offset1:97
    ds_read2_b32 a[50:51], v14 offset0:98 offset1:99
    s_waitcnt lgkmcnt(11)
    v_mfma_f32_32x32x16_bf16 a[16:31], a[32:35], a[56:59], a[16:31]
    ds_read_b128 a[72:75], v11 offset:4592
    ds_read2_b32 a[52:53], v14 offset0:104 offset1:105
    ds_read2_b32 a[54:55], v14 offset0:106 offset1:107
    s_waitcnt lgkmcnt(11)
    v_mfma_f32_32x32x16_bf16 a[16:31], a[36:39], a[60:63], a[16:31]
    ds_read_b128 a[76:79], v11 offset:4560
    ds_read2_b32 a[32:33], v14 offset0:112 offset1:113
    ds_read2_b32 a[34:35], v14 offset0:114 offset1:115
    s_waitcnt lgkmcnt(11)
    v_mfma_f32_32x32x16_bf16 a[16:31], a[40:43], a[64:67], a[16:31]
    ds_read_b128 a[80:83], v11 offset:4512
    ds_read2_b32 a[36:37], v14 offset0:120 offset1:121
    ds_read2_b32 a[38:39], v14 offset0:122 offset1:123
    s_waitcnt lgkmcnt(11)
    v_mfma_f32_32x32x16_bf16 a[16:31], a[44:47], a[68:71], a[16:31]
    ds_read_b128 a[84:87], v11 offset:4480
    ds_read2_b32 a[40:41], v14 offset0:128 offset1:129
    ds_read2_b32 a[42:43], v14 offset0:130 offset1:131
    s_waitcnt lgkmcnt(11)
    v_mfma_f32_32x32x16_bf16 a[16:31], a[48:51], a[72:75], a[16:31]
    ds_read_b128 a[56:59], v11 offset:4432
    ds_read2_b32 a[44:45], v14 offset0:136 offset1:137
    ds_read2_b32 a[46:47], v14 offset0:138 offset1:139
    s_waitcnt lgkmcnt(11)
    v_mfma_f32_32x32x16_bf16 a[16:31], a[52:55], a[76:79], a[16:31]
    ds_read_b128 a[60:63], v11 offset:4400
    ds_read2_b32 a[48:49], v14 offset0:144 offset1:145
    ds_read2_b32 a[50:51], v14 offset0:146 offset1:147
    s_waitcnt lgkmcnt(11)
    v_mfma_f32_32x32x16_bf16 a[16:31], a[32:35], a[80:83], a[16:31]
    ds_read_b128 a[64:67], v11 offset:4352
    ds_read2_b32 a[52:53], v14 offset0:152 offset1:153
    ds_read2_b32 a[54:55], v14 offset0:154 offset1:155
    s_waitcnt lgkmcnt(11)
    v_mfma_f32_32x32x16_bf16 a[16:31], a[36:39], a[84:87], a[16:31]
    ds_read_b128 a[68:71], v11 offset:4320
    ds_read2_b32 a[32:33], v14 offset0:160 offset1:161
    ds_read2_b32 a[34:35], v14 offset0:162 offset1:163
    s_waitcnt lgkmcnt(11)
    v_mfma_f32_32x32x16_bf16 a[16:31], a[40:43], a[56:59], a[16:31]
    ds_read_b128 a[72:75], v11 offset:4272
    ds_read2_b32 a[36:37], v14 offset0:168 offset1:169
    ds_read2_b32 a[38:39], v14 offset0:170 offset1:171
    s_waitcnt lgkmcnt(11)
    v_mfma_f32_32x32x16_bf16 a[16:31], a[44:47], a[60:63], a[16:31]
    ds_read_b128 a[76:79], v11 offset:4240
    ds_read2_b32 a[40:41], v14 offset0:176 offset1:177
    ds_read2_b32 a[42:43], v14 offset0:178 offset1:179
    s_waitcnt lgkmcnt(11)
    v_mfma_f32_32x32x16_bf16 a[16:31], a[48:51], a[64:67], a[16:31]
    ds_read_b128 a[80:83], v11 offset:4192
    ds_read2_b32 a[44:45], v14 offset0:184 offset1:185
    ds_read2_b32 a[46:47], v14 offset0:186 offset1:187
    s_waitcnt lgkmcnt(11)
    v_mfma_f32_32x32x16_bf16 a[16:31], a[52:55], a[68:71], a[16:31]
    ds_read_b128 a[84:87], v11 offset:4160
    ds_read2_b32 a[48:49], v14 offset0:192 offset1:193
    ds_read2_b32 a[50:51], v14 offset0:194 offset1:195
    s_waitcnt lgkmcnt(11)
    v_mfma_f32_32x32x16_bf16 a[16:31], a[32:35], a[72:75], a[16:31]
    ds_read_b128 a[56:59], v11 offset:4112
    ds_read2_b32 a[52:53], v14 offset0:200 offset1:201
    ds_read2_b32 a[54:55], v14 offset0:202 offset1:203
    s_waitcnt lgkmcnt(11)
    v_mfma_f32_32x32x16_bf16 a[16:31], a[36:39], a[76:79], a[16:31]
    ds_read_b128 a[60:63], v11 offset:4080
    ds_read2_b32 a[32:33], v14 offset0:208 offset1:209
    ds_read2_b32 a[34:35], v14 offset0:210 offset1:211
    s_waitcnt lgkmcnt(11)
    v_mfma_f32_32x32x16_bf16 a[16:31], a[40:43], a[80:83], a[16:31]
    ds_read_b128 a[64:67], v11 offset:4032
    ds_read2_b32 a[36:37], v14 offset0:216 offset1:217
    ds_read2_b32 a[38:39], v14 offset0:218 offset1:219
    s_waitcnt lgkmcnt(11)
    v_mfma_f32_32x32x16_bf16 a[16:31], a[44:47], a[84:87], a[16:31]
    ds_read_b128 a[68:71], v11 offset:4000
    ds_read2_b32 a[40:41], v14 offset0:224 offset1:225
    ds_read2_b32 a[42:43], v14 offset0:226 offset1:227
    s_waitcnt lgkmcnt(11)
    v_mfma_f32_32x32x16_bf16 a[16:31], a[48:51], a[56:59], a[16:31]
    ds_read_b128 a[72:75], v11 offset:3952
    ds_read2_b32 a[44:45], v14 offset0:232 offset1:233
    ds_read2_b32 a[46:47], v14 offset0:234 offset1:235
    s_waitcnt lgkmcnt(11)
    v_mfma_f32_32x32x16_bf16 a[16:31], a[52:55], a[60:63], a[16:31]
    ds_read_b128 a[76:79], v11 offset:3920
    ds_read2_b32 a[48:49], v14 offset0:240 offset1:241
    ds_read2_b32 a[50:51], v14 offset0:242 offset1:243
    s_waitcnt lgkmcnt(11)
    v_mfma_f32_32x32x16_bf16 a[16:31], a[32:35], a[64:67], a[16:31]
    ds_read_b128 a[80:83], v11 offset:3872
    ds_read2_b32 a[52:53], v14 offset0:248 offset1:249
    ds_read2_b32 a[54:55], v14 offset0:250 offset1:251
    v_add_u32 v14, 1024, v14
    s_waitcnt lgkmcnt(11)
    v_mfma_f32_32x32x16_bf16 a[16:31], a[36:39], a[68:71], a[16:31]
    ds_read_b128 a[84:87], v11 offset:3840
    ds_read2_b32 a[32:33], v14 offset0:0 offset1:1
    ds_read2_b32 a[34:35], v14 offset0:2 offset1:3
    s_waitcnt lgkmcnt(11)
    v_mfma_f32_32x32x16_bf16 a[16:31], a[40:43], a[72:75], a[16:31]
    ds_read_b128 a[56:59], v11 offset:3792
    ds_read2_b32 a[36:37], v14 offset0:8 offset1:9
    ds_read2_b32 a[38:39], v14 offset0:10 offset1:11
    s_waitcnt lgkmcnt(11)
    v_mfma_f32_32x32x16_bf16 a[16:31], a[44:47], a[76:79], a[16:31]
    ds_read_b128 a[60:63], v11 offset:3760
    ds_read2_b32 a[40:41], v14 offset0:16 offset1:17
    ds_read2_b32 a[42:43], v14 offset0:18 offset1:19
    s_waitcnt lgkmcnt(11)
    v_mfma_f32_32x32x16_bf16 a[16:31], a[48:51], a[80:83], a[16:31]
    ds_read_b128 a[64:67], v11 offset:3712
    ds_read2_b32 a[44:45], v14 offset0:24 offset1:25
    ds_read2_b32 a[46:47], v14 offset0:26 offset1:27
    s_waitcnt lgkmcnt(11)
    v_mfma_f32_32x32x16_bf16 a[16:31], a[52:55], a[84:87], a[16:31]
    ds_read_b128 a[68:71], v11 offset:3680
    ds_read2_b32 a[48:49], v14 offset0:32 offset1:33
    ds_read2_b32 a[50:51], v14 offset0:34 offset1:35
    s_waitcnt lgkmcnt(11)
    v_mfma_f32_32x32x16_bf16 a[16:31], a[32:35], a[56:59], a[16:31]
    ds_read_b128 a[72:75], v11 offset:3632
    ds_read2_b32 a[52:53], v14 offset0:40 offset1:41
    ds_read2_b32 a[54:55], v14 offset0:42 offset1:43
    s_waitcnt lgkmcnt(11)
    v_mfma_f32_32x32x16_bf16 a[16:31], a[36:39], a[60:63], a[16:31]
    ds_read_b128 a[76:79], v11 offset:3600
    ds_read2_b32 a[32:33], v14 offset0:48 offset1:49
    ds_read2_b32 a[34:35], v14 offset0:50 offset1:51
    s_waitcnt lgkmcnt(11)
    v_mfma_f32_32x32x16_bf16 a[16:31], a[40:43], a[64:67], a[16:31]
    ds_read_b128 a[80:83], v11 offset:3552
    ds_read2_b32 a[36:37], v14 offset0:56 offset1:57
    ds_read2_b32 a[38:39], v14 offset0:58 offset1:59
    s_waitcnt lgkmcnt(11)
    v_mfma_f32_32x32x16_bf16 a[16:31], a[44:47], a[68:71], a[16:31]
    ds_read_b128 a[84:87], v11 offset:3520
    ds_read2_b32 a[40:41], v14 offset0:64 offset1:65
    ds_read2_b32 a[42:43], v14 offset0:66 offset1:67
    s_waitcnt lgkmcnt(11)
    v_mfma_f32_32x32x16_bf16 a[16:31], a[48:51], a[72:75], a[16:31]
    ds_read_b128 a[56:59], v11 offset:3472
    ds_read2_b32 a[44:45], v14 offset0:72 offset1:73
    ds_read2_b32 a[46:47], v14 offset0:74 offset1:75
    s_waitcnt lgkmcnt(11)
    v_mfma_f32_32x32x16_bf16 a[16:31], a[52:55], a[76:79], a[16:31]
    ds_read_b128 a[60:63], v11 offset:3440
    ds_read2_b32 a[48:49], v14 offset0:80 offset1:81
    ds_read2_b32 a[50:51], v14 offset0:82 offset1:83
    s_waitcnt lgkmcnt(11)
    v_mfma_f32_32x32x16_bf16 a[16:31], a[32:35], a[80:83], a[16:31]
    ds_read_b128 a[64:67], v11 offset:3392
    ds_read2_b32 a[52:53], v14 offset0:88 offset1:89
    ds_read2_b32 a[54:55], v14 offset0:90 offset1:91
    s_waitcnt lgkmcnt(11)
    v_mfma_f32_32x32x16_bf16 a[16:31], a[36:39], a[84:87], a[16:31]
    ds_read_b128 a[68:71], v11 offset:3360
    ds_read2_b32 a[32:33], v14 offset0:96 offset1:97
    ds_read2_b32 a[34:35], v14 offset0:98 offset1:99
    s_waitcnt lgkmcnt(11)
    v_mfma_f32_32x32x16_bf16 a[16:31], a[40:43], a[56:59], a[16:31]
    ds_read_b128 a[72:75], v11 offset:3312
    ds_read2_b32 a[36:37], v14 offset0:104 offset1:105
    ds_read2_b32 a[38:39], v14 offset0:106 offset1:107
    s_waitcnt lgkmcnt(11)
    v_mfma_f32_32x32x16_bf16 a[16:31], a[44:47], a[60:63], a[16:31]
    ds_read_b128 a[76:79], v11 offset:3280
    ds_read2_b32 a[40:41], v14 offset0:112 offset1:113
    ds_read2_b32 a[42:43], v14 offset0:114 offset1:115
    s_waitcnt lgkmcnt(11)
    v_mfma_f32_32x32x16_bf16 a[16:31], a[48:51], a[64:67], a[16:31]
    ds_read_b128 a[80:83], v11 offset:3232
    ds_read2_b32 a[44:45], v14 offset0:120 offset1:121
    ds_read2_b32 a[46:47], v14 offset0:122 offset1:123
    s_waitcnt lgkmcnt(11)
    v_mfma_f32_32x32x16_bf16 a[16:31], a[52:55], a[68:71], a[16:31]
    ds_read_b128 a[84:87], v11 offset:3200
    ds_read2_b32 a[48:49], v14 offset0:128 offset1:129
    ds_read2_b32 a[50:51], v14 offset0:130 offset1:131
    s_waitcnt lgkmcnt(11)
    v_mfma_f32_32x32x16_bf16 a[16:31], a[32:35], a[72:75], a[16:31]
    ds_read_b128 a[56:59], v11 offset:3152
    ds_read2_b32 a[52:53], v14 offset0:136 offset1:137
    ds_read2_b32 a[54:55], v14 offset0:138 offset1:139
    s_waitcnt lgkmcnt(11)
    v_mfma_f32_32x32x16_bf16 a[16:31], a[36:39], a[76:79], a[16:31]
    ds_read_b128 a[60:63], v11 offset:3120
    ds_read2_b32 a[32:33], v14 offset0:144 offset1:145
    ds_read2_b32 a[34:35], v14 offset0:146 offset1:147
    s_waitcnt lgkmcnt(11)
    v_mfma_f32_32x32x16_bf16 a[16:31], a[40:43], a[80:83], a[16:31]
    ds_read_b128 a[64:67], v11 offset:3072
    ds_read2_b32 a[36:37], v14 offset0:152 offset1:153
    ds_read2_b32 a[38:39], v14 offset0:154 offset1:155
    s_waitcnt lgkmcnt(11)
    v_mfma_f32_32x32x16_bf16 a[16:31], a[44:47], a[84:87], a[16:31]
    ds_read_b128 a[68:71], v11 offset:3040
    ds_read2_b32 a[40:41], v14 offset0:160 offset1:161
    ds_read2_b32 a[42:43], v14 offset0:162 offset1:163
    s_waitcnt lgkmcnt(11)
    v_mfma_f32_32x32x16_bf16 a[16:31], a[48:51], a[56:59], a[16:31]
    ds_read_b128 a[72:75], v11 offset:2992
    ds_read2_b32 a[44:45], v14 offset0:168 offset1:169
    ds_read2_b32 a[46:47], v14 offset0:170 offset1:171
    s_waitcnt lgkmcnt(11)
    v_mfma_f32_32x32x16_bf16 a[16:31], a[52:55], a[60:63], a[16:31]
    ds_read_b128 a[76:79], v11 offset:2960
    ds_read2_b32 a[48:49], v14 offset0:176 offset1:177
    ds_read2_b32 a[50:51], v14 offset0:178 offset1:179
    s_waitcnt lgkmcnt(11)
    v_mfma_f32_32x32x16_bf16 a[16:31], a[32:35], a[64:67], a[16:31]
    ds_read_b128 a[80:83], v11 offset:2912
    ds_read2_b32 a[52:53], v14 offset0:184 offset1:185
    ds_read2_b32 a[54:55], v14 offset0:186 offset1:187
    s_waitcnt lgkmcnt(11)
    v_mfma_f32_32x32x16_bf16 a[16:31], a[36:39], a[68:71], a[16:31]
    ds_read_b128 a[84:87], v11 offset:2880
    ds_read2_b32 a[32:33], v14 offset0:192 offset1:193
    ds_read2_b32 a[34:35], v14 offset0:194 offset1:195
    s_waitcnt lgkmcnt(11)
    v_mfma_f32_32x32x16_bf16 a[16:31], a[40:43], a[72:75], a[16:31]
    ds_read_b128 a[56:59], v11 offset:2832
    ds_read2_b32 a[36:37], v14 offset0:200 offset1:201
    ds_read2_b32 a[38:39], v14 offset0:202 offset1:203
    s_waitcnt lgkmcnt(11)
    v_mfma_f32_32x32x16_bf16 a[16:31], a[44:47], a[76:79], a[16:31]
    ds_read_b128 a[60:63], v11 offset:2800
    ds_read2_b32 a[40:41], v14 offset0:208 offset1:209
    ds_read2_b32 a[42:43], v14 offset0:210 offset1:211
    s_waitcnt lgkmcnt(11)
    v_mfma_f32_32x32x16_bf16 a[16:31], a[48:51], a[80:83], a[16:31]
    ds_read_b128 a[64:67], v11 offset:2752
    ds_read2_b32 a[44:45], v14 offset0:216 offset1:217
    ds_read2_b32 a[46:47], v14 offset0:218 offset1:219
    s_waitcnt lgkmcnt(11)
    v_mfma_f32_32x32x16_bf16 a[16:31], a[52:55], a[84:87], a[16:31]
    ds_read_b128 a[68:71], v11 offset:2720
    ds_read2_b32 a[48:49], v14 offset0:224 offset1:225
    ds_read2_b32 a[50:51], v14 offset0:226 offset1:227
    s_waitcnt lgkmcnt(11)
    v_mfma_f32_32x32x16_bf16 a[16:31], a[32:35], a[56:59], a[16:31]
    ds_read_b128 a[72:75], v11 offset:2672
    ds_read2_b32 a[52:53], v14 offset0:232 offset1:233
    ds_read2_b32 a[54:55], v14 offset0:234 offset1:235
    s_waitcnt lgkmcnt(11)
    v_mfma_f32_32x32x16_bf16 a[16:31], a[36:39], a[60:63], a[16:31]
    ds_read_b128 a[76:79], v11 offset:2640
    ds_read2_b32 a[32:33], v14 offset0:240 offset1:241
    ds_read2_b32 a[34:35], v14 offset0:242 offset1:243
    s_waitcnt lgkmcnt(11)
    v_mfma_f32_32x32x16_bf16 a[16:31], a[40:43], a[64:67], a[16:31]
    ds_read_b128 a[80:83], v11 offset:2592
    ds_read2_b32 a[36:37], v14 offset0:248 offset1:249
    ds_read2_b32 a[38:39], v14 offset0:250 offset1:251
    v_add_u32 v14, 1024, v14
    s_waitcnt lgkmcnt(11)
    v_mfma_f32_32x32x16_bf16 a[16:31], a[44:47], a[68:71], a[16:31]
    ds_read_b128 a[84:87], v11 offset:2560
    s_waitcnt lgkmcnt(9)
    v_mfma_f32_32x32x16_bf16 a[16:31], a[48:51], a[72:75], a[16:31]
    s_waitcnt lgkmcnt(6)
    v_mfma_f32_32x32x16_bf16 a[16:31], a[52:55], a[76:79], a[16:31]
    s_waitcnt lgkmcnt(3)
    v_mfma_f32_32x32x16_bf16 a[16:31], a[32:35], a[80:83], a[16:31]
    s_waitcnt lgkmcnt(0)
    v_mfma_f32_32x32x16_bf16 a[16:31], a[36:39], a[84:87], a[16:31]
    v_accvgpr_read_b32 v220, a0
    v_accvgpr_read_b32 v221, a1
    v_accvgpr_read_b32 v222, a2
    v_accvgpr_read_b32 v223, a3
    v_accvgpr_read_b32 v224, a4
    v_accvgpr_read_b32 v225, a5
    v_accvgpr_read_b32 v226, a6
    v_accvgpr_read_b32 v227, a7
    v_accvgpr_read_b32 v228, a8
    v_accvgpr_read_b32 v229, a9
    v_accvgpr_read_b32 v230, a10
    v_accvgpr_read_b32 v231, a11
    v_accvgpr_read_b32 v232, a12
    v_accvgpr_read_b32 v233, a13
    v_accvgpr_read_b32 v234, a14
    v_accvgpr_read_b32 v235, a15
    v_cvt_pk_bf16_f32 v236, v220, v221
    v_cvt_pk_bf16_f32 v237, v222, v223
    v_cvt_pk_bf16_f32 v238, v224, v225
    v_cvt_pk_bf16_f32 v239, v226, v227
    v_cvt_pk_bf16_f32 v240, v228, v229
    v_cvt_pk_bf16_f32 v241, v230, v231
    v_cvt_pk_bf16_f32 v242, v232, v233
    v_cvt_pk_bf16_f32 v243, v234, v235
    s_nop 0
    v_permlane32_swap_b32 v236, v238
    v_permlane32_swap_b32 v237, v239
    v_permlane32_swap_b32 v240, v242
    v_permlane32_swap_b32 v241, v243
    buffer_store_dwordx4 v[236:239], v2, s[8:11], s7 offen offset:0 sc1
    buffer_store_dwordx4 v[240:243], v2, s[8:11], s7 offen offset:1024 sc1
    v_accvgpr_read_b32 v220, a16
    v_accvgpr_read_b32 v221, a17
    v_accvgpr_read_b32 v222, a18
    v_accvgpr_read_b32 v223, a19
    v_accvgpr_read_b32 v224, a20
    v_accvgpr_read_b32 v225, a21
    v_accvgpr_read_b32 v226, a22
    v_accvgpr_read_b32 v227, a23
    v_accvgpr_read_b32 v228, a24
    v_accvgpr_read_b32 v229, a25
    v_accvgpr_read_b32 v230, a26
    v_accvgpr_read_b32 v231, a27
    v_accvgpr_read_b32 v232, a28
    v_accvgpr_read_b32 v233, a29
    v_accvgpr_read_b32 v234, a30
    v_accvgpr_read_b32 v235, a31
    v_cvt_pk_bf16_f32 v236, v220, v221
    v_cvt_pk_bf16_f32 v237, v222, v223
    v_cvt_pk_bf16_f32 v238, v224, v225
    v_cvt_pk_bf16_f32 v239, v226, v227
    v_cvt_pk_bf16_f32 v240, v228, v229
    v_cvt_pk_bf16_f32 v241, v230, v231
    v_cvt_pk_bf16_f32 v242, v232, v233
    v_cvt_pk_bf16_f32 v243, v234, v235
    s_nop 0
    v_permlane32_swap_b32 v236, v238
    v_permlane32_swap_b32 v237, v239
    v_permlane32_swap_b32 v240, v242
    v_permlane32_swap_b32 v241, v243
    buffer_store_dwordx4 v[236:239], v2, s[8:11], s7 offen offset:2048 sc1
    buffer_store_dwordx4 v[240:243], v2, s[8:11], s7 offen offset:3072 sc1
    v_add_u32 v11, 30720, v11
    s_add_u32 s64, s64, 1
    s_cmp_lt_u32 s64, 4
    s_waitcnt vmcnt(4)
    s_cbranch_scc1 .chan_198
    s_waitcnt vmcnt(0)
    s_barrier
    s_cmp_lg_u32 s24, 0
    s_cbranch_scc1 .sg_203
    s_mov_b64 exec, 1
    v_mov_b32 v4, 1
    v_mov_b32 v5, 0
    buffer_atomic_add v4, v5, s[20:23], 0 offen offset:192 sc1
    s_mov_b64 exec, -1
.sg_203:
    s_cmp_eq_u32 s98, 3
    s_cbranch_scc1 .ph2_195
.qkv_196:
    s_lshl_b32 s4, s98, 3
    s_add_u32 s4, s4, 64
    s_load_dwordx2 s[40:41], s[0:1], 0
    s_load_dwordx2 s[42:43], s[0:1], s4
    s_lshl_b32 s4, s99, 8
    s_lshl_b32 s6, s24, 14
    s_lshl_b32 s5, s24, 19
    s_add_u32 s4, s4, s5
    v_bfe_u32 v2, v1, 4, 1
    v_lshlrev_b32 v2, 2, v2
    v_and_b32 v3, 7, v1
    v_xor_b32 v2, v2, v3
    v_lshlrev_b32 v2, 4, v2
    v_bfe_u32 v254, v1, 3, 2
    v_mul_u32_u24 v240, 8192, v254
    v_bfe_u32 v254, v1, 5, 1
    v_mul_u32_u24 v254, 128, v254
    v_add_u32 v240, v240, v254
    v_add_u32 v240, s4, v240
    v_add_u32 v240, v2, v240
    s_lshr_b32 s5, s24, 1
    s_lshl_b32 s5, s5, 9
    v_bfe_u32 v2, v1, 3, 1
    v_xor_b32 v2, s24, v2
    v_and_b32 v2, 1, v2
    v_lshlrev_b32 v2, 6, v2
    v_bfe_u32 v254, v1, 4, 2
    v_mul_u32_u24 v242, 2048, v254
    v_bfe_u32 v254, v1, 2, 2
    v_mul_u32_u24 v254, 128, v254
    v_add_u32 v242, v242, v254
    v_bfe_u32 v254, v1, 0, 2
    v_mul_u32_u24 v254, 16, v254
    v_add_u32 v242, v242, v254
    v_add_u32 v242, s5, v242
    v_add_u32 v242, v2, v242
    v_add_u32 v243, 0x10000, v242
    s_waitcnt lgkmcnt(0)
    s_mov_b32 s12, s40
    s_and_b32 s13, s41, 0xffff
    s_mov_b32 s14, 0x400000
    s_mov_b32 s15, 0x00020000
    s_mov_b32 s16, s42
    s_and_b32 s17, s43, 0xffff
    s_mov_b32 s18, 0x800000
    s_mov_b32 s19, 0x00020000
    s_add_u32 m0, s6, 0
    s_mov_b32 s5, 0
    buffer_load_dwordx4 v240, s[16:19], s5 offen nt lds
    s_add_u32 m0, s6, 1024
    s_mov_b32 s5, 32768
    buffer_load_dwordx4 v240, s[16:19], s5 offen nt lds
    s_add_u32 m0, s6, 2048
    s_mov_b32 s5, 65536
    buffer_load_dwordx4 v240, s[16:19], s5 offen nt lds
    s_add_u32 m0, s6, 3072
    s_mov_b32 s5, 98304
    buffer_load_dwordx4 v240, s[16:19], s5 offen nt lds
    s_add_u32 m0, s6, 4096
    s_mov_b32 s5, 131072
    buffer_load_dwordx4 v240, s[16:19], s5 offen nt lds
    s_add_u32 m0, s6, 5120
    s_mov_b32 s5, 163840
    buffer_load_dwordx4 v240, s[16:19], s5 offen nt lds
    s_add_u32 m0, s6, 6144
    s_mov_b32 s5, 196608
    buffer_load_dwordx4 v240, s[16:19], s5 offen nt lds
    s_add_u32 m0, s6, 7168
    s_mov_b32 s5, 229376
    buffer_load_dwordx4 v240, s[16:19], s5 offen nt lds
    s_add_u32 m0, s6, 8192
    s_mov_b32 s5, 262144
    buffer_load_dwordx4 v240, s[16:19], s5 offen nt lds
    s_add_u32 m0, s6, 9216
    s_mov_b32 s5, 294912
    buffer_load_dwordx4 v240, s[16:19], s5 offen nt lds
    s_add_u32 m0, s6, 10240
    s_mov_b32 s5, 327680
    buffer_load_dwordx4 v240, s[16:19], s5 offen nt lds
    s_add_u32 m0, s6, 11264
    s_mov_b32 s5, 360448
    buffer_load_dwordx4 v240, s[16:19], s5 offen nt lds
    s_add_u32 m0, s6, 12288
    s_mov_b32 s5, 393216
    buffer_load_dwordx4 v240, s[16:19], s5 offen nt lds
    s_add_u32 m0, s6, 13312
    s_mov_b32 s5, 425984
    buffer_load_dwordx4 v240, s[16:19], s5 offen nt lds
    s_add_u32 m0, s6, 14336
    s_mov_b32 s5, 458752
    buffer_load_dwordx4 v240, s[16:19], s5 offen nt lds
    s_add_u32 m0, s6, 15360
    s_mov_b32 s5, 491520
    buffer_load_dwordx4 v240, s[16:19], s5 offen nt lds
    s_add_u32 m0, s6, 65536
    s_mov_b32 s5, 2097152
    buffer_load_dwordx4 v240, s[16:19], s5 offen nt lds
    s_add_u32 m0, s6, 66560
    s_mov_b32 s5, 2129920
    buffer_load_dwordx4 v240, s[16:19], s5 offen nt lds
    s_add_u32 m0, s6, 67584
    s_mov_b32 s5, 2162688
    buffer_load_dwordx4 v240, s[16:19], s5 offen nt lds
    s_add_u32 m0, s6, 68608
    s_mov_b32 s5, 2195456
    buffer_load_dwordx4 v240, s[16:19], s5 offen nt lds
    s_add_u32 m0, s6, 69632
    s_mov_b32 s5, 2228224
    buffer_load_dwordx4 v240, s[16:19], s5 offen nt lds
    s_add_u32 m0, s6, 70656
    s_mov_b32 s5, 2260992
    buffer_load_dwordx4 v240, s[16:19], s5 offen nt lds
    s_add_u32 m0, s6, 71680
    s_mov_b32 s5, 2293760
    buffer_load_dwordx4 v240, s[16:19], s5 offen nt lds
    s_add_u32 m0, s6, 72704
    s_mov_b32 s5, 2326528
    buffer_load_dwordx4 v240, s[16:19], s5 offen nt lds
    s_add_u32 m0, s6, 73728
    s_mov_b32 s5, 2359296
    buffer_load_dwordx4 v240, s[16:19], s5 offen nt lds
    s_add_u32 m0, s6, 74752
    s_mov_b32 s5, 2392064
    buffer_load_dwordx4 v240, s[16:19], s5 offen nt lds
    s_add_u32 m0, s6, 75776
    s_mov_b32 s5, 2424832
    buffer_load_dwordx4 v240, s[16:19], s5 offen nt lds
    s_add_u32 m0, s6, 76800
    s_mov_b32 s5, 2457600
    buffer_load_dwordx4 v240, s[16:19], s5 offen nt lds
    s_add_u32 m0, s6, 77824
    s_mov_b32 s5, 2490368
    buffer_load_dwordx4 v240, s[16:19], s5 offen nt lds
    s_add_u32 m0, s6, 78848
    s_mov_b32 s5, 2523136
    buffer_load_dwordx4 v240, s[16:19], s5 offen nt lds
    s_add_u32 m0, s6, 79872
    s_mov_b32 s5, 2555904
    buffer_load_dwordx4 v240, s[16:19], s5 offen nt lds
    s_add_u32 m0, s6, 80896
    s_mov_b32 s5, 2588672
    buffer_load_dwordx4 v240, s[16:19], s5 offen nt lds
    v_and_b32 v2, 15, v1
    v_lshrrev_b32 v3, 4, v1
    v_lshlrev_b32 v4, 11, v2
    v_add_u32 v5, 0, v3
    v_xor_b32 v5, v5, v2
    v_lshl_add_u32 v8, v5, 4, v4
    v_add_u32 v12, 0x10000, v8
    v_add_u32 v5, 4, v3
    v_xor_b32 v5, v5, v2
    v_lshl_add_u32 v9, v5, 4, v4
    v_add_u32 v13, 0x10000, v9
    v_add_u32 v5, 8, v3
    v_xor_b32 v5, v5, v2
    v_lshl_add_u32 v10, v5, 4, v4
    v_add_u32 v14, 0x10000, v10
    v_add_u32 v5, 12, v3
    v_xor_b32 v5, v5, v2
    v_lshl_add_u32 v11, v5, 4, v4
    v_add_u32 v15, 0x10000, v11
    s_lshl_b32 s4, s24, 3
    s_and_b32 s4, s4, 8
    s_add_u32 s5, s4, 0
    v_xor_b32 v5, s5, v1
    s_add_u32 s5, s6, 0
    v_lshlrev_b32 v5, 4, v5
    v_add_u32 v16, s5, v5
    s_add_u32 s5, s4, 1
    v_xor_b32 v5, s5, v1
    s_add_u32 s5, s6, 0
    v_lshlrev_b32 v5, 4, v5
    v_add_u32 v17, s5, v5
    s_add_u32 s5, s4, 2
    v_xor_b32 v5, s5, v1
    s_add_u32 s5, s6, 4096
    v_lshlrev_b32 v5, 4, v5
    v_add_u32 v18, s5, v5
    s_add_u32 s5, s4, 3
    v_xor_b32 v5, s5, v1
    s_add_u32 s5, s6, 4096
    v_lshlrev_b32 v5, 4, v5
    v_add_u32 v19, s5, v5
    s_add_u32 s5, s4, 4
    v_xor_b32 v5, s5, v1
    s_add_u32 s5, s6, 8192
    v_lshlrev_b32 v5, 4, v5
    v_add_u32 v20, s5, v5
    s_add_u32 s5, s4, 5
    v_xor_b32 v5, s5, v1
    s_add_u32 s5, s6, 8192
    v_lshlrev_b32 v5, 4, v5
    v_add_u32 v21, s5, v5
    s_add_u32 s5, s4, 6
    v_xor_b32 v5, s5, v1
    s_add_u32 s5, s6, 12288
    v_lshlrev_b32 v5, 4, v5
    v_add_u32 v22, s5, v5
    s_add_u32 s5, s4, 7
    v_xor_b32 v5, s5, v1
    s_add_u32 s5, s6, 12288
    v_lshlrev_b32 v5, 4, v5
    v_add_u32 v23, s5, v5
    s_cmp_eq_u32 s98, 2
    s_cselect_b32 s4, 11, 10
    s_cselect_b32 s5, 1, 4
    s_lshl_b32 s5, s5, 10
    s_lshl_b32 s4, s24, s4
    v_lshlrev_b32 v24, 4, v1
    v_add_u32 v24, s4, v24
    v_add_u32 v25, s5, v24
    v_mov_b32 v26, 0
    s_and_b32 s4, s99, 7
    s_lshl_b32 s4, s4, 13
    s_lshl_b32 s5, s24, 11
    s_add_u32 s4, s4, s5
    s_add_u32 s4, s4, 196608
    v_lshlrev_b32 v28, 5, v1
    v_add_u32 v28, s4, v28
    s_lshl_b32 s31, s98, 24
    s_lshl_b32 s4, s99, 13
    s_add_u32 s31, s31, s4
    s_mov_b32 s30, 75497472
    s_mov_b32 s28, 0
    s_mov_b32 s29, 0
    s_waitcnt vmcnt(16)
    s_barrier
    ds_read_b64_tr_b16 a[0:1], v242 offset:0
    ds_read_b64_tr_b16 a[2:3], v242 offset:1024
    ds_read_b64_tr_b16 a[4:5], v242 offset:8
    ds_read_b64_tr_b16 a[6:7], v242 offset:1032
    ds_read_b64_tr_b16 a[8:9], v242 offset:8192
    ds_read_b64_tr_b16 a[10:11], v242 offset:9216
    ds_read_b64_tr_b16 a[12:13], v242 offset:8200
    ds_read_b64_tr_b16 a[14:15], v242 offset:9224
    ds_read_b64_tr_b16 a[16:17], v242 offset:16384
    ds_read_b64_tr_b16 a[18:19], v242 offset:17408
    ds_read_b64_tr_b16 a[20:21], v242 offset:16392
    ds_read_b64_tr_b16 a[22:23], v242 offset:17416
    ds_read_b64_tr_b16 a[24:25], v242 offset:24576
    ds_read_b64_tr_b16 a[26:27], v242 offset:25600
    ds_read_b64_tr_b16 a[28:29], v242 offset:24584
    ds_read_b64_tr_b16 a[30:31], v242 offset:25608
    ds_read_b64_tr_b16 a[32:33], v242 offset:32768
    ds_read_b64_tr_b16 a[34:35], v242 offset:33792
    ds_read_b64_tr_b16 a[36:37], v242 offset:32776
    ds_read_b64_tr_b16 a[38:39], v242 offset:33800
    ds_read_b64_tr_b16 a[40:41], v242 offset:40960
    ds_read_b64_tr_b16 a[42:43], v242 offset:41984
    ds_read_b64_tr_b16 a[44:45], v242 offset:40968
    ds_read_b64_tr_b16 a[46:47], v242 offset:41992
    ds_read_b64_tr_b16 a[48:49], v242 offset:49152
    ds_read_b64_tr_b16 a[50:51], v242 offset:50176
    ds_read_b64_tr_b16 a[52:53], v242 offset:49160
    ds_read_b64_tr_b16 a[54:55], v242 offset:50184
    ds_read_b64_tr_b16 a[56:57], v242 offset:57344
    ds_read_b64_tr_b16 a[58:59], v242 offset:58368
    ds_read_b64_tr_b16 a[60:61], v242 offset:57352
    ds_read_b64_tr_b16 a[62:63], v242 offset:58376
    s_waitcnt lgkmcnt(0)
    s_barrier
    s_add_u32 m0, s6, 0
    s_mov_b32 s5, 4194304
    buffer_load_dwordx4 v240, s[16:19], s5 offen nt lds
    s_add_u32 m0, s6, 1024
    s_mov_b32 s5, 4227072
    buffer_load_dwordx4 v240, s[16:19], s5 offen nt lds
    s_add_u32 m0, s6, 2048
    s_mov_b32 s5, 4259840
    buffer_load_dwordx4 v240, s[16:19], s5 offen nt lds
    s_add_u32 m0, s6, 3072
    s_mov_b32 s5, 4292608
    buffer_load_dwordx4 v240, s[16:19], s5 offen nt lds
    s_add_u32 m0, s6, 4096
    s_mov_b32 s5, 4325376
    buffer_load_dwordx4 v240, s[16:19], s5 offen nt lds
    s_add_u32 m0, s6, 5120
    s_mov_b32 s5, 4358144
    buffer_load_dwordx4 v240, s[16:19], s5 offen nt lds
    s_add_u32 m0, s6, 6144
    s_mov_b32 s5, 4390912
    buffer_load_dwordx4 v240, s[16:19], s5 offen nt lds
    s_add_u32 m0, s6, 7168
    s_mov_b32 s5, 4423680
    buffer_load_dwordx4 v240, s[16:19], s5 offen nt lds
    s_add_u32 m0, s6, 8192
    s_mov_b32 s5, 4456448
    buffer_load_dwordx4 v240, s[16:19], s5 offen nt lds
    s_add_u32 m0, s6, 9216
    s_mov_b32 s5, 4489216
    buffer_load_dwordx4 v240, s[16:19], s5 offen nt lds
    s_add_u32 m0, s6, 10240
    s_mov_b32 s5, 4521984
    buffer_load_dwordx4 v240, s[16:19], s5 offen nt lds
    s_add_u32 m0, s6, 11264
    s_mov_b32 s5, 4554752
    buffer_load_dwordx4 v240, s[16:19], s5 offen nt lds
    s_add_u32 m0, s6, 12288
    s_mov_b32 s5, 4587520
    buffer_load_dwordx4 v240, s[16:19], s5 offen nt lds
    s_add_u32 m0, s6, 13312
    s_mov_b32 s5, 4620288
    buffer_load_dwordx4 v240, s[16:19], s5 offen nt lds
    s_add_u32 m0, s6, 14336
    s_mov_b32 s5, 4653056
    buffer_load_dwordx4 v240, s[16:19], s5 offen nt lds
    s_add_u32 m0, s6, 15360
    s_mov_b32 s5, 4685824
    buffer_load_dwordx4 v240, s[16:19], s5 offen nt lds
    s_waitcnt vmcnt(16)
    s_lshl_b32 s4, s99, 7
    s_lshl_b32 s5, s24, 2
    s_add_u32 s4, s4, s5
    s_lshl_b32 s5, s98, 12
    s_add_u32 s4, s4, s5
    s_add_u32 s94, s4, 92274688
    s_barrier
    ds_read_b64_tr_b16 a[64:65], v243 offset:0
    ds_read_b64_tr_b16 a[66:67], v243 offset:1024
    ds_read_b64_tr_b16 a[68:69], v243 offset:8
    ds_read_b64_tr_b16 a[70:71], v243 offset:1032
    ds_read_b64_tr_b16 a[72:73], v243 offset:8192
    ds_read_b64_tr_b16 a[74:75], v243 offset:9216
    ds_read_b64_tr_b16 a[76:77], v243 offset:8200
    ds_read_b64_tr_b16 a[78:79], v243 offset:9224
    ds_read_b64_tr_b16 a[80:81], v243 offset:16384
    ds_read_b64_tr_b16 a[82:83], v243 offset:17408
    ds_read_b64_tr_b16 a[84:85], v243 offset:16392
    ds_read_b64_tr_b16 a[86:87], v243 offset:17416
    ds_read_b64_tr_b16 a[88:89], v243 offset:24576
    ds_read_b64_tr_b16 a[90:91], v243 offset:25600
    ds_read_b64_tr_b16 a[92:93], v243 offset:24584
    ds_read_b64_tr_b16 a[94:95], v243 offset:25608
    ds_read_b64_tr_b16 a[96:97], v243 offset:32768
    ds_read_b64_tr_b16 a[98:99], v243 offset:33792
    ds_read_b64_tr_b16 a[100:101], v243 offset:32776
    ds_read_b64_tr_b16 a[102:103], v243 offset:33800
    ds_read_b64_tr_b16 a[104:105], v243 offset:40960
    ds_read_b64_tr_b16 a[106:107], v243 offset:41984
    ds_read_b64_tr_b16 a[108:109], v243 offset:40968
    ds_read_b64_tr_b16 a[110:111], v243 offset:41992
    ds_read_b64_tr_b16 a[112:113], v243 offset:49152
    ds_read_b64_tr_b16 a[114:115], v243 offset:50176
    ds_read_b64_tr_b16 a[116:117], v243 offset:49160
    ds_read_b64_tr_b16 a[118:119], v243 offset:50184
    ds_read_b64_tr_b16 a[120:121], v243 offset:57344
    ds_read_b64_tr_b16 a[122:123], v243 offset:58368
    ds_read_b64_tr_b16 a[124:125], v243 offset:57352
    ds_read_b64_tr_b16 a[126:127], v243 offset:58376
    s_waitcnt lgkmcnt(0)
    s_barrier
    v_lshlrev_b32 v239, 2, v1
    buffer_load_dword v238, v239, s[20:23], 0 offen sc1
    s_add_u32 m0, s6, 65536
    s_mov_b32 s5, 6291456
    buffer_load_dwordx4 v240, s[16:19], s5 offen nt lds
    s_add_u32 m0, s6, 66560
    s_mov_b32 s5, 6324224
    buffer_load_dwordx4 v240, s[16:19], s5 offen nt lds
    s_add_u32 m0, s6, 67584
    s_mov_b32 s5, 6356992
    buffer_load_dwordx4 v240, s[16:19], s5 offen nt lds
    s_add_u32 m0, s6, 68608
    s_mov_b32 s5, 6389760
    buffer_load_dwordx4 v240, s[16:19], s5 offen nt lds
    s_add_u32 m0, s6, 69632
    s_mov_b32 s5, 6422528
    buffer_load_dwordx4 v240, s[16:19], s5 offen nt lds
    s_add_u32 m0, s6, 70656
    s_mov_b32 s5, 6455296
    buffer_load_dwordx4 v240, s[16:19], s5 offen nt lds
    s_add_u32 m0, s6, 71680
    s_mov_b32 s5, 6488064
    buffer_load_dwordx4 v240, s[16:19], s5 offen nt lds
    s_add_u32 m0, s6, 72704
    s_mov_b32 s5, 6520832
    buffer_load_dwordx4 v240, s[16:19], s5 offen nt lds
    s_add_u32 m0, s6, 73728
    s_mov_b32 s5, 6553600
    buffer_load_dwordx4 v240, s[16:19], s5 offen nt lds
    s_add_u32 m0, s6, 74752
    s_mov_b32 s5, 6586368
    buffer_load_dwordx4 v240, s[16:19], s5 offen nt lds
    s_add_u32 m0, s6, 75776
    s_mov_b32 s5, 6619136
    buffer_load_dwordx4 v240, s[16:19], s5 offen nt lds
    s_add_u32 m0, s6, 76800
    s_mov_b32 s5, 6651904
    buffer_load_dwordx4 v240, s[16:19], s5 offen nt lds
    s_add_u32 m0, s6, 77824
    s_mov_b32 s5, 6684672
    buffer_load_dwordx4 v240, s[16:19], s5 offen nt lds
    s_add_u32 m0, s6, 78848
    s_mov_b32 s5, 6717440
    buffer_load_dwordx4 v240, s[16:19], s5 offen nt lds
    s_add_u32 m0, s6, 79872
    s_mov_b32 s5, 6750208
    buffer_load_dwordx4 v240, s[16:19], s5 offen nt lds
    s_add_u32 m0, s6, 80896
    s_mov_b32 s5, 6782976
    buffer_load_dwordx4 v240, s[16:19], s5 offen nt lds
    s_waitcnt vmcnt(16)
    s_cmp_lg_u32 s27, 0
    s_cbranch_scc1 .vd_205
    s_mov_b32 s62, 0
.vp_204:
    v_readlane_b32 s4, v238, 8
    s_cmp_ge_u32 s4, 256
    s_cbranch_scc1 .va_206
    s_add_u32 s62, s62, 1
    s_cmp_gt_u32 s62, 0x100000
    s_cbranch_scc1 .mg_end_1
    s_sleep 16
    buffer_load_dword v238, v239, s[20:23], 0 offen sc1
    s_waitcnt vmcnt(0)
    s_branch .vp_204
.va_206:
    v_cmp_ne_u32 vcc, 32, v238
    s_and_b32 s4, vcc_lo, 0xff
    s_cbranch_scc0 .vd_205
    s_lshr_b32 s25, s2, 5
    s_and_b32 s26, s2, 31
    s_mov_b32 s27, 1
    s_waitcnt vmcnt(0) lgkmcnt(0)
    s_barrier
    s_branch .mg_role_3
.vd_205:
    s_barrier
    ds_read_b64_tr_b16 a[128:129], v242 offset:0
    ds_read_b64_tr_b16 a[130:131], v242 offset:1024
    ds_read_b64_tr_b16 a[132:133], v242 offset:8
    ds_read_b64_tr_b16 a[134:135], v242 offset:1032
    ds_read_b64_tr_b16 a[136:137], v242 offset:8192
    ds_read_b64_tr_b16 a[138:139], v242 offset:9216
    ds_read_b64_tr_b16 a[140:141], v242 offset:8200
    ds_read_b64_tr_b16 a[142:143], v242 offset:9224
    ds_read_b64_tr_b16 a[144:145], v242 offset:16384
    ds_read_b64_tr_b16 a[146:147], v242 offset:17408
    ds_read_b64_tr_b16 a[148:149], v242 offset:16392
    ds_read_b64_tr_b16 a[150:151], v242 offset:17416
    ds_read_b64_tr_b16 a[152:153], v242 offset:24576
    ds_read_b64_tr_b16 a[154:155], v242 offset:25600
    ds_read_b64_tr_b16 a[156:157], v242 offset:24584
    ds_read_b64_tr_b16 a[158:159], v242 offset:25608
    ds_read_b64_tr_b16 a[160:161], v242 offset:32768
    ds_read_b64_tr_b16 a[162:163], v242 offset:33792
    ds_read_b64_tr_b16 a[164:165], v242 offset:32776
    ds_read_b64_tr_b16 a[166:167], v242 offset:33800
    ds_read_b64_tr_b16 a[168:169], v242 offset:40960
    ds_read_b64_tr_b16 a[170:171], v242 offset:41984
    ds_read_b64_tr_b16 a[172:173], v242 offset:40968
    ds_read_b64_tr_b16 a[174:175], v242 offset:41992
    ds_read_b64_tr_b16 a[176:177], v242 offset:49152
    ds_read_b64_tr_b16 a[178:179], v242 offset:50176
    ds_read_b64_tr_b16 a[180:181], v242 offset:49160
    ds_read_b64_tr_b16 a[182:183], v242 offset:50184
    ds_read_b64_tr_b16 a[184:185], v242 offset:57344
    ds_read_b64_tr_b16 a[186:187], v242 offset:58368
    ds_read_b64_tr_b16 a[188:189], v242 offset:57352
    ds_read_b64_tr_b16 a[190:191], v242 offset:58376
    s_waitcnt lgkmcnt(0)
    s_barrier
    s_add_u32 m0, s6, 0
    s_nop 0
    buffer_load_dwordx4 v16, s[12:15], s29 offen offset:0 lds
    buffer_load_dwordx4 v16, s[12:15], s29 offen offset:1024 lds
    buffer_load_dwordx4 v17, s[12:15], s29 offen offset:2048 lds
    buffer_load_dwordx4 v17, s[12:15], s29 offen offset:3072 lds
    s_add_u32 m0, s6, 4096
    s_nop 0
    buffer_load_dwordx4 v18, s[12:15], s29 offen offset:0 lds
    buffer_load_dwordx4 v18, s[12:15], s29 offen offset:1024 lds
    buffer_load_dwordx4 v19, s[12:15], s29 offen offset:2048 lds
    buffer_load_dwordx4 v19, s[12:15], s29 offen offset:3072 lds
    s_add_u32 m0, s6, 8192
    s_nop 0
    buffer_load_dwordx4 v20, s[12:15], s29 offen offset:0 lds
    buffer_load_dwordx4 v20, s[12:15], s29 offen offset:1024 lds
    buffer_load_dwordx4 v21, s[12:15], s29 offen offset:2048 lds
    buffer_load_dwordx4 v21, s[12:15], s29 offen offset:3072 lds
    s_add_u32 m0, s6, 12288
    s_nop 0
    buffer_load_dwordx4 v22, s[12:15], s29 offen offset:0 lds
    buffer_load_dwordx4 v22, s[12:15], s29 offen offset:1024 lds
    buffer_load_dwordx4 v23, s[12:15], s29 offen offset:2048 lds
    buffer_load_dwordx4 v23, s[12:15], s29 offen offset:3072 lds
    s_waitcnt vmcnt(16)
    s_barrier
    ds_read_b64_tr_b16 a[192:193], v243 offset:0
    ds_read_b64_tr_b16 a[194:195], v243 offset:1024
    ds_read_b64_tr_b16 a[196:197], v243 offset:8
    ds_read_b64_tr_b16 a[198:199], v243 offset:1032
    ds_read_b64_tr_b16 a[200:201], v243 offset:8192
    ds_read_b64_tr_b16 a[202:203], v243 offset:9216
    ds_read_b64_tr_b16 a[204:205], v243 offset:8200
    ds_read_b64_tr_b16 a[206:207], v243 offset:9224
    ds_read_b64_tr_b16 a[208:209], v243 offset:16384
    ds_read_b64_tr_b16 a[210:211], v243 offset:17408
    ds_read_b64_tr_b16 a[212:213], v243 offset:16392
    ds_read_b64_tr_b16 a[214:215], v243 offset:17416
    ds_read_b64_tr_b16 a[216:217], v243 offset:24576
    ds_read_b64_tr_b16 a[218:219], v243 offset:25600
    ds_read_b64_tr_b16 a[220:221], v243 offset:24584
    ds_read_b64_tr_b16 a[222:223], v243 offset:25608
    ds_read_b64_tr_b16 a[224:225], v243 offset:32768
    ds_read_b64_tr_b16 a[226:227], v243 offset:33792
    ds_read_b64_tr_b16 a[228:229], v243 offset:32776
    ds_read_b64_tr_b16 a[230:231], v243 offset:33800
    ds_read_b64_tr_b16 a[232:233], v243 offset:40960
    ds_read_b64_tr_b16 a[234:235], v243 offset:41984
    ds_read_b64_tr_b16 a[236:237], v243 offset:40968
    ds_read_b64_tr_b16 a[238:239], v243 offset:41992
    ds_read_b64_tr_b16 a[240:241], v243 offset:49152
    ds_read_b64_tr_b16 a[242:243], v243 offset:50176
    ds_read_b64_tr_b16 a[244:245], v243 offset:49160
    ds_read_b64_tr_b16 a[246:247], v243 offset:50184
    ds_read_b64_tr_b16 a[248:249], v243 offset:57344
    ds_read_b64_tr_b16 a[250:251], v243 offset:58368
    ds_read_b64_tr_b16 a[252:253], v243 offset:57352
    ds_read_b64_tr_b16 a[254:255], v243 offset:58376
    s_waitcnt lgkmcnt(0)
    s_barrier
    s_waitcnt vmcnt(0)
    s_barrier
    s_mov_b32 s29, 0x10000
    ds_read_b128 v[64:67], v8 offset:0
    ds_read_b128 v[68:71], v8 offset:32768
    ds_read_b128 v[72:75], v9 offset:0
    ds_read_b128 v[76:79], v9 offset:32768
    ds_read_b128 v[80:83], v10 offset:0
    ds_read_b128 v[84:87], v10 offset:32768
    ds_read_b128 v[88:91], v11 offset:0
    ds_read_b128 v[92:95], v11 offset:32768
    ds_read_b128 v[96:99], v8 offset:256
    ds_read_b128 v[100:103], v8 offset:33024
    ds_read_b128 v[104:107], v9 offset:256
    ds_read_b128 v[108:111], v9 offset:33024
    ds_read_b128 v[112:115], v10 offset:256
    ds_read_b128 v[116:119], v10 offset:33024
    ds_read_b128 v[120:123], v11 offset:256
    ds_read_b128 v[124:127], v11 offset:33024
    s_add_u32 m0, s6, 65536
    s_nop 0
    buffer_load_dwordx4 v16, s[12:15], s29 offen offset:0 lds
    buffer_load_dwordx4 v16, s[12:15], s29 offen offset:1024 lds
    buffer_load_dwordx4 v17, s[12:15], s29 offen offset:2048 lds
    buffer_load_dwordx4 v17, s[12:15], s29 offen offset:3072 lds
    s_add_u32 m0, s6, 69632
    s_nop 0
    buffer_load_dwordx4 v18, s[12:15], s29 offen offset:0 lds
    buffer_load_dwordx4 v18, s[12:15], s29 offen offset:1024 lds
    s_cmp_eq_u32 s98, 0
    s_cbranch_scc1 .qa_207
    s_cmp_eq_u32 s98, 2
    s_cbranch_scc1 .vt_208
.p2align 6
.ql_210:
    s_waitcnt lgkmcnt(12)
    v_mfma_f32_16x16x32_bf16 v[192:195], a[0:3], v[64:67], 0
    ds_read_b128 v[128:131], v8 offset:512
    v_mfma_f32_16x16x32_bf16 v[196:199], a[4:7], v[64:67], 0
    v_mfma_f32_16x16x32_bf16 v[200:203], a[0:3], v[68:71], 0
    ds_read_b128 v[132:135], v8 offset:33280
    v_mfma_f32_16x16x32_bf16 v[204:207], a[4:7], v[68:71], 0
    buffer_load_dwordx4 v19, s[12:15], s29 offen offset:2048 lds
    v_mfma_f32_16x16x32_bf16 v[192:195], a[8:11], v[72:75], v[192:195]
    ds_read_b128 v[136:139], v9 offset:512
    v_mfma_f32_16x16x32_bf16 v[196:199], a[12:15], v[72:75], v[196:199]
    v_cvt_pk_bf16_f32 v224, v208, v209
    v_cvt_pk_bf16_f32 v225, v210, v211
    v_mfma_f32_16x16x32_bf16 v[200:203], a[8:11], v[76:79], v[200:203]
    ds_read_b128 v[140:143], v9 offset:33280
    v_mfma_f32_16x16x32_bf16 v[204:207], a[12:15], v[76:79], v[204:207]
    buffer_load_dwordx4 v19, s[12:15], s29 offen offset:3072 lds
    s_waitcnt lgkmcnt(12)
    v_mfma_f32_16x16x32_bf16 v[192:195], a[16:19], v[80:83], v[192:195]
    ds_read_b128 v[144:147], v10 offset:512
    v_mfma_f32_16x16x32_bf16 v[196:199], a[20:23], v[80:83], v[196:199]
    s_add_u32 m0, s6, 73728
    v_cvt_pk_bf16_f32 v226, v212, v213
    v_cvt_pk_bf16_f32 v227, v214, v215
    v_mfma_f32_16x16x32_bf16 v[200:203], a[16:19], v[84:87], v[200:203]
    ds_read_b128 v[148:151], v10 offset:33280
    v_mfma_f32_16x16x32_bf16 v[204:207], a[20:23], v[84:87], v[204:207]
    buffer_load_dwordx4 v20, s[12:15], s29 offen offset:0 lds
    v_mfma_f32_16x16x32_bf16 v[192:195], a[24:27], v[88:91], v[192:195]
    ds_read_b128 v[152:155], v11 offset:512
    v_cvt_pk_bf16_f32 v228, v216, v217
    v_mfma_f32_16x16x32_bf16 v[196:199], a[28:31], v[88:91], v[196:199]
    buffer_store_dwordx4 v[224:227], v24, s[8:11], s30 offen sc1
    v_mfma_f32_16x16x32_bf16 v[200:203], a[24:27], v[92:95], v[200:203]
    ds_read_b128 v[156:159], v11 offset:33280
    v_cvt_pk_bf16_f32 v229, v218, v219
    v_mfma_f32_16x16x32_bf16 v[204:207], a[28:31], v[92:95], v[204:207]
    buffer_load_dwordx4 v20, s[12:15], s29 offen offset:1024 lds
    s_waitcnt lgkmcnt(12)
    v_mfma_f32_16x16x32_bf16 v[192:195], a[32:35], v[96:99], v[192:195]
    ds_read_b128 v[160:163], v8 offset:768
    v_mfma_f32_16x16x32_bf16 v[196:199], a[36:39], v[96:99], v[196:199]
    v_cvt_pk_bf16_f32 v230, v220, v221
    v_cvt_pk_bf16_f32 v231, v222, v223
    v_mfma_f32_16x16x32_bf16 v[200:203], a[32:35], v[100:103], v[200:203]
    ds_read_b128 v[164:167], v8 offset:33536
    v_mfma_f32_16x16x32_bf16 v[204:207], a[36:39], v[100:103], v[204:207]
    buffer_load_dwordx4 v21, s[12:15], s29 offen offset:2048 lds
    v_mfma_f32_16x16x32_bf16 v[192:195], a[40:43], v[104:107], v[192:195]
    ds_read_b128 v[168:171], v9 offset:768
    v_mfma_f32_16x16x32_bf16 v[196:199], a[44:47], v[104:107], v[196:199]
    buffer_store_dwordx4 v[228:231], v25, s[8:11], s30 offen sc1
    v_mfma_f32_16x16x32_bf16 v[200:203], a[40:43], v[108:111], v[200:203]
    ds_read_b128 v[172:175], v9 offset:33536
    v_mfma_f32_16x16x32_bf16 v[204:207], a[44:47], v[108:111], v[204:207]
    buffer_load_dwordx4 v21, s[12:15], s29 offen offset:3072 lds
    s_waitcnt lgkmcnt(12)
    v_mfma_f32_16x16x32_bf16 v[192:195], a[48:51], v[112:115], v[192:195]
    ds_read_b128 v[176:179], v10 offset:768
    v_mfma_f32_16x16x32_bf16 v[196:199], a[52:55], v[112:115], v[196:199]
    s_add_u32 m0, s6, 77824
    s_mov_b32 s30, s31
    v_mfma_f32_16x16x32_bf16 v[200:203], a[48:51], v[116:119], v[200:203]
    ds_read_b128 v[180:183], v10 offset:33536
    v_mfma_f32_16x16x32_bf16 v[204:207], a[52:55], v[116:119], v[204:207]
    buffer_load_dwordx4 v22, s[12:15], s29 offen offset:0 lds
    v_mfma_f32_16x16x32_bf16 v[192:195], a[56:59], v[120:123], v[192:195]
    ds_read_b128 v[184:187], v11 offset:768
    v_mfma_f32_16x16x32_bf16 v[196:199], a[60:63], v[120:123], v[196:199]
    s_add_u32 s31, s31, 262144
    v_mfma_f32_16x16x32_bf16 v[200:203], a[56:59], v[124:127], v[200:203]
    ds_read_b128 v[188:191], v11 offset:33536
    v_mfma_f32_16x16x32_bf16 v[204:207], a[60:63], v[124:127], v[204:207]
    buffer_load_dwordx4 v22, s[12:15], s29 offen offset:1024 lds
    s_waitcnt lgkmcnt(12)
    v_mfma_f32_16x16x32_bf16 v[192:195], a[64:67], v[128:131], v[192:195]
    ds_read_b128 v[64:67], v8 offset:1024
    v_mfma_f32_16x16x32_bf16 v[196:199], a[68:71], v[128:131], v[196:199]
    v_mfma_f32_16x16x32_bf16 v[200:203], a[64:67], v[132:135], v[200:203]
    ds_read_b128 v[68:71], v8 offset:33792
    v_mfma_f32_16x16x32_bf16 v[204:207], a[68:71], v[132:135], v[204:207]
    buffer_load_dwordx4 v23, s[12:15], s29 offen offset:2048 lds
    v_mfma_f32_16x16x32_bf16 v[192:195], a[72:75], v[136:139], v[192:195]
    ds_read_b128 v[72:75], v9 offset:1024
    v_mfma_f32_16x16x32_bf16 v[196:199], a[76:79], v[136:139], v[196:199]
    v_mfma_f32_16x16x32_bf16 v[200:203], a[72:75], v[140:143], v[200:203]
    ds_read_b128 v[76:79], v9 offset:33792
    v_mfma_f32_16x16x32_bf16 v[204:207], a[76:79], v[140:143], v[204:207]
    buffer_load_dwordx4 v23, s[12:15], s29 offen offset:3072 lds
    s_waitcnt lgkmcnt(12)
    v_mfma_f32_16x16x32_bf16 v[192:195], a[80:83], v[144:147], v[192:195]
    ds_read_b128 v[80:83], v10 offset:1024
    v_mfma_f32_16x16x32_bf16 v[196:199], a[84:87], v[144:147], v[196:199]
    v_mfma_f32_16x16x32_bf16 v[200:203], a[80:83], v[148:151], v[200:203]
    ds_read_b128 v[84:87], v10 offset:33792
    v_mfma_f32_16x16x32_bf16 v[204:207], a[84:87], v[148:151], v[204:207]
    buffer_load_dword v29, v28, s[12:15], s29 offen
    v_mfma_f32_16x16x32_bf16 v[192:195], a[88:91], v[152:155], v[192:195]
    ds_read_b128 v[88:91], v11 offset:1024
    v_mfma_f32_16x16x32_bf16 v[196:199], a[92:95], v[152:155], v[196:199]
    v_mfma_f32_16x16x32_bf16 v[200:203], a[88:91], v[156:159], v[200:203]
    ds_read_b128 v[92:95], v11 offset:33792
    v_mfma_f32_16x16x32_bf16 v[204:207], a[92:95], v[156:159], v[204:207]
    s_waitcnt lgkmcnt(12)
    v_mfma_f32_16x16x32_bf16 v[192:195], a[96:99], v[160:163], v[192:195]
    ds_read_b128 v[96:99], v8 offset:1280
    v_mfma_f32_16x16x32_bf16 v[196:199], a[100:103], v[160:163], v[196:199]
    v_mfma_f32_16x16x32_bf16 v[200:203], a[96:99], v[164:167], v[200:203]
    ds_read_b128 v[100:103], v8 offset:34048
    v_mfma_f32_16x16x32_bf16 v[204:207], a[100:103], v[164:167], v[204:207]
    v_mfma_f32_16x16x32_bf16 v[192:195], a[104:107], v[168:171], v[192:195]
    ds_read_b128 v[104:107], v9 offset:1280
    v_mfma_f32_16x16x32_bf16 v[196:199], a[108:111], v[168:171], v[196:199]
    v_mfma_f32_16x16x32_bf16 v[200:203], a[104:107], v[172:175], v[200:203]
    ds_read_b128 v[108:111], v9 offset:34048
    v_mfma_f32_16x16x32_bf16 v[204:207], a[108:111], v[172:175], v[204:207]
    s_waitcnt lgkmcnt(12)
    v_mfma_f32_16x16x32_bf16 v[192:195], a[112:115], v[176:179], v[192:195]
    ds_read_b128 v[112:115], v10 offset:1280
    v_mfma_f32_16x16x32_bf16 v[196:199], a[116:119], v[176:179], v[196:199]
    v_mfma_f32_16x16x32_bf16 v[200:203], a[112:115], v[180:183], v[200:203]
    ds_read_b128 v[116:119], v10 offset:34048
    v_mfma_f32_16x16x32_bf16 v[204:207], a[116:119], v[180:183], v[204:207]
    v_mfma_f32_16x16x32_bf16 v[192:195], a[120:123], v[184:187], v[192:195]
    ds_read_b128 v[120:123], v11 offset:1280
    v_mfma_f32_16x16x32_bf16 v[196:199], a[124:127], v[184:187], v[196:199]
    v_mfma_f32_16x16x32_bf16 v[200:203], a[120:123], v[188:191], v[200:203]
    ds_read_b128 v[124:127], v11 offset:34048
    v_mfma_f32_16x16x32_bf16 v[204:207], a[124:127], v[188:191], v[204:207]
    s_waitcnt lgkmcnt(12)
    v_mfma_f32_16x16x32_bf16 v[192:195], a[128:131], v[64:67], v[192:195]
    ds_read_b128 v[128:131], v8 offset:1536
    v_mfma_f32_16x16x32_bf16 v[196:199], a[132:135], v[64:67], v[196:199]
    v_mfma_f32_16x16x32_bf16 v[200:203], a[128:131], v[68:71], v[200:203]
    ds_read_b128 v[132:135], v8 offset:34304
    v_mfma_f32_16x16x32_bf16 v[204:207], a[132:135], v[68:71], v[204:207]
    v_mfma_f32_16x16x32_bf16 v[192:195], a[136:139], v[72:75], v[192:195]
    ds_read_b128 v[136:139], v9 offset:1536
    v_mfma_f32_16x16x32_bf16 v[196:199], a[140:143], v[72:75], v[196:199]
    v_mfma_f32_16x16x32_bf16 v[200:203], a[136:139], v[76:79], v[200:203]
    ds_read_b128 v[140:143], v9 offset:34304
    v_mfma_f32_16x16x32_bf16 v[204:207], a[140:143], v[76:79], v[204:207]
    s_waitcnt lgkmcnt(12)
    v_mfma_f32_16x16x32_bf16 v[192:195], a[144:147], v[80:83], v[192:195]
    ds_read_b128 v[144:147], v10 offset:1536
    v_mfma_f32_16x16x32_bf16 v[196:199], a[148:151], v[80:83], v[196:199]
    v_mfma_f32_16x16x32_bf16 v[200:203], a[144:147], v[84:87], v[200:203]
    ds_read_b128 v[148:151], v10 offset:34304
    v_mfma_f32_16x16x32_bf16 v[204:207], a[148:151], v[84:87], v[204:207]
    v_mfma_f32_16x16x32_bf16 v[192:195], a[152:155], v[88:91], v[192:195]
    ds_read_b128 v[152:155], v11 offset:1536
    v_mfma_f32_16x16x32_bf16 v[196:199], a[156:159], v[88:91], v[196:199]
    v_mfma_f32_16x16x32_bf16 v[200:203], a[152:155], v[92:95], v[200:203]
    ds_read_b128 v[156:159], v11 offset:34304
    v_mfma_f32_16x16x32_bf16 v[204:207], a[156:159], v[92:95], v[204:207]
    s_waitcnt lgkmcnt(12)
    v_mfma_f32_16x16x32_bf16 v[192:195], a[160:163], v[96:99], v[192:195]
    ds_read_b128 v[160:163], v8 offset:1792
    v_mfma_f32_16x16x32_bf16 v[196:199], a[164:167], v[96:99], v[196:199]
    v_mfma_f32_16x16x32_bf16 v[200:203], a[160:163], v[100:103], v[200:203]
    ds_read_b128 v[164:167], v8 offset:34560
    v_mfma_f32_16x16x32_bf16 v[204:207], a[164:167], v[100:103], v[204:207]
    v_mfma_f32_16x16x32_bf16 v[192:195], a[168:171], v[104:107], v[192:195]
    ds_read_b128 v[168:171], v9 offset:1792
    v_mfma_f32_16x16x32_bf16 v[196:199], a[172:175], v[104:107], v[196:199]
    v_mfma_f32_16x16x32_bf16 v[200:203], a[168:171], v[108:111], v[200:203]
    ds_read_b128 v[172:175], v9 offset:34560
    v_mfma_f32_16x16x32_bf16 v[204:207], a[172:175], v[108:111], v[204:207]
    s_waitcnt lgkmcnt(12)
    v_mfma_f32_16x16x32_bf16 v[192:195], a[176:179], v[112:115], v[192:195]
    ds_read_b128 v[176:179], v10 offset:1792
    v_mfma_f32_16x16x32_bf16 v[196:199], a[180:183], v[112:115], v[196:199]
    s_waitcnt vmcnt(6)
    v_mov_b32 v27, s28
    s_mov_b64 exec, 1
    buffer_store_dword v27, v26, s[8:11], s94 offen sc1
    s_mov_b64 exec, -1
    v_mfma_f32_16x16x32_bf16 v[200:203], a[176:179], v[116:119], v[200:203]
    ds_read_b128 v[180:183], v10 offset:34560
    v_mfma_f32_16x16x32_bf16 v[204:207], a[180:183], v[116:119], v[204:207]
    v_mfma_f32_16x16x32_bf16 v[192:195], a[184:187], v[120:123], v[192:195]
    ds_read_b128 v[184:187], v11 offset:1792
    v_mfma_f32_16x16x32_bf16 v[196:199], a[188:191], v[120:123], v[196:199]
    s_add_u32 s28, s28, 1
    v_mfma_f32_16x16x32_bf16 v[200:203], a[184:187], v[124:127], v[200:203]
    ds_read_b128 v[188:191], v11 offset:34560
    v_mfma_f32_16x16x32_bf16 v[204:207], a[188:191], v[124:127], v[204:207]
    s_waitcnt lgkmcnt(12)
    v_mfma_f32_16x16x32_bf16 v[192:195], a[192:195], v[128:131], v[192:195]
    v_mfma_f32_16x16x32_bf16 v[196:199], a[196:199], v[128:131], v[196:199]
    v_mfma_f32_16x16x32_bf16 v[200:203], a[192:195], v[132:135], v[200:203]
    v_mfma_f32_16x16x32_bf16 v[204:207], a[196:199], v[132:135], v[204:207]
    v_mfma_f32_16x16x32_bf16 v[192:195], a[200:203], v[136:139], v[192:195]
    v_mfma_f32_16x16x32_bf16 v[196:199], a[204:207], v[136:139], v[196:199]
    s_add_u32 s29, s29, 0x10000
    s_min_u32 s29, s29, 0x3f0000
    v_mfma_f32_16x16x32_bf16 v[200:203], a[200:203], v[140:143], v[200:203]
    v_mfma_f32_16x16x32_bf16 v[204:207], a[204:207], v[140:143], v[204:207]
    s_waitcnt vmcnt(2) lgkmcnt(0)
    s_barrier
    v_mfma_f32_16x16x32_bf16 v[192:195], a[208:211], v[144:147], v[192:195]
    ds_read_b128 v[64:67], v12 offset:0
    ds_read_b128 v[68:71], v12 offset:32768
    v_mfma_f32_16x16x32_bf16 v[196:199], a[212:215], v[144:147], v[196:199]
    s_add_u32 m0, s6, 0
    v_mfma_f32_16x16x32_bf16 v[200:203], a[208:211], v[148:151], v[200:203]
    ds_read_b128 v[72:75], v13 offset:0
    ds_read_b128 v[76:79], v13 offset:32768
    v_mfma_f32_16x16x32_bf16 v[204:207], a[212:215], v[148:151], v[204:207]
    buffer_load_dwordx4 v16, s[12:15], s29 offen offset:0 lds
    v_mfma_f32_16x16x32_bf16 v[192:195], a[216:219], v[152:155], v[192:195]
    ds_read_b128 v[80:83], v14 offset:0
    ds_read_b128 v[84:87], v14 offset:32768
    v_mfma_f32_16x16x32_bf16 v[196:199], a[220:223], v[152:155], v[196:199]
    v_mfma_f32_16x16x32_bf16 v[200:203], a[216:219], v[156:159], v[200:203]
    ds_read_b128 v[88:91], v15 offset:0
    ds_read_b128 v[92:95], v15 offset:32768
    v_mfma_f32_16x16x32_bf16 v[204:207], a[220:223], v[156:159], v[204:207]
    buffer_load_dwordx4 v16, s[12:15], s29 offen offset:1024 lds
    v_mfma_f32_16x16x32_bf16 v[192:195], a[224:227], v[160:163], v[192:195]
    ds_read_b128 v[96:99], v12 offset:256
    v_mfma_f32_16x16x32_bf16 v[196:199], a[228:231], v[160:163], v[196:199]
    v_mfma_f32_16x16x32_bf16 v[200:203], a[224:227], v[164:167], v[200:203]
    ds_read_b128 v[100:103], v12 offset:33024
    v_mfma_f32_16x16x32_bf16 v[204:207], a[228:231], v[164:167], v[204:207]
    buffer_load_dwordx4 v17, s[12:15], s29 offen offset:2048 lds
    v_mfma_f32_16x16x32_bf16 v[192:195], a[232:235], v[168:171], v[192:195]
    ds_read_b128 v[104:107], v13 offset:256
    v_mfma_f32_16x16x32_bf16 v[196:199], a[236:239], v[168:171], v[196:199]
    v_mfma_f32_16x16x32_bf16 v[200:203], a[232:235], v[172:175], v[200:203]
    ds_read_b128 v[108:111], v13 offset:33024
    v_mfma_f32_16x16x32_bf16 v[204:207], a[236:239], v[172:175], v[204:207]
    buffer_load_dwordx4 v17, s[12:15], s29 offen offset:3072 lds
    v_mfma_f32_16x16x32_bf16 v[192:195], a[240:243], v[176:179], v[192:195]
    ds_read_b128 v[112:115], v14 offset:256
    v_mfma_f32_16x16x32_bf16 v[196:199], a[244:247], v[176:179], v[196:199]
    s_add_u32 m0, s6, 4096
    v_mfma_f32_16x16x32_bf16 v[200:203], a[240:243], v[180:183], v[200:203]
    ds_read_b128 v[116:119], v14 offset:33024
    v_mfma_f32_16x16x32_bf16 v[204:207], a[244:247], v[180:183], v[204:207]
    buffer_load_dwordx4 v18, s[12:15], s29 offen offset:0 lds
    v_mfma_f32_16x16x32_bf16 v[192:195], a[248:251], v[184:187], v[192:195]
    ds_read_b128 v[120:123], v15 offset:256
    v_mfma_f32_16x16x32_bf16 v[196:199], a[252:255], v[184:187], v[196:199]
    v_mfma_f32_16x16x32_bf16 v[200:203], a[248:251], v[188:191], v[200:203]
    ds_read_b128 v[124:127], v15 offset:33024
    v_mfma_f32_16x16x32_bf16 v[204:207], a[252:255], v[188:191], v[204:207]
    buffer_load_dwordx4 v18, s[12:15], s29 offen offset:1024 lds
    s_waitcnt lgkmcnt(12)
    v_mfma_f32_16x16x32_bf16 v[208:211], a[0:3], v[64:67], 0
    ds_read_b128 v[128:131], v12 offset:512
    v_mfma_f32_16x16x32_bf16 v[212:215], a[4:7], v[64:67], 0
    v_mfma_f32_16x16x32_bf16 v[216:219], a[0:3], v[68:71], 0
    ds_read_b128 v[132:135], v12 offset:33280
    v_mfma_f32_16x16x32_bf16 v[220:223], a[4:7], v[68:71], 0
    buffer_load_dwordx4 v19, s[12:15], s29 offen offset:2048 lds
    v_mfma_f32_16x16x32_bf16 v[208:211], a[8:11], v[72:75], v[208:211]
    ds_read_b128 v[136:139], v13 offset:512
    v_mfma_f32_16x16x32_bf16 v[212:215], a[12:15], v[72:75], v[212:215]
    v_cvt_pk_bf16_f32 v224, v192, v193
    v_cvt_pk_bf16_f32 v225, v194, v195
    v_mfma_f32_16x16x32_bf16 v[216:219], a[8:11], v[76:79], v[216:219]
    ds_read_b128 v[140:143], v13 offset:33280
    v_mfma_f32_16x16x32_bf16 v[220:223], a[12:15], v[76:79], v[220:223]
    buffer_load_dwordx4 v19, s[12:15], s29 offen offset:3072 lds
    s_waitcnt lgkmcnt(12)
    v_mfma_f32_16x16x32_bf16 v[208:211], a[16:19], v[80:83], v[208:211]
    ds_read_b128 v[144:147], v14 offset:512
    v_mfma_f32_16x16x32_bf16 v[212:215], a[20:23], v[80:83], v[212:215]
    s_add_u32 m0, s6, 8192
    v_cvt_pk_bf16_f32 v226, v196, v197
    v_cvt_pk_bf16_f32 v227, v198, v199
    v_mfma_f32_16x16x32_bf16 v[216:219], a[16:19], v[84:87], v[216:219]
    ds_read_b128 v[148:151], v14 offset:33280
    v_mfma_f32_16x16x32_bf16 v[220:223], a[20:23], v[84:87], v[220:223]
    buffer_load_dwordx4 v20, s[12:15], s29 offen offset:0 lds
    v_mfma_f32_16x16x32_bf16 v[208:211], a[24:27], v[88:91], v[208:211]
    ds_read_b128 v[152:155], v15 offset:512
    v_cvt_pk_bf16_f32 v228, v200, v201
    v_mfma_f32_16x16x32_bf16 v[212:215], a[28:31], v[88:91], v[212:215]
    buffer_store_dwordx4 v[224:227], v24, s[8:11], s30 offen sc1
    v_mfma_f32_16x16x32_bf16 v[216:219], a[24:27], v[92:95], v[216:219]
    ds_read_b128 v[156:159], v15 offset:33280
    v_cvt_pk_bf16_f32 v229, v202, v203
    v_mfma_f32_16x16x32_bf16 v[220:223], a[28:31], v[92:95], v[220:223]
    buffer_load_dwordx4 v20, s[12:15], s29 offen offset:1024 lds
    s_waitcnt lgkmcnt(12)
    v_mfma_f32_16x16x32_bf16 v[208:211], a[32:35], v[96:99], v[208:211]
    ds_read_b128 v[160:163], v12 offset:768
    v_mfma_f32_16x16x32_bf16 v[212:215], a[36:39], v[96:99], v[212:215]
    v_cvt_pk_bf16_f32 v230, v204, v205
    v_cvt_pk_bf16_f32 v231, v206, v207
    v_mfma_f32_16x16x32_bf16 v[216:219], a[32:35], v[100:103], v[216:219]
    ds_read_b128 v[164:167], v12 offset:33536
    v_mfma_f32_16x16x32_bf16 v[220:223], a[36:39], v[100:103], v[220:223]
    buffer_load_dwordx4 v21, s[12:15], s29 offen offset:2048 lds
    v_mfma_f32_16x16x32_bf16 v[208:211], a[40:43], v[104:107], v[208:211]
    ds_read_b128 v[168:171], v13 offset:768
    v_mfma_f32_16x16x32_bf16 v[212:215], a[44:47], v[104:107], v[212:215]
    buffer_store_dwordx4 v[228:231], v25, s[8:11], s30 offen sc1
    v_mfma_f32_16x16x32_bf16 v[216:219], a[40:43], v[108:111], v[216:219]
    ds_read_b128 v[172:175], v13 offset:33536
    v_mfma_f32_16x16x32_bf16 v[220:223], a[44:47], v[108:111], v[220:223]
    buffer_load_dwordx4 v21, s[12:15], s29 offen offset:3072 lds
    s_waitcnt lgkmcnt(12)
    v_mfma_f32_16x16x32_bf16 v[208:211], a[48:51], v[112:115], v[208:211]
    ds_read_b128 v[176:179], v14 offset:768
    v_mfma_f32_16x16x32_bf16 v[212:215], a[52:55], v[112:115], v[212:215]
    s_add_u32 m0, s6, 12288
    s_mov_b32 s30, s31
    v_mfma_f32_16x16x32_bf16 v[216:219], a[48:51], v[116:119], v[216:219]
    ds_read_b128 v[180:183], v14 offset:33536
    v_mfma_f32_16x16x32_bf16 v[220:223], a[52:55], v[116:119], v[220:223]
    buffer_load_dwordx4 v22, s[12:15], s29 offen offset:0 lds
    v_mfma_f32_16x16x32_bf16 v[208:211], a[56:59], v[120:123], v[208:211]
    ds_read_b128 v[184:187], v15 offset:768
    v_mfma_f32_16x16x32_bf16 v[212:215], a[60:63], v[120:123], v[212:215]
    s_add_u32 s31, s31, 262144
    v_mfma_f32_16x16x32_bf16 v[216:219], a[56:59], v[124:127], v[216:219]
    ds_read_b128 v[188:191], v15 offset:33536
    v_mfma_f32_16x16x32_bf16 v[220:223], a[60:63], v[124:127], v[220:223]
    buffer_load_dwordx4 v22, s[12:15], s29 offen offset:1024 lds
    s_waitcnt lgkmcnt(12)
    v_mfma_f32_16x16x32_bf16 v[208:211], a[64:67], v[128:131], v[208:211]
    ds_read_b128 v[64:67], v12 offset:1024
    v_mfma_f32_16x16x32_bf16 v[212:215], a[68:71], v[128:131], v[212:215]
    v_mfma_f32_16x16x32_bf16 v[216:219], a[64:67], v[132:135], v[216:219]
    ds_read_b128 v[68:71], v12 offset:33792
    v_mfma_f32_16x16x32_bf16 v[220:223], a[68:71], v[132:135], v[220:223]
    buffer_load_dwordx4 v23, s[12:15], s29 offen offset:2048 lds
    v_mfma_f32_16x16x32_bf16 v[208:211], a[72:75], v[136:139], v[208:211]
    ds_read_b128 v[72:75], v13 offset:1024
    v_mfma_f32_16x16x32_bf16 v[212:215], a[76:79], v[136:139], v[212:215]
    v_mfma_f32_16x16x32_bf16 v[216:219], a[72:75], v[140:143], v[216:219]
    ds_read_b128 v[76:79], v13 offset:33792
    v_mfma_f32_16x16x32_bf16 v[220:223], a[76:79], v[140:143], v[220:223]
    buffer_load_dwordx4 v23, s[12:15], s29 offen offset:3072 lds
    s_waitcnt lgkmcnt(12)
    v_mfma_f32_16x16x32_bf16 v[208:211], a[80:83], v[144:147], v[208:211]
    ds_read_b128 v[80:83], v14 offset:1024
    v_mfma_f32_16x16x32_bf16 v[212:215], a[84:87], v[144:147], v[212:215]
    v_mfma_f32_16x16x32_bf16 v[216:219], a[80:83], v[148:151], v[216:219]
    ds_read_b128 v[84:87], v14 offset:33792
    v_mfma_f32_16x16x32_bf16 v[220:223], a[84:87], v[148:151], v[220:223]
    buffer_load_dword v29, v28, s[12:15], s29 offen
    v_mfma_f32_16x16x32_bf16 v[208:211], a[88:91], v[152:155], v[208:211]
    ds_read_b128 v[88:91], v15 offset:1024
    v_mfma_f32_16x16x32_bf16 v[212:215], a[92:95], v[152:155], v[212:215]
    v_mfma_f32_16x16x32_bf16 v[216:219], a[88:91], v[156:159], v[216:219]
    ds_read_b128 v[92:95], v15 offset:33792
    v_mfma_f32_16x16x32_bf16 v[220:223], a[92:95], v[156:159], v[220:223]
    s_waitcnt lgkmcnt(12)
    v_mfma_f32_16x16x32_bf16 v[208:211], a[96:99], v[160:163], v[208:211]
    ds_read_b128 v[96:99], v12 offset:1280
    v_mfma_f32_16x16x32_bf16 v[212:215], a[100:103], v[160:163], v[212:215]
    v_mfma_f32_16x16x32_bf16 v[216:219], a[96:99], v[164:167], v[216:219]
    ds_read_b128 v[100:103], v12 offset:34048
    v_mfma_f32_16x16x32_bf16 v[220:223], a[100:103], v[164:167], v[220:223]
    v_mfma_f32_16x16x32_bf16 v[208:211], a[104:107], v[168:171], v[208:211]
    ds_read_b128 v[104:107], v13 offset:1280
    v_mfma_f32_16x16x32_bf16 v[212:215], a[108:111], v[168:171], v[212:215]
    v_mfma_f32_16x16x32_bf16 v[216:219], a[104:107], v[172:175], v[216:219]
    ds_read_b128 v[108:111], v13 offset:34048
    v_mfma_f32_16x16x32_bf16 v[220:223], a[108:111], v[172:175], v[220:223]
    s_waitcnt lgkmcnt(12)
    v_mfma_f32_16x16x32_bf16 v[208:211], a[112:115], v[176:179], v[208:211]
    ds_read_b128 v[112:115], v14 offset:1280
    v_mfma_f32_16x16x32_bf16 v[212:215], a[116:119], v[176:179], v[212:215]
    v_mfma_f32_16x16x32_bf16 v[216:219], a[112:115], v[180:183], v[216:219]
    ds_read_b128 v[116:119], v14 offset:34048
    v_mfma_f32_16x16x32_bf16 v[220:223], a[116:119], v[180:183], v[220:223]
    v_mfma_f32_16x16x32_bf16 v[208:211], a[120:123], v[184:187], v[208:211]
    ds_read_b128 v[120:123], v15 offset:1280
    v_mfma_f32_16x16x32_bf16 v[212:215], a[124:127], v[184:187], v[212:215]
    v_mfma_f32_16x16x32_bf16 v[216:219], a[120:123], v[188:191], v[216:219]
    ds_read_b128 v[124:127], v15 offset:34048
    v_mfma_f32_16x16x32_bf16 v[220:223], a[124:127], v[188:191], v[220:223]
    s_waitcnt lgkmcnt(12)
    v_mfma_f32_16x16x32_bf16 v[208:211], a[128:131], v[64:67], v[208:211]
    ds_read_b128 v[128:131], v12 offset:1536
    v_mfma_f32_16x16x32_bf16 v[212:215], a[132:135], v[64:67], v[212:215]
    v_mfma_f32_16x16x32_bf16 v[216:219], a[128:131], v[68:71], v[216:219]
    ds_read_b128 v[132:135], v12 offset:34304
    v_mfma_f32_16x16x32_bf16 v[220:223], a[132:135], v[68:71], v[220:223]
    v_mfma_f32_16x16x32_bf16 v[208:211], a[136:139], v[72:75], v[208:211]
    ds_read_b128 v[136:139], v13 offset:1536
    v_mfma_f32_16x16x32_bf16 v[212:215], a[140:143], v[72:75], v[212:215]
    v_mfma_f32_16x16x32_bf16 v[216:219], a[136:139], v[76:79], v[216:219]
    ds_read_b128 v[140:143], v13 offset:34304
    v_mfma_f32_16x16x32_bf16 v[220:223], a[140:143], v[76:79], v[220:223]
    s_waitcnt lgkmcnt(12)
    v_mfma_f32_16x16x32_bf16 v[208:211], a[144:147], v[80:83], v[208:211]
    ds_read_b128 v[144:147], v14 offset:1536
    v_mfma_f32_16x16x32_bf16 v[212:215], a[148:151], v[80:83], v[212:215]
    v_mfma_f32_16x16x32_bf16 v[216:219], a[144:147], v[84:87], v[216:219]
    ds_read_b128 v[148:151], v14 offset:34304
    v_mfma_f32_16x16x32_bf16 v[220:223], a[148:151], v[84:87], v[220:223]
    v_mfma_f32_16x16x32_bf16 v[208:211], a[152:155], v[88:91], v[208:211]
    ds_read_b128 v[152:155], v15 offset:1536
    v_mfma_f32_16x16x32_bf16 v[212:215], a[156:159], v[88:91], v[212:215]
    v_mfma_f32_16x16x32_bf16 v[216:219], a[152:155], v[92:95], v[216:219]
    ds_read_b128 v[156:159], v15 offset:34304
    v_mfma_f32_16x16x32_bf16 v[220:223], a[156:159], v[92:95], v[220:223]
    s_waitcnt lgkmcnt(12)
    v_mfma_f32_16x16x32_bf16 v[208:211], a[160:163], v[96:99], v[208:211]
    ds_read_b128 v[160:163], v12 offset:1792
    v_mfma_f32_16x16x32_bf16 v[212:215], a[164:167], v[96:99], v[212:215]
    v_mfma_f32_16x16x32_bf16 v[216:219], a[160:163], v[100:103], v[216:219]
    ds_read_b128 v[164:167], v12 offset:34560
    v_mfma_f32_16x16x32_bf16 v[220:223], a[164:167], v[100:103], v[220:223]
    v_mfma_f32_16x16x32_bf16 v[208:211], a[168:171], v[104:107], v[208:211]
    ds_read_b128 v[168:171], v13 offset:1792
    v_mfma_f32_16x16x32_bf16 v[212:215], a[172:175], v[104:107], v[212:215]
    v_mfma_f32_16x16x32_bf16 v[216:219], a[168:171], v[108:111], v[216:219]
    ds_read_b128 v[172:175], v13 offset:34560
    v_mfma_f32_16x16x32_bf16 v[220:223], a[172:175], v[108:111], v[220:223]
    s_waitcnt lgkmcnt(12)
    v_mfma_f32_16x16x32_bf16 v[208:211], a[176:179], v[112:115], v[208:211]
    ds_read_b128 v[176:179], v14 offset:1792
    v_mfma_f32_16x16x32_bf16 v[212:215], a[180:183], v[112:115], v[212:215]
    s_waitcnt vmcnt(6)
    v_mov_b32 v27, s28
    s_mov_b64 exec, 1
    buffer_store_dword v27, v26, s[8:11], s94 offen sc1
    s_mov_b64 exec, -1
    v_mfma_f32_16x16x32_bf16 v[216:219], a[176:179], v[116:119], v[216:219]
    ds_read_b128 v[180:183], v14 offset:34560
    v_mfma_f32_16x16x32_bf16 v[220:223], a[180:183], v[116:119], v[220:223]
    v_mfma_f32_16x16x32_bf16 v[208:211], a[184:187], v[120:123], v[208:211]
    ds_read_b128 v[184:187], v15 offset:1792
    v_mfma_f32_16x16x32_bf16 v[212:215], a[188:191], v[120:123], v[212:215]
    s_add_u32 s28, s28, 1
    v_mfma_f32_16x16x32_bf16 v[216:219], a[184:187], v[124:127], v[216:219]
    ds_read_b128 v[188:191], v15 offset:34560
    v_mfma_f32_16x16x32_bf16 v[220:223], a[188:191], v[124:127], v[220:223]
    s_waitcnt lgkmcnt(12)
    v_mfma_f32_16x16x32_bf16 v[208:211], a[192:195], v[128:131], v[208:211]
    v_mfma_f32_16x16x32_bf16 v[212:215], a[196:199], v[128:131], v[212:215]
    v_mfma_f32_16x16x32_bf16 v[216:219], a[192:195], v[132:135], v[216:219]
    v_mfma_f32_16x16x32_bf16 v[220:223], a[196:199], v[132:135], v[220:223]
    v_mfma_f32_16x16x32_bf16 v[208:211], a[200:203], v[136:139], v[208:211]
    v_mfma_f32_16x16x32_bf16 v[212:215], a[204:207], v[136:139], v[212:215]
    s_add_u32 s29, s29, 0x10000
    s_min_u32 s29, s29, 0x3f0000
    v_mfma_f32_16x16x32_bf16 v[216:219], a[200:203], v[140:143], v[216:219]
    v_mfma_f32_16x16x32_bf16 v[220:223], a[204:207], v[140:143], v[220:223]
    s_waitcnt vmcnt(2) lgkmcnt(0)
    s_barrier
    v_mfma_f32_16x16x32_bf16 v[208:211], a[208:211], v[144:147], v[208:211]
    ds_read_b128 v[64:67], v8 offset:0
    ds_read_b128 v[68:71], v8 offset:32768
    v_mfma_f32_16x16x32_bf16 v[212:215], a[212:215], v[144:147], v[212:215]
    s_add_u32 m0, s6, 65536
    v_mfma_f32_16x16x32_bf16 v[216:219], a[208:211], v[148:151], v[216:219]
    ds_read_b128 v[72:75], v9 offset:0
    ds_read_b128 v[76:79], v9 offset:32768
    v_mfma_f32_16x16x32_bf16 v[220:223], a[212:215], v[148:151], v[220:223]
    buffer_load_dwordx4 v16, s[12:15], s29 offen offset:0 lds
    v_mfma_f32_16x16x32_bf16 v[208:211], a[216:219], v[152:155], v[208:211]
    ds_read_b128 v[80:83], v10 offset:0
    ds_read_b128 v[84:87], v10 offset:32768
    v_mfma_f32_16x16x32_bf16 v[212:215], a[220:223], v[152:155], v[212:215]
    v_mfma_f32_16x16x32_bf16 v[216:219], a[216:219], v[156:159], v[216:219]
    ds_read_b128 v[88:91], v11 offset:0
    ds_read_b128 v[92:95], v11 offset:32768
    v_mfma_f32_16x16x32_bf16 v[220:223], a[220:223], v[156:159], v[220:223]
    buffer_load_dwordx4 v16, s[12:15], s29 offen offset:1024 lds
    v_mfma_f32_16x16x32_bf16 v[208:211], a[224:227], v[160:163], v[208:211]
    ds_read_b128 v[96:99], v8 offset:256
    v_mfma_f32_16x16x32_bf16 v[212:215], a[228:231], v[160:163], v[212:215]
    v_mfma_f32_16x16x32_bf16 v[216:219], a[224:227], v[164:167], v[216:219]
    ds_read_b128 v[100:103], v8 offset:33024
    v_mfma_f32_16x16x32_bf16 v[220:223], a[228:231], v[164:167], v[220:223]
    buffer_load_dwordx4 v17, s[12:15], s29 offen offset:2048 lds
    v_mfma_f32_16x16x32_bf16 v[208:211], a[232:235], v[168:171], v[208:211]
    ds_read_b128 v[104:107], v9 offset:256
    v_mfma_f32_16x16x32_bf16 v[212:215], a[236:239], v[168:171], v[212:215]
    v_mfma_f32_16x16x32_bf16 v[216:219], a[232:235], v[172:175], v[216:219]
    ds_read_b128 v[108:111], v9 offset:33024
    v_mfma_f32_16x16x32_bf16 v[220:223], a[236:239], v[172:175], v[220:223]
    buffer_load_dwordx4 v17, s[12:15], s29 offen offset:3072 lds
    v_mfma_f32_16x16x32_bf16 v[208:211], a[240:243], v[176:179], v[208:211]
    ds_read_b128 v[112:115], v10 offset:256
    v_mfma_f32_16x16x32_bf16 v[212:215], a[244:247], v[176:179], v[212:215]
    s_add_u32 m0, s6, 69632
    v_mfma_f32_16x16x32_bf16 v[216:219], a[240:243], v[180:183], v[216:219]
    ds_read_b128 v[116:119], v10 offset:33024
    v_mfma_f32_16x16x32_bf16 v[220:223], a[244:247], v[180:183], v[220:223]
    buffer_load_dwordx4 v18, s[12:15], s29 offen offset:0 lds
    v_mfma_f32_16x16x32_bf16 v[208:211], a[248:251], v[184:187], v[208:211]
    ds_read_b128 v[120:123], v11 offset:256
    v_mfma_f32_16x16x32_bf16 v[212:215], a[252:255], v[184:187], v[212:215]
    v_mfma_f32_16x16x32_bf16 v[216:219], a[248:251], v[188:191], v[216:219]
    ds_read_b128 v[124:127], v11 offset:33024
    v_mfma_f32_16x16x32_bf16 v[220:223], a[252:255], v[188:191], v[220:223]
    buffer_load_dwordx4 v18, s[12:15], s29 offen offset:1024 lds
    s_cmp_lt_u32 s28, 64
    s_cbranch_scc1 .ql_210
    s_branch .qe_209
.vt_208:
.p2align 6
.ql_211:
    s_waitcnt lgkmcnt(12)
    v_mfma_f32_16x16x32_bf16 v[192:195], v[64:67], a[0:3], 0
    ds_read_b128 v[128:131], v8 offset:512
    v_mfma_f32_16x16x32_bf16 v[200:203], v[64:67], a[4:7], 0
    v_mfma_f32_16x16x32_bf16 v[196:199], v[68:71], a[0:3], 0
    ds_read_b128 v[132:135], v8 offset:33280
    v_mfma_f32_16x16x32_bf16 v[204:207], v[68:71], a[4:7], 0
    buffer_load_dwordx4 v19, s[12:15], s29 offen offset:2048 lds
    v_mfma_f32_16x16x32_bf16 v[192:195], v[72:75], a[8:11], v[192:195]
    ds_read_b128 v[136:139], v9 offset:512
    v_mfma_f32_16x16x32_bf16 v[200:203], v[72:75], a[12:15], v[200:203]
    v_cvt_pk_bf16_f32 v224, v208, v209
    v_cvt_pk_bf16_f32 v225, v210, v211
    v_mfma_f32_16x16x32_bf16 v[196:199], v[76:79], a[8:11], v[196:199]
    ds_read_b128 v[140:143], v9 offset:33280
    v_mfma_f32_16x16x32_bf16 v[204:207], v[76:79], a[12:15], v[204:207]
    buffer_load_dwordx4 v19, s[12:15], s29 offen offset:3072 lds
    s_waitcnt lgkmcnt(12)
    v_mfma_f32_16x16x32_bf16 v[192:195], v[80:83], a[16:19], v[192:195]
    ds_read_b128 v[144:147], v10 offset:512
    v_mfma_f32_16x16x32_bf16 v[200:203], v[80:83], a[20:23], v[200:203]
    s_add_u32 m0, s6, 73728
    v_cvt_pk_bf16_f32 v226, v212, v213
    v_cvt_pk_bf16_f32 v227, v214, v215
    v_mfma_f32_16x16x32_bf16 v[196:199], v[84:87], a[16:19], v[196:199]
    ds_read_b128 v[148:151], v10 offset:33280
    v_mfma_f32_16x16x32_bf16 v[204:207], v[84:87], a[20:23], v[204:207]
    buffer_load_dwordx4 v20, s[12:15], s29 offen offset:0 lds
    v_mfma_f32_16x16x32_bf16 v[192:195], v[88:91], a[24:27], v[192:195]
    ds_read_b128 v[152:155], v11 offset:512
    v_cvt_pk_bf16_f32 v228, v216, v217
    v_mfma_f32_16x16x32_bf16 v[200:203], v[88:91], a[28:31], v[200:203]
    buffer_store_dwordx4 v[224:227], v24, s[8:11], s30 offen sc1
    v_mfma_f32_16x16x32_bf16 v[196:199], v[92:95], a[24:27], v[196:199]
    ds_read_b128 v[156:159], v11 offset:33280
    v_cvt_pk_bf16_f32 v229, v218, v219
    v_mfma_f32_16x16x32_bf16 v[204:207], v[92:95], a[28:31], v[204:207]
    buffer_load_dwordx4 v20, s[12:15], s29 offen offset:1024 lds
    s_waitcnt lgkmcnt(12)
    v_mfma_f32_16x16x32_bf16 v[192:195], v[96:99], a[32:35], v[192:195]
    ds_read_b128 v[160:163], v8 offset:768
    v_mfma_f32_16x16x32_bf16 v[200:203], v[96:99], a[36:39], v[200:203]
    v_cvt_pk_bf16_f32 v230, v220, v221
    v_cvt_pk_bf16_f32 v231, v222, v223
    v_mfma_f32_16x16x32_bf16 v[196:199], v[100:103], a[32:35], v[196:199]
    ds_read_b128 v[164:167], v8 offset:33536
    v_mfma_f32_16x16x32_bf16 v[204:207], v[100:103], a[36:39], v[204:207]
    buffer_load_dwordx4 v21, s[12:15], s29 offen offset:2048 lds
    v_mfma_f32_16x16x32_bf16 v[192:195], v[104:107], a[40:43], v[192:195]
    ds_read_b128 v[168:171], v9 offset:768
    v_mfma_f32_16x16x32_bf16 v[200:203], v[104:107], a[44:47], v[200:203]
    buffer_store_dwordx4 v[228:231], v25, s[8:11], s30 offen sc1
    v_mfma_f32_16x16x32_bf16 v[196:199], v[108:111], a[40:43], v[196:199]
    ds_read_b128 v[172:175], v9 offset:33536
    v_mfma_f32_16x16x32_bf16 v[204:207], v[108:111], a[44:47], v[204:207]
    buffer_load_dwordx4 v21, s[12:15], s29 offen offset:3072 lds
    s_waitcnt lgkmcnt(12)
    v_mfma_f32_16x16x32_bf16 v[192:195], v[112:115], a[48:51], v[192:195]
    ds_read_b128 v[176:179], v10 offset:768
    v_mfma_f32_16x16x32_bf16 v[200:203], v[112:115], a[52:55], v[200:203]
    s_add_u32 m0, s6, 77824
    s_mov_b32 s30, s31
    v_mfma_f32_16x16x32_bf16 v[196:199], v[116:119], a[48:51], v[196:199]
    ds_read_b128 v[180:183], v10 offset:33536
    v_mfma_f32_16x16x32_bf16 v[204:207], v[116:119], a[52:55], v[204:207]
    buffer_load_dwordx4 v22, s[12:15], s29 offen offset:0 lds
    v_mfma_f32_16x16x32_bf16 v[192:195], v[120:123], a[56:59], v[192:195]
    ds_read_b128 v[184:187], v11 offset:768
    v_mfma_f32_16x16x32_bf16 v[200:203], v[120:123], a[60:63], v[200:203]
    s_add_u32 s31, s31, 262144
    v_mfma_f32_16x16x32_bf16 v[196:199], v[124:127], a[56:59], v[196:199]
    ds_read_b128 v[188:191], v11 offset:33536
    v_mfma_f32_16x16x32_bf16 v[204:207], v[124:127], a[60:63], v[204:207]
    buffer_load_dwordx4 v22, s[12:15], s29 offen offset:1024 lds
    s_waitcnt lgkmcnt(12)
    v_mfma_f32_16x16x32_bf16 v[192:195], v[128:131], a[64:67], v[192:195]
    ds_read_b128 v[64:67], v8 offset:1024
    v_mfma_f32_16x16x32_bf16 v[200:203], v[128:131], a[68:71], v[200:203]
    v_mfma_f32_16x16x32_bf16 v[196:199], v[132:135], a[64:67], v[196:199]
    ds_read_b128 v[68:71], v8 offset:33792
    v_mfma_f32_16x16x32_bf16 v[204:207], v[132:135], a[68:71], v[204:207]
    buffer_load_dwordx4 v23, s[12:15], s29 offen offset:2048 lds
    v_mfma_f32_16x16x32_bf16 v[192:195], v[136:139], a[72:75], v[192:195]
    ds_read_b128 v[72:75], v9 offset:1024
    v_mfma_f32_16x16x32_bf16 v[200:203], v[136:139], a[76:79], v[200:203]
    v_mfma_f32_16x16x32_bf16 v[196:199], v[140:143], a[72:75], v[196:199]
    ds_read_b128 v[76:79], v9 offset:33792
    v_mfma_f32_16x16x32_bf16 v[204:207], v[140:143], a[76:79], v[204:207]
    buffer_load_dwordx4 v23, s[12:15], s29 offen offset:3072 lds
    s_waitcnt lgkmcnt(12)
    v_mfma_f32_16x16x32_bf16 v[192:195], v[144:147], a[80:83], v[192:195]
    ds_read_b128 v[80:83], v10 offset:1024
    v_mfma_f32_16x16x32_bf16 v[200:203], v[144:147], a[84:87], v[200:203]
    v_mfma_f32_16x16x32_bf16 v[196:199], v[148:151], a[80:83], v[196:199]
    ds_read_b128 v[84:87], v10 offset:33792
    v_mfma_f32_16x16x32_bf16 v[204:207], v[148:151], a[84:87], v[204:207]
    buffer_load_dword v29, v28, s[12:15], s29 offen
    v_mfma_f32_16x16x32_bf16 v[192:195], v[152:155], a[88:91], v[192:195]
    ds_read_b128 v[88:91], v11 offset:1024
    v_mfma_f32_16x16x32_bf16 v[200:203], v[152:155], a[92:95], v[200:203]
    v_mfma_f32_16x16x32_bf16 v[196:199], v[156:159], a[88:91], v[196:199]
    ds_read_b128 v[92:95], v11 offset:33792
    v_mfma_f32_16x16x32_bf16 v[204:207], v[156:159], a[92:95], v[204:207]
    s_waitcnt lgkmcnt(12)
    v_mfma_f32_16x16x32_bf16 v[192:195], v[160:163], a[96:99], v[192:195]
    ds_read_b128 v[96:99], v8 offset:1280
    v_mfma_f32_16x16x32_bf16 v[200:203], v[160:163], a[100:103], v[200:203]
    v_mfma_f32_16x16x32_bf16 v[196:199], v[164:167], a[96:99], v[196:199]
    ds_read_b128 v[100:103], v8 offset:34048
    v_mfma_f32_16x16x32_bf16 v[204:207], v[164:167], a[100:103], v[204:207]
    v_mfma_f32_16x16x32_bf16 v[192:195], v[168:171], a[104:107], v[192:195]
    ds_read_b128 v[104:107], v9 offset:1280
    v_mfma_f32_16x16x32_bf16 v[200:203], v[168:171], a[108:111], v[200:203]
    v_mfma_f32_16x16x32_bf16 v[196:199], v[172:175], a[104:107], v[196:199]
    ds_read_b128 v[108:111], v9 offset:34048
    v_mfma_f32_16x16x32_bf16 v[204:207], v[172:175], a[108:111], v[204:207]
    s_waitcnt lgkmcnt(12)
    v_mfma_f32_16x16x32_bf16 v[192:195], v[176:179], a[112:115], v[192:195]
    ds_read_b128 v[112:115], v10 offset:1280
    v_mfma_f32_16x16x32_bf16 v[200:203], v[176:179], a[116:119], v[200:203]
    v_mfma_f32_16x16x32_bf16 v[196:199], v[180:183], a[112:115], v[196:199]
    ds_read_b128 v[116:119], v10 offset:34048
    v_mfma_f32_16x16x32_bf16 v[204:207], v[180:183], a[116:119], v[204:207]
    v_mfma_f32_16x16x32_bf16 v[192:195], v[184:187], a[120:123], v[192:195]
    ds_read_b128 v[120:123], v11 offset:1280
    v_mfma_f32_16x16x32_bf16 v[200:203], v[184:187], a[124:127], v[200:203]
    v_mfma_f32_16x16x32_bf16 v[196:199], v[188:191], a[120:123], v[196:199]
    ds_read_b128 v[124:127], v11 offset:34048
    v_mfma_f32_16x16x32_bf16 v[204:207], v[188:191], a[124:127], v[204:207]
    s_waitcnt lgkmcnt(12)
    v_mfma_f32_16x16x32_bf16 v[192:195], v[64:67], a[128:131], v[192:195]
    ds_read_b128 v[128:131], v8 offset:1536
    v_mfma_f32_16x16x32_bf16 v[200:203], v[64:67], a[132:135], v[200:203]
    v_mfma_f32_16x16x32_bf16 v[196:199], v[68:71], a[128:131], v[196:199]
    ds_read_b128 v[132:135], v8 offset:34304
    v_mfma_f32_16x16x32_bf16 v[204:207], v[68:71], a[132:135], v[204:207]
    v_mfma_f32_16x16x32_bf16 v[192:195], v[72:75], a[136:139], v[192:195]
    ds_read_b128 v[136:139], v9 offset:1536
    v_mfma_f32_16x16x32_bf16 v[200:203], v[72:75], a[140:143], v[200:203]
    v_mfma_f32_16x16x32_bf16 v[196:199], v[76:79], a[136:139], v[196:199]
    ds_read_b128 v[140:143], v9 offset:34304
    v_mfma_f32_16x16x32_bf16 v[204:207], v[76:79], a[140:143], v[204:207]
    s_waitcnt lgkmcnt(12)
    v_mfma_f32_16x16x32_bf16 v[192:195], v[80:83], a[144:147], v[192:195]
    ds_read_b128 v[144:147], v10 offset:1536
    v_mfma_f32_16x16x32_bf16 v[200:203], v[80:83], a[148:151], v[200:203]
    v_mfma_f32_16x16x32_bf16 v[196:199], v[84:87], a[144:147], v[196:199]
    ds_read_b128 v[148:151], v10 offset:34304
    v_mfma_f32_16x16x32_bf16 v[204:207], v[84:87], a[148:151], v[204:207]
    v_mfma_f32_16x16x32_bf16 v[192:195], v[88:91], a[152:155], v[192:195]
    ds_read_b128 v[152:155], v11 offset:1536
    v_mfma_f32_16x16x32_bf16 v[200:203], v[88:91], a[156:159], v[200:203]
    v_mfma_f32_16x16x32_bf16 v[196:199], v[92:95], a[152:155], v[196:199]
    ds_read_b128 v[156:159], v11 offset:34304
    v_mfma_f32_16x16x32_bf16 v[204:207], v[92:95], a[156:159], v[204:207]
    s_waitcnt lgkmcnt(12)
    v_mfma_f32_16x16x32_bf16 v[192:195], v[96:99], a[160:163], v[192:195]
    ds_read_b128 v[160:163], v8 offset:1792
    v_mfma_f32_16x16x32_bf16 v[200:203], v[96:99], a[164:167], v[200:203]
    v_mfma_f32_16x16x32_bf16 v[196:199], v[100:103], a[160:163], v[196:199]
    ds_read_b128 v[164:167], v8 offset:34560
    v_mfma_f32_16x16x32_bf16 v[204:207], v[100:103], a[164:167], v[204:207]
    v_mfma_f32_16x16x32_bf16 v[192:195], v[104:107], a[168:171], v[192:195]
    ds_read_b128 v[168:171], v9 offset:1792
    v_mfma_f32_16x16x32_bf16 v[200:203], v[104:107], a[172:175], v[200:203]
    v_mfma_f32_16x16x32_bf16 v[196:199], v[108:111], a[168:171], v[196:199]
    ds_read_b128 v[172:175], v9 offset:34560
    v_mfma_f32_16x16x32_bf16 v[204:207], v[108:111], a[172:175], v[204:207]
    s_waitcnt lgkmcnt(12)
    v_mfma_f32_16x16x32_bf16 v[192:195], v[112:115], a[176:179], v[192:195]
    ds_read_b128 v[176:179], v10 offset:1792
    v_mfma_f32_16x16x32_bf16 v[200:203], v[112:115], a[180:183], v[200:203]
    s_waitcnt vmcnt(6)
    v_mov_b32 v27, s28
    s_mov_b64 exec, 1
    buffer_store_dword v27, v26, s[8:11], s94 offen sc1
    s_mov_b64 exec, -1
    v_mfma_f32_16x16x32_bf16 v[196:199], v[116:119], a[176:179], v[196:199]
    ds_read_b128 v[180:183], v10 offset:34560
    v_mfma_f32_16x16x32_bf16 v[204:207], v[116:119], a[180:183], v[204:207]
    v_mfma_f32_16x16x32_bf16 v[192:195], v[120:123], a[184:187], v[192:195]
    ds_read_b128 v[184:187], v11 offset:1792
    v_mfma_f32_16x16x32_bf16 v[200:203], v[120:123], a[188:191], v[200:203]
    s_add_u32 s28, s28, 1
    v_mfma_f32_16x16x32_bf16 v[196:199], v[124:127], a[184:187], v[196:199]
    ds_read_b128 v[188:191], v11 offset:34560
    v_mfma_f32_16x16x32_bf16 v[204:207], v[124:127], a[188:191], v[204:207]
    s_waitcnt lgkmcnt(12)
    v_mfma_f32_16x16x32_bf16 v[192:195], v[128:131], a[192:195], v[192:195]
    v_mfma_f32_16x16x32_bf16 v[200:203], v[128:131], a[196:199], v[200:203]
    v_mfma_f32_16x16x32_bf16 v[196:199], v[132:135], a[192:195], v[196:199]
    v_mfma_f32_16x16x32_bf16 v[204:207], v[132:135], a[196:199], v[204:207]
    v_mfma_f32_16x16x32_bf16 v[192:195], v[136:139], a[200:203], v[192:195]
    v_mfma_f32_16x16x32_bf16 v[200:203], v[136:139], a[204:207], v[200:203]
    s_add_u32 s29, s29, 0x10000
    s_min_u32 s29, s29, 0x3f0000
    v_mfma_f32_16x16x32_bf16 v[196:199], v[140:143], a[200:203], v[196:199]
    v_mfma_f32_16x16x32_bf16 v[204:207], v[140:143], a[204:207], v[204:207]
    s_waitcnt vmcnt(2) lgkmcnt(0)
    s_barrier
    v_mfma_f32_16x16x32_bf16 v[192:195], v[144:147], a[208:211], v[192:195]
    ds_read_b128 v[64:67], v12 offset:0
    ds_read_b128 v[68:71], v12 offset:32768
    v_mfma_f32_16x16x32_bf16 v[200:203], v[144:147], a[212:215], v[200:203]
    s_add_u32 m0, s6, 0
    v_mfma_f32_16x16x32_bf16 v[196:199], v[148:151], a[208:211], v[196:199]
    ds_read_b128 v[72:75], v13 offset:0
    ds_read_b128 v[76:79], v13 offset:32768
    v_mfma_f32_16x16x32_bf16 v[204:207], v[148:151], a[212:215], v[204:207]
    buffer_load_dwordx4 v16, s[12:15], s29 offen offset:0 lds
    v_mfma_f32_16x16x32_bf16 v[192:195], v[152:155], a[216:219], v[192:195]
    ds_read_b128 v[80:83], v14 offset:0
    ds_read_b128 v[84:87], v14 offset:32768
    v_mfma_f32_16x16x32_bf16 v[200:203], v[152:155], a[220:223], v[200:203]
    v_mfma_f32_16x16x32_bf16 v[196:199], v[156:159], a[216:219], v[196:199]
    ds_read_b128 v[88:91], v15 offset:0
    ds_read_b128 v[92:95], v15 offset:32768
    v_mfma_f32_16x16x32_bf16 v[204:207], v[156:159], a[220:223], v[204:207]
    buffer_load_dwordx4 v16, s[12:15], s29 offen offset:1024 lds
    v_mfma_f32_16x16x32_bf16 v[192:195], v[160:163], a[224:227], v[192:195]
    ds_read_b128 v[96:99], v12 offset:256
    v_mfma_f32_16x16x32_bf16 v[200:203], v[160:163], a[228:231], v[200:203]
    v_mfma_f32_16x16x32_bf16 v[196:199], v[164:167], a[224:227], v[196:199]
    ds_read_b128 v[100:103], v12 offset:33024
    v_mfma_f32_16x16x32_bf16 v[204:207], v[164:167], a[228:231], v[204:207]
    buffer_load_dwordx4 v17, s[12:15], s29 offen offset:2048 lds
    v_mfma_f32_16x16x32_bf16 v[192:195], v[168:171], a[232:235], v[192:195]
    ds_read_b128 v[104:107], v13 offset:256
    v_mfma_f32_16x16x32_bf16 v[200:203], v[168:171], a[236:239], v[200:203]
    v_mfma_f32_16x16x32_bf16 v[196:199], v[172:175], a[232:235], v[196:199]
    ds_read_b128 v[108:111], v13 offset:33024
    v_mfma_f32_16x16x32_bf16 v[204:207], v[172:175], a[236:239], v[204:207]
    buffer_load_dwordx4 v17, s[12:15], s29 offen offset:3072 lds
    v_mfma_f32_16x16x32_bf16 v[192:195], v[176:179], a[240:243], v[192:195]
    ds_read_b128 v[112:115], v14 offset:256
    v_mfma_f32_16x16x32_bf16 v[200:203], v[176:179], a[244:247], v[200:203]
    s_add_u32 m0, s6, 4096
    v_mfma_f32_16x16x32_bf16 v[196:199], v[180:183], a[240:243], v[196:199]
    ds_read_b128 v[116:119], v14 offset:33024
    v_mfma_f32_16x16x32_bf16 v[204:207], v[180:183], a[244:247], v[204:207]
    buffer_load_dwordx4 v18, s[12:15], s29 offen offset:0 lds
    v_mfma_f32_16x16x32_bf16 v[192:195], v[184:187], a[248:251], v[192:195]
    ds_read_b128 v[120:123], v15 offset:256
    v_mfma_f32_16x16x32_bf16 v[200:203], v[184:187], a[252:255], v[200:203]
    v_mfma_f32_16x16x32_bf16 v[196:199], v[188:191], a[248:251], v[196:199]
    ds_read_b128 v[124:127], v15 offset:33024
    v_mfma_f32_16x16x32_bf16 v[204:207], v[188:191], a[252:255], v[204:207]
    buffer_load_dwordx4 v18, s[12:15], s29 offen offset:1024 lds
    s_waitcnt lgkmcnt(12)
    v_mfma_f32_16x16x32_bf16 v[208:211], v[64:67], a[0:3], 0
    ds_read_b128 v[128:131], v12 offset:512
    v_mfma_f32_16x16x32_bf16 v[216:219], v[64:67], a[4:7], 0
    v_mfma_f32_16x16x32_bf16 v[212:215], v[68:71], a[0:3], 0
    ds_read_b128 v[132:135], v12 offset:33280
    v_mfma_f32_16x16x32_bf16 v[220:223], v[68:71], a[4:7], 0
    buffer_load_dwordx4 v19, s[12:15], s29 offen offset:2048 lds
    v_mfma_f32_16x16x32_bf16 v[208:211], v[72:75], a[8:11], v[208:211]
    ds_read_b128 v[136:139], v13 offset:512
    v_mfma_f32_16x16x32_bf16 v[216:219], v[72:75], a[12:15], v[216:219]
    v_cvt_pk_bf16_f32 v224, v192, v193
    v_cvt_pk_bf16_f32 v225, v194, v195
    v_mfma_f32_16x16x32_bf16 v[212:215], v[76:79], a[8:11], v[212:215]
    ds_read_b128 v[140:143], v13 offset:33280
    v_mfma_f32_16x16x32_bf16 v[220:223], v[76:79], a[12:15], v[220:223]
    buffer_load_dwordx4 v19, s[12:15], s29 offen offset:3072 lds
    s_waitcnt lgkmcnt(12)
    v_mfma_f32_16x16x32_bf16 v[208:211], v[80:83], a[16:19], v[208:211]
    ds_read_b128 v[144:147], v14 offset:512
    v_mfma_f32_16x16x32_bf16 v[216:219], v[80:83], a[20:23], v[216:219]
    s_add_u32 m0, s6, 8192
    v_cvt_pk_bf16_f32 v226, v196, v197
    v_cvt_pk_bf16_f32 v227, v198, v199
    v_mfma_f32_16x16x32_bf16 v[212:215], v[84:87], a[16:19], v[212:215]
    ds_read_b128 v[148:151], v14 offset:33280
    v_mfma_f32_16x16x32_bf16 v[220:223], v[84:87], a[20:23], v[220:223]
    buffer_load_dwordx4 v20, s[12:15], s29 offen offset:0 lds
    v_mfma_f32_16x16x32_bf16 v[208:211], v[88:91], a[24:27], v[208:211]
    ds_read_b128 v[152:155], v15 offset:512
    v_cvt_pk_bf16_f32 v228, v200, v201
    v_mfma_f32_16x16x32_bf16 v[216:219], v[88:91], a[28:31], v[216:219]
    buffer_store_dwordx4 v[224:227], v24, s[8:11], s30 offen sc1
    v_mfma_f32_16x16x32_bf16 v[212:215], v[92:95], a[24:27], v[212:215]
    ds_read_b128 v[156:159], v15 offset:33280
    v_cvt_pk_bf16_f32 v229, v202, v203
    v_mfma_f32_16x16x32_bf16 v[220:223], v[92:95], a[28:31], v[220:223]
    buffer_load_dwordx4 v20, s[12:15], s29 offen offset:1024 lds
    s_waitcnt lgkmcnt(12)
    v_mfma_f32_16x16x32_bf16 v[208:211], v[96:99], a[32:35], v[208:211]
    ds_read_b128 v[160:163], v12 offset:768
    v_mfma_f32_16x16x32_bf16 v[216:219], v[96:99], a[36:39], v[216:219]
    v_cvt_pk_bf16_f32 v230, v204, v205
    v_cvt_pk_bf16_f32 v231, v206, v207
    v_mfma_f32_16x16x32_bf16 v[212:215], v[100:103], a[32:35], v[212:215]
    ds_read_b128 v[164:167], v12 offset:33536
    v_mfma_f32_16x16x32_bf16 v[220:223], v[100:103], a[36:39], v[220:223]
    buffer_load_dwordx4 v21, s[12:15], s29 offen offset:2048 lds
    v_mfma_f32_16x16x32_bf16 v[208:211], v[104:107], a[40:43], v[208:211]
    ds_read_b128 v[168:171], v13 offset:768
    v_mfma_f32_16x16x32_bf16 v[216:219], v[104:107], a[44:47], v[216:219]
    buffer_store_dwordx4 v[228:231], v25, s[8:11], s30 offen sc1
    v_mfma_f32_16x16x32_bf16 v[212:215], v[108:111], a[40:43], v[212:215]
    ds_read_b128 v[172:175], v13 offset:33536
    v_mfma_f32_16x16x32_bf16 v[220:223], v[108:111], a[44:47], v[220:223]
    buffer_load_dwordx4 v21, s[12:15], s29 offen offset:3072 lds
    s_waitcnt lgkmcnt(12)
    v_mfma_f32_16x16x32_bf16 v[208:211], v[112:115], a[48:51], v[208:211]
    ds_read_b128 v[176:179], v14 offset:768
    v_mfma_f32_16x16x32_bf16 v[216:219], v[112:115], a[52:55], v[216:219]
    s_add_u32 m0, s6, 12288
    s_mov_b32 s30, s31
    v_mfma_f32_16x16x32_bf16 v[212:215], v[116:119], a[48:51], v[212:215]
    ds_read_b128 v[180:183], v14 offset:33536
    v_mfma_f32_16x16x32_bf16 v[220:223], v[116:119], a[52:55], v[220:223]
    buffer_load_dwordx4 v22, s[12:15], s29 offen offset:0 lds
    v_mfma_f32_16x16x32_bf16 v[208:211], v[120:123], a[56:59], v[208:211]
    ds_read_b128 v[184:187], v15 offset:768
    v_mfma_f32_16x16x32_bf16 v[216:219], v[120:123], a[60:63], v[216:219]
    s_add_u32 s31, s31, 262144
    v_mfma_f32_16x16x32_bf16 v[212:215], v[124:127], a[56:59], v[212:215]
    ds_read_b128 v[188:191], v15 offset:33536
    v_mfma_f32_16x16x32_bf16 v[220:223], v[124:127], a[60:63], v[220:223]
    buffer_load_dwordx4 v22, s[12:15], s29 offen offset:1024 lds
    s_waitcnt lgkmcnt(12)
    v_mfma_f32_16x16x32_bf16 v[208:211], v[128:131], a[64:67], v[208:211]
    ds_read_b128 v[64:67], v12 offset:1024
    v_mfma_f32_16x16x32_bf16 v[216:219], v[128:131], a[68:71], v[216:219]
    v_mfma_f32_16x16x32_bf16 v[212:215], v[132:135], a[64:67], v[212:215]
    ds_read_b128 v[68:71], v12 offset:33792
    v_mfma_f32_16x16x32_bf16 v[220:223], v[132:135], a[68:71], v[220:223]
    buffer_load_dwordx4 v23, s[12:15], s29 offen offset:2048 lds
    v_mfma_f32_16x16x32_bf16 v[208:211], v[136:139], a[72:75], v[208:211]
    ds_read_b128 v[72:75], v13 offset:1024
    v_mfma_f32_16x16x32_bf16 v[216:219], v[136:139], a[76:79], v[216:219]
    v_mfma_f32_16x16x32_bf16 v[212:215], v[140:143], a[72:75], v[212:215]
    ds_read_b128 v[76:79], v13 offset:33792
    v_mfma_f32_16x16x32_bf16 v[220:223], v[140:143], a[76:79], v[220:223]
    buffer_load_dwordx4 v23, s[12:15], s29 offen offset:3072 lds
    s_waitcnt lgkmcnt(12)
    v_mfma_f32_16x16x32_bf16 v[208:211], v[144:147], a[80:83], v[208:211]
    ds_read_b128 v[80:83], v14 offset:1024
    v_mfma_f32_16x16x32_bf16 v[216:219], v[144:147], a[84:87], v[216:219]
    v_mfma_f32_16x16x32_bf16 v[212:215], v[148:151], a[80:83], v[212:215]
    ds_read_b128 v[84:87], v14 offset:33792
    v_mfma_f32_16x16x32_bf16 v[220:223], v[148:151], a[84:87], v[220:223]
    buffer_load_dword v29, v28, s[12:15], s29 offen
    v_mfma_f32_16x16x32_bf16 v[208:211], v[152:155], a[88:91], v[208:211]
    ds_read_b128 v[88:91], v15 offset:1024
    v_mfma_f32_16x16x32_bf16 v[216:219], v[152:155], a[92:95], v[216:219]
    v_mfma_f32_16x16x32_bf16 v[212:215], v[156:159], a[88:91], v[212:215]
    ds_read_b128 v[92:95], v15 offset:33792
    v_mfma_f32_16x16x32_bf16 v[220:223], v[156:159], a[92:95], v[220:223]
    s_waitcnt lgkmcnt(12)
    v_mfma_f32_16x16x32_bf16 v[208:211], v[160:163], a[96:99], v[208:211]
    ds_read_b128 v[96:99], v12 offset:1280
    v_mfma_f32_16x16x32_bf16 v[216:219], v[160:163], a[100:103], v[216:219]
    v_mfma_f32_16x16x32_bf16 v[212:215], v[164:167], a[96:99], v[212:215]
    ds_read_b128 v[100:103], v12 offset:34048
    v_mfma_f32_16x16x32_bf16 v[220:223], v[164:167], a[100:103], v[220:223]
    v_mfma_f32_16x16x32_bf16 v[208:211], v[168:171], a[104:107], v[208:211]
    ds_read_b128 v[104:107], v13 offset:1280
    v_mfma_f32_16x16x32_bf16 v[216:219], v[168:171], a[108:111], v[216:219]
    v_mfma_f32_16x16x32_bf16 v[212:215], v[172:175], a[104:107], v[212:215]
    ds_read_b128 v[108:111], v13 offset:34048
    v_mfma_f32_16x16x32_bf16 v[220:223], v[172:175], a[108:111], v[220:223]
    s_waitcnt lgkmcnt(12)
    v_mfma_f32_16x16x32_bf16 v[208:211], v[176:179], a[112:115], v[208:211]
    ds_read_b128 v[112:115], v14 offset:1280
    v_mfma_f32_16x16x32_bf16 v[216:219], v[176:179], a[116:119], v[216:219]
    v_mfma_f32_16x16x32_bf16 v[212:215], v[180:183], a[112:115], v[212:215]
    ds_read_b128 v[116:119], v14 offset:34048
    v_mfma_f32_16x16x32_bf16 v[220:223], v[180:183], a[116:119], v[220:223]
    v_mfma_f32_16x16x32_bf16 v[208:211], v[184:187], a[120:123], v[208:211]
    ds_read_b128 v[120:123], v15 offset:1280
    v_mfma_f32_16x16x32_bf16 v[216:219], v[184:187], a[124:127], v[216:219]
    v_mfma_f32_16x16x32_bf16 v[212:215], v[188:191], a[120:123], v[212:215]
    ds_read_b128 v[124:127], v15 offset:34048
    v_mfma_f32_16x16x32_bf16 v[220:223], v[188:191], a[124:127], v[220:223]
    s_waitcnt lgkmcnt(12)
    v_mfma_f32_16x16x32_bf16 v[208:211], v[64:67], a[128:131], v[208:211]
    ds_read_b128 v[128:131], v12 offset:1536
    v_mfma_f32_16x16x32_bf16 v[216:219], v[64:67], a[132:135], v[216:219]
    v_mfma_f32_16x16x32_bf16 v[212:215], v[68:71], a[128:131], v[212:215]
    ds_read_b128 v[132:135], v12 offset:34304
    v_mfma_f32_16x16x32_bf16 v[220:223], v[68:71], a[132:135], v[220:223]
    v_mfma_f32_16x16x32_bf16 v[208:211], v[72:75], a[136:139], v[208:211]
    ds_read_b128 v[136:139], v13 offset:1536
    v_mfma_f32_16x16x32_bf16 v[216:219], v[72:75], a[140:143], v[216:219]
    v_mfma_f32_16x16x32_bf16 v[212:215], v[76:79], a[136:139], v[212:215]
    ds_read_b128 v[140:143], v13 offset:34304
    v_mfma_f32_16x16x32_bf16 v[220:223], v[76:79], a[140:143], v[220:223]
    s_waitcnt lgkmcnt(12)
    v_mfma_f32_16x16x32_bf16 v[208:211], v[80:83], a[144:147], v[208:211]
    ds_read_b128 v[144:147], v14 offset:1536
    v_mfma_f32_16x16x32_bf16 v[216:219], v[80:83], a[148:151], v[216:219]
    v_mfma_f32_16x16x32_bf16 v[212:215], v[84:87], a[144:147], v[212:215]
    ds_read_b128 v[148:151], v14 offset:34304
    v_mfma_f32_16x16x32_bf16 v[220:223], v[84:87], a[148:151], v[220:223]
    v_mfma_f32_16x16x32_bf16 v[208:211], v[88:91], a[152:155], v[208:211]
    ds_read_b128 v[152:155], v15 offset:1536
    v_mfma_f32_16x16x32_bf16 v[216:219], v[88:91], a[156:159], v[216:219]
    v_mfma_f32_16x16x32_bf16 v[212:215], v[92:95], a[152:155], v[212:215]
    ds_read_b128 v[156:159], v15 offset:34304
    v_mfma_f32_16x16x32_bf16 v[220:223], v[92:95], a[156:159], v[220:223]
    s_waitcnt lgkmcnt(12)
    v_mfma_f32_16x16x32_bf16 v[208:211], v[96:99], a[160:163], v[208:211]
    ds_read_b128 v[160:163], v12 offset:1792
    v_mfma_f32_16x16x32_bf16 v[216:219], v[96:99], a[164:167], v[216:219]
    v_mfma_f32_16x16x32_bf16 v[212:215], v[100:103], a[160:163], v[212:215]
    ds_read_b128 v[164:167], v12 offset:34560
    v_mfma_f32_16x16x32_bf16 v[220:223], v[100:103], a[164:167], v[220:223]
    v_mfma_f32_16x16x32_bf16 v[208:211], v[104:107], a[168:171], v[208:211]
    ds_read_b128 v[168:171], v13 offset:1792
    v_mfma_f32_16x16x32_bf16 v[216:219], v[104:107], a[172:175], v[216:219]
    v_mfma_f32_16x16x32_bf16 v[212:215], v[108:111], a[168:171], v[212:215]
    ds_read_b128 v[172:175], v13 offset:34560
    v_mfma_f32_16x16x32_bf16 v[220:223], v[108:111], a[172:175], v[220:223]
    s_waitcnt lgkmcnt(12)
    v_mfma_f32_16x16x32_bf16 v[208:211], v[112:115], a[176:179], v[208:211]
    ds_read_b128 v[176:179], v14 offset:1792
    v_mfma_f32_16x16x32_bf16 v[216:219], v[112:115], a[180:183], v[216:219]
    s_waitcnt vmcnt(6)
    v_mov_b32 v27, s28
    s_mov_b64 exec, 1
    buffer_store_dword v27, v26, s[8:11], s94 offen sc1
    s_mov_b64 exec, -1
    v_mfma_f32_16x16x32_bf16 v[212:215], v[116:119], a[176:179], v[212:215]
    ds_read_b128 v[180:183], v14 offset:34560
    v_mfma_f32_16x16x32_bf16 v[220:223], v[116:119], a[180:183], v[220:223]
    v_mfma_f32_16x16x32_bf16 v[208:211], v[120:123], a[184:187], v[208:211]
    ds_read_b128 v[184:187], v15 offset:1792
    v_mfma_f32_16x16x32_bf16 v[216:219], v[120:123], a[188:191], v[216:219]
    s_add_u32 s28, s28, 1
    v_mfma_f32_16x16x32_bf16 v[212:215], v[124:127], a[184:187], v[212:215]
    ds_read_b128 v[188:191], v15 offset:34560
    v_mfma_f32_16x16x32_bf16 v[220:223], v[124:127], a[188:191], v[220:223]
    s_waitcnt lgkmcnt(12)
    v_mfma_f32_16x16x32_bf16 v[208:211], v[128:131], a[192:195], v[208:211]
    v_mfma_f32_16x16x32_bf16 v[216:219], v[128:131], a[196:199], v[216:219]
    v_mfma_f32_16x16x32_bf16 v[212:215], v[132:135], a[192:195], v[212:215]
    v_mfma_f32_16x16x32_bf16 v[220:223], v[132:135], a[196:199], v[220:223]
    v_mfma_f32_16x16x32_bf16 v[208:211], v[136:139], a[200:203], v[208:211]
    v_mfma_f32_16x16x32_bf16 v[216:219], v[136:139], a[204:207], v[216:219]
    s_add_u32 s29, s29, 0x10000
    s_min_u32 s29, s29, 0x3f0000
    v_mfma_f32_16x16x32_bf16 v[212:215], v[140:143], a[200:203], v[212:215]
    v_mfma_f32_16x16x32_bf16 v[220:223], v[140:143], a[204:207], v[220:223]
    s_waitcnt vmcnt(2) lgkmcnt(0)
    s_barrier
    v_mfma_f32_16x16x32_bf16 v[208:211], v[144:147], a[208:211], v[208:211]
    ds_read_b128 v[64:67], v8 offset:0
    ds_read_b128 v[68:71], v8 offset:32768
    v_mfma_f32_16x16x32_bf16 v[216:219], v[144:147], a[212:215], v[216:219]
    s_add_u32 m0, s6, 65536
    v_mfma_f32_16x16x32_bf16 v[212:215], v[148:151], a[208:211], v[212:215]
    ds_read_b128 v[72:75], v9 offset:0
    ds_read_b128 v[76:79], v9 offset:32768
    v_mfma_f32_16x16x32_bf16 v[220:223], v[148:151], a[212:215], v[220:223]
    buffer_load_dwordx4 v16, s[12:15], s29 offen offset:0 lds
    v_mfma_f32_16x16x32_bf16 v[208:211], v[152:155], a[216:219], v[208:211]
    ds_read_b128 v[80:83], v10 offset:0
    ds_read_b128 v[84:87], v10 offset:32768
    v_mfma_f32_16x16x32_bf16 v[216:219], v[152:155], a[220:223], v[216:219]
    v_mfma_f32_16x16x32_bf16 v[212:215], v[156:159], a[216:219], v[212:215]
    ds_read_b128 v[88:91], v11 offset:0
    ds_read_b128 v[92:95], v11 offset:32768
    v_mfma_f32_16x16x32_bf16 v[220:223], v[156:159], a[220:223], v[220:223]
    buffer_load_dwordx4 v16, s[12:15], s29 offen offset:1024 lds
    v_mfma_f32_16x16x32_bf16 v[208:211], v[160:163], a[224:227], v[208:211]
    ds_read_b128 v[96:99], v8 offset:256
    v_mfma_f32_16x16x32_bf16 v[216:219], v[160:163], a[228:231], v[216:219]
    v_mfma_f32_16x16x32_bf16 v[212:215], v[164:167], a[224:227], v[212:215]
    ds_read_b128 v[100:103], v8 offset:33024
    v_mfma_f32_16x16x32_bf16 v[220:223], v[164:167], a[228:231], v[220:223]
    buffer_load_dwordx4 v17, s[12:15], s29 offen offset:2048 lds
    v_mfma_f32_16x16x32_bf16 v[208:211], v[168:171], a[232:235], v[208:211]
    ds_read_b128 v[104:107], v9 offset:256
    v_mfma_f32_16x16x32_bf16 v[216:219], v[168:171], a[236:239], v[216:219]
    v_mfma_f32_16x16x32_bf16 v[212:215], v[172:175], a[232:235], v[212:215]
    ds_read_b128 v[108:111], v9 offset:33024
    v_mfma_f32_16x16x32_bf16 v[220:223], v[172:175], a[236:239], v[220:223]
    buffer_load_dwordx4 v17, s[12:15], s29 offen offset:3072 lds
    v_mfma_f32_16x16x32_bf16 v[208:211], v[176:179], a[240:243], v[208:211]
    ds_read_b128 v[112:115], v10 offset:256
    v_mfma_f32_16x16x32_bf16 v[216:219], v[176:179], a[244:247], v[216:219]
    s_add_u32 m0, s6, 69632
    v_mfma_f32_16x16x32_bf16 v[212:215], v[180:183], a[240:243], v[212:215]
    ds_read_b128 v[116:119], v10 offset:33024
    v_mfma_f32_16x16x32_bf16 v[220:223], v[180:183], a[244:247], v[220:223]
    buffer_load_dwordx4 v18, s[12:15], s29 offen offset:0 lds
    v_mfma_f32_16x16x32_bf16 v[208:211], v[184:187], a[248:251], v[208:211]
    ds_read_b128 v[120:123], v11 offset:256
    v_mfma_f32_16x16x32_bf16 v[216:219], v[184:187], a[252:255], v[216:219]
    v_mfma_f32_16x16x32_bf16 v[212:215], v[188:191], a[248:251], v[212:215]
    ds_read_b128 v[124:127], v11 offset:33024
    v_mfma_f32_16x16x32_bf16 v[220:223], v[188:191], a[252:255], v[220:223]
    buffer_load_dwordx4 v18, s[12:15], s29 offen offset:1024 lds
    s_cmp_lt_u32 s28, 64
    s_cbranch_scc1 .ql_211
.qe_209:
    s_nop 7
    v_cvt_pk_bf16_f32 v224, v208, v209
    v_cvt_pk_bf16_f32 v225, v210, v211
    v_cvt_pk_bf16_f32 v226, v212, v213
    v_cvt_pk_bf16_f32 v227, v214, v215
    v_cvt_pk_bf16_f32 v228, v216, v217
    v_cvt_pk_bf16_f32 v229, v218, v219
    v_cvt_pk_bf16_f32 v230, v220, v221
    v_cvt_pk_bf16_f32 v231, v222, v223
    buffer_store_dwordx4 v[224:227], v24, s[8:11], s30 offen sc1
    buffer_store_dwordx4 v[228:231], v25, s[8:11], s30 offen sc1
    s_waitcnt vmcnt(0) lgkmcnt(0)
    v_mov_b32 v27, s28
    s_mov_b64 exec, 1
    buffer_store_dword v27, v26, s[8:11], s94 offen sc1
    s_mov_b64 exec, -1
    s_branch .ph2_195
.qa_207:
    s_and_b32 s34, s24, 1
    s_lshr_b32 s35, s24, 1
    s_lshl_b32 s4, s35, 10
    s_add_u32 s4, s4, 2048
    v_lshlrev_b32 v2, 4, v1
    s_lshl_b32 s5, s24, 10
    s_add_u32 s5, s5, 131072
    v_add_u32 v24, s5, v2
    s_lshl_b32 s5, s34, 12
    s_add_u32 s5, s5, 131072
    v_add_u32 v25, s5, v2
    v_add_u32 v31, 139264, v2
    s_lshl_b32 s5, s35, 12
    v_add_u32 v5, s5, v31
    s_lshl_b32 s43, s24, 11
    v_bfe_u32 v254, v1, 4, 2
    v_mul_u32_u24 v3, 128, v254
    v_bfe_u32 v254, v1, 2, 2
    v_mul_u32_u24 v254, 32, v254
    v_add_u32 v3, v3, v254
    v_bfe_u32 v254, v1, 0, 1
    v_mul_u32_u24 v254, 16, v254
    v_add_u32 v3, v3, v254
    v_add_u32 v3, 155648, v3
    v_bfe_u32 v254, v1, 2, 2
    v_mul_u32_u24 v6, 128, v254
    v_bfe_u32 v254, v1, 0, 2
    v_mul_u32_u24 v254, 16, v254
    v_add_u32 v6, v6, v254
    v_bfe_u32 v254, v1, 4, 2
    v_mul_u32_u24 v254, 4, v254
    v_add_u32 v6, v6, v254
    v_add_u32 v6, 155648, v6
    v_add_u32 v6, s4, v6
    s_lshl_b32 s4, s99, 7
    s_add_u32 s4, s4, 92274688
    v_bfe_u32 v254, v1, 0, 2
    v_mul_u32_u24 v7, 4, v254
    v_add_u32 v7, s4, v7
    v_mov_b32 v232, 0
    v_mov_b32 v233, 0
    v_mov_b32 v234, 0
    v_mov_b32 v235, 0
    v_mov_b32 v236, 0
    v_mov_b32 v237, 0
    v_mov_b32 v238, 0
    v_mov_b32 v239, 0
    v_mov_b32 v240, 0
    v_mov_b32 v241, 0
    v_mov_b32 v40, 0
    v_mov_b32 v44, 0x3f803f80
    v_mov_b32 v41, 0
    v_mov_b32 v45, 0x3f803f80
    v_mov_b32 v42, 0
    v_mov_b32 v46, 0x3f803f80
    v_mov_b32 v43, 0
    v_mov_b32 v47, 0x3f803f80
    s_lshl_b32 s4, s34, 4
    v_and_b32 v48, 15, v1
    v_add_u32 v48, s4, v48
    v_lshrrev_b32 v49, 4, v1
    v_lshlrev_b32 v49, 2, v49
    v_mov_b32 v51, 0xff800000
    v_add_u32 v50, 0, v49
    v_cmp_le_u32 vcc, v50, v48
    s_nop 1
    v_cndmask_b32 v32, v51, v40, vcc
    v_add_u32 v50, 1, v49
    v_cmp_le_u32 vcc, v50, v48
    s_nop 1
    v_cndmask_b32 v33, v51, v40, vcc
    v_add_u32 v50, 2, v49
    v_cmp_le_u32 vcc, v50, v48
    s_nop 1
    v_cndmask_b32 v34, v51, v40, vcc
    v_add_u32 v50, 3, v49
    v_cmp_le_u32 vcc, v50, v48
    s_nop 1
    v_cndmask_b32 v35, v51, v40, vcc
    v_add_u32 v50, 16, v49
    v_cmp_le_u32 vcc, v50, v48
    s_nop 1
    v_cndmask_b32 v36, v51, v40, vcc
    v_add_u32 v50, 17, v49
    v_cmp_le_u32 vcc, v50, v48
    s_nop 1
    v_cndmask_b32 v37, v51, v40, vcc
    v_add_u32 v50, 18, v49
    v_cmp_le_u32 vcc, v50, v48
    s_nop 1
    v_cndmask_b32 v38, v51, v40, vcc
    v_add_u32 v50, 19, v49
    v_cmp_le_u32 vcc, v50, v48
    s_nop 1
    v_cndmask_b32 v39, v51, v40, vcc
    s_lshl_b32 s4, s99, 7
    s_add_u32 s94, s4, 92286976
    s_movk_i32 s46, 4096
    s_movk_i32 s47, 8192
    s_mov_b32 s30, -1
    s_mov_b32 s32, 0
    s_mov_b32 s33, 0
    s_mov_b32 s42, 0
    s_mov_b32 s53, 75497472
    s_mov_b32 s45, 0x3e0293ee
    s_lshl_b32 s36, s99, 13
    s_add_u32 s36, s36, s43
    s_add_u32 s36, s36, 16777216
    s_add_u32 s43, s43, 139264
    s_sub_u32 s37, s36, 0x40000
    v_and_b32 v255, 15, v1
    v_bfe_u32 v254, v1, 4, 1
    v_lshlrev_b32 v255, 7, v255
    v_lshl_add_u32 v255, v254, 24, v255
    s_lshl_b32 s39, s99, 12
    s_lshl_b32 s4, s34, 17
    s_add_u32 s40, s39, s4
    s_lshl_b32 s4, s35, 11
    s_add_u32 s40, s40, s4
    s_add_u32 s40, s40, 50331648
    s_add_u32 s39, s39, 67108864
    s_lshl_b32 s52, s24, 10
    s_add_u32 s39, s39, s52
    s_add_u32 s52, s52, 155648
    s_mov_b32 s31, 1
    s_sub_u32 s48, s39, 0x20000
    s_mov_b32 s49, s37
    s_cmp_gt_u32 s32, 0
    s_cbranch_scc1 .ndd_223
    s_mov_b32 s62, 0
.nd_222:
    buffer_load_dword v29, v7, s[8:11], s46 offen sc1
    buffer_load_dword v30, v7, s[8:11], s47 offen sc1
    s_add_u32 s62, s62, 1
    s_cmp_gt_u32 s62, 0x200000
    s_cbranch_scc1 .mg_end_1
    s_waitcnt vmcnt(0)
    v_min_u32 v29, v29, v30
    s_nop 1
    v_min_u32_dpp v29, v29, v29 quad_perm:[1,0,3,2] row_mask:0xf bank_mask:0xf
    s_nop 1
    v_min_u32_dpp v29, v29, v29 quad_perm:[2,3,0,1] row_mask:0xf bank_mask:0xf
    s_nop 1
    v_readfirstlane_b32 s32, v29
    s_lshl_b32 s55, s32, 18
    s_add_u32 s55, s55, s37
    s_cmp_gt_u32 s32, 0
    s_cbranch_scc1 .ndd_223
    s_sleep 4
    s_branch .nd_222
.ndd_223:
    s_waitcnt lgkmcnt(0)
.p2align 6
.ql_224:
    s_waitcnt lgkmcnt(8)
    v_mfma_f32_16x16x32_bf16 v[192:195], a[0:3], v[64:67], 0
    buffer_load_dwordx4 v19, s[12:15], s29 offen offset:2048 lds
    v_mfma_f32_16x16x32_bf16 v[196:199], a[4:7], v[64:67], 0
    ds_read_b128 v[112:115], v10 offset:256
    ds_read_b128 v[116:119], v10 offset:33024
    v_mfma_f32_16x16x32_bf16 v[200:203], a[0:3], v[68:71], 0
    ds_read_b128 v[120:123], v11 offset:256
    ds_read_b128 v[124:127], v11 offset:33024
    v_mfma_f32_16x16x32_bf16 v[204:207], a[4:7], v[68:71], 0
    ds_read_b128 v[64:67], v8 offset:512
    ds_read_b128 v[68:71], v8 offset:33280
    v_mfma_f32_16x16x32_bf16 v[192:195], a[8:11], v[72:75], v[192:195]
    buffer_load_dwordx4 v19, s[12:15], s29 offen offset:3072 lds
    v_mfma_f32_16x16x32_bf16 v[196:199], a[12:15], v[72:75], v[196:199]
    v_cvt_pk_bf16_f32 v224, v208, v209
    v_cvt_pk_bf16_f32 v225, v210, v211
    v_mfma_f32_16x16x32_bf16 v[200:203], a[8:11], v[76:79], v[200:203]
    v_cvt_pk_bf16_f32 v226, v212, v213
    v_cvt_pk_bf16_f32 v227, v214, v215
    v_mfma_f32_16x16x32_bf16 v[204:207], a[12:15], v[76:79], v[204:207]
    ds_write_b128 v24, v[224:227] offset:0
    s_waitcnt lgkmcnt(11)
    v_mfma_f32_16x16x32_bf16 v[192:195], a[16:19], v[80:83], v[192:195]
    s_add_u32 m0, s6, 73728
    v_cvt_pk_bf16_f32 v228, v216, v217
    v_mfma_f32_16x16x32_bf16 v[196:199], a[20:23], v[80:83], v[196:199]
    buffer_load_dwordx4 v20, s[12:15], s29 offen offset:0 lds
    v_mfma_f32_16x16x32_bf16 v[200:203], a[16:19], v[84:87], v[200:203]
    v_cvt_pk_bf16_f32 v229, v218, v219
    v_cvt_pk_bf16_f32 v230, v220, v221
    v_mfma_f32_16x16x32_bf16 v[204:207], a[20:23], v[84:87], v[204:207]
    v_cvt_pk_bf16_f32 v231, v222, v223
    ds_write_b128 v24, v[228:231] offset:4096
    v_mfma_f32_16x16x32_bf16 v[192:195], a[24:27], v[88:91], v[192:195]
    ds_read_b128 v[72:75], v9 offset:512
    ds_read_b128 v[76:79], v9 offset:33280
    v_mfma_f32_16x16x32_bf16 v[196:199], a[28:31], v[88:91], v[196:199]
    buffer_load_dwordx4 v20, s[12:15], s29 offen offset:1024 lds
    v_mfma_f32_16x16x32_bf16 v[200:203], a[24:27], v[92:95], v[200:203]
    ds_read_b128 v[80:83], v10 offset:512
    ds_read_b128 v[84:87], v10 offset:33280
    v_mfma_f32_16x16x32_bf16 v[204:207], a[28:31], v[92:95], v[204:207]
    ds_read_b128 v[88:91], v11 offset:512
    s_waitcnt lgkmcnt(13)
    v_mfma_f32_16x16x32_bf16 v[192:195], a[32:35], v[96:99], v[192:195]
    s_waitcnt vmcnt(13) lgkmcnt(5)
    s_barrier
    v_mfma_f32_16x16x32_bf16 v[196:199], a[36:39], v[96:99], v[196:199]
    buffer_load_dwordx4 v21, s[12:15], s29 offen offset:2048 lds
    v_mfma_f32_16x16x32_bf16 v[200:203], a[32:35], v[100:103], v[200:203]
    ds_read_b128 v[208:211], v25 offset:0
    ds_read_b128 v[128:131], v31 offset:0
    v_mfma_f32_16x16x32_bf16 v[204:207], a[36:39], v[100:103], v[204:207]
    ds_read_b128 v[144:147], v31 offset:4096
    ds_read_b128 v[212:215], v25 offset:1024
    v_mfma_f32_16x16x32_bf16 v[192:195], a[40:43], v[104:107], v[192:195]
    ds_read_b128 v[132:135], v31 offset:1024
    ds_read_b128 v[148:151], v31 offset:5120
    v_mfma_f32_16x16x32_bf16 v[196:199], a[44:47], v[104:107], v[196:199]
    buffer_load_dwordx4 v21, s[12:15], s29 offen offset:3072 lds
    v_mfma_f32_16x16x32_bf16 v[200:203], a[40:43], v[108:111], v[200:203]
    ds_read_b128 v[92:95], v11 offset:33280
    ds_read_b128 v[216:219], v25 offset:2048
    v_mfma_f32_16x16x32_bf16 v[204:207], a[44:47], v[108:111], v[204:207]
    ds_read_b128 v[136:139], v31 offset:2048
    ds_read_b128 v[152:155], v31 offset:6144
    v_mfma_f32_16x16x32_bf16 v[192:195], a[48:51], v[112:115], v[192:195]
    ds_read_b128 v[220:223], v25 offset:3072
    ds_read_b128 v[140:143], v31 offset:3072
    v_mfma_f32_16x16x32_bf16 v[196:199], a[52:55], v[112:115], v[196:199]
    s_add_u32 m0, s6, 77824
    s_waitcnt lgkmcnt(9)
    v_mfma_f32_16x16x32_bf16 v[48:51], v[128:131], v[208:211], v[32:35]
    buffer_load_dwordx4 v22, s[12:15], s29 offen offset:0 lds
    v_mfma_f32_16x16x32_bf16 v[52:55], v[144:147], v[208:211], v[36:39]
    ds_read_b128 v[156:159], v31 offset:7168
    s_waitcnt lgkmcnt(7)
    v_mfma_f32_16x16x32_bf16 v[48:51], v[132:135], v[212:215], v[48:51]
    ds_read_b128 v[160:163], v5 offset:8192
    ds_read_b128 v[164:167], v5 offset:9216
    v_mfma_f32_16x16x32_bf16 v[52:55], v[148:151], v[212:215], v[52:55]
    ds_read_b128 v[96:99], v8 offset:768
    s_waitcnt lgkmcnt(6)
    v_mfma_f32_16x16x32_bf16 v[48:51], v[136:139], v[216:219], v[48:51]
    buffer_load_dwordx4 v22, s[12:15], s29 offen offset:1024 lds
    v_mfma_f32_16x16x32_bf16 v[52:55], v[152:155], v[216:219], v[52:55]
    ds_read_b128 v[100:103], v8 offset:33536
    ds_read_b128 v[104:107], v9 offset:768
    v_mfma_f32_16x16x32_bf16 v[200:203], a[48:51], v[116:119], v[200:203]
    ds_read_b128 v[108:111], v9 offset:33536
    ds_read_b128 v[168:171], v5 offset:10240
    v_mfma_f32_16x16x32_bf16 v[204:207], a[52:55], v[116:119], v[204:207]
    ds_read_b128 v[172:175], v5 offset:11264
    s_waitcnt lgkmcnt(8)
    v_mfma_f32_16x16x32_bf16 v[48:51], v[140:143], v[220:223], v[48:51]
    buffer_load_dwordx4 v23, s[12:15], s29 offen offset:2048 lds
    v_mfma_f32_16x16x32_bf16 v[52:55], v[156:159], v[220:223], v[52:55]
    ds_read_b128 v[112:115], v10 offset:768
    ds_read_b128 v[116:119], v10 offset:33536
    v_mfma_f32_16x16x32_bf16 v[192:195], a[56:59], v[120:123], v[192:195]
    v_mfma_f32_16x16x32_bf16 v[196:199], a[60:63], v[120:123], v[196:199]
    ds_read_b128 v[120:123], v11 offset:768
    v_mfma_f32_16x16x32_bf16 v[200:203], a[56:59], v[124:127], v[200:203]
    buffer_load_dwordx4 v23, s[12:15], s29 offen offset:3072 lds
    v_mfma_f32_16x16x32_bf16 v[204:207], a[60:63], v[124:127], v[204:207]
    s_cmp_eq_u32 s31, 0
    s_cbranch_scc1 .cp_225
.cb_226:
    v_mfma_f32_16x16x32_bf16 v[192:195], a[64:67], v[64:67], v[192:195]
    s_waitcnt vmcnt(13) lgkmcnt(3)
    s_barrier
    v_mfma_f32_16x16x32_bf16 v[196:199], a[68:71], v[64:67], v[196:199]
    ds_read_b128 v[124:127], v11 offset:33536
    ds_read_b128 v[176:179], v3 offset:0
    v_mfma_f32_16x16x32_bf16 v[200:203], a[64:67], v[68:71], v[200:203]
    ds_read_b128 v[180:183], v3 offset:512
    ds_read_b128 v[184:187], v3 offset:1024
    v_mfma_f32_16x16x32_bf16 v[204:207], a[68:71], v[68:71], v[204:207]
    ds_read_b128 v[188:191], v3 offset:1536
    ds_read_b128 v[64:67], v8 offset:1024
    v_mfma_f32_16x16x32_bf16 v[192:195], a[72:75], v[72:75], v[192:195]
    ds_read_b128 v[68:71], v8 offset:33792
    v_max3_f32 v248, v48, v49, v50
    v_mfma_f32_16x16x32_bf16 v[196:199], a[76:79], v[72:75], v[196:199]
    ds_read_b128 v[72:75], v9 offset:1024
    v_max3_f32 v248, v248, v51, v52
    v_mfma_f32_16x16x32_bf16 v[200:203], a[72:75], v[76:79], v[200:203]
    v_max3_f32 v249, v53, v54, v55
    s_add_u32 m0, s52, 4096
    v_mfma_f32_16x16x32_bf16 v[204:207], a[76:79], v[76:79], v[204:207]
    ds_read_b128 v[76:79], v9 offset:33792
    s_add_u32 s48, s48, 0x20000
    v_mfma_f32_16x16x32_bf16 v[192:195], a[80:83], v[80:83], v[192:195]
    s_mov_b32 s31, 1
    buffer_load_dword v29, v28, s[12:15], s29 offen
    v_mfma_f32_16x16x32_bf16 v[196:199], a[84:87], v[80:83], v[196:199]
    s_cmp_gt_u32 s33, s42
    s_cbranch_scc0 .pp_227
    buffer_load_dwordx4 v2, s[8:11], s48 offen lds
.pb_228:
    s_waitcnt lgkmcnt(4)
    v_mfma_f32_16x16x32_bf16 v[56:59], v[176:179], v[208:211], 0
    ds_read_b128 v[80:83], v10 offset:1024
    s_add_u32 s29, s29, 0x10000
    v_mfma_f32_16x16x32_bf16 v[56:59], v[180:183], v[212:215], v[56:59]
    s_cmp_eq_u32 s24, 0
    s_cbranch_scc1 .cp_229
.cb_230:
    v_mfma_f32_16x16x32_bf16 v[56:59], v[184:187], v[216:219], v[56:59]
    s_cmp_gt_u32 s32, s42
    s_cbranch_scc0 .cp_231
.cb_232:
    v_mfma_f32_16x16x32_bf16 v[56:59], v[188:191], v[220:223], v[56:59]
    ds_read_b32 v232, v6 offset:0
    ds_read_b32 v234, v6 offset:64
    v_mfma_f32_16x16x32_bf16 v[200:203], a[80:83], v[84:87], v[200:203]
    ds_read_b32 v236, v6 offset:512
    ds_read_b32 v238, v6 offset:576
    v_mfma_f32_16x16x32_bf16 v[204:207], a[84:87], v[84:87], v[204:207]
    ds_read_b128 v[84:87], v10 offset:33792
    s_mov_b32 m0, s43
    v_mfma_f32_16x16x32_bf16 v[192:195], a[88:91], v[88:91], v[192:195]
    s_add_u32 s49, s49, 0x40000
    v_mfma_f32_16x16x32_bf16 v[196:199], a[92:95], v[88:91], v[196:199]
    ds_read_b128 v[88:91], v11 offset:1024
    v_max3_f32 v248, v248, v56, v57
    v_mfma_f32_16x16x32_bf16 v[200:203], a[88:91], v[92:95], v[200:203]
    v_max_f32 v30, v248, v249
    v_max_f32 v249, v248, v249
    v_mfma_f32_16x16x32_bf16 v[204:207], a[92:95], v[92:95], v[204:207]
    ds_read_b128 v[92:95], v11 offset:33792
    v_mfma_f32_16x16x32_bf16 v[192:195], a[96:99], v[96:99], v[192:195]
    v_permlane16_swap_b32 v249, v30
    v_max_f32 v248, v249, v30
    v_mfma_f32_16x16x32_bf16 v[196:199], a[100:103], v[96:99], v[196:199]
    v_max_f32 v249, v249, v30
    ds_read_b128 v[96:99], v8 offset:1280
    v_mfma_f32_16x16x32_bf16 v[200:203], a[96:99], v[100:103], v[200:203]
    buffer_load_dwordx4 v2, s[8:11], s49 offen lds
    v_mfma_f32_16x16x32_bf16 v[204:207], a[100:103], v[100:103], v[204:207]
    v_permlane32_swap_b32 v248, v249
    v_max_f32 v248, v248, v249
    v_mfma_f32_16x16x32_bf16 v[192:195], a[104:107], v[104:107], v[192:195]
    v_mul_f32 v248, s45, v248
    ds_read_b128 v[100:103], v8 offset:34048
    v_mfma_f32_16x16x32_bf16 v[196:199], a[108:111], v[104:107], v[196:199]
    ds_read_b128 v[104:107], v9 offset:1280
    s_add_u32 s50, s49, 16777216
    v_mfma_f32_16x16x32_bf16 v[200:203], a[104:107], v[108:111], v[200:203]
    v_fma_f32 v60, v48, s45, -v248
    v_fma_f32 v61, v49, s45, -v248
    v_mfma_f32_16x16x32_bf16 v[204:207], a[108:111], v[108:111], v[204:207]
    ds_read_b128 v[108:111], v9 offset:34048
    v_fma_f32 v62, v50, s45, -v248
    v_mfma_f32_16x16x32_bf16 v[192:195], a[112:115], v[112:115], v[192:195]
    v_fma_f32 v63, v51, s45, -v248
    v_fma_f32 v242, v52, s45, -v248
    v_mfma_f32_16x16x32_bf16 v[196:199], a[116:119], v[112:115], v[196:199]
    v_fma_f32 v243, v53, s45, -v248
    v_fma_f32 v244, v54, s45, -v248
    v_mfma_f32_16x16x32_bf16 v[200:203], a[112:115], v[116:119], v[200:203]
    v_fma_f32 v245, v55, s45, -v248
    v_fma_f32 v246, v56, s45, -v248
    v_mfma_f32_16x16x32_bf16 v[204:207], a[116:119], v[116:119], v[204:207]
    v_fma_f32 v247, v57, s45, -v248
    ds_read_b128 v[112:115], v10 offset:1280
    v_mfma_f32_16x16x32_bf16 v[192:195], a[120:123], v[120:123], v[192:195]
    ds_read_b128 v[116:119], v10 offset:34048
    v_mfma_f32_16x16x32_bf16 v[196:199], a[124:127], v[120:123], v[196:199]
    ds_read_b128 v[120:123], v11 offset:1280
    v_mfma_f32_16x16x32_bf16 v[200:203], a[120:123], v[124:127], v[200:203]
    buffer_load_dwordx4 v2, s[8:11], s49 offen offset:1024 lds
    v_mfma_f32_16x16x32_bf16 v[204:207], a[124:127], v[124:127], v[204:207]
    ds_read_b128 v[124:127], v11 offset:34048
    s_waitcnt lgkmcnt(15)
    v_mfma_f32_16x16x32_bf16 v[192:195], a[128:131], v[64:67], v[192:195]
    s_add_u32 m0, s43, 8192
    s_add_u32 s5, s49, 0x40000
    v_mfma_f32_16x16x32_bf16 v[196:199], a[132:135], v[64:67], v[196:199]
    v_exp_f32 v60, v60
    v_mfma_f32_16x16x32_bf16 v[200:203], a[128:131], v[68:71], v[200:203]
    buffer_load_dwordx4 v2, s[8:11], s50 offen lds
    v_mfma_f32_16x16x32_bf16 v[204:207], a[132:135], v[68:71], v[204:207]
    s_min_u32 s5, s5, s55
    ds_read_b128 v[64:67], v8 offset:1536
    v_mfma_f32_16x16x32_bf16 v[192:195], a[136:139], v[72:75], v[192:195]
    v_exp_f32 v61, v61
    v_mfma_f32_16x16x32_bf16 v[196:199], a[140:143], v[72:75], v[196:199]
    v_exp_f32 v62, v62
    v_mfma_f32_16x16x32_bf16 v[200:203], a[136:139], v[76:79], v[200:203]
    v_exp_f32 v63, v63
    v_mfma_f32_16x16x32_bf16 v[204:207], a[140:143], v[76:79], v[204:207]
    ds_read_b128 v[68:71], v8 offset:34304
    s_waitcnt lgkmcnt(10)
    v_mfma_f32_16x16x32_bf16 v[192:195], a[144:147], v[80:83], v[192:195]
    v_exp_f32 v242, v242
    v_mfma_f32_16x16x32_bf16 v[196:199], a[148:151], v[80:83], v[196:199]
    v_exp_f32 v243, v243
    v_mfma_f32_16x16x32_bf16 v[200:203], a[144:147], v[84:87], v[200:203]
    v_exp_f32 v244, v244
    v_mfma_f32_16x16x32_bf16 v[204:207], a[148:151], v[84:87], v[204:207]
    v_exp_f32 v245, v245
    v_mfma_f32_16x16x32_bf16 v[192:195], a[152:155], v[88:91], v[192:195]
    v_exp_f32 v246, v246
    v_mfma_f32_16x16x32_bf16 v[196:199], a[156:159], v[88:91], v[196:199]
    v_exp_f32 v247, v247
    v_mfma_f32_16x16x32_bf16 v[200:203], a[152:155], v[92:95], v[200:203]
    ds_read_b128 v[72:75], v9 offset:1536
    ds_read_b128 v[76:79], v9 offset:34304
    v_mfma_f32_16x16x32_bf16 v[204:207], a[156:159], v[92:95], v[204:207]
    v_cvt_pk_bf16_f32 v48, v60, v61
    s_waitcnt lgkmcnt(8)
    v_mfma_f32_16x16x32_bf16 v[192:195], a[160:163], v[96:99], v[192:195]
    buffer_load_dwordx4 v2, s[8:11], s50 offen offset:1024 lds
    v_mfma_f32_16x16x32_bf16 v[196:199], a[164:167], v[96:99], v[196:199]
    v_cvt_pk_bf16_f32 v49, v62, v63
    v_cvt_pk_bf16_f32 v50, v242, v243
    v_mfma_f32_16x16x32_bf16 v[200:203], a[160:163], v[100:103], v[200:203]
    v_cvt_pk_bf16_f32 v51, v244, v245
    v_cvt_pk_bf16_f32 v40, v246, v247
    v_mfma_f32_16x16x32_bf16 v[204:207], a[164:167], v[100:103], v[204:207]
    buffer_load_dword v29, v255, s[8:11], s5 offen
    ds_read_b128 v[80:83], v10 offset:1536
    v_mfma_f32_16x16x32_bf16 v[52:55], v[44:47], v[48:51], 0
    ds_read_b128 v[84:87], v10 offset:34304
    ds_read_b128 v[88:91], v11 offset:1536
    v_mfma_f32_16x16x32_bf16 v[52:55], v[44:47], v[40:43], v[52:55]
    ds_read_b128 v[92:95], v11 offset:34304
    ds_read_b128 v[96:99], v8 offset:1792
    v_mfma_f32_16x16x32_bf16 v[208:211], v[160:163], v[48:51], 0
    ds_read_b128 v[100:103], v8 offset:34560
    v_mfma_f32_16x16x32_bf16 v[208:211], v[232:235], v[40:43], v[208:211]
    v_mfma_f32_16x16x32_bf16 v[212:215], v[164:167], v[48:51], 0
    v_mfma_f32_16x16x32_bf16 v[212:215], v[234:237], v[40:43], v[212:215]
    v_mfma_f32_16x16x32_bf16 v[216:219], v[168:171], v[48:51], 0
    v_mfma_f32_16x16x32_bf16 v[216:219], v[236:239], v[40:43], v[216:219]
    v_mfma_f32_16x16x32_bf16 v[220:223], v[172:175], v[48:51], 0
    v_mfma_f32_16x16x32_bf16 v[220:223], v[238:241], v[40:43], v[220:223]
    v_rcp_f32 v248, v52
    v_mfma_f32_16x16x32_bf16 v[192:195], a[168:171], v[104:107], v[192:195]
    v_mul_f32 v208, v248, v208
    v_mul_f32 v209, v248, v209
    v_mfma_f32_16x16x32_bf16 v[196:199], a[172:175], v[104:107], v[196:199]
    ds_read_b128 v[104:107], v9 offset:1792
    v_mul_f32 v210, v248, v210
    v_mfma_f32_16x16x32_bf16 v[200:203], a[168:171], v[108:111], v[200:203]
    v_mul_f32 v211, v248, v211
    v_cvt_pk_bf16_f32 v224, v208, v209
    v_mfma_f32_16x16x32_bf16 v[204:207], a[172:175], v[108:111], v[204:207]
    ds_read_b128 v[108:111], v9 offset:34560
    s_waitcnt lgkmcnt(12)
    v_mfma_f32_16x16x32_bf16 v[192:195], a[176:179], v[112:115], v[192:195]
    v_cvt_pk_bf16_f32 v225, v210, v211
    v_mul_f32 v212, v248, v212
    v_mfma_f32_16x16x32_bf16 v[196:199], a[180:183], v[112:115], v[196:199]
    ds_read_b128 v[112:115], v10 offset:1792
    v_mul_f32 v213, v248, v213
    v_mfma_f32_16x16x32_bf16 v[200:203], a[176:179], v[116:119], v[200:203]
    v_mul_f32 v214, v248, v214
    v_mul_f32 v215, v248, v215
    v_mfma_f32_16x16x32_bf16 v[204:207], a[180:183], v[116:119], v[204:207]
    ds_read_b128 v[116:119], v10 offset:34560
    v_cvt_pk_bf16_f32 v226, v212, v213
    v_mfma_f32_16x16x32_bf16 v[192:195], a[184:187], v[120:123], v[192:195]
    v_cvt_pk_bf16_f32 v227, v214, v215
    v_mfma_f32_16x16x32_bf16 v[196:199], a[188:191], v[120:123], v[196:199]
    ds_read_b128 v[120:123], v11 offset:1792
    v_mfma_f32_16x16x32_bf16 v[200:203], a[184:187], v[124:127], v[200:203]
    v_mfma_f32_16x16x32_bf16 v[204:207], a[188:191], v[124:127], v[204:207]
    ds_read_b128 v[124:127], v11 offset:34560
    s_waitcnt lgkmcnt(12)
    v_mfma_f32_16x16x32_bf16 v[192:195], a[192:195], v[64:67], v[192:195]
    v_mfma_f32_16x16x32_bf16 v[196:199], a[196:199], v[64:67], v[196:199]
    v_mfma_f32_16x16x32_bf16 v[200:203], a[192:195], v[68:71], v[200:203]
    s_cmp_eq_u32 s31, 0
    s_cbranch_scc1 .cp_233
.cb_234:
    v_mfma_f32_16x16x32_bf16 v[204:207], a[196:199], v[68:71], v[204:207]
    buffer_store_dwordx4 v[224:227], v2, s[8:11], s53 offen offset:0 sc1
    v_mul_f32 v216, v248, v216
    v_mfma_f32_16x16x32_bf16 v[192:195], a[200:203], v[72:75], v[192:195]
    s_waitcnt vmcnt(8) lgkmcnt(0)
    s_barrier
    v_mfma_f32_16x16x32_bf16 v[196:199], a[204:207], v[72:75], v[196:199]
    s_add_u32 m0, s6, 0
    ds_read_b128 v[64:67], v12 offset:0
    v_mfma_f32_16x16x32_bf16 v[200:203], a[200:203], v[76:79], v[200:203]
    buffer_load_dwordx4 v16, s[12:15], s29 offen offset:0 lds
    v_mfma_f32_16x16x32_bf16 v[204:207], a[204:207], v[76:79], v[204:207]
    ds_read_b128 v[68:71], v12 offset:32768
    ds_read_b128 v[72:75], v13 offset:0
    v_mfma_f32_16x16x32_bf16 v[192:195], a[208:211], v[80:83], v[192:195]
    ds_read_b128 v[76:79], v13 offset:32768
    v_mul_f32 v217, v248, v217
    v_mfma_f32_16x16x32_bf16 v[196:199], a[212:215], v[80:83], v[196:199]
    v_mul_f32 v218, v248, v218
    v_mul_f32 v219, v248, v219
    v_mfma_f32_16x16x32_bf16 v[200:203], a[208:211], v[84:87], v[200:203]
    buffer_load_dwordx4 v16, s[12:15], s29 offen offset:1024 lds
    v_mfma_f32_16x16x32_bf16 v[204:207], a[212:215], v[84:87], v[204:207]
    v_cvt_pk_bf16_f32 v228, v216, v217
    v_cvt_pk_bf16_f32 v229, v218, v219
    v_mfma_f32_16x16x32_bf16 v[192:195], a[216:219], v[88:91], v[192:195]
    v_mul_f32 v220, v248, v220
    v_mul_f32 v221, v248, v221
    v_mfma_f32_16x16x32_bf16 v[196:199], a[220:223], v[88:91], v[196:199]
    v_mul_f32 v222, v248, v222
    v_mul_f32 v223, v248, v223
    v_mfma_f32_16x16x32_bf16 v[200:203], a[216:219], v[92:95], v[200:203]
    buffer_load_dwordx4 v17, s[12:15], s29 offen offset:2048 lds
    v_mfma_f32_16x16x32_bf16 v[204:207], a[220:223], v[92:95], v[204:207]
    v_cvt_pk_bf16_f32 v230, v220, v221
    v_cvt_pk_bf16_f32 v231, v222, v223
    v_mfma_f32_16x16x32_bf16 v[192:195], a[224:227], v[96:99], v[192:195]
    buffer_store_dwordx4 v[228:231], v2, s[8:11], s53 offen offset:1024 sc1
    ds_read_b128 v[80:83], v14 offset:0
    v_mfma_f32_16x16x32_bf16 v[196:199], a[228:231], v[96:99], v[196:199]
    ds_read_b128 v[84:87], v14 offset:32768
    ds_read_b128 v[88:91], v15 offset:0
    v_mfma_f32_16x16x32_bf16 v[200:203], a[224:227], v[100:103], v[200:203]
    buffer_load_dwordx4 v17, s[12:15], s29 offen offset:3072 lds
    v_mfma_f32_16x16x32_bf16 v[204:207], a[228:231], v[100:103], v[204:207]
    ds_read_b128 v[92:95], v15 offset:32768
    ds_read_b128 v[96:99], v12 offset:256
    v_mfma_f32_16x16x32_bf16 v[192:195], a[232:235], v[104:107], v[192:195]
    ds_read_b128 v[100:103], v12 offset:33024
    s_mov_b32 s53, s40
    v_mfma_f32_16x16x32_bf16 v[196:199], a[236:239], v[104:107], v[196:199]
    ds_read_b128 v[104:107], v13 offset:256
    s_add_u32 s40, s40, 0x40000
    v_mfma_f32_16x16x32_bf16 v[200:203], a[232:235], v[108:111], v[200:203]
    s_add_u32 m0, s6, 4096
    s_mov_b32 s30, s42
    v_mfma_f32_16x16x32_bf16 v[204:207], a[236:239], v[108:111], v[204:207]
    buffer_load_dwordx4 v18, s[12:15], s29 offen offset:0 lds
    v_mfma_f32_16x16x32_bf16 v[192:195], a[240:243], v[112:115], v[192:195]
    ds_read_b128 v[108:111], v13 offset:33024
    s_add_u32 s42, s42, 1
    v_mfma_f32_16x16x32_bf16 v[196:199], a[244:247], v[112:115], v[196:199]
    v_mfma_f32_16x16x32_bf16 v[200:203], a[240:243], v[116:119], v[200:203]
    v_mfma_f32_16x16x32_bf16 v[204:207], a[244:247], v[116:119], v[204:207]
    buffer_load_dwordx4 v18, s[12:15], s29 offen offset:1024 lds
    v_mfma_f32_16x16x32_bf16 v[192:195], a[248:251], v[120:123], v[192:195]
    v_mfma_f32_16x16x32_bf16 v[196:199], a[252:255], v[120:123], v[196:199]
    v_mfma_f32_16x16x32_bf16 v[200:203], a[248:251], v[124:127], v[200:203]
    v_mfma_f32_16x16x32_bf16 v[204:207], a[252:255], v[124:127], v[204:207]
    s_waitcnt lgkmcnt(8)
    v_mfma_f32_16x16x32_bf16 v[208:211], a[0:3], v[64:67], 0
    buffer_load_dwordx4 v19, s[12:15], s29 offen offset:2048 lds
    v_mfma_f32_16x16x32_bf16 v[212:215], a[4:7], v[64:67], 0
    ds_read_b128 v[112:115], v14 offset:256
    ds_read_b128 v[116:119], v14 offset:33024
    v_mfma_f32_16x16x32_bf16 v[216:219], a[0:3], v[68:71], 0
    ds_read_b128 v[120:123], v15 offset:256
    ds_read_b128 v[124:127], v15 offset:33024
    v_mfma_f32_16x16x32_bf16 v[220:223], a[4:7], v[68:71], 0
    ds_read_b128 v[64:67], v12 offset:512
    ds_read_b128 v[68:71], v12 offset:33280
    v_mfma_f32_16x16x32_bf16 v[208:211], a[8:11], v[72:75], v[208:211]
    buffer_load_dwordx4 v19, s[12:15], s29 offen offset:3072 lds
    v_mfma_f32_16x16x32_bf16 v[212:215], a[12:15], v[72:75], v[212:215]
    v_cvt_pk_bf16_f32 v224, v192, v193
    v_cvt_pk_bf16_f32 v225, v194, v195
    v_mfma_f32_16x16x32_bf16 v[216:219], a[8:11], v[76:79], v[216:219]
    v_cvt_pk_bf16_f32 v226, v196, v197
    v_cvt_pk_bf16_f32 v227, v198, v199
    v_mfma_f32_16x16x32_bf16 v[220:223], a[12:15], v[76:79], v[220:223]
    ds_write_b128 v24, v[224:227] offset:0
    s_waitcnt lgkmcnt(11)
    v_mfma_f32_16x16x32_bf16 v[208:211], a[16:19], v[80:83], v[208:211]
    s_add_u32 m0, s6, 8192
    v_cvt_pk_bf16_f32 v228, v200, v201
    v_mfma_f32_16x16x32_bf16 v[212:215], a[20:23], v[80:83], v[212:215]
    buffer_load_dwordx4 v20, s[12:15], s29 offen offset:0 lds
    v_mfma_f32_16x16x32_bf16 v[216:219], a[16:19], v[84:87], v[216:219]
    v_cvt_pk_bf16_f32 v229, v202, v203
    v_cvt_pk_bf16_f32 v230, v204, v205
    v_mfma_f32_16x16x32_bf16 v[220:223], a[20:23], v[84:87], v[220:223]
    v_cvt_pk_bf16_f32 v231, v206, v207
    ds_write_b128 v24, v[228:231] offset:4096
    v_mfma_f32_16x16x32_bf16 v[208:211], a[24:27], v[88:91], v[208:211]
    ds_read_b128 v[72:75], v13 offset:512
    ds_read_b128 v[76:79], v13 offset:33280
    v_mfma_f32_16x16x32_bf16 v[212:215], a[28:31], v[88:91], v[212:215]
    buffer_load_dwordx4 v20, s[12:15], s29 offen offset:1024 lds
    v_mfma_f32_16x16x32_bf16 v[216:219], a[24:27], v[92:95], v[216:219]
    ds_read_b128 v[80:83], v14 offset:512
    ds_read_b128 v[84:87], v14 offset:33280
    v_mfma_f32_16x16x32_bf16 v[220:223], a[28:31], v[92:95], v[220:223]
    ds_read_b128 v[88:91], v15 offset:512
    s_waitcnt lgkmcnt(13)
    v_mfma_f32_16x16x32_bf16 v[208:211], a[32:35], v[96:99], v[208:211]
    s_waitcnt vmcnt(13) lgkmcnt(5)
    s_barrier
    v_mfma_f32_16x16x32_bf16 v[212:215], a[36:39], v[96:99], v[212:215]
    buffer_load_dwordx4 v21, s[12:15], s29 offen offset:2048 lds
    v_mfma_f32_16x16x32_bf16 v[216:219], a[32:35], v[100:103], v[216:219]
    ds_read_b128 v[192:195], v25 offset:0
    ds_read_b128 v[128:131], v31 offset:0
    v_mfma_f32_16x16x32_bf16 v[220:223], a[36:39], v[100:103], v[220:223]
    ds_read_b128 v[144:147], v31 offset:4096
    ds_read_b128 v[196:199], v25 offset:1024
    v_mfma_f32_16x16x32_bf16 v[208:211], a[40:43], v[104:107], v[208:211]
    ds_read_b128 v[132:135], v31 offset:1024
    ds_read_b128 v[148:151], v31 offset:5120
    v_mfma_f32_16x16x32_bf16 v[212:215], a[44:47], v[104:107], v[212:215]
    buffer_load_dwordx4 v21, s[12:15], s29 offen offset:3072 lds
    v_mfma_f32_16x16x32_bf16 v[216:219], a[40:43], v[108:111], v[216:219]
    ds_read_b128 v[92:95], v15 offset:33280
    ds_read_b128 v[200:203], v25 offset:2048
    v_mfma_f32_16x16x32_bf16 v[220:223], a[44:47], v[108:111], v[220:223]
    ds_read_b128 v[136:139], v31 offset:2048
    ds_read_b128 v[152:155], v31 offset:6144
    v_mfma_f32_16x16x32_bf16 v[208:211], a[48:51], v[112:115], v[208:211]
    ds_read_b128 v[204:207], v25 offset:3072
    ds_read_b128 v[140:143], v31 offset:3072
    v_mfma_f32_16x16x32_bf16 v[212:215], a[52:55], v[112:115], v[212:215]
    s_add_u32 m0, s6, 12288
    s_waitcnt lgkmcnt(9)
    v_mfma_f32_16x16x32_bf16 v[48:51], v[128:131], v[192:195], v[32:35]
    buffer_load_dwordx4 v22, s[12:15], s29 offen offset:0 lds
    v_mfma_f32_16x16x32_bf16 v[52:55], v[144:147], v[192:195], v[36:39]
    ds_read_b128 v[156:159], v31 offset:7168
    s_waitcnt lgkmcnt(7)
    v_mfma_f32_16x16x32_bf16 v[48:51], v[132:135], v[196:199], v[48:51]
    ds_read_b128 v[160:163], v5 offset:8192
    ds_read_b128 v[164:167], v5 offset:9216
    v_mfma_f32_16x16x32_bf16 v[52:55], v[148:151], v[196:199], v[52:55]
    ds_read_b128 v[96:99], v12 offset:768
    s_waitcnt lgkmcnt(6)
    v_mfma_f32_16x16x32_bf16 v[48:51], v[136:139], v[200:203], v[48:51]
    buffer_load_dwordx4 v22, s[12:15], s29 offen offset:1024 lds
    v_mfma_f32_16x16x32_bf16 v[52:55], v[152:155], v[200:203], v[52:55]
    ds_read_b128 v[100:103], v12 offset:33536
    ds_read_b128 v[104:107], v13 offset:768
    v_mfma_f32_16x16x32_bf16 v[216:219], a[48:51], v[116:119], v[216:219]
    ds_read_b128 v[108:111], v13 offset:33536
    ds_read_b128 v[168:171], v5 offset:10240
    v_mfma_f32_16x16x32_bf16 v[220:223], a[52:55], v[116:119], v[220:223]
    ds_read_b128 v[172:175], v5 offset:11264
    s_waitcnt lgkmcnt(8)
    v_mfma_f32_16x16x32_bf16 v[48:51], v[140:143], v[204:207], v[48:51]
    buffer_load_dwordx4 v23, s[12:15], s29 offen offset:2048 lds
    v_mfma_f32_16x16x32_bf16 v[52:55], v[156:159], v[204:207], v[52:55]
    ds_read_b128 v[112:115], v14 offset:768
    ds_read_b128 v[116:119], v14 offset:33536
    v_mfma_f32_16x16x32_bf16 v[208:211], a[56:59], v[120:123], v[208:211]
    v_mfma_f32_16x16x32_bf16 v[212:215], a[60:63], v[120:123], v[212:215]
    ds_read_b128 v[120:123], v15 offset:768
    v_mfma_f32_16x16x32_bf16 v[216:219], a[56:59], v[124:127], v[216:219]
    buffer_load_dwordx4 v23, s[12:15], s29 offen offset:3072 lds
    v_mfma_f32_16x16x32_bf16 v[220:223], a[60:63], v[124:127], v[220:223]
    s_cmp_eq_u32 s31, 0
    s_cbranch_scc1 .cp_235
.cb_236:
    v_mfma_f32_16x16x32_bf16 v[208:211], a[64:67], v[64:67], v[208:211]
    s_waitcnt vmcnt(13) lgkmcnt(3)
    s_barrier
    v_mfma_f32_16x16x32_bf16 v[212:215], a[68:71], v[64:67], v[212:215]
    ds_read_b128 v[124:127], v15 offset:33536
    ds_read_b128 v[176:179], v3 offset:4096
    v_mfma_f32_16x16x32_bf16 v[216:219], a[64:67], v[68:71], v[216:219]
    ds_read_b128 v[180:183], v3 offset:4608
    ds_read_b128 v[184:187], v3 offset:5120
    v_mfma_f32_16x16x32_bf16 v[220:223], a[68:71], v[68:71], v[220:223]
    ds_read_b128 v[188:191], v3 offset:5632
    ds_read_b128 v[64:67], v12 offset:1024
    v_mfma_f32_16x16x32_bf16 v[208:211], a[72:75], v[72:75], v[208:211]
    ds_read_b128 v[68:71], v12 offset:33792
    v_max3_f32 v248, v48, v49, v50
    v_mfma_f32_16x16x32_bf16 v[212:215], a[76:79], v[72:75], v[212:215]
    ds_read_b128 v[72:75], v13 offset:1024
    v_max3_f32 v248, v248, v51, v52
    v_mfma_f32_16x16x32_bf16 v[216:219], a[72:75], v[76:79], v[216:219]
    v_max3_f32 v249, v53, v54, v55
    s_add_u32 m0, s52, 0
    v_mfma_f32_16x16x32_bf16 v[220:223], a[76:79], v[76:79], v[220:223]
    ds_read_b128 v[76:79], v13 offset:33792
    s_add_u32 s48, s48, 0x20000
    v_mfma_f32_16x16x32_bf16 v[208:211], a[80:83], v[80:83], v[208:211]
    s_mov_b32 s31, 1
    buffer_load_dword v29, v28, s[12:15], s29 offen
    v_mfma_f32_16x16x32_bf16 v[212:215], a[84:87], v[80:83], v[212:215]
    s_cmp_gt_u32 s33, s42
    s_cbranch_scc0 .pp_237
    buffer_load_dwordx4 v2, s[8:11], s48 offen lds
.pb_238:
    s_waitcnt lgkmcnt(4)
    v_mfma_f32_16x16x32_bf16 v[56:59], v[176:179], v[192:195], 0
    ds_read_b128 v[80:83], v14 offset:1024
    s_add_u32 s29, s29, 0x10000
    v_mfma_f32_16x16x32_bf16 v[56:59], v[180:183], v[196:199], v[56:59]
    s_cmp_eq_u32 s24, 0
    s_cbranch_scc1 .cp_239
.cb_240:
    v_mfma_f32_16x16x32_bf16 v[56:59], v[184:187], v[200:203], v[56:59]
    s_cmp_gt_u32 s32, s42
    s_cbranch_scc0 .cp_241
.cb_242:
    v_mfma_f32_16x16x32_bf16 v[56:59], v[188:191], v[204:207], v[56:59]
    ds_read_b32 v232, v6 offset:4096
    ds_read_b32 v234, v6 offset:4160
    v_mfma_f32_16x16x32_bf16 v[216:219], a[80:83], v[84:87], v[216:219]
    ds_read_b32 v236, v6 offset:4608
    ds_read_b32 v238, v6 offset:4672
    v_mfma_f32_16x16x32_bf16 v[220:223], a[84:87], v[84:87], v[220:223]
    ds_read_b128 v[84:87], v14 offset:33792
    s_mov_b32 m0, s43
    v_mfma_f32_16x16x32_bf16 v[208:211], a[88:91], v[88:91], v[208:211]
    s_add_u32 s49, s49, 0x40000
    v_mfma_f32_16x16x32_bf16 v[212:215], a[92:95], v[88:91], v[212:215]
    ds_read_b128 v[88:91], v15 offset:1024
    v_max3_f32 v248, v248, v56, v57
    v_mfma_f32_16x16x32_bf16 v[216:219], a[88:91], v[92:95], v[216:219]
    v_max_f32 v30, v248, v249
    v_max_f32 v249, v248, v249
    v_mfma_f32_16x16x32_bf16 v[220:223], a[92:95], v[92:95], v[220:223]
    ds_read_b128 v[92:95], v15 offset:33792
    v_mfma_f32_16x16x32_bf16 v[208:211], a[96:99], v[96:99], v[208:211]
    v_permlane16_swap_b32 v249, v30
    v_max_f32 v248, v249, v30
    v_mfma_f32_16x16x32_bf16 v[212:215], a[100:103], v[96:99], v[212:215]
    v_max_f32 v249, v249, v30
    ds_read_b128 v[96:99], v12 offset:1280
    v_mfma_f32_16x16x32_bf16 v[216:219], a[96:99], v[100:103], v[216:219]
    buffer_load_dwordx4 v2, s[8:11], s49 offen lds
    v_mfma_f32_16x16x32_bf16 v[220:223], a[100:103], v[100:103], v[220:223]
    v_permlane32_swap_b32 v248, v249
    v_max_f32 v248, v248, v249
    v_mfma_f32_16x16x32_bf16 v[208:211], a[104:107], v[104:107], v[208:211]
    v_mul_f32 v248, s45, v248
    ds_read_b128 v[100:103], v12 offset:34048
    v_mfma_f32_16x16x32_bf16 v[212:215], a[108:111], v[104:107], v[212:215]
    ds_read_b128 v[104:107], v13 offset:1280
    s_add_u32 s50, s49, 16777216
    v_mfma_f32_16x16x32_bf16 v[216:219], a[104:107], v[108:111], v[216:219]
    v_fma_f32 v60, v48, s45, -v248
    v_fma_f32 v61, v49, s45, -v248
    v_mfma_f32_16x16x32_bf16 v[220:223], a[108:111], v[108:111], v[220:223]
    ds_read_b128 v[108:111], v13 offset:34048
    v_fma_f32 v62, v50, s45, -v248
    v_mfma_f32_16x16x32_bf16 v[208:211], a[112:115], v[112:115], v[208:211]
    v_fma_f32 v63, v51, s45, -v248
    v_fma_f32 v242, v52, s45, -v248
    v_mfma_f32_16x16x32_bf16 v[212:215], a[116:119], v[112:115], v[212:215]
    v_fma_f32 v243, v53, s45, -v248
    v_fma_f32 v244, v54, s45, -v248
    v_mfma_f32_16x16x32_bf16 v[216:219], a[112:115], v[116:119], v[216:219]
    v_fma_f32 v245, v55, s45, -v248
    v_fma_f32 v246, v56, s45, -v248
    v_mfma_f32_16x16x32_bf16 v[220:223], a[116:119], v[116:119], v[220:223]
    v_fma_f32 v247, v57, s45, -v248
    ds_read_b128 v[112:115], v14 offset:1280
    v_mfma_f32_16x16x32_bf16 v[208:211], a[120:123], v[120:123], v[208:211]
    ds_read_b128 v[116:119], v14 offset:34048
    v_mfma_f32_16x16x32_bf16 v[212:215], a[124:127], v[120:123], v[212:215]
    ds_read_b128 v[120:123], v15 offset:1280
    v_mfma_f32_16x16x32_bf16 v[216:219], a[120:123], v[124:127], v[216:219]
    buffer_load_dwordx4 v2, s[8:11], s49 offen offset:1024 lds
    v_mfma_f32_16x16x32_bf16 v[220:223], a[124:127], v[124:127], v[220:223]
    ds_read_b128 v[124:127], v15 offset:34048
    s_waitcnt lgkmcnt(15)
    v_mfma_f32_16x16x32_bf16 v[208:211], a[128:131], v[64:67], v[208:211]
    s_add_u32 m0, s43, 8192
    s_add_u32 s5, s49, 0x40000
    v_mfma_f32_16x16x32_bf16 v[212:215], a[132:135], v[64:67], v[212:215]
    v_exp_f32 v60, v60
    v_mfma_f32_16x16x32_bf16 v[216:219], a[128:131], v[68:71], v[216:219]
    buffer_load_dwordx4 v2, s[8:11], s50 offen lds
    v_mfma_f32_16x16x32_bf16 v[220:223], a[132:135], v[68:71], v[220:223]
    s_min_u32 s5, s5, s55
    ds_read_b128 v[64:67], v12 offset:1536
    v_mfma_f32_16x16x32_bf16 v[208:211], a[136:139], v[72:75], v[208:211]
    v_exp_f32 v61, v61
    v_mfma_f32_16x16x32_bf16 v[212:215], a[140:143], v[72:75], v[212:215]
    v_exp_f32 v62, v62
    v_mfma_f32_16x16x32_bf16 v[216:219], a[136:139], v[76:79], v[216:219]
    v_exp_f32 v63, v63
    v_mfma_f32_16x16x32_bf16 v[220:223], a[140:143], v[76:79], v[220:223]
    ds_read_b128 v[68:71], v12 offset:34304
    s_waitcnt lgkmcnt(10)
    v_mfma_f32_16x16x32_bf16 v[208:211], a[144:147], v[80:83], v[208:211]
    v_exp_f32 v242, v242
    v_mfma_f32_16x16x32_bf16 v[212:215], a[148:151], v[80:83], v[212:215]
    v_exp_f32 v243, v243
    v_mfma_f32_16x16x32_bf16 v[216:219], a[144:147], v[84:87], v[216:219]
    v_exp_f32 v244, v244
    v_mfma_f32_16x16x32_bf16 v[220:223], a[148:151], v[84:87], v[220:223]
    v_exp_f32 v245, v245
    v_mfma_f32_16x16x32_bf16 v[208:211], a[152:155], v[88:91], v[208:211]
    v_exp_f32 v246, v246
    v_mfma_f32_16x16x32_bf16 v[212:215], a[156:159], v[88:91], v[212:215]
    v_exp_f32 v247, v247
    v_mfma_f32_16x16x32_bf16 v[216:219], a[152:155], v[92:95], v[216:219]
    ds_read_b128 v[72:75], v13 offset:1536
    ds_read_b128 v[76:79], v13 offset:34304
    v_mfma_f32_16x16x32_bf16 v[220:223], a[156:159], v[92:95], v[220:223]
    v_cvt_pk_bf16_f32 v48, v60, v61
    s_waitcnt lgkmcnt(8)
    v_mfma_f32_16x16x32_bf16 v[208:211], a[160:163], v[96:99], v[208:211]
    buffer_load_dwordx4 v2, s[8:11], s50 offen offset:1024 lds
    v_mfma_f32_16x16x32_bf16 v[212:215], a[164:167], v[96:99], v[212:215]
    v_cvt_pk_bf16_f32 v49, v62, v63
    v_cvt_pk_bf16_f32 v50, v242, v243
    v_mfma_f32_16x16x32_bf16 v[216:219], a[160:163], v[100:103], v[216:219]
    v_cvt_pk_bf16_f32 v51, v244, v245
    v_cvt_pk_bf16_f32 v40, v246, v247
    v_mfma_f32_16x16x32_bf16 v[220:223], a[164:167], v[100:103], v[220:223]
    buffer_load_dword v29, v255, s[8:11], s5 offen
    ds_read_b128 v[80:83], v14 offset:1536
    v_mfma_f32_16x16x32_bf16 v[52:55], v[44:47], v[48:51], 0
    ds_read_b128 v[84:87], v14 offset:34304
    ds_read_b128 v[88:91], v15 offset:1536
    v_mfma_f32_16x16x32_bf16 v[52:55], v[44:47], v[40:43], v[52:55]
    ds_read_b128 v[92:95], v15 offset:34304
    ds_read_b128 v[96:99], v12 offset:1792
    v_mfma_f32_16x16x32_bf16 v[192:195], v[160:163], v[48:51], 0
    ds_read_b128 v[100:103], v12 offset:34560
    v_mfma_f32_16x16x32_bf16 v[192:195], v[232:235], v[40:43], v[192:195]
    v_mfma_f32_16x16x32_bf16 v[196:199], v[164:167], v[48:51], 0
    v_mfma_f32_16x16x32_bf16 v[196:199], v[234:237], v[40:43], v[196:199]
    v_mfma_f32_16x16x32_bf16 v[200:203], v[168:171], v[48:51], 0
    v_mfma_f32_16x16x32_bf16 v[200:203], v[236:239], v[40:43], v[200:203]
    v_mfma_f32_16x16x32_bf16 v[204:207], v[172:175], v[48:51], 0
    v_mfma_f32_16x16x32_bf16 v[204:207], v[238:241], v[40:43], v[204:207]
    v_rcp_f32 v248, v52
    v_mfma_f32_16x16x32_bf16 v[208:211], a[168:171], v[104:107], v[208:211]
    v_mul_f32 v192, v248, v192
    v_mul_f32 v193, v248, v193
    v_mfma_f32_16x16x32_bf16 v[212:215], a[172:175], v[104:107], v[212:215]
    ds_read_b128 v[104:107], v13 offset:1792
    v_mul_f32 v194, v248, v194
    v_mfma_f32_16x16x32_bf16 v[216:219], a[168:171], v[108:111], v[216:219]
    v_mul_f32 v195, v248, v195
    v_cvt_pk_bf16_f32 v224, v192, v193
    v_mfma_f32_16x16x32_bf16 v[220:223], a[172:175], v[108:111], v[220:223]
    ds_read_b128 v[108:111], v13 offset:34560
    s_waitcnt lgkmcnt(12)
    v_mfma_f32_16x16x32_bf16 v[208:211], a[176:179], v[112:115], v[208:211]
    v_cvt_pk_bf16_f32 v225, v194, v195
    v_mul_f32 v196, v248, v196
    v_mfma_f32_16x16x32_bf16 v[212:215], a[180:183], v[112:115], v[212:215]
    ds_read_b128 v[112:115], v14 offset:1792
    v_mul_f32 v197, v248, v197
    v_mfma_f32_16x16x32_bf16 v[216:219], a[176:179], v[116:119], v[216:219]
    v_mul_f32 v198, v248, v198
    v_mul_f32 v199, v248, v199
    v_mfma_f32_16x16x32_bf16 v[220:223], a[180:183], v[116:119], v[220:223]
    ds_read_b128 v[116:119], v14 offset:34560
    v_cvt_pk_bf16_f32 v226, v196, v197
    v_mfma_f32_16x16x32_bf16 v[208:211], a[184:187], v[120:123], v[208:211]
    v_cvt_pk_bf16_f32 v227, v198, v199
    v_mfma_f32_16x16x32_bf16 v[212:215], a[188:191], v[120:123], v[212:215]
    ds_read_b128 v[120:123], v15 offset:1792
    v_mfma_f32_16x16x32_bf16 v[216:219], a[184:187], v[124:127], v[216:219]
    v_mfma_f32_16x16x32_bf16 v[220:223], a[188:191], v[124:127], v[220:223]
    ds_read_b128 v[124:127], v15 offset:34560
    s_waitcnt lgkmcnt(12)
    v_mfma_f32_16x16x32_bf16 v[208:211], a[192:195], v[64:67], v[208:211]
    v_mfma_f32_16x16x32_bf16 v[212:215], a[196:199], v[64:67], v[212:215]
    v_mfma_f32_16x16x32_bf16 v[216:219], a[192:195], v[68:71], v[216:219]
    s_cmp_eq_u32 s31, 0
    s_cbranch_scc1 .cp_243
.cb_244:
    v_mfma_f32_16x16x32_bf16 v[220:223], a[196:199], v[68:71], v[220:223]
    buffer_store_dwordx4 v[224:227], v2, s[8:11], s53 offen offset:0 sc1
    v_mul_f32 v200, v248, v200
    v_mfma_f32_16x16x32_bf16 v[208:211], a[200:203], v[72:75], v[208:211]
    s_waitcnt vmcnt(8) lgkmcnt(0)
    s_barrier
    v_mfma_f32_16x16x32_bf16 v[212:215], a[204:207], v[72:75], v[212:215]
    s_add_u32 m0, s6, 65536
    ds_read_b128 v[64:67], v8 offset:0
    v_mfma_f32_16x16x32_bf16 v[216:219], a[200:203], v[76:79], v[216:219]
    buffer_load_dwordx4 v16, s[12:15], s29 offen offset:0 lds
    v_mfma_f32_16x16x32_bf16 v[220:223], a[204:207], v[76:79], v[220:223]
    ds_read_b128 v[68:71], v8 offset:32768
    ds_read_b128 v[72:75], v9 offset:0
    v_mfma_f32_16x16x32_bf16 v[208:211], a[208:211], v[80:83], v[208:211]
    ds_read_b128 v[76:79], v9 offset:32768
    v_mul_f32 v201, v248, v201
    v_mfma_f32_16x16x32_bf16 v[212:215], a[212:215], v[80:83], v[212:215]
    v_mul_f32 v202, v248, v202
    v_mul_f32 v203, v248, v203
    v_mfma_f32_16x16x32_bf16 v[216:219], a[208:211], v[84:87], v[216:219]
    buffer_load_dwordx4 v16, s[12:15], s29 offen offset:1024 lds
    v_mfma_f32_16x16x32_bf16 v[220:223], a[212:215], v[84:87], v[220:223]
    v_cvt_pk_bf16_f32 v228, v200, v201
    v_cvt_pk_bf16_f32 v229, v202, v203
    v_mfma_f32_16x16x32_bf16 v[208:211], a[216:219], v[88:91], v[208:211]
    v_mul_f32 v204, v248, v204
    v_mul_f32 v205, v248, v205
    v_mfma_f32_16x16x32_bf16 v[212:215], a[220:223], v[88:91], v[212:215]
    v_mul_f32 v206, v248, v206
    v_mul_f32 v207, v248, v207
    v_mfma_f32_16x16x32_bf16 v[216:219], a[216:219], v[92:95], v[216:219]
    buffer_load_dwordx4 v17, s[12:15], s29 offen offset:2048 lds
    v_mfma_f32_16x16x32_bf16 v[220:223], a[220:223], v[92:95], v[220:223]
    v_cvt_pk_bf16_f32 v230, v204, v205
    v_cvt_pk_bf16_f32 v231, v206, v207
    v_mfma_f32_16x16x32_bf16 v[208:211], a[224:227], v[96:99], v[208:211]
    buffer_store_dwordx4 v[228:231], v2, s[8:11], s53 offen offset:1024 sc1
    ds_read_b128 v[80:83], v10 offset:0
    v_mfma_f32_16x16x32_bf16 v[212:215], a[228:231], v[96:99], v[212:215]
    ds_read_b128 v[84:87], v10 offset:32768
    ds_read_b128 v[88:91], v11 offset:0
    v_mfma_f32_16x16x32_bf16 v[216:219], a[224:227], v[100:103], v[216:219]
    buffer_load_dwordx4 v17, s[12:15], s29 offen offset:3072 lds
    v_mfma_f32_16x16x32_bf16 v[220:223], a[228:231], v[100:103], v[220:223]
    ds_read_b128 v[92:95], v11 offset:32768
    ds_read_b128 v[96:99], v8 offset:256
    v_mfma_f32_16x16x32_bf16 v[208:211], a[232:235], v[104:107], v[208:211]
    ds_read_b128 v[100:103], v8 offset:33024
    s_mov_b32 s53, s40
    v_mfma_f32_16x16x32_bf16 v[212:215], a[236:239], v[104:107], v[212:215]
    ds_read_b128 v[104:107], v9 offset:256
    s_add_u32 s40, s40, 0x40000
    v_mfma_f32_16x16x32_bf16 v[216:219], a[232:235], v[108:111], v[216:219]
    s_add_u32 m0, s6, 69632
    s_mov_b32 s30, s42
    v_mfma_f32_16x16x32_bf16 v[220:223], a[236:239], v[108:111], v[220:223]
    buffer_load_dwordx4 v18, s[12:15], s29 offen offset:0 lds
    v_mfma_f32_16x16x32_bf16 v[208:211], a[240:243], v[112:115], v[208:211]
    ds_read_b128 v[108:111], v9 offset:33024
    s_add_u32 s42, s42, 1
    v_mfma_f32_16x16x32_bf16 v[212:215], a[244:247], v[112:115], v[212:215]
    v_mfma_f32_16x16x32_bf16 v[216:219], a[240:243], v[116:119], v[216:219]
    v_mfma_f32_16x16x32_bf16 v[220:223], a[244:247], v[116:119], v[220:223]
    buffer_load_dwordx4 v18, s[12:15], s29 offen offset:1024 lds
    v_mfma_f32_16x16x32_bf16 v[208:211], a[248:251], v[120:123], v[208:211]
    v_mfma_f32_16x16x32_bf16 v[212:215], a[252:255], v[120:123], v[212:215]
    v_mfma_f32_16x16x32_bf16 v[216:219], a[248:251], v[124:127], v[216:219]
    v_mfma_f32_16x16x32_bf16 v[220:223], a[252:255], v[124:127], v[220:223]
    s_cmp_lt_u32 s42, 64
    s_cbranch_scc1 .ql_224
    s_nop 7
    v_cvt_pk_bf16_f32 v224, v208, v209
    v_cvt_pk_bf16_f32 v225, v210, v211
    v_cvt_pk_bf16_f32 v226, v212, v213
    v_cvt_pk_bf16_f32 v227, v214, v215
    v_cvt_pk_bf16_f32 v228, v216, v217
    v_cvt_pk_bf16_f32 v229, v218, v219
    v_cvt_pk_bf16_f32 v230, v220, v221
    v_cvt_pk_bf16_f32 v231, v222, v223
    ds_write_b128 v24, v[224:227] offset:0
    ds_write_b128 v24, v[228:231] offset:4096
    s_waitcnt vmcnt(0) lgkmcnt(0)
    s_barrier
    ds_read_b128 v[208:211], v25 offset:0
    ds_read_b128 v[128:131], v31 offset:0
    ds_read_b128 v[144:147], v31 offset:4096
    ds_read_b128 v[212:215], v25 offset:1024
    ds_read_b128 v[132:135], v31 offset:1024
    ds_read_b128 v[148:151], v31 offset:5120
    ds_read_b128 v[216:219], v25 offset:2048
    ds_read_b128 v[136:139], v31 offset:2048
    ds_read_b128 v[152:155], v31 offset:6144
    ds_read_b128 v[220:223], v25 offset:3072
    ds_read_b128 v[140:143], v31 offset:3072
    ds_read_b128 v[156:159], v31 offset:7168
    ds_read_b128 v[160:163], v5 offset:8192
    ds_read_b128 v[164:167], v5 offset:9216
    ds_read_b128 v[168:171], v5 offset:10240
    ds_read_b128 v[172:175], v5 offset:11264
    s_cmp_eq_u32 s24, 0
    s_cbranch_scc1 .cp_245
.cb_246:
    s_waitcnt lgkmcnt(4)
    v_mfma_f32_16x16x32_bf16 v[48:51], v[128:131], v[208:211], v[32:35]
    v_mfma_f32_16x16x32_bf16 v[52:55], v[144:147], v[208:211], v[36:39]
    v_mfma_f32_16x16x32_bf16 v[48:51], v[132:135], v[212:215], v[48:51]
    v_mfma_f32_16x16x32_bf16 v[52:55], v[148:151], v[212:215], v[52:55]
    v_mfma_f32_16x16x32_bf16 v[48:51], v[136:139], v[216:219], v[48:51]
    v_mfma_f32_16x16x32_bf16 v[52:55], v[152:155], v[216:219], v[52:55]
    v_mfma_f32_16x16x32_bf16 v[48:51], v[140:143], v[220:223], v[48:51]
    v_mfma_f32_16x16x32_bf16 v[52:55], v[156:159], v[220:223], v[52:55]
    s_cmp_eq_u32 s31, 0
    s_cbranch_scc1 .cp_247
.cb_248:
    s_barrier
    ds_read_b128 v[176:179], v3 offset:0
    ds_read_b128 v[180:183], v3 offset:512
    ds_read_b128 v[184:187], v3 offset:1024
    ds_read_b128 v[188:191], v3 offset:1536
    ds_read_b32 v232, v6 offset:0
    ds_read_b32 v234, v6 offset:64
    ds_read_b32 v236, v6 offset:512
    ds_read_b32 v238, v6 offset:576
    v_max3_f32 v248, v48, v49, v50
    v_max3_f32 v248, v248, v51, v52
    v_max3_f32 v249, v53, v54, v55
    s_waitcnt lgkmcnt(4)
    v_mfma_f32_16x16x32_bf16 v[56:59], v[176:179], v[208:211], 0
    v_mfma_f32_16x16x32_bf16 v[56:59], v[180:183], v[212:215], v[56:59]
    v_mfma_f32_16x16x32_bf16 v[56:59], v[184:187], v[216:219], v[56:59]
    v_mfma_f32_16x16x32_bf16 v[56:59], v[188:191], v[220:223], v[56:59]
    s_nop 7
    v_max3_f32 v248, v248, v56, v57
    v_max_f32 v30, v248, v249
    v_max_f32 v249, v248, v249
    s_nop 1
    v_permlane16_swap_b32 v249, v30
    v_max_f32 v248, v249, v30
    v_max_f32 v249, v249, v30
    s_nop 1
    v_permlane32_swap_b32 v248, v249
    v_max_f32 v248, v248, v249
    v_mul_f32 v248, s45, v248
    v_fma_f32 v60, v48, s45, -v248
    v_fma_f32 v61, v49, s45, -v248
    v_fma_f32 v62, v50, s45, -v248
    v_fma_f32 v63, v51, s45, -v248
    v_fma_f32 v242, v52, s45, -v248
    v_fma_f32 v243, v53, s45, -v248
    v_fma_f32 v244, v54, s45, -v248
    v_fma_f32 v245, v55, s45, -v248
    v_fma_f32 v246, v56, s45, -v248
    v_fma_f32 v247, v57, s45, -v248
    v_exp_f32 v60, v60
    v_exp_f32 v61, v61
    v_exp_f32 v62, v62
    v_exp_f32 v63, v63
    v_exp_f32 v242, v242
    v_exp_f32 v243, v243
    v_exp_f32 v244, v244
    v_exp_f32 v245, v245
    v_exp_f32 v246, v246
    v_exp_f32 v247, v247
    v_cvt_pk_bf16_f32 v48, v60, v61
    v_cvt_pk_bf16_f32 v49, v62, v63
    v_cvt_pk_bf16_f32 v50, v242, v243
    v_cvt_pk_bf16_f32 v51, v244, v245
    v_cvt_pk_bf16_f32 v40, v246, v247
    s_waitcnt lgkmcnt(0)
    v_mfma_f32_16x16x32_bf16 v[52:55], v[44:47], v[48:51], 0
    v_mfma_f32_16x16x32_bf16 v[52:55], v[44:47], v[40:43], v[52:55]
    v_mfma_f32_16x16x32_bf16 v[208:211], v[160:163], v[48:51], 0
    v_mfma_f32_16x16x32_bf16 v[208:211], v[232:235], v[40:43], v[208:211]
    v_mfma_f32_16x16x32_bf16 v[212:215], v[164:167], v[48:51], 0
    v_mfma_f32_16x16x32_bf16 v[212:215], v[234:237], v[40:43], v[212:215]
    v_mfma_f32_16x16x32_bf16 v[216:219], v[168:171], v[48:51], 0
    v_mfma_f32_16x16x32_bf16 v[216:219], v[236:239], v[40:43], v[216:219]
    v_mfma_f32_16x16x32_bf16 v[220:223], v[172:175], v[48:51], 0
    v_mfma_f32_16x16x32_bf16 v[220:223], v[238:241], v[40:43], v[220:223]
    v_rcp_f32 v248, v52
    s_nop 0
    v_mul_f32 v208, v248, v208
    v_mul_f32 v209, v248, v209
    v_mul_f32 v210, v248, v210
    v_mul_f32 v211, v248, v211
    v_cvt_pk_bf16_f32 v224, v208, v209
    v_cvt_pk_bf16_f32 v225, v210, v211
    v_mul_f32 v212, v248, v212
    v_mul_f32 v213, v248, v213
    v_mul_f32 v214, v248, v214
    v_mul_f32 v215, v248, v215
    v_cvt_pk_bf16_f32 v226, v212, v213
    v_cvt_pk_bf16_f32 v227, v214, v215
    buffer_store_dwordx4 v[224:227], v2, s[8:11], s53 offen offset:0 sc1
    v_mul_f32 v216, v248, v216
    v_mul_f32 v217, v248, v217
    v_mul_f32 v218, v248, v218
    v_mul_f32 v219, v248, v219
    v_cvt_pk_bf16_f32 v228, v216, v217
    v_cvt_pk_bf16_f32 v229, v218, v219
    v_mul_f32 v220, v248, v220
    v_mul_f32 v221, v248, v221
    v_mul_f32 v222, v248, v222
    v_mul_f32 v223, v248, v223
    v_cvt_pk_bf16_f32 v230, v220, v221
    v_cvt_pk_bf16_f32 v231, v222, v223
    buffer_store_dwordx4 v[228:231], v2, s[8:11], s53 offen offset:1024 sc1
    s_mov_b32 s30, 64
    s_waitcnt vmcnt(0)
    s_barrier
    s_cmp_eq_u32 s24, 0
    s_cbranch_scc1 .cp_249
.cb_250:
    s_endpgm
.cp_225:
    s_cmp_gt_u32 s33, s30
    s_cbranch_scc1 .ndd_252
    s_mov_b32 s62, 0
.nd_251:
    buffer_load_dword v4, v7, s[8:11], 0 offen sc1
    s_add_u32 s62, s62, 1
    s_cmp_gt_u32 s62, 0x200000
    s_cbranch_scc1 .mg_end_1
    s_waitcnt vmcnt(0)
    v_min_u32_dpp v4, v4, v4 quad_perm:[1,0,3,2] row_mask:0xf bank_mask:0xf
    s_nop 1
    v_min_u32_dpp v4, v4, v4 quad_perm:[2,3,0,1] row_mask:0xf bank_mask:0xf
    s_nop 1
    v_readfirstlane_b32 s33, v4
    s_cmp_gt_u32 s33, s30
    s_cbranch_scc1 .ndd_252
    s_sleep 4
    s_branch .nd_251
.ndd_252:
    s_add_u32 m0, s52, 0
    s_nop 0
    buffer_load_dwordx4 v2, s[8:11], s48 offen lds
    s_waitcnt vmcnt(0)
    s_branch .cb_226
.pp_227:
    buffer_load_dword v4, v7, s[8:11], 0 offen sc1
    s_mov_b32 s31, 0
    s_branch .pb_228
.cp_229:
    s_max_i32 s4, s30, 0
    v_mov_b32 v27, s4
    s_mov_b64 exec, 1
    buffer_store_dword v27, v26, s[8:11], s94 offen sc1
    s_mov_b64 exec, -1
    s_branch .cb_230
.cp_231:
    s_cmp_gt_u32 s32, s42
    s_cbranch_scc1 .ndd_254
    s_mov_b32 s62, 0
.nd_253:
    buffer_load_dword v29, v7, s[8:11], s46 offen sc1
    buffer_load_dword v30, v7, s[8:11], s47 offen sc1
    s_add_u32 s62, s62, 1
    s_cmp_gt_u32 s62, 0x200000
    s_cbranch_scc1 .mg_end_1
    s_waitcnt vmcnt(0)
    v_min_u32 v29, v29, v30
    s_nop 1
    v_min_u32_dpp v29, v29, v29 quad_perm:[1,0,3,2] row_mask:0xf bank_mask:0xf
    s_nop 1
    v_min_u32_dpp v29, v29, v29 quad_perm:[2,3,0,1] row_mask:0xf bank_mask:0xf
    s_nop 1
    v_readfirstlane_b32 s32, v29
    s_lshl_b32 s55, s32, 18
    s_add_u32 s55, s55, s37
    s_cmp_gt_u32 s32, s42
    s_cbranch_scc1 .ndd_254
    s_sleep 4
    s_branch .nd_253
.ndd_254:
    s_branch .cb_232
.cp_233:
    s_waitcnt vmcnt(1)
    v_min_u32_dpp v4, v4, v4 quad_perm:[1,0,3,2] row_mask:0xf bank_mask:0xf
    s_nop 1
    v_min_u32_dpp v4, v4, v4 quad_perm:[2,3,0,1] row_mask:0xf bank_mask:0xf
    s_nop 1
    v_readfirstlane_b32 s33, v4
    s_cmp_gt_u32 s33, s42
    s_cbranch_scc0 .cb_234
    s_mov_b32 s31, 1
    s_add_u32 m0, s52, 4096
    s_nop 0
    buffer_load_dwordx4 v2, s[8:11], s48 offen lds
    s_branch .cb_234
.cp_235:
    s_cmp_gt_u32 s33, s30
    s_cbranch_scc1 .ndd_256
    s_mov_b32 s62, 0
.nd_255:
    buffer_load_dword v4, v7, s[8:11], 0 offen sc1
    s_add_u32 s62, s62, 1
    s_cmp_gt_u32 s62, 0x200000
    s_cbranch_scc1 .mg_end_1
    s_waitcnt vmcnt(0)
    v_min_u32_dpp v4, v4, v4 quad_perm:[1,0,3,2] row_mask:0xf bank_mask:0xf
    s_nop 1
    v_min_u32_dpp v4, v4, v4 quad_perm:[2,3,0,1] row_mask:0xf bank_mask:0xf
    s_nop 1
    v_readfirstlane_b32 s33, v4
    s_cmp_gt_u32 s33, s30
    s_cbranch_scc1 .ndd_256
    s_sleep 4
    s_branch .nd_255
.ndd_256:
    s_add_u32 m0, s52, 4096
    s_nop 0
    buffer_load_dwordx4 v2, s[8:11], s48 offen lds
    s_waitcnt vmcnt(0)
    s_branch .cb_236
.pp_237:
    buffer_load_dword v4, v7, s[8:11], 0 offen sc1
    s_mov_b32 s31, 0
    s_branch .pb_238
.cp_239:
    s_max_i32 s4, s30, 0
    v_mov_b32 v27, s4
    s_mov_b64 exec, 1
    buffer_store_dword v27, v26, s[8:11], s94 offen sc1
    s_mov_b64 exec, -1
    s_branch .cb_240
.cp_241:
    s_cmp_gt_u32 s32, s42
    s_cbranch_scc1 .ndd_258
    s_mov_b32 s62, 0
.nd_257:
    buffer_load_dword v29, v7, s[8:11], s46 offen sc1
    buffer_load_dword v30, v7, s[8:11], s47 offen sc1
    s_add_u32 s62, s62, 1
    s_cmp_gt_u32 s62, 0x200000
    s_cbranch_scc1 .mg_end_1
    s_waitcnt vmcnt(0)
    v_min_u32 v29, v29, v30
    s_nop 1
    v_min_u32_dpp v29, v29, v29 quad_perm:[1,0,3,2] row_mask:0xf bank_mask:0xf
    s_nop 1
    v_min_u32_dpp v29, v29, v29 quad_perm:[2,3,0,1] row_mask:0xf bank_mask:0xf
    s_nop 1
    v_readfirstlane_b32 s32, v29
    s_lshl_b32 s55, s32, 18
    s_add_u32 s55, s55, s37
    s_cmp_gt_u32 s32, s42
    s_cbranch_scc1 .ndd_258
    s_sleep 4
    s_branch .nd_257
.ndd_258:
    s_branch .cb_242
.cp_243:
    s_waitcnt vmcnt(1)
    v_min_u32_dpp v4, v4, v4 quad_perm:[1,0,3,2] row_mask:0xf bank_mask:0xf
    s_nop 1
    v_min_u32_dpp v4, v4, v4 quad_perm:[2,3,0,1] row_mask:0xf bank_mask:0xf
    s_nop 1
    v_readfirstlane_b32 s33, v4
    s_cmp_gt_u32 s33, s42
    s_cbranch_scc0 .cb_244
    s_mov_b32 s31, 1
    s_add_u32 m0, s52, 0
    s_nop 0
    buffer_load_dwordx4 v2, s[8:11], s48 offen lds
    s_branch .cb_244
.cp_245:
    s_max_i32 s4, s30, 0
    v_mov_b32 v27, s4
    s_mov_b64 exec, 1
    buffer_store_dword v27, v26, s[8:11], s94 offen sc1
    s_mov_b64 exec, -1
    s_branch .cb_246
.cp_247:
    s_cmp_gt_u32 s33, s30
    s_cbranch_scc1 .ndd_260
    s_mov_b32 s62, 0
.nd_259:
    buffer_load_dword v4, v7, s[8:11], 0 offen sc1
    s_add_u32 s62, s62, 1
    s_cmp_gt_u32 s62, 0x200000
    s_cbranch_scc1 .mg_end_1
    s_waitcnt vmcnt(0)
    v_min_u32_dpp v4, v4, v4 quad_perm:[1,0,3,2] row_mask:0xf bank_mask:0xf
    s_nop 1
    v_min_u32_dpp v4, v4, v4 quad_perm:[2,3,0,1] row_mask:0xf bank_mask:0xf
    s_nop 1
    v_readfirstlane_b32 s33, v4
    s_cmp_gt_u32 s33, s30
    s_cbranch_scc1 .ndd_260
    s_sleep 4
    s_branch .nd_259
.ndd_260:
    s_add_u32 m0, s52, 0
    s_nop 0
    buffer_load_dwordx4 v2, s[8:11], s48 offen lds
    s_waitcnt vmcnt(0)
    s_branch .cb_248
.cp_249:
    s_max_i32 s4, s30, 0
    v_mov_b32 v27, s4
    s_mov_b64 exec, 1
    buffer_store_dword v27, v26, s[8:11], s94 offen sc1
    s_mov_b64 exec, -1
    s_branch .cb_250
.ph2_195:
    s_load_dwordx2 s[42:43], s[0:1], 88
    s_load_dwordx2 s[44:45], s[0:1], 112
    s_load_dwordx2 s[40:41], s[0:1], 0
    s_lshl_b32 s4, s99, 6
    s_lshl_b32 s5, s24, 21
    s_add_u32 s4, s4, s5
    s_lshl_b32 s6, s24, 14
    v_bfe_u32 v254, v1, 2, 4
    v_mul_u32_u24 v240, 2048, v254
    v_bfe_u32 v254, v1, 0, 2
    v_mul_u32_u24 v254, 16, v254
    v_add_u32 v240, v240, v254
    v_add_u32 v240, s4, v240
    v_bfe_u32 v254, v1, 4, 2
    v_mul_u32_u24 v242, 512, v254
    v_bfe_u32 v254, v1, 2, 2
    v_mul_u32_u24 v254, 64, v254
    v_add_u32 v242, v242, v254
    v_bfe_u32 v254, v1, 0, 2
    v_mul_u32_u24 v254, 16, v254
    v_add_u32 v242, v242, v254
    v_add_u32 v242, s6, v242
    v_add_u32 v243, 0x10000, v242
    s_waitcnt lgkmcnt(0)
    s_barrier
    s_mov_b32 s16, s42
    s_and_b32 s17, s43, 0xffff
    s_mov_b32 s18, 0x800000
    s_mov_b32 s19, 0x00020000
    s_mov_b32 s84, s44
    s_and_b32 s85, s45, 0xffff
    s_mov_b32 s86, 0x400000
    s_mov_b32 s87, 0x00020000
    s_mov_b32 s12, s40
    s_and_b32 s13, s41, 0xffff
    s_mov_b32 s14, 0x400000
    s_mov_b32 s15, 0x00020000
    s_add_u32 m0, s6, 0
    s_mov_b32 s5, 0
    buffer_load_dwordx4 v240, s[16:19], s5 offen nt lds
    s_add_u32 m0, s6, 1024
    s_mov_b32 s5, 32768
    buffer_load_dwordx4 v240, s[16:19], s5 offen nt lds
    s_add_u32 m0, s6, 2048
    s_mov_b32 s5, 65536
    buffer_load_dwordx4 v240, s[16:19], s5 offen nt lds
    s_add_u32 m0, s6, 3072
    s_mov_b32 s5, 98304
    buffer_load_dwordx4 v240, s[16:19], s5 offen nt lds
    s_add_u32 m0, s6, 4096
    s_mov_b32 s5, 131072
    buffer_load_dwordx4 v240, s[16:19], s5 offen nt lds
    s_add_u32 m0, s6, 5120
    s_mov_b32 s5, 163840
    buffer_load_dwordx4 v240, s[16:19], s5 offen nt lds
    s_add_u32 m0, s6, 6144
    s_mov_b32 s5, 196608
    buffer_load_dwordx4 v240, s[16:19], s5 offen nt lds
    s_add_u32 m0, s6, 7168
    s_mov_b32 s5, 229376
    buffer_load_dwordx4 v240, s[16:19], s5 offen nt lds
    s_add_u32 m0, s6, 8192
    s_mov_b32 s5, 262144
    buffer_load_dwordx4 v240, s[16:19], s5 offen nt lds
    s_add_u32 m0, s6, 9216
    s_mov_b32 s5, 294912
    buffer_load_dwordx4 v240, s[16:19], s5 offen nt lds
    s_add_u32 m0, s6, 10240
    s_mov_b32 s5, 327680
    buffer_load_dwordx4 v240, s[16:19], s5 offen nt lds
    s_add_u32 m0, s6, 11264
    s_mov_b32 s5, 360448
    buffer_load_dwordx4 v240, s[16:19], s5 offen nt lds
    s_add_u32 m0, s6, 12288
    s_mov_b32 s5, 393216
    buffer_load_dwordx4 v240, s[16:19], s5 offen nt lds
    s_add_u32 m0, s6, 13312
    s_mov_b32 s5, 425984
    buffer_load_dwordx4 v240, s[16:19], s5 offen nt lds
    s_add_u32 m0, s6, 14336
    s_mov_b32 s5, 458752
    buffer_load_dwordx4 v240, s[16:19], s5 offen nt lds
    s_add_u32 m0, s6, 15360
    s_mov_b32 s5, 491520
    buffer_load_dwordx4 v240, s[16:19], s5 offen nt lds
    s_add_u32 m0, s6, 65536
    s_mov_b32 s5, 524288
    buffer_load_dwordx4 v240, s[16:19], s5 offen nt lds
    s_add_u32 m0, s6, 66560
    s_mov_b32 s5, 557056
    buffer_load_dwordx4 v240, s[16:19], s5 offen nt lds
    s_add_u32 m0, s6, 67584
    s_mov_b32 s5, 589824
    buffer_load_dwordx4 v240, s[16:19], s5 offen nt lds
    s_add_u32 m0, s6, 68608
    s_mov_b32 s5, 622592
    buffer_load_dwordx4 v240, s[16:19], s5 offen nt lds
    s_add_u32 m0, s6, 69632
    s_mov_b32 s5, 655360
    buffer_load_dwordx4 v240, s[16:19], s5 offen nt lds
    s_add_u32 m0, s6, 70656
    s_mov_b32 s5, 688128
    buffer_load_dwordx4 v240, s[16:19], s5 offen nt lds
    s_add_u32 m0, s6, 71680
    s_mov_b32 s5, 720896
    buffer_load_dwordx4 v240, s[16:19], s5 offen nt lds
    s_add_u32 m0, s6, 72704
    s_mov_b32 s5, 753664
    buffer_load_dwordx4 v240, s[16:19], s5 offen nt lds
    s_add_u32 m0, s6, 73728
    s_mov_b32 s5, 786432
    buffer_load_dwordx4 v240, s[16:19], s5 offen nt lds
    s_add_u32 m0, s6, 74752
    s_mov_b32 s5, 819200
    buffer_load_dwordx4 v240, s[16:19], s5 offen nt lds
    s_add_u32 m0, s6, 75776
    s_mov_b32 s5, 851968
    buffer_load_dwordx4 v240, s[16:19], s5 offen nt lds
    s_add_u32 m0, s6, 76800
    s_mov_b32 s5, 884736
    buffer_load_dwordx4 v240, s[16:19], s5 offen nt lds
    s_add_u32 m0, s6, 77824
    s_mov_b32 s5, 917504
    buffer_load_dwordx4 v240, s[16:19], s5 offen nt lds
    s_add_u32 m0, s6, 78848
    s_mov_b32 s5, 950272
    buffer_load_dwordx4 v240, s[16:19], s5 offen nt lds
    s_add_u32 m0, s6, 79872
    s_mov_b32 s5, 983040
    buffer_load_dwordx4 v240, s[16:19], s5 offen nt lds
    s_add_u32 m0, s6, 80896
    s_mov_b32 s5, 1015808
    buffer_load_dwordx4 v240, s[16:19], s5 offen nt lds
    s_and_b32 s34, s24, 1
    s_lshr_b32 s35, s24, 1
    v_lshlrev_b32 v2, 4, v1
    s_lshl_b32 s4, s24, 10
    s_add_u32 s4, s4, 92286976
    v_bfe_u32 v254, v1, 0, 3
    v_mul_u32_u24 v8, 128, v254
    v_add_u32 v8, s4, v8
    s_lshl_b32 s4, s24, 15
    v_add_u32 v9, s4, v2
    v_add_u32 v10, 0x20000, v9
    s_lshl_b32 s4, s24, 12
    v_add_u32 v11, s4, v2
    s_lshl_b32 s4, s35, 11
    s_lshl_b32 s5, s34, 7
    s_add_u32 s4, s4, s5
    v_bfe_u32 v254, v1, 0, 1
    v_mul_u32_u24 v12, 1024, v254
    v_bfe_u32 v254, v1, 1, 2
    v_mul_u32_u24 v254, 256, v254
    v_add_u32 v12, v12, v254
    v_bfe_u32 v254, v1, 3, 3
    v_mul_u32_u24 v254, 16, v254
    v_add_u32 v12, v12, v254
    v_add_u32 v12, s4, v12
    s_lshl_b32 s4, s24, 14
    s_lshl_b32 s5, s99, 6
    s_add_u32 s4, s4, s5
    v_bfe_u32 v254, v1, 3, 3
    v_mul_u32_u24 v13, 2048, v254
    v_bfe_u32 v254, v1, 0, 3
    v_mul_u32_u24 v254, 8, v254
    v_add_u32 v13, v13, v254
    v_add_u32 v13, s4, v13
    s_lshl_b32 s4, s99, 17
    s_lshl_b32 s5, s24, 9
    s_add_u32 s4, s4, s5
    v_bfe_u32 v254, v1, 0, 3
    v_mul_u32_u24 v14, 16384, v254
    v_bfe_u32 v254, v1, 3, 3
    v_mul_u32_u24 v254, 2, v254
    v_add_u32 v14, v14, v254
    v_add_u32 v14, s4, v14
    v_add_u32 v15, 4096, v14
    v_add_u32 v16, 8192, v14
    v_add_u32 v17, 12288, v14
    s_lshl_b32 s4, s24, 5
    v_bfe_u32 v254, v1, 3, 3
    v_mul_u32_u24 v18, 4, v254
    v_add_u32 v18, s4, v18
    s_and_b32 s4, s99, 7
    s_lshl_b32 s4, s4, 12
    s_lshl_b32 s5, s24, 15
    s_add_u32 s4, s4, s5
    s_add_u32 s4, s4, 50331648
    v_bfe_u32 v254, v1, 0, 5
    v_mul_u32_u24 v19, 128, v254
    v_bfe_u32 v254, v1, 5, 1
    v_mul_u32_u24 v254, 131072, v254
    v_add_u32 v19, v19, v254
    v_add_u32 v19, s4, v19
    s_lshl_b32 s4, s24, 8
    s_add_u32 s4, s4, 0x8000
    v_lshlrev_b32 v21, 2, v1
    v_add_u32 v21, s4, v21
    v_mov_b32 v22, 0x8000
    v_mov_b32 v23, 0
    s_lshl_b32 s4, s99, 7
    s_add_u32 s94, s4, 92291072
    s_mov_b32 s33, 0
    s_waitcnt vmcnt(16)
    ds_read_b64_tr_b16 a[0:1], v242 offset:0
    ds_read_b64_tr_b16 a[2:3], v242 offset:256
    ds_read_b64_tr_b16 a[4:5], v242 offset:8
    ds_read_b64_tr_b16 a[6:7], v242 offset:264
    ds_read_b64_tr_b16 a[8:9], v242 offset:2048
    ds_read_b64_tr_b16 a[10:11], v242 offset:2304
    ds_read_b64_tr_b16 a[12:13], v242 offset:2056
    ds_read_b64_tr_b16 a[14:15], v242 offset:2312
    ds_read_b64_tr_b16 a[16:17], v242 offset:4096
    ds_read_b64_tr_b16 a[18:19], v242 offset:4352
    ds_read_b64_tr_b16 a[20:21], v242 offset:4104
    ds_read_b64_tr_b16 a[22:23], v242 offset:4360
    ds_read_b64_tr_b16 a[24:25], v242 offset:6144
    ds_read_b64_tr_b16 a[26:27], v242 offset:6400
    ds_read_b64_tr_b16 a[28:29], v242 offset:6152
    ds_read_b64_tr_b16 a[30:31], v242 offset:6408
    ds_read_b64_tr_b16 a[32:33], v242 offset:8192
    ds_read_b64_tr_b16 a[34:35], v242 offset:8448
    ds_read_b64_tr_b16 a[36:37], v242 offset:8200
    ds_read_b64_tr_b16 a[38:39], v242 offset:8456
    ds_read_b64_tr_b16 a[40:41], v242 offset:10240
    ds_read_b64_tr_b16 a[42:43], v242 offset:10496
    ds_read_b64_tr_b16 a[44:45], v242 offset:10248
    ds_read_b64_tr_b16 a[46:47], v242 offset:10504
    ds_read_b64_tr_b16 a[48:49], v242 offset:12288
    ds_read_b64_tr_b16 a[50:51], v242 offset:12544
    ds_read_b64_tr_b16 a[52:53], v242 offset:12296
    ds_read_b64_tr_b16 a[54:55], v242 offset:12552
    ds_read_b64_tr_b16 a[56:57], v242 offset:14336
    ds_read_b64_tr_b16 a[58:59], v242 offset:14592
    ds_read_b64_tr_b16 a[60:61], v242 offset:14344
    ds_read_b64_tr_b16 a[62:63], v242 offset:14600
    s_waitcnt lgkmcnt(0)
    s_add_u32 m0, s6, 0
    s_mov_b32 s5, 1048576
    buffer_load_dwordx4 v240, s[16:19], s5 offen nt lds
    s_add_u32 m0, s6, 1024
    s_mov_b32 s5, 1081344
    buffer_load_dwordx4 v240, s[16:19], s5 offen nt lds
    s_add_u32 m0, s6, 2048
    s_mov_b32 s5, 1114112
    buffer_load_dwordx4 v240, s[16:19], s5 offen nt lds
    s_add_u32 m0, s6, 3072
    s_mov_b32 s5, 1146880
    buffer_load_dwordx4 v240, s[16:19], s5 offen nt lds
    s_add_u32 m0, s6, 4096
    s_mov_b32 s5, 1179648
    buffer_load_dwordx4 v240, s[16:19], s5 offen nt lds
    s_add_u32 m0, s6, 5120
    s_mov_b32 s5, 1212416
    buffer_load_dwordx4 v240, s[16:19], s5 offen nt lds
    s_add_u32 m0, s6, 6144
    s_mov_b32 s5, 1245184
    buffer_load_dwordx4 v240, s[16:19], s5 offen nt lds
    s_add_u32 m0, s6, 7168
    s_mov_b32 s5, 1277952
    buffer_load_dwordx4 v240, s[16:19], s5 offen nt lds
    s_add_u32 m0, s6, 8192
    s_mov_b32 s5, 1310720
    buffer_load_dwordx4 v240, s[16:19], s5 offen nt lds
    s_add_u32 m0, s6, 9216
    s_mov_b32 s5, 1343488
    buffer_load_dwordx4 v240, s[16:19], s5 offen nt lds
    s_add_u32 m0, s6, 10240
    s_mov_b32 s5, 1376256
    buffer_load_dwordx4 v240, s[16:19], s5 offen nt lds
    s_add_u32 m0, s6, 11264
    s_mov_b32 s5, 1409024
    buffer_load_dwordx4 v240, s[16:19], s5 offen nt lds
    s_add_u32 m0, s6, 12288
    s_mov_b32 s5, 1441792
    buffer_load_dwordx4 v240, s[16:19], s5 offen nt lds
    s_add_u32 m0, s6, 13312
    s_mov_b32 s5, 1474560
    buffer_load_dwordx4 v240, s[16:19], s5 offen nt lds
    s_add_u32 m0, s6, 14336
    s_mov_b32 s5, 1507328
    buffer_load_dwordx4 v240, s[16:19], s5 offen nt lds
    s_add_u32 m0, s6, 15360
    s_mov_b32 s5, 1540096
    buffer_load_dwordx4 v240, s[16:19], s5 offen nt lds
    s_waitcnt vmcnt(16)
    ds_read_b64_tr_b16 a[64:65], v243 offset:0
    ds_read_b64_tr_b16 a[66:67], v243 offset:256
    ds_read_b64_tr_b16 a[68:69], v243 offset:8
    ds_read_b64_tr_b16 a[70:71], v243 offset:264
    ds_read_b64_tr_b16 a[72:73], v243 offset:2048
    ds_read_b64_tr_b16 a[74:75], v243 offset:2304
    ds_read_b64_tr_b16 a[76:77], v243 offset:2056
    ds_read_b64_tr_b16 a[78:79], v243 offset:2312
    ds_read_b64_tr_b16 a[80:81], v243 offset:4096
    ds_read_b64_tr_b16 a[82:83], v243 offset:4352
    ds_read_b64_tr_b16 a[84:85], v243 offset:4104
    ds_read_b64_tr_b16 a[86:87], v243 offset:4360
    ds_read_b64_tr_b16 a[88:89], v243 offset:6144
    ds_read_b64_tr_b16 a[90:91], v243 offset:6400
    ds_read_b64_tr_b16 a[92:93], v243 offset:6152
    ds_read_b64_tr_b16 a[94:95], v243 offset:6408
    ds_read_b64_tr_b16 a[96:97], v243 offset:8192
    ds_read_b64_tr_b16 a[98:99], v243 offset:8448
    ds_read_b64_tr_b16 a[100:101], v243 offset:8200
    ds_read_b64_tr_b16 a[102:103], v243 offset:8456
    ds_read_b64_tr_b16 a[104:105], v243 offset:10240
    ds_read_b64_tr_b16 a[106:107], v243 offset:10496
    ds_read_b64_tr_b16 a[108:109], v243 offset:10248
    ds_read_b64_tr_b16 a[110:111], v243 offset:10504
    ds_read_b64_tr_b16 a[112:113], v243 offset:12288
    ds_read_b64_tr_b16 a[114:115], v243 offset:12544
    ds_read_b64_tr_b16 a[116:117], v243 offset:12296
    ds_read_b64_tr_b16 a[118:119], v243 offset:12552
    ds_read_b64_tr_b16 a[120:121], v243 offset:14336
    ds_read_b64_tr_b16 a[122:123], v243 offset:14592
    ds_read_b64_tr_b16 a[124:125], v243 offset:14344
    ds_read_b64_tr_b16 a[126:127], v243 offset:14600
    s_waitcnt lgkmcnt(0)
    s_add_u32 m0, s6, 65536
    s_mov_b32 s5, 1572864
    buffer_load_dwordx4 v240, s[16:19], s5 offen nt lds
    s_add_u32 m0, s6, 66560
    s_mov_b32 s5, 1605632
    buffer_load_dwordx4 v240, s[16:19], s5 offen nt lds
    s_add_u32 m0, s6, 67584
    s_mov_b32 s5, 1638400
    buffer_load_dwordx4 v240, s[16:19], s5 offen nt lds
    s_add_u32 m0, s6, 68608
    s_mov_b32 s5, 1671168
    buffer_load_dwordx4 v240, s[16:19], s5 offen nt lds
    s_add_u32 m0, s6, 69632
    s_mov_b32 s5, 1703936
    buffer_load_dwordx4 v240, s[16:19], s5 offen nt lds
    s_add_u32 m0, s6, 70656
    s_mov_b32 s5, 1736704
    buffer_load_dwordx4 v240, s[16:19], s5 offen nt lds
    s_add_u32 m0, s6, 71680
    s_mov_b32 s5, 1769472
    buffer_load_dwordx4 v240, s[16:19], s5 offen nt lds
    s_add_u32 m0, s6, 72704
    s_mov_b32 s5, 1802240
    buffer_load_dwordx4 v240, s[16:19], s5 offen nt lds
    s_add_u32 m0, s6, 73728
    s_mov_b32 s5, 1835008
    buffer_load_dwordx4 v240, s[16:19], s5 offen nt lds
    s_add_u32 m0, s6, 74752
    s_mov_b32 s5, 1867776
    buffer_load_dwordx4 v240, s[16:19], s5 offen nt lds
    s_add_u32 m0, s6, 75776
    s_mov_b32 s5, 1900544
    buffer_load_dwordx4 v240, s[16:19], s5 offen nt lds
    s_add_u32 m0, s6, 76800
    s_mov_b32 s5, 1933312
    buffer_load_dwordx4 v240, s[16:19], s5 offen nt lds
    s_add_u32 m0, s6, 77824
    s_mov_b32 s5, 1966080
    buffer_load_dwordx4 v240, s[16:19], s5 offen nt lds
    s_add_u32 m0, s6, 78848
    s_mov_b32 s5, 1998848
    buffer_load_dwordx4 v240, s[16:19], s5 offen nt lds
    s_add_u32 m0, s6, 79872
    s_mov_b32 s5, 2031616
    buffer_load_dwordx4 v240, s[16:19], s5 offen nt lds
    s_add_u32 m0, s6, 80896
    s_mov_b32 s5, 2064384
    buffer_load_dwordx4 v240, s[16:19], s5 offen nt lds
    s_waitcnt vmcnt(16)
    ds_read_b64_tr_b16 a[128:129], v242 offset:0
    ds_read_b64_tr_b16 a[130:131], v242 offset:256
    ds_read_b64_tr_b16 a[132:133], v242 offset:8
    ds_read_b64_tr_b16 a[134:135], v242 offset:264
    ds_read_b64_tr_b16 a[136:137], v242 offset:2048
    ds_read_b64_tr_b16 a[138:139], v242 offset:2304
    ds_read_b64_tr_b16 a[140:141], v242 offset:2056
    ds_read_b64_tr_b16 a[142:143], v242 offset:2312
    ds_read_b64_tr_b16 a[144:145], v242 offset:4096
    ds_read_b64_tr_b16 a[146:147], v242 offset:4352
    ds_read_b64_tr_b16 a[148:149], v242 offset:4104
    ds_read_b64_tr_b16 a[150:151], v242 offset:4360
    ds_read_b64_tr_b16 a[152:153], v242 offset:6144
    ds_read_b64_tr_b16 a[154:155], v242 offset:6400
    ds_read_b64_tr_b16 a[156:157], v242 offset:6152
    ds_read_b64_tr_b16 a[158:159], v242 offset:6408
    ds_read_b64_tr_b16 a[160:161], v242 offset:8192
    ds_read_b64_tr_b16 a[162:163], v242 offset:8448
    ds_read_b64_tr_b16 a[164:165], v242 offset:8200
    ds_read_b64_tr_b16 a[166:167], v242 offset:8456
    ds_read_b64_tr_b16 a[168:169], v242 offset:10240
    ds_read_b64_tr_b16 a[170:171], v242 offset:10496
    ds_read_b64_tr_b16 a[172:173], v242 offset:10248
    ds_read_b64_tr_b16 a[174:175], v242 offset:10504
    ds_read_b64_tr_b16 a[176:177], v242 offset:12288
    ds_read_b64_tr_b16 a[178:179], v242 offset:12544
    ds_read_b64_tr_b16 a[180:181], v242 offset:12296
    ds_read_b64_tr_b16 a[182:183], v242 offset:12552
    ds_read_b64_tr_b16 a[184:185], v242 offset:14336
    ds_read_b64_tr_b16 a[186:187], v242 offset:14592
    ds_read_b64_tr_b16 a[188:189], v242 offset:14344
    ds_read_b64_tr_b16 a[190:191], v242 offset:14600
    s_waitcnt lgkmcnt(0)
    s_waitcnt vmcnt(0)
    ds_read_b64_tr_b16 a[192:193], v243 offset:0
    ds_read_b64_tr_b16 a[194:195], v243 offset:256
    ds_read_b64_tr_b16 a[196:197], v243 offset:8
    ds_read_b64_tr_b16 a[198:199], v243 offset:264
    ds_read_b64_tr_b16 a[200:201], v243 offset:2048
    ds_read_b64_tr_b16 a[202:203], v243 offset:2304
    ds_read_b64_tr_b16 a[204:205], v243 offset:2056
    ds_read_b64_tr_b16 a[206:207], v243 offset:2312
    ds_read_b64_tr_b16 a[208:209], v243 offset:4096
    ds_read_b64_tr_b16 a[210:211], v243 offset:4352
    ds_read_b64_tr_b16 a[212:213], v243 offset:4104
    ds_read_b64_tr_b16 a[214:215], v243 offset:4360
    ds_read_b64_tr_b16 a[216:217], v243 offset:6144
    ds_read_b64_tr_b16 a[218:219], v243 offset:6400
    ds_read_b64_tr_b16 a[220:221], v243 offset:6152
    ds_read_b64_tr_b16 a[222:223], v243 offset:6408
    ds_read_b64_tr_b16 a[224:225], v243 offset:8192
    ds_read_b64_tr_b16 a[226:227], v243 offset:8448
    ds_read_b64_tr_b16 a[228:229], v243 offset:8200
    ds_read_b64_tr_b16 a[230:231], v243 offset:8456
    ds_read_b64_tr_b16 a[232:233], v243 offset:10240
    ds_read_b64_tr_b16 a[234:235], v243 offset:10496
    ds_read_b64_tr_b16 a[236:237], v243 offset:10248
    ds_read_b64_tr_b16 a[238:239], v243 offset:10504
    ds_read_b64_tr_b16 a[240:241], v243 offset:12288
    ds_read_b64_tr_b16 a[242:243], v243 offset:12544
    ds_read_b64_tr_b16 a[244:245], v243 offset:12296
    ds_read_b64_tr_b16 a[246:247], v243 offset:12552
    ds_read_b64_tr_b16 a[248:249], v243 offset:14336
    ds_read_b64_tr_b16 a[250:251], v243 offset:14592
    ds_read_b64_tr_b16 a[252:253], v243 offset:14344
    ds_read_b64_tr_b16 a[254:255], v243 offset:14600
    s_waitcnt lgkmcnt(0)
    s_mov_b32 s62, 0
    v_mov_b32 v5, 0
.wc_261:
    buffer_load_dword v4, v5, s[20:23], 0 offen offset:192 sc1
    s_add_u32 s62, s62, 1
    s_cmp_gt_u32 s62, 0x200000
    s_cbranch_scc1 .mg_end_1
    s_waitcnt vmcnt(0)
    v_readfirstlane_b32 s4, v4
    s_cmp_ge_u32 s4, 64
    s_cbranch_scc1 .wd_262
    s_sleep 8
    s_branch .wc_261
.wd_262:
    s_mov_b64 exec, 1
    s_cmp_lg_u32 s24, 0
    s_cbranch_scc1 .dr_263
    v_mov_b32 v20, 2
    buffer_atomic_add v20, v23, s[8:11], s94 offen sc0 sc1
    s_branch .drd_264
.dr_263:
    buffer_load_dword v20, v23, s[16:19], 0 offen
.drd_264:
    s_mov_b64 exec, -1
    s_barrier
    s_waitcnt vmcnt(0)
    ds_write_b32 v21, v20 offset:0x4000
    s_waitcnt lgkmcnt(0)
    s_barrier
    ds_read_b32 v20, v22 offset:0x4000
    s_waitcnt lgkmcnt(0)
    v_readfirstlane_b32 s31, v20
    s_add_u32 s30, s31, 1
    s_cmp_ge_u32 s31, 64
    s_cbranch_scc1 .gx_265
.cold_266:
    s_mov_b32 s62, 0
.gp_269:
    buffer_load_dword v4, v8, s[8:11], 0 offen sc1
    s_add_u32 s62, s62, 1
    s_cmp_gt_u32 s62, 0x200000
    s_cbranch_scc1 .mg_end_1
    s_waitcnt vmcnt(0)
    v_min_u32_dpp v4, v4, v4 quad_perm:[1,0,3,2] row_mask:0xf bank_mask:0xf
    s_nop 1
    v_min_u32_dpp v4, v4, v4 quad_perm:[2,3,0,1] row_mask:0xf bank_mask:0xf
    s_nop 1
    v_min_u32_dpp v4, v4, v4 row_half_mirror row_mask:0xf bank_mask:0xf
    s_nop 1
    v_readfirstlane_b32 s33, v4
    s_cmp_gt_u32 s33, s31
    s_cbranch_scc1 .gd_270
    s_sleep 4
    s_cmp_eq_u32 s33, s31
    s_cbranch_scc1 .gp_269
    s_sleep 24
    s_branch .gp_269
.gd_270:
    s_lshl_b32 s57, s31, 16
    s_and_b32 s4, s31, 31
    s_lshl_b32 s4, s4, 4
    s_lshr_b32 s5, s31, 5
    s_lshl_b32 s5, s5, 11
    s_add_u32 s58, s4, s5
    s_add_u32 s58, s58, 130023424
    s_lshl_b32 s59, s31, 7
    s_add_u32 s59, s59, 121634816
    s_lshl_b32 s48, s31, 18
    s_add_u32 s4, s31, 4
    s_min_u32 s4, s4, s33
    s_sub_u32 s4, s4, 1
    s_lshl_b32 s4, s4, 18
    buffer_load_dword v6, v19, s[8:11], s48 offen
    buffer_load_dword v7, v19, s[8:11], s4 offen
    buffer_load_dword v4, v8, s[8:11], 0 offen sc1
    buffer_load_dwordx2 v[208:209], v13, s[12:15], s57 offen
    buffer_load_dword v214, v18, s[8:11], s59 offen
    s_add_u32 s48, s48, 50331648
    buffer_load_ushort v210, v14, s[8:11], s58 offen
    buffer_load_ushort v211, v15, s[8:11], s58 offen
    buffer_load_ushort v212, v16, s[8:11], s58 offen
    buffer_load_ushort v213, v17, s[8:11], s58 offen
    s_mov_b64 exec, 1
    s_cmp_lg_u32 s24, 0
    s_cbranch_scc1 .dr_271
    v_mov_b32 v20, 1
    buffer_atomic_add v20, v23, s[8:11], s94 offen sc0 sc1
    s_branch .drd_272
.dr_271:
    buffer_load_dword v20, v23, s[16:19], 0 offen
.drd_272:
    s_mov_b64 exec, -1
    s_add_u32 s49, s48, 4096
    s_add_u32 s50, s48, 8192
    s_add_u32 s51, s48, 12288
    s_add_u32 s52, s48, 16384
    s_add_u32 s53, s48, 20480
    s_add_u32 s54, s48, 24576
    s_add_u32 s55, s48, 28672
    buffer_load_dwordx4 v[64:67], v9, s[8:11], s48 offen offset:0
    buffer_load_dwordx4 v[68:71], v10, s[8:11], s48 offen offset:0
    buffer_load_dwordx4 v[72:75], v9, s[8:11], s48 offen offset:1024
    buffer_load_dwordx4 v[76:79], v10, s[8:11], s48 offen offset:1024
    buffer_load_dwordx4 v[80:83], v9, s[8:11], s48 offen offset:2048
    buffer_load_dwordx4 v[84:87], v10, s[8:11], s48 offen offset:2048
    buffer_load_dwordx4 v[88:91], v9, s[8:11], s48 offen offset:3072
    buffer_load_dwordx4 v[92:95], v10, s[8:11], s48 offen offset:3072
    buffer_load_dwordx4 v[96:99], v9, s[8:11], s49 offen offset:0
    buffer_load_dwordx4 v[100:103], v10, s[8:11], s49 offen offset:0
    buffer_load_dwordx4 v[104:107], v9, s[8:11], s49 offen offset:1024
    buffer_load_dwordx4 v[108:111], v10, s[8:11], s49 offen offset:1024
    buffer_load_dwordx4 v[112:115], v9, s[8:11], s49 offen offset:2048
    buffer_load_dwordx4 v[116:119], v10, s[8:11], s49 offen offset:2048
    buffer_load_dwordx4 v[120:123], v9, s[8:11], s49 offen offset:3072
    buffer_load_dwordx4 v[124:127], v10, s[8:11], s49 offen offset:3072
    buffer_load_dwordx4 v[128:131], v9, s[8:11], s50 offen offset:0
    buffer_load_dwordx4 v[132:135], v10, s[8:11], s50 offen offset:0
    buffer_load_dwordx4 v[136:139], v9, s[8:11], s50 offen offset:1024
    buffer_load_dwordx4 v[140:143], v10, s[8:11], s50 offen offset:1024
    buffer_load_dwordx4 v[144:147], v9, s[8:11], s50 offen offset:2048
    buffer_load_dwordx4 v[148:151], v10, s[8:11], s50 offen offset:2048
    buffer_load_dwordx4 v[152:155], v9, s[8:11], s50 offen offset:3072
    buffer_load_dwordx4 v[156:159], v10, s[8:11], s50 offen offset:3072
    buffer_load_dwordx4 v[160:163], v9, s[8:11], s51 offen offset:0
    buffer_load_dwordx4 v[164:167], v10, s[8:11], s51 offen offset:0
    buffer_load_dwordx4 v[168:171], v9, s[8:11], s51 offen offset:1024
    buffer_load_dwordx4 v[172:175], v10, s[8:11], s51 offen offset:1024
    buffer_load_dwordx4 v[176:179], v9, s[8:11], s51 offen offset:2048
    buffer_load_dwordx4 v[180:183], v10, s[8:11], s51 offen offset:2048
    buffer_load_dwordx4 v[184:187], v9, s[8:11], s51 offen offset:3072
    buffer_load_dwordx4 v[188:191], v10, s[8:11], s51 offen offset:3072
.main_267:
    s_waitcnt vmcnt(31)
    v_mfma_f32_16x16x32_bf16 v[192:195], a[0:3], v[64:67], 0
    v_mfma_f32_16x16x32_bf16 v[196:199], a[4:7], v[64:67], 0
    buffer_load_dwordx4 v[64:67], v9, s[8:11], s52 offen offset:0
    v_lshlrev_b32 v216, 16, v208
    s_waitcnt vmcnt(31)
    v_mfma_f32_16x16x32_bf16 v[200:203], a[0:3], v[68:71], 0
    v_mfma_f32_16x16x32_bf16 v[204:207], a[4:7], v[68:71], 0
    buffer_load_dwordx4 v[68:71], v10, s[8:11], s52 offen offset:0
    v_and_b32 v217, 0xffff0000, v208
    s_waitcnt vmcnt(31)
    v_mfma_f32_16x16x32_bf16 v[192:195], a[8:11], v[72:75], v[192:195]
    v_mfma_f32_16x16x32_bf16 v[196:199], a[12:15], v[72:75], v[196:199]
    buffer_load_dwordx4 v[72:75], v9, s[8:11], s52 offen offset:1024
    v_lshlrev_b32 v218, 16, v209
    s_waitcnt vmcnt(31)
    v_mfma_f32_16x16x32_bf16 v[200:203], a[8:11], v[76:79], v[200:203]
    v_mfma_f32_16x16x32_bf16 v[204:207], a[12:15], v[76:79], v[204:207]
    buffer_load_dwordx4 v[76:79], v10, s[8:11], s52 offen offset:1024
    v_and_b32 v219, 0xffff0000, v209
    s_waitcnt vmcnt(31)
    v_mfma_f32_16x16x32_bf16 v[192:195], a[16:19], v[80:83], v[192:195]
    v_mfma_f32_16x16x32_bf16 v[196:199], a[20:23], v[80:83], v[196:199]
    buffer_load_dwordx4 v[80:83], v9, s[8:11], s52 offen offset:2048
    v_lshlrev_b32 v210, 16, v210
    s_waitcnt vmcnt(31)
    v_mfma_f32_16x16x32_bf16 v[200:203], a[16:19], v[84:87], v[200:203]
    v_mfma_f32_16x16x32_bf16 v[204:207], a[20:23], v[84:87], v[204:207]
    buffer_load_dwordx4 v[84:87], v10, s[8:11], s52 offen offset:2048
    v_lshlrev_b32 v211, 16, v211
    s_waitcnt vmcnt(31)
    v_mfma_f32_16x16x32_bf16 v[192:195], a[24:27], v[88:91], v[192:195]
    v_mfma_f32_16x16x32_bf16 v[196:199], a[28:31], v[88:91], v[196:199]
    buffer_load_dwordx4 v[88:91], v9, s[8:11], s52 offen offset:3072
    v_lshlrev_b32 v212, 16, v212
    s_waitcnt vmcnt(31)
    v_mfma_f32_16x16x32_bf16 v[200:203], a[24:27], v[92:95], v[200:203]
    v_mfma_f32_16x16x32_bf16 v[204:207], a[28:31], v[92:95], v[204:207]
    buffer_load_dwordx4 v[92:95], v10, s[8:11], s52 offen offset:3072
    v_lshlrev_b32 v213, 16, v213
    s_waitcnt vmcnt(31)
    v_mfma_f32_16x16x32_bf16 v[192:195], a[32:35], v[96:99], v[192:195]
    v_mfma_f32_16x16x32_bf16 v[196:199], a[36:39], v[96:99], v[196:199]
    buffer_load_dwordx4 v[96:99], v9, s[8:11], s53 offen offset:0
    v_mul_f32 v216, v216, v210
    s_waitcnt vmcnt(31)
    v_mfma_f32_16x16x32_bf16 v[200:203], a[32:35], v[100:103], v[200:203]
    v_mfma_f32_16x16x32_bf16 v[204:207], a[36:39], v[100:103], v[204:207]
    buffer_load_dwordx4 v[100:103], v10, s[8:11], s53 offen offset:0
    v_mul_f32 v217, v217, v211
    s_waitcnt vmcnt(31)
    v_mfma_f32_16x16x32_bf16 v[192:195], a[40:43], v[104:107], v[192:195]
    v_mfma_f32_16x16x32_bf16 v[196:199], a[44:47], v[104:107], v[196:199]
    buffer_load_dwordx4 v[104:107], v9, s[8:11], s53 offen offset:1024
    v_mul_f32 v218, v218, v212
    s_waitcnt vmcnt(31)
    v_mfma_f32_16x16x32_bf16 v[200:203], a[40:43], v[108:111], v[200:203]
    v_mfma_f32_16x16x32_bf16 v[204:207], a[44:47], v[108:111], v[204:207]
    buffer_load_dwordx4 v[108:111], v10, s[8:11], s53 offen offset:1024
    v_mul_f32 v219, v219, v213
    s_waitcnt vmcnt(31)
    v_mfma_f32_16x16x32_bf16 v[192:195], a[48:51], v[112:115], v[192:195]
    v_mfma_f32_16x16x32_bf16 v[196:199], a[52:55], v[112:115], v[196:199]
    buffer_load_dwordx4 v[112:115], v9, s[8:11], s53 offen offset:2048
    v_mul_f32 v216, v216, v214
    s_waitcnt vmcnt(31)
    v_mfma_f32_16x16x32_bf16 v[200:203], a[48:51], v[116:119], v[200:203]
    v_mfma_f32_16x16x32_bf16 v[204:207], a[52:55], v[116:119], v[204:207]
    buffer_load_dwordx4 v[116:119], v10, s[8:11], s53 offen offset:2048
    v_mul_f32 v217, v217, v214
    s_waitcnt vmcnt(31)
    v_mfma_f32_16x16x32_bf16 v[192:195], a[56:59], v[120:123], v[192:195]
    v_mfma_f32_16x16x32_bf16 v[196:199], a[60:63], v[120:123], v[196:199]
    buffer_load_dwordx4 v[120:123], v9, s[8:11], s53 offen offset:3072
    v_mul_f32 v218, v218, v214
    s_waitcnt vmcnt(31)
    v_mfma_f32_16x16x32_bf16 v[200:203], a[56:59], v[124:127], v[200:203]
    v_mfma_f32_16x16x32_bf16 v[204:207], a[60:63], v[124:127], v[204:207]
    buffer_load_dwordx4 v[124:127], v10, s[8:11], s53 offen offset:3072
    v_mul_f32 v219, v219, v214
    s_waitcnt vmcnt(31)
    v_mfma_f32_16x16x32_bf16 v[192:195], a[64:67], v[128:131], v[192:195]
    v_mfma_f32_16x16x32_bf16 v[196:199], a[68:71], v[128:131], v[196:199]
    buffer_load_dwordx4 v[128:131], v9, s[8:11], s54 offen offset:0
    v_sub_f32 v220, 1.0, v214
    s_waitcnt vmcnt(31)
    v_mfma_f32_16x16x32_bf16 v[200:203], a[64:67], v[132:135], v[200:203]
    v_mfma_f32_16x16x32_bf16 v[204:207], a[68:71], v[132:135], v[204:207]
    buffer_load_dwordx4 v[132:135], v10, s[8:11], s54 offen offset:0
    s_mov_b32 s56, s57
    s_waitcnt vmcnt(31)
    v_mfma_f32_16x16x32_bf16 v[192:195], a[72:75], v[136:139], v[192:195]
    v_mfma_f32_16x16x32_bf16 v[196:199], a[76:79], v[136:139], v[196:199]
    buffer_load_dwordx4 v[136:139], v9, s[8:11], s54 offen offset:1024
    ds_write_b32 v21, v20
    s_waitcnt vmcnt(31)
    v_mfma_f32_16x16x32_bf16 v[200:203], a[72:75], v[140:143], v[200:203]
    v_mfma_f32_16x16x32_bf16 v[204:207], a[76:79], v[140:143], v[204:207]
    buffer_load_dwordx4 v[140:143], v10, s[8:11], s54 offen offset:1024
    s_waitcnt vmcnt(31)
    v_mfma_f32_16x16x32_bf16 v[192:195], a[80:83], v[144:147], v[192:195]
    v_mfma_f32_16x16x32_bf16 v[196:199], a[84:87], v[144:147], v[196:199]
    buffer_load_dwordx4 v[144:147], v9, s[8:11], s54 offen offset:2048
    s_waitcnt vmcnt(31)
    v_mfma_f32_16x16x32_bf16 v[200:203], a[80:83], v[148:151], v[200:203]
    v_mfma_f32_16x16x32_bf16 v[204:207], a[84:87], v[148:151], v[204:207]
    buffer_load_dwordx4 v[148:151], v10, s[8:11], s54 offen offset:2048
    s_waitcnt vmcnt(31)
    v_mfma_f32_16x16x32_bf16 v[192:195], a[88:91], v[152:155], v[192:195]
    v_mfma_f32_16x16x32_bf16 v[196:199], a[92:95], v[152:155], v[196:199]
    buffer_load_dwordx4 v[152:155], v9, s[8:11], s54 offen offset:3072
    s_waitcnt vmcnt(31)
    v_mfma_f32_16x16x32_bf16 v[200:203], a[88:91], v[156:159], v[200:203]
    v_mfma_f32_16x16x32_bf16 v[204:207], a[92:95], v[156:159], v[204:207]
    buffer_load_dwordx4 v[156:159], v10, s[8:11], s54 offen offset:3072
    s_waitcnt vmcnt(31)
    v_mfma_f32_16x16x32_bf16 v[192:195], a[96:99], v[160:163], v[192:195]
    v_mfma_f32_16x16x32_bf16 v[196:199], a[100:103], v[160:163], v[196:199]
    buffer_load_dwordx4 v[160:163], v9, s[8:11], s55 offen offset:0
    v_min_u32_dpp v4, v4, v4 quad_perm:[1,0,3,2] row_mask:0xf bank_mask:0xf
    s_nop 1
    v_min_u32_dpp v4, v4, v4 quad_perm:[2,3,0,1] row_mask:0xf bank_mask:0xf
    s_nop 1
    v_min_u32_dpp v4, v4, v4 row_half_mirror row_mask:0xf bank_mask:0xf
    s_nop 1
    v_readfirstlane_b32 s33, v4
    s_waitcnt vmcnt(31)
    v_mfma_f32_16x16x32_bf16 v[200:203], a[96:99], v[164:167], v[200:203]
    v_mfma_f32_16x16x32_bf16 v[204:207], a[100:103], v[164:167], v[204:207]
    buffer_load_dwordx4 v[164:167], v10, s[8:11], s55 offen offset:0
    s_waitcnt vmcnt(31)
    v_mfma_f32_16x16x32_bf16 v[192:195], a[104:107], v[168:171], v[192:195]
    v_mfma_f32_16x16x32_bf16 v[196:199], a[108:111], v[168:171], v[196:199]
    buffer_load_dwordx4 v[168:171], v9, s[8:11], s55 offen offset:1024
    s_waitcnt vmcnt(31)
    v_mfma_f32_16x16x32_bf16 v[200:203], a[104:107], v[172:175], v[200:203]
    v_mfma_f32_16x16x32_bf16 v[204:207], a[108:111], v[172:175], v[204:207]
    buffer_load_dwordx4 v[172:175], v10, s[8:11], s55 offen offset:1024
    s_waitcnt vmcnt(31)
    v_mfma_f32_16x16x32_bf16 v[192:195], a[112:115], v[176:179], v[192:195]
    v_mfma_f32_16x16x32_bf16 v[196:199], a[116:119], v[176:179], v[196:199]
    buffer_load_dwordx4 v[176:179], v9, s[8:11], s55 offen offset:2048
    s_waitcnt vmcnt(31)
    v_mfma_f32_16x16x32_bf16 v[200:203], a[112:115], v[180:183], v[200:203]
    v_mfma_f32_16x16x32_bf16 v[204:207], a[116:119], v[180:183], v[204:207]
    buffer_load_dwordx4 v[180:183], v10, s[8:11], s55 offen offset:2048
    s_waitcnt vmcnt(31)
    v_mfma_f32_16x16x32_bf16 v[192:195], a[120:123], v[184:187], v[192:195]
    v_mfma_f32_16x16x32_bf16 v[196:199], a[124:127], v[184:187], v[196:199]
    buffer_load_dwordx4 v[184:187], v9, s[8:11], s55 offen offset:3072
    s_waitcnt vmcnt(31)
    v_mfma_f32_16x16x32_bf16 v[200:203], a[120:123], v[188:191], v[200:203]
    v_mfma_f32_16x16x32_bf16 v[204:207], a[124:127], v[188:191], v[204:207]
    buffer_load_dwordx4 v[188:191], v10, s[8:11], s55 offen offset:3072
    s_cmp_gt_u32 s33, s30
    s_cbranch_scc0 .drain_268
    s_lshl_b32 s57, s30, 16
    s_and_b32 s4, s30, 31
    s_lshl_b32 s4, s4, 4
    s_lshr_b32 s5, s30, 5
    s_lshl_b32 s5, s5, 11
    s_add_u32 s58, s4, s5
    s_add_u32 s58, s58, 130023424
    s_lshl_b32 s59, s30, 7
    s_add_u32 s59, s59, 121634816
    s_lshl_b32 s48, s30, 18
    s_add_u32 s4, s30, 4
    s_min_u32 s4, s4, s33
    s_sub_u32 s4, s4, 1
    s_lshl_b32 s4, s4, 18
    buffer_load_dword v6, v19, s[8:11], s48 offen
    buffer_load_dword v7, v19, s[8:11], s4 offen
    buffer_load_dword v4, v8, s[8:11], 0 offen sc1
    buffer_load_dwordx2 v[208:209], v13, s[12:15], s57 offen
    buffer_load_dword v214, v18, s[8:11], s59 offen
    s_add_u32 s48, s48, 50331648
    buffer_load_ushort v210, v14, s[8:11], s58 offen
    buffer_load_ushort v211, v15, s[8:11], s58 offen
    buffer_load_ushort v212, v16, s[8:11], s58 offen
    buffer_load_ushort v213, v17, s[8:11], s58 offen
    s_mov_b64 exec, 1
    s_cmp_lg_u32 s24, 0
    s_cbranch_scc1 .dr_273
    v_mov_b32 v20, 1
    buffer_atomic_add v20, v23, s[8:11], s94 offen sc0 sc1
    s_branch .drd_274
.dr_273:
    buffer_load_dword v20, v23, s[16:19], 0 offen
.drd_274:
    s_mov_b64 exec, -1
    s_add_u32 s49, s48, 4096
    s_add_u32 s50, s48, 8192
    s_add_u32 s51, s48, 12288
    s_add_u32 s52, s48, 16384
    s_add_u32 s53, s48, 20480
    s_add_u32 s54, s48, 24576
    s_add_u32 s55, s48, 28672
    s_waitcnt vmcnt(41)
    v_mfma_f32_16x16x32_bf16 v[192:195], a[128:131], v[64:67], v[192:195]
    v_mfma_f32_16x16x32_bf16 v[196:199], a[132:135], v[64:67], v[196:199]
    buffer_load_dwordx4 v[64:67], v9, s[8:11], s48 offen offset:0
    s_waitcnt vmcnt(41)
    v_mfma_f32_16x16x32_bf16 v[200:203], a[128:131], v[68:71], v[200:203]
    v_mfma_f32_16x16x32_bf16 v[204:207], a[132:135], v[68:71], v[204:207]
    buffer_load_dwordx4 v[68:71], v10, s[8:11], s48 offen offset:0
    s_waitcnt vmcnt(41)
    v_mfma_f32_16x16x32_bf16 v[192:195], a[136:139], v[72:75], v[192:195]
    v_mfma_f32_16x16x32_bf16 v[196:199], a[140:143], v[72:75], v[196:199]
    buffer_load_dwordx4 v[72:75], v9, s[8:11], s48 offen offset:1024
    s_waitcnt vmcnt(41)
    v_mfma_f32_16x16x32_bf16 v[200:203], a[136:139], v[76:79], v[200:203]
    v_mfma_f32_16x16x32_bf16 v[204:207], a[140:143], v[76:79], v[204:207]
    buffer_load_dwordx4 v[76:79], v10, s[8:11], s48 offen offset:1024
    s_waitcnt vmcnt(41)
    v_mfma_f32_16x16x32_bf16 v[192:195], a[144:147], v[80:83], v[192:195]
    v_mfma_f32_16x16x32_bf16 v[196:199], a[148:151], v[80:83], v[196:199]
    buffer_load_dwordx4 v[80:83], v9, s[8:11], s48 offen offset:2048
    s_waitcnt vmcnt(41)
    v_mfma_f32_16x16x32_bf16 v[200:203], a[144:147], v[84:87], v[200:203]
    v_mfma_f32_16x16x32_bf16 v[204:207], a[148:151], v[84:87], v[204:207]
    buffer_load_dwordx4 v[84:87], v10, s[8:11], s48 offen offset:2048
    s_waitcnt vmcnt(41)
    v_mfma_f32_16x16x32_bf16 v[192:195], a[152:155], v[88:91], v[192:195]
    v_mfma_f32_16x16x32_bf16 v[196:199], a[156:159], v[88:91], v[196:199]
    buffer_load_dwordx4 v[88:91], v9, s[8:11], s48 offen offset:3072
    s_waitcnt vmcnt(41)
    v_mfma_f32_16x16x32_bf16 v[200:203], a[152:155], v[92:95], v[200:203]
    v_mfma_f32_16x16x32_bf16 v[204:207], a[156:159], v[92:95], v[204:207]
    buffer_load_dwordx4 v[92:95], v10, s[8:11], s48 offen offset:3072
    s_waitcnt vmcnt(41)
    v_mfma_f32_16x16x32_bf16 v[192:195], a[160:163], v[96:99], v[192:195]
    v_mfma_f32_16x16x32_bf16 v[196:199], a[164:167], v[96:99], v[196:199]
    buffer_load_dwordx4 v[96:99], v9, s[8:11], s49 offen offset:0
    s_waitcnt vmcnt(41)
    v_mfma_f32_16x16x32_bf16 v[200:203], a[160:163], v[100:103], v[200:203]
    v_mfma_f32_16x16x32_bf16 v[204:207], a[164:167], v[100:103], v[204:207]
    buffer_load_dwordx4 v[100:103], v10, s[8:11], s49 offen offset:0
    s_waitcnt vmcnt(41)
    v_mfma_f32_16x16x32_bf16 v[192:195], a[168:171], v[104:107], v[192:195]
    v_mfma_f32_16x16x32_bf16 v[196:199], a[172:175], v[104:107], v[196:199]
    buffer_load_dwordx4 v[104:107], v9, s[8:11], s49 offen offset:1024
    s_waitcnt vmcnt(41)
    v_mfma_f32_16x16x32_bf16 v[200:203], a[168:171], v[108:111], v[200:203]
    v_mfma_f32_16x16x32_bf16 v[204:207], a[172:175], v[108:111], v[204:207]
    buffer_load_dwordx4 v[108:111], v10, s[8:11], s49 offen offset:1024
    s_waitcnt vmcnt(41)
    v_mfma_f32_16x16x32_bf16 v[192:195], a[176:179], v[112:115], v[192:195]
    v_mfma_f32_16x16x32_bf16 v[196:199], a[180:183], v[112:115], v[196:199]
    buffer_load_dwordx4 v[112:115], v9, s[8:11], s49 offen offset:2048
    s_waitcnt vmcnt(41)
    v_mfma_f32_16x16x32_bf16 v[200:203], a[176:179], v[116:119], v[200:203]
    v_mfma_f32_16x16x32_bf16 v[204:207], a[180:183], v[116:119], v[204:207]
    buffer_load_dwordx4 v[116:119], v10, s[8:11], s49 offen offset:2048
    s_waitcnt vmcnt(41)
    v_mfma_f32_16x16x32_bf16 v[192:195], a[184:187], v[120:123], v[192:195]
    v_mfma_f32_16x16x32_bf16 v[196:199], a[188:191], v[120:123], v[196:199]
    buffer_load_dwordx4 v[120:123], v9, s[8:11], s49 offen offset:3072
    s_waitcnt vmcnt(41)
    v_mfma_f32_16x16x32_bf16 v[200:203], a[184:187], v[124:127], v[200:203]
    v_mfma_f32_16x16x32_bf16 v[204:207], a[188:191], v[124:127], v[204:207]
    buffer_load_dwordx4 v[124:127], v10, s[8:11], s49 offen offset:3072
    s_waitcnt vmcnt(41)
    v_mfma_f32_16x16x32_bf16 v[192:195], a[192:195], v[128:131], v[192:195]
    v_mfma_f32_16x16x32_bf16 v[196:199], a[196:199], v[128:131], v[196:199]
    buffer_load_dwordx4 v[128:131], v9, s[8:11], s50 offen offset:0
    s_waitcnt vmcnt(41)
    v_mfma_f32_16x16x32_bf16 v[200:203], a[192:195], v[132:135], v[200:203]
    v_mfma_f32_16x16x32_bf16 v[204:207], a[196:199], v[132:135], v[204:207]
    buffer_load_dwordx4 v[132:135], v10, s[8:11], s50 offen offset:0
    s_waitcnt vmcnt(41)
    v_mfma_f32_16x16x32_bf16 v[192:195], a[200:203], v[136:139], v[192:195]
    v_mfma_f32_16x16x32_bf16 v[196:199], a[204:207], v[136:139], v[196:199]
    buffer_load_dwordx4 v[136:139], v9, s[8:11], s50 offen offset:1024
    s_waitcnt vmcnt(41)
    v_mfma_f32_16x16x32_bf16 v[200:203], a[200:203], v[140:143], v[200:203]
    v_mfma_f32_16x16x32_bf16 v[204:207], a[204:207], v[140:143], v[204:207]
    buffer_load_dwordx4 v[140:143], v10, s[8:11], s50 offen offset:1024
    s_waitcnt vmcnt(41)
    v_mfma_f32_16x16x32_bf16 v[192:195], a[208:211], v[144:147], v[192:195]
    v_mfma_f32_16x16x32_bf16 v[196:199], a[212:215], v[144:147], v[196:199]
    buffer_load_dwordx4 v[144:147], v9, s[8:11], s50 offen offset:2048
    s_waitcnt vmcnt(41)
    v_mfma_f32_16x16x32_bf16 v[200:203], a[208:211], v[148:151], v[200:203]
    v_mfma_f32_16x16x32_bf16 v[204:207], a[212:215], v[148:151], v[204:207]
    buffer_load_dwordx4 v[148:151], v10, s[8:11], s50 offen offset:2048
    s_waitcnt vmcnt(41)
    v_mfma_f32_16x16x32_bf16 v[192:195], a[216:219], v[152:155], v[192:195]
    v_mfma_f32_16x16x32_bf16 v[196:199], a[220:223], v[152:155], v[196:199]
    buffer_load_dwordx4 v[152:155], v9, s[8:11], s50 offen offset:3072
    s_waitcnt vmcnt(41)
    v_mfma_f32_16x16x32_bf16 v[200:203], a[216:219], v[156:159], v[200:203]
    v_mfma_f32_16x16x32_bf16 v[204:207], a[220:223], v[156:159], v[204:207]
    buffer_load_dwordx4 v[156:159], v10, s[8:11], s50 offen offset:3072
    s_waitcnt vmcnt(41)
    v_mfma_f32_16x16x32_bf16 v[192:195], a[224:227], v[160:163], v[192:195]
    v_mfma_f32_16x16x32_bf16 v[196:199], a[228:231], v[160:163], v[196:199]
    buffer_load_dwordx4 v[160:163], v9, s[8:11], s51 offen offset:0
    s_waitcnt vmcnt(41)
    v_mfma_f32_16x16x32_bf16 v[200:203], a[224:227], v[164:167], v[200:203]
    v_mfma_f32_16x16x32_bf16 v[204:207], a[228:231], v[164:167], v[204:207]
    buffer_load_dwordx4 v[164:167], v10, s[8:11], s51 offen offset:0
    s_waitcnt vmcnt(41)
    v_mfma_f32_16x16x32_bf16 v[192:195], a[232:235], v[168:171], v[192:195]
    v_mfma_f32_16x16x32_bf16 v[196:199], a[236:239], v[168:171], v[196:199]
    buffer_load_dwordx4 v[168:171], v9, s[8:11], s51 offen offset:1024
    s_waitcnt vmcnt(41)
    v_mfma_f32_16x16x32_bf16 v[200:203], a[232:235], v[172:175], v[200:203]
    v_mfma_f32_16x16x32_bf16 v[204:207], a[236:239], v[172:175], v[204:207]
    buffer_load_dwordx4 v[172:175], v10, s[8:11], s51 offen offset:1024
    s_waitcnt vmcnt(41)
    v_mfma_f32_16x16x32_bf16 v[192:195], a[240:243], v[176:179], v[192:195]
    v_mfma_f32_16x16x32_bf16 v[196:199], a[244:247], v[176:179], v[196:199]
    buffer_load_dwordx4 v[176:179], v9, s[8:11], s51 offen offset:2048
    s_waitcnt vmcnt(41)
    v_mfma_f32_16x16x32_bf16 v[200:203], a[240:243], v[180:183], v[200:203]
    v_mfma_f32_16x16x32_bf16 v[204:207], a[244:247], v[180:183], v[204:207]
    buffer_load_dwordx4 v[180:183], v10, s[8:11], s51 offen offset:2048
    s_waitcnt vmcnt(41)
    v_mfma_f32_16x16x32_bf16 v[192:195], a[248:251], v[184:187], v[192:195]
    v_mfma_f32_16x16x32_bf16 v[196:199], a[252:255], v[184:187], v[196:199]
    buffer_load_dwordx4 v[184:187], v9, s[8:11], s51 offen offset:3072
    s_waitcnt vmcnt(41)
    v_mfma_f32_16x16x32_bf16 v[200:203], a[248:251], v[188:191], v[200:203]
    v_mfma_f32_16x16x32_bf16 v[204:207], a[252:255], v[188:191], v[204:207]
    buffer_load_dwordx4 v[188:191], v10, s[8:11], s51 offen offset:3072
    s_nop 5
    ds_write_b128 v11, v[192:195] offset:0
    ds_write_b128 v11, v[196:199] offset:1024
    ds_write_b128 v11, v[200:203] offset:2048
    ds_write_b128 v11, v[204:207] offset:3072
    s_waitcnt lgkmcnt(0)
    s_barrier
    ds_read_b32 v24, v22
    ds_read_b128 v[224:227], v12 offset:0
    ds_read_b128 v[228:231], v12 offset:4096
    ds_read_b128 v[232:235], v12 offset:8192
    ds_read_b128 v[236:239], v12 offset:12288
    v_xor_b32 v11, 0x4000, v11
    v_xor_b32 v12, 0x4000, v12
    v_xor_b32 v21, 0x4000, v21
    v_xor_b32 v22, 0x4000, v22
    s_waitcnt lgkmcnt(2)
    v_add_f32 v224, v224, v228
    v_add_f32 v225, v225, v229
    v_add_f32 v226, v226, v230
    v_add_f32 v227, v227, v231
    s_waitcnt lgkmcnt(0)
    v_add_f32 v232, v232, v236
    v_add_f32 v233, v233, v237
    v_add_f32 v234, v234, v238
    v_add_f32 v235, v235, v239
    v_add_f32 v224, v224, v232
    v_add_f32 v225, v225, v233
    v_add_f32 v226, v226, v234
    v_add_f32 v227, v227, v235
    v_fma_f32 v224, v224, v220, v216
    v_fma_f32 v225, v225, v220, v217
    v_fma_f32 v226, v226, v220, v218
    v_fma_f32 v227, v227, v220, v219
    v_cvt_pk_bf16_f32 v228, v224, v225
    v_cvt_pk_bf16_f32 v229, v226, v227
    buffer_store_dwordx2 v[228:229], v13, s[84:87], s56 offen
    s_mov_b32 s31, s30
    v_readfirstlane_b32 s30, v24
    s_branch .main_267
.drain_268:
    s_waitcnt vmcnt(31)
    v_mfma_f32_16x16x32_bf16 v[192:195], a[128:131], v[64:67], v[192:195]
    v_mfma_f32_16x16x32_bf16 v[196:199], a[132:135], v[64:67], v[196:199]
    s_waitcnt vmcnt(30)
    v_mfma_f32_16x16x32_bf16 v[200:203], a[128:131], v[68:71], v[200:203]
    v_mfma_f32_16x16x32_bf16 v[204:207], a[132:135], v[68:71], v[204:207]
    s_waitcnt vmcnt(29)
    v_mfma_f32_16x16x32_bf16 v[192:195], a[136:139], v[72:75], v[192:195]
    v_mfma_f32_16x16x32_bf16 v[196:199], a[140:143], v[72:75], v[196:199]
    s_waitcnt vmcnt(28)
    v_mfma_f32_16x16x32_bf16 v[200:203], a[136:139], v[76:79], v[200:203]
    v_mfma_f32_16x16x32_bf16 v[204:207], a[140:143], v[76:79], v[204:207]
    s_waitcnt vmcnt(27)
    v_mfma_f32_16x16x32_bf16 v[192:195], a[144:147], v[80:83], v[192:195]
    v_mfma_f32_16x16x32_bf16 v[196:199], a[148:151], v[80:83], v[196:199]
    s_waitcnt vmcnt(26)
    v_mfma_f32_16x16x32_bf16 v[200:203], a[144:147], v[84:87], v[200:203]
    v_mfma_f32_16x16x32_bf16 v[204:207], a[148:151], v[84:87], v[204:207]
    s_waitcnt vmcnt(25)
    v_mfma_f32_16x16x32_bf16 v[192:195], a[152:155], v[88:91], v[192:195]
    v_mfma_f32_16x16x32_bf16 v[196:199], a[156:159], v[88:91], v[196:199]
    s_waitcnt vmcnt(24)
    v_mfma_f32_16x16x32_bf16 v[200:203], a[152:155], v[92:95], v[200:203]
    v_mfma_f32_16x16x32_bf16 v[204:207], a[156:159], v[92:95], v[204:207]
    s_waitcnt vmcnt(23)
    v_mfma_f32_16x16x32_bf16 v[192:195], a[160:163], v[96:99], v[192:195]
    v_mfma_f32_16x16x32_bf16 v[196:199], a[164:167], v[96:99], v[196:199]
    s_waitcnt vmcnt(22)
    v_mfma_f32_16x16x32_bf16 v[200:203], a[160:163], v[100:103], v[200:203]
    v_mfma_f32_16x16x32_bf16 v[204:207], a[164:167], v[100:103], v[204:207]
    s_waitcnt vmcnt(21)
    v_mfma_f32_16x16x32_bf16 v[192:195], a[168:171], v[104:107], v[192:195]
    v_mfma_f32_16x16x32_bf16 v[196:199], a[172:175], v[104:107], v[196:199]
    s_waitcnt vmcnt(20)
    v_mfma_f32_16x16x32_bf16 v[200:203], a[168:171], v[108:111], v[200:203]
    v_mfma_f32_16x16x32_bf16 v[204:207], a[172:175], v[108:111], v[204:207]
    s_waitcnt vmcnt(19)
    v_mfma_f32_16x16x32_bf16 v[192:195], a[176:179], v[112:115], v[192:195]
    v_mfma_f32_16x16x32_bf16 v[196:199], a[180:183], v[112:115], v[196:199]
    s_waitcnt vmcnt(18)
    v_mfma_f32_16x16x32_bf16 v[200:203], a[176:179], v[116:119], v[200:203]
    v_mfma_f32_16x16x32_bf16 v[204:207], a[180:183], v[116:119], v[204:207]
    s_waitcnt vmcnt(17)
    v_mfma_f32_16x16x32_bf16 v[192:195], a[184:187], v[120:123], v[192:195]
    v_mfma_f32_16x16x32_bf16 v[196:199], a[188:191], v[120:123], v[196:199]
    s_waitcnt vmcnt(16)
    v_mfma_f32_16x16x32_bf16 v[200:203], a[184:187], v[124:127], v[200:203]
    v_mfma_f32_16x16x32_bf16 v[204:207], a[188:191], v[124:127], v[204:207]
    s_waitcnt vmcnt(15)
    v_mfma_f32_16x16x32_bf16 v[192:195], a[192:195], v[128:131], v[192:195]
    v_mfma_f32_16x16x32_bf16 v[196:199], a[196:199], v[128:131], v[196:199]
    s_waitcnt vmcnt(14)
    v_mfma_f32_16x16x32_bf16 v[200:203], a[192:195], v[132:135], v[200:203]
    v_mfma_f32_16x16x32_bf16 v[204:207], a[196:199], v[132:135], v[204:207]
    s_waitcnt vmcnt(13)
    v_mfma_f32_16x16x32_bf16 v[192:195], a[200:203], v[136:139], v[192:195]
    v_mfma_f32_16x16x32_bf16 v[196:199], a[204:207], v[136:139], v[196:199]
    s_waitcnt vmcnt(12)
    v_mfma_f32_16x16x32_bf16 v[200:203], a[200:203], v[140:143], v[200:203]
    v_mfma_f32_16x16x32_bf16 v[204:207], a[204:207], v[140:143], v[204:207]
    s_waitcnt vmcnt(11)
    v_mfma_f32_16x16x32_bf16 v[192:195], a[208:211], v[144:147], v[192:195]
    v_mfma_f32_16x16x32_bf16 v[196:199], a[212:215], v[144:147], v[196:199]
    s_waitcnt vmcnt(10)
    v_mfma_f32_16x16x32_bf16 v[200:203], a[208:211], v[148:151], v[200:203]
    v_mfma_f32_16x16x32_bf16 v[204:207], a[212:215], v[148:151], v[204:207]
    s_waitcnt vmcnt(9)
    v_mfma_f32_16x16x32_bf16 v[192:195], a[216:219], v[152:155], v[192:195]
    v_mfma_f32_16x16x32_bf16 v[196:199], a[220:223], v[152:155], v[196:199]
    s_waitcnt vmcnt(8)
    v_mfma_f32_16x16x32_bf16 v[200:203], a[216:219], v[156:159], v[200:203]
    v_mfma_f32_16x16x32_bf16 v[204:207], a[220:223], v[156:159], v[204:207]
    s_waitcnt vmcnt(7)
    v_mfma_f32_16x16x32_bf16 v[192:195], a[224:227], v[160:163], v[192:195]
    v_mfma_f32_16x16x32_bf16 v[196:199], a[228:231], v[160:163], v[196:199]
    s_waitcnt vmcnt(6)
    v_mfma_f32_16x16x32_bf16 v[200:203], a[224:227], v[164:167], v[200:203]
    v_mfma_f32_16x16x32_bf16 v[204:207], a[228:231], v[164:167], v[204:207]
    s_waitcnt vmcnt(5)
    v_mfma_f32_16x16x32_bf16 v[192:195], a[232:235], v[168:171], v[192:195]
    v_mfma_f32_16x16x32_bf16 v[196:199], a[236:239], v[168:171], v[196:199]
    s_waitcnt vmcnt(4)
    v_mfma_f32_16x16x32_bf16 v[200:203], a[232:235], v[172:175], v[200:203]
    v_mfma_f32_16x16x32_bf16 v[204:207], a[236:239], v[172:175], v[204:207]
    s_waitcnt vmcnt(3)
    v_mfma_f32_16x16x32_bf16 v[192:195], a[240:243], v[176:179], v[192:195]
    v_mfma_f32_16x16x32_bf16 v[196:199], a[244:247], v[176:179], v[196:199]
    s_waitcnt vmcnt(2)
    v_mfma_f32_16x16x32_bf16 v[200:203], a[240:243], v[180:183], v[200:203]
    v_mfma_f32_16x16x32_bf16 v[204:207], a[244:247], v[180:183], v[204:207]
    s_waitcnt vmcnt(1)
    v_mfma_f32_16x16x32_bf16 v[192:195], a[248:251], v[184:187], v[192:195]
    v_mfma_f32_16x16x32_bf16 v[196:199], a[252:255], v[184:187], v[196:199]
    s_waitcnt vmcnt(0)
    v_mfma_f32_16x16x32_bf16 v[200:203], a[248:251], v[188:191], v[200:203]
    v_mfma_f32_16x16x32_bf16 v[204:207], a[252:255], v[188:191], v[204:207]
    s_nop 5
    ds_write_b128 v11, v[192:195] offset:0
    ds_write_b128 v11, v[196:199] offset:1024
    ds_write_b128 v11, v[200:203] offset:2048
    ds_write_b128 v11, v[204:207] offset:3072
    s_waitcnt lgkmcnt(0)
    s_barrier
    ds_read_b32 v24, v22
    ds_read_b128 v[224:227], v12 offset:0
    ds_read_b128 v[228:231], v12 offset:4096
    ds_read_b128 v[232:235], v12 offset:8192
    ds_read_b128 v[236:239], v12 offset:12288
    v_xor_b32 v11, 0x4000, v11
    v_xor_b32 v12, 0x4000, v12
    v_xor_b32 v21, 0x4000, v21
    v_xor_b32 v22, 0x4000, v22
    s_waitcnt lgkmcnt(2)
    v_add_f32 v224, v224, v228
    v_add_f32 v225, v225, v229
    v_add_f32 v226, v226, v230
    v_add_f32 v227, v227, v231
    s_waitcnt lgkmcnt(0)
    v_add_f32 v232, v232, v236
    v_add_f32 v233, v233, v237
    v_add_f32 v234, v234, v238
    v_add_f32 v235, v235, v239
    v_add_f32 v224, v224, v232
    v_add_f32 v225, v225, v233
    v_add_f32 v226, v226, v234
    v_add_f32 v227, v227, v235
    v_fma_f32 v224, v224, v220, v216
    v_fma_f32 v225, v225, v220, v217
    v_fma_f32 v226, v226, v220, v218
    v_fma_f32 v227, v227, v220, v219
    v_cvt_pk_bf16_f32 v228, v224, v225
    v_cvt_pk_bf16_f32 v229, v226, v227
    buffer_store_dwordx2 v[228:229], v13, s[84:87], s56 offen
    s_mov_b32 s31, s30
    v_readfirstlane_b32 s30, v24
    s_cmp_lt_u32 s31, 64
    s_cbranch_scc1 .cold_266
.gx_265:
    s_endpgm
.mg_end_1:
    s_endpgm
.section .rodata,"a"
.p2align 6
.amdhsa_kernel mega_kernel
  .amdhsa_next_free_vgpr 512
  .amdhsa_next_free_sgpr 102
  .amdhsa_accum_offset 256
  .amdhsa_group_segment_fixed_size 0
  .amdhsa_kernarg_size 136
  .amdhsa_user_sgpr_count 2
  .amdhsa_user_sgpr_kernarg_segment_ptr 1
  .amdhsa_system_sgpr_workgroup_id_x 1
.end_amdhsa_kernel
```

```asm
; @launch kernel=mega_kernel grid=(256,1,1) block=(256,1,1) lds=163840
.amdgcn_target "amdgcn-amd-amdhsa--gfx950"
.text
.globl mega_kernel
.p2align 8
.type mega_kernel,@function
mega_kernel:
    s_cmp_ge_u32 s2, 256
    s_cbranch_scc1 .mg_end_1
    s_load_dwordx4 s[52:55], s[0:1], 120
    s_getreg_b32 s3, hwreg(HW_REG_XCC_ID)
    v_and_b32 v1, 63, v0
    v_lshrrev_b32 v4, 6, v0
    s_and_b32 s3, s3, 7
    v_readfirstlane_b32 s24, v4
    s_waitcnt lgkmcnt(0)
    s_mov_b32 s8, s54
    s_and_b32 s9, s55, 0xffff
    s_mov_b32 s10, 0x10000000
    s_mov_b32 s11, 0x00020000
    s_mov_b32 s20, s52
    s_and_b32 s21, s53, 0xffff
    s_mov_b32 s22, 0x100
    s_mov_b32 s23, 0x00020000
    s_mov_b32 s100, s54
    v_mov_b32 v7, 163832
    s_cmp_lg_u32 s24, 0
    s_cbranch_scc1 .noat_4
    s_mov_b64 exec, 1
    v_mov_b32 v5, 1
    s_lshl_b32 s4, s3, 3
    s_mov_b32 s6, 0x60402000
    s_mov_b32 s7, 0xe4e08480
    s_lshr_b64 s[6:7], s[6:7], s4
    s_and_b32 s4, s6, 0xff
    v_mov_b32 v6, s4
    buffer_atomic_add v5, v6, s[20:23], 0 offen sc0 sc1
    s_mov_b64 exec, -1
.noat_4:
    s_sub_u32 s101, 0, s100
    s_and_b32 s101, s101, 0x1fffff
    s_add_u32 s101, s101, 100663296
    s_lshl_b32 s4, s2, 2
    s_add_u32 s4, s4, s24
    s_lshl_b32 s5, s4, 11
    s_add_u32 s5, s5, s101
    v_lshlrev_b32 v8, 4, v1
    v_mov_b32 v20, -1
    v_mov_b32 v21, -1
    v_mov_b32 v22, -1
    v_mov_b32 v23, -1
    s_lshl_b32 s4, s4, 10
    s_add_u32 s4, s4, 83886080
    buffer_store_dwordx4 v[20:23], v8, s[8:11], s5 offen sc1
    buffer_store_dwordx4 v[20:23], v8, s[8:11], s5 offen offset:1024 sc1
    buffer_store_dwordx4 v[20:23], v8, s[8:11], s4 offen sc1
    s_cmp_eq_u32 s24, 3
    s_cselect_b32 s6, s2, -1
    s_cmp_ge_u32 s6, 68
    s_cbranch_scc1 .nf_5
    v_mov_b32 v24, 0
    v_mov_b32 v25, 0
    v_mov_b32 v26, 0
    v_mov_b32 v27, 0
    s_lshl_b32 s6, s6, 10
    s_add_u32 s6, s6, 92274688
    buffer_store_dwordx4 v[24:27], v8, s[8:11], s6 offen sc1
.nf_5:
    s_cmp_lg_u32 s24, 0
    s_cbranch_scc1 .nw_6
    s_mov_b64 exec, 1
    s_waitcnt vmcnt(3)
    ds_write_b32 v7, v5
    s_waitcnt lgkmcnt(0)
    s_mov_b64 exec, -1
.nw_6:
    s_barrier
    ds_read_b32 v5, v7
    s_mov_b32 s25, s3
    s_mov_b32 s27, 0
    s_waitcnt lgkmcnt(0)
    v_readfirstlane_b32 s26, v5
    s_cmp_ge_u32 s26, 32
    s_cselect_b32 s3, 0x10001, 1
    s_and_b32 s26, s26, 31
.mg_role_3:
    s_cmp_ge_u32 s25, 4
    s_cbranch_scc1 .mg_bg_2
    s_load_dwordx8 s[84:91], s[0:1], 64
    s_load_dwordx2 s[40:41], s[0:1], 56
    v_and_b32 v1, 63, v0
    s_lshl_b32 s4, s25, 3
    s_and_b32 s5, s26, 4
    s_or_b32 s4, s4, s5
    s_cbranch_scc1 .nocal_7
    s_cmp_lg_u32 s24, 3
    s_cbranch_scc1 .calb_8
    s_lshr_b32 s4, s26, 1
    s_and_b32 s4, s4, 12
    s_and_b32 s5, s26, 3
    s_or_b32 s4, s4, s5
    s_lshl_b32 s5, s4, 11
    s_add_u32 s5, s5, s101
    s_mov_b64 exec, 1
    v_mov_b32 v4, -1
    v_mov_b32 v5, 0
    s_mov_b32 s7, 0xffff
    s_memtime s[72:73]
    s_waitcnt lgkmcnt(0)
    buffer_store_dword v4, v5, s[8:11], s5 offen sc1
    s_waitcnt vmcnt(0)
    s_memtime s[74:75]
    s_waitcnt lgkmcnt(0)
    s_sub_u32 s74, s74, s72
    s_min_u32 s7, s7, s74
    s_memtime s[72:73]
    s_waitcnt lgkmcnt(0)
    buffer_store_dword v4, v5, s[8:11], s5 offen sc1
    s_waitcnt vmcnt(0)
    s_memtime s[74:75]
    s_waitcnt lgkmcnt(0)
    s_sub_u32 s74, s74, s72
    s_min_u32 s7, s7, s74
    s_memtime s[72:73]
    s_waitcnt lgkmcnt(0)
    buffer_store_dword v4, v5, s[8:11], s5 offen sc1
    s_waitcnt vmcnt(0)
    s_memtime s[74:75]
    s_waitcnt lgkmcnt(0)
    s_sub_u32 s74, s74, s72
    s_min_u32 s7, s7, s74
    s_lshl_b32 s5, s4, 1
    s_add_u32 s5, s5, 160
    v_mov_b32 v4, s7
    buffer_store_short v4, v5, s[20:23], s5 offen sc1
    s_mov_b64 exec, -1
.calb_8:
    s_barrier
.nocal_7:
    s_lshl_b32 s4, s25, 11
    s_lshl_b32 s5, s26, 6
    s_add_u32 s4, s4, s5
    s_lshl_b32 s6, s24, 21
    s_add_u32 s4, s4, s6
    s_lshl_b32 s7, s25, 21
    s_lshl_b32 s6, s24, 19
    s_add_u32 s7, s7, s6
    s_add_u32 s7, s7, s5
    s_lshl_b32 s6, s24, 15
    v_bfe_u32 v4, v1, 4, 1
    v_lshlrev_b32 v4, 1, v4
    v_and_b32 v5, 3, v1
    v_xor_b32 v4, v4, v5
    v_lshlrev_b32 v4, 4, v4
    v_bfe_u32 v254, v1, 2, 1
    v_mul_u32_u24 v5, 1, v254
    v_bfe_u32 v254, v1, 3, 1
    v_mul_u32_u24 v254, 8, v254
    v_add_u32 v5, v5, v254
    v_bfe_u32 v254, v1, 4, 1
    v_mul_u32_u24 v254, 4, v254
    v_add_u32 v5, v5, v254
    v_bfe_u32 v254, v1, 5, 1
    v_mul_u32_u24 v254, 2, v254
    v_add_u32 v5, v5, v254
    v_lshlrev_b32 v6, 13, v5
    v_add_u32 v6, v6, v4
    v_add_u32 v240, s4, v6
    v_lshlrev_b32 v6, 11, v5
    v_add_u32 v6, v6, v4
    v_add_u32 v241, s7, v6
    v_xor_b32 v241, 256, v241
    v_bfe_u32 v254, v1, 2, 2
    v_mul_u32_u24 v242, 64, v254
    v_bfe_u32 v254, v1, 4, 1
    v_mul_u32_u24 v254, 288, v254
    v_add_u32 v242, v242, v254
    v_bfe_u32 v254, v1, 5, 1
    v_mul_u32_u24 v254, 1024, v254
    v_add_u32 v242, v242, v254
    v_bfe_u32 v254, v1, 0, 2
    v_mul_u32_u24 v254, 8, v254
    v_add_u32 v242, v242, v254
    v_add_u32 v242, s6, v242
    v_xor_b32 v243, 32, v242
    s_waitcnt lgkmcnt(0)
    s_mov_b32 s16, s84
    s_and_b32 s17, s85, 0xffff
    s_mov_b32 s18, 0x800000
    s_mov_b32 s19, 0x00020000
    v_xor_b32 v240, 512, v240
    s_and_b32 s4, s26, 1
    s_lshl_b32 s98, s4, 11
    s_lshl_b32 s99, s4, 18
    s_add_u32 s98, s98, s6
    s_xor_b32 m0, s98, 0
    s_xor_b32 s5, s99, 0
    buffer_load_dwordx4 v240, s[16:19], s5 offen nt lds
    s_xor_b32 m0, s98, 1024
    s_xor_b32 s5, s99, 131072
    buffer_load_dwordx4 v240, s[16:19], s5 offen nt lds
    s_xor_b32 m0, s98, 2048
    s_xor_b32 s5, s99, 262144
    buffer_load_dwordx4 v240, s[16:19], s5 offen nt lds
    s_xor_b32 m0, s98, 3072
    s_xor_b32 s5, s99, 393216
    buffer_load_dwordx4 v240, s[16:19], s5 offen nt lds
    s_xor_b32 m0, s98, 4096
    s_xor_b32 s5, s99, 524288
    buffer_load_dwordx4 v240, s[16:19], s5 offen nt lds
    s_xor_b32 m0, s98, 5120
    s_xor_b32 s5, s99, 655360
    buffer_load_dwordx4 v240, s[16:19], s5 offen nt lds
    s_xor_b32 m0, s98, 6144
    s_xor_b32 s5, s99, 786432
    buffer_load_dwordx4 v240, s[16:19], s5 offen nt lds
    s_xor_b32 m0, s98, 7168
    s_xor_b32 s5, s99, 917504
    buffer_load_dwordx4 v240, s[16:19], s5 offen nt lds
    s_xor_b32 m0, s98, 8192
    s_xor_b32 s5, s99, 1048576
    buffer_load_dwordx4 v240, s[16:19], s5 offen nt lds
    s_xor_b32 m0, s98, 9216
    s_xor_b32 s5, s99, 1179648
    buffer_load_dwordx4 v240, s[16:19], s5 offen nt lds
    s_xor_b32 m0, s98, 10240
    s_xor_b32 s5, s99, 1310720
    buffer_load_dwordx4 v240, s[16:19], s5 offen nt lds
    s_xor_b32 m0, s98, 11264
    s_xor_b32 s5, s99, 1441792
    buffer_load_dwordx4 v240, s[16:19], s5 offen nt lds
    s_xor_b32 m0, s98, 12288
    s_xor_b32 s5, s99, 1572864
    buffer_load_dwordx4 v240, s[16:19], s5 offen nt lds
    s_xor_b32 m0, s98, 13312
    s_xor_b32 s5, s99, 1703936
    buffer_load_dwordx4 v240, s[16:19], s5 offen nt lds
    s_xor_b32 m0, s98, 14336
    s_xor_b32 s5, s99, 1835008
    buffer_load_dwordx4 v240, s[16:19], s5 offen nt lds
    s_xor_b32 m0, s98, 15360
    s_xor_b32 s5, s99, 1966080
    buffer_load_dwordx4 v240, s[16:19], s5 offen nt lds
    s_waitcnt vmcnt(16)
    s_barrier
    s_cmp_lg_u32 s24, 1
    s_cbranch_scc1 .ns_9
    s_mov_b64 exec, 1
    v_mov_b32 v238, s3
    v_mov_b32 v239, 0
    buffer_atomic_add v238, v239, s[20:23], 0 offen offset:196 sc1
    s_mov_b64 exec, -1
.ns_9:
    s_mov_b32 s16, s86
    s_and_b32 s17, s87, 0xffff
    s_mov_b32 s18, 0x800000
    s_mov_b32 s19, 0x00020000
    v_xor_b32 v240, 640, v240
    s_and_b32 s4, s26, 1
    s_lshl_b32 s98, s4, 11
    s_lshl_b32 s99, s4, 18
    s_add_u32 s98, s98, s6
    s_xor_b32 m0, s98, 16384
    s_xor_b32 s5, s99, 0
    buffer_load_dwordx4 v240, s[16:19], s5 offen nt lds
    s_xor_b32 m0, s98, 17408
    s_xor_b32 s5, s99, 131072
    buffer_load_dwordx4 v240, s[16:19], s5 offen nt lds
    s_xor_b32 m0, s98, 18432
    s_xor_b32 s5, s99, 262144
    buffer_load_dwordx4 v240, s[16:19], s5 offen nt lds
    s_xor_b32 m0, s98, 19456
    s_xor_b32 s5, s99, 393216
    buffer_load_dwordx4 v240, s[16:19], s5 offen nt lds
    s_xor_b32 m0, s98, 20480
    s_xor_b32 s5, s99, 524288
    buffer_load_dwordx4 v240, s[16:19], s5 offen nt lds
    s_xor_b32 m0, s98, 21504
    s_xor_b32 s5, s99, 655360
    buffer_load_dwordx4 v240, s[16:19], s5 offen nt lds
    s_xor_b32 m0, s98, 22528
    s_xor_b32 s5, s99, 786432
    buffer_load_dwordx4 v240, s[16:19], s5 offen nt lds
    s_xor_b32 m0, s98, 23552
    s_xor_b32 s5, s99, 917504
    buffer_load_dwordx4 v240, s[16:19], s5 offen nt lds
    s_xor_b32 m0, s98, 24576
    s_xor_b32 s5, s99, 1048576
    buffer_load_dwordx4 v240, s[16:19], s5 offen nt lds
    s_xor_b32 m0, s98, 25600
    s_xor_b32 s5, s99, 1179648
    buffer_load_dwordx4 v240, s[16:19], s5 offen nt lds
    s_xor_b32 m0, s98, 26624
    s_xor_b32 s5, s99, 1310720
    buffer_load_dwordx4 v240, s[16:19], s5 offen nt lds
    s_xor_b32 m0, s98, 27648
    s_xor_b32 s5, s99, 1441792
    buffer_load_dwordx4 v240, s[16:19], s5 offen nt lds
    s_xor_b32 m0, s98, 28672
    s_xor_b32 s5, s99, 1572864
    buffer_load_dwordx4 v240, s[16:19], s5 offen nt lds
    s_xor_b32 m0, s98, 29696
    s_xor_b32 s5, s99, 1703936
    buffer_load_dwordx4 v240, s[16:19], s5 offen nt lds
    s_xor_b32 m0, s98, 30720
    s_xor_b32 s5, s99, 1835008
    buffer_load_dwordx4 v240, s[16:19], s5 offen nt lds
    s_xor_b32 m0, s98, 31744
    s_xor_b32 s5, s99, 1966080
    buffer_load_dwordx4 v240, s[16:19], s5 offen nt lds
    s_lshr_b32 s52, s26, 2
    s_and_b32 s53, s26, 3
    s_lshl_b32 s54, s25, 14
    s_lshl_b32 s55, s26, 9
    s_add_u32 s55, s55, s54
    s_lshl_b32 s56, s25, 3
    s_add_u32 s56, s56, s52
    s_lshl_b32 s57, s56, 12
    s_lshl_b32 s58, s53, 9
    s_add_u32 s58, s58, s57
    s_mov_b32 s48, 0x00ff00ff
    s_mov_b32 s49, 0x00ff00ff
    s_mov_b32 s50, 0xff00ff00
    s_mov_b32 s51, 0xff00ff00
    v_mov_b32 v2, 0x4444
    v_mov_b32 v4, 0xeeee
    s_lshl_b32 s4, s24, 12
    s_add_u32 s4, s4, s54
    v_cndmask_b32 v2, v4, v2, s[48:49]
    v_bfe_u32 v254, v1, 0, 6
    v_mul_u32_u24 v3, 16, v254
    v_add_u32 v3, s4, v3
    v_add_u32 v4, 0x10000, v3
    s_mul_i32 s4, s24, 1152
    v_bfe_u32 v254, v1, 4, 1
    v_mul_u32_u24 v5, 576, v254
    v_bfe_u32 v254, v1, 5, 1
    v_mul_u32_u24 v254, 64, v254
    v_add_u32 v5, v5, v254
    v_bfe_u32 v254, v1, 0, 4
    v_mul_u32_u24 v254, 4, v254
    v_add_u32 v5, v5, v254
    v_add_u32 v5, s4, v5
    v_add_u32 v6, 4608, v5
    v_add_u32 v7, 9216, v5
    s_lshl_b32 s4, s24, 10
    v_bfe_u32 v254, v1, 0, 6
    v_mul_u32_u24 v8, 16, v254
    v_add_u32 v8, 13824, v8
    v_add_u32 v8, s4, v8
    s_and_b32 s4, s24, 1
    s_lshr_b32 s5, s24, 1
    s_lshl_b32 s59, s4, 6
    s_mul_i32 s60, s5, 4608
    s_add_u32 s59, s59, s60
    s_lshl_b32 s4, s4, 8
    s_add_u32 s60, s58, s4
    s_lshl_b32 s5, s5, 11
    s_add_u32 s61, s60, s5
    s_cmp_lt_u32 s24, 2
    s_cselect_b32 s5, 8, 1
    s_lshl_b32 s5, s5, 10
    s_xor_b32 s61, s61, s5
    v_bfe_u32 v254, v1, 2, 3
    v_mul_u32_u24 v9, 144, v254
    v_bfe_u32 v254, v1, 5, 1
    v_mul_u32_u24 v254, 32, v254
    v_add_u32 v9, v9, v254
    v_bfe_u32 v254, v1, 0, 2
    v_mul_u32_u24 v254, 8, v254
    v_add_u32 v9, v9, v254
    v_add_u32 v9, s59, v9
    v_bfe_u32 v254, v1, 0, 6
    v_mul_u32_u24 v10, 4, v254
    v_add_u32 v10, 131072, v10
    v_add_u32 v10, s61, v10
    v_bfe_u32 v254, v1, 0, 6
    v_mul_u32_u24 v11, 4, v254
    v_add_u32 v11, 17920, v11
    v_add_u32 v11, s4, v11
    v_mov_b32 v20, -1
    v_mov_b32 v21, -1
    v_mov_b32 v22, -1
    v_mov_b32 v23, -1
    v_mov_b32 v40, 0
    v_mov_b32 v41, 0
    v_mov_b32 v42, 0
    v_mov_b32 v43, 0
    v_mov_b32 v44, 0
    v_mov_b32 v45, 0
    v_mov_b32 v46, 0
    v_mov_b32 v47, 0
    v_mov_b32 v48, 0
    v_mov_b32 v49, 0
    v_mov_b32 v50, 0
    v_mov_b32 v51, 0
    v_mov_b32 v52, 0
    v_mov_b32 v53, 0
    v_mov_b32 v54, 0
    v_mov_b32 v55, 0
    v_mov_b32 v56, 0
    v_mov_b32 v57, 0
    v_mov_b32 v58, 0
    v_mov_b32 v59, 0
    v_mov_b32 v60, 0
    v_mov_b32 v61, 0
    v_mov_b32 v62, 0
    v_mov_b32 v63, 0
    v_mov_b32 v64, 0
    v_mov_b32 v65, 0
    v_mov_b32 v66, 0
    v_mov_b32 v67, 0
    v_mov_b32 v68, 0
    v_mov_b32 v69, 0
    v_mov_b32 v70, 0
    v_mov_b32 v71, 0
    v_bfe_u32 v254, v1, 0, 5
    v_mul_u32_u24 v244, 16, v254
    v_bfe_u32 v254, v1, 5, 1
    v_mul_u32_u24 v254, 2048, v254
    v_add_u32 v244, v244, v254
    v_add_u32 v244, 131072, v244
    v_add_u32 v244, s58, v244
    v_bfe_u32 v254, v1, 0, 5
    v_mul_u32_u24 v245, 16, v254
    v_bfe_u32 v254, v1, 5, 1
    v_mul_u32_u24 v254, 65536, v254
    v_add_u32 v245, v245, v254
    v_add_u32 v245, s55, v245
    v_mov_b32 v246, v244
    s_waitcnt vmcnt(16)
    ds_read_b64_tr_b16 a[0:1], v242 offset:0
    ds_read_b64_tr_b16 a[2:3], v242 offset:512
    ds_read_b64_tr_b16 a[4:5], v242 offset:2048
    ds_read_b64_tr_b16 a[6:7], v242 offset:2560
    ds_read_b64_tr_b16 a[8:9], v242 offset:4096
    ds_read_b64_tr_b16 a[10:11], v242 offset:4608
    ds_read_b64_tr_b16 a[12:13], v242 offset:6144
    ds_read_b64_tr_b16 a[14:15], v242 offset:6656
    ds_read_b64_tr_b16 a[16:17], v242 offset:8192
    ds_read_b64_tr_b16 a[18:19], v242 offset:8704
    ds_read_b64_tr_b16 a[20:21], v242 offset:10240
    ds_read_b64_tr_b16 a[22:23], v242 offset:10752
    ds_read_b64_tr_b16 a[24:25], v242 offset:12288
    ds_read_b64_tr_b16 a[26:27], v242 offset:12800
    ds_read_b64_tr_b16 a[28:29], v242 offset:14336
    ds_read_b64_tr_b16 a[30:31], v242 offset:14848
    ds_read_b64_tr_b16 a[32:33], v243 offset:0
    ds_read_b64_tr_b16 a[34:35], v243 offset:512
    ds_read_b64_tr_b16 a[36:37], v243 offset:2048
    ds_read_b64_tr_b16 a[38:39], v243 offset:2560
    ds_read_b64_tr_b16 a[40:41], v243 offset:4096
    ds_read_b64_tr_b16 a[42:43], v243 offset:4608
    ds_read_b64_tr_b16 a[44:45], v243 offset:6144
    ds_read_b64_tr_b16 a[46:47], v243 offset:6656
    ds_read_b64_tr_b16 a[48:49], v243 offset:8192
    ds_read_b64_tr_b16 a[50:51], v243 offset:8704
    ds_read_b64_tr_b16 a[52:53], v243 offset:10240
    ds_read_b64_tr_b16 a[54:55], v243 offset:10752
    ds_read_b64_tr_b16 a[56:57], v243 offset:12288
    ds_read_b64_tr_b16 a[58:59], v243 offset:12800
    ds_read_b64_tr_b16 a[60:61], v243 offset:14336
    ds_read_b64_tr_b16 a[62:63], v243 offset:14848
    s_waitcnt lgkmcnt(0)
    s_mov_b32 s16, s88
    s_and_b32 s17, s89, 0xffff
    s_mov_b32 s18, 0x800000
    s_mov_b32 s19, 0x00020000
    v_xor_b32 v240, 128, v240
    s_and_b32 s4, s26, 1
    s_lshl_b32 s98, s4, 11
    s_lshl_b32 s99, s4, 18
    s_add_u32 s98, s98, s6
    s_xor_b32 m0, s98, 0
    s_xor_b32 s5, s99, 0
    buffer_load_dwordx4 v240, s[16:19], s5 offen nt lds
    s_xor_b32 m0, s98, 1024
    s_xor_b32 s5, s99, 131072
    buffer_load_dwordx4 v240, s[16:19], s5 offen nt lds
    s_xor_b32 m0, s98, 2048
    s_xor_b32 s5, s99, 262144
    buffer_load_dwordx4 v240, s[16:19], s5 offen nt lds
    s_xor_b32 m0, s98, 3072
    s_xor_b32 s5, s99, 393216
    buffer_load_dwordx4 v240, s[16:19], s5 offen nt lds
    s_xor_b32 m0, s98, 4096
    s_xor_b32 s5, s99, 524288
    buffer_load_dwordx4 v240, s[16:19], s5 offen nt lds
    s_xor_b32 m0, s98, 5120
    s_xor_b32 s5, s99, 655360
    buffer_load_dwordx4 v240, s[16:19], s5 offen nt lds
    s_xor_b32 m0, s98, 6144
    s_xor_b32 s5, s99, 786432
    buffer_load_dwordx4 v240, s[16:19], s5 offen nt lds
    s_xor_b32 m0, s98, 7168
    s_xor_b32 s5, s99, 917504
    buffer_load_dwordx4 v240, s[16:19], s5 offen nt lds
    s_xor_b32 m0, s98, 8192
    s_xor_b32 s5, s99, 1048576
    buffer_load_dwordx4 v240, s[16:19], s5 offen nt lds
    s_xor_b32 m0, s98, 9216
    s_xor_b32 s5, s99, 1179648
    buffer_load_dwordx4 v240, s[16:19], s5 offen nt lds
    s_xor_b32 m0, s98, 10240
    s_xor_b32 s5, s99, 1310720
    buffer_load_dwordx4 v240, s[16:19], s5 offen nt lds
    s_xor_b32 m0, s98, 11264
    s_xor_b32 s5, s99, 1441792
    buffer_load_dwordx4 v240, s[16:19], s5 offen nt lds
    s_xor_b32 m0, s98, 12288
    s_xor_b32 s5, s99, 1572864
    buffer_load_dwordx4 v240, s[16:19], s5 offen nt lds
    s_xor_b32 m0, s98, 13312
    s_xor_b32 s5, s99, 1703936
    buffer_load_dwordx4 v240, s[16:19], s5 offen nt lds
    s_xor_b32 m0, s98, 14336
    s_xor_b32 s5, s99, 1835008
    buffer_load_dwordx4 v240, s[16:19], s5 offen nt lds
    s_xor_b32 m0, s98, 15360
    s_xor_b32 s5, s99, 1966080
    buffer_load_dwordx4 v240, s[16:19], s5 offen nt lds
    s_waitcnt vmcnt(16)
    ds_read_b64_tr_b16 a[64:65], v242 offset:16384
    ds_read_b64_tr_b16 a[66:67], v242 offset:16896
    ds_read_b64_tr_b16 a[68:69], v242 offset:18432
    ds_read_b64_tr_b16 a[70:71], v242 offset:18944
    ds_read_b64_tr_b16 a[72:73], v242 offset:20480
    ds_read_b64_tr_b16 a[74:75], v242 offset:20992
    ds_read_b64_tr_b16 a[76:77], v242 offset:22528
    ds_read_b64_tr_b16 a[78:79], v242 offset:23040
    ds_read_b64_tr_b16 a[80:81], v242 offset:24576
    ds_read_b64_tr_b16 a[82:83], v242 offset:25088
    ds_read_b64_tr_b16 a[84:85], v242 offset:26624
    ds_read_b64_tr_b16 a[86:87], v242 offset:27136
    ds_read_b64_tr_b16 a[88:89], v242 offset:28672
    ds_read_b64_tr_b16 a[90:91], v242 offset:29184
    ds_read_b64_tr_b16 a[92:93], v242 offset:30720
    ds_read_b64_tr_b16 a[94:95], v242 offset:31232
    ds_read_b64_tr_b16 a[96:97], v243 offset:16384
    ds_read_b64_tr_b16 a[98:99], v243 offset:16896
    ds_read_b64_tr_b16 a[100:101], v243 offset:18432
    ds_read_b64_tr_b16 a[102:103], v243 offset:18944
    ds_read_b64_tr_b16 a[104:105], v243 offset:20480
    ds_read_b64_tr_b16 a[106:107], v243 offset:20992
    ds_read_b64_tr_b16 a[108:109], v243 offset:22528
    ds_read_b64_tr_b16 a[110:111], v243 offset:23040
    ds_read_b64_tr_b16 a[112:113], v243 offset:24576
    ds_read_b64_tr_b16 a[114:115], v243 offset:25088
    ds_read_b64_tr_b16 a[116:117], v243 offset:26624
    ds_read_b64_tr_b16 a[118:119], v243 offset:27136
    ds_read_b64_tr_b16 a[120:121], v243 offset:28672
    ds_read_b64_tr_b16 a[122:123], v243 offset:29184
    ds_read_b64_tr_b16 a[124:125], v243 offset:30720
    ds_read_b64_tr_b16 a[126:127], v243 offset:31232
    s_waitcnt lgkmcnt(0)
    v_or_b32 v239, 32, v1
    v_lshlrev_b32 v239, 2, v239
    buffer_load_dword v238, v239, s[20:23], 0 offen sc1
    s_mov_b32 s12, s40
    s_and_b32 s13, s41, 0xffff
    s_mov_b32 s14, 0x4000
    s_mov_b32 s15, 0x00020000
    s_xor_b32 s4, s26, 4
    s_lshl_b32 s4, s4, 6
    v_bfe_u32 v254, v1, 1, 3
    v_mul_u32_u24 v247, 2048, v254
    v_bfe_u32 v254, v1, 4, 2
    v_mul_u32_u24 v254, 16, v254
    v_add_u32 v247, v247, v254
    v_bfe_u32 v254, v1, 0, 1
    v_mul_u32_u24 v254, 8, v254
    v_add_u32 v247, v247, v254
    buffer_load_dwordx2 v[248:249], v247, s[12:15], s4 offen
    s_mov_b32 s16, s90
    s_and_b32 s17, s91, 0xffff
    s_mov_b32 s18, 0x800000
    s_mov_b32 s19, 0x00020000
    s_and_b32 s4, s26, 1
    s_lshl_b32 s98, s4, 11
    s_lshl_b32 s99, s4, 16
    s_add_u32 s98, s98, s6
    s_xor_b32 m0, s98, 16384
    s_xor_b32 s5, s99, 0
    buffer_load_dwordx4 v241, s[16:19], s5 offen nt lds
    s_xor_b32 m0, s98, 17408
    s_xor_b32 s5, s99, 32768
    buffer_load_dwordx4 v241, s[16:19], s5 offen nt lds
    s_xor_b32 m0, s98, 18432
    s_xor_b32 s5, s99, 65536
    buffer_load_dwordx4 v241, s[16:19], s5 offen nt lds
    s_xor_b32 m0, s98, 19456
    s_xor_b32 s5, s99, 98304
    buffer_load_dwordx4 v241, s[16:19], s5 offen nt lds
    s_xor_b32 m0, s98, 20480
    s_xor_b32 s5, s99, 131072
    buffer_load_dwordx4 v241, s[16:19], s5 offen nt lds
    s_xor_b32 m0, s98, 21504
    s_xor_b32 s5, s99, 163840
    buffer_load_dwordx4 v241, s[16:19], s5 offen nt lds
    s_xor_b32 m0, s98, 22528
    s_xor_b32 s5, s99, 196608
    buffer_load_dwordx4 v241, s[16:19], s5 offen nt lds
    s_xor_b32 m0, s98, 23552
    s_xor_b32 s5, s99, 229376
    buffer_load_dwordx4 v241, s[16:19], s5 offen nt lds
    s_xor_b32 m0, s98, 24576
    s_xor_b32 s5, s99, 262144
    buffer_load_dwordx4 v241, s[16:19], s5 offen nt lds
    s_xor_b32 m0, s98, 25600
    s_xor_b32 s5, s99, 294912
    buffer_load_dwordx4 v241, s[16:19], s5 offen nt lds
    s_xor_b32 m0, s98, 26624
    s_xor_b32 s5, s99, 327680
    buffer_load_dwordx4 v241, s[16:19], s5 offen nt lds
    s_xor_b32 m0, s98, 27648
    s_xor_b32 s5, s99, 360448
    buffer_load_dwordx4 v241, s[16:19], s5 offen nt lds
    s_xor_b32 m0, s98, 28672
    s_xor_b32 s5, s99, 393216
    buffer_load_dwordx4 v241, s[16:19], s5 offen nt lds
    s_xor_b32 m0, s98, 29696
    s_xor_b32 s5, s99, 425984
    buffer_load_dwordx4 v241, s[16:19], s5 offen nt lds
    s_xor_b32 m0, s98, 30720
    s_xor_b32 s5, s99, 458752
    buffer_load_dwordx4 v241, s[16:19], s5 offen nt lds
    s_xor_b32 m0, s98, 31744
    s_xor_b32 s5, s99, 491520
    buffer_load_dwordx4 v241, s[16:19], s5 offen nt lds
    s_waitcnt vmcnt(16)
    s_cmp_lg_u32 s27, 0
    s_cbranch_scc1 .vd_11
    s_mov_b32 s62, 0
.vp_10:
    v_readlane_b32 s4, v238, 49
    s_and_b32 s5, s4, 0xffff
    s_cmp_ge_u32 s5, 256
    s_cbranch_scc1 .va_12
    s_add_u32 s62, s62, 1
    s_cmp_gt_u32 s62, 0x100000
    s_cbranch_scc1 .mg_end_1
    s_sleep 16
    buffer_load_dword v238, v239, s[20:23], 0 offen sc1
    s_waitcnt vmcnt(0)
    s_branch .vp_10
.va_12:
    s_lshr_b32 s4, s4, 16
    s_cbranch_scc0 .vd_11
    s_lshr_b32 s25, s2, 5
    s_and_b32 s26, s2, 31
    s_mov_b32 s27, 1
    s_waitcnt vmcnt(0) lgkmcnt(0)
    s_barrier
    s_branch .mg_role_3
.vd_11:
    ds_read_b64_tr_b16 a[128:129], v242 offset:0
    ds_read_b64_tr_b16 a[130:131], v242 offset:512
    ds_read_b64_tr_b16 a[132:133], v242 offset:2048
    ds_read_b64_tr_b16 a[134:135], v242 offset:2560
    ds_read_b64_tr_b16 a[136:137], v242 offset:4096
    ds_read_b64_tr_b16 a[138:139], v242 offset:4608
    ds_read_b64_tr_b16 a[140:141], v242 offset:6144
    ds_read_b64_tr_b16 a[142:143], v242 offset:6656
    ds_read_b64_tr_b16 a[144:145], v242 offset:8192
    ds_read_b64_tr_b16 a[146:147], v242 offset:8704
    ds_read_b64_tr_b16 a[148:149], v242 offset:10240
    ds_read_b64_tr_b16 a[150:151], v242 offset:10752
    ds_read_b64_tr_b16 a[152:153], v242 offset:12288
    ds_read_b64_tr_b16 a[154:155], v242 offset:12800
    ds_read_b64_tr_b16 a[156:157], v242 offset:14336
    ds_read_b64_tr_b16 a[158:159], v242 offset:14848
    ds_read_b64_tr_b16 a[160:161], v243 offset:0
    ds_read_b64_tr_b16 a[162:163], v243 offset:512
    ds_read_b64_tr_b16 a[164:165], v243 offset:2048
    ds_read_b64_tr_b16 a[166:167], v243 offset:2560
    ds_read_b64_tr_b16 a[168:169], v243 offset:4096
    ds_read_b64_tr_b16 a[170:171], v243 offset:4608
    ds_read_b64_tr_b16 a[172:173], v243 offset:6144
    ds_read_b64_tr_b16 a[174:175], v243 offset:6656
    ds_read_b64_tr_b16 a[176:177], v243 offset:8192
    ds_read_b64_tr_b16 a[178:179], v243 offset:8704
    ds_read_b64_tr_b16 a[180:181], v243 offset:10240
    ds_read_b64_tr_b16 a[182:183], v243 offset:10752
    ds_read_b64_tr_b16 a[184:185], v243 offset:12288
    ds_read_b64_tr_b16 a[186:187], v243 offset:12800
    ds_read_b64_tr_b16 a[188:189], v243 offset:14336
    ds_read_b64_tr_b16 a[190:191], v243 offset:14848
    s_waitcnt lgkmcnt(0)
    s_mov_b32 s47, 0
    s_cmp_lg_u32 s27, 0
    s_cbranch_scc1 .cd_14
    s_mov_b32 s62, 0
.cp_13:
    v_and_b32 v18, 0xffff, v238
    v_lshrrev_b32 v19, 16, v238
    v_min_u32 v17, v18, v19
    v_cmp_eq_u32 vcc, 0, v17
    s_and_b32 s4, vcc_hi, 65280
    s_cbranch_scc0 .cg_15
    s_add_u32 s62, s62, 1
    s_cmp_gt_u32 s62, 0x100000
    s_cbranch_scc1 .mg_end_1
    s_sleep 16
    buffer_load_dword v238, v239, s[20:23], 0 offen sc1
    s_waitcnt vmcnt(0)
    s_branch .cp_13
.cg_15:
    v_readlane_b32 s66, v18, 40
    v_readlane_b32 s67, v19, 40
    v_readlane_b32 s68, v18, 41
    v_readlane_b32 s69, v19, 41
    v_readlane_b32 s70, v18, 42
    v_readlane_b32 s71, v19, 42
    v_readlane_b32 s72, v18, 43
    v_readlane_b32 s73, v19, 43
    v_readlane_b32 s74, v18, 44
    v_readlane_b32 s75, v19, 44
    v_readlane_b32 s76, v18, 45
    v_readlane_b32 s77, v19, 45
    v_readlane_b32 s78, v18, 46
    v_readlane_b32 s79, v19, 46
    v_readlane_b32 s80, v18, 47
    v_readlane_b32 s81, v19, 47
    s_nop 3
    s_add_u32 s4, s66, s67
    s_add_u32 s4, s4, s68
    s_add_u32 s4, s4, s69
    s_add_u32 s4, s4, s74
    s_add_u32 s4, s4, s75
    s_add_u32 s4, s4, s76
    s_add_u32 s4, s4, s77
    s_add_u32 s5, s70, s71
    s_add_u32 s5, s5, s72
    s_add_u32 s5, s5, s73
    s_add_u32 s5, s5, s78
    s_add_u32 s5, s5, s79
    s_add_u32 s5, s5, s80
    s_add_u32 s5, s5, s81
    s_cmp_lt_u32 s5, s4
    s_cselect_b32 s47, 0x2000, 0
    s_cselect_b32 s66, s70, s66
    s_cselect_b32 s67, s71, s67
    s_cselect_b32 s68, s72, s68
    s_cselect_b32 s69, s73, s69
    s_cselect_b32 s74, s78, s74
    s_cselect_b32 s75, s79, s75
    s_cselect_b32 s76, s80, s76
    s_cselect_b32 s77, s81, s77
    s_add_u32 s4, s66, s68
    s_add_u32 s4, s4, s74
    s_add_u32 s4, s4, s76
    s_add_u32 s5, s67, s69
    s_add_u32 s5, s5, s75
    s_add_u32 s5, s5, s77
    s_cmp_lt_u32 s5, s4
    s_cselect_b32 s4, 2048, 0
    s_or_b32 s47, s47, s4
    s_add_u32 s4, s66, s67
    s_add_u32 s4, s4, s74
    s_add_u32 s4, s4, s75
    s_add_u32 s5, s68, s69
    s_add_u32 s5, s5, s76
    s_add_u32 s5, s5, s77
    s_cmp_lt_u32 s5, s4
    s_cselect_b32 s4, 4096, 0
    s_or_b32 s47, s47, s4
    s_add_u32 s4, s66, s67
    s_add_u32 s4, s4, s68
    s_add_u32 s4, s4, s69
    s_add_u32 s5, s74, s75
    s_add_u32 s5, s5, s76
    s_add_u32 s5, s5, s77
    s_cmp_lt_u32 s5, s4
    s_cselect_b32 s4, 16384, 0
    s_or_b32 s47, s47, s4
.cd_14:
    s_cmp_lg_u32 s27, 0
    s_cbranch_scc1 .slowv_16
    s_mov_b32 s28, 0
    s_mov_b32 s30, 83886080
    s_mov_b32 s31, 84148224
    s_mov_b32 s32, 84410368
    s_mov_b32 s33, 84672512
    s_mov_b32 s41, 66977792
    s_lshl_b32 s42, s56, 13
    s_lshl_b32 s4, s53, 11
    s_add_u32 s44, s42, s4
    s_add_u32 s44, s44, 33554432
    s_add_u32 s42, s42, 16777216
    s_add_u32 s43, s42, 4096
    s_add_u32 s96, s44, 524288
    s_sub_u32 s95, s96, 16777216
    s_mov_b32 s62, 0
    s_mov_b32 s45, 0x3e0293ee
    s_mov_b32 s46, 0
    s_and_b32 s4, s25, 1
    s_lshl_b32 s4, s4, 14
    s_lshr_b32 s5, s25, 1
    s_lshl_b32 s5, s5, 12
    s_or_b32 s4, s4, s5
    s_xor_b32 s47, s47, s4
    s_and_b32 s5, s26, 1
    s_lshl_b32 s5, s5, 10
    s_lshr_b32 s4, s26, 1
    s_lshl_b32 s4, s4, 15
    s_or_b32 s5, s5, s4
    s_bfe_u32 s4, s26, 0x10004
    s_lshl_b32 s4, s4, 11
    s_xor_b32 s5, s5, s4
    s_xor_b32 s34, s5, s47
    s_xor_b32 s35, s34, 0x84000
    s_xor_b32 s36, s34, 0x101000
    s_xor_b32 s37, s34, 0x185000
    s_cmp_eq_u32 s24, 1
    s_cbranch_scc1 .w1_18
    s_cmp_eq_u32 s24, 2
    s_cbranch_scc1 .w2_19
    s_cmp_eq_u32 s24, 3
    s_cbranch_scc1 .w3_20
.w0_17:
    v_bfe_u32 v254, v1, 4, 2
    v_mul_u32_u24 v12, 128, v254
    v_bfe_u32 v254, v1, 0, 3
    v_mul_u32_u24 v254, 16, v254
    v_add_u32 v12, v12, v254
    v_add_u32 v12, 131072, v12
    v_add_u32 v12, s57, v12
    v_bfe_u32 v254, v1, 4, 2
    v_mul_u32_u24 v13, 128, v254
    v_bfe_u32 v254, v1, 2, 2
    v_mul_u32_u24 v254, 32, v254
    v_add_u32 v13, v13, v254
    v_bfe_u32 v254, v1, 0, 1
    v_mul_u32_u24 v254, 16, v254
    v_add_u32 v13, v13, v254
    v_add_u32 v13, 133120, v13
    v_add_u32 v13, s57, v13
    v_bfe_u32 v254, v1, 4, 2
    v_mul_u32_u24 v14, 128, v254
    v_bfe_u32 v254, v1, 0, 4
    v_mul_u32_u24 v254, 16, v254
    v_add_u32 v14, v14, v254
    v_add_u32 v14, 65536, v14
    v_add_u32 v14, s55, v14
    v_bfe_u32 v254, v1, 0, 6
    v_mul_u32_u24 v15, 16, v254
    v_bfe_u32 v254, v1, 2, 2
    v_mul_u32_u24 v16, 128, v254
    v_bfe_u32 v254, v1, 0, 2
    v_mul_u32_u24 v254, 16, v254
    v_add_u32 v16, v16, v254
    v_bfe_u32 v254, v1, 4, 2
    v_mul_u32_u24 v254, 4, v254
    v_add_u32 v16, v16, v254
    v_add_u32 v16, 18432, v16
    v_mov_b32 v144, 0
    v_mov_b32 v145, 0
    v_mov_b32 v146, 0
    v_mov_b32 v147, 0
    v_mov_b32 v148, 0
    v_mov_b32 v149, 0
    v_mov_b32 v150, 0
    v_mov_b32 v151, 0
    v_mov_b32 v152, 0
    v_mov_b32 v153, 0
    v_mov_b32 v154, 0
    v_mov_b32 v155, 0
    v_mov_b32 v156, 0
    v_mov_b32 v157, 0
    v_mov_b32 v158, 0
    v_mov_b32 v159, 0
    v_mov_b32 v160, 0
    v_mov_b32 v161, 0
    v_mov_b32 v162, 0
    v_mov_b32 v163, 0
    v_mov_b32 v164, 0
    v_mov_b32 v165, 0
    v_mov_b32 v166, 0
    v_mov_b32 v167, 0
    v_mov_b32 v168, 0
    v_mov_b32 v169, 0
    v_mov_b32 v170, 0
    v_mov_b32 v171, 0
    v_mov_b32 v172, 0
    v_mov_b32 v173, 0
    v_mov_b32 v174, 0
    v_mov_b32 v175, 0
    v_mov_b32 v208, 0
    v_mov_b32 v209, 0
    v_mov_b32 v210, 0
    v_mov_b32 v211, 0
    v_mov_b32 v212, 0
    v_mov_b32 v213, 0
    v_mov_b32 v214, 0
    v_mov_b32 v215, 0
    v_mov_b32 v216, 0
    v_mov_b32 v217, 0
    v_mov_b32 v218, 0
    v_mov_b32 v219, 0
    v_mov_b32 v18, 0xff800000
    v_mov_b32 v200, s45
    v_mov_b32 v220, 0x3f803f80
    v_mov_b32 v201, s45
    v_mov_b32 v221, 0x3f803f80
    v_mov_b32 v202, s45
    v_mov_b32 v222, 0x3f803f80
    v_mov_b32 v203, s45
    v_mov_b32 v223, 0x3f803f80
    buffer_load_dwordx4 v[24:27], v246, s[8:11], s30 offen sc1
    buffer_load_dwordx4 v[28:31], v245, s[8:11], s30 offen sc1
    s_waitcnt vmcnt(0)
    ds_read_b64_tr_b16 a[192:193], v242 offset:16384
    ds_read_b64_tr_b16 a[194:195], v242 offset:16896
    ds_read_b64_tr_b16 a[196:197], v242 offset:18432
    ds_read_b64_tr_b16 a[198:199], v242 offset:18944
    ds_read_b64_tr_b16 a[200:201], v242 offset:20480
    ds_read_b64_tr_b16 a[202:203], v242 offset:20992
    ds_read_b64_tr_b16 a[204:205], v242 offset:22528
    ds_read_b64_tr_b16 a[206:207], v242 offset:23040
    ds_read_b64_tr_b16 a[208:209], v242 offset:24576
    ds_read_b64_tr_b16 a[210:211], v242 offset:25088
    ds_read_b64_tr_b16 a[212:213], v242 offset:26624
    ds_read_b64_tr_b16 a[214:215], v242 offset:27136
    ds_read_b64_tr_b16 a[216:217], v242 offset:28672
    ds_read_b64_tr_b16 a[218:219], v242 offset:29184
    ds_read_b64_tr_b16 a[220:221], v242 offset:30720
    ds_read_b64_tr_b16 a[222:223], v242 offset:31232
    ds_read_b64_tr_b16 a[224:225], v243 offset:16384
    ds_read_b64_tr_b16 a[226:227], v243 offset:16896
    ds_read_b64_tr_b16 a[228:229], v243 offset:18432
    ds_read_b64_tr_b16 a[230:231], v243 offset:18944
    ds_read_b64_tr_b16 a[232:233], v243 offset:20480
    ds_read_b64_tr_b16 a[234:235], v243 offset:20992
    ds_read_b64_tr_b16 a[236:237], v243 offset:22528
    ds_read_b64_tr_b16 a[238:239], v243 offset:23040
    ds_read_b64_tr_b16 a[240:241], v243 offset:24576
    ds_read_b64_tr_b16 a[242:243], v243 offset:25088
    ds_read_b64_tr_b16 a[244:245], v243 offset:26624
    ds_read_b64_tr_b16 a[246:247], v243 offset:27136
    ds_read_b64_tr_b16 a[248:249], v243 offset:28672
    ds_read_b64_tr_b16 a[250:251], v243 offset:29184
    ds_read_b64_tr_b16 a[252:253], v243 offset:30720
    ds_read_b64_tr_b16 a[254:255], v243 offset:31232
    s_waitcnt lgkmcnt(0)
    s_barrier
    buffer_load_dwordx4 v[104:107], v15, s[8:11], s42 offen offset:0
    buffer_load_dwordx4 v[108:111], v15, s[8:11], s42 offen offset:1024
    buffer_load_dwordx4 v[112:115], v15, s[8:11], s42 offen offset:2048
    buffer_load_dwordx4 v[116:119], v15, s[8:11], s42 offen offset:3072
    buffer_load_dwordx4 v[120:123], v15, s[8:11], s43 offen offset:0
    buffer_load_dwordx4 v[124:127], v15, s[8:11], s43 offen offset:1024
    buffer_load_dwordx4 v[128:131], v15, s[8:11], s43 offen offset:2048
    buffer_load_dwordx4 v[132:135], v15, s[8:11], s43 offen offset:3072
    buffer_load_dwordx4 v[136:139], v15, s[8:11], s44 offen offset:0
    buffer_load_dwordx4 v[140:143], v15, s[8:11], s44 offen offset:1024
    s_add_u32 s42, s42, 262144
    s_add_u32 s43, s43, 262144
    s_add_u32 s44, s44, 262144
.p2align 6
.step_21:
    s_barrier
    s_setprio 3
    buffer_load_dwordx4 v[24:27], v3, s[8:11], s30 offen offset:0 sc1
    s_setprio 2
    buffer_load_dwordx4 v[28:31], v3, s[8:11], s30 offen offset:1024 sc1
    s_setprio 1
    buffer_load_dwordx4 v[32:35], v3, s[8:11], s30 offen offset:2048 sc1
    s_setprio 0
    buffer_load_dwordx4 v[36:39], v3, s[8:11], s30 offen offset:3072 sc1
    s_waitcnt vmcnt(3)
    v_max_u32 v18, v25, v27
    v_cmp_eq_u32 vcc, -1, v18
    s_cbranch_vccnz .gs_23
.gr_24:
    v_smfmac_f32_16x16x64_bf16 v[40:43], v[24:27], a[0:7], v2
    v_smfmac_f32_16x16x64_bf16 v[44:47], v[24:27], a[32:39], v2
    s_waitcnt vmcnt(2)
    v_max_u32 v18, v29, v31
    v_cmp_eq_u32 vcc, -1, v18
    v_smfmac_f32_16x16x64_bf16 v[48:51], v[24:27], a[64:71], v2
    s_cbranch_vccnz .gs_26
.gr_27:
    v_smfmac_f32_16x16x64_bf16 v[40:43], v[28:31], a[8:15], v2
    v_smfmac_f32_16x16x64_bf16 v[44:47], v[28:31], a[40:47], v2
    v_smfmac_f32_16x16x64_bf16 v[52:55], v[24:27], a[96:103], v2
    s_waitcnt vmcnt(1)
    v_max_u32 v18, v33, v35
    v_cmp_eq_u32 vcc, -1, v18
    v_smfmac_f32_16x16x64_bf16 v[48:51], v[28:31], a[72:79], v2
    s_cbranch_vccnz .gs_29
.gr_30:
    v_smfmac_f32_16x16x64_bf16 v[40:43], v[32:35], a[16:23], v2
    v_smfmac_f32_16x16x64_bf16 v[44:47], v[32:35], a[48:55], v2
    v_smfmac_f32_16x16x64_bf16 v[52:55], v[28:31], a[104:111], v2
    s_waitcnt vmcnt(0)
    v_max_u32 v18, v37, v39
    v_cmp_eq_u32 vcc, -1, v18
    v_smfmac_f32_16x16x64_bf16 v[48:51], v[32:35], a[80:87], v2
    s_cbranch_vccnz .gs_32
.gr_33:
    v_smfmac_f32_16x16x64_bf16 v[40:43], v[36:39], a[24:31], v2
    v_smfmac_f32_16x16x64_bf16 v[44:47], v[36:39], a[56:63], v2
    v_smfmac_f32_16x16x64_bf16 v[52:55], v[32:35], a[112:119], v2
    v_smfmac_f32_16x16x64_bf16 v[48:51], v[36:39], a[88:95], v2
    v_permlane32_swap_b32 v40, v44
    v_permlane32_swap_b32 v41, v45
    v_smfmac_f32_16x16x64_bf16 v[52:55], v[36:39], a[120:127], v2
    v_permlane32_swap_b32 v42, v46
    v_permlane32_swap_b32 v43, v47
    v_add_f32 v40, v40, v44
    v_add_f32 v41, v41, v45
    v_add_f32 v42, v42, v46
    v_add_f32 v43, v43, v47
    ds_write2_b32 v5, v40, v41 offset0:0 offset1:36
    ds_write2_b32 v5, v42, v43 offset0:72 offset1:108
    v_permlane32_swap_b32 v48, v52
    v_permlane32_swap_b32 v49, v53
    v_permlane32_swap_b32 v50, v54
    v_permlane32_swap_b32 v51, v55
    v_pk_add_f32 v[48:49], v[48:49], v[52:53]
    v_pk_add_f32 v[50:51], v[50:51], v[54:55]
    ds_write2_b32 v6, v48, v49 offset0:0 offset1:36
    ds_write2_b32 v6, v50, v51 offset0:72 offset1:108
    s_waitcnt lgkmcnt(2)
    s_barrier
    ds_read_b64 v[72:73], v9 offset:0
    ds_read_b64 v[74:75], v9 offset:1152
    ds_read_b64 v[76:77], v9 offset:2304
    ds_read_b64 v[78:79], v9 offset:3456
    s_waitcnt lgkmcnt(4)
    s_barrier
    s_waitcnt lgkmcnt(2)
    v_pk_add_f32 v[72:73], v[72:73], v[74:75]
    s_waitcnt lgkmcnt(0)
    v_pk_add_f32 v[76:77], v[76:77], v[78:79]
    v_pk_add_f32 v[72:73], v[72:73], v[76:77]
    v_cvt_pk_bf16_f32 v72, v72, v73
    v_min_u32 v72, 0xfffffffe, v72
    buffer_store_dword v72, v10, s[8:11], s30 offen
    v_smfmac_f32_16x16x64_bf16 v[56:59], v[24:27], a[128:135], v2
    v_smfmac_f32_16x16x64_bf16 v[60:63], v[24:27], a[160:167], v2
    v_smfmac_f32_16x16x64_bf16 v[56:59], v[28:31], a[136:143], v2
    v_smfmac_f32_16x16x64_bf16 v[60:63], v[28:31], a[168:175], v2
    v_smfmac_f32_16x16x64_bf16 v[56:59], v[32:35], a[144:151], v2
    v_smfmac_f32_16x16x64_bf16 v[60:63], v[32:35], a[176:183], v2
    v_smfmac_f32_16x16x64_bf16 v[56:59], v[36:39], a[152:159], v2
    v_smfmac_f32_16x16x64_bf16 v[60:63], v[36:39], a[184:191], v2
    v_mov_b32 v40, 0
    v_mov_b32 v41, 0
    v_mov_b32 v42, 0
    v_mov_b32 v43, 0
    v_mov_b32 v44, 0
    v_mov_b32 v45, 0
    v_mov_b32 v46, 0
    v_mov_b32 v47, 0
    v_permlane32_swap_b32 v56, v60
    v_permlane32_swap_b32 v57, v61
    v_permlane32_swap_b32 v58, v62
    v_permlane32_swap_b32 v59, v63
    v_pk_add_f32 v[56:57], v[56:57], v[60:61]
    v_pk_add_f32 v[58:59], v[58:59], v[62:63]
    ds_write_b128 v8, v[56:59]
    s_cmp_eq_u32 s28, 63
    s_cbranch_scc1 .fin_22
    s_waitcnt vmcnt(0)
    buffer_load_dwordx4 v[144:147], v12, s[8:11], s30 offen offset:0 sc1
    buffer_load_dwordx4 v[148:151], v12, s[8:11], s30 offen offset:512 sc1
    buffer_load_dwordx4 v[152:155], v12, s[8:11], s30 offen offset:1024 sc1
    buffer_load_dwordx4 v[156:159], v12, s[8:11], s30 offen offset:1536 sc1
    buffer_load_dwordx4 v[176:179], v13, s[8:11], s30 offen offset:0 sc1
    buffer_load_dwordx4 v[180:183], v13, s[8:11], s30 offen offset:512 sc1
    buffer_load_dwordx4 v[184:187], v13, s[8:11], s30 offen offset:1024 sc1
    buffer_load_dwordx4 v[188:191], v13, s[8:11], s30 offen offset:1536 sc1
    s_waitcnt lgkmcnt(0)
    s_barrier
.mf_35:
    s_waitcnt vmcnt(7)
    v_mfma_f32_16x16x32_bf16 v[192:195], v[104:107], v[144:147], 0
    v_max3_u32 v18, v144, v145, v146
    v_max_u32 v18, v18, v147
    v_mfma_f32_16x16x32_bf16 v[160:163], v[120:123], v[144:147], 0
    s_waitcnt vmcnt(6)
    v_max3_u32 v18, v18, v148, v149
    v_max3_u32 v18, v18, v150, v151
    v_mfma_f32_16x16x32_bf16 v[192:195], v[108:111], v[148:151], v[192:195]
    s_waitcnt vmcnt(5)
    v_max3_u32 v18, v18, v152, v153
    v_max3_u32 v18, v18, v154, v155
    v_mfma_f32_16x16x32_bf16 v[160:163], v[124:127], v[148:151], v[160:163]
    s_waitcnt vmcnt(4)
    v_max3_u32 v18, v18, v156, v157
    v_max3_u32 v18, v18, v158, v159
    v_mfma_f32_16x16x32_bf16 v[192:195], v[112:115], v[152:155], v[192:195]
    v_cmp_eq_u32 vcc, -1, v18
    v_mfma_f32_16x16x32_bf16 v[160:163], v[128:131], v[152:155], v[160:163]
    s_cbranch_vccnz .re_36
    s_waitcnt vmcnt(3)
    v_max3_u32 v18, v176, v177, v178
    v_max_u32 v18, v18, v179
    v_mfma_f32_16x16x32_bf16 v[192:195], v[116:119], v[156:159], v[192:195]
    s_waitcnt vmcnt(2)
    v_max3_u32 v18, v18, v180, v181
    v_max3_u32 v18, v18, v182, v183
    v_mfma_f32_16x16x32_bf16 v[160:163], v[132:135], v[156:159], v[160:163]
    s_waitcnt vmcnt(1)
    v_max3_u32 v18, v18, v184, v185
    v_max3_u32 v18, v18, v186, v187
    v_mfma_f32_16x16x32_bf16 v[196:199], v[176:179], v[144:147], 0
    s_waitcnt vmcnt(0)
    v_max3_u32 v18, v18, v188, v189
    v_max3_u32 v18, v18, v190, v191
    v_mfma_f32_16x16x32_bf16 v[196:199], v[180:183], v[148:151], v[196:199]
    v_cmp_eq_u32 vcc, -1, v18
    v_mfma_f32_16x16x32_bf16 v[196:199], v[184:187], v[152:155], v[196:199]
    s_cbranch_vccnz .rk_38
    v_cndmask_b32 v192, v160, v192, s[48:49]
    v_cndmask_b32 v193, v161, v193, s[48:49]
    v_mfma_f32_16x16x32_bf16 v[196:199], v[188:191], v[156:159], v[196:199]
.mk_37:
    v_cndmask_b32 v194, v162, v194, s[48:49]
    v_cndmask_b32 v195, v163, v195, s[48:49]
    v_max3_f32 v19, v192, v193, v194
    v_max_f32 v19, v19, v195
    s_barrier
    ds_read_b32 v212, v16
    ds_read_b32 v216, v16 offset:64
    v_max_f32_dpp v19, v19, v19 row_ror:8 row_mask:0xf bank_mask:0xf
    v_max3_f32 v18, v19, v196, v197
    v_max3_f32 v17, v19, v196, v197
    s_nop 1
    v_permlane16_swap_b32 v18, v17
    v_max_f32 v19, v18, v17
    v_max_f32 v18, v18, v17
    s_nop 1
    v_permlane32_swap_b32 v18, v19
    v_max_f32 v18, v18, v19
    v_mul_f32 v18, s45, v18
    v_pk_fma_f32 v[244:245], v[196:197], v[200:201], v[18:19] op_sel_hi:[1,1,0] neg_lo:[0,0,1] neg_hi:[0,0,1]
    v_pk_fma_f32 v[240:241], v[192:193], v[200:201], v[18:19] op_sel_hi:[1,1,0] neg_lo:[0,0,1] neg_hi:[0,0,1]
    v_pk_fma_f32 v[242:243], v[194:195], v[200:201], v[18:19] op_sel_hi:[1,1,0] neg_lo:[0,0,1] neg_hi:[0,0,1]
    v_exp_f32 v244, v244
    v_exp_f32 v245, v245
    v_exp_f32 v240, v240
    v_cvt_pk_bf16_f32 v208, v244, v245
    v_exp_f32 v241, v241
    v_exp_f32 v242, v242
    v_mfma_f32_16x16x32_bf16 v[224:227], v[220:223], v[208:211], 0
    v_exp_f32 v243, v243
    s_waitcnt lgkmcnt(0)
    v_mfma_f32_16x16x32_bf16 v[228:231], v[212:215], v[208:211], 0
    v_cvt_pk_bf16_f32 v204, v240, v241
    v_cvt_pk_bf16_f32 v205, v242, v243
    v_mfma_f32_16x16x32_bf16 v[232:235], v[216:219], v[208:211], 0
    v_mov_b32_dpp v206, v204 row_ror:8 row_mask:0xf bank_mask:0xf
    v_mov_b32_dpp v207, v205 row_ror:8 row_mask:0xf bank_mask:0xf
    s_nop 1
    v_mfma_f32_16x16x32_bf16 v[224:227], v[220:223], v[204:207], v[224:227]
    v_mfma_f32_16x16x32_bf16 v[228:231], v[136:139], v[204:207], v[228:231]
    v_mfma_f32_16x16x32_bf16 v[232:235], v[140:143], v[204:207], v[232:235]
    s_mov_b64 exec, s[48:49]
    v_rcp_f32 v18, v224
    s_nop 1
    v_mul_f32 v228, v18, v228
    v_mul_f32 v229, v18, v229
    v_mul_f32 v230, v18, v230
    v_mul_f32 v231, v18, v231
    v_pk_mul_f32 v[232:233], v[18:19], v[232:233] op_sel_hi:[0,1]
    v_pk_mul_f32 v[234:235], v[18:19], v[234:235] op_sel_hi:[0,1]
    v_cvt_pk_bf16_f32 v236, v228, v229
    v_cvt_pk_bf16_f32 v239, v234, v235
    v_cvt_pk_bf16_f32 v237, v230, v231
    v_cvt_pk_bf16_f32 v238, v232, v233
    v_min_u32 v239, 0xfffffffe, v239
    buffer_store_dwordx4 v[236:239], v14, s[8:11], s30 offen
    s_mov_b64 exec, -1
    v_mov_b32 v48, 0
    v_mov_b32 v49, 0
    v_mov_b32 v50, 0
    v_mov_b32 v51, 0
    v_mov_b32 v52, 0
    v_mov_b32 v53, 0
    v_mov_b32 v54, 0
    v_mov_b32 v55, 0
    v_mov_b32 v56, 0
    v_mov_b32 v57, 0
    v_mov_b32 v58, 0
    v_mov_b32 v59, 0
    v_mov_b32 v60, 0
    v_mov_b32 v61, 0
    v_mov_b32 v62, 0
    v_mov_b32 v63, 0
    s_waitcnt vmcnt(0)
    s_barrier
    s_setprio 3
    buffer_load_dwordx4 v[24:27], v4, s[8:11], s30 offen offset:0 sc1
    s_setprio 2
    buffer_load_dwordx4 v[28:31], v4, s[8:11], s30 offen offset:1024 sc1
    s_setprio 1
    buffer_load_dwordx4 v[32:35], v4, s[8:11], s30 offen offset:2048 sc1
    s_setprio 0
    buffer_load_dwordx4 v[36:39], v4, s[8:11], s30 offen offset:3072 sc1
    s_waitcnt vmcnt(3)
    v_smfmac_f32_16x16x64_bf16 v[64:67], v[24:27], a[192:199], v2
    v_cmp_eq_u32 vcc, -1, v27
    v_smfmac_f32_16x16x64_bf16 v[68:71], v[24:27], a[224:231], v2
    s_cbranch_vccnz .gs_40
.gr_41:
    s_waitcnt vmcnt(2)
    v_smfmac_f32_16x16x64_bf16 v[64:67], v[28:31], a[200:207], v2
    v_cmp_eq_u32 vcc, -1, v31
    v_smfmac_f32_16x16x64_bf16 v[68:71], v[28:31], a[232:239], v2
    s_cbranch_vccnz .gs_43
.gr_44:
    s_waitcnt vmcnt(1)
    v_smfmac_f32_16x16x64_bf16 v[64:67], v[32:35], a[208:215], v2
    v_cmp_eq_u32 vcc, -1, v35
    v_smfmac_f32_16x16x64_bf16 v[68:71], v[32:35], a[240:247], v2
    s_cbranch_vccnz .gs_46
.gr_47:
    s_waitcnt vmcnt(0)
    v_smfmac_f32_16x16x64_bf16 v[64:67], v[36:39], a[216:223], v2
    v_cmp_eq_u32 vcc, -1, v39
    v_smfmac_f32_16x16x64_bf16 v[68:71], v[36:39], a[248:255], v2
    s_cbranch_vccnz .gs_49
.gr_50:
    s_nop 6
    v_permlane32_swap_b32 v64, v68
    v_permlane32_swap_b32 v65, v69
    v_permlane32_swap_b32 v66, v70
    v_permlane32_swap_b32 v67, v71
    v_pk_add_f32 v[64:65], v[64:65], v[68:69]
    v_pk_add_f32 v[66:67], v[66:67], v[70:71]
    ds_write2_b32 v7, v64, v65 offset0:0 offset1:36
    ds_write2_b32 v7, v66, v67 offset0:72 offset1:108
    s_waitcnt lgkmcnt(0)
    s_barrier
    buffer_load_dwordx4 v[104:107], v15, s[8:11], s42 offen offset:0
    buffer_load_dwordx4 v[108:111], v15, s[8:11], s42 offen offset:1024
    buffer_load_dwordx4 v[112:115], v15, s[8:11], s42 offen offset:2048
    buffer_load_dwordx4 v[116:119], v15, s[8:11], s42 offen offset:3072
    buffer_load_dwordx4 v[120:123], v15, s[8:11], s43 offen offset:0
    buffer_load_dwordx4 v[124:127], v15, s[8:11], s43 offen offset:1024
    buffer_load_dwordx4 v[128:131], v15, s[8:11], s43 offen offset:2048
    buffer_load_dwordx4 v[132:135], v15, s[8:11], s43 offen offset:3072
    buffer_load_dwordx4 v[136:139], v15, s[8:11], s44 offen offset:0
    buffer_load_dwordx4 v[140:143], v15, s[8:11], s44 offen offset:1024
    s_add_u32 s42, s42, 262144
    s_add_u32 s43, s43, 262144
    s_add_u32 s44, s44, 262144
    v_mov_b32 v64, 0
    v_mov_b32 v65, 0
    v_mov_b32 v66, 0
    v_mov_b32 v67, 0
    v_mov_b32 v68, 0
    v_mov_b32 v69, 0
    v_mov_b32 v70, 0
    v_mov_b32 v71, 0
    s_mov_b32 s4, s30
    s_mov_b32 s30, s31
    s_mov_b32 s31, s32
    s_mov_b32 s32, s33
    s_mov_b32 s33, s4
    s_add_u32 s28, s28, 1
    s_mov_b32 s62, 0
    s_branch .step_21
.fin_22:
    s_waitcnt lgkmcnt(0)
    s_barrier
    s_barrier
    s_endpgm
.gs_23:
    buffer_load_dwordx4 v[24:27], v3, s[8:11], s30 offen offset:0 sc1
    buffer_load_dwordx4 v[28:31], v3, s[8:11], s30 offen offset:1024 sc1
    buffer_load_dwordx4 v[32:35], v3, s[8:11], s30 offen offset:2048 sc1
    buffer_load_dwordx4 v[36:39], v3, s[8:11], s30 offen offset:3072 sc1
    s_add_u32 s62, s62, 1
    s_cmp_gt_u32 s62, 0x100000
    s_cbranch_scc1 .mg_end_1
    s_waitcnt vmcnt(3)
    v_max_u32 v18, v25, v27
    v_cmp_eq_u32 vcc, -1, v18
    s_cbranch_vccz .gr_24
    s_branch .gs_23
.gs_26:
    buffer_load_dwordx4 v[28:31], v3, s[8:11], s30 offen offset:1024 sc1
    buffer_load_dwordx4 v[32:35], v3, s[8:11], s30 offen offset:2048 sc1
    buffer_load_dwordx4 v[36:39], v3, s[8:11], s30 offen offset:3072 sc1
    s_add_u32 s62, s62, 1
    s_cmp_gt_u32 s62, 0x100000
    s_cbranch_scc1 .mg_end_1
    s_waitcnt vmcnt(2)
    v_max_u32 v18, v29, v31
    v_cmp_eq_u32 vcc, -1, v18
    s_cbranch_vccz .gr_27
    s_branch .gs_26
.gs_29:
    buffer_load_dwordx4 v[32:35], v3, s[8:11], s30 offen offset:2048 sc1
    buffer_load_dwordx4 v[36:39], v3, s[8:11], s30 offen offset:3072 sc1
    s_add_u32 s62, s62, 1
    s_cmp_gt_u32 s62, 0x100000
    s_cbranch_scc1 .mg_end_1
    s_waitcnt vmcnt(1)
    v_max_u32 v18, v33, v35
    v_cmp_eq_u32 vcc, -1, v18
    s_cbranch_vccz .gr_30
    s_branch .gs_29
.gs_32:
    buffer_load_dwordx4 v[36:39], v3, s[8:11], s30 offen offset:3072 sc1
    s_add_u32 s62, s62, 1
    s_cmp_gt_u32 s62, 0x100000
    s_cbranch_scc1 .mg_end_1
    s_waitcnt vmcnt(0)
    v_max_u32 v18, v37, v39
    v_cmp_eq_u32 vcc, -1, v18
    s_cbranch_vccz .gr_33
    s_branch .gs_32
.re_36:
    buffer_load_dwordx4 v[144:147], v12, s[8:11], s30 offen offset:0 sc1
    buffer_load_dwordx4 v[148:151], v12, s[8:11], s30 offen offset:512 sc1
    buffer_load_dwordx4 v[152:155], v12, s[8:11], s30 offen offset:1024 sc1
    buffer_load_dwordx4 v[156:159], v12, s[8:11], s30 offen offset:1536 sc1
    buffer_load_dwordx4 v[176:179], v13, s[8:11], s30 offen offset:0 sc1
    buffer_load_dwordx4 v[180:183], v13, s[8:11], s30 offen offset:512 sc1
    buffer_load_dwordx4 v[184:187], v13, s[8:11], s30 offen offset:1024 sc1
    buffer_load_dwordx4 v[188:191], v13, s[8:11], s30 offen offset:1536 sc1
    s_add_u32 s62, s62, 1
    s_cmp_gt_u32 s62, 0x100000
    s_cbranch_scc1 .mg_end_1
    s_branch .mf_35
.rk_38:
    s_nop 3
    buffer_load_dwordx4 v[176:179], v13, s[8:11], s30 offen offset:0 sc1
    buffer_load_dwordx4 v[180:183], v13, s[8:11], s30 offen offset:512 sc1
    buffer_load_dwordx4 v[184:187], v13, s[8:11], s30 offen offset:1024 sc1
    buffer_load_dwordx4 v[188:191], v13, s[8:11], s30 offen offset:1536 sc1
    s_add_u32 s62, s62, 1
    s_cmp_gt_u32 s62, 0x100000
    s_cbranch_scc1 .mg_end_1
    s_waitcnt vmcnt(3)
    v_mfma_f32_16x16x32_bf16 v[196:199], v[176:179], v[144:147], 0
    v_max3_u32 v18, v176, v177, v178
    v_max_u32 v18, v18, v179
    s_waitcnt vmcnt(2)
    v_mfma_f32_16x16x32_bf16 v[196:199], v[180:183], v[148:151], v[196:199]
    v_max3_u32 v18, v18, v180, v181
    v_max3_u32 v18, v18, v182, v183
    s_waitcnt vmcnt(1)
    v_mfma_f32_16x16x32_bf16 v[196:199], v[184:187], v[152:155], v[196:199]
    v_max3_u32 v18, v18, v184, v185
    v_max3_u32 v18, v18, v186, v187
    s_waitcnt vmcnt(0)
    v_mfma_f32_16x16x32_bf16 v[196:199], v[188:191], v[156:159], v[196:199]
    v_max3_u32 v18, v18, v188, v189
    v_max3_u32 v18, v18, v190, v191
    v_cmp_eq_u32 vcc, -1, v18
    s_cbranch_vccnz .rk_38
    v_cndmask_b32 v192, v160, v192, s[48:49]
    v_cndmask_b32 v193, v161, v193, s[48:49]
    s_branch .mk_37
.gs_40:
    buffer_load_dwordx4 v[24:27], v4, s[8:11], s30 offen offset:0 sc1
    buffer_load_dwordx4 v[28:31], v4, s[8:11], s30 offen offset:1024 sc1
    buffer_load_dwordx4 v[32:35], v4, s[8:11], s30 offen offset:2048 sc1
    buffer_load_dwordx4 v[36:39], v4, s[8:11], s30 offen offset:3072 sc1
    s_nop 2
    v_mov_b32 v64, 0
    v_mov_b32 v65, 0
    v_mov_b32 v66, 0
    v_mov_b32 v67, 0
    v_mov_b32 v68, 0
    v_mov_b32 v69, 0
    v_mov_b32 v70, 0
    v_mov_b32 v71, 0
    s_nop 1
    s_branch .gc_52
.gl_42:
    buffer_load_dwordx4 v[24:27], v4, s[8:11], s30 offen offset:0 sc1
    buffer_load_dwordx4 v[28:31], v4, s[8:11], s30 offen offset:1024 sc1
    buffer_load_dwordx4 v[32:35], v4, s[8:11], s30 offen offset:2048 sc1
    buffer_load_dwordx4 v[36:39], v4, s[8:11], s30 offen offset:3072 sc1
.gc_52:
    s_add_u32 s62, s62, 1
    s_cmp_gt_u32 s62, 0x100000
    s_cbranch_scc1 .mg_end_1
    s_waitcnt vmcnt(3)
    v_cmp_eq_u32 vcc, -1, v27
    s_cbranch_vccnz .gl_42
    v_smfmac_f32_16x16x64_bf16 v[64:67], v[24:27], a[192:199], v2
    v_smfmac_f32_16x16x64_bf16 v[68:71], v[24:27], a[224:231], v2
    s_branch .gr_41
.gs_43:
    buffer_load_dwordx4 v[28:31], v4, s[8:11], s30 offen offset:1024 sc1
    buffer_load_dwordx4 v[32:35], v4, s[8:11], s30 offen offset:2048 sc1
    buffer_load_dwordx4 v[36:39], v4, s[8:11], s30 offen offset:3072 sc1
    s_nop 3
    v_mov_b32 v64, 0
    v_mov_b32 v65, 0
    v_mov_b32 v66, 0
    v_mov_b32 v67, 0
    v_mov_b32 v68, 0
    v_mov_b32 v69, 0
    v_mov_b32 v70, 0
    v_mov_b32 v71, 0
    s_nop 1
    v_smfmac_f32_16x16x64_bf16 v[64:67], v[24:27], a[192:199], v2
    v_smfmac_f32_16x16x64_bf16 v[68:71], v[24:27], a[224:231], v2
    s_branch .gc_53
.gl_45:
    buffer_load_dwordx4 v[28:31], v4, s[8:11], s30 offen offset:1024 sc1
    buffer_load_dwordx4 v[32:35], v4, s[8:11], s30 offen offset:2048 sc1
    buffer_load_dwordx4 v[36:39], v4, s[8:11], s30 offen offset:3072 sc1
.gc_53:
    s_add_u32 s62, s62, 1
    s_cmp_gt_u32 s62, 0x100000
    s_cbranch_scc1 .mg_end_1
    s_waitcnt vmcnt(2)
    v_cmp_eq_u32 vcc, -1, v31
    s_cbranch_vccnz .gl_45
    v_smfmac_f32_16x16x64_bf16 v[64:67], v[28:31], a[200:207], v2
    v_smfmac_f32_16x16x64_bf16 v[68:71], v[28:31], a[232:239], v2
    s_branch .gr_44
.gs_46:
    buffer_load_dwordx4 v[32:35], v4, s[8:11], s30 offen offset:2048 sc1
    buffer_load_dwordx4 v[36:39], v4, s[8:11], s30 offen offset:3072 sc1
    s_nop 4
    v_mov_b32 v64, 0
    v_mov_b32 v65, 0
    v_mov_b32 v66, 0
    v_mov_b32 v67, 0
    v_mov_b32 v68, 0
    v_mov_b32 v69, 0
    v_mov_b32 v70, 0
    v_mov_b32 v71, 0
    s_nop 1
    v_smfmac_f32_16x16x64_bf16 v[64:67], v[24:27], a[192:199], v2
    v_smfmac_f32_16x16x64_bf16 v[68:71], v[24:27], a[224:231], v2
    v_smfmac_f32_16x16x64_bf16 v[64:67], v[28:31], a[200:207], v2
    v_smfmac_f32_16x16x64_bf16 v[68:71], v[28:31], a[232:239], v2
    s_branch .gc_54
.gl_48:
    buffer_load_dwordx4 v[32:35], v4, s[8:11], s30 offen offset:2048 sc1
    buffer_load_dwordx4 v[36:39], v4, s[8:11], s30 offen offset:3072 sc1
.gc_54:
    s_add_u32 s62, s62, 1
    s_cmp_gt_u32 s62, 0x100000
    s_cbranch_scc1 .mg_end_1
    s_waitcnt vmcnt(1)
    v_cmp_eq_u32 vcc, -1, v35
    s_cbranch_vccnz .gl_48
    v_smfmac_f32_16x16x64_bf16 v[64:67], v[32:35], a[208:215], v2
    v_smfmac_f32_16x16x64_bf16 v[68:71], v[32:35], a[240:247], v2
    s_branch .gr_47
.gs_49:
    buffer_load_dwordx4 v[36:39], v4, s[8:11], s30 offen offset:3072 sc1
    s_nop 5
    v_mov_b32 v64, 0
    v_mov_b32 v65, 0
    v_mov_b32 v66, 0
    v_mov_b32 v67, 0
    v_mov_b32 v68, 0
    v_mov_b32 v69, 0
    v_mov_b32 v70, 0
    v_mov_b32 v71, 0
    s_nop 1
    v_smfmac_f32_16x16x64_bf16 v[64:67], v[24:27], a[192:199], v2
    v_smfmac_f32_16x16x64_bf16 v[68:71], v[24:27], a[224:231], v2
    v_smfmac_f32_16x16x64_bf16 v[64:67], v[28:31], a[200:207], v2
    v_smfmac_f32_16x16x64_bf16 v[68:71], v[28:31], a[232:239], v2
    v_smfmac_f32_16x16x64_bf16 v[64:67], v[32:35], a[208:215], v2
    v_smfmac_f32_16x16x64_bf16 v[68:71], v[32:35], a[240:247], v2
    s_branch .gc_55
.gl_51:
    buffer_load_dwordx4 v[36:39], v4, s[8:11], s30 offen offset:3072 sc1
.gc_55:
    s_add_u32 s62, s62, 1
    s_cmp_gt_u32 s62, 0x100000
    s_cbranch_scc1 .mg_end_1
    s_waitcnt vmcnt(0)
    v_cmp_eq_u32 vcc, -1, v39
    s_cbranch_vccnz .gl_51
    v_smfmac_f32_16x16x64_bf16 v[64:67], v[36:39], a[216:223], v2
    v_smfmac_f32_16x16x64_bf16 v[68:71], v[36:39], a[248:255], v2
    s_branch .gr_50
.w1_18:
    v_bfe_u32 v254, v1, 1, 3
    v_mul_u32_u24 v12, 144, v254
    v_bfe_u32 v254, v1, 4, 2
    v_mul_u32_u24 v254, 32, v254
    v_add_u32 v12, v12, v254
    v_bfe_u32 v254, v1, 0, 1
    v_mul_u32_u24 v254, 16, v254
    v_add_u32 v12, v12, v254
    v_add_u32 v12, 9216, v12
    v_bfe_u32 v254, v1, 0, 6
    v_mul_u32_u24 v13, 16, v254
    v_add_u32 v13, s101, v13
    v_bfe_u32 v254, v1, 0, 6
    v_mul_u32_u24 v14, 8, v254
    v_add_u32 v14, s55, v14
    v_xor_b32 v14, 2048, v14
    v_min_u32 v249, 0xfffffffe, v249
    buffer_store_dwordx2 v[248:249], v14, s[8:11], s30 offen
    v_bfe_u32 v254, v1, 0, 6
    v_mul_u32_u24 v15, 16, v254
    s_add_u32 s42, s42, 262144
    s_add_u32 s43, s43, 262144
    s_add_u32 s44, s44, 262144
    buffer_load_dwordx4 v[24:27], v246, s[8:11], s31 offen sc1
    buffer_load_dwordx4 v[28:31], v245, s[8:11], s31 offen sc1
    s_waitcnt vmcnt(0)
    ds_read_b64_tr_b16 a[192:193], v242 offset:16384
    ds_read_b64_tr_b16 a[194:195], v242 offset:16896
    ds_read_b64_tr_b16 a[196:197], v242 offset:18432
    ds_read_b64_tr_b16 a[198:199], v242 offset:18944
    ds_read_b64_tr_b16 a[200:201], v242 offset:20480
    ds_read_b64_tr_b16 a[202:203], v242 offset:20992
    ds_read_b64_tr_b16 a[204:205], v242 offset:22528
    ds_read_b64_tr_b16 a[206:207], v242 offset:23040
    ds_read_b64_tr_b16 a[208:209], v242 offset:24576
    ds_read_b64_tr_b16 a[210:211], v242 offset:25088
    ds_read_b64_tr_b16 a[212:213], v242 offset:26624
    ds_read_b64_tr_b16 a[214:215], v242 offset:27136
    ds_read_b64_tr_b16 a[216:217], v242 offset:28672
    ds_read_b64_tr_b16 a[218:219], v242 offset:29184
    ds_read_b64_tr_b16 a[220:221], v242 offset:30720
    ds_read_b64_tr_b16 a[222:223], v242 offset:31232
    ds_read_b64_tr_b16 a[224:225], v243 offset:16384
    ds_read_b64_tr_b16 a[226:227], v243 offset:16896
    ds_read_b64_tr_b16 a[228:229], v243 offset:18432
    ds_read_b64_tr_b16 a[230:231], v243 offset:18944
    ds_read_b64_tr_b16 a[232:233], v243 offset:20480
    ds_read_b64_tr_b16 a[234:235], v243 offset:20992
    ds_read_b64_tr_b16 a[236:237], v243 offset:22528
    ds_read_b64_tr_b16 a[238:239], v243 offset:23040
    ds_read_b64_tr_b16 a[240:241], v243 offset:24576
    ds_read_b64_tr_b16 a[242:243], v243 offset:25088
    ds_read_b64_tr_b16 a[244:245], v243 offset:26624
    ds_read_b64_tr_b16 a[246:247], v243 offset:27136
    ds_read_b64_tr_b16 a[248:249], v243 offset:28672
    ds_read_b64_tr_b16 a[250:251], v243 offset:29184
    ds_read_b64_tr_b16 a[252:253], v243 offset:30720
    ds_read_b64_tr_b16 a[254:255], v243 offset:31232
    s_waitcnt lgkmcnt(0)
    s_barrier
.p2align 6
.step_56:
    s_waitcnt vmcnt(0)
    s_barrier
    s_setprio 3
    buffer_load_dwordx4 v[24:27], v3, s[8:11], s30 offen offset:0 sc1
    s_setprio 2
    buffer_load_dwordx4 v[28:31], v3, s[8:11], s30 offen offset:1024 sc1
    s_setprio 1
    buffer_load_dwordx4 v[32:35], v3, s[8:11], s30 offen offset:2048 sc1
    s_setprio 0
    buffer_load_dwordx4 v[36:39], v3, s[8:11], s30 offen offset:3072 sc1
    s_waitcnt vmcnt(3)
    v_max_u32 v18, v25, v27
    v_cmp_eq_u32 vcc, -1, v18
    s_cbranch_vccnz .gs_58
.gr_59:
    v_smfmac_f32_16x16x64_bf16 v[40:43], v[24:27], a[0:7], v2
    v_smfmac_f32_16x16x64_bf16 v[44:47], v[24:27], a[32:39], v2
    s_waitcnt vmcnt(2)
    v_max_u32 v18, v29, v31
    v_cmp_eq_u32 vcc, -1, v18
    v_smfmac_f32_16x16x64_bf16 v[48:51], v[24:27], a[64:71], v2
    s_cbranch_vccnz .gs_61
.gr_62:
    v_smfmac_f32_16x16x64_bf16 v[40:43], v[28:31], a[8:15], v2
    v_smfmac_f32_16x16x64_bf16 v[44:47], v[28:31], a[40:47], v2
    v_smfmac_f32_16x16x64_bf16 v[52:55], v[24:27], a[96:103], v2
    s_waitcnt vmcnt(1)
    v_max_u32 v18, v33, v35
    v_cmp_eq_u32 vcc, -1, v18
    v_smfmac_f32_16x16x64_bf16 v[48:51], v[28:31], a[72:79], v2
    s_cbranch_vccnz .gs_64
.gr_65:
    v_smfmac_f32_16x16x64_bf16 v[40:43], v[32:35], a[16:23], v2
    v_smfmac_f32_16x16x64_bf16 v[44:47], v[32:35], a[48:55], v2
    v_smfmac_f32_16x16x64_bf16 v[52:55], v[28:31], a[104:111], v2
    s_waitcnt vmcnt(0)
    v_max_u32 v18, v37, v39
    v_cmp_eq_u32 vcc, -1, v18
    v_smfmac_f32_16x16x64_bf16 v[48:51], v[32:35], a[80:87], v2
    s_cbranch_vccnz .gs_67
.gr_68:
    v_smfmac_f32_16x16x64_bf16 v[40:43], v[36:39], a[24:31], v2
    v_smfmac_f32_16x16x64_bf16 v[44:47], v[36:39], a[56:63], v2
    v_smfmac_f32_16x16x64_bf16 v[52:55], v[32:35], a[112:119], v2
    v_smfmac_f32_16x16x64_bf16 v[48:51], v[36:39], a[88:95], v2
    v_permlane32_swap_b32 v40, v44
    v_permlane32_swap_b32 v41, v45
    v_smfmac_f32_16x16x64_bf16 v[52:55], v[36:39], a[120:127], v2
    v_permlane32_swap_b32 v42, v46
    v_permlane32_swap_b32 v43, v47
    v_add_f32 v40, v40, v44
    v_add_f32 v41, v41, v45
    v_add_f32 v42, v42, v46
    v_add_f32 v43, v43, v47
    ds_write2_b32 v5, v40, v41 offset0:0 offset1:36
    ds_write2_b32 v5, v42, v43 offset0:72 offset1:108
    v_permlane32_swap_b32 v48, v52
    v_permlane32_swap_b32 v49, v53
    v_permlane32_swap_b32 v50, v54
    v_permlane32_swap_b32 v51, v55
    v_pk_add_f32 v[48:49], v[48:49], v[52:53]
    v_pk_add_f32 v[50:51], v[50:51], v[54:55]
    ds_write2_b32 v6, v48, v49 offset0:0 offset1:36
    ds_write2_b32 v6, v50, v51 offset0:72 offset1:108
    s_waitcnt lgkmcnt(2)
    s_barrier
    ds_read_b64 v[72:73], v9 offset:0
    ds_read_b64 v[74:75], v9 offset:1152
    ds_read_b64 v[76:77], v9 offset:2304
    ds_read_b64 v[78:79], v9 offset:3456
    s_waitcnt lgkmcnt(4)
    s_barrier
    s_waitcnt lgkmcnt(2)
    v_pk_add_f32 v[72:73], v[72:73], v[74:75]
    s_waitcnt lgkmcnt(0)
    v_pk_add_f32 v[76:77], v[76:77], v[78:79]
    v_pk_add_f32 v[72:73], v[72:73], v[76:77]
    v_cvt_pk_bf16_f32 v72, v72, v73
    v_min_u32 v72, 0xfffffffe, v72
    buffer_store_dword v72, v10, s[8:11], s30 offen
    v_smfmac_f32_16x16x64_bf16 v[56:59], v[24:27], a[128:135], v2
    v_smfmac_f32_16x16x64_bf16 v[60:63], v[24:27], a[160:167], v2
    v_smfmac_f32_16x16x64_bf16 v[56:59], v[28:31], a[136:143], v2
    v_smfmac_f32_16x16x64_bf16 v[60:63], v[28:31], a[168:175], v2
    v_smfmac_f32_16x16x64_bf16 v[56:59], v[32:35], a[144:151], v2
    v_smfmac_f32_16x16x64_bf16 v[60:63], v[32:35], a[176:183], v2
    v_smfmac_f32_16x16x64_bf16 v[56:59], v[36:39], a[152:159], v2
    v_smfmac_f32_16x16x64_bf16 v[60:63], v[36:39], a[184:191], v2
    v_mov_b32 v40, 0
    v_mov_b32 v41, 0
    v_mov_b32 v42, 0
    v_mov_b32 v43, 0
    v_mov_b32 v44, 0
    v_mov_b32 v45, 0
    v_mov_b32 v46, 0
    v_mov_b32 v47, 0
    v_permlane32_swap_b32 v56, v60
    v_permlane32_swap_b32 v57, v61
    v_permlane32_swap_b32 v58, v62
    v_permlane32_swap_b32 v59, v63
    v_pk_add_f32 v[56:57], v[56:57], v[60:61]
    v_pk_add_f32 v[58:59], v[58:59], v[62:63]
    ds_write_b128 v8, v[56:59]
    s_waitcnt lgkmcnt(0)
    s_barrier
    s_barrier
    s_cmp_eq_u32 s28, 63
    s_cbranch_scc1 .fin_57
    s_xor_b32 s38, s34, 0x4000
    s_xor_b32 s39, s34, 0x1000
    s_xor_b32 s40, s34, 0x5000
    v_mov_b32 v48, 0
    v_mov_b32 v49, 0
    v_mov_b32 v50, 0
    v_mov_b32 v51, 0
    v_mov_b32 v52, 0
    v_mov_b32 v53, 0
    v_mov_b32 v54, 0
    v_mov_b32 v55, 0
    v_mov_b32 v56, 0
    v_mov_b32 v57, 0
    v_mov_b32 v58, 0
    v_mov_b32 v59, 0
    v_mov_b32 v60, 0
    v_mov_b32 v61, 0
    v_mov_b32 v62, 0
    v_mov_b32 v63, 0
    s_barrier
    s_setprio 3
    buffer_load_dwordx4 v[24:27], v4, s[8:11], s30 offen offset:0 sc1
    s_setprio 2
    buffer_load_dwordx4 v[28:31], v4, s[8:11], s30 offen offset:1024 sc1
    s_setprio 1
    buffer_load_dwordx4 v[32:35], v4, s[8:11], s30 offen offset:2048 sc1
    s_setprio 0
    buffer_load_dwordx4 v[36:39], v4, s[8:11], s30 offen offset:3072 sc1
    s_waitcnt vmcnt(3)
    v_smfmac_f32_16x16x64_bf16 v[64:67], v[24:27], a[192:199], v2
    v_cmp_eq_u32 vcc, -1, v27
    v_smfmac_f32_16x16x64_bf16 v[68:71], v[24:27], a[224:231], v2
    s_cbranch_vccnz .gs_70
.gr_71:
    s_waitcnt vmcnt(2)
    v_smfmac_f32_16x16x64_bf16 v[64:67], v[28:31], a[200:207], v2
    v_cmp_eq_u32 vcc, -1, v31
    v_smfmac_f32_16x16x64_bf16 v[68:71], v[28:31], a[232:239], v2
    s_cbranch_vccnz .gs_73
.gr_74:
    s_waitcnt vmcnt(1)
    v_smfmac_f32_16x16x64_bf16 v[64:67], v[32:35], a[208:215], v2
    v_cmp_eq_u32 vcc, -1, v35
    v_smfmac_f32_16x16x64_bf16 v[68:71], v[32:35], a[240:247], v2
    s_cbranch_vccnz .gs_76
.gr_77:
    s_waitcnt vmcnt(0)
    v_smfmac_f32_16x16x64_bf16 v[64:67], v[36:39], a[216:223], v2
    v_cmp_eq_u32 vcc, -1, v39
    v_smfmac_f32_16x16x64_bf16 v[68:71], v[36:39], a[248:255], v2
    s_cbranch_vccnz .gs_79
.gr_80:
    s_nop 6
    v_permlane32_swap_b32 v64, v68
    v_permlane32_swap_b32 v65, v69
    v_permlane32_swap_b32 v66, v70
    v_permlane32_swap_b32 v67, v71
    v_pk_add_f32 v[64:65], v[64:65], v[68:69]
    v_pk_add_f32 v[66:67], v[66:67], v[70:71]
    ds_write2_b32 v7, v64, v65 offset0:0 offset1:36
    ds_write2_b32 v7, v66, v67 offset0:72 offset1:108
    s_waitcnt lgkmcnt(0)
    s_barrier
    ds_read_b128 v[72:75], v12 offset:0
    ds_read_b128 v[76:79], v12 offset:1152
    ds_read_b128 v[80:83], v12 offset:2304
    ds_read_b128 v[84:87], v12 offset:3456
    s_waitcnt lgkmcnt(2)
    v_pk_add_f32 v[72:73], v[72:73], v[76:77]
    v_pk_add_f32 v[74:75], v[74:75], v[78:79]
    s_waitcnt lgkmcnt(0)
    v_pk_add_f32 v[80:81], v[80:81], v[84:85]
    v_pk_add_f32 v[82:83], v[82:83], v[86:87]
    v_pk_add_f32 v[72:73], v[72:73], v[80:81]
    v_pk_add_f32 v[74:75], v[74:75], v[82:83]
    v_min_u32 v75, 0xfffffffe, v75
    buffer_store_dwordx4 v[72:75], v13, s[8:11], s34 offen sc1
    v_mov_b32 v64, 0
    v_mov_b32 v65, 0
    v_mov_b32 v66, 0
    v_mov_b32 v67, 0
    v_mov_b32 v68, 0
    v_mov_b32 v69, 0
    v_mov_b32 v70, 0
    v_mov_b32 v71, 0
    s_waitcnt vmcnt(0)
.pl_82:
    buffer_load_dwordx4 v[76:79], v13, s[8:11], s38 offen sc1
    buffer_load_dwordx4 v[80:83], v13, s[8:11], s39 offen sc1
    buffer_load_dwordx4 v[84:87], v13, s[8:11], s40 offen sc1
    s_waitcnt vmcnt(2)
    v_pk_add_f32 v[88:89], v[72:73], v[76:77]
    v_pk_add_f32 v[90:91], v[74:75], v[78:79]
    s_waitcnt vmcnt(0)
    v_max3_u32 v18, v79, v83, v87
    v_cmp_eq_u32 vcc, -1, v18
    v_pk_add_f32 v[80:81], v[80:81], v[84:85]
    v_pk_add_f32 v[82:83], v[82:83], v[86:87]
    v_pk_add_f32 v[88:89], v[88:89], v[80:81]
    v_pk_add_f32 v[90:91], v[90:91], v[82:83]
    v_cvt_pk_bf16_f32 v92, v88, v89
    v_cvt_pk_bf16_f32 v93, v90, v91
    v_min_u32 v93, 0xfffffffe, v93
    s_cbranch_vccnz .pr_83
    buffer_store_dwordx2 v[92:93], v14, s[8:11], s31 offen
    s_mov_b32 s4, s30
    s_mov_b32 s30, s31
    s_mov_b32 s31, s32
    s_mov_b32 s32, s33
    s_mov_b32 s33, s4
    s_add_u32 s28, s28, 1
    s_mov_b32 s62, 0
    s_mov_b32 s4, s34
    s_mov_b32 s34, s35
    s_mov_b32 s35, s36
    s_mov_b32 s36, s37
    s_mov_b32 s37, s4
    s_branch .step_56
.fin_57:
    s_waitcnt vmcnt(0)
    s_endpgm
.gs_58:
    buffer_load_dwordx4 v[24:27], v3, s[8:11], s30 offen offset:0 sc1
    buffer_load_dwordx4 v[28:31], v3, s[8:11], s30 offen offset:1024 sc1
    buffer_load_dwordx4 v[32:35], v3, s[8:11], s30 offen offset:2048 sc1
    buffer_load_dwordx4 v[36:39], v3, s[8:11], s30 offen offset:3072 sc1
    s_add_u32 s62, s62, 1
    s_cmp_gt_u32 s62, 0x100000
    s_cbranch_scc1 .mg_end_1
    s_waitcnt vmcnt(3)
    v_max_u32 v18, v25, v27
    v_cmp_eq_u32 vcc, -1, v18
    s_cbranch_vccz .gr_59
    s_branch .gs_58
.gs_61:
    buffer_load_dwordx4 v[28:31], v3, s[8:11], s30 offen offset:1024 sc1
    buffer_load_dwordx4 v[32:35], v3, s[8:11], s30 offen offset:2048 sc1
    buffer_load_dwordx4 v[36:39], v3, s[8:11], s30 offen offset:3072 sc1
    s_add_u32 s62, s62, 1
    s_cmp_gt_u32 s62, 0x100000
    s_cbranch_scc1 .mg_end_1
    s_waitcnt vmcnt(2)
    v_max_u32 v18, v29, v31
    v_cmp_eq_u32 vcc, -1, v18
    s_cbranch_vccz .gr_62
    s_branch .gs_61
.gs_64:
    buffer_load_dwordx4 v[32:35], v3, s[8:11], s30 offen offset:2048 sc1
    buffer_load_dwordx4 v[36:39], v3, s[8:11], s30 offen offset:3072 sc1
    s_add_u32 s62, s62, 1
    s_cmp_gt_u32 s62, 0x100000
    s_cbranch_scc1 .mg_end_1
    s_waitcnt vmcnt(1)
    v_max_u32 v18, v33, v35
    v_cmp_eq_u32 vcc, -1, v18
    s_cbranch_vccz .gr_65
    s_branch .gs_64
.gs_67:
    buffer_load_dwordx4 v[36:39], v3, s[8:11], s30 offen offset:3072 sc1
    s_add_u32 s62, s62, 1
    s_cmp_gt_u32 s62, 0x100000
    s_cbranch_scc1 .mg_end_1
    s_waitcnt vmcnt(0)
    v_max_u32 v18, v37, v39
    v_cmp_eq_u32 vcc, -1, v18
    s_cbranch_vccz .gr_68
    s_branch .gs_67
.gs_70:
    buffer_load_dwordx4 v[24:27], v4, s[8:11], s30 offen offset:0 sc1
    buffer_load_dwordx4 v[28:31], v4, s[8:11], s30 offen offset:1024 sc1
    buffer_load_dwordx4 v[32:35], v4, s[8:11], s30 offen offset:2048 sc1
    buffer_load_dwordx4 v[36:39], v4, s[8:11], s30 offen offset:3072 sc1
    s_nop 2
    v_mov_b32 v64, 0
    v_mov_b32 v65, 0
    v_mov_b32 v66, 0
    v_mov_b32 v67, 0
    v_mov_b32 v68, 0
    v_mov_b32 v69, 0
    v_mov_b32 v70, 0
    v_mov_b32 v71, 0
    s_nop 1
    s_branch .gc_84
.gl_72:
    buffer_load_dwordx4 v[24:27], v4, s[8:11], s30 offen offset:0 sc1
    buffer_load_dwordx4 v[28:31], v4, s[8:11], s30 offen offset:1024 sc1
    buffer_load_dwordx4 v[32:35], v4, s[8:11], s30 offen offset:2048 sc1
    buffer_load_dwordx4 v[36:39], v4, s[8:11], s30 offen offset:3072 sc1
.gc_84:
    s_add_u32 s62, s62, 1
    s_cmp_gt_u32 s62, 0x100000
    s_cbranch_scc1 .mg_end_1
    s_waitcnt vmcnt(3)
    v_cmp_eq_u32 vcc, -1, v27
    s_cbranch_vccnz .gl_72
    v_smfmac_f32_16x16x64_bf16 v[64:67], v[24:27], a[192:199], v2
    v_smfmac_f32_16x16x64_bf16 v[68:71], v[24:27], a[224:231], v2
    s_branch .gr_71
.gs_73:
    buffer_load_dwordx4 v[28:31], v4, s[8:11], s30 offen offset:1024 sc1
    buffer_load_dwordx4 v[32:35], v4, s[8:11], s30 offen offset:2048 sc1
    buffer_load_dwordx4 v[36:39], v4, s[8:11], s30 offen offset:3072 sc1
    s_nop 3
    v_mov_b32 v64, 0
    v_mov_b32 v65, 0
    v_mov_b32 v66, 0
    v_mov_b32 v67, 0
    v_mov_b32 v68, 0
    v_mov_b32 v69, 0
    v_mov_b32 v70, 0
    v_mov_b32 v71, 0
    s_nop 1
    v_smfmac_f32_16x16x64_bf16 v[64:67], v[24:27], a[192:199], v2
    v_smfmac_f32_16x16x64_bf16 v[68:71], v[24:27], a[224:231], v2
    s_branch .gc_85
.gl_75:
    buffer_load_dwordx4 v[28:31], v4, s[8:11], s30 offen offset:1024 sc1
    buffer_load_dwordx4 v[32:35], v4, s[8:11], s30 offen offset:2048 sc1
    buffer_load_dwordx4 v[36:39], v4, s[8:11], s30 offen offset:3072 sc1
.gc_85:
    s_add_u32 s62, s62, 1
    s_cmp_gt_u32 s62, 0x100000
    s_cbranch_scc1 .mg_end_1
    s_waitcnt vmcnt(2)
    v_cmp_eq_u32 vcc, -1, v31
    s_cbranch_vccnz .gl_75
    v_smfmac_f32_16x16x64_bf16 v[64:67], v[28:31], a[200:207], v2
    v_smfmac_f32_16x16x64_bf16 v[68:71], v[28:31], a[232:239], v2
    s_branch .gr_74
.gs_76:
    buffer_load_dwordx4 v[32:35], v4, s[8:11], s30 offen offset:2048 sc1
    buffer_load_dwordx4 v[36:39], v4, s[8:11], s30 offen offset:3072 sc1
    s_nop 4
    v_mov_b32 v64, 0
    v_mov_b32 v65, 0
    v_mov_b32 v66, 0
    v_mov_b32 v67, 0
    v_mov_b32 v68, 0
    v_mov_b32 v69, 0
    v_mov_b32 v70, 0
    v_mov_b32 v71, 0
    s_nop 1
    v_smfmac_f32_16x16x64_bf16 v[64:67], v[24:27], a[192:199], v2
    v_smfmac_f32_16x16x64_bf16 v[68:71], v[24:27], a[224:231], v2
    v_smfmac_f32_16x16x64_bf16 v[64:67], v[28:31], a[200:207], v2
    v_smfmac_f32_16x16x64_bf16 v[68:71], v[28:31], a[232:239], v2
    s_branch .gc_86
.gl_78:
    buffer_load_dwordx4 v[32:35], v4, s[8:11], s30 offen offset:2048 sc1
    buffer_load_dwordx4 v[36:39], v4, s[8:11], s30 offen offset:3072 sc1
.gc_86:
    s_add_u32 s62, s62, 1
    s_cmp_gt_u32 s62, 0x100000
    s_cbranch_scc1 .mg_end_1
    s_waitcnt vmcnt(1)
    v_cmp_eq_u32 vcc, -1, v35
    s_cbranch_vccnz .gl_78
    v_smfmac_f32_16x16x64_bf16 v[64:67], v[32:35], a[208:215], v2
    v_smfmac_f32_16x16x64_bf16 v[68:71], v[32:35], a[240:247], v2
    s_branch .gr_77
.gs_79:
    buffer_load_dwordx4 v[36:39], v4, s[8:11], s30 offen offset:3072 sc1
    s_nop 5
    v_mov_b32 v64, 0
    v_mov_b32 v65, 0
    v_mov_b32 v66, 0
    v_mov_b32 v67, 0
    v_mov_b32 v68, 0
    v_mov_b32 v69, 0
    v_mov_b32 v70, 0
    v_mov_b32 v71, 0
    s_nop 1
    v_smfmac_f32_16x16x64_bf16 v[64:67], v[24:27], a[192:199], v2
    v_smfmac_f32_16x16x64_bf16 v[68:71], v[24:27], a[224:231], v2
    v_smfmac_f32_16x16x64_bf16 v[64:67], v[28:31], a[200:207], v2
    v_smfmac_f32_16x16x64_bf16 v[68:71], v[28:31], a[232:239], v2
    v_smfmac_f32_16x16x64_bf16 v[64:67], v[32:35], a[208:215], v2
    v_smfmac_f32_16x16x64_bf16 v[68:71], v[32:35], a[240:247], v2
    s_branch .gc_87
.gl_81:
    buffer_load_dwordx4 v[36:39], v4, s[8:11], s30 offen offset:3072 sc1
.gc_87:
    s_add_u32 s62, s62, 1
    s_cmp_gt_u32 s62, 0x100000
    s_cbranch_scc1 .mg_end_1
    s_waitcnt vmcnt(0)
    v_cmp_eq_u32 vcc, -1, v39
    s_cbranch_vccnz .gl_81
    v_smfmac_f32_16x16x64_bf16 v[64:67], v[36:39], a[216:223], v2
    v_smfmac_f32_16x16x64_bf16 v[68:71], v[36:39], a[248:255], v2
    s_branch .gr_80
.pr_83:
    s_add_u32 s62, s62, 1
    s_cmp_gt_u32 s62, 0x100000
    s_cbranch_scc1 .mg_end_1
    s_branch .pl_82
.w2_19:
    s_lshl_b32 s4, s56, 9
    s_lshl_b32 s5, s53, 7
    s_add_u32 s4, s4, s5
    s_add_u32 s4, s4, 92274688
    v_mov_b32 v14, s4
    v_bfe_u32 v254, v1, 0, 6
    v_mul_u32_u24 v12, 16, v254
    v_add_u32 v12, 17920, v12
    v_bfe_u32 v254, v1, 0, 6
    v_mul_u32_u24 v15, 16, v254
    s_add_u32 s42, s42, 262144
    s_add_u32 s43, s43, 262144
    s_add_u32 s44, s44, 262144
    s_mov_b32 exec_hi, 0
    v_xor_b32 v244, 1024, v244
    s_mov_b32 exec_hi, -1
    buffer_load_dwordx4 v[24:27], v246, s[8:11], s32 offen sc1
    buffer_load_dwordx4 v[28:31], v245, s[8:11], s32 offen sc1
    s_waitcnt vmcnt(0)
    ds_read_b64_tr_b16 a[192:193], v242 offset:16384
    ds_read_b64_tr_b16 a[194:195], v242 offset:16896
    ds_read_b64_tr_b16 a[196:197], v242 offset:18432
    ds_read_b64_tr_b16 a[198:199], v242 offset:18944
    ds_read_b64_tr_b16 a[200:201], v242 offset:20480
    ds_read_b64_tr_b16 a[202:203], v242 offset:20992
    ds_read_b64_tr_b16 a[204:205], v242 offset:22528
    ds_read_b64_tr_b16 a[206:207], v242 offset:23040
    ds_read_b64_tr_b16 a[208:209], v242 offset:24576
    ds_read_b64_tr_b16 a[210:211], v242 offset:25088
    ds_read_b64_tr_b16 a[212:213], v242 offset:26624
    ds_read_b64_tr_b16 a[214:215], v242 offset:27136
    ds_read_b64_tr_b16 a[216:217], v242 offset:28672
    ds_read_b64_tr_b16 a[218:219], v242 offset:29184
    ds_read_b64_tr_b16 a[220:221], v242 offset:30720
    ds_read_b64_tr_b16 a[222:223], v242 offset:31232
    ds_read_b64_tr_b16 a[224:225], v243 offset:16384
    ds_read_b64_tr_b16 a[226:227], v243 offset:16896
    ds_read_b64_tr_b16 a[228:229], v243 offset:18432
    ds_read_b64_tr_b16 a[230:231], v243 offset:18944
    ds_read_b64_tr_b16 a[232:233], v243 offset:20480
    ds_read_b64_tr_b16 a[234:235], v243 offset:20992
    ds_read_b64_tr_b16 a[236:237], v243 offset:22528
    ds_read_b64_tr_b16 a[238:239], v243 offset:23040
    ds_read_b64_tr_b16 a[240:241], v243 offset:24576
    ds_read_b64_tr_b16 a[242:243], v243 offset:25088
    ds_read_b64_tr_b16 a[244:245], v243 offset:26624
    ds_read_b64_tr_b16 a[246:247], v243 offset:27136
    ds_read_b64_tr_b16 a[248:249], v243 offset:28672
    ds_read_b64_tr_b16 a[250:251], v243 offset:29184
    ds_read_b64_tr_b16 a[252:253], v243 offset:30720
    ds_read_b64_tr_b16 a[254:255], v243 offset:31232
    s_waitcnt lgkmcnt(0)
    s_barrier
.p2align 6
.step_88:
    s_barrier
    s_setprio 3
    buffer_load_dwordx4 v[24:27], v3, s[8:11], s30 offen offset:0 sc1
    s_setprio 2
    buffer_load_dwordx4 v[28:31], v3, s[8:11], s30 offen offset:1024 sc1
    s_setprio 1
    buffer_load_dwordx4 v[32:35], v3, s[8:11], s30 offen offset:2048 sc1
    s_setprio 0
    buffer_load_dwordx4 v[36:39], v3, s[8:11], s30 offen offset:3072 sc1
    s_waitcnt vmcnt(3)
    v_max_u32 v18, v25, v27
    v_cmp_eq_u32 vcc, -1, v18
    s_cbranch_vccnz .gs_90
.gr_91:
    v_smfmac_f32_16x16x64_bf16 v[40:43], v[24:27], a[0:7], v2
    v_smfmac_f32_16x16x64_bf16 v[44:47], v[24:27], a[32:39], v2
    s_waitcnt vmcnt(2)
    v_max_u32 v18, v29, v31
    v_cmp_eq_u32 vcc, -1, v18
    v_smfmac_f32_16x16x64_bf16 v[48:51], v[24:27], a[64:71], v2
    s_cbranch_vccnz .gs_93
.gr_94:
    v_smfmac_f32_16x16x64_bf16 v[40:43], v[28:31], a[8:15], v2
    v_smfmac_f32_16x16x64_bf16 v[44:47], v[28:31], a[40:47], v2
    v_smfmac_f32_16x16x64_bf16 v[52:55], v[24:27], a[96:103], v2
    s_waitcnt vmcnt(1)
    v_max_u32 v18, v33, v35
    v_cmp_eq_u32 vcc, -1, v18
    v_smfmac_f32_16x16x64_bf16 v[48:51], v[28:31], a[72:79], v2
    s_cbranch_vccnz .gs_96
.gr_97:
    v_smfmac_f32_16x16x64_bf16 v[40:43], v[32:35], a[16:23], v2
    v_smfmac_f32_16x16x64_bf16 v[44:47], v[32:35], a[48:55], v2
    v_smfmac_f32_16x16x64_bf16 v[52:55], v[28:31], a[104:111], v2
    s_waitcnt vmcnt(0)
    v_max_u32 v18, v37, v39
    v_cmp_eq_u32 vcc, -1, v18
    v_smfmac_f32_16x16x64_bf16 v[48:51], v[32:35], a[80:87], v2
    s_cbranch_vccnz .gs_99
.gr_100:
    v_smfmac_f32_16x16x64_bf16 v[40:43], v[36:39], a[24:31], v2
    v_smfmac_f32_16x16x64_bf16 v[44:47], v[36:39], a[56:63], v2
    v_smfmac_f32_16x16x64_bf16 v[52:55], v[32:35], a[112:119], v2
    v_smfmac_f32_16x16x64_bf16 v[48:51], v[36:39], a[88:95], v2
    v_permlane32_swap_b32 v40, v44
    v_permlane32_swap_b32 v41, v45
    v_smfmac_f32_16x16x64_bf16 v[52:55], v[36:39], a[120:127], v2
    v_permlane32_swap_b32 v42, v46
    v_permlane32_swap_b32 v43, v47
    v_add_f32 v40, v40, v44
    v_add_f32 v41, v41, v45
    v_add_f32 v42, v42, v46
    v_add_f32 v43, v43, v47
    ds_write2_b32 v5, v40, v41 offset0:0 offset1:36
    ds_write2_b32 v5, v42, v43 offset0:72 offset1:108
    v_permlane32_swap_b32 v48, v52
    v_permlane32_swap_b32 v49, v53
    v_permlane32_swap_b32 v50, v54
    v_permlane32_swap_b32 v51, v55
    v_pk_add_f32 v[48:49], v[48:49], v[52:53]
    v_pk_add_f32 v[50:51], v[50:51], v[54:55]
    ds_write2_b32 v6, v48, v49 offset0:0 offset1:36
    ds_write2_b32 v6, v50, v51 offset0:72 offset1:108
    s_waitcnt lgkmcnt(2)
    s_barrier
    s_waitcnt lgkmcnt(0)
    s_barrier
    ds_read_b64 v[72:73], v9 offset:0
    ds_read_b64 v[74:75], v9 offset:1152
    ds_read_b64 v[76:77], v9 offset:2304
    ds_read_b64 v[78:79], v9 offset:3456
    s_waitcnt lgkmcnt(2)
    v_pk_add_f32 v[72:73], v[72:73], v[74:75]
    s_waitcnt lgkmcnt(0)
    v_pk_add_f32 v[76:77], v[76:77], v[78:79]
    v_pk_add_f32 v[72:73], v[72:73], v[76:77]
    v_cvt_pk_bf16_f32 v72, v72, v73
    v_min_u32 v72, 0xfffffffe, v72
    buffer_store_dword v72, v10, s[8:11], s30 offen
    v_smfmac_f32_16x16x64_bf16 v[56:59], v[24:27], a[128:135], v2
    v_smfmac_f32_16x16x64_bf16 v[60:63], v[24:27], a[160:167], v2
    v_smfmac_f32_16x16x64_bf16 v[56:59], v[28:31], a[136:143], v2
    v_smfmac_f32_16x16x64_bf16 v[60:63], v[28:31], a[168:175], v2
    v_smfmac_f32_16x16x64_bf16 v[56:59], v[32:35], a[144:151], v2
    v_smfmac_f32_16x16x64_bf16 v[60:63], v[32:35], a[176:183], v2
    v_smfmac_f32_16x16x64_bf16 v[56:59], v[36:39], a[152:159], v2
    v_smfmac_f32_16x16x64_bf16 v[60:63], v[36:39], a[184:191], v2
    ds_write_b32 v11, v72
    v_mov_b32 v40, 0
    v_mov_b32 v41, 0
    v_mov_b32 v42, 0
    v_mov_b32 v43, 0
    v_mov_b32 v44, 0
    v_mov_b32 v45, 0
    v_mov_b32 v46, 0
    v_mov_b32 v47, 0
    v_permlane32_swap_b32 v56, v60
    v_permlane32_swap_b32 v57, v61
    v_permlane32_swap_b32 v58, v62
    v_permlane32_swap_b32 v59, v63
    v_pk_add_f32 v[56:57], v[56:57], v[60:61]
    v_pk_add_f32 v[58:59], v[58:59], v[62:63]
    ds_write_b128 v8, v[56:59]
    s_waitcnt lgkmcnt(0)
    s_barrier
    s_barrier
    ds_read_b128 v[72:75], v12
    s_cmp_eq_u32 s28, 63
    s_cbranch_scc1 .fin_89
    s_waitcnt lgkmcnt(0)
    buffer_store_dwordx4 v[72:75], v244, s[8:11], s41 offen sc1
    v_mov_b32 v48, 0
    v_mov_b32 v49, 0
    v_mov_b32 v50, 0
    v_mov_b32 v51, 0
    v_mov_b32 v52, 0
    v_mov_b32 v53, 0
    v_mov_b32 v54, 0
    v_mov_b32 v55, 0
    v_mov_b32 v56, 0
    v_mov_b32 v57, 0
    v_mov_b32 v58, 0
    v_mov_b32 v59, 0
    v_mov_b32 v60, 0
    v_mov_b32 v61, 0
    v_mov_b32 v62, 0
    v_mov_b32 v63, 0
    s_barrier
    s_setprio 3
    buffer_load_dwordx4 v[24:27], v4, s[8:11], s30 offen offset:0 sc1
    s_setprio 2
    buffer_load_dwordx4 v[28:31], v4, s[8:11], s30 offen offset:1024 sc1
    s_setprio 1
    buffer_load_dwordx4 v[32:35], v4, s[8:11], s30 offen offset:2048 sc1
    s_setprio 0
    buffer_load_dwordx4 v[36:39], v4, s[8:11], s30 offen offset:3072 sc1
    s_waitcnt vmcnt(3)
    v_smfmac_f32_16x16x64_bf16 v[64:67], v[24:27], a[192:199], v2
    v_cmp_eq_u32 vcc, -1, v27
    v_smfmac_f32_16x16x64_bf16 v[68:71], v[24:27], a[224:231], v2
    s_cbranch_vccnz .gs_102
.gr_103:
    s_waitcnt vmcnt(2)
    v_smfmac_f32_16x16x64_bf16 v[64:67], v[28:31], a[200:207], v2
    v_cmp_eq_u32 vcc, -1, v31
    v_smfmac_f32_16x16x64_bf16 v[68:71], v[28:31], a[232:239], v2
    s_cbranch_vccnz .gs_105
.gr_106:
    s_waitcnt vmcnt(1)
    v_smfmac_f32_16x16x64_bf16 v[64:67], v[32:35], a[208:215], v2
    v_cmp_eq_u32 vcc, -1, v35
    v_smfmac_f32_16x16x64_bf16 v[68:71], v[32:35], a[240:247], v2
    s_cbranch_vccnz .gs_108
.gr_109:
    s_waitcnt vmcnt(0)
    v_smfmac_f32_16x16x64_bf16 v[64:67], v[36:39], a[216:223], v2
    v_cmp_eq_u32 vcc, -1, v39
    v_smfmac_f32_16x16x64_bf16 v[68:71], v[36:39], a[248:255], v2
    s_cbranch_vccnz .gs_111
.gr_112:
    s_nop 6
    v_permlane32_swap_b32 v64, v68
    v_permlane32_swap_b32 v65, v69
    v_permlane32_swap_b32 v66, v70
    v_permlane32_swap_b32 v67, v71
    v_pk_add_f32 v[64:65], v[64:65], v[68:69]
    v_pk_add_f32 v[66:67], v[66:67], v[70:71]
    ds_write2_b32 v7, v64, v65 offset0:0 offset1:36
    ds_write2_b32 v7, v66, v67 offset0:72 offset1:108
    s_waitcnt lgkmcnt(0)
    s_barrier
    s_cmp_lt_u32 s28, 52
    s_cselect_b32 s4, 3, 0
    s_andn2_b32 s4, s4, s28
    s_cbranch_scc1 .nl_114
    v_mov_b32 v18, s28
    v_add_u32 v18, 1, v18
    s_mov_b64 exec, 1
    buffer_store_dword v18, v14, s[8:11], 0 offen sc1
    s_mov_b64 exec, -1
.nl_114:
    v_mov_b32 v64, 0
    v_mov_b32 v65, 0
    v_mov_b32 v66, 0
    v_mov_b32 v67, 0
    v_mov_b32 v68, 0
    v_mov_b32 v69, 0
    v_mov_b32 v70, 0
    v_mov_b32 v71, 0
    s_mov_b32 s4, s30
    s_mov_b32 s30, s31
    s_mov_b32 s31, s32
    s_mov_b32 s32, s33
    s_mov_b32 s33, s4
    s_add_u32 s28, s28, 1
    s_mov_b32 s62, 0
    s_add_u32 s41, s41, 0x20000
    s_branch .step_88
.fin_89:
    s_waitcnt lgkmcnt(0)
    buffer_store_dwordx4 v[72:75], v244, s[8:11], s41 offen sc1
    s_waitcnt vmcnt(0)
    v_mov_b32 v18, 64
    s_mov_b64 exec, 1
    buffer_store_dword v18, v14, s[8:11], 0 offen sc1
    s_mov_b64 exec, -1
    s_endpgm
.gs_90:
    buffer_load_dwordx4 v[24:27], v3, s[8:11], s30 offen offset:0 sc1
    buffer_load_dwordx4 v[28:31], v3, s[8:11], s30 offen offset:1024 sc1
    buffer_load_dwordx4 v[32:35], v3, s[8:11], s30 offen offset:2048 sc1
    buffer_load_dwordx4 v[36:39], v3, s[8:11], s30 offen offset:3072 sc1
    s_add_u32 s62, s62, 1
    s_cmp_gt_u32 s62, 0x100000
    s_cbranch_scc1 .mg_end_1
    s_waitcnt vmcnt(3)
    v_max_u32 v18, v25, v27
    v_cmp_eq_u32 vcc, -1, v18
    s_cbranch_vccz .gr_91
    s_branch .gs_90
.gs_93:
    buffer_load_dwordx4 v[28:31], v3, s[8:11], s30 offen offset:1024 sc1
    buffer_load_dwordx4 v[32:35], v3, s[8:11], s30 offen offset:2048 sc1
    buffer_load_dwordx4 v[36:39], v3, s[8:11], s30 offen offset:3072 sc1
    s_add_u32 s62, s62, 1
    s_cmp_gt_u32 s62, 0x100000
    s_cbranch_scc1 .mg_end_1
    s_waitcnt vmcnt(2)
    v_max_u32 v18, v29, v31
    v_cmp_eq_u32 vcc, -1, v18
    s_cbranch_vccz .gr_94
    s_branch .gs_93
.gs_96:
    buffer_load_dwordx4 v[32:35], v3, s[8:11], s30 offen offset:2048 sc1
    buffer_load_dwordx4 v[36:39], v3, s[8:11], s30 offen offset:3072 sc1
    s_add_u32 s62, s62, 1
    s_cmp_gt_u32 s62, 0x100000
    s_cbranch_scc1 .mg_end_1
    s_waitcnt vmcnt(1)
    v_max_u32 v18, v33, v35
    v_cmp_eq_u32 vcc, -1, v18
    s_cbranch_vccz .gr_97
    s_branch .gs_96
.gs_99:
    buffer_load_dwordx4 v[36:39], v3, s[8:11], s30 offen offset:3072 sc1
    s_add_u32 s62, s62, 1
    s_cmp_gt_u32 s62, 0x100000
    s_cbranch_scc1 .mg_end_1
    s_waitcnt vmcnt(0)
    v_max_u32 v18, v37, v39
    v_cmp_eq_u32 vcc, -1, v18
    s_cbranch_vccz .gr_100
    s_branch .gs_99
.gs_102:
    buffer_load_dwordx4 v[24:27], v4, s[8:11], s30 offen offset:0 sc1
    buffer_load_dwordx4 v[28:31], v4, s[8:11], s30 offen offset:1024 sc1
    buffer_load_dwordx4 v[32:35], v4, s[8:11], s30 offen offset:2048 sc1
    buffer_load_dwordx4 v[36:39], v4, s[8:11], s30 offen offset:3072 sc1
    s_nop 2
    v_mov_b32 v64, 0
    v_mov_b32 v65, 0
    v_mov_b32 v66, 0
    v_mov_b32 v67, 0
    v_mov_b32 v68, 0
    v_mov_b32 v69, 0
    v_mov_b32 v70, 0
    v_mov_b32 v71, 0
    s_nop 1
    s_branch .gc_115
.gl_104:
    buffer_load_dwordx4 v[24:27], v4, s[8:11], s30 offen offset:0 sc1
    buffer_load_dwordx4 v[28:31], v4, s[8:11], s30 offen offset:1024 sc1
    buffer_load_dwordx4 v[32:35], v4, s[8:11], s30 offen offset:2048 sc1
    buffer_load_dwordx4 v[36:39], v4, s[8:11], s30 offen offset:3072 sc1
.gc_115:
    s_add_u32 s62, s62, 1
    s_cmp_gt_u32 s62, 0x100000
    s_cbranch_scc1 .mg_end_1
    s_waitcnt vmcnt(3)
    v_cmp_eq_u32 vcc, -1, v27
    s_cbranch_vccnz .gl_104
    v_smfmac_f32_16x16x64_bf16 v[64:67], v[24:27], a[192:199], v2
    v_smfmac_f32_16x16x64_bf16 v[68:71], v[24:27], a[224:231], v2
    s_branch .gr_103
.gs_105:
    buffer_load_dwordx4 v[28:31], v4, s[8:11], s30 offen offset:1024 sc1
    buffer_load_dwordx4 v[32:35], v4, s[8:11], s30 offen offset:2048 sc1
    buffer_load_dwordx4 v[36:39], v4, s[8:11], s30 offen offset:3072 sc1
    s_nop 3
    v_mov_b32 v64, 0
    v_mov_b32 v65, 0
    v_mov_b32 v66, 0
    v_mov_b32 v67, 0
    v_mov_b32 v68, 0
    v_mov_b32 v69, 0
    v_mov_b32 v70, 0
    v_mov_b32 v71, 0
    s_nop 1
    v_smfmac_f32_16x16x64_bf16 v[64:67], v[24:27], a[192:199], v2
    v_smfmac_f32_16x16x64_bf16 v[68:71], v[24:27], a[224:231], v2
    s_branch .gc_116
.gl_107:
    buffer_load_dwordx4 v[28:31], v4, s[8:11], s30 offen offset:1024 sc1
    buffer_load_dwordx4 v[32:35], v4, s[8:11], s30 offen offset:2048 sc1
    buffer_load_dwordx4 v[36:39], v4, s[8:11], s30 offen offset:3072 sc1
.gc_116:
    s_add_u32 s62, s62, 1
    s_cmp_gt_u32 s62, 0x100000
    s_cbranch_scc1 .mg_end_1
    s_waitcnt vmcnt(2)
    v_cmp_eq_u32 vcc, -1, v31
    s_cbranch_vccnz .gl_107
    v_smfmac_f32_16x16x64_bf16 v[64:67], v[28:31], a[200:207], v2
    v_smfmac_f32_16x16x64_bf16 v[68:71], v[28:31], a[232:239], v2
    s_branch .gr_106
.gs_108:
    buffer_load_dwordx4 v[32:35], v4, s[8:11], s30 offen offset:2048 sc1
    buffer_load_dwordx4 v[36:39], v4, s[8:11], s30 offen offset:3072 sc1
    s_nop 4
    v_mov_b32 v64, 0
    v_mov_b32 v65, 0
    v_mov_b32 v66, 0
    v_mov_b32 v67, 0
    v_mov_b32 v68, 0
    v_mov_b32 v69, 0
    v_mov_b32 v70, 0
    v_mov_b32 v71, 0
    s_nop 1
    v_smfmac_f32_16x16x64_bf16 v[64:67], v[24:27], a[192:199], v2
    v_smfmac_f32_16x16x64_bf16 v[68:71], v[24:27], a[224:231], v2
    v_smfmac_f32_16x16x64_bf16 v[64:67], v[28:31], a[200:207], v2
    v_smfmac_f32_16x16x64_bf16 v[68:71], v[28:31], a[232:239], v2
    s_branch .gc_117
.gl_110:
    buffer_load_dwordx4 v[32:35], v4, s[8:11], s30 offen offset:2048 sc1
    buffer_load_dwordx4 v[36:39], v4, s[8:11], s30 offen offset:3072 sc1
.gc_117:
    s_add_u32 s62, s62, 1
    s_cmp_gt_u32 s62, 0x100000
    s_cbranch_scc1 .mg_end_1
    s_waitcnt vmcnt(1)
    v_cmp_eq_u32 vcc, -1, v35
    s_cbranch_vccnz .gl_110
    v_smfmac_f32_16x16x64_bf16 v[64:67], v[32:35], a[208:215], v2
    v_smfmac_f32_16x16x64_bf16 v[68:71], v[32:35], a[240:247], v2
    s_branch .gr_109
.gs_111:
    buffer_load_dwordx4 v[36:39], v4, s[8:11], s30 offen offset:3072 sc1
    s_nop 5
    v_mov_b32 v64, 0
    v_mov_b32 v65, 0
    v_mov_b32 v66, 0
    v_mov_b32 v67, 0
    v_mov_b32 v68, 0
    v_mov_b32 v69, 0
    v_mov_b32 v70, 0
    v_mov_b32 v71, 0
    s_nop 1
    v_smfmac_f32_16x16x64_bf16 v[64:67], v[24:27], a[192:199], v2
    v_smfmac_f32_16x16x64_bf16 v[68:71], v[24:27], a[224:231], v2
    v_smfmac_f32_16x16x64_bf16 v[64:67], v[28:31], a[200:207], v2
    v_smfmac_f32_16x16x64_bf16 v[68:71], v[28:31], a[232:239], v2
    v_smfmac_f32_16x16x64_bf16 v[64:67], v[32:35], a[208:215], v2
    v_smfmac_f32_16x16x64_bf16 v[68:71], v[32:35], a[240:247], v2
    s_branch .gc_118
.gl_113:
    buffer_load_dwordx4 v[36:39], v4, s[8:11], s30 offen offset:3072 sc1
.gc_118:
    s_add_u32 s62, s62, 1
    s_cmp_gt_u32 s62, 0x100000
    s_cbranch_scc1 .mg_end_1
    s_waitcnt vmcnt(0)
    v_cmp_eq_u32 vcc, -1, v39
    s_cbranch_vccnz .gl_113
    v_smfmac_f32_16x16x64_bf16 v[64:67], v[36:39], a[216:223], v2
    v_smfmac_f32_16x16x64_bf16 v[68:71], v[36:39], a[248:255], v2
    s_branch .gr_112
.w3_20:
    v_bfe_u32 v254, v1, 3, 1
    v_mul_u32_u24 v12, 512, v254
    v_bfe_u32 v254, v1, 5, 1
    v_mul_u32_u24 v254, 256, v254
    v_add_u32 v12, v12, v254
    v_bfe_u32 v254, v1, 2, 1
    v_mul_u32_u24 v254, 128, v254
    v_add_u32 v12, v12, v254
    v_bfe_u32 v254, v1, 0, 2
    v_mul_u32_u24 v254, 16, v254
    v_add_u32 v12, v12, v254
    v_bfe_u32 v254, v1, 4, 1
    v_mul_u32_u24 v254, 8, v254
    v_add_u32 v12, v12, v254
    v_add_u32 v12, 13824, v12
    v_bfe_u32 v254, v1, 2, 2
    v_mul_u32_u24 v14, 128, v254
    v_bfe_u32 v254, v1, 0, 2
    v_mul_u32_u24 v254, 16, v254
    v_add_u32 v14, v14, v254
    v_bfe_u32 v254, v1, 4, 2
    v_mul_u32_u24 v254, 4, v254
    v_add_u32 v14, v14, v254
    v_add_u32 v14, 18432, v14
    v_bfe_u32 v254, v1, 0, 6
    v_mul_u32_u24 v15, 16, v254
    v_add_u32 v15, s101, v15
    v_bfe_u32 v254, v1, 2, 2
    v_mul_u32_u24 v16, 128, v254
    v_bfe_u32 v254, v1, 0, 2
    v_mul_u32_u24 v254, 16, v254
    v_add_u32 v16, v16, v254
    v_bfe_u32 v254, v1, 4, 2
    v_mul_u32_u24 v254, 4, v254
    v_add_u32 v16, v16, v254
    v_add_u32 v16, 135168, v16
    v_add_u32 v16, s58, v16
    s_lshl_b32 s4, s56, 9
    s_add_u32 s4, s4, 92291072
    v_bfe_u32 v254, v1, 0, 2
    v_mul_u32_u24 v13, 128, v254
    v_bfe_u32 v254, v1, 2, 1
    v_mul_u32_u24 v254, 16384, v254
    v_add_u32 v13, v13, v254
    v_add_u32 v13, s4, v13
    buffer_load_dwordx4 v[24:27], v246, s[8:11], s33 offen sc1
    buffer_load_dwordx4 v[28:31], v245, s[8:11], s33 offen sc1
    s_waitcnt vmcnt(0)
    ds_read_b64_tr_b16 a[192:193], v242 offset:16384
    ds_read_b64_tr_b16 a[194:195], v242 offset:16896
    ds_read_b64_tr_b16 a[196:197], v242 offset:18432
    ds_read_b64_tr_b16 a[198:199], v242 offset:18944
    ds_read_b64_tr_b16 a[200:201], v242 offset:20480
    ds_read_b64_tr_b16 a[202:203], v242 offset:20992
    ds_read_b64_tr_b16 a[204:205], v242 offset:22528
    ds_read_b64_tr_b16 a[206:207], v242 offset:23040
    ds_read_b64_tr_b16 a[208:209], v242 offset:24576
    ds_read_b64_tr_b16 a[210:211], v242 offset:25088
    ds_read_b64_tr_b16 a[212:213], v242 offset:26624
    ds_read_b64_tr_b16 a[214:215], v242 offset:27136
    ds_read_b64_tr_b16 a[216:217], v242 offset:28672
    ds_read_b64_tr_b16 a[218:219], v242 offset:29184
    ds_read_b64_tr_b16 a[220:221], v242 offset:30720
    ds_read_b64_tr_b16 a[222:223], v242 offset:31232
    ds_read_b64_tr_b16 a[224:225], v243 offset:16384
    ds_read_b64_tr_b16 a[226:227], v243 offset:16896
    ds_read_b64_tr_b16 a[228:229], v243 offset:18432
    ds_read_b64_tr_b16 a[230:231], v243 offset:18944
    ds_read_b64_tr_b16 a[232:233], v243 offset:20480
    ds_read_b64_tr_b16 a[234:235], v243 offset:20992
    ds_read_b64_tr_b16 a[236:237], v243 offset:22528
    ds_read_b64_tr_b16 a[238:239], v243 offset:23040
    ds_read_b64_tr_b16 a[240:241], v243 offset:24576
    ds_read_b64_tr_b16 a[242:243], v243 offset:25088
    ds_read_b64_tr_b16 a[244:245], v243 offset:26624
    ds_read_b64_tr_b16 a[246:247], v243 offset:27136
    ds_read_b64_tr_b16 a[248:249], v243 offset:28672
    ds_read_b64_tr_b16 a[250:251], v243 offset:29184
    ds_read_b64_tr_b16 a[252:253], v243 offset:30720
    ds_read_b64_tr_b16 a[254:255], v243 offset:31232
    s_waitcnt lgkmcnt(0)
    s_cmp_ge_u32 s46, 1
    s_cbranch_scc1 .kvd_120
    s_mov_b32 s62, 0
.kv_119:
    buffer_load_dword v18, v13, s[8:11], 0 offen sc1
    s_add_u32 s62, s62, 1
    s_cmp_gt_u32 s62, 0x100000
    s_cbranch_scc1 .mg_end_1
    s_waitcnt vmcnt(0)
    v_min_u32_dpp v18, v18, v18 quad_perm:[1,0,3,2] row_mask:0xf bank_mask:0xf
    s_nop 1
    v_min_u32_dpp v18, v18, v18 quad_perm:[2,3,0,1] row_mask:0xf bank_mask:0xf
    s_nop 1
    v_min_u32_dpp v18, v18, v18 row_half_mirror row_mask:0xf bank_mask:0xf
    s_nop 0
    v_readfirstlane_b32 s46, v18
    s_cmp_lt_u32 s46, 1
    s_cbranch_scc1 .kv_119
.kvd_120:
    s_barrier
.p2align 6
.step_121:
    s_barrier
    s_setprio 3
    buffer_load_dwordx4 v[24:27], v3, s[8:11], s30 offen offset:0 sc1
    s_setprio 2
    buffer_load_dwordx4 v[28:31], v3, s[8:11], s30 offen offset:1024 sc1
    s_setprio 1
    buffer_load_dwordx4 v[32:35], v3, s[8:11], s30 offen offset:2048 sc1
    s_setprio 0
    buffer_load_dwordx4 v[36:39], v3, s[8:11], s30 offen offset:3072 sc1
    s_waitcnt vmcnt(3)
    v_max_u32 v18, v25, v27
    v_cmp_eq_u32 vcc, -1, v18
    s_cbranch_vccnz .gs_123
.gr_124:
    v_smfmac_f32_16x16x64_bf16 v[40:43], v[24:27], a[0:7], v2
    v_smfmac_f32_16x16x64_bf16 v[44:47], v[24:27], a[32:39], v2
    s_waitcnt vmcnt(2)
    v_max_u32 v18, v29, v31
    v_cmp_eq_u32 vcc, -1, v18
    v_smfmac_f32_16x16x64_bf16 v[48:51], v[24:27], a[64:71], v2
    s_cbranch_vccnz .gs_126
.gr_127:
    v_smfmac_f32_16x16x64_bf16 v[40:43], v[28:31], a[8:15], v2
    v_smfmac_f32_16x16x64_bf16 v[44:47], v[28:31], a[40:47], v2
    v_smfmac_f32_16x16x64_bf16 v[52:55], v[24:27], a[96:103], v2
    s_waitcnt vmcnt(1)
    v_max_u32 v18, v33, v35
    v_cmp_eq_u32 vcc, -1, v18
    v_smfmac_f32_16x16x64_bf16 v[48:51], v[28:31], a[72:79], v2
    s_cbranch_vccnz .gs_129
.gr_130:
    v_smfmac_f32_16x16x64_bf16 v[40:43], v[32:35], a[16:23], v2
    v_smfmac_f32_16x16x64_bf16 v[44:47], v[32:35], a[48:55], v2
    v_smfmac_f32_16x16x64_bf16 v[52:55], v[28:31], a[104:111], v2
    s_waitcnt vmcnt(0)
    v_max_u32 v18, v37, v39
    v_cmp_eq_u32 vcc, -1, v18
    v_smfmac_f32_16x16x64_bf16 v[48:51], v[32:35], a[80:87], v2
    s_cbranch_vccnz .gs_132
.gr_133:
    v_smfmac_f32_16x16x64_bf16 v[40:43], v[36:39], a[24:31], v2
    v_smfmac_f32_16x16x64_bf16 v[44:47], v[36:39], a[56:63], v2
    v_smfmac_f32_16x16x64_bf16 v[52:55], v[32:35], a[112:119], v2
    v_smfmac_f32_16x16x64_bf16 v[48:51], v[36:39], a[88:95], v2
    v_permlane32_swap_b32 v40, v44
    v_permlane32_swap_b32 v41, v45
    v_smfmac_f32_16x16x64_bf16 v[52:55], v[36:39], a[120:127], v2
    v_permlane32_swap_b32 v42, v46
    v_permlane32_swap_b32 v43, v47
    v_add_f32 v40, v40, v44
    v_add_f32 v41, v41, v45
    v_add_f32 v42, v42, v46
    v_add_f32 v43, v43, v47
    ds_write2_b32 v5, v40, v41 offset0:0 offset1:36
    ds_write2_b32 v5, v42, v43 offset0:72 offset1:108
    v_permlane32_swap_b32 v48, v52
    v_permlane32_swap_b32 v49, v53
    v_permlane32_swap_b32 v50, v54
    v_permlane32_swap_b32 v51, v55
    v_pk_add_f32 v[48:49], v[48:49], v[52:53]
    v_pk_add_f32 v[50:51], v[50:51], v[54:55]
    ds_write2_b32 v6, v48, v49 offset0:0 offset1:36
    ds_write2_b32 v6, v50, v51 offset0:72 offset1:108
    s_waitcnt lgkmcnt(2)
    s_barrier
    s_waitcnt lgkmcnt(0)
    s_barrier
    ds_read_b64 v[72:73], v9 offset:0
    ds_read_b64 v[74:75], v9 offset:1152
    ds_read_b64 v[76:77], v9 offset:2304
    ds_read_b64 v[78:79], v9 offset:3456
    s_waitcnt lgkmcnt(2)
    v_pk_add_f32 v[72:73], v[72:73], v[74:75]
    s_waitcnt lgkmcnt(0)
    v_pk_add_f32 v[76:77], v[76:77], v[78:79]
    v_pk_add_f32 v[72:73], v[72:73], v[76:77]
    v_cvt_pk_bf16_f32 v72, v72, v73
    v_min_u32 v72, 0xfffffffe, v72
    buffer_store_dword v72, v10, s[8:11], s30 offen
    v_smfmac_f32_16x16x64_bf16 v[56:59], v[24:27], a[128:135], v2
    v_smfmac_f32_16x16x64_bf16 v[60:63], v[24:27], a[160:167], v2
    v_smfmac_f32_16x16x64_bf16 v[56:59], v[28:31], a[136:143], v2
    v_smfmac_f32_16x16x64_bf16 v[60:63], v[28:31], a[168:175], v2
    v_smfmac_f32_16x16x64_bf16 v[56:59], v[32:35], a[144:151], v2
    v_smfmac_f32_16x16x64_bf16 v[60:63], v[32:35], a[176:183], v2
    v_smfmac_f32_16x16x64_bf16 v[56:59], v[36:39], a[152:159], v2
    v_smfmac_f32_16x16x64_bf16 v[60:63], v[36:39], a[184:191], v2
    ds_write_b32 v11, v72
    v_mov_b32 v40, 0
    v_mov_b32 v41, 0
    v_mov_b32 v42, 0
    v_mov_b32 v43, 0
    v_mov_b32 v44, 0
    v_mov_b32 v45, 0
    v_mov_b32 v46, 0
    v_mov_b32 v47, 0
    v_permlane32_swap_b32 v56, v60
    v_permlane32_swap_b32 v57, v61
    v_permlane32_swap_b32 v58, v62
    v_permlane32_swap_b32 v59, v63
    v_pk_add_f32 v[56:57], v[56:57], v[60:61]
    v_pk_add_f32 v[58:59], v[58:59], v[62:63]
    ds_write_b128 v8, v[56:59]
    s_waitcnt lgkmcnt(0)
    s_barrier
    ds_read_b64 v[72:73], v12 offset:0
    ds_read_b64 v[74:75], v12 offset:1024
    ds_read_b64 v[76:77], v12 offset:2048
    ds_read_b64 v[78:79], v12 offset:3072
    ds_read_b64 v[80:81], v12 offset:64
    ds_read_b64 v[82:83], v12 offset:1088
    ds_read_b64 v[84:85], v12 offset:2112
    ds_read_b64 v[86:87], v12 offset:3136
    s_waitcnt lgkmcnt(4)
    v_add_f32 v72, v72, v74
    v_add_f32 v73, v73, v75
    v_add_f32 v76, v76, v78
    v_add_f32 v77, v77, v79
    v_add_f32 v72, v72, v76
    v_add_f32 v73, v73, v77
    v_cvt_pk_bf16_f32 v72, v72, v73
    s_waitcnt lgkmcnt(0)
    v_add_f32 v80, v80, v82
    v_add_f32 v81, v81, v83
    v_add_f32 v84, v84, v86
    v_add_f32 v85, v85, v87
    v_add_f32 v80, v80, v84
    v_add_f32 v81, v81, v85
    v_cvt_pk_bf16_f32 v80, v80, v81
    ds_write_b32 v14, v72
    ds_write_b32 v14, v80 offset:64
    s_waitcnt lgkmcnt(0)
    s_barrier
    s_cmp_eq_u32 s28, 63
    s_cbranch_scc1 .fin_122
    s_add_u32 s5, s28, 2
    s_cmp_ge_u32 s46, s5
    s_cbranch_scc1 .kvd_136
    s_mov_b32 s62, 0
.kv_135:
    buffer_load_dword v18, v13, s[8:11], 0 offen sc1
    s_add_u32 s62, s62, 1
    s_cmp_gt_u32 s62, 0x100000
    s_cbranch_scc1 .mg_end_1
    s_waitcnt vmcnt(0)
    v_min_u32_dpp v18, v18, v18 quad_perm:[1,0,3,2] row_mask:0xf bank_mask:0xf
    s_nop 1
    v_min_u32_dpp v18, v18, v18 quad_perm:[2,3,0,1] row_mask:0xf bank_mask:0xf
    s_nop 1
    v_min_u32_dpp v18, v18, v18 row_half_mirror row_mask:0xf bank_mask:0xf
    s_nop 0
    v_readfirstlane_b32 s46, v18
    s_cmp_lt_u32 s46, s5
    s_cbranch_scc1 .kv_135
.kvd_136:
    v_mov_b32 v48, 0
    v_mov_b32 v49, 0
    v_mov_b32 v50, 0
    v_mov_b32 v51, 0
    v_mov_b32 v52, 0
    v_mov_b32 v53, 0
    v_mov_b32 v54, 0
    v_mov_b32 v55, 0
    v_mov_b32 v56, 0
    v_mov_b32 v57, 0
    v_mov_b32 v58, 0
    v_mov_b32 v59, 0
    v_mov_b32 v60, 0
    v_mov_b32 v61, 0
    v_mov_b32 v62, 0
    v_mov_b32 v63, 0
    s_barrier
    s_setprio 3
    buffer_load_dwordx4 v[24:27], v4, s[8:11], s30 offen offset:0 sc1
    s_setprio 2
    buffer_load_dwordx4 v[28:31], v4, s[8:11], s30 offen offset:1024 sc1
    s_setprio 1
    buffer_load_dwordx4 v[32:35], v4, s[8:11], s30 offen offset:2048 sc1
    s_setprio 0
    buffer_load_dwordx4 v[36:39], v4, s[8:11], s30 offen offset:3072 sc1
    s_waitcnt vmcnt(3)
    v_smfmac_f32_16x16x64_bf16 v[64:67], v[24:27], a[192:199], v2
    v_cmp_eq_u32 vcc, -1, v27
    v_smfmac_f32_16x16x64_bf16 v[68:71], v[24:27], a[224:231], v2
    s_cbranch_vccnz .gs_137
.gr_138:
    s_waitcnt vmcnt(2)
    v_smfmac_f32_16x16x64_bf16 v[64:67], v[28:31], a[200:207], v2
    v_cmp_eq_u32 vcc, -1, v31
    v_smfmac_f32_16x16x64_bf16 v[68:71], v[28:31], a[232:239], v2
    s_cbranch_vccnz .gs_140
.gr_141:
    s_waitcnt vmcnt(1)
    v_smfmac_f32_16x16x64_bf16 v[64:67], v[32:35], a[208:215], v2
    v_cmp_eq_u32 vcc, -1, v35
    v_smfmac_f32_16x16x64_bf16 v[68:71], v[32:35], a[240:247], v2
    s_cbranch_vccnz .gs_143
.gr_144:
    s_waitcnt vmcnt(0)
    v_smfmac_f32_16x16x64_bf16 v[64:67], v[36:39], a[216:223], v2
    v_cmp_eq_u32 vcc, -1, v39
    v_smfmac_f32_16x16x64_bf16 v[68:71], v[36:39], a[248:255], v2
    s_cbranch_vccnz .gs_146
.gr_147:
    s_nop 6
    v_permlane32_swap_b32 v64, v68
    v_permlane32_swap_b32 v65, v69
    v_permlane32_swap_b32 v66, v70
    v_permlane32_swap_b32 v67, v71
    v_pk_add_f32 v[64:65], v[64:65], v[68:69]
    v_pk_add_f32 v[66:67], v[66:67], v[70:71]
    ds_write2_b32 v7, v64, v65 offset0:0 offset1:36
    ds_write2_b32 v7, v66, v67 offset0:72 offset1:108
    s_waitcnt lgkmcnt(0)
    s_barrier
    buffer_store_dwordx4 v[20:23], v15, s[8:11], s36 offen sc1
    buffer_store_dwordx4 v[20:23], v244, s[8:11], s32 offen
    buffer_store_dwordx4 v[20:23], v245, s[8:11], s32 offen
    s_add_u32 s5, s28, 3
    s_min_u32 s5, s5, 64
    s_cmp_ge_u32 s46, s5
    s_cbranch_scc1 .kvd_150
    s_mov_b32 s62, 0
.kv_149:
    buffer_load_dword v18, v13, s[8:11], 0 offen sc1
    s_add_u32 s62, s62, 1
    s_cmp_gt_u32 s62, 0x100000
    s_cbranch_scc1 .mg_end_1
    s_waitcnt vmcnt(0)
    v_min_u32_dpp v18, v18, v18 quad_perm:[1,0,3,2] row_mask:0xf bank_mask:0xf
    s_nop 1
    v_min_u32_dpp v18, v18, v18 quad_perm:[2,3,0,1] row_mask:0xf bank_mask:0xf
    s_nop 1
    v_min_u32_dpp v18, v18, v18 row_half_mirror row_mask:0xf bank_mask:0xf
    s_nop 0
    v_readfirstlane_b32 s46, v18
.kvd_150:
    v_mov_b32 v64, 0
    v_mov_b32 v65, 0
    v_mov_b32 v66, 0
    v_mov_b32 v67, 0
    v_mov_b32 v68, 0
    v_mov_b32 v69, 0
    v_mov_b32 v70, 0
    v_mov_b32 v71, 0
    s_mov_b32 s4, s30
    s_mov_b32 s30, s31
    s_mov_b32 s31, s32
    s_mov_b32 s32, s33
    s_mov_b32 s33, s4
    s_add_u32 s28, s28, 1
    s_mov_b32 s62, 0
    s_mov_b32 s4, s34
    s_mov_b32 s34, s35
    s_mov_b32 s35, s36
    s_mov_b32 s36, s37
    s_mov_b32 s37, s4
    s_add_u32 s41, s41, 0x20000
    s_branch .step_121
.fin_122:
    s_endpgm
.gs_123:
    buffer_load_dwordx4 v[24:27], v3, s[8:11], s30 offen offset:0 sc1
    buffer_load_dwordx4 v[28:31], v3, s[8:11], s30 offen offset:1024 sc1
    buffer_load_dwordx4 v[32:35], v3, s[8:11], s30 offen offset:2048 sc1
    buffer_load_dwordx4 v[36:39], v3, s[8:11], s30 offen offset:3072 sc1
    s_add_u32 s62, s62, 1
    s_cmp_gt_u32 s62, 0x100000
    s_cbranch_scc1 .mg_end_1
    s_waitcnt vmcnt(3)
    v_max_u32 v18, v25, v27
    v_cmp_eq_u32 vcc, -1, v18
    s_cbranch_vccz .gr_124
    s_branch .gs_123
.gs_126:
    buffer_load_dwordx4 v[28:31], v3, s[8:11], s30 offen offset:1024 sc1
    buffer_load_dwordx4 v[32:35], v3, s[8:11], s30 offen offset:2048 sc1
    buffer_load_dwordx4 v[36:39], v3, s[8:11], s30 offen offset:3072 sc1
    s_add_u32 s62, s62, 1
    s_cmp_gt_u32 s62, 0x100000
    s_cbranch_scc1 .mg_end_1
    s_waitcnt vmcnt(2)
    v_max_u32 v18, v29, v31
    v_cmp_eq_u32 vcc, -1, v18
    s_cbranch_vccz .gr_127
    s_branch .gs_126
.gs_129:
    buffer_load_dwordx4 v[32:35], v3, s[8:11], s30 offen offset:2048 sc1
    buffer_load_dwordx4 v[36:39], v3, s[8:11], s30 offen offset:3072 sc1
    s_add_u32 s62, s62, 1
    s_cmp_gt_u32 s62, 0x100000
    s_cbranch_scc1 .mg_end_1
    s_waitcnt vmcnt(1)
    v_max_u32 v18, v33, v35
    v_cmp_eq_u32 vcc, -1, v18
    s_cbranch_vccz .gr_130
    s_branch .gs_129
.gs_132:
    buffer_load_dwordx4 v[36:39], v3, s[8:11], s30 offen offset:3072 sc1
    s_add_u32 s62, s62, 1
    s_cmp_gt_u32 s62, 0x100000
    s_cbranch_scc1 .mg_end_1
    s_waitcnt vmcnt(0)
    v_max_u32 v18, v37, v39
    v_cmp_eq_u32 vcc, -1, v18
    s_cbranch_vccz .gr_133
    s_branch .gs_132
.gs_137:
    buffer_load_dwordx4 v[24:27], v4, s[8:11], s30 offen offset:0 sc1
    buffer_load_dwordx4 v[28:31], v4, s[8:11], s30 offen offset:1024 sc1
    buffer_load_dwordx4 v[32:35], v4, s[8:11], s30 offen offset:2048 sc1
    buffer_load_dwordx4 v[36:39], v4, s[8:11], s30 offen offset:3072 sc1
    s_nop 2
    v_mov_b32 v64, 0
    v_mov_b32 v65, 0
    v_mov_b32 v66, 0
    v_mov_b32 v67, 0
    v_mov_b32 v68, 0
    v_mov_b32 v69, 0
    v_mov_b32 v70, 0
    v_mov_b32 v71, 0
    s_nop 1
    s_branch .gc_151
.gl_139:
    buffer_load_dwordx4 v[24:27], v4, s[8:11], s30 offen offset:0 sc1
    buffer_load_dwordx4 v[28:31], v4, s[8:11], s30 offen offset:1024 sc1
    buffer_load_dwordx4 v[32:35], v4, s[8:11], s30 offen offset:2048 sc1
    buffer_load_dwordx4 v[36:39], v4, s[8:11], s30 offen offset:3072 sc1
.gc_151:
    s_add_u32 s62, s62, 1
    s_cmp_gt_u32 s62, 0x100000
    s_cbranch_scc1 .mg_end_1
    s_waitcnt vmcnt(3)
    v_cmp_eq_u32 vcc, -1, v27
    s_cbranch_vccnz .gl_139
    v_smfmac_f32_16x16x64_bf16 v[64:67], v[24:27], a[192:199], v2
    v_smfmac_f32_16x16x64_bf16 v[68:71], v[24:27], a[224:231], v2
    s_branch .gr_138
.gs_140:
    buffer_load_dwordx4 v[28:31], v4, s[8:11], s30 offen offset:1024 sc1
    buffer_load_dwordx4 v[32:35], v4, s[8:11], s30 offen offset:2048 sc1
    buffer_load_dwordx4 v[36:39], v4, s[8:11], s30 offen offset:3072 sc1
    s_nop 3
    v_mov_b32 v64, 0
    v_mov_b32 v65, 0
    v_mov_b32 v66, 0
    v_mov_b32 v67, 0
    v_mov_b32 v68, 0
    v_mov_b32 v69, 0
    v_mov_b32 v70, 0
    v_mov_b32 v71, 0
    s_nop 1
    v_smfmac_f32_16x16x64_bf16 v[64:67], v[24:27], a[192:199], v2
    v_smfmac_f32_16x16x64_bf16 v[68:71], v[24:27], a[224:231], v2
    s_branch .gc_152
.gl_142:
    buffer_load_dwordx4 v[28:31], v4, s[8:11], s30 offen offset:1024 sc1
    buffer_load_dwordx4 v[32:35], v4, s[8:11], s30 offen offset:2048 sc1
    buffer_load_dwordx4 v[36:39], v4, s[8:11], s30 offen offset:3072 sc1
.gc_152:
    s_add_u32 s62, s62, 1
    s_cmp_gt_u32 s62, 0x100000
    s_cbranch_scc1 .mg_end_1
    s_waitcnt vmcnt(2)
    v_cmp_eq_u32 vcc, -1, v31
    s_cbranch_vccnz .gl_142
    v_smfmac_f32_16x16x64_bf16 v[64:67], v[28:31], a[200:207], v2
    v_smfmac_f32_16x16x64_bf16 v[68:71], v[28:31], a[232:239], v2
    s_branch .gr_141
.gs_143:
    buffer_load_dwordx4 v[32:35], v4, s[8:11], s30 offen offset:2048 sc1
    buffer_load_dwordx4 v[36:39], v4, s[8:11], s30 offen offset:3072 sc1
    s_nop 4
    v_mov_b32 v64, 0
    v_mov_b32 v65, 0
    v_mov_b32 v66, 0
    v_mov_b32 v67, 0
    v_mov_b32 v68, 0
    v_mov_b32 v69, 0
    v_mov_b32 v70, 0
    v_mov_b32 v71, 0
    s_nop 1
    v_smfmac_f32_16x16x64_bf16 v[64:67], v[24:27], a[192:199], v2
    v_smfmac_f32_16x16x64_bf16 v[68:71], v[24:27], a[224:231], v2
    v_smfmac_f32_16x16x64_bf16 v[64:67], v[28:31], a[200:207], v2
    v_smfmac_f32_16x16x64_bf16 v[68:71], v[28:31], a[232:239], v2
    s_branch .gc_153
.gl_145:
    buffer_load_dwordx4 v[32:35], v4, s[8:11], s30 offen offset:2048 sc1
    buffer_load_dwordx4 v[36:39], v4, s[8:11], s30 offen offset:3072 sc1
.gc_153:
    s_add_u32 s62, s62, 1
    s_cmp_gt_u32 s62, 0x100000
    s_cbranch_scc1 .mg_end_1
    s_waitcnt vmcnt(1)
    v_cmp_eq_u32 vcc, -1, v35
    s_cbranch_vccnz .gl_145
    v_smfmac_f32_16x16x64_bf16 v[64:67], v[32:35], a[208:215], v2
    v_smfmac_f32_16x16x64_bf16 v[68:71], v[32:35], a[240:247], v2
    s_branch .gr_144
.gs_146:
    buffer_load_dwordx4 v[36:39], v4, s[8:11], s30 offen offset:3072 sc1
    s_nop 5
    v_mov_b32 v64, 0
    v_mov_b32 v65, 0
    v_mov_b32 v66, 0
    v_mov_b32 v67, 0
    v_mov_b32 v68, 0
    v_mov_b32 v69, 0
    v_mov_b32 v70, 0
    v_mov_b32 v71, 0
    s_nop 1
    v_smfmac_f32_16x16x64_bf16 v[64:67], v[24:27], a[192:199], v2
    v_smfmac_f32_16x16x64_bf16 v[68:71], v[24:27], a[224:231], v2
    v_smfmac_f32_16x16x64_bf16 v[64:67], v[28:31], a[200:207], v2
    v_smfmac_f32_16x16x64_bf16 v[68:71], v[28:31], a[232:239], v2
    v_smfmac_f32_16x16x64_bf16 v[64:67], v[32:35], a[208:215], v2
    v_smfmac_f32_16x16x64_bf16 v[68:71], v[32:35], a[240:247], v2
    s_branch .gc_154
.gl_148:
    buffer_load_dwordx4 v[36:39], v4, s[8:11], s30 offen offset:3072 sc1
.gc_154:
    s_add_u32 s62, s62, 1
    s_cmp_gt_u32 s62, 0x100000
    s_cbranch_scc1 .mg_end_1
    s_waitcnt vmcnt(0)
    v_cmp_eq_u32 vcc, -1, v39
    s_cbranch_vccnz .gl_148
    v_smfmac_f32_16x16x64_bf16 v[64:67], v[36:39], a[216:223], v2
    v_smfmac_f32_16x16x64_bf16 v[68:71], v[36:39], a[248:255], v2
    s_branch .gr_147
.slowv_16:
    s_mov_b32 s28, 0
    s_mov_b32 s30, 83886080
    s_mov_b32 s31, 84148224
    s_mov_b32 s32, 84410368
    s_mov_b32 s33, 84672512
    s_mov_b32 s41, 66977792
    s_lshl_b32 s42, s56, 13
    s_lshl_b32 s4, s53, 11
    s_add_u32 s44, s42, s4
    s_add_u32 s44, s44, 33554432
    s_add_u32 s42, s42, 16777216
    s_add_u32 s43, s42, 4096
    s_add_u32 s96, s44, 524288
    s_sub_u32 s95, s96, 16777216
    s_mov_b32 s62, 0
    s_mov_b32 s45, 0x3e0293ee
    s_mov_b32 s46, 0
    s_and_b32 s4, s25, 1
    s_lshl_b32 s4, s4, 14
    s_lshr_b32 s5, s25, 1
    s_lshl_b32 s5, s5, 12
    s_or_b32 s4, s4, s5
    s_xor_b32 s47, s47, s4
    s_and_b32 s5, s26, 1
    s_lshl_b32 s5, s5, 10
    s_lshr_b32 s4, s26, 1
    s_lshl_b32 s4, s4, 15
    s_or_b32 s5, s5, s4
    s_bfe_u32 s4, s26, 0x10004
    s_lshl_b32 s4, s4, 11
    s_xor_b32 s5, s5, s4
    s_xor_b32 s34, s5, s47
    s_xor_b32 s35, s34, 0x84000
    s_xor_b32 s36, s34, 0x101000
    s_xor_b32 s37, s34, 0x185000
    s_cmp_eq_u32 s24, 1
    s_cbranch_scc1 .w1_156
    s_cmp_eq_u32 s24, 2
    s_cbranch_scc1 .w2_157
    s_cmp_eq_u32 s24, 3
    s_cbranch_scc1 .w3_158
.w0_155:
    v_bfe_u32 v254, v1, 4, 2
    v_mul_u32_u24 v12, 128, v254
    v_bfe_u32 v254, v1, 0, 3
    v_mul_u32_u24 v254, 16, v254
    v_add_u32 v12, v12, v254
    v_add_u32 v12, 131072, v12
    v_add_u32 v12, s57, v12
    v_bfe_u32 v254, v1, 4, 2
    v_mul_u32_u24 v13, 128, v254
    v_bfe_u32 v254, v1, 2, 2
    v_mul_u32_u24 v254, 32, v254
    v_add_u32 v13, v13, v254
    v_bfe_u32 v254, v1, 0, 1
    v_mul_u32_u24 v254, 16, v254
    v_add_u32 v13, v13, v254
    v_add_u32 v13, 133120, v13
    v_add_u32 v13, s57, v13
    v_bfe_u32 v254, v1, 4, 2
    v_mul_u32_u24 v14, 128, v254
    v_bfe_u32 v254, v1, 0, 4
    v_mul_u32_u24 v254, 16, v254
    v_add_u32 v14, v14, v254
    v_add_u32 v14, 65536, v14
    v_add_u32 v14, s55, v14
    v_bfe_u32 v254, v1, 0, 6
    v_mul_u32_u24 v15, 16, v254
    v_bfe_u32 v254, v1, 2, 2
    v_mul_u32_u24 v16, 128, v254
    v_bfe_u32 v254, v1, 0, 2
    v_mul_u32_u24 v254, 16, v254
    v_add_u32 v16, v16, v254
    v_bfe_u32 v254, v1, 4, 2
    v_mul_u32_u24 v254, 4, v254
    v_add_u32 v16, v16, v254
    v_add_u32 v16, 18432, v16
    v_mov_b32 v144, 0
    v_mov_b32 v145, 0
    v_mov_b32 v146, 0
    v_mov_b32 v147, 0
    v_mov_b32 v148, 0
    v_mov_b32 v149, 0
    v_mov_b32 v150, 0
    v_mov_b32 v151, 0
    v_mov_b32 v152, 0
    v_mov_b32 v153, 0
    v_mov_b32 v154, 0
    v_mov_b32 v155, 0
    v_mov_b32 v156, 0
    v_mov_b32 v157, 0
    v_mov_b32 v158, 0
    v_mov_b32 v159, 0
    v_mov_b32 v160, 0
    v_mov_b32 v161, 0
    v_mov_b32 v162, 0
    v_mov_b32 v163, 0
    v_mov_b32 v164, 0
    v_mov_b32 v165, 0
    v_mov_b32 v166, 0
    v_mov_b32 v167, 0
    v_mov_b32 v168, 0
    v_mov_b32 v169, 0
    v_mov_b32 v170, 0
    v_mov_b32 v171, 0
    v_mov_b32 v172, 0
    v_mov_b32 v173, 0
    v_mov_b32 v174, 0
    v_mov_b32 v175, 0
    v_mov_b32 v208, 0
    v_mov_b32 v209, 0
    v_mov_b32 v210, 0
    v_mov_b32 v211, 0
    v_mov_b32 v212, 0
    v_mov_b32 v213, 0
    v_mov_b32 v214, 0
    v_mov_b32 v215, 0
    v_mov_b32 v216, 0
    v_mov_b32 v217, 0
    v_mov_b32 v218, 0
    v_mov_b32 v219, 0
    v_mov_b32 v18, 0xff800000
    v_mov_b32 v200, s45
    v_mov_b32 v220, 0x3f803f80
    v_mov_b32 v201, s45
    v_mov_b32 v221, 0x3f803f80
    v_mov_b32 v202, s45
    v_mov_b32 v222, 0x3f803f80
    v_mov_b32 v203, s45
    v_mov_b32 v223, 0x3f803f80
    s_waitcnt vmcnt(0)
    ds_read_b64_tr_b16 a[192:193], v242 offset:16384
    ds_read_b64_tr_b16 a[194:195], v242 offset:16896
    ds_read_b64_tr_b16 a[196:197], v242 offset:18432
    ds_read_b64_tr_b16 a[198:199], v242 offset:18944
    ds_read_b64_tr_b16 a[200:201], v242 offset:20480
    ds_read_b64_tr_b16 a[202:203], v242 offset:20992
    ds_read_b64_tr_b16 a[204:205], v242 offset:22528
    ds_read_b64_tr_b16 a[206:207], v242 offset:23040
    ds_read_b64_tr_b16 a[208:209], v242 offset:24576
    ds_read_b64_tr_b16 a[210:211], v242 offset:25088
    ds_read_b64_tr_b16 a[212:213], v242 offset:26624
    ds_read_b64_tr_b16 a[214:215], v242 offset:27136
    ds_read_b64_tr_b16 a[216:217], v242 offset:28672
    ds_read_b64_tr_b16 a[218:219], v242 offset:29184
    ds_read_b64_tr_b16 a[220:221], v242 offset:30720
    ds_read_b64_tr_b16 a[222:223], v242 offset:31232
    ds_read_b64_tr_b16 a[224:225], v243 offset:16384
    ds_read_b64_tr_b16 a[226:227], v243 offset:16896
    ds_read_b64_tr_b16 a[228:229], v243 offset:18432
    ds_read_b64_tr_b16 a[230:231], v243 offset:18944
    ds_read_b64_tr_b16 a[232:233], v243 offset:20480
    ds_read_b64_tr_b16 a[234:235], v243 offset:20992
    ds_read_b64_tr_b16 a[236:237], v243 offset:22528
    ds_read_b64_tr_b16 a[238:239], v243 offset:23040
    ds_read_b64_tr_b16 a[240:241], v243 offset:24576
    ds_read_b64_tr_b16 a[242:243], v243 offset:25088
    ds_read_b64_tr_b16 a[244:245], v243 offset:26624
    ds_read_b64_tr_b16 a[246:247], v243 offset:27136
    ds_read_b64_tr_b16 a[248:249], v243 offset:28672
    ds_read_b64_tr_b16 a[250:251], v243 offset:29184
    ds_read_b64_tr_b16 a[252:253], v243 offset:30720
    ds_read_b64_tr_b16 a[254:255], v243 offset:31232
    s_waitcnt lgkmcnt(0)
    s_barrier
    buffer_load_dwordx4 v[104:107], v15, s[8:11], s42 offen offset:0
    buffer_load_dwordx4 v[108:111], v15, s[8:11], s42 offen offset:1024
    buffer_load_dwordx4 v[112:115], v15, s[8:11], s42 offen offset:2048
    buffer_load_dwordx4 v[116:119], v15, s[8:11], s42 offen offset:3072
    buffer_load_dwordx4 v[120:123], v15, s[8:11], s43 offen offset:0
    buffer_load_dwordx4 v[124:127], v15, s[8:11], s43 offen offset:1024
    buffer_load_dwordx4 v[128:131], v15, s[8:11], s43 offen offset:2048
    buffer_load_dwordx4 v[132:135], v15, s[8:11], s43 offen offset:3072
    buffer_load_dwordx4 v[136:139], v15, s[8:11], s44 offen offset:0
    buffer_load_dwordx4 v[140:143], v15, s[8:11], s44 offen offset:1024
    s_add_u32 s42, s42, 262144
    s_add_u32 s43, s43, 262144
    s_add_u32 s44, s44, 262144
.p2align 6
.step_159:
    s_barrier
    s_setprio 3
    buffer_load_dwordx4 v[24:27], v3, s[8:11], s30 offen offset:0 sc1
    s_setprio 2
    buffer_load_dwordx4 v[28:31], v3, s[8:11], s30 offen offset:1024 sc1
    s_setprio 1
    buffer_load_dwordx4 v[32:35], v3, s[8:11], s30 offen offset:2048 sc1
    s_setprio 0
    buffer_load_dwordx4 v[36:39], v3, s[8:11], s30 offen offset:3072 sc1
    s_waitcnt vmcnt(3)
    v_max_u32 v18, v25, v27
    v_cmp_eq_u32 vcc, -1, v18
    s_cbranch_vccnz .gs_161
.gr_162:
    v_smfmac_f32_16x16x64_bf16 v[40:43], v[24:27], a[0:7], v2
    v_smfmac_f32_16x16x64_bf16 v[44:47], v[24:27], a[32:39], v2
    s_waitcnt vmcnt(2)
    v_max_u32 v18, v29, v31
    v_cmp_eq_u32 vcc, -1, v18
    v_smfmac_f32_16x16x64_bf16 v[48:51], v[24:27], a[64:71], v2
    s_cbranch_vccnz .gs_164
.gr_165:
    v_smfmac_f32_16x16x64_bf16 v[40:43], v[28:31], a[8:15], v2
    v_smfmac_f32_16x16x64_bf16 v[44:47], v[28:31], a[40:47], v2
    v_smfmac_f32_16x16x64_bf16 v[52:55], v[24:27], a[96:103], v2
    s_waitcnt vmcnt(1)
    v_max_u32 v18, v33, v35
    v_cmp_eq_u32 vcc, -1, v18
    v_smfmac_f32_16x16x64_bf16 v[48:51], v[28:31], a[72:79], v2
    s_cbranch_vccnz .gs_167
.gr_168:
    v_smfmac_f32_16x16x64_bf16 v[40:43], v[32:35], a[16:23], v2
    v_smfmac_f32_16x16x64_bf16 v[44:47], v[32:35], a[48:55], v2
    v_smfmac_f32_16x16x64_bf16 v[52:55], v[28:31], a[104:111], v2
    s_waitcnt vmcnt(0)
    v_max_u32 v18, v37, v39
    v_cmp_eq_u32 vcc, -1, v18
    v_smfmac_f32_16x16x64_bf16 v[48:51], v[32:35], a[80:87], v2
    s_cbranch_vccnz .gs_170
.gr_171:
    v_smfmac_f32_16x16x64_bf16 v[40:43], v[36:39], a[24:31], v2
    v_smfmac_f32_16x16x64_bf16 v[44:47], v[36:39], a[56:63], v2
    v_smfmac_f32_16x16x64_bf16 v[52:55], v[32:35], a[112:119], v2
    v_smfmac_f32_16x16x64_bf16 v[48:51], v[36:39], a[88:95], v2
    v_permlane32_swap_b32 v40, v44
    v_permlane32_swap_b32 v41, v45
    v_smfmac_f32_16x16x64_bf16 v[52:55], v[36:39], a[120:127], v2
    v_permlane32_swap_b32 v42, v46
    v_permlane32_swap_b32 v43, v47
    v_add_f32 v40, v40, v44
    v_add_f32 v41, v41, v45
    v_add_f32 v42, v42, v46
    v_add_f32 v43, v43, v47
    ds_write2_b32 v5, v40, v41 offset0:0 offset1:36
    ds_write2_b32 v5, v42, v43 offset0:72 offset1:108
    v_permlane32_swap_b32 v48, v52
    v_permlane32_swap_b32 v49, v53
    v_permlane32_swap_b32 v50, v54
    v_permlane32_swap_b32 v51, v55
    v_pk_add_f32 v[48:49], v[48:49], v[52:53]
    v_pk_add_f32 v[50:51], v[50:51], v[54:55]
    ds_write2_b32 v6, v48, v49 offset0:0 offset1:36
    ds_write2_b32 v6, v50, v51 offset0:72 offset1:108
    s_waitcnt lgkmcnt(2)
    s_barrier
    ds_read_b64 v[72:73], v9 offset:0
    ds_read_b64 v[74:75], v9 offset:1152
    ds_read_b64 v[76:77], v9 offset:2304
    ds_read_b64 v[78:79], v9 offset:3456
    s_waitcnt lgkmcnt(4)
    s_barrier
    s_waitcnt lgkmcnt(2)
    v_pk_add_f32 v[72:73], v[72:73], v[74:75]
    s_waitcnt lgkmcnt(0)
    v_pk_add_f32 v[76:77], v[76:77], v[78:79]
    v_pk_add_f32 v[72:73], v[72:73], v[76:77]
    v_cvt_pk_bf16_f32 v72, v72, v73
    v_min_u32 v72, 0xfffffffe, v72
    buffer_store_dword v72, v10, s[8:11], s30 offen sc1
    v_smfmac_f32_16x16x64_bf16 v[56:59], v[24:27], a[128:135], v2
    v_smfmac_f32_16x16x64_bf16 v[60:63], v[24:27], a[160:167], v2
    v_smfmac_f32_16x16x64_bf16 v[56:59], v[28:31], a[136:143], v2
    v_smfmac_f32_16x16x64_bf16 v[60:63], v[28:31], a[168:175], v2
    v_smfmac_f32_16x16x64_bf16 v[56:59], v[32:35], a[144:151], v2
    v_smfmac_f32_16x16x64_bf16 v[60:63], v[32:35], a[176:183], v2
    v_smfmac_f32_16x16x64_bf16 v[56:59], v[36:39], a[152:159], v2
    v_smfmac_f32_16x16x64_bf16 v[60:63], v[36:39], a[184:191], v2
    v_mov_b32 v40, 0
    v_mov_b32 v41, 0
    v_mov_b32 v42, 0
    v_mov_b32 v43, 0
    v_mov_b32 v44, 0
    v_mov_b32 v45, 0
    v_mov_b32 v46, 0
    v_mov_b32 v47, 0
    v_permlane32_swap_b32 v56, v60
    v_permlane32_swap_b32 v57, v61
    v_permlane32_swap_b32 v58, v62
    v_permlane32_swap_b32 v59, v63
    v_pk_add_f32 v[56:57], v[56:57], v[60:61]
    v_pk_add_f32 v[58:59], v[58:59], v[62:63]
    ds_write_b128 v8, v[56:59]
    s_cmp_eq_u32 s28, 63
    s_cbranch_scc1 .fin_160
    s_waitcnt vmcnt(0)
    buffer_load_dwordx4 v[144:147], v12, s[8:11], s30 offen offset:0 sc1
    buffer_load_dwordx4 v[148:151], v12, s[8:11], s30 offen offset:512 sc1
    buffer_load_dwordx4 v[152:155], v12, s[8:11], s30 offen offset:1024 sc1
    buffer_load_dwordx4 v[156:159], v12, s[8:11], s30 offen offset:1536 sc1
    buffer_load_dwordx4 v[176:179], v13, s[8:11], s30 offen offset:0 sc1
    buffer_load_dwordx4 v[180:183], v13, s[8:11], s30 offen offset:512 sc1
    buffer_load_dwordx4 v[184:187], v13, s[8:11], s30 offen offset:1024 sc1
    buffer_load_dwordx4 v[188:191], v13, s[8:11], s30 offen offset:1536 sc1
    s_waitcnt lgkmcnt(0)
    s_barrier
.mf_173:
    s_waitcnt vmcnt(7)
    v_mfma_f32_16x16x32_bf16 v[192:195], v[104:107], v[144:147], 0
    v_max3_u32 v18, v144, v145, v146
    v_max_u32 v18, v18, v147
    v_mfma_f32_16x16x32_bf16 v[160:163], v[120:123], v[144:147], 0
    s_waitcnt vmcnt(6)
    v_max3_u32 v18, v18, v148, v149
    v_max3_u32 v18, v18, v150, v151
    v_mfma_f32_16x16x32_bf16 v[192:195], v[108:111], v[148:151], v[192:195]
    s_waitcnt vmcnt(5)
    v_max3_u32 v18, v18, v152, v153
    v_max3_u32 v18, v18, v154, v155
    v_mfma_f32_16x16x32_bf16 v[160:163], v[124:127], v[148:151], v[160:163]
    s_waitcnt vmcnt(4)
    v_max3_u32 v18, v18, v156, v157
    v_max3_u32 v18, v18, v158, v159
    v_mfma_f32_16x16x32_bf16 v[192:195], v[112:115], v[152:155], v[192:195]
    v_cmp_eq_u32 vcc, -1, v18
    v_mfma_f32_16x16x32_bf16 v[160:163], v[128:131], v[152:155], v[160:163]
    s_cbranch_vccnz .re_174
    s_waitcnt vmcnt(3)
    v_max3_u32 v18, v176, v177, v178
    v_max_u32 v18, v18, v179
    v_mfma_f32_16x16x32_bf16 v[192:195], v[116:119], v[156:159], v[192:195]
    s_waitcnt vmcnt(2)
    v_max3_u32 v18, v18, v180, v181
    v_max3_u32 v18, v18, v182, v183
    v_mfma_f32_16x16x32_bf16 v[160:163], v[132:135], v[156:159], v[160:163]
    s_waitcnt vmcnt(1)
    v_max3_u32 v18, v18, v184, v185
    v_max3_u32 v18, v18, v186, v187
    v_mfma_f32_16x16x32_bf16 v[196:199], v[176:179], v[144:147], 0
    s_waitcnt vmcnt(0)
    v_max3_u32 v18, v18, v188, v189
    v_max3_u32 v18, v18, v190, v191
    v_mfma_f32_16x16x32_bf16 v[196:199], v[180:183], v[148:151], v[196:199]
    v_cmp_eq_u32 vcc, -1, v18
    v_mfma_f32_16x16x32_bf16 v[196:199], v[184:187], v[152:155], v[196:199]
    s_cbranch_vccnz .rk_176
    v_cndmask_b32 v192, v160, v192, s[48:49]
    v_cndmask_b32 v193, v161, v193, s[48:49]
    v_mfma_f32_16x16x32_bf16 v[196:199], v[188:191], v[156:159], v[196:199]
.mk_175:
    v_cndmask_b32 v194, v162, v194, s[48:49]
    v_cndmask_b32 v195, v163, v195, s[48:49]
    v_max3_f32 v19, v192, v193, v194
    v_max_f32 v19, v19, v195
    s_barrier
    ds_read_b32 v212, v16
    ds_read_b32 v216, v16 offset:64
    v_max_f32_dpp v19, v19, v19 row_ror:8 row_mask:0xf bank_mask:0xf
    v_max3_f32 v18, v19, v196, v197
    v_max3_f32 v17, v19, v196, v197
    s_nop 1
    v_permlane16_swap_b32 v18, v17
    v_max_f32 v19, v18, v17
    v_max_f32 v18, v18, v17
    s_nop 1
    v_permlane32_swap_b32 v18, v19
    v_max_f32 v18, v18, v19
    v_mul_f32 v18, s45, v18
    v_pk_fma_f32 v[244:245], v[196:197], v[200:201], v[18:19] op_sel_hi:[1,1,0] neg_lo:[0,0,1] neg_hi:[0,0,1]
    v_pk_fma_f32 v[240:241], v[192:193], v[200:201], v[18:19] op_sel_hi:[1,1,0] neg_lo:[0,0,1] neg_hi:[0,0,1]
    v_pk_fma_f32 v[242:243], v[194:195], v[200:201], v[18:19] op_sel_hi:[1,1,0] neg_lo:[0,0,1] neg_hi:[0,0,1]
    v_exp_f32 v244, v244
    v_exp_f32 v245, v245
    v_exp_f32 v240, v240
    v_cvt_pk_bf16_f32 v208, v244, v245
    v_exp_f32 v241, v241
    v_exp_f32 v242, v242
    v_mfma_f32_16x16x32_bf16 v[224:227], v[220:223], v[208:211], 0
    v_exp_f32 v243, v243
    s_waitcnt lgkmcnt(0)
    v_mfma_f32_16x16x32_bf16 v[228:231], v[212:215], v[208:211], 0
    v_cvt_pk_bf16_f32 v204, v240, v241
    v_cvt_pk_bf16_f32 v205, v242, v243
    v_mfma_f32_16x16x32_bf16 v[232:235], v[216:219], v[208:211], 0
    v_mov_b32_dpp v206, v204 row_ror:8 row_mask:0xf bank_mask:0xf
    v_mov_b32_dpp v207, v205 row_ror:8 row_mask:0xf bank_mask:0xf
    s_nop 1
    v_mfma_f32_16x16x32_bf16 v[224:227], v[220:223], v[204:207], v[224:227]
    v_mfma_f32_16x16x32_bf16 v[228:231], v[136:139], v[204:207], v[228:231]
    v_mfma_f32_16x16x32_bf16 v[232:235], v[140:143], v[204:207], v[232:235]
    s_mov_b64 exec, s[48:49]
    v_rcp_f32 v18, v224
    s_nop 1
    v_mul_f32 v228, v18, v228
    v_mul_f32 v229, v18, v229
    v_mul_f32 v230, v18, v230
    v_mul_f32 v231, v18, v231
    v_pk_mul_f32 v[232:233], v[18:19], v[232:233] op_sel_hi:[0,1]
    v_pk_mul_f32 v[234:235], v[18:19], v[234:235] op_sel_hi:[0,1]
    v_cvt_pk_bf16_f32 v236, v228, v229
    v_cvt_pk_bf16_f32 v239, v234, v235
    v_cvt_pk_bf16_f32 v237, v230, v231
    v_cvt_pk_bf16_f32 v238, v232, v233
    v_min_u32 v239, 0xfffffffe, v239
    buffer_store_dwordx4 v[236:239], v14, s[8:11], s30 offen sc1
    s_mov_b64 exec, -1
    v_mov_b32 v48, 0
    v_mov_b32 v49, 0
    v_mov_b32 v50, 0
    v_mov_b32 v51, 0
    v_mov_b32 v52, 0
    v_mov_b32 v53, 0
    v_mov_b32 v54, 0
    v_mov_b32 v55, 0
    v_mov_b32 v56, 0
    v_mov_b32 v57, 0
    v_mov_b32 v58, 0
    v_mov_b32 v59, 0
    v_mov_b32 v60, 0
    v_mov_b32 v61, 0
    v_mov_b32 v62, 0
    v_mov_b32 v63, 0
    s_waitcnt vmcnt(0)
    s_barrier
    s_setprio 3
    buffer_load_dwordx4 v[24:27], v4, s[8:11], s30 offen offset:0 sc1
    s_setprio 2
    buffer_load_dwordx4 v[28:31], v4, s[8:11], s30 offen offset:1024 sc1
    s_setprio 1
    buffer_load_dwordx4 v[32:35], v4, s[8:11], s30 offen offset:2048 sc1
    s_setprio 0
    buffer_load_dwordx4 v[36:39], v4, s[8:11], s30 offen offset:3072 sc1
    s_waitcnt vmcnt(3)
    v_smfmac_f32_16x16x64_bf16 v[64:67], v[24:27], a[192:199], v2
    v_cmp_eq_u32 vcc, -1, v27
    v_smfmac_f32_16x16x64_bf16 v[68:71], v[24:27], a[224:231], v2
    s_cbranch_vccnz .gs_178
.gr_179:
    s_waitcnt vmcnt(2)
    v_smfmac_f32_16x16x64_bf16 v[64:67], v[28:31], a[200:207], v2
    v_cmp_eq_u32 vcc, -1, v31
    v_smfmac_f32_16x16x64_bf16 v[68:71], v[28:31], a[232:239], v2
    s_cbranch_vccnz .gs_181
.gr_182:
    s_waitcnt vmcnt(1)
    v_smfmac_f32_16x16x64_bf16 v[64:67], v[32:35], a[208:215], v2
    v_cmp_eq_u32 vcc, -1, v35
    v_smfmac_f32_16x16x64_bf16 v[68:71], v[32:35], a[240:247], v2
    s_cbranch_vccnz .gs_184
.gr_185:
    s_waitcnt vmcnt(0)
    v_smfmac_f32_16x16x64_bf16 v[64:67], v[36:39], a[216:223], v2
    v_cmp_eq_u32 vcc, -1, v39
    v_smfmac_f32_16x16x64_bf16 v[68:71], v[36:39], a[248:255], v2
    s_cbranch_vccnz .gs_187
.gr_188:
    s_nop 6
    v_permlane32_swap_b32 v64, v68
    v_permlane32_swap_b32 v65, v69
    v_permlane32_swap_b32 v66, v70
    v_permlane32_swap_b32 v67, v71
    v_pk_add_f32 v[64:65], v[64:65], v[68:69]
    v_pk_add_f32 v[66:67], v[66:67], v[70:71]
    ds_write2_b32 v7, v64, v65 offset0:0 offset1:36
    ds_write2_b32 v7, v66, v67 offset0:72 offset1:108
    s_waitcnt lgkmcnt(0)
    s_barrier
    buffer_load_dwordx4 v[104:107], v15, s[8:11], s42 offen offset:0
    buffer_load_dwordx4 v[108:111], v15, s[8:11], s42 offen offset:1024
    buffer_load_dwordx4 v[112:115], v15, s[8:11], s42 offen offset:2048
    buffer_load_dwordx4 v[116:119], v15, s[8:11], s42 offen offset:3072
    buffer_load_dwordx4 v[120:123], v15, s[8:11], s43 offen offset:0
    buffer_load_dwordx4 v[124:127], v15, s[8:11], s43 offen offset:1024
    buffer_load_dwordx4 v[128:131], v15, s[8:11], s43 offen offset:2048
    buffer_load_dwordx4 v[132:135], v15, s[8:11], s43 offen offset:3072
    buffer_load_dwordx4 v[136:139], v15, s[8:11], s44 offen offset:0
    buffer_load_dwordx4 v[140:143], v15, s[8:11], s44 offen offset:1024
    s_add_u32 s42, s42, 262144
    s_add_u32 s43, s43, 262144
    s_add_u32 s44, s44, 262144
    v_mov_b32 v64, 0
    v_mov_b32 v65, 0
    v_mov_b32 v66, 0
    v_mov_b32 v67, 0
    v_mov_b32 v68, 0
    v_mov_b32 v69, 0
    v_mov_b32 v70, 0
    v_mov_b32 v71, 0
    s_mov_b32 s4, s30
    s_mov_b32 s30, s31
    s_mov_b32 s31, s32
    s_mov_b32 s32, s33
    s_mov_b32 s33, s4
    s_add_u32 s28, s28, 1
    s_mov_b32 s62, 0
    s_branch .step_159
.fin_160:
    s_waitcnt lgkmcnt(0)
    s_barrier
    s_barrier
    s_endpgm
.gs_161:
    buffer_load_dwordx4 v[24:27], v3, s[8:11], s30 offen offset:0 sc1
    buffer_load_dwordx4 v[28:31], v3, s[8:11], s30 offen offset:1024 sc1
    buffer_load_dwordx4 v[32:35], v3, s[8:11], s30 offen offset:2048 sc1
    buffer_load_dwordx4 v[36:39], v3, s[8:11], s30 offen offset:3072 sc1
    s_add_u32 s62, s62, 1
    s_cmp_gt_u32 s62, 0x100000
    s_cbranch_scc1 .mg_end_1
    s_waitcnt vmcnt(3)
    v_max_u32 v18, v25, v27
    v_cmp_eq_u32 vcc, -1, v18
    s_cbranch_vccz .gr_162
    s_branch .gs_161
.gs_164:
    buffer_load_dwordx4 v[28:31], v3, s[8:11], s30 offen offset:1024 sc1
    buffer_load_dwordx4 v[32:35], v3, s[8:11], s30 offen offset:2048 sc1
    buffer_load_dwordx4 v[36:39], v3, s[8:11], s30 offen offset:3072 sc1
    s_add_u32 s62, s62, 1
    s_cmp_gt_u32 s62, 0x100000
    s_cbranch_scc1 .mg_end_1
    s_waitcnt vmcnt(2)
    v_max_u32 v18, v29, v31
    v_cmp_eq_u32 vcc, -1, v18
    s_cbranch_vccz .gr_165
    s_branch .gs_164
.gs_167:
    buffer_load_dwordx4 v[32:35], v3, s[8:11], s30 offen offset:2048 sc1
    buffer_load_dwordx4 v[36:39], v3, s[8:11], s30 offen offset:3072 sc1
    s_add_u32 s62, s62, 1
    s_cmp_gt_u32 s62, 0x100000
    s_cbranch_scc1 .mg_end_1
    s_waitcnt vmcnt(1)
    v_max_u32 v18, v33, v35
    v_cmp_eq_u32 vcc, -1, v18
    s_cbranch_vccz .gr_168
    s_branch .gs_167
.gs_170:
    buffer_load_dwordx4 v[36:39], v3, s[8:11], s30 offen offset:3072 sc1
    s_add_u32 s62, s62, 1
    s_cmp_gt_u32 s62, 0x100000
    s_cbranch_scc1 .mg_end_1
    s_waitcnt vmcnt(0)
    v_max_u32 v18, v37, v39
    v_cmp_eq_u32 vcc, -1, v18
    s_cbranch_vccz .gr_171
    s_branch .gs_170
.re_174:
    buffer_load_dwordx4 v[144:147], v12, s[8:11], s30 offen offset:0 sc1
    buffer_load_dwordx4 v[148:151], v12, s[8:11], s30 offen offset:512 sc1
    buffer_load_dwordx4 v[152:155], v12, s[8:11], s30 offen offset:1024 sc1
    buffer_load_dwordx4 v[156:159], v12, s[8:11], s30 offen offset:1536 sc1
    buffer_load_dwordx4 v[176:179], v13, s[8:11], s30 offen offset:0 sc1
    buffer_load_dwordx4 v[180:183], v13, s[8:11], s30 offen offset:512 sc1
    buffer_load_dwordx4 v[184:187], v13, s[8:11], s30 offen offset:1024 sc1
    buffer_load_dwordx4 v[188:191], v13, s[8:11], s30 offen offset:1536 sc1
    s_add_u32 s62, s62, 1
    s_cmp_gt_u32 s62, 0x100000
    s_cbranch_scc1 .mg_end_1
    s_branch .mf_173
.rk_176:
    s_nop 3
    buffer_load_dwordx4 v[176:179], v13, s[8:11], s30 offen offset:0 sc1
    buffer_load_dwordx4 v[180:183], v13, s[8:11], s30 offen offset:512 sc1
    buffer_load_dwordx4 v[184:187], v13, s[8:11], s30 offen offset:1024 sc1
    buffer_load_dwordx4 v[188:191], v13, s[8:11], s30 offen offset:1536 sc1
    s_add_u32 s62, s62, 1
    s_cmp_gt_u32 s62, 0x100000
    s_cbranch_scc1 .mg_end_1
    s_waitcnt vmcnt(3)
    v_mfma_f32_16x16x32_bf16 v[196:199], v[176:179], v[144:147], 0
    v_max3_u32 v18, v176, v177, v178
    v_max_u32 v18, v18, v179
    s_waitcnt vmcnt(2)
    v_mfma_f32_16x16x32_bf16 v[196:199], v[180:183], v[148:151], v[196:199]
    v_max3_u32 v18, v18, v180, v181
    v_max3_u32 v18, v18, v182, v183
    s_waitcnt vmcnt(1)
    v_mfma_f32_16x16x32_bf16 v[196:199], v[184:187], v[152:155], v[196:199]
    v_max3_u32 v18, v18, v184, v185
    v_max3_u32 v18, v18, v186, v187
    s_waitcnt vmcnt(0)
    v_mfma_f32_16x16x32_bf16 v[196:199], v[188:191], v[156:159], v[196:199]
    v_max3_u32 v18, v18, v188, v189
    v_max3_u32 v18, v18, v190, v191
    v_cmp_eq_u32 vcc, -1, v18
    s_cbranch_vccnz .rk_176
    v_cndmask_b32 v192, v160, v192, s[48:49]
    v_cndmask_b32 v193, v161, v193, s[48:49]
    s_branch .mk_175
.gs_178:
    buffer_load_dwordx4 v[24:27], v4, s[8:11], s30 offen offset:0 sc1
    buffer_load_dwordx4 v[28:31], v4, s[8:11], s30 offen offset:1024 sc1
    buffer_load_dwordx4 v[32:35], v4, s[8:11], s30 offen offset:2048 sc1
    buffer_load_dwordx4 v[36:39], v4, s[8:11], s30 offen offset:3072 sc1
    s_nop 2
    v_mov_b32 v64, 0
    v_mov_b32 v65, 0
    v_mov_b32 v66, 0
    v_mov_b32 v67, 0
    v_mov_b32 v68, 0
    v_mov_b32 v69, 0
    v_mov_b32 v70, 0
    v_mov_b32 v71, 0
    s_nop 1
    s_branch .gc_190
.gl_180:
    buffer_load_dwordx4 v[24:27], v4, s[8:11], s30 offen offset:0 sc1
    buffer_load_dwordx4 v[28:31], v4, s[8:11], s30 offen offset:1024 sc1
    buffer_load_dwordx4 v[32:35], v4, s[8:11], s30 offen offset:2048 sc1
    buffer_load_dwordx4 v[36:39], v4, s[8:11], s30 offen offset:3072 sc1
.gc_190:
    s_add_u32 s62, s62, 1
    s_cmp_gt_u32 s62, 0x100000
    s_cbranch_scc1 .mg_end_1
    s_waitcnt vmcnt(3)
    v_cmp_eq_u32 vcc, -1, v27
    s_cbranch_vccnz .gl_180
    v_smfmac_f32_16x16x64_bf16 v[64:67], v[24:27], a[192:199], v2
    v_smfmac_f32_16x16x64_bf16 v[68:71], v[24:27], a[224:231], v2
    s_branch .gr_179
.gs_181:
    buffer_load_dwordx4 v[28:31], v4, s[8:11], s30 offen offset:1024 sc1
    buffer_load_dwordx4 v[32:35], v4, s[8:11], s30 offen offset:2048 sc1
    buffer_load_dwordx4 v[36:39], v4, s[8:11], s30 offen offset:3072 sc1
    s_nop 3
    v_mov_b32 v64, 0
    v_mov_b32 v65, 0
    v_mov_b32 v66, 0
    v_mov_b32 v67, 0
    v_mov_b32 v68, 0
    v_mov_b32 v69, 0
    v_mov_b32 v70, 0
    v_mov_b32 v71, 0
    s_nop 1
    v_smfmac_f32_16x16x64_bf16 v[64:67], v[24:27], a[192:199], v2
    v_smfmac_f32_16x16x64_bf16 v[68:71], v[24:27], a[224:231], v2
    s_branch .gc_191
.gl_183:
    buffer_load_dwordx4 v[28:31], v4, s[8:11], s30 offen offset:1024 sc1
    buffer_load_dwordx4 v[32:35], v4, s[8:11], s30 offen offset:2048 sc1
    buffer_load_dwordx4 v[36:39], v4, s[8:11], s30 offen offset:3072 sc1
.gc_191:
    s_add_u32 s62, s62, 1
    s_cmp_gt_u32 s62, 0x100000
    s_cbranch_scc1 .mg_end_1
    s_waitcnt vmcnt(2)
    v_cmp_eq_u32 vcc, -1, v31
    s_cbranch_vccnz .gl_183
    v_smfmac_f32_16x16x64_bf16 v[64:67], v[28:31], a[200:207], v2
    v_smfmac_f32_16x16x64_bf16 v[68:71], v[28:31], a[232:239], v2
    s_branch .gr_182
.gs_184:
    buffer_load_dwordx4 v[32:35], v4, s[8:11], s30 offen offset:2048 sc1
    buffer_load_dwordx4 v[36:39], v4, s[8:11], s30 offen offset:3072 sc1
    s_nop 4
    v_mov_b32 v64, 0
    v_mov_b32 v65, 0
    v_mov_b32 v66, 0
    v_mov_b32 v67, 0
    v_mov_b32 v68, 0
    v_mov_b32 v69, 0
    v_mov_b32 v70, 0
    v_mov_b32 v71, 0
    s_nop 1
    v_smfmac_f32_16x16x64_bf16 v[64:67], v[24:27], a[192:199], v2
    v_smfmac_f32_16x16x64_bf16 v[68:71], v[24:27], a[224:231], v2
    v_smfmac_f32_16x16x64_bf16 v[64:67], v[28:31], a[200:207], v2
    v_smfmac_f32_16x16x64_bf16 v[68:71], v[28:31], a[232:239], v2
    s_branch .gc_192
.gl_186:
    buffer_load_dwordx4 v[32:35], v4, s[8:11], s30 offen offset:2048 sc1
    buffer_load_dwordx4 v[36:39], v4, s[8:11], s30 offen offset:3072 sc1
.gc_192:
    s_add_u32 s62, s62, 1
    s_cmp_gt_u32 s62, 0x100000
    s_cbranch_scc1 .mg_end_1
    s_waitcnt vmcnt(1)
    v_cmp_eq_u32 vcc, -1, v35
    s_cbranch_vccnz .gl_186
    v_smfmac_f32_16x16x64_bf16 v[64:67], v[32:35], a[208:215], v2
    v_smfmac_f32_16x16x64_bf16 v[68:71], v[32:35], a[240:247], v2
    s_branch .gr_185
.gs_187:
    buffer_load_dwordx4 v[36:39], v4, s[8:11], s30 offen offset:3072 sc1
    s_nop 5
    v_mov_b32 v64, 0
    v_mov_b32 v65, 0
    v_mov_b32 v66, 0
    v_mov_b32 v67, 0
    v_mov_b32 v68, 0
    v_mov_b32 v69, 0
    v_mov_b32 v70, 0
    v_mov_b32 v71, 0
    s_nop 1
    v_smfmac_f32_16x16x64_bf16 v[64:67], v[24:27], a[192:199], v2
    v_smfmac_f32_16x16x64_bf16 v[68:71], v[24:27], a[224:231], v2
    v_smfmac_f32_16x16x64_bf16 v[64:67], v[28:31], a[200:207], v2
    v_smfmac_f32_16x16x64_bf16 v[68:71], v[28:31], a[232:239], v2
    v_smfmac_f32_16x16x64_bf16 v[64:67], v[32:35], a[208:215], v2
    v_smfmac_f32_16x16x64_bf16 v[68:71], v[32:35], a[240:247], v2
    s_branch .gc_193
.gl_189:
    buffer_load_dwordx4 v[36:39], v4, s[8:11], s30 offen offset:3072 sc1
.gc_193:
    s_add_u32 s62, s62, 1
    s_cmp_gt_u32 s62, 0x100000
    s_cbranch_scc1 .mg_end_1
    s_waitcnt vmcnt(0)
    v_cmp_eq_u32 vcc, -1, v39
    s_cbranch_vccnz .gl_189
    v_smfmac_f32_16x16x64_bf16 v[64:67], v[36:39], a[216:223], v2
    v_smfmac_f32_16x16x64_bf16 v[68:71], v[36:39], a[248:255], v2
    s_branch .gr_188
.w1_156:
    v_bfe_u32 v254, v1, 1, 3
    v_mul_u32_u24 v12, 144, v254
    v_bfe_u32 v254, v1, 4, 2
    v_mul_u32_u24 v254, 32, v254
    v_add_u32 v12, v12, v254
    v_bfe_u32 v254, v1, 0, 1
    v_mul_u32_u24 v254, 16, v254
    v_add_u32 v12, v12, v254
    v_add_u32 v12, 9216, v12
    v_bfe_u32 v254, v1, 0, 6
    v_mul_u32_u24 v13, 16, v254
    v_add_u32 v13, s101, v13
    v_bfe_u32 v254, v1, 0, 6
    v_mul_u32_u24 v14, 8, v254
    v_add_u32 v14, s55, v14
    v_xor_b32 v14, 2048, v14
    v_min_u32 v249, 0xfffffffe, v249
    buffer_store_dwordx2 v[248:249], v14, s[8:11], s30 offen sc1
    v_bfe_u32 v254, v1, 0, 6
    v_mul_u32_u24 v15, 16, v254
    s_add_u32 s42, s42, 262144
    s_add_u32 s43, s43, 262144
    s_add_u32 s44, s44, 262144
    s_waitcnt vmcnt(0)
    ds_read_b64_tr_b16 a[192:193], v242 offset:16384
    ds_read_b64_tr_b16 a[194:195], v242 offset:16896
    ds_read_b64_tr_b16 a[196:197], v242 offset:18432
    ds_read_b64_tr_b16 a[198:199], v242 offset:18944
    ds_read_b64_tr_b16 a[200:201], v242 offset:20480
    ds_read_b64_tr_b16 a[202:203], v242 offset:20992
    ds_read_b64_tr_b16 a[204:205], v242 offset:22528
    ds_read_b64_tr_b16 a[206:207], v242 offset:23040
    ds_read_b64_tr_b16 a[208:209], v242 offset:24576
    ds_read_b64_tr_b16 a[210:211], v242 offset:25088
    ds_read_b64_tr_b16 a[212:213], v242 offset:26624
    ds_read_b64_tr_b16 a[214:215], v242 offset:27136
    ds_read_b64_tr_b16 a[216:217], v242 offset:28672
    ds_read_b64_tr_b16 a[218:219], v242 offset:29184
    ds_read_b64_tr_b16 a[220:221], v242 offset:30720
    ds_read_b64_tr_b16 a[222:223], v242 offset:31232
    ds_read_b64_tr_b16 a[224:225], v243 offset:16384
    ds_read_b64_tr_b16 a[226:227], v243 offset:16896
    ds_read_b64_tr_b16 a[228:229], v243 offset:18432
    ds_read_b64_tr_b16 a[230:231], v243 offset:18944
    ds_read_b64_tr_b16 a[232:233], v243 offset:20480
    ds_read_b64_tr_b16 a[234:235], v243 offset:20992
    ds_read_b64_tr_b16 a[236:237], v243 offset:22528
    ds_read_b64_tr_b16 a[238:239], v243 offset:23040
    ds_read_b64_tr_b16 a[240:241], v243 offset:24576
    ds_read_b64_tr_b16 a[242:243], v243 offset:25088
    ds_read_b64_tr_b16 a[244:245], v243 offset:26624
    ds_read_b64_tr_b16 a[246:247], v243 offset:27136
    ds_read_b64_tr_b16 a[248:249], v243 offset:28672
    ds_read_b64_tr_b16 a[250:251], v243 offset:29184
    ds_read_b64_tr_b16 a[252:253], v243 offset:30720
    ds_read_b64_tr_b16 a[254:255], v243 offset:31232
    s_waitcnt lgkmcnt(0)
    s_barrier
.p2align 6
.step_194:
    s_waitcnt vmcnt(0)
    s_barrier
    s_setprio 3
    buffer_load_dwordx4 v[24:27], v3, s[8:11], s30 offen offset:0 sc1
    s_setprio 2
    buffer_load_dwordx4 v[28:31], v3, s[8:11], s30 offen offset:1024 sc1
    s_setprio 1
    buffer_load_dwordx4 v[32:35], v3, s[8:11], s30 offen offset:2048 sc1
    s_setprio 0
    buffer_load_dwordx4 v[36:39], v3, s[8:11], s30 offen offset:3072 sc1
    s_waitcnt vmcnt(3)
    v_max_u32 v18, v25, v27
    v_cmp_eq_u32 vcc, -1, v18
    s_cbranch_vccnz .gs_196
.gr_197:
    v_smfmac_f32_16x16x64_bf16 v[40:43], v[24:27], a[0:7], v2
    v_smfmac_f32_16x16x64_bf16 v[44:47], v[24:27], a[32:39], v2
    s_waitcnt vmcnt(2)
    v_max_u32 v18, v29, v31
    v_cmp_eq_u32 vcc, -1, v18
    v_smfmac_f32_16x16x64_bf16 v[48:51], v[24:27], a[64:71], v2
    s_cbranch_vccnz .gs_199
.gr_200:
    v_smfmac_f32_16x16x64_bf16 v[40:43], v[28:31], a[8:15], v2
    v_smfmac_f32_16x16x64_bf16 v[44:47], v[28:31], a[40:47], v2
    v_smfmac_f32_16x16x64_bf16 v[52:55], v[24:27], a[96:103], v2
    s_waitcnt vmcnt(1)
    v_max_u32 v18, v33, v35
    v_cmp_eq_u32 vcc, -1, v18
    v_smfmac_f32_16x16x64_bf16 v[48:51], v[28:31], a[72:79], v2
    s_cbranch_vccnz .gs_202
.gr_203:
    v_smfmac_f32_16x16x64_bf16 v[40:43], v[32:35], a[16:23], v2
    v_smfmac_f32_16x16x64_bf16 v[44:47], v[32:35], a[48:55], v2
    v_smfmac_f32_16x16x64_bf16 v[52:55], v[28:31], a[104:111], v2
    s_waitcnt vmcnt(0)
    v_max_u32 v18, v37, v39
    v_cmp_eq_u32 vcc, -1, v18
    v_smfmac_f32_16x16x64_bf16 v[48:51], v[32:35], a[80:87], v2
    s_cbranch_vccnz .gs_205
.gr_206:
    v_smfmac_f32_16x16x64_bf16 v[40:43], v[36:39], a[24:31], v2
    v_smfmac_f32_16x16x64_bf16 v[44:47], v[36:39], a[56:63], v2
    v_smfmac_f32_16x16x64_bf16 v[52:55], v[32:35], a[112:119], v2
    v_smfmac_f32_16x16x64_bf16 v[48:51], v[36:39], a[88:95], v2
    v_permlane32_swap_b32 v40, v44
    v_permlane32_swap_b32 v41, v45
    v_smfmac_f32_16x16x64_bf16 v[52:55], v[36:39], a[120:127], v2
    v_permlane32_swap_b32 v42, v46
    v_permlane32_swap_b32 v43, v47
    v_add_f32 v40, v40, v44
    v_add_f32 v41, v41, v45
    v_add_f32 v42, v42, v46
    v_add_f32 v43, v43, v47
    ds_write2_b32 v5, v40, v41 offset0:0 offset1:36
    ds_write2_b32 v5, v42, v43 offset0:72 offset1:108
    v_permlane32_swap_b32 v48, v52
    v_permlane32_swap_b32 v49, v53
    v_permlane32_swap_b32 v50, v54
    v_permlane32_swap_b32 v51, v55
    v_pk_add_f32 v[48:49], v[48:49], v[52:53]
    v_pk_add_f32 v[50:51], v[50:51], v[54:55]
    ds_write2_b32 v6, v48, v49 offset0:0 offset1:36
    ds_write2_b32 v6, v50, v51 offset0:72 offset1:108
    s_waitcnt lgkmcnt(2)
    s_barrier
    ds_read_b64 v[72:73], v9 offset:0
    ds_read_b64 v[74:75], v9 offset:1152
    ds_read_b64 v[76:77], v9 offset:2304
    ds_read_b64 v[78:79], v9 offset:3456
    s_waitcnt lgkmcnt(4)
    s_barrier
    s_waitcnt lgkmcnt(2)
    v_pk_add_f32 v[72:73], v[72:73], v[74:75]
    s_waitcnt lgkmcnt(0)
    v_pk_add_f32 v[76:77], v[76:77], v[78:79]
    v_pk_add_f32 v[72:73], v[72:73], v[76:77]
    v_cvt_pk_bf16_f32 v72, v72, v73
    v_min_u32 v72, 0xfffffffe, v72
    buffer_store_dword v72, v10, s[8:11], s30 offen sc1
    v_smfmac_f32_16x16x64_bf16 v[56:59], v[24:27], a[128:135], v2
    v_smfmac_f32_16x16x64_bf16 v[60:63], v[24:27], a[160:167], v2
    v_smfmac_f32_16x16x64_bf16 v[56:59], v[28:31], a[136:143], v2
    v_smfmac_f32_16x16x64_bf16 v[60:63], v[28:31], a[168:175], v2
    v_smfmac_f32_16x16x64_bf16 v[56:59], v[32:35], a[144:151], v2
    v_smfmac_f32_16x16x64_bf16 v[60:63], v[32:35], a[176:183], v2
    v_smfmac_f32_16x16x64_bf16 v[56:59], v[36:39], a[152:159], v2
    v_smfmac_f32_16x16x64_bf16 v[60:63], v[36:39], a[184:191], v2
    v_mov_b32 v40, 0
    v_mov_b32 v41, 0
    v_mov_b32 v42, 0
    v_mov_b32 v43, 0
    v_mov_b32 v44, 0
    v_mov_b32 v45, 0
    v_mov_b32 v46, 0
    v_mov_b32 v47, 0
    v_permlane32_swap_b32 v56, v60
    v_permlane32_swap_b32 v57, v61
    v_permlane32_swap_b32 v58, v62
    v_permlane32_swap_b32 v59, v63
    v_pk_add_f32 v[56:57], v[56:57], v[60:61]
    v_pk_add_f32 v[58:59], v[58:59], v[62:63]
    ds_write_b128 v8, v[56:59]
    s_waitcnt lgkmcnt(0)
    s_barrier
    s_barrier
    s_cmp_eq_u32 s28, 63
    s_cbranch_scc1 .fin_195
    s_xor_b32 s38, s34, 0x4000
    s_xor_b32 s39, s34, 0x1000
    s_xor_b32 s40, s34, 0x5000
    v_mov_b32 v48, 0
    v_mov_b32 v49, 0
    v_mov_b32 v50, 0
    v_mov_b32 v51, 0
    v_mov_b32 v52, 0
    v_mov_b32 v53, 0
    v_mov_b32 v54, 0
    v_mov_b32 v55, 0
    v_mov_b32 v56, 0
    v_mov_b32 v57, 0
    v_mov_b32 v58, 0
    v_mov_b32 v59, 0
    v_mov_b32 v60, 0
    v_mov_b32 v61, 0
    v_mov_b32 v62, 0
    v_mov_b32 v63, 0
    s_barrier
    s_setprio 3
    buffer_load_dwordx4 v[24:27], v4, s[8:11], s30 offen offset:0 sc1
    s_setprio 2
    buffer_load_dwordx4 v[28:31], v4, s[8:11], s30 offen offset:1024 sc1
    s_setprio 1
    buffer_load_dwordx4 v[32:35], v4, s[8:11], s30 offen offset:2048 sc1
    s_setprio 0
    buffer_load_dwordx4 v[36:39], v4, s[8:11], s30 offen offset:3072 sc1
    s_waitcnt vmcnt(3)
    v_smfmac_f32_16x16x64_bf16 v[64:67], v[24:27], a[192:199], v2
    v_cmp_eq_u32 vcc, -1, v27
    v_smfmac_f32_16x16x64_bf16 v[68:71], v[24:27], a[224:231], v2
    s_cbranch_vccnz .gs_208
.gr_209:
    s_waitcnt vmcnt(2)
    v_smfmac_f32_16x16x64_bf16 v[64:67], v[28:31], a[200:207], v2
    v_cmp_eq_u32 vcc, -1, v31
    v_smfmac_f32_16x16x64_bf16 v[68:71], v[28:31], a[232:239], v2
    s_cbranch_vccnz .gs_211
.gr_212:
    s_waitcnt vmcnt(1)
    v_smfmac_f32_16x16x64_bf16 v[64:67], v[32:35], a[208:215], v2
    v_cmp_eq_u32 vcc, -1, v35
    v_smfmac_f32_16x16x64_bf16 v[68:71], v[32:35], a[240:247], v2
    s_cbranch_vccnz .gs_214
.gr_215:
    s_waitcnt vmcnt(0)
    v_smfmac_f32_16x16x64_bf16 v[64:67], v[36:39], a[216:223], v2
    v_cmp_eq_u32 vcc, -1, v39
    v_smfmac_f32_16x16x64_bf16 v[68:71], v[36:39], a[248:255], v2
    s_cbranch_vccnz .gs_217
.gr_218:
    s_nop 6
    v_permlane32_swap_b32 v64, v68
    v_permlane32_swap_b32 v65, v69
    v_permlane32_swap_b32 v66, v70
    v_permlane32_swap_b32 v67, v71
    v_pk_add_f32 v[64:65], v[64:65], v[68:69]
    v_pk_add_f32 v[66:67], v[66:67], v[70:71]
    ds_write2_b32 v7, v64, v65 offset0:0 offset1:36
    ds_write2_b32 v7, v66, v67 offset0:72 offset1:108
    s_waitcnt lgkmcnt(0)
    s_barrier
    ds_read_b128 v[72:75], v12 offset:0
    ds_read_b128 v[76:79], v12 offset:1152
    ds_read_b128 v[80:83], v12 offset:2304
    ds_read_b128 v[84:87], v12 offset:3456
    s_waitcnt lgkmcnt(2)
    v_pk_add_f32 v[72:73], v[72:73], v[76:77]
    v_pk_add_f32 v[74:75], v[74:75], v[78:79]
    s_waitcnt lgkmcnt(0)
    v_pk_add_f32 v[80:81], v[80:81], v[84:85]
    v_pk_add_f32 v[82:83], v[82:83], v[86:87]
    v_pk_add_f32 v[72:73], v[72:73], v[80:81]
    v_pk_add_f32 v[74:75], v[74:75], v[82:83]
    v_min_u32 v75, 0xfffffffe, v75
    buffer_store_dwordx4 v[72:75], v13, s[8:11], s34 offen sc1
    v_mov_b32 v64, 0
    v_mov_b32 v65, 0
    v_mov_b32 v66, 0
    v_mov_b32 v67, 0
    v_mov_b32 v68, 0
    v_mov_b32 v69, 0
    v_mov_b32 v70, 0
    v_mov_b32 v71, 0
    s_waitcnt vmcnt(0)
.pl_220:
    buffer_load_dwordx4 v[76:79], v13, s[8:11], s38 offen sc1
    buffer_load_dwordx4 v[80:83], v13, s[8:11], s39 offen sc1
    buffer_load_dwordx4 v[84:87], v13, s[8:11], s40 offen sc1
    s_waitcnt vmcnt(2)
    v_pk_add_f32 v[88:89], v[72:73], v[76:77]
    v_pk_add_f32 v[90:91], v[74:75], v[78:79]
    s_waitcnt vmcnt(0)
    v_max3_u32 v18, v79, v83, v87
    v_cmp_eq_u32 vcc, -1, v18
    v_pk_add_f32 v[80:81], v[80:81], v[84:85]
    v_pk_add_f32 v[82:83], v[82:83], v[86:87]
    v_pk_add_f32 v[88:89], v[88:89], v[80:81]
    v_pk_add_f32 v[90:91], v[90:91], v[82:83]
    v_cvt_pk_bf16_f32 v92, v88, v89
    v_cvt_pk_bf16_f32 v93, v90, v91
    v_min_u32 v93, 0xfffffffe, v93
    s_cbranch_vccnz .pr_221
    buffer_store_dwordx2 v[92:93], v14, s[8:11], s31 offen sc1
    s_mov_b32 s4, s30
    s_mov_b32 s30, s31
    s_mov_b32 s31, s32
    s_mov_b32 s32, s33
    s_mov_b32 s33, s4
    s_add_u32 s28, s28, 1
    s_mov_b32 s62, 0
    s_mov_b32 s4, s34
    s_mov_b32 s34, s35
    s_mov_b32 s35, s36
    s_mov_b32 s36, s37
    s_mov_b32 s37, s4
    s_branch .step_194
.fin_195:
    s_waitcnt vmcnt(0)
    s_endpgm
.gs_196:
    buffer_load_dwordx4 v[24:27], v3, s[8:11], s30 offen offset:0 sc1
    buffer_load_dwordx4 v[28:31], v3, s[8:11], s30 offen offset:1024 sc1
    buffer_load_dwordx4 v[32:35], v3, s[8:11], s30 offen offset:2048 sc1
    buffer_load_dwordx4 v[36:39], v3, s[8:11], s30 offen offset:3072 sc1
    s_add_u32 s62, s62, 1
    s_cmp_gt_u32 s62, 0x100000
    s_cbranch_scc1 .mg_end_1
    s_waitcnt vmcnt(3)
    v_max_u32 v18, v25, v27
    v_cmp_eq_u32 vcc, -1, v18
    s_cbranch_vccz .gr_197
    s_branch .gs_196
.gs_199:
    buffer_load_dwordx4 v[28:31], v3, s[8:11], s30 offen offset:1024 sc1
    buffer_load_dwordx4 v[32:35], v3, s[8:11], s30 offen offset:2048 sc1
    buffer_load_dwordx4 v[36:39], v3, s[8:11], s30 offen offset:3072 sc1
    s_add_u32 s62, s62, 1
    s_cmp_gt_u32 s62, 0x100000
    s_cbranch_scc1 .mg_end_1
    s_waitcnt vmcnt(2)
    v_max_u32 v18, v29, v31
    v_cmp_eq_u32 vcc, -1, v18
    s_cbranch_vccz .gr_200
    s_branch .gs_199
.gs_202:
    buffer_load_dwordx4 v[32:35], v3, s[8:11], s30 offen offset:2048 sc1
    buffer_load_dwordx4 v[36:39], v3, s[8:11], s30 offen offset:3072 sc1
    s_add_u32 s62, s62, 1
    s_cmp_gt_u32 s62, 0x100000
    s_cbranch_scc1 .mg_end_1
    s_waitcnt vmcnt(1)
    v_max_u32 v18, v33, v35
    v_cmp_eq_u32 vcc, -1, v18
    s_cbranch_vccz .gr_203
    s_branch .gs_202
.gs_205:
    buffer_load_dwordx4 v[36:39], v3, s[8:11], s30 offen offset:3072 sc1
    s_add_u32 s62, s62, 1
    s_cmp_gt_u32 s62, 0x100000
    s_cbranch_scc1 .mg_end_1
    s_waitcnt vmcnt(0)
    v_max_u32 v18, v37, v39
    v_cmp_eq_u32 vcc, -1, v18
    s_cbranch_vccz .gr_206
    s_branch .gs_205
.gs_208:
    buffer_load_dwordx4 v[24:27], v4, s[8:11], s30 offen offset:0 sc1
    buffer_load_dwordx4 v[28:31], v4, s[8:11], s30 offen offset:1024 sc1
    buffer_load_dwordx4 v[32:35], v4, s[8:11], s30 offen offset:2048 sc1
    buffer_load_dwordx4 v[36:39], v4, s[8:11], s30 offen offset:3072 sc1
    s_nop 2
    v_mov_b32 v64, 0
    v_mov_b32 v65, 0
    v_mov_b32 v66, 0
    v_mov_b32 v67, 0
    v_mov_b32 v68, 0
    v_mov_b32 v69, 0
    v_mov_b32 v70, 0
    v_mov_b32 v71, 0
    s_nop 1
    s_branch .gc_222
.gl_210:
    buffer_load_dwordx4 v[24:27], v4, s[8:11], s30 offen offset:0 sc1
    buffer_load_dwordx4 v[28:31], v4, s[8:11], s30 offen offset:1024 sc1
    buffer_load_dwordx4 v[32:35], v4, s[8:11], s30 offen offset:2048 sc1
    buffer_load_dwordx4 v[36:39], v4, s[8:11], s30 offen offset:3072 sc1
.gc_222:
    s_add_u32 s62, s62, 1
    s_cmp_gt_u32 s62, 0x100000
    s_cbranch_scc1 .mg_end_1
    s_waitcnt vmcnt(3)
    v_cmp_eq_u32 vcc, -1, v27
    s_cbranch_vccnz .gl_210
    v_smfmac_f32_16x16x64_bf16 v[64:67], v[24:27], a[192:199], v2
    v_smfmac_f32_16x16x64_bf16 v[68:71], v[24:27], a[224:231], v2
    s_branch .gr_209
.gs_211:
    buffer_load_dwordx4 v[28:31], v4, s[8:11], s30 offen offset:1024 sc1
    buffer_load_dwordx4 v[32:35], v4, s[8:11], s30 offen offset:2048 sc1
    buffer_load_dwordx4 v[36:39], v4, s[8:11], s30 offen offset:3072 sc1
    s_nop 3
    v_mov_b32 v64, 0
    v_mov_b32 v65, 0
    v_mov_b32 v66, 0
    v_mov_b32 v67, 0
    v_mov_b32 v68, 0
    v_mov_b32 v69, 0
    v_mov_b32 v70, 0
    v_mov_b32 v71, 0
    s_nop 1
    v_smfmac_f32_16x16x64_bf16 v[64:67], v[24:27], a[192:199], v2
    v_smfmac_f32_16x16x64_bf16 v[68:71], v[24:27], a[224:231], v2
    s_branch .gc_223
.gl_213:
    buffer_load_dwordx4 v[28:31], v4, s[8:11], s30 offen offset:1024 sc1
    buffer_load_dwordx4 v[32:35], v4, s[8:11], s30 offen offset:2048 sc1
    buffer_load_dwordx4 v[36:39], v4, s[8:11], s30 offen offset:3072 sc1
.gc_223:
    s_add_u32 s62, s62, 1
    s_cmp_gt_u32 s62, 0x100000
    s_cbranch_scc1 .mg_end_1
    s_waitcnt vmcnt(2)
    v_cmp_eq_u32 vcc, -1, v31
    s_cbranch_vccnz .gl_213
    v_smfmac_f32_16x16x64_bf16 v[64:67], v[28:31], a[200:207], v2
    v_smfmac_f32_16x16x64_bf16 v[68:71], v[28:31], a[232:239], v2
    s_branch .gr_212
.gs_214:
    buffer_load_dwordx4 v[32:35], v4, s[8:11], s30 offen offset:2048 sc1
    buffer_load_dwordx4 v[36:39], v4, s[8:11], s30 offen offset:3072 sc1
    s_nop 4
    v_mov_b32 v64, 0
    v_mov_b32 v65, 0
    v_mov_b32 v66, 0
    v_mov_b32 v67, 0
    v_mov_b32 v68, 0
    v_mov_b32 v69, 0
    v_mov_b32 v70, 0
    v_mov_b32 v71, 0
    s_nop 1
    v_smfmac_f32_16x16x64_bf16 v[64:67], v[24:27], a[192:199], v2
    v_smfmac_f32_16x16x64_bf16 v[68:71], v[24:27], a[224:231], v2
    v_smfmac_f32_16x16x64_bf16 v[64:67], v[28:31], a[200:207], v2
    v_smfmac_f32_16x16x64_bf16 v[68:71], v[28:31], a[232:239], v2
    s_branch .gc_224
.gl_216:
    buffer_load_dwordx4 v[32:35], v4, s[8:11], s30 offen offset:2048 sc1
    buffer_load_dwordx4 v[36:39], v4, s[8:11], s30 offen offset:3072 sc1
.gc_224:
    s_add_u32 s62, s62, 1
    s_cmp_gt_u32 s62, 0x100000
    s_cbranch_scc1 .mg_end_1
    s_waitcnt vmcnt(1)
    v_cmp_eq_u32 vcc, -1, v35
    s_cbranch_vccnz .gl_216
    v_smfmac_f32_16x16x64_bf16 v[64:67], v[32:35], a[208:215], v2
    v_smfmac_f32_16x16x64_bf16 v[68:71], v[32:35], a[240:247], v2
    s_branch .gr_215
.gs_217:
    buffer_load_dwordx4 v[36:39], v4, s[8:11], s30 offen offset:3072 sc1
    s_nop 5
    v_mov_b32 v64, 0
    v_mov_b32 v65, 0
    v_mov_b32 v66, 0
    v_mov_b32 v67, 0
    v_mov_b32 v68, 0
    v_mov_b32 v69, 0
    v_mov_b32 v70, 0
    v_mov_b32 v71, 0
    s_nop 1
    v_smfmac_f32_16x16x64_bf16 v[64:67], v[24:27], a[192:199], v2
    v_smfmac_f32_16x16x64_bf16 v[68:71], v[24:27], a[224:231], v2
    v_smfmac_f32_16x16x64_bf16 v[64:67], v[28:31], a[200:207], v2
    v_smfmac_f32_16x16x64_bf16 v[68:71], v[28:31], a[232:239], v2
    v_smfmac_f32_16x16x64_bf16 v[64:67], v[32:35], a[208:215], v2
    v_smfmac_f32_16x16x64_bf16 v[68:71], v[32:35], a[240:247], v2
    s_branch .gc_225
.gl_219:
    buffer_load_dwordx4 v[36:39], v4, s[8:11], s30 offen offset:3072 sc1
.gc_225:
    s_add_u32 s62, s62, 1
    s_cmp_gt_u32 s62, 0x100000
    s_cbranch_scc1 .mg_end_1
    s_waitcnt vmcnt(0)
    v_cmp_eq_u32 vcc, -1, v39
    s_cbranch_vccnz .gl_219
    v_smfmac_f32_16x16x64_bf16 v[64:67], v[36:39], a[216:223], v2
    v_smfmac_f32_16x16x64_bf16 v[68:71], v[36:39], a[248:255], v2
    s_branch .gr_218
.pr_221:
    s_add_u32 s62, s62, 1
    s_cmp_gt_u32 s62, 0x100000
    s_cbranch_scc1 .mg_end_1
    s_branch .pl_220
.w2_157:
    s_lshl_b32 s4, s56, 9
    s_lshl_b32 s5, s53, 7
    s_add_u32 s4, s4, s5
    s_add_u32 s4, s4, 92274688
    v_mov_b32 v14, s4
    v_bfe_u32 v254, v1, 0, 6
    v_mul_u32_u24 v12, 16, v254
    v_add_u32 v12, 17920, v12
    v_bfe_u32 v254, v1, 0, 6
    v_mul_u32_u24 v15, 16, v254
    s_add_u32 s42, s42, 262144
    s_add_u32 s43, s43, 262144
    s_add_u32 s44, s44, 262144
    s_mov_b32 exec_hi, 0
    v_xor_b32 v244, 1024, v244
    s_mov_b32 exec_hi, -1
    s_waitcnt vmcnt(0)
    ds_read_b64_tr_b16 a[192:193], v242 offset:16384
    ds_read_b64_tr_b16 a[194:195], v242 offset:16896
    ds_read_b64_tr_b16 a[196:197], v242 offset:18432
    ds_read_b64_tr_b16 a[198:199], v242 offset:18944
    ds_read_b64_tr_b16 a[200:201], v242 offset:20480
    ds_read_b64_tr_b16 a[202:203], v242 offset:20992
    ds_read_b64_tr_b16 a[204:205], v242 offset:22528
    ds_read_b64_tr_b16 a[206:207], v242 offset:23040
    ds_read_b64_tr_b16 a[208:209], v242 offset:24576
    ds_read_b64_tr_b16 a[210:211], v242 offset:25088
    ds_read_b64_tr_b16 a[212:213], v242 offset:26624
    ds_read_b64_tr_b16 a[214:215], v242 offset:27136
    ds_read_b64_tr_b16 a[216:217], v242 offset:28672
    ds_read_b64_tr_b16 a[218:219], v242 offset:29184
    ds_read_b64_tr_b16 a[220:221], v242 offset:30720
    ds_read_b64_tr_b16 a[222:223], v242 offset:31232
    ds_read_b64_tr_b16 a[224:225], v243 offset:16384
    ds_read_b64_tr_b16 a[226:227], v243 offset:16896
    ds_read_b64_tr_b16 a[228:229], v243 offset:18432
    ds_read_b64_tr_b16 a[230:231], v243 offset:18944
    ds_read_b64_tr_b16 a[232:233], v243 offset:20480
    ds_read_b64_tr_b16 a[234:235], v243 offset:20992
    ds_read_b64_tr_b16 a[236:237], v243 offset:22528
    ds_read_b64_tr_b16 a[238:239], v243 offset:23040
    ds_read_b64_tr_b16 a[240:241], v243 offset:24576
    ds_read_b64_tr_b16 a[242:243], v243 offset:25088
    ds_read_b64_tr_b16 a[244:245], v243 offset:26624
    ds_read_b64_tr_b16 a[246:247], v243 offset:27136
    ds_read_b64_tr_b16 a[248:249], v243 offset:28672
    ds_read_b64_tr_b16 a[250:251], v243 offset:29184
    ds_read_b64_tr_b16 a[252:253], v243 offset:30720
    ds_read_b64_tr_b16 a[254:255], v243 offset:31232
    s_waitcnt lgkmcnt(0)
    s_barrier
.p2align 6
.step_226:
    s_barrier
    s_setprio 3
    buffer_load_dwordx4 v[24:27], v3, s[8:11], s30 offen offset:0 sc1
    s_setprio 2
    buffer_load_dwordx4 v[28:31], v3, s[8:11], s30 offen offset:1024 sc1
    s_setprio 1
    buffer_load_dwordx4 v[32:35], v3, s[8:11], s30 offen offset:2048 sc1
    s_setprio 0
    buffer_load_dwordx4 v[36:39], v3, s[8:11], s30 offen offset:3072 sc1
    s_waitcnt vmcnt(3)
    v_max_u32 v18, v25, v27
    v_cmp_eq_u32 vcc, -1, v18
    s_cbranch_vccnz .gs_228
.gr_229:
    v_smfmac_f32_16x16x64_bf16 v[40:43], v[24:27], a[0:7], v2
    v_smfmac_f32_16x16x64_bf16 v[44:47], v[24:27], a[32:39], v2
    s_waitcnt vmcnt(2)
    v_max_u32 v18, v29, v31
    v_cmp_eq_u32 vcc, -1, v18
    v_smfmac_f32_16x16x64_bf16 v[48:51], v[24:27], a[64:71], v2
    s_cbranch_vccnz .gs_231
.gr_232:
    v_smfmac_f32_16x16x64_bf16 v[40:43], v[28:31], a[8:15], v2
    v_smfmac_f32_16x16x64_bf16 v[44:47], v[28:31], a[40:47], v2
    v_smfmac_f32_16x16x64_bf16 v[52:55], v[24:27], a[96:103], v2
    s_waitcnt vmcnt(1)
    v_max_u32 v18, v33, v35
    v_cmp_eq_u32 vcc, -1, v18
    v_smfmac_f32_16x16x64_bf16 v[48:51], v[28:31], a[72:79], v2
    s_cbranch_vccnz .gs_234
.gr_235:
    v_smfmac_f32_16x16x64_bf16 v[40:43], v[32:35], a[16:23], v2
    v_smfmac_f32_16x16x64_bf16 v[44:47], v[32:35], a[48:55], v2
    v_smfmac_f32_16x16x64_bf16 v[52:55], v[28:31], a[104:111], v2
    s_waitcnt vmcnt(0)
    v_max_u32 v18, v37, v39
    v_cmp_eq_u32 vcc, -1, v18
    v_smfmac_f32_16x16x64_bf16 v[48:51], v[32:35], a[80:87], v2
    s_cbranch_vccnz .gs_237
.gr_238:
    v_smfmac_f32_16x16x64_bf16 v[40:43], v[36:39], a[24:31], v2
    v_smfmac_f32_16x16x64_bf16 v[44:47], v[36:39], a[56:63], v2
    v_smfmac_f32_16x16x64_bf16 v[52:55], v[32:35], a[112:119], v2
    v_smfmac_f32_16x16x64_bf16 v[48:51], v[36:39], a[88:95], v2
    v_permlane32_swap_b32 v40, v44
    v_permlane32_swap_b32 v41, v45
    v_smfmac_f32_16x16x64_bf16 v[52:55], v[36:39], a[120:127], v2
    v_permlane32_swap_b32 v42, v46
    v_permlane32_swap_b32 v43, v47
    v_add_f32 v40, v40, v44
    v_add_f32 v41, v41, v45
    v_add_f32 v42, v42, v46
    v_add_f32 v43, v43, v47
    ds_write2_b32 v5, v40, v41 offset0:0 offset1:36
    ds_write2_b32 v5, v42, v43 offset0:72 offset1:108
    v_permlane32_swap_b32 v48, v52
    v_permlane32_swap_b32 v49, v53
    v_permlane32_swap_b32 v50, v54
    v_permlane32_swap_b32 v51, v55
    v_pk_add_f32 v[48:49], v[48:49], v[52:53]
    v_pk_add_f32 v[50:51], v[50:51], v[54:55]
    ds_write2_b32 v6, v48, v49 offset0:0 offset1:36
    ds_write2_b32 v6, v50, v51 offset0:72 offset1:108
    s_waitcnt lgkmcnt(2)
    s_barrier
    s_waitcnt lgkmcnt(0)
    s_barrier
    ds_read_b64 v[72:73], v9 offset:0
    ds_read_b64 v[74:75], v9 offset:1152
    ds_read_b64 v[76:77], v9 offset:2304
    ds_read_b64 v[78:79], v9 offset:3456
    s_waitcnt lgkmcnt(2)
    v_pk_add_f32 v[72:73], v[72:73], v[74:75]
    s_waitcnt lgkmcnt(0)
    v_pk_add_f32 v[76:77], v[76:77], v[78:79]
    v_pk_add_f32 v[72:73], v[72:73], v[76:77]
    v_cvt_pk_bf16_f32 v72, v72, v73
    v_min_u32 v72, 0xfffffffe, v72
    buffer_store_dword v72, v10, s[8:11], s30 offen sc1
    v_smfmac_f32_16x16x64_bf16 v[56:59], v[24:27], a[128:135], v2
    v_smfmac_f32_16x16x64_bf16 v[60:63], v[24:27], a[160:167], v2
    v_smfmac_f32_16x16x64_bf16 v[56:59], v[28:31], a[136:143], v2
    v_smfmac_f32_16x16x64_bf16 v[60:63], v[28:31], a[168:175], v2
    v_smfmac_f32_16x16x64_bf16 v[56:59], v[32:35], a[144:151], v2
    v_smfmac_f32_16x16x64_bf16 v[60:63], v[32:35], a[176:183], v2
    v_smfmac_f32_16x16x64_bf16 v[56:59], v[36:39], a[152:159], v2
    v_smfmac_f32_16x16x64_bf16 v[60:63], v[36:39], a[184:191], v2
    ds_write_b32 v11, v72
    v_mov_b32 v40, 0
    v_mov_b32 v41, 0
    v_mov_b32 v42, 0
    v_mov_b32 v43, 0
    v_mov_b32 v44, 0
    v_mov_b32 v45, 0
    v_mov_b32 v46, 0
    v_mov_b32 v47, 0
    v_permlane32_swap_b32 v56, v60
    v_permlane32_swap_b32 v57, v61
    v_permlane32_swap_b32 v58, v62
    v_permlane32_swap_b32 v59, v63
    v_pk_add_f32 v[56:57], v[56:57], v[60:61]
    v_pk_add_f32 v[58:59], v[58:59], v[62:63]
    ds_write_b128 v8, v[56:59]
    s_waitcnt lgkmcnt(0)
    s_barrier
    s_barrier
    ds_read_b128 v[72:75], v12
    s_cmp_eq_u32 s28, 63
    s_cbranch_scc1 .fin_227
    s_waitcnt lgkmcnt(0)
    buffer_store_dwordx4 v[72:75], v244, s[8:11], s41 offen sc1
    v_mov_b32 v48, 0
    v_mov_b32 v49, 0
    v_mov_b32 v50, 0
    v_mov_b32 v51, 0
    v_mov_b32 v52, 0
    v_mov_b32 v53, 0
    v_mov_b32 v54, 0
    v_mov_b32 v55, 0
    v_mov_b32 v56, 0
    v_mov_b32 v57, 0
    v_mov_b32 v58, 0
    v_mov_b32 v59, 0
    v_mov_b32 v60, 0
    v_mov_b32 v61, 0
    v_mov_b32 v62, 0
    v_mov_b32 v63, 0
    s_barrier
    s_setprio 3
    buffer_load_dwordx4 v[24:27], v4, s[8:11], s30 offen offset:0 sc1
    s_setprio 2
    buffer_load_dwordx4 v[28:31], v4, s[8:11], s30 offen offset:1024 sc1
    s_setprio 1
    buffer_load_dwordx4 v[32:35], v4, s[8:11], s30 offen offset:2048 sc1
    s_setprio 0
    buffer_load_dwordx4 v[36:39], v4, s[8:11], s30 offen offset:3072 sc1
    s_waitcnt vmcnt(3)
    v_smfmac_f32_16x16x64_bf16 v[64:67], v[24:27], a[192:199], v2
    v_cmp_eq_u32 vcc, -1, v27
    v_smfmac_f32_16x16x64_bf16 v[68:71], v[24:27], a[224:231], v2
    s_cbranch_vccnz .gs_240
.gr_241:
    s_waitcnt vmcnt(2)
    v_smfmac_f32_16x16x64_bf16 v[64:67], v[28:31], a[200:207], v2
    v_cmp_eq_u32 vcc, -1, v31
    v_smfmac_f32_16x16x64_bf16 v[68:71], v[28:31], a[232:239], v2
    s_cbranch_vccnz .gs_243
.gr_244:
    s_waitcnt vmcnt(1)
    v_smfmac_f32_16x16x64_bf16 v[64:67], v[32:35], a[208:215], v2
    v_cmp_eq_u32 vcc, -1, v35
    v_smfmac_f32_16x16x64_bf16 v[68:71], v[32:35], a[240:247], v2
    s_cbranch_vccnz .gs_246
.gr_247:
    s_waitcnt vmcnt(0)
    v_smfmac_f32_16x16x64_bf16 v[64:67], v[36:39], a[216:223], v2
    v_cmp_eq_u32 vcc, -1, v39
    v_smfmac_f32_16x16x64_bf16 v[68:71], v[36:39], a[248:255], v2
    s_cbranch_vccnz .gs_249
.gr_250:
    s_nop 6
    v_permlane32_swap_b32 v64, v68
    v_permlane32_swap_b32 v65, v69
    v_permlane32_swap_b32 v66, v70
    v_permlane32_swap_b32 v67, v71
    v_pk_add_f32 v[64:65], v[64:65], v[68:69]
    v_pk_add_f32 v[66:67], v[66:67], v[70:71]
    ds_write2_b32 v7, v64, v65 offset0:0 offset1:36
    ds_write2_b32 v7, v66, v67 offset0:72 offset1:108
    s_waitcnt lgkmcnt(0)
    s_barrier
    s_cmp_lt_u32 s28, 52
    s_cselect_b32 s4, 3, 0
    s_andn2_b32 s4, s4, s28
    s_cbranch_scc1 .nl_252
    v_mov_b32 v18, s28
    v_add_u32 v18, 1, v18
    s_mov_b64 exec, 1
    buffer_store_dword v18, v14, s[8:11], 0 offen sc1
    s_mov_b64 exec, -1
.nl_252:
    v_mov_b32 v64, 0
    v_mov_b32 v65, 0
    v_mov_b32 v66, 0
    v_mov_b32 v67, 0
    v_mov_b32 v68, 0
    v_mov_b32 v69, 0
    v_mov_b32 v70, 0
    v_mov_b32 v71, 0
    s_mov_b32 s4, s30
    s_mov_b32 s30, s31
    s_mov_b32 s31, s32
    s_mov_b32 s32, s33
    s_mov_b32 s33, s4
    s_add_u32 s28, s28, 1
    s_mov_b32 s62, 0
    s_add_u32 s41, s41, 0x20000
    s_branch .step_226
.fin_227:
    s_waitcnt lgkmcnt(0)
    buffer_store_dwordx4 v[72:75], v244, s[8:11], s41 offen sc1
    s_waitcnt vmcnt(0)
    v_mov_b32 v18, 64
    s_mov_b64 exec, 1
    buffer_store_dword v18, v14, s[8:11], 0 offen sc1
    s_mov_b64 exec, -1
    s_endpgm
.gs_228:
    buffer_load_dwordx4 v[24:27], v3, s[8:11], s30 offen offset:0 sc1
    buffer_load_dwordx4 v[28:31], v3, s[8:11], s30 offen offset:1024 sc1
    buffer_load_dwordx4 v[32:35], v3, s[8:11], s30 offen offset:2048 sc1
    buffer_load_dwordx4 v[36:39], v3, s[8:11], s30 offen offset:3072 sc1
    s_add_u32 s62, s62, 1
    s_cmp_gt_u32 s62, 0x100000
    s_cbranch_scc1 .mg_end_1
    s_waitcnt vmcnt(3)
    v_max_u32 v18, v25, v27
    v_cmp_eq_u32 vcc, -1, v18
    s_cbranch_vccz .gr_229
    s_branch .gs_228
.gs_231:
    buffer_load_dwordx4 v[28:31], v3, s[8:11], s30 offen offset:1024 sc1
    buffer_load_dwordx4 v[32:35], v3, s[8:11], s30 offen offset:2048 sc1
    buffer_load_dwordx4 v[36:39], v3, s[8:11], s30 offen offset:3072 sc1
    s_add_u32 s62, s62, 1
    s_cmp_gt_u32 s62, 0x100000
    s_cbranch_scc1 .mg_end_1
    s_waitcnt vmcnt(2)
    v_max_u32 v18, v29, v31
    v_cmp_eq_u32 vcc, -1, v18
    s_cbranch_vccz .gr_232
    s_branch .gs_231
.gs_234:
    buffer_load_dwordx4 v[32:35], v3, s[8:11], s30 offen offset:2048 sc1
    buffer_load_dwordx4 v[36:39], v3, s[8:11], s30 offen offset:3072 sc1
    s_add_u32 s62, s62, 1
    s_cmp_gt_u32 s62, 0x100000
    s_cbranch_scc1 .mg_end_1
    s_waitcnt vmcnt(1)
    v_max_u32 v18, v33, v35
    v_cmp_eq_u32 vcc, -1, v18
    s_cbranch_vccz .gr_235
    s_branch .gs_234
.gs_237:
    buffer_load_dwordx4 v[36:39], v3, s[8:11], s30 offen offset:3072 sc1
    s_add_u32 s62, s62, 1
    s_cmp_gt_u32 s62, 0x100000
    s_cbranch_scc1 .mg_end_1
    s_waitcnt vmcnt(0)
    v_max_u32 v18, v37, v39
    v_cmp_eq_u32 vcc, -1, v18
    s_cbranch_vccz .gr_238
    s_branch .gs_237
.gs_240:
    buffer_load_dwordx4 v[24:27], v4, s[8:11], s30 offen offset:0 sc1
    buffer_load_dwordx4 v[28:31], v4, s[8:11], s30 offen offset:1024 sc1
    buffer_load_dwordx4 v[32:35], v4, s[8:11], s30 offen offset:2048 sc1
    buffer_load_dwordx4 v[36:39], v4, s[8:11], s30 offen offset:3072 sc1
    s_nop 2
    v_mov_b32 v64, 0
    v_mov_b32 v65, 0
    v_mov_b32 v66, 0
    v_mov_b32 v67, 0
    v_mov_b32 v68, 0
    v_mov_b32 v69, 0
    v_mov_b32 v70, 0
    v_mov_b32 v71, 0
    s_nop 1
    s_branch .gc_253
.gl_242:
    buffer_load_dwordx4 v[24:27], v4, s[8:11], s30 offen offset:0 sc1
    buffer_load_dwordx4 v[28:31], v4, s[8:11], s30 offen offset:1024 sc1
    buffer_load_dwordx4 v[32:35], v4, s[8:11], s30 offen offset:2048 sc1
    buffer_load_dwordx4 v[36:39], v4, s[8:11], s30 offen offset:3072 sc1
.gc_253:
    s_add_u32 s62, s62, 1
    s_cmp_gt_u32 s62, 0x100000
    s_cbranch_scc1 .mg_end_1
    s_waitcnt vmcnt(3)
    v_cmp_eq_u32 vcc, -1, v27
    s_cbranch_vccnz .gl_242
    v_smfmac_f32_16x16x64_bf16 v[64:67], v[24:27], a[192:199], v2
    v_smfmac_f32_16x16x64_bf16 v[68:71], v[24:27], a[224:231], v2
    s_branch .gr_241
.gs_243:
    buffer_load_dwordx4 v[28:31], v4, s[8:11], s30 offen offset:1024 sc1
    buffer_load_dwordx4 v[32:35], v4, s[8:11], s30 offen offset:2048 sc1
    buffer_load_dwordx4 v[36:39], v4, s[8:11], s30 offen offset:3072 sc1
    s_nop 3
    v_mov_b32 v64, 0
    v_mov_b32 v65, 0
    v_mov_b32 v66, 0
    v_mov_b32 v67, 0
    v_mov_b32 v68, 0
    v_mov_b32 v69, 0
    v_mov_b32 v70, 0
    v_mov_b32 v71, 0
    s_nop 1
    v_smfmac_f32_16x16x64_bf16 v[64:67], v[24:27], a[192:199], v2
    v_smfmac_f32_16x16x64_bf16 v[68:71], v[24:27], a[224:231], v2
    s_branch .gc_254
.gl_245:
    buffer_load_dwordx4 v[28:31], v4, s[8:11], s30 offen offset:1024 sc1
    buffer_load_dwordx4 v[32:35], v4, s[8:11], s30 offen offset:2048 sc1
    buffer_load_dwordx4 v[36:39], v4, s[8:11], s30 offen offset:3072 sc1
.gc_254:
    s_add_u32 s62, s62, 1
    s_cmp_gt_u32 s62, 0x100000
    s_cbranch_scc1 .mg_end_1
    s_waitcnt vmcnt(2)
    v_cmp_eq_u32 vcc, -1, v31
    s_cbranch_vccnz .gl_245
    v_smfmac_f32_16x16x64_bf16 v[64:67], v[28:31], a[200:207], v2
    v_smfmac_f32_16x16x64_bf16 v[68:71], v[28:31], a[232:239], v2
    s_branch .gr_244
.gs_246:
    buffer_load_dwordx4 v[32:35], v4, s[8:11], s30 offen offset:2048 sc1
    buffer_load_dwordx4 v[36:39], v4, s[8:11], s30 offen offset:3072 sc1
    s_nop 4
    v_mov_b32 v64, 0
    v_mov_b32 v65, 0
    v_mov_b32 v66, 0
    v_mov_b32 v67, 0
    v_mov_b32 v68, 0
    v_mov_b32 v69, 0
    v_mov_b32 v70, 0
    v_mov_b32 v71, 0
    s_nop 1
    v_smfmac_f32_16x16x64_bf16 v[64:67], v[24:27], a[192:199], v2
    v_smfmac_f32_16x16x64_bf16 v[68:71], v[24:27], a[224:231], v2
    v_smfmac_f32_16x16x64_bf16 v[64:67], v[28:31], a[200:207], v2
    v_smfmac_f32_16x16x64_bf16 v[68:71], v[28:31], a[232:239], v2
    s_branch .gc_255
.gl_248:
    buffer_load_dwordx4 v[32:35], v4, s[8:11], s30 offen offset:2048 sc1
    buffer_load_dwordx4 v[36:39], v4, s[8:11], s30 offen offset:3072 sc1
.gc_255:
    s_add_u32 s62, s62, 1
    s_cmp_gt_u32 s62, 0x100000
    s_cbranch_scc1 .mg_end_1
    s_waitcnt vmcnt(1)
    v_cmp_eq_u32 vcc, -1, v35
    s_cbranch_vccnz .gl_248
    v_smfmac_f32_16x16x64_bf16 v[64:67], v[32:35], a[208:215], v2
    v_smfmac_f32_16x16x64_bf16 v[68:71], v[32:35], a[240:247], v2
    s_branch .gr_247
.gs_249:
    buffer_load_dwordx4 v[36:39], v4, s[8:11], s30 offen offset:3072 sc1
    s_nop 5
    v_mov_b32 v64, 0
    v_mov_b32 v65, 0
    v_mov_b32 v66, 0
    v_mov_b32 v67, 0
    v_mov_b32 v68, 0
    v_mov_b32 v69, 0
    v_mov_b32 v70, 0
    v_mov_b32 v71, 0
    s_nop 1
    v_smfmac_f32_16x16x64_bf16 v[64:67], v[24:27], a[192:199], v2
    v_smfmac_f32_16x16x64_bf16 v[68:71], v[24:27], a[224:231], v2
    v_smfmac_f32_16x16x64_bf16 v[64:67], v[28:31], a[200:207], v2
    v_smfmac_f32_16x16x64_bf16 v[68:71], v[28:31], a[232:239], v2
    v_smfmac_f32_16x16x64_bf16 v[64:67], v[32:35], a[208:215], v2
    v_smfmac_f32_16x16x64_bf16 v[68:71], v[32:35], a[240:247], v2
    s_branch .gc_256
.gl_251:
    buffer_load_dwordx4 v[36:39], v4, s[8:11], s30 offen offset:3072 sc1
.gc_256:
    s_add_u32 s62, s62, 1
    s_cmp_gt_u32 s62, 0x100000
    s_cbranch_scc1 .mg_end_1
    s_waitcnt vmcnt(0)
    v_cmp_eq_u32 vcc, -1, v39
    s_cbranch_vccnz .gl_251
    v_smfmac_f32_16x16x64_bf16 v[64:67], v[36:39], a[216:223], v2
    v_smfmac_f32_16x16x64_bf16 v[68:71], v[36:39], a[248:255], v2
    s_branch .gr_250
.w3_158:
    v_bfe_u32 v254, v1, 3, 1
    v_mul_u32_u24 v12, 512, v254
    v_bfe_u32 v254, v1, 5, 1
    v_mul_u32_u24 v254, 256, v254
    v_add_u32 v12, v12, v254
    v_bfe_u32 v254, v1, 2, 1
    v_mul_u32_u24 v254, 128, v254
    v_add_u32 v12, v12, v254
    v_bfe_u32 v254, v1, 0, 2
    v_mul_u32_u24 v254, 16, v254
    v_add_u32 v12, v12, v254
    v_bfe_u32 v254, v1, 4, 1
    v_mul_u32_u24 v254, 8, v254
    v_add_u32 v12, v12, v254
    v_add_u32 v12, 13824, v12
    v_bfe_u32 v254, v1, 2, 2
    v_mul_u32_u24 v14, 128, v254
    v_bfe_u32 v254, v1, 0, 2
    v_mul_u32_u24 v254, 16, v254
    v_add_u32 v14, v14, v254
    v_bfe_u32 v254, v1, 4, 2
    v_mul_u32_u24 v254, 4, v254
    v_add_u32 v14, v14, v254
    v_add_u32 v14, 18432, v14
    v_bfe_u32 v254, v1, 0, 6
    v_mul_u32_u24 v15, 16, v254
    v_add_u32 v15, s101, v15
    v_bfe_u32 v254, v1, 2, 2
    v_mul_u32_u24 v16, 128, v254
    v_bfe_u32 v254, v1, 0, 2
    v_mul_u32_u24 v254, 16, v254
    v_add_u32 v16, v16, v254
    v_bfe_u32 v254, v1, 4, 2
    v_mul_u32_u24 v254, 4, v254
    v_add_u32 v16, v16, v254
    v_add_u32 v16, 135168, v16
    v_add_u32 v16, s58, v16
    s_lshl_b32 s4, s56, 9
    s_add_u32 s4, s4, 92291072
    v_bfe_u32 v254, v1, 0, 2
    v_mul_u32_u24 v13, 128, v254
    v_bfe_u32 v254, v1, 2, 1
    v_mul_u32_u24 v254, 16384, v254
    v_add_u32 v13, v13, v254
    v_add_u32 v13, s4, v13
    s_waitcnt vmcnt(0)
    ds_read_b64_tr_b16 a[192:193], v242 offset:16384
    ds_read_b64_tr_b16 a[194:195], v242 offset:16896
    ds_read_b64_tr_b16 a[196:197], v242 offset:18432
    ds_read_b64_tr_b16 a[198:199], v242 offset:18944
    ds_read_b64_tr_b16 a[200:201], v242 offset:20480
    ds_read_b64_tr_b16 a[202:203], v242 offset:20992
    ds_read_b64_tr_b16 a[204:205], v242 offset:22528
    ds_read_b64_tr_b16 a[206:207], v242 offset:23040
    ds_read_b64_tr_b16 a[208:209], v242 offset:24576
    ds_read_b64_tr_b16 a[210:211], v242 offset:25088
    ds_read_b64_tr_b16 a[212:213], v242 offset:26624
    ds_read_b64_tr_b16 a[214:215], v242 offset:27136
    ds_read_b64_tr_b16 a[216:217], v242 offset:28672
    ds_read_b64_tr_b16 a[218:219], v242 offset:29184
    ds_read_b64_tr_b16 a[220:221], v242 offset:30720
    ds_read_b64_tr_b16 a[222:223], v242 offset:31232
    ds_read_b64_tr_b16 a[224:225], v243 offset:16384
    ds_read_b64_tr_b16 a[226:227], v243 offset:16896
    ds_read_b64_tr_b16 a[228:229], v243 offset:18432
    ds_read_b64_tr_b16 a[230:231], v243 offset:18944
    ds_read_b64_tr_b16 a[232:233], v243 offset:20480
    ds_read_b64_tr_b16 a[234:235], v243 offset:20992
    ds_read_b64_tr_b16 a[236:237], v243 offset:22528
    ds_read_b64_tr_b16 a[238:239], v243 offset:23040
    ds_read_b64_tr_b16 a[240:241], v243 offset:24576
    ds_read_b64_tr_b16 a[242:243], v243 offset:25088
    ds_read_b64_tr_b16 a[244:245], v243 offset:26624
    ds_read_b64_tr_b16 a[246:247], v243 offset:27136
    ds_read_b64_tr_b16 a[248:249], v243 offset:28672
    ds_read_b64_tr_b16 a[250:251], v243 offset:29184
    ds_read_b64_tr_b16 a[252:253], v243 offset:30720
    ds_read_b64_tr_b16 a[254:255], v243 offset:31232
    s_waitcnt lgkmcnt(0)
    s_cmp_ge_u32 s46, 1
    s_cbranch_scc1 .kvd_258
    s_mov_b32 s62, 0
.kv_257:
    buffer_load_dword v18, v13, s[8:11], 0 offen sc1
    s_add_u32 s62, s62, 1
    s_cmp_gt_u32 s62, 0x100000
    s_cbranch_scc1 .mg_end_1
    s_waitcnt vmcnt(0)
    v_min_u32_dpp v18, v18, v18 quad_perm:[1,0,3,2] row_mask:0xf bank_mask:0xf
    s_nop 1
    v_min_u32_dpp v18, v18, v18 quad_perm:[2,3,0,1] row_mask:0xf bank_mask:0xf
    s_nop 1
    v_min_u32_dpp v18, v18, v18 row_half_mirror row_mask:0xf bank_mask:0xf
    s_nop 0
    v_readfirstlane_b32 s46, v18
    s_cmp_lt_u32 s46, 1
    s_cbranch_scc1 .kv_257
.kvd_258:
    s_barrier
.p2align 6
.step_259:
    s_barrier
    s_setprio 3
    buffer_load_dwordx4 v[24:27], v3, s[8:11], s30 offen offset:0 sc1
    s_setprio 2
    buffer_load_dwordx4 v[28:31], v3, s[8:11], s30 offen offset:1024 sc1
    s_setprio 1
    buffer_load_dwordx4 v[32:35], v3, s[8:11], s30 offen offset:2048 sc1
    s_setprio 0
    buffer_load_dwordx4 v[36:39], v3, s[8:11], s30 offen offset:3072 sc1
    s_waitcnt vmcnt(3)
    v_max_u32 v18, v25, v27
    v_cmp_eq_u32 vcc, -1, v18
    s_cbranch_vccnz .gs_261
.gr_262:
    v_smfmac_f32_16x16x64_bf16 v[40:43], v[24:27], a[0:7], v2
    v_smfmac_f32_16x16x64_bf16 v[44:47], v[24:27], a[32:39], v2
    s_waitcnt vmcnt(2)
    v_max_u32 v18, v29, v31
    v_cmp_eq_u32 vcc, -1, v18
    v_smfmac_f32_16x16x64_bf16 v[48:51], v[24:27], a[64:71], v2
    s_cbranch_vccnz .gs_264
.gr_265:
    v_smfmac_f32_16x16x64_bf16 v[40:43], v[28:31], a[8:15], v2
    v_smfmac_f32_16x16x64_bf16 v[44:47], v[28:31], a[40:47], v2
    v_smfmac_f32_16x16x64_bf16 v[52:55], v[24:27], a[96:103], v2
    s_waitcnt vmcnt(1)
    v_max_u32 v18, v33, v35
    v_cmp_eq_u32 vcc, -1, v18
    v_smfmac_f32_16x16x64_bf16 v[48:51], v[28:31], a[72:79], v2
    s_cbranch_vccnz .gs_267
.gr_268:
    v_smfmac_f32_16x16x64_bf16 v[40:43], v[32:35], a[16:23], v2
    v_smfmac_f32_16x16x64_bf16 v[44:47], v[32:35], a[48:55], v2
    v_smfmac_f32_16x16x64_bf16 v[52:55], v[28:31], a[104:111], v2
    s_waitcnt vmcnt(0)
    v_max_u32 v18, v37, v39
    v_cmp_eq_u32 vcc, -1, v18
    v_smfmac_f32_16x16x64_bf16 v[48:51], v[32:35], a[80:87], v2
    s_cbranch_vccnz .gs_270
.gr_271:
    v_smfmac_f32_16x16x64_bf16 v[40:43], v[36:39], a[24:31], v2
    v_smfmac_f32_16x16x64_bf16 v[44:47], v[36:39], a[56:63], v2
    v_smfmac_f32_16x16x64_bf16 v[52:55], v[32:35], a[112:119], v2
    v_smfmac_f32_16x16x64_bf16 v[48:51], v[36:39], a[88:95], v2
    v_permlane32_swap_b32 v40, v44
    v_permlane32_swap_b32 v41, v45
    v_smfmac_f32_16x16x64_bf16 v[52:55], v[36:39], a[120:127], v2
    v_permlane32_swap_b32 v42, v46
    v_permlane32_swap_b32 v43, v47
    v_add_f32 v40, v40, v44
    v_add_f32 v41, v41, v45
    v_add_f32 v42, v42, v46
    v_add_f32 v43, v43, v47
    ds_write2_b32 v5, v40, v41 offset0:0 offset1:36
    ds_write2_b32 v5, v42, v43 offset0:72 offset1:108
    v_permlane32_swap_b32 v48, v52
    v_permlane32_swap_b32 v49, v53
    v_permlane32_swap_b32 v50, v54
    v_permlane32_swap_b32 v51, v55
    v_pk_add_f32 v[48:49], v[48:49], v[52:53]
    v_pk_add_f32 v[50:51], v[50:51], v[54:55]
    ds_write2_b32 v6, v48, v49 offset0:0 offset1:36
    ds_write2_b32 v6, v50, v51 offset0:72 offset1:108
    s_waitcnt lgkmcnt(2)
    s_barrier
    s_waitcnt lgkmcnt(0)
    s_barrier
    ds_read_b64 v[72:73], v9 offset:0
    ds_read_b64 v[74:75], v9 offset:1152
    ds_read_b64 v[76:77], v9 offset:2304
    ds_read_b64 v[78:79], v9 offset:3456
    s_waitcnt lgkmcnt(2)
    v_pk_add_f32 v[72:73], v[72:73], v[74:75]
    s_waitcnt lgkmcnt(0)
    v_pk_add_f32 v[76:77], v[76:77], v[78:79]
    v_pk_add_f32 v[72:73], v[72:73], v[76:77]
    v_cvt_pk_bf16_f32 v72, v72, v73
    v_min_u32 v72, 0xfffffffe, v72
    buffer_store_dword v72, v10, s[8:11], s30 offen sc1
    v_smfmac_f32_16x16x64_bf16 v[56:59], v[24:27], a[128:135], v2
    v_smfmac_f32_16x16x64_bf16 v[60:63], v[24:27], a[160:167], v2
    v_smfmac_f32_16x16x64_bf16 v[56:59], v[28:31], a[136:143], v2
    v_smfmac_f32_16x16x64_bf16 v[60:63], v[28:31], a[168:175], v2
    v_smfmac_f32_16x16x64_bf16 v[56:59], v[32:35], a[144:151], v2
    v_smfmac_f32_16x16x64_bf16 v[60:63], v[32:35], a[176:183], v2
    v_smfmac_f32_16x16x64_bf16 v[56:59], v[36:39], a[152:159], v2
    v_smfmac_f32_16x16x64_bf16 v[60:63], v[36:39], a[184:191], v2
    ds_write_b32 v11, v72
    v_mov_b32 v40, 0
    v_mov_b32 v41, 0
    v_mov_b32 v42, 0
    v_mov_b32 v43, 0
    v_mov_b32 v44, 0
    v_mov_b32 v45, 0
    v_mov_b32 v46, 0
    v_mov_b32 v47, 0
    v_permlane32_swap_b32 v56, v60
    v_permlane32_swap_b32 v57, v61
    v_permlane32_swap_b32 v58, v62
    v_permlane32_swap_b32 v59, v63
    v_pk_add_f32 v[56:57], v[56:57], v[60:61]
    v_pk_add_f32 v[58:59], v[58:59], v[62:63]
    ds_write_b128 v8, v[56:59]
    s_waitcnt lgkmcnt(0)
    s_barrier
    ds_read_b64 v[72:73], v12 offset:0
    ds_read_b64 v[74:75], v12 offset:1024
    ds_read_b64 v[76:77], v12 offset:2048
    ds_read_b64 v[78:79], v12 offset:3072
    ds_read_b64 v[80:81], v12 offset:64
    ds_read_b64 v[82:83], v12 offset:1088
    ds_read_b64 v[84:85], v12 offset:2112
    ds_read_b64 v[86:87], v12 offset:3136
    s_waitcnt lgkmcnt(4)
    v_add_f32 v72, v72, v74
    v_add_f32 v73, v73, v75
    v_add_f32 v76, v76, v78
    v_add_f32 v77, v77, v79
    v_add_f32 v72, v72, v76
    v_add_f32 v73, v73, v77
    v_cvt_pk_bf16_f32 v72, v72, v73
    s_waitcnt lgkmcnt(0)
    v_add_f32 v80, v80, v82
    v_add_f32 v81, v81, v83
    v_add_f32 v84, v84, v86
    v_add_f32 v85, v85, v87
    v_add_f32 v80, v80, v84
    v_add_f32 v81, v81, v85
    v_cvt_pk_bf16_f32 v80, v80, v81
    ds_write_b32 v14, v72
    ds_write_b32 v14, v80 offset:64
    s_waitcnt lgkmcnt(0)
    s_barrier
    s_cmp_eq_u32 s28, 63
    s_cbranch_scc1 .fin_260
    s_add_u32 s5, s28, 2
    s_cmp_ge_u32 s46, s5
    s_cbranch_scc1 .kvd_274
    s_mov_b32 s62, 0
.kv_273:
    buffer_load_dword v18, v13, s[8:11], 0 offen sc1
    s_add_u32 s62, s62, 1
    s_cmp_gt_u32 s62, 0x100000
    s_cbranch_scc1 .mg_end_1
    s_waitcnt vmcnt(0)
    v_min_u32_dpp v18, v18, v18 quad_perm:[1,0,3,2] row_mask:0xf bank_mask:0xf
    s_nop 1
    v_min_u32_dpp v18, v18, v18 quad_perm:[2,3,0,1] row_mask:0xf bank_mask:0xf
    s_nop 1
    v_min_u32_dpp v18, v18, v18 row_half_mirror row_mask:0xf bank_mask:0xf
    s_nop 0
    v_readfirstlane_b32 s46, v18
    s_cmp_lt_u32 s46, s5
    s_cbranch_scc1 .kv_273
.kvd_274:
    v_mov_b32 v48, 0
    v_mov_b32 v49, 0
    v_mov_b32 v50, 0
    v_mov_b32 v51, 0
    v_mov_b32 v52, 0
    v_mov_b32 v53, 0
    v_mov_b32 v54, 0
    v_mov_b32 v55, 0
    v_mov_b32 v56, 0
    v_mov_b32 v57, 0
    v_mov_b32 v58, 0
    v_mov_b32 v59, 0
    v_mov_b32 v60, 0
    v_mov_b32 v61, 0
    v_mov_b32 v62, 0
    v_mov_b32 v63, 0
    s_barrier
    s_setprio 3
    buffer_load_dwordx4 v[24:27], v4, s[8:11], s30 offen offset:0 sc1
    s_setprio 2
    buffer_load_dwordx4 v[28:31], v4, s[8:11], s30 offen offset:1024 sc1
    s_setprio 1
    buffer_load_dwordx4 v[32:35], v4, s[8:11], s30 offen offset:2048 sc1
    s_setprio 0
    buffer_load_dwordx4 v[36:39], v4, s[8:11], s30 offen offset:3072 sc1
    s_waitcnt vmcnt(3)
    v_smfmac_f32_16x16x64_bf16 v[64:67], v[24:27], a[192:199], v2
    v_cmp_eq_u32 vcc, -1, v27
    v_smfmac_f32_16x16x64_bf16 v[68:71], v[24:27], a[224:231], v2
    s_cbranch_vccnz .gs_275
.gr_276:
    s_waitcnt vmcnt(2)
    v_smfmac_f32_16x16x64_bf16 v[64:67], v[28:31], a[200:207], v2
    v_cmp_eq_u32 vcc, -1, v31
    v_smfmac_f32_16x16x64_bf16 v[68:71], v[28:31], a[232:239], v2
    s_cbranch_vccnz .gs_278
.gr_279:
    s_waitcnt vmcnt(1)
    v_smfmac_f32_16x16x64_bf16 v[64:67], v[32:35], a[208:215], v2
    v_cmp_eq_u32 vcc, -1, v35
    v_smfmac_f32_16x16x64_bf16 v[68:71], v[32:35], a[240:247], v2
    s_cbranch_vccnz .gs_281
.gr_282:
    s_waitcnt vmcnt(0)
    v_smfmac_f32_16x16x64_bf16 v[64:67], v[36:39], a[216:223], v2
    v_cmp_eq_u32 vcc, -1, v39
    v_smfmac_f32_16x16x64_bf16 v[68:71], v[36:39], a[248:255], v2
    s_cbranch_vccnz .gs_284
.gr_285:
    s_nop 6
    v_permlane32_swap_b32 v64, v68
    v_permlane32_swap_b32 v65, v69
    v_permlane32_swap_b32 v66, v70
    v_permlane32_swap_b32 v67, v71
    v_pk_add_f32 v[64:65], v[64:65], v[68:69]
    v_pk_add_f32 v[66:67], v[66:67], v[70:71]
    ds_write2_b32 v7, v64, v65 offset0:0 offset1:36
    ds_write2_b32 v7, v66, v67 offset0:72 offset1:108
    s_waitcnt lgkmcnt(0)
    s_barrier
    buffer_store_dwordx4 v[20:23], v15, s[8:11], s36 offen sc1
    buffer_store_dwordx4 v[20:23], v244, s[8:11], s32 offen sc1
    buffer_store_dwordx4 v[20:23], v245, s[8:11], s32 offen sc1
    s_add_u32 s5, s28, 3
    s_min_u32 s5, s5, 64
    s_cmp_ge_u32 s46, s5
    s_cbranch_scc1 .kvd_288
    s_mov_b32 s62, 0
.kv_287:
    buffer_load_dword v18, v13, s[8:11], 0 offen sc1
    s_add_u32 s62, s62, 1
    s_cmp_gt_u32 s62, 0x100000
    s_cbranch_scc1 .mg_end_1
    s_waitcnt vmcnt(0)
    v_min_u32_dpp v18, v18, v18 quad_perm:[1,0,3,2] row_mask:0xf bank_mask:0xf
    s_nop 1
    v_min_u32_dpp v18, v18, v18 quad_perm:[2,3,0,1] row_mask:0xf bank_mask:0xf
    s_nop 1
    v_min_u32_dpp v18, v18, v18 row_half_mirror row_mask:0xf bank_mask:0xf
    s_nop 0
    v_readfirstlane_b32 s46, v18
.kvd_288:
    v_mov_b32 v64, 0
    v_mov_b32 v65, 0
    v_mov_b32 v66, 0
    v_mov_b32 v67, 0
    v_mov_b32 v68, 0
    v_mov_b32 v69, 0
    v_mov_b32 v70, 0
    v_mov_b32 v71, 0
    s_mov_b32 s4, s30
    s_mov_b32 s30, s31
    s_mov_b32 s31, s32
    s_mov_b32 s32, s33
    s_mov_b32 s33, s4
    s_add_u32 s28, s28, 1
    s_mov_b32 s62, 0
    s_mov_b32 s4, s34
    s_mov_b32 s34, s35
    s_mov_b32 s35, s36
    s_mov_b32 s36, s37
    s_mov_b32 s37, s4
    s_add_u32 s41, s41, 0x20000
    s_branch .step_259
.fin_260:
    s_endpgm
.gs_261:
    buffer_load_dwordx4 v[24:27], v3, s[8:11], s30 offen offset:0 sc1
    buffer_load_dwordx4 v[28:31], v3, s[8:11], s30 offen offset:1024 sc1
    buffer_load_dwordx4 v[32:35], v3, s[8:11], s30 offen offset:2048 sc1
    buffer_load_dwordx4 v[36:39], v3, s[8:11], s30 offen offset:3072 sc1
    s_add_u32 s62, s62, 1
    s_cmp_gt_u32 s62, 0x100000
    s_cbranch_scc1 .mg_end_1
    s_waitcnt vmcnt(3)
    v_max_u32 v18, v25, v27
    v_cmp_eq_u32 vcc, -1, v18
    s_cbranch_vccz .gr_262
    s_branch .gs_261
.gs_264:
    buffer_load_dwordx4 v[28:31], v3, s[8:11], s30 offen offset:1024 sc1
    buffer_load_dwordx4 v[32:35], v3, s[8:11], s30 offen offset:2048 sc1
    buffer_load_dwordx4 v[36:39], v3, s[8:11], s30 offen offset:3072 sc1
    s_add_u32 s62, s62, 1
    s_cmp_gt_u32 s62, 0x100000
    s_cbranch_scc1 .mg_end_1
    s_waitcnt vmcnt(2)
    v_max_u32 v18, v29, v31
    v_cmp_eq_u32 vcc, -1, v18
    s_cbranch_vccz .gr_265
    s_branch .gs_264
.gs_267:
    buffer_load_dwordx4 v[32:35], v3, s[8:11], s30 offen offset:2048 sc1
    buffer_load_dwordx4 v[36:39], v3, s[8:11], s30 offen offset:3072 sc1
    s_add_u32 s62, s62, 1
    s_cmp_gt_u32 s62, 0x100000
    s_cbranch_scc1 .mg_end_1
    s_waitcnt vmcnt(1)
    v_max_u32 v18, v33, v35
    v_cmp_eq_u32 vcc, -1, v18
    s_cbranch_vccz .gr_268
    s_branch .gs_267
.gs_270:
    buffer_load_dwordx4 v[36:39], v3, s[8:11], s30 offen offset:3072 sc1
    s_add_u32 s62, s62, 1
    s_cmp_gt_u32 s62, 0x100000
    s_cbranch_scc1 .mg_end_1
    s_waitcnt vmcnt(0)
    v_max_u32 v18, v37, v39
    v_cmp_eq_u32 vcc, -1, v18
    s_cbranch_vccz .gr_271
    s_branch .gs_270
.gs_275:
    buffer_load_dwordx4 v[24:27], v4, s[8:11], s30 offen offset:0 sc1
    buffer_load_dwordx4 v[28:31], v4, s[8:11], s30 offen offset:1024 sc1
    buffer_load_dwordx4 v[32:35], v4, s[8:11], s30 offen offset:2048 sc1
    buffer_load_dwordx4 v[36:39], v4, s[8:11], s30 offen offset:3072 sc1
    s_nop 2
    v_mov_b32 v64, 0
    v_mov_b32 v65, 0
    v_mov_b32 v66, 0
    v_mov_b32 v67, 0
    v_mov_b32 v68, 0
    v_mov_b32 v69, 0
    v_mov_b32 v70, 0
    v_mov_b32 v71, 0
    s_nop 1
    s_branch .gc_289
.gl_277:
    buffer_load_dwordx4 v[24:27], v4, s[8:11], s30 offen offset:0 sc1
    buffer_load_dwordx4 v[28:31], v4, s[8:11], s30 offen offset:1024 sc1
    buffer_load_dwordx4 v[32:35], v4, s[8:11], s30 offen offset:2048 sc1
    buffer_load_dwordx4 v[36:39], v4, s[8:11], s30 offen offset:3072 sc1
.gc_289:
    s_add_u32 s62, s62, 1
    s_cmp_gt_u32 s62, 0x100000
    s_cbranch_scc1 .mg_end_1
    s_waitcnt vmcnt(3)
    v_cmp_eq_u32 vcc, -1, v27
    s_cbranch_vccnz .gl_277
    v_smfmac_f32_16x16x64_bf16 v[64:67], v[24:27], a[192:199], v2
    v_smfmac_f32_16x16x64_bf16 v[68:71], v[24:27], a[224:231], v2
    s_branch .gr_276
.gs_278:
    buffer_load_dwordx4 v[28:31], v4, s[8:11], s30 offen offset:1024 sc1
    buffer_load_dwordx4 v[32:35], v4, s[8:11], s30 offen offset:2048 sc1
    buffer_load_dwordx4 v[36:39], v4, s[8:11], s30 offen offset:3072 sc1
    s_nop 3
    v_mov_b32 v64, 0
    v_mov_b32 v65, 0
    v_mov_b32 v66, 0
    v_mov_b32 v67, 0
    v_mov_b32 v68, 0
    v_mov_b32 v69, 0
    v_mov_b32 v70, 0
    v_mov_b32 v71, 0
    s_nop 1
    v_smfmac_f32_16x16x64_bf16 v[64:67], v[24:27], a[192:199], v2
    v_smfmac_f32_16x16x64_bf16 v[68:71], v[24:27], a[224:231], v2
    s_branch .gc_290
.gl_280:
    buffer_load_dwordx4 v[28:31], v4, s[8:11], s30 offen offset:1024 sc1
    buffer_load_dwordx4 v[32:35], v4, s[8:11], s30 offen offset:2048 sc1
    buffer_load_dwordx4 v[36:39], v4, s[8:11], s30 offen offset:3072 sc1
.gc_290:
    s_add_u32 s62, s62, 1
    s_cmp_gt_u32 s62, 0x100000
    s_cbranch_scc1 .mg_end_1
    s_waitcnt vmcnt(2)
    v_cmp_eq_u32 vcc, -1, v31
    s_cbranch_vccnz .gl_280
    v_smfmac_f32_16x16x64_bf16 v[64:67], v[28:31], a[200:207], v2
    v_smfmac_f32_16x16x64_bf16 v[68:71], v[28:31], a[232:239], v2
    s_branch .gr_279
.gs_281:
    buffer_load_dwordx4 v[32:35], v4, s[8:11], s30 offen offset:2048 sc1
    buffer_load_dwordx4 v[36:39], v4, s[8:11], s30 offen offset:3072 sc1
    s_nop 4
    v_mov_b32 v64, 0
    v_mov_b32 v65, 0
    v_mov_b32 v66, 0
    v_mov_b32 v67, 0
    v_mov_b32 v68, 0
    v_mov_b32 v69, 0
    v_mov_b32 v70, 0
    v_mov_b32 v71, 0
    s_nop 1
    v_smfmac_f32_16x16x64_bf16 v[64:67], v[24:27], a[192:199], v2
    v_smfmac_f32_16x16x64_bf16 v[68:71], v[24:27], a[224:231], v2
    v_smfmac_f32_16x16x64_bf16 v[64:67], v[28:31], a[200:207], v2
    v_smfmac_f32_16x16x64_bf16 v[68:71], v[28:31], a[232:239], v2
    s_branch .gc_291
.gl_283:
    buffer_load_dwordx4 v[32:35], v4, s[8:11], s30 offen offset:2048 sc1
    buffer_load_dwordx4 v[36:39], v4, s[8:11], s30 offen offset:3072 sc1
.gc_291:
    s_add_u32 s62, s62, 1
    s_cmp_gt_u32 s62, 0x100000
    s_cbranch_scc1 .mg_end_1
    s_waitcnt vmcnt(1)
    v_cmp_eq_u32 vcc, -1, v35
    s_cbranch_vccnz .gl_283
    v_smfmac_f32_16x16x64_bf16 v[64:67], v[32:35], a[208:215], v2
    v_smfmac_f32_16x16x64_bf16 v[68:71], v[32:35], a[240:247], v2
    s_branch .gr_282
.gs_284:
    buffer_load_dwordx4 v[36:39], v4, s[8:11], s30 offen offset:3072 sc1
    s_nop 5
    v_mov_b32 v64, 0
    v_mov_b32 v65, 0
    v_mov_b32 v66, 0
    v_mov_b32 v67, 0
    v_mov_b32 v68, 0
    v_mov_b32 v69, 0
    v_mov_b32 v70, 0
    v_mov_b32 v71, 0
    s_nop 1
    v_smfmac_f32_16x16x64_bf16 v[64:67], v[24:27], a[192:199], v2
    v_smfmac_f32_16x16x64_bf16 v[68:71], v[24:27], a[224:231], v2
    v_smfmac_f32_16x16x64_bf16 v[64:67], v[28:31], a[200:207], v2
    v_smfmac_f32_16x16x64_bf16 v[68:71], v[28:31], a[232:239], v2
    v_smfmac_f32_16x16x64_bf16 v[64:67], v[32:35], a[208:215], v2
    v_smfmac_f32_16x16x64_bf16 v[68:71], v[32:35], a[240:247], v2
    s_branch .gc_292
.gl_286:
    buffer_load_dwordx4 v[36:39], v4, s[8:11], s30 offen offset:3072 sc1
.gc_292:
    s_add_u32 s62, s62, 1
    s_cmp_gt_u32 s62, 0x100000
    s_cbranch_scc1 .mg_end_1
    s_waitcnt vmcnt(0)
    v_cmp_eq_u32 vcc, -1, v39
    s_cbranch_vccnz .gl_286
    v_smfmac_f32_16x16x64_bf16 v[64:67], v[36:39], a[216:223], v2
    v_smfmac_f32_16x16x64_bf16 v[68:71], v[36:39], a[248:255], v2
    s_branch .gr_285
.mg_bg_2:
    s_lshr_b32 s98, s26, 3
    s_add_u32 s98, s98, 1
    s_and_b32 s98, s98, 3
    s_and_b32 s99, s25, 3
    s_lshl_b32 s99, s99, 3
    s_and_b32 s4, s26, 7
    s_add_u32 s99, s99, s4
    s_mov_b32 s96, 0
    v_and_b32 v1, 63, v0
    v_mov_b32 v250, 0
    v_mov_b32 v251, 0
    s_bitcmp0_b32 s26, 4
    s_cbranch_scc1 .qkv_294
    s_bfe_u32 s95, s26, 0x10003
    s_waitcnt vmcnt(0)
    s_barrier
    s_cmp_lg_u32 s24, 1
    s_cbranch_scc1 .ns_295
    s_mov_b64 exec, 1
    v_mov_b32 v238, s3
    v_mov_b32 v239, 0
    buffer_atomic_add v238, v239, s[20:23], 0 offen offset:196 sc1
    s_mov_b64 exec, -1
.ns_295:
    s_load_dwordx8 s[40:47], s[0:1], 0
    s_load_dwordx4 s[48:51], s[0:1], 32
    s_load_dwordx2 s[52:53], s[0:1], 104
    s_mul_i32 s6, s24, 8320
    s_add_u32 s6, s6, 122880
    s_lshl_b32 s97, s95, 4
    s_and_b32 s4, s99, 16
    s_add_u32 s97, s97, s4
    s_add_u32 s97, s97, s99
    s_lshl_b32 s4, s97, 16
    s_lshl_b32 s5, s24, 14
    s_add_u32 s4, s4, s5
    v_lshlrev_b32 v2, 4, v1
    v_bfe_u32 v254, v1, 0, 3
    v_mul_u32_u24 v3, 2048, v254
    v_bfe_u32 v254, v1, 4, 2
    v_mul_u32_u24 v254, 16, v254
    v_add_u32 v3, v3, v254
    v_add_u32 v3, s4, v3
    v_bfe_u32 v254, v1, 4, 2
    v_mul_u32_u24 v4, 16, v254
    v_add_u32 v4, s6, v4
    s_waitcnt lgkmcnt(0)
    s_mov_b32 s12, s40
    s_and_b32 s13, s41, 0xffff
    s_mov_b32 s14, 0x400000
    s_mov_b32 s15, 0x00020000
    s_mov_b32 s16, s42
    s_and_b32 s17, s43, 0xffff
    s_mov_b32 s18, 0x400000
    s_mov_b32 s19, 0x00020000
    s_mov_b32 s28, s44
    s_and_b32 s29, s45, 0xffff
    s_mov_b32 s30, 0x400000
    s_mov_b32 s31, 0x00020000
    s_mov_b32 s32, s46
    s_and_b32 s33, s47, 0xffff
    s_mov_b32 s34, 0x2000
    s_mov_b32 s35, 0x00020000
    s_mov_b32 s36, s48
    s_and_b32 s37, s49, 0xffff
    s_mov_b32 s38, 0x400000
    s_mov_b32 s39, 0x00020000
    s_mov_b32 s56, s52
    s_and_b32 s57, s53, 0xffff
    s_mov_b32 s58, 0x800
    s_mov_b32 s59, 0x00020000
    s_mov_b32 m0, s6
    s_lshl_b32 s60, s97, 4
    buffer_load_dwordx4 v2, s[56:59], 0 offen lds
    buffer_load_dwordx4 v2, s[56:59], 0 offen offset:1024 lds
    s_add_u32 s61, s60, s24
    v_subrev_u32 v5, 4, v2
    buffer_load_dwordx4 a[0:3], v3, s[12:15], 0 offen offset:0
    buffer_load_dwordx4 a[4:7], v3, s[12:15], 0 offen offset:64
    buffer_load_dwordx4 a[8:11], v3, s[12:15], 0 offen offset:128
    buffer_load_dwordx4 a[12:15], v3, s[12:15], 0 offen offset:192
    buffer_load_dwordx4 a[16:19], v3, s[12:15], 0 offen offset:256
    buffer_load_dwordx4 a[20:23], v3, s[12:15], 0 offen offset:320
    buffer_load_dwordx4 a[24:27], v3, s[12:15], 0 offen offset:384
    buffer_load_dwordx4 a[28:31], v3, s[12:15], 0 offen offset:448
    buffer_load_dwordx4 a[32:35], v3, s[12:15], 0 offen offset:512
    buffer_load_dwordx4 a[36:39], v3, s[12:15], 0 offen offset:576
    buffer_load_dwordx4 a[40:43], v3, s[12:15], 0 offen offset:640
    buffer_load_dwordx4 a[44:47], v3, s[12:15], 0 offen offset:704
    buffer_load_dwordx4 a[48:51], v3, s[12:15], 0 offen offset:768
    buffer_load_dwordx4 a[52:55], v3, s[12:15], 0 offen offset:832
    buffer_load_dwordx4 a[56:59], v3, s[12:15], 0 offen offset:896
    buffer_load_dwordx4 a[60:63], v3, s[12:15], 0 offen offset:960
    buffer_load_dwordx4 a[64:67], v3, s[12:15], 0 offen offset:1024
    buffer_load_dwordx4 a[68:71], v3, s[12:15], 0 offen offset:1088
    buffer_load_dwordx4 a[72:75], v3, s[12:15], 0 offen offset:1152
    buffer_load_dwordx4 a[76:79], v3, s[12:15], 0 offen offset:1216
    buffer_load_dwordx4 a[80:83], v3, s[12:15], 0 offen offset:1280
    buffer_load_dwordx4 a[84:87], v3, s[12:15], 0 offen offset:1344
    buffer_load_dwordx4 a[88:91], v3, s[12:15], 0 offen offset:1408
    buffer_load_dwordx4 a[92:95], v3, s[12:15], 0 offen offset:1472
    buffer_load_dwordx4 a[96:99], v3, s[12:15], 0 offen offset:1536
    buffer_load_dwordx4 a[100:103], v3, s[12:15], 0 offen offset:1600
    buffer_load_dwordx4 a[104:107], v3, s[12:15], 0 offen offset:1664
    buffer_load_dwordx4 a[108:111], v3, s[12:15], 0 offen offset:1728
    buffer_load_dwordx4 a[112:115], v3, s[12:15], 0 offen offset:1792
    buffer_load_dwordx4 a[116:119], v3, s[12:15], 0 offen offset:1856
    buffer_load_dwordx4 a[120:123], v3, s[12:15], 0 offen offset:1920
    buffer_load_dwordx4 a[124:127], v3, s[12:15], 0 offen offset:1984
    s_lshl_b32 s4, s24, 19
    s_lshl_b32 s5, s97, 5
    s_add_u32 s4, s4, s5
    v_bfe_u32 v254, v1, 1, 5
    v_mul_u32_u24 v7, 16384, v254
    v_bfe_u32 v254, v1, 0, 1
    v_mul_u32_u24 v254, 16, v254
    v_add_u32 v7, v7, v254
    v_add_u32 v7, s4, v7
    s_waitcnt vmcnt(32)
    ds_read_b128 a[128:131], v4 offset:0
    ds_read_b128 a[132:135], v4 offset:64
    ds_read_b128 a[136:139], v4 offset:128
    ds_read_b128 a[140:143], v4 offset:192
    ds_read_b128 a[144:147], v4 offset:256
    ds_read_b128 a[148:151], v4 offset:320
    ds_read_b128 a[152:155], v4 offset:384
    ds_read_b128 a[156:159], v4 offset:448
    ds_read_b128 a[160:163], v4 offset:512
    ds_read_b128 a[164:167], v4 offset:576
    ds_read_b128 a[168:171], v4 offset:640
    ds_read_b128 a[172:175], v4 offset:704
    ds_read_b128 a[176:179], v4 offset:768
    ds_read_b128 a[180:183], v4 offset:832
    ds_read_b128 a[184:187], v4 offset:896
    ds_read_b128 a[188:191], v4 offset:960
    ds_read_b128 a[192:195], v4 offset:1024
    ds_read_b128 a[196:199], v4 offset:1088
    ds_read_b128 a[200:203], v4 offset:1152
    ds_read_b128 a[204:207], v4 offset:1216
    ds_read_b128 a[208:211], v4 offset:1280
    ds_read_b128 a[212:215], v4 offset:1344
    ds_read_b128 a[216:219], v4 offset:1408
    ds_read_b128 a[220:223], v4 offset:1472
    ds_read_b128 a[224:227], v4 offset:1536
    ds_read_b128 a[228:231], v4 offset:1600
    ds_read_b128 a[232:235], v4 offset:1664
    ds_read_b128 a[236:239], v4 offset:1728
    ds_read_b128 a[240:243], v4 offset:1792
    ds_read_b128 a[244:247], v4 offset:1856
    ds_read_b128 a[248:251], v4 offset:1920
    ds_read_b128 a[252:255], v4 offset:1984
    v_subrev_u32 v8, 6144, v7
    buffer_load_dwordx4 v[32:35], v8, s[16:19], 0 offen
    v_subrev_u32 v8, 4096, v7
    buffer_load_dwordx4 v[36:39], v8, s[16:19], 0 offen
    v_subrev_u32 v8, 2048, v7
    buffer_load_dwordx4 v[40:43], v8, s[16:19], 0 offen
    s_mov_b32 s4, 0
    buffer_load_dwordx4 v[44:47], v7, s[16:19], s4 offen offset:0
    buffer_load_dwordx4 v[76:79], v7, s[28:31], s4 offen offset:0
    buffer_load_dwordx4 v[48:51], v7, s[16:19], s4 offen offset:2048
    buffer_load_dwordx4 v[80:83], v7, s[28:31], s4 offen offset:2048
    s_mov_b32 s4, 4096
    buffer_load_dwordx4 v[52:55], v7, s[16:19], s4 offen offset:0
    buffer_load_dwordx4 v[84:87], v7, s[28:31], s4 offen offset:0
    buffer_load_dwordx4 v[56:59], v7, s[16:19], s4 offen offset:2048
    buffer_load_dwordx4 v[88:91], v7, s[28:31], s4 offen offset:2048
    s_mov_b32 s4, 8192
    buffer_load_dwordx4 v[60:63], v7, s[16:19], s4 offen offset:0
    buffer_load_dwordx4 v[92:95], v7, s[28:31], s4 offen offset:0
    buffer_load_dwordx4 v[64:67], v7, s[16:19], s4 offen offset:2048
    buffer_load_dwordx4 v[96:99], v7, s[28:31], s4 offen offset:2048
    s_mov_b32 s4, 12288
    buffer_load_dwordx4 v[68:71], v7, s[16:19], s4 offen offset:0
    buffer_load_dwordx4 v[100:103], v7, s[28:31], s4 offen offset:0
    buffer_load_dwordx4 v[72:75], v7, s[16:19], s4 offen offset:2048
    buffer_load_dwordx4 v[104:107], v7, s[28:31], s4 offen offset:2048
    v_add_u32 v9, s6, v2
    v_and_b32 v12, 31, v1
    v_lshrrev_b32 v13, 5, v1
    v_lshlrev_b32 v14, 3, v13
    v_sub_u32 v14, v12, v14
    v_add_u32 v15, 10, v14
    v_and_b32 v10, 1, v15
    v_xor_b32 v10, 1, v10
    v_mul_u32_u24 v10, 4160, v10
    v_lshrrev_b32 v15, 1, v15
    v_lshl_add_u32 v10, v15, 2, v10
    v_add_u32 v10, s6, v10
    v_mul_u32_u24 v11, 80, v12
    v_lshl_add_u32 v11, v13, 4, v11
    s_mul_i32 s4, s24, 7680
    s_sub_u32 s4, s4, 2480
    v_add_u32 v11, s4, v11
    v_cmp_eq_u32 vcc, 7, v14
    v_mov_b32 v15, 0xffff
    s_nop 0
    v_cndmask_b32 v24, 0, v15, vcc
    v_cmp_eq_u32 vcc, 6, v14
    v_mov_b32 v15, 0xffff0000
    s_nop 0
    v_cndmask_b32 v24, v24, v15, vcc
    v_cmp_eq_u32 vcc, 5, v14
    v_mov_b32 v15, 0xffff
    s_nop 0
    v_cndmask_b32 v25, 0, v15, vcc
    v_cmp_eq_u32 vcc, 4, v14
    v_mov_b32 v15, 0xffff0000
    s_nop 0
    v_cndmask_b32 v25, v25, v15, vcc
    v_cmp_eq_u32 vcc, 3, v14
    v_mov_b32 v15, 0xffff
    s_nop 0
    v_cndmask_b32 v26, 0, v15, vcc
    v_cmp_eq_u32 vcc, 2, v14
    v_mov_b32 v15, 0xffff0000
    s_nop 0
    v_cndmask_b32 v26, v26, v15, vcc
    v_cmp_eq_u32 vcc, 1, v14
    v_mov_b32 v15, 0xffff
    s_nop 0
    v_cndmask_b32 v27, 0, v15, vcc
    v_cmp_eq_u32 vcc, 0, v14
    v_mov_b32 v15, 0xffff0000
    s_nop 0
    v_cndmask_b32 v27, v27, v15, vcc
    v_cmp_eq_u32 vcc, 23, v14
    v_mov_b32 v15, 0xffff
    s_nop 0
    v_cndmask_b32 v28, 0, v15, vcc
    v_cmp_eq_u32 vcc, 22, v14
    v_mov_b32 v15, 0xffff0000
    s_nop 0
    v_cndmask_b32 v28, v28, v15, vcc
    v_cmp_eq_u32 vcc, 21, v14
    v_mov_b32 v15, 0xffff
    s_nop 0
    v_cndmask_b32 v29, 0, v15, vcc
    v_cmp_eq_u32 vcc, 20, v14
    v_mov_b32 v15, 0xffff0000
    s_nop 0
    v_cndmask_b32 v29, v29, v15, vcc
    v_cmp_eq_u32 vcc, 19, v14
    v_mov_b32 v15, 0xffff
    s_nop 0
    v_cndmask_b32 v30, 0, v15, vcc
    v_cmp_eq_u32 vcc, 18, v14
    v_mov_b32 v15, 0xffff0000
    s_nop 0
    v_cndmask_b32 v30, v30, v15, vcc
    v_cmp_eq_u32 vcc, 17, v14
    v_mov_b32 v15, 0xffff
    s_nop 0
    v_cndmask_b32 v31, 0, v15, vcc
    v_cmp_eq_u32 vcc, 16, v14
    v_mov_b32 v15, 0xffff0000
    s_nop 0
    v_cndmask_b32 v31, v31, v15, vcc
    s_waitcnt lgkmcnt(0)
    s_waitcnt vmcnt(50)
    v_mfma_f32_16x16x32_bf16 v[216:219], a[128:131], a[0:3], 0
    s_waitcnt vmcnt(49)
    v_mfma_f32_16x16x32_bf16 v[216:219], a[132:135], a[4:7], v[216:219]
    s_waitcnt vmcnt(48)
    v_mfma_f32_16x16x32_bf16 v[216:219], a[136:139], a[8:11], v[216:219]
    s_waitcnt vmcnt(47)
    v_mfma_f32_16x16x32_bf16 v[216:219], a[140:143], a[12:15], v[216:219]
    s_waitcnt vmcnt(46)
    v_mfma_f32_16x16x32_bf16 v[216:219], a[144:147], a[16:19], v[216:219]
    s_waitcnt vmcnt(45)
    v_mfma_f32_16x16x32_bf16 v[216:219], a[148:151], a[20:23], v[216:219]
    s_waitcnt vmcnt(44)
    v_mfma_f32_16x16x32_bf16 v[216:219], a[152:155], a[24:27], v[216:219]
    s_waitcnt vmcnt(43)
    v_mfma_f32_16x16x32_bf16 v[216:219], a[156:159], a[28:31], v[216:219]
    s_waitcnt vmcnt(42)
    v_mfma_f32_16x16x32_bf16 v[216:219], a[160:163], a[32:35], v[216:219]
    s_waitcnt vmcnt(41)
    v_mfma_f32_16x16x32_bf16 v[216:219], a[164:167], a[36:39], v[216:219]
    s_waitcnt vmcnt(40)
    v_mfma_f32_16x16x32_bf16 v[216:219], a[168:171], a[40:43], v[216:219]
    s_waitcnt vmcnt(39)
    v_mfma_f32_16x16x32_bf16 v[216:219], a[172:175], a[44:47], v[216:219]
    s_waitcnt vmcnt(38)
    v_mfma_f32_16x16x32_bf16 v[216:219], a[176:179], a[48:51], v[216:219]
    s_waitcnt vmcnt(37)
    v_mfma_f32_16x16x32_bf16 v[216:219], a[180:183], a[52:55], v[216:219]
    s_waitcnt vmcnt(36)
    v_mfma_f32_16x16x32_bf16 v[216:219], a[184:187], a[56:59], v[216:219]
    s_waitcnt vmcnt(35)
    v_mfma_f32_16x16x32_bf16 v[216:219], a[188:191], a[60:63], v[216:219]
    s_waitcnt vmcnt(34)
    v_mfma_f32_16x16x32_bf16 v[216:219], a[192:195], a[64:67], v[216:219]
    s_waitcnt vmcnt(33)
    v_mfma_f32_16x16x32_bf16 v[216:219], a[196:199], a[68:71], v[216:219]
    s_waitcnt vmcnt(32)
    v_mfma_f32_16x16x32_bf16 v[216:219], a[200:203], a[72:75], v[216:219]
    s_waitcnt vmcnt(31)
    v_mfma_f32_16x16x32_bf16 v[216:219], a[204:207], a[76:79], v[216:219]
    s_waitcnt vmcnt(30)
    v_mfma_f32_16x16x32_bf16 v[216:219], a[208:211], a[80:83], v[216:219]
    s_waitcnt vmcnt(29)
    v_mfma_f32_16x16x32_bf16 v[216:219], a[212:215], a[84:87], v[216:219]
    s_waitcnt vmcnt(28)
    v_mfma_f32_16x16x32_bf16 v[216:219], a[216:219], a[88:91], v[216:219]
    s_waitcnt vmcnt(27)
    v_mfma_f32_16x16x32_bf16 v[216:219], a[220:223], a[92:95], v[216:219]
    s_waitcnt vmcnt(26)
    v_mfma_f32_16x16x32_bf16 v[216:219], a[224:227], a[96:99], v[216:219]
    s_waitcnt vmcnt(25)
    v_mfma_f32_16x16x32_bf16 v[216:219], a[228:231], a[100:103], v[216:219]
    s_waitcnt vmcnt(24)
    v_mfma_f32_16x16x32_bf16 v[216:219], a[232:235], a[104:107], v[216:219]
    s_waitcnt vmcnt(23)
    v_mfma_f32_16x16x32_bf16 v[216:219], a[236:239], a[108:111], v[216:219]
    s_waitcnt vmcnt(22)
    v_mfma_f32_16x16x32_bf16 v[216:219], a[240:243], a[112:115], v[216:219]
    s_waitcnt vmcnt(21)
    v_mfma_f32_16x16x32_bf16 v[216:219], a[244:247], a[116:119], v[216:219]
    s_waitcnt vmcnt(20)
    v_mfma_f32_16x16x32_bf16 v[216:219], a[248:251], a[120:123], v[216:219]
    s_waitcnt vmcnt(19)
    v_mfma_f32_16x16x32_bf16 v[216:219], a[252:255], a[124:127], v[216:219]
    v_add_u32 v7, 2097152, v7
    v_subrev_u32 v8, 6144, v7
    buffer_load_dwordx4 v[108:111], v8, s[16:19], 0 offen
    v_subrev_u32 v8, 4096, v7
    buffer_load_dwordx4 v[112:115], v8, s[16:19], 0 offen
    v_subrev_u32 v8, 2048, v7
    buffer_load_dwordx4 v[116:119], v8, s[16:19], 0 offen
    s_mov_b32 s4, 0
    buffer_load_dwordx4 v[120:123], v7, s[16:19], s4 offen offset:0
    buffer_load_dwordx4 v[152:155], v7, s[28:31], s4 offen offset:0
    buffer_load_dwordx4 v[124:127], v7, s[16:19], s4 offen offset:2048
    buffer_load_dwordx4 v[156:159], v7, s[28:31], s4 offen offset:2048
    s_mov_b32 s4, 4096
    buffer_load_dwordx4 v[128:131], v7, s[16:19], s4 offen offset:0
    buffer_load_dwordx4 v[160:163], v7, s[28:31], s4 offen offset:0
    buffer_load_dwordx4 v[132:135], v7, s[16:19], s4 offen offset:2048
    buffer_load_dwordx4 v[164:167], v7, s[28:31], s4 offen offset:2048
    s_mov_b32 s4, 8192
    buffer_load_dwordx4 v[136:139], v7, s[16:19], s4 offen offset:0
    buffer_load_dwordx4 v[168:171], v7, s[28:31], s4 offen offset:0
    buffer_load_dwordx4 v[140:143], v7, s[16:19], s4 offen offset:2048
    buffer_load_dwordx4 v[172:175], v7, s[28:31], s4 offen offset:2048
    s_mov_b32 s4, 12288
    buffer_load_dwordx4 v[144:147], v7, s[16:19], s4 offen offset:0
    buffer_load_dwordx4 v[176:179], v7, s[28:31], s4 offen offset:0
    buffer_load_dwordx4 v[148:151], v7, s[16:19], s4 offen offset:2048
    buffer_load_dwordx4 v[180:183], v7, s[28:31], s4 offen offset:2048
    v_cvt_pk_bf16_f32 v216, v216, v216
    v_lshlrev_b32 v216, 16, v216
    v_mul_f32 v216, 0xbfb8aa3b, v216
    v_exp_f32 v216, v216
    s_lshl_b32 s4, s97, 7
    v_add_f32 v216, 1.0, v216
    v_rcp_f32 v216, v216
    s_lshl_b32 s5, s24, 5
    v_cvt_pk_bf16_f32 v216, v216, v216
    v_lshlrev_b32 v216, 16, v216
    s_add_u32 s4, s4, s5
    s_add_u32 s4, s4, 121634816
    v_lshlrev_b32 v15, 2, v1
    s_mov_b64 exec, 0xff
    buffer_store_dword v216, v15, s[8:11], s4 offen sc1
    s_mov_b64 exec, -1
    v_mov_b32 v220, 0
    v_mov_b32 v221, 0
    v_mov_b32 v222, 0
    v_mov_b32 v223, 0
    s_mul_i32 s4, s24, 7680
    v_add_u32 v15, s4, v2
    ds_write_b128 v15, v[220:223] offset:0
    ds_write_b128 v15, v[220:223] offset:1024
    ds_write_b128 v15, v[220:223] offset:1536
    v_add_u32 v15, 30720, v15
    ds_write_b128 v15, v[220:223] offset:0
    ds_write_b128 v15, v[220:223] offset:1024
    ds_write_b128 v15, v[220:223] offset:1536
    v_add_u32 v15, 30720, v15
    ds_write_b128 v15, v[220:223] offset:0
    ds_write_b128 v15, v[220:223] offset:1024
    ds_write_b128 v15, v[220:223] offset:1536
    v_add_u32 v15, 30720, v15
    ds_write_b128 v15, v[220:223] offset:0
    ds_write_b128 v15, v[220:223] offset:1024
    ds_write_b128 v15, v[220:223] offset:1536
    v_add_u32 v15, 30720, v15
    s_mov_b64 exec, 0xf
    ds_write_b128 v9, v[220:223]
    ds_write_b128 v9, v[220:223] offset:4160
    s_mov_b64 exec, -1
    s_mul_i32 s4, s24, 640
    s_add_u32 s4, s4, 2560
    v_bfe_u32 v254, v1, 0, 1
    v_mul_u32_u24 v12, 61440, v254
    v_bfe_u32 v254, v1, 3, 3
    v_mul_u32_u24 v254, 80, v254
    v_add_u32 v12, v12, v254
    v_bfe_u32 v254, v1, 1, 2
    v_mul_u32_u24 v254, 16, v254
    v_add_u32 v12, v12, v254
    v_add_u32 v12, s4, v12
    s_lshl_b32 s4, s97, 7
    v_bfe_u32 v254, v1, 0, 1
    v_mul_u32_u24 v13, 64, v254
    v_add_u32 v13, s4, v13
    buffer_load_dwordx4 v[216:219], v13, s[32:35], 0 offen offset:0
    buffer_load_dwordx4 v[220:223], v13, s[32:35], 0 offen offset:16
    buffer_load_dwordx4 v[224:227], v13, s[32:35], 0 offen offset:32
    buffer_load_dwordx4 v[228:231], v13, s[32:35], 0 offen offset:48
    v_or_b32 v239, 32, v1
    v_lshlrev_b32 v239, 2, v239
    buffer_load_dword v238, v239, s[20:23], 0 offen sc1
    s_waitcnt vmcnt(0)
    s_cmp_lg_u32 s27, 0
    s_cbranch_scc1 .vd_300
    s_mov_b32 s62, 0
.vp_299:
    v_readlane_b32 s4, v238, 49
    s_and_b32 s5, s4, 0xffff
    s_cmp_ge_u32 s5, 256
    s_cbranch_scc1 .va_301
    s_add_u32 s62, s62, 1
    s_cmp_gt_u32 s62, 0x100000
    s_cbranch_scc1 .mg_end_1
    s_sleep 16
    buffer_load_dword v238, v239, s[20:23], 0 offen sc1
    s_waitcnt vmcnt(0)
    s_branch .vp_299
.va_301:
    s_lshr_b32 s4, s4, 16
    s_cbranch_scc0 .vd_300
    s_lshr_b32 s25, s2, 5
    s_and_b32 s26, s2, 31
    s_mov_b32 s27, 1
    s_waitcnt vmcnt(0) lgkmcnt(0)
    s_barrier
    s_branch .mg_role_3
.vd_300:
    v_lshlrev_b32 v184, 16, v216
    v_lshlrev_b32 v185, 16, v218
    v_and_b32 v186, 0xffff0000, v216
    v_and_b32 v187, 0xffff0000, v218
    v_lshlrev_b32 v188, 16, v217
    v_lshlrev_b32 v189, 16, v219
    v_and_b32 v190, 0xffff0000, v217
    v_and_b32 v191, 0xffff0000, v219
    v_lshlrev_b32 v192, 16, v220
    v_lshlrev_b32 v193, 16, v222
    v_and_b32 v194, 0xffff0000, v220
    v_and_b32 v195, 0xffff0000, v222
    v_lshlrev_b32 v196, 16, v221
    v_lshlrev_b32 v197, 16, v223
    v_and_b32 v198, 0xffff0000, v221
    v_and_b32 v199, 0xffff0000, v223
    v_lshlrev_b32 v200, 16, v224
    v_lshlrev_b32 v201, 16, v226
    v_and_b32 v202, 0xffff0000, v224
    v_and_b32 v203, 0xffff0000, v226
    v_lshlrev_b32 v204, 16, v225
    v_lshlrev_b32 v205, 16, v227
    v_and_b32 v206, 0xffff0000, v225
    v_and_b32 v207, 0xffff0000, v227
    v_lshlrev_b32 v208, 16, v228
    v_lshlrev_b32 v209, 16, v230
    v_and_b32 v210, 0xffff0000, v228
    v_and_b32 v211, 0xffff0000, v230
    v_lshlrev_b32 v212, 16, v229
    v_lshlrev_b32 v213, 16, v231
    v_and_b32 v214, 0xffff0000, v229
    v_and_b32 v215, 0xffff0000, v231
    v_lshlrev_b32 v216, 16, v32
    v_and_b32 v217, 0xffff0000, v32
    v_lshlrev_b32 v218, 16, v36
    v_and_b32 v219, 0xffff0000, v36
    v_lshlrev_b32 v220, 16, v40
    v_and_b32 v221, 0xffff0000, v40
    v_lshlrev_b32 v222, 16, v44
    v_and_b32 v223, 0xffff0000, v44
    v_lshlrev_b32 v224, 16, v48
    v_and_b32 v225, 0xffff0000, v48
    v_lshlrev_b32 v226, 16, v52
    v_and_b32 v227, 0xffff0000, v52
    v_lshlrev_b32 v228, 16, v56
    v_and_b32 v229, 0xffff0000, v56
    v_lshlrev_b32 v230, 16, v60
    v_and_b32 v231, 0xffff0000, v60
    v_lshlrev_b32 v232, 16, v64
    v_and_b32 v233, 0xffff0000, v64
    v_lshlrev_b32 v234, 16, v68
    v_and_b32 v235, 0xffff0000, v68
    v_lshlrev_b32 v236, 16, v72
    v_and_b32 v237, 0xffff0000, v72
    v_pk_mul_f32 v[216:217], v[216:217], v[190:191]
    v_lshlrev_b32 v238, 16, v76
    v_pk_fma_f32 v[216:217], v[218:219], v[188:189], v[216:217]
    v_and_b32 v239, 0xffff0000, v76
    v_pk_fma_f32 v[216:217], v[220:221], v[186:187], v[216:217]
    v_pk_fma_f32 v[216:217], v[222:223], v[184:185], v[216:217]
    v_pk_mul_f32 v[216:217], v[216:217], v[238:239]
    v_pk_mul_f32 v[218:219], v[218:219], v[190:191]
    v_lshlrev_b32 v240, 16, v80
    v_pk_fma_f32 v[218:219], v[220:221], v[188:189], v[218:219]
    v_and_b32 v241, 0xffff0000, v80
    v_pk_fma_f32 v[218:219], v[222:223], v[186:187], v[218:219]
    v_pk_fma_f32 v[218:219], v[224:225], v[184:185], v[218:219]
    v_pk_mul_f32 v[218:219], v[218:219], v[240:241]
    v_pk_mul_f32 v[220:221], v[220:221], v[190:191]
    v_lshlrev_b32 v238, 16, v84
    v_pk_fma_f32 v[220:221], v[222:223], v[188:189], v[220:221]
    v_and_b32 v239, 0xffff0000, v84
    v_pk_fma_f32 v[220:221], v[224:225], v[186:187], v[220:221]
    v_pk_fma_f32 v[220:221], v[226:227], v[184:185], v[220:221]
    v_pk_mul_f32 v[220:221], v[220:221], v[238:239]
    v_pk_mul_f32 v[222:223], v[222:223], v[190:191]
    v_lshlrev_b32 v240, 16, v88
    v_pk_fma_f32 v[222:223], v[224:225], v[188:189], v[222:223]
    v_and_b32 v241, 0xffff0000, v88
    v_pk_fma_f32 v[222:223], v[226:227], v[186:187], v[222:223]
    v_pk_fma_f32 v[222:223], v[228:229], v[184:185], v[222:223]
    v_pk_mul_f32 v[222:223], v[222:223], v[240:241]
    v_pk_mul_f32 v[224:225], v[224:225], v[190:191]
    v_lshlrev_b32 v238, 16, v92
    v_pk_fma_f32 v[224:225], v[226:227], v[188:189], v[224:225]
    v_and_b32 v239, 0xffff0000, v92
    v_pk_fma_f32 v[224:225], v[228:229], v[186:187], v[224:225]
    v_pk_fma_f32 v[224:225], v[230:231], v[184:185], v[224:225]
    v_pk_mul_f32 v[224:225], v[224:225], v[238:239]
    v_pk_mul_f32 v[226:227], v[226:227], v[190:191]
    v_lshlrev_b32 v240, 16, v96
    v_pk_fma_f32 v[226:227], v[228:229], v[188:189], v[226:227]
    v_and_b32 v241, 0xffff0000, v96
    v_pk_fma_f32 v[226:227], v[230:231], v[186:187], v[226:227]
    v_pk_fma_f32 v[226:227], v[232:233], v[184:185], v[226:227]
    v_pk_mul_f32 v[226:227], v[226:227], v[240:241]
    v_pk_mul_f32 v[228:229], v[228:229], v[190:191]
    v_lshlrev_b32 v238, 16, v100
    v_pk_fma_f32 v[228:229], v[230:231], v[188:189], v[228:229]
    v_and_b32 v239, 0xffff0000, v100
    v_pk_fma_f32 v[228:229], v[232:233], v[186:187], v[228:229]
    v_pk_fma_f32 v[228:229], v[234:235], v[184:185], v[228:229]
    v_pk_mul_f32 v[228:229], v[228:229], v[238:239]
    v_pk_mul_f32 v[230:231], v[230:231], v[190:191]
    v_lshlrev_b32 v240, 16, v104
    v_pk_fma_f32 v[230:231], v[232:233], v[188:189], v[230:231]
    v_and_b32 v241, 0xffff0000, v104
    v_pk_fma_f32 v[230:231], v[234:235], v[186:187], v[230:231]
    v_pk_fma_f32 v[230:231], v[236:237], v[184:185], v[230:231]
    v_pk_mul_f32 v[230:231], v[230:231], v[240:241]
    v_cvt_pk_bf16_f32 v242, v230, v228
    v_cvt_pk_bf16_f32 v243, v226, v224
    v_cvt_pk_bf16_f32 v244, v222, v220
    v_cvt_pk_bf16_f32 v245, v218, v216
    ds_write_b128 v12, v[242:245] offset:0
    v_cvt_pk_bf16_f32 v246, v231, v229
    v_cvt_pk_bf16_f32 v247, v227, v225
    v_cvt_pk_bf16_f32 v248, v223, v221
    v_cvt_pk_bf16_f32 v249, v219, v217
    ds_write_b128 v12, v[246:249] offset:7680
    v_lshlrev_b32 v216, 16, v33
    v_and_b32 v217, 0xffff0000, v33
    v_lshlrev_b32 v218, 16, v37
    v_and_b32 v219, 0xffff0000, v37
    v_lshlrev_b32 v220, 16, v41
    v_and_b32 v221, 0xffff0000, v41
    v_lshlrev_b32 v222, 16, v45
    v_and_b32 v223, 0xffff0000, v45
    v_lshlrev_b32 v224, 16, v49
    v_and_b32 v225, 0xffff0000, v49
    v_lshlrev_b32 v226, 16, v53
    v_and_b32 v227, 0xffff0000, v53
    v_lshlrev_b32 v228, 16, v57
    v_and_b32 v229, 0xffff0000, v57
    v_lshlrev_b32 v230, 16, v61
    v_and_b32 v231, 0xffff0000, v61
    v_lshlrev_b32 v232, 16, v65
    v_and_b32 v233, 0xffff0000, v65
    v_lshlrev_b32 v234, 16, v69
    v_and_b32 v235, 0xffff0000, v69
    v_lshlrev_b32 v236, 16, v73
    v_and_b32 v237, 0xffff0000, v73
    v_pk_mul_f32 v[216:217], v[216:217], v[198:199]
    v_lshlrev_b32 v238, 16, v77
    v_pk_fma_f32 v[216:217], v[218:219], v[196:197], v[216:217]
    v_and_b32 v239, 0xffff0000, v77
    v_pk_fma_f32 v[216:217], v[220:221], v[194:195], v[216:217]
    v_pk_fma_f32 v[216:217], v[222:223], v[192:193], v[216:217]
    v_pk_mul_f32 v[216:217], v[216:217], v[238:239]
    v_pk_mul_f32 v[218:219], v[218:219], v[198:199]
    v_lshlrev_b32 v240, 16, v81
    v_pk_fma_f32 v[218:219], v[220:221], v[196:197], v[218:219]
    v_and_b32 v241, 0xffff0000, v81
    v_pk_fma_f32 v[218:219], v[222:223], v[194:195], v[218:219]
    v_pk_fma_f32 v[218:219], v[224:225], v[192:193], v[218:219]
    v_pk_mul_f32 v[218:219], v[218:219], v[240:241]
    v_pk_mul_f32 v[220:221], v[220:221], v[198:199]
    v_lshlrev_b32 v238, 16, v85
    v_pk_fma_f32 v[220:221], v[222:223], v[196:197], v[220:221]
    v_and_b32 v239, 0xffff0000, v85
    v_pk_fma_f32 v[220:221], v[224:225], v[194:195], v[220:221]
    v_pk_fma_f32 v[220:221], v[226:227], v[192:193], v[220:221]
    v_pk_mul_f32 v[220:221], v[220:221], v[238:239]
    v_pk_mul_f32 v[222:223], v[222:223], v[198:199]
    v_lshlrev_b32 v240, 16, v89
    v_pk_fma_f32 v[222:223], v[224:225], v[196:197], v[222:223]
    v_and_b32 v241, 0xffff0000, v89
    v_pk_fma_f32 v[222:223], v[226:227], v[194:195], v[222:223]
    v_pk_fma_f32 v[222:223], v[228:229], v[192:193], v[222:223]
    v_pk_mul_f32 v[222:223], v[222:223], v[240:241]
    v_pk_mul_f32 v[224:225], v[224:225], v[198:199]
    v_lshlrev_b32 v238, 16, v93
    v_pk_fma_f32 v[224:225], v[226:227], v[196:197], v[224:225]
    v_and_b32 v239, 0xffff0000, v93
    v_pk_fma_f32 v[224:225], v[228:229], v[194:195], v[224:225]
    v_pk_fma_f32 v[224:225], v[230:231], v[192:193], v[224:225]
    v_pk_mul_f32 v[224:225], v[224:225], v[238:239]
    v_pk_mul_f32 v[226:227], v[226:227], v[198:199]
    v_lshlrev_b32 v240, 16, v97
    v_pk_fma_f32 v[226:227], v[228:229], v[196:197], v[226:227]
    v_and_b32 v241, 0xffff0000, v97
    v_pk_fma_f32 v[226:227], v[230:231], v[194:195], v[226:227]
    v_pk_fma_f32 v[226:227], v[232:233], v[192:193], v[226:227]
    v_pk_mul_f32 v[226:227], v[226:227], v[240:241]
    v_pk_mul_f32 v[228:229], v[228:229], v[198:199]
    v_lshlrev_b32 v238, 16, v101
    v_pk_fma_f32 v[228:229], v[230:231], v[196:197], v[228:229]
    v_and_b32 v239, 0xffff0000, v101
    v_pk_fma_f32 v[228:229], v[232:233], v[194:195], v[228:229]
    v_pk_fma_f32 v[228:229], v[234:235], v[192:193], v[228:229]
    v_pk_mul_f32 v[228:229], v[228:229], v[238:239]
    v_pk_mul_f32 v[230:231], v[230:231], v[198:199]
    v_lshlrev_b32 v240, 16, v105
    v_pk_fma_f32 v[230:231], v[232:233], v[196:197], v[230:231]
    v_and_b32 v241, 0xffff0000, v105
    v_pk_fma_f32 v[230:231], v[234:235], v[194:195], v[230:231]
    v_pk_fma_f32 v[230:231], v[236:237], v[192:193], v[230:231]
    v_pk_mul_f32 v[230:231], v[230:231], v[240:241]
    v_cvt_pk_bf16_f32 v242, v230, v228
    v_cvt_pk_bf16_f32 v243, v226, v224
    v_cvt_pk_bf16_f32 v244, v222, v220
    v_cvt_pk_bf16_f32 v245, v218, v216
    ds_write_b128 v12, v[242:245] offset:15360
    v_cvt_pk_bf16_f32 v246, v231, v229
    v_cvt_pk_bf16_f32 v247, v227, v225
    v_cvt_pk_bf16_f32 v248, v223, v221
    v_cvt_pk_bf16_f32 v249, v219, v217
    ds_write_b128 v12, v[246:249] offset:23040
    v_lshlrev_b32 v216, 16, v34
    v_and_b32 v217, 0xffff0000, v34
    v_lshlrev_b32 v218, 16, v38
    v_and_b32 v219, 0xffff0000, v38
    v_lshlrev_b32 v220, 16, v42
    v_and_b32 v221, 0xffff0000, v42
    v_lshlrev_b32 v222, 16, v46
    v_and_b32 v223, 0xffff0000, v46
    v_lshlrev_b32 v224, 16, v50
    v_and_b32 v225, 0xffff0000, v50
    v_lshlrev_b32 v226, 16, v54
    v_and_b32 v227, 0xffff0000, v54
    v_lshlrev_b32 v228, 16, v58
    v_and_b32 v229, 0xffff0000, v58
    v_lshlrev_b32 v230, 16, v62
    v_and_b32 v231, 0xffff0000, v62
    v_lshlrev_b32 v232, 16, v66
    v_and_b32 v233, 0xffff0000, v66
    v_lshlrev_b32 v234, 16, v70
    v_and_b32 v235, 0xffff0000, v70
    v_lshlrev_b32 v236, 16, v74
    v_and_b32 v237, 0xffff0000, v74
    v_pk_mul_f32 v[216:217], v[216:217], v[206:207]
    v_lshlrev_b32 v238, 16, v78
    v_pk_fma_f32 v[216:217], v[218:219], v[204:205], v[216:217]
    v_and_b32 v239, 0xffff0000, v78
    v_pk_fma_f32 v[216:217], v[220:221], v[202:203], v[216:217]
    v_pk_fma_f32 v[216:217], v[222:223], v[200:201], v[216:217]
    v_pk_mul_f32 v[216:217], v[216:217], v[238:239]
    v_pk_mul_f32 v[218:219], v[218:219], v[206:207]
    v_lshlrev_b32 v240, 16, v82
    v_pk_fma_f32 v[218:219], v[220:221], v[204:205], v[218:219]
    v_and_b32 v241, 0xffff0000, v82
    v_pk_fma_f32 v[218:219], v[222:223], v[202:203], v[218:219]
    v_pk_fma_f32 v[218:219], v[224:225], v[200:201], v[218:219]
    v_pk_mul_f32 v[218:219], v[218:219], v[240:241]
    v_pk_mul_f32 v[220:221], v[220:221], v[206:207]
    v_lshlrev_b32 v238, 16, v86
    v_pk_fma_f32 v[220:221], v[222:223], v[204:205], v[220:221]
    v_and_b32 v239, 0xffff0000, v86
    v_pk_fma_f32 v[220:221], v[224:225], v[202:203], v[220:221]
    v_pk_fma_f32 v[220:221], v[226:227], v[200:201], v[220:221]
    v_pk_mul_f32 v[220:221], v[220:221], v[238:239]
    v_pk_mul_f32 v[222:223], v[222:223], v[206:207]
    v_lshlrev_b32 v240, 16, v90
    v_pk_fma_f32 v[222:223], v[224:225], v[204:205], v[222:223]
    v_and_b32 v241, 0xffff0000, v90
    v_pk_fma_f32 v[222:223], v[226:227], v[202:203], v[222:223]
    v_pk_fma_f32 v[222:223], v[228:229], v[200:201], v[222:223]
    v_pk_mul_f32 v[222:223], v[222:223], v[240:241]
    v_pk_mul_f32 v[224:225], v[224:225], v[206:207]
    v_lshlrev_b32 v238, 16, v94
    v_pk_fma_f32 v[224:225], v[226:227], v[204:205], v[224:225]
    v_and_b32 v239, 0xffff0000, v94
    v_pk_fma_f32 v[224:225], v[228:229], v[202:203], v[224:225]
    v_pk_fma_f32 v[224:225], v[230:231], v[200:201], v[224:225]
    v_pk_mul_f32 v[224:225], v[224:225], v[238:239]
    v_pk_mul_f32 v[226:227], v[226:227], v[206:207]
    v_lshlrev_b32 v240, 16, v98
    v_pk_fma_f32 v[226:227], v[228:229], v[204:205], v[226:227]
    v_and_b32 v241, 0xffff0000, v98
    v_pk_fma_f32 v[226:227], v[230:231], v[202:203], v[226:227]
    v_pk_fma_f32 v[226:227], v[232:233], v[200:201], v[226:227]
    v_pk_mul_f32 v[226:227], v[226:227], v[240:241]
    v_pk_mul_f32 v[228:229], v[228:229], v[206:207]
    v_lshlrev_b32 v238, 16, v102
    v_pk_fma_f32 v[228:229], v[230:231], v[204:205], v[228:229]
    v_and_b32 v239, 0xffff0000, v102
    v_pk_fma_f32 v[228:229], v[232:233], v[202:203], v[228:229]
    v_pk_fma_f32 v[228:229], v[234:235], v[200:201], v[228:229]
    v_pk_mul_f32 v[228:229], v[228:229], v[238:239]
    v_pk_mul_f32 v[230:231], v[230:231], v[206:207]
    v_lshlrev_b32 v240, 16, v106
    v_pk_fma_f32 v[230:231], v[232:233], v[204:205], v[230:231]
    v_and_b32 v241, 0xffff0000, v106
    v_pk_fma_f32 v[230:231], v[234:235], v[202:203], v[230:231]
    v_pk_fma_f32 v[230:231], v[236:237], v[200:201], v[230:231]
    v_pk_mul_f32 v[230:231], v[230:231], v[240:241]
    v_cvt_pk_bf16_f32 v242, v230, v228
    v_cvt_pk_bf16_f32 v243, v226, v224
    v_cvt_pk_bf16_f32 v244, v222, v220
    v_cvt_pk_bf16_f32 v245, v218, v216
    ds_write_b128 v12, v[242:245] offset:30720
    v_cvt_pk_bf16_f32 v246, v231, v229
    v_cvt_pk_bf16_f32 v247, v227, v225
    v_cvt_pk_bf16_f32 v248, v223, v221
    v_cvt_pk_bf16_f32 v249, v219, v217
    ds_write_b128 v12, v[246:249] offset:38400
    v_lshlrev_b32 v216, 16, v35
    v_and_b32 v217, 0xffff0000, v35
    v_lshlrev_b32 v218, 16, v39
    v_and_b32 v219, 0xffff0000, v39
    v_lshlrev_b32 v220, 16, v43
    v_and_b32 v221, 0xffff0000, v43
    v_lshlrev_b32 v222, 16, v47
    v_and_b32 v223, 0xffff0000, v47
    v_lshlrev_b32 v224, 16, v51
    v_and_b32 v225, 0xffff0000, v51
    v_lshlrev_b32 v226, 16, v55
    v_and_b32 v227, 0xffff0000, v55
    v_lshlrev_b32 v228, 16, v59
    v_and_b32 v229, 0xffff0000, v59
    v_lshlrev_b32 v230, 16, v63
    v_and_b32 v231, 0xffff0000, v63
    v_lshlrev_b32 v232, 16, v67
    v_and_b32 v233, 0xffff0000, v67
    v_lshlrev_b32 v234, 16, v71
    v_and_b32 v235, 0xffff0000, v71
    v_lshlrev_b32 v236, 16, v75
    v_and_b32 v237, 0xffff0000, v75
    v_pk_mul_f32 v[216:217], v[216:217], v[214:215]
    v_lshlrev_b32 v238, 16, v79
    v_pk_fma_f32 v[216:217], v[218:219], v[212:213], v[216:217]
    v_and_b32 v239, 0xffff0000, v79
    v_pk_fma_f32 v[216:217], v[220:221], v[210:211], v[216:217]
    v_pk_fma_f32 v[216:217], v[222:223], v[208:209], v[216:217]
    v_pk_mul_f32 v[216:217], v[216:217], v[238:239]
    v_pk_mul_f32 v[218:219], v[218:219], v[214:215]
    v_lshlrev_b32 v240, 16, v83
    v_pk_fma_f32 v[218:219], v[220:221], v[212:213], v[218:219]
    v_and_b32 v241, 0xffff0000, v83
    v_pk_fma_f32 v[218:219], v[222:223], v[210:211], v[218:219]
    v_pk_fma_f32 v[218:219], v[224:225], v[208:209], v[218:219]
    v_pk_mul_f32 v[218:219], v[218:219], v[240:241]
    v_pk_mul_f32 v[220:221], v[220:221], v[214:215]
    v_lshlrev_b32 v238, 16, v87
    v_pk_fma_f32 v[220:221], v[222:223], v[212:213], v[220:221]
    v_and_b32 v239, 0xffff0000, v87
    v_pk_fma_f32 v[220:221], v[224:225], v[210:211], v[220:221]
    v_pk_fma_f32 v[220:221], v[226:227], v[208:209], v[220:221]
    v_pk_mul_f32 v[220:221], v[220:221], v[238:239]
    v_pk_mul_f32 v[222:223], v[222:223], v[214:215]
    v_lshlrev_b32 v240, 16, v91
    v_pk_fma_f32 v[222:223], v[224:225], v[212:213], v[222:223]
    v_and_b32 v241, 0xffff0000, v91
    v_pk_fma_f32 v[222:223], v[226:227], v[210:211], v[222:223]
    v_pk_fma_f32 v[222:223], v[228:229], v[208:209], v[222:223]
    v_pk_mul_f32 v[222:223], v[222:223], v[240:241]
    v_pk_mul_f32 v[224:225], v[224:225], v[214:215]
    v_lshlrev_b32 v238, 16, v95
    v_pk_fma_f32 v[224:225], v[226:227], v[212:213], v[224:225]
    v_and_b32 v239, 0xffff0000, v95
    v_pk_fma_f32 v[224:225], v[228:229], v[210:211], v[224:225]
    v_pk_fma_f32 v[224:225], v[230:231], v[208:209], v[224:225]
    v_pk_mul_f32 v[224:225], v[224:225], v[238:239]
    v_pk_mul_f32 v[226:227], v[226:227], v[214:215]
    v_lshlrev_b32 v240, 16, v99
    v_pk_fma_f32 v[226:227], v[228:229], v[212:213], v[226:227]
    v_and_b32 v241, 0xffff0000, v99
    v_pk_fma_f32 v[226:227], v[230:231], v[210:211], v[226:227]
    v_pk_fma_f32 v[226:227], v[232:233], v[208:209], v[226:227]
    v_pk_mul_f32 v[226:227], v[226:227], v[240:241]
    v_pk_mul_f32 v[228:229], v[228:229], v[214:215]
    v_lshlrev_b32 v238, 16, v103
    v_pk_fma_f32 v[228:229], v[230:231], v[212:213], v[228:229]
    v_and_b32 v239, 0xffff0000, v103
    v_pk_fma_f32 v[228:229], v[232:233], v[210:211], v[228:229]
    v_pk_fma_f32 v[228:229], v[234:235], v[208:209], v[228:229]
    v_pk_mul_f32 v[228:229], v[228:229], v[238:239]
    v_pk_mul_f32 v[230:231], v[230:231], v[214:215]
    v_lshlrev_b32 v240, 16, v107
    v_pk_fma_f32 v[230:231], v[232:233], v[212:213], v[230:231]
    v_and_b32 v241, 0xffff0000, v107
    v_pk_fma_f32 v[230:231], v[234:235], v[210:211], v[230:231]
    v_pk_fma_f32 v[230:231], v[236:237], v[208:209], v[230:231]
    v_pk_mul_f32 v[230:231], v[230:231], v[240:241]
    v_cvt_pk_bf16_f32 v242, v230, v228
    v_cvt_pk_bf16_f32 v243, v226, v224
    v_cvt_pk_bf16_f32 v244, v222, v220
    v_cvt_pk_bf16_f32 v245, v218, v216
    ds_write_b128 v12, v[242:245] offset:46080
    v_cvt_pk_bf16_f32 v246, v231, v229
    v_cvt_pk_bf16_f32 v247, v227, v225
    v_cvt_pk_bf16_f32 v248, v223, v221
    v_cvt_pk_bf16_f32 v249, v219, v217
    ds_write_b128 v12, v[246:249] offset:53760
    v_lshlrev_b32 v216, 16, v108
    v_and_b32 v217, 0xffff0000, v108
    v_lshlrev_b32 v218, 16, v112
    v_and_b32 v219, 0xffff0000, v112
    v_lshlrev_b32 v220, 16, v116
    v_and_b32 v221, 0xffff0000, v116
    v_lshlrev_b32 v222, 16, v120
    v_and_b32 v223, 0xffff0000, v120
    v_lshlrev_b32 v224, 16, v124
    v_and_b32 v225, 0xffff0000, v124
    v_lshlrev_b32 v226, 16, v128
    v_and_b32 v227, 0xffff0000, v128
    v_lshlrev_b32 v228, 16, v132
    v_and_b32 v229, 0xffff0000, v132
    v_lshlrev_b32 v230, 16, v136
    v_and_b32 v231, 0xffff0000, v136
    v_lshlrev_b32 v232, 16, v140
    v_and_b32 v233, 0xffff0000, v140
    v_lshlrev_b32 v234, 16, v144
    v_and_b32 v235, 0xffff0000, v144
    v_lshlrev_b32 v236, 16, v148
    v_and_b32 v237, 0xffff0000, v148
    v_pk_mul_f32 v[216:217], v[216:217], v[190:191]
    v_lshlrev_b32 v238, 16, v152
    v_pk_fma_f32 v[216:217], v[218:219], v[188:189], v[216:217]
    v_and_b32 v239, 0xffff0000, v152
    v_pk_fma_f32 v[216:217], v[220:221], v[186:187], v[216:217]
    v_pk_fma_f32 v[216:217], v[222:223], v[184:185], v[216:217]
    v_pk_mul_f32 v[216:217], v[216:217], v[238:239]
    v_pk_mul_f32 v[218:219], v[218:219], v[190:191]
    v_lshlrev_b32 v240, 16, v156
    v_pk_fma_f32 v[218:219], v[220:221], v[188:189], v[218:219]
    v_and_b32 v241, 0xffff0000, v156
    v_pk_fma_f32 v[218:219], v[222:223], v[186:187], v[218:219]
    v_pk_fma_f32 v[218:219], v[224:225], v[184:185], v[218:219]
    v_pk_mul_f32 v[218:219], v[218:219], v[240:241]
    v_pk_mul_f32 v[220:221], v[220:221], v[190:191]
    v_lshlrev_b32 v238, 16, v160
    v_pk_fma_f32 v[220:221], v[222:223], v[188:189], v[220:221]
    v_and_b32 v239, 0xffff0000, v160
    v_pk_fma_f32 v[220:221], v[224:225], v[186:187], v[220:221]
    v_pk_fma_f32 v[220:221], v[226:227], v[184:185], v[220:221]
    v_pk_mul_f32 v[220:221], v[220:221], v[238:239]
    v_pk_mul_f32 v[222:223], v[222:223], v[190:191]
    v_lshlrev_b32 v240, 16, v164
    v_pk_fma_f32 v[222:223], v[224:225], v[188:189], v[222:223]
    v_and_b32 v241, 0xffff0000, v164
    v_pk_fma_f32 v[222:223], v[226:227], v[186:187], v[222:223]
    v_pk_fma_f32 v[222:223], v[228:229], v[184:185], v[222:223]
    v_pk_mul_f32 v[222:223], v[222:223], v[240:241]
    v_pk_mul_f32 v[224:225], v[224:225], v[190:191]
    v_lshlrev_b32 v238, 16, v168
    v_pk_fma_f32 v[224:225], v[226:227], v[188:189], v[224:225]
    v_and_b32 v239, 0xffff0000, v168
    v_pk_fma_f32 v[224:225], v[228:229], v[186:187], v[224:225]
    v_pk_fma_f32 v[224:225], v[230:231], v[184:185], v[224:225]
    v_pk_mul_f32 v[224:225], v[224:225], v[238:239]
    v_pk_mul_f32 v[226:227], v[226:227], v[190:191]
    v_lshlrev_b32 v240, 16, v172
    v_pk_fma_f32 v[226:227], v[228:229], v[188:189], v[226:227]
    v_and_b32 v241, 0xffff0000, v172
    v_pk_fma_f32 v[226:227], v[230:231], v[186:187], v[226:227]
    v_pk_fma_f32 v[226:227], v[232:233], v[184:185], v[226:227]
    v_pk_mul_f32 v[226:227], v[226:227], v[240:241]
    v_pk_mul_f32 v[228:229], v[228:229], v[190:191]
    v_lshlrev_b32 v238, 16, v176
    v_pk_fma_f32 v[228:229], v[230:231], v[188:189], v[228:229]
    v_and_b32 v239, 0xffff0000, v176
    v_pk_fma_f32 v[228:229], v[232:233], v[186:187], v[228:229]
    v_pk_fma_f32 v[228:229], v[234:235], v[184:185], v[228:229]
    v_pk_mul_f32 v[228:229], v[228:229], v[238:239]
    v_pk_mul_f32 v[230:231], v[230:231], v[190:191]
    v_lshlrev_b32 v240, 16, v180
    v_pk_fma_f32 v[230:231], v[232:233], v[188:189], v[230:231]
    v_and_b32 v241, 0xffff0000, v180
    v_pk_fma_f32 v[230:231], v[234:235], v[186:187], v[230:231]
    v_pk_fma_f32 v[230:231], v[236:237], v[184:185], v[230:231]
    v_pk_mul_f32 v[230:231], v[230:231], v[240:241]
    v_cvt_pk_bf16_f32 v242, v230, v228
    v_cvt_pk_bf16_f32 v243, v226, v224
    v_cvt_pk_bf16_f32 v244, v222, v220
    v_cvt_pk_bf16_f32 v245, v218, v216
    ds_write_b128 v12, v[242:245] offset:2560
    v_cvt_pk_bf16_f32 v246, v231, v229
    v_cvt_pk_bf16_f32 v247, v227, v225
    v_cvt_pk_bf16_f32 v248, v223, v221
    v_cvt_pk_bf16_f32 v249, v219, v217
    ds_write_b128 v12, v[246:249] offset:10240
    v_lshlrev_b32 v216, 16, v109
    v_and_b32 v217, 0xffff0000, v109
    v_lshlrev_b32 v218, 16, v113
    v_and_b32 v219, 0xffff0000, v113
    v_lshlrev_b32 v220, 16, v117
    v_and_b32 v221, 0xffff0000, v117
    v_lshlrev_b32 v222, 16, v121
    v_and_b32 v223, 0xffff0000, v121
    v_lshlrev_b32 v224, 16, v125
    v_and_b32 v225, 0xffff0000, v125
    v_lshlrev_b32 v226, 16, v129
    v_and_b32 v227, 0xffff0000, v129
    v_lshlrev_b32 v228, 16, v133
    v_and_b32 v229, 0xffff0000, v133
    v_lshlrev_b32 v230, 16, v137
    v_and_b32 v231, 0xffff0000, v137
    v_lshlrev_b32 v232, 16, v141
    v_and_b32 v233, 0xffff0000, v141
    v_lshlrev_b32 v234, 16, v145
    v_and_b32 v235, 0xffff0000, v145
    v_lshlrev_b32 v236, 16, v149
    v_and_b32 v237, 0xffff0000, v149
    v_pk_mul_f32 v[216:217], v[216:217], v[198:199]
    v_lshlrev_b32 v238, 16, v153
    v_pk_fma_f32 v[216:217], v[218:219], v[196:197], v[216:217]
    v_and_b32 v239, 0xffff0000, v153
    v_pk_fma_f32 v[216:217], v[220:221], v[194:195], v[216:217]
    v_pk_fma_f32 v[216:217], v[222:223], v[192:193], v[216:217]
    v_pk_mul_f32 v[216:217], v[216:217], v[238:239]
    v_pk_mul_f32 v[218:219], v[218:219], v[198:199]
    v_lshlrev_b32 v240, 16, v157
    v_pk_fma_f32 v[218:219], v[220:221], v[196:197], v[218:219]
    v_and_b32 v241, 0xffff0000, v157
    v_pk_fma_f32 v[218:219], v[222:223], v[194:195], v[218:219]
    v_pk_fma_f32 v[218:219], v[224:225], v[192:193], v[218:219]
    v_pk_mul_f32 v[218:219], v[218:219], v[240:241]
    v_pk_mul_f32 v[220:221], v[220:221], v[198:199]
    v_lshlrev_b32 v238, 16, v161
    v_pk_fma_f32 v[220:221], v[222:223], v[196:197], v[220:221]
    v_and_b32 v239, 0xffff0000, v161
    v_pk_fma_f32 v[220:221], v[224:225], v[194:195], v[220:221]
    v_pk_fma_f32 v[220:221], v[226:227], v[192:193], v[220:221]
    v_pk_mul_f32 v[220:221], v[220:221], v[238:239]
    v_pk_mul_f32 v[222:223], v[222:223], v[198:199]
    v_lshlrev_b32 v240, 16, v165
    v_pk_fma_f32 v[222:223], v[224:225], v[196:197], v[222:223]
    v_and_b32 v241, 0xffff0000, v165
    v_pk_fma_f32 v[222:223], v[226:227], v[194:195], v[222:223]
    v_pk_fma_f32 v[222:223], v[228:229], v[192:193], v[222:223]
    v_pk_mul_f32 v[222:223], v[222:223], v[240:241]
    v_pk_mul_f32 v[224:225], v[224:225], v[198:199]
    v_lshlrev_b32 v238, 16, v169
    v_pk_fma_f32 v[224:225], v[226:227], v[196:197], v[224:225]
    v_and_b32 v239, 0xffff0000, v169
    v_pk_fma_f32 v[224:225], v[228:229], v[194:195], v[224:225]
    v_pk_fma_f32 v[224:225], v[230:231], v[192:193], v[224:225]
    v_pk_mul_f32 v[224:225], v[224:225], v[238:239]
    v_pk_mul_f32 v[226:227], v[226:227], v[198:199]
    v_lshlrev_b32 v240, 16, v173
    v_pk_fma_f32 v[226:227], v[228:229], v[196:197], v[226:227]
    v_and_b32 v241, 0xffff0000, v173
    v_pk_fma_f32 v[226:227], v[230:231], v[194:195], v[226:227]
    v_pk_fma_f32 v[226:227], v[232:233], v[192:193], v[226:227]
    v_pk_mul_f32 v[226:227], v[226:227], v[240:241]
    v_pk_mul_f32 v[228:229], v[228:229], v[198:199]
    v_lshlrev_b32 v238, 16, v177
    v_pk_fma_f32 v[228:229], v[230:231], v[196:197], v[228:229]
    v_and_b32 v239, 0xffff0000, v177
    v_pk_fma_f32 v[228:229], v[232:233], v[194:195], v[228:229]
    v_pk_fma_f32 v[228:229], v[234:235], v[192:193], v[228:229]
    v_pk_mul_f32 v[228:229], v[228:229], v[238:239]
    v_pk_mul_f32 v[230:231], v[230:231], v[198:199]
    v_lshlrev_b32 v240, 16, v181
    v_pk_fma_f32 v[230:231], v[232:233], v[196:197], v[230:231]
    v_and_b32 v241, 0xffff0000, v181
    v_pk_fma_f32 v[230:231], v[234:235], v[194:195], v[230:231]
    v_pk_fma_f32 v[230:231], v[236:237], v[192:193], v[230:231]
    v_pk_mul_f32 v[230:231], v[230:231], v[240:241]
    v_cvt_pk_bf16_f32 v242, v230, v228
    v_cvt_pk_bf16_f32 v243, v226, v224
    v_cvt_pk_bf16_f32 v244, v222, v220
    v_cvt_pk_bf16_f32 v245, v218, v216
    ds_write_b128 v12, v[242:245] offset:17920
    v_cvt_pk_bf16_f32 v246, v231, v229
    v_cvt_pk_bf16_f32 v247, v227, v225
    v_cvt_pk_bf16_f32 v248, v223, v221
    v_cvt_pk_bf16_f32 v249, v219, v217
    ds_write_b128 v12, v[246:249] offset:25600
    v_lshlrev_b32 v216, 16, v110
    v_and_b32 v217, 0xffff0000, v110
    v_lshlrev_b32 v218, 16, v114
    v_and_b32 v219, 0xffff0000, v114
    v_lshlrev_b32 v220, 16, v118
    v_and_b32 v221, 0xffff0000, v118
    v_lshlrev_b32 v222, 16, v122
    v_and_b32 v223, 0xffff0000, v122
    v_lshlrev_b32 v224, 16, v126
    v_and_b32 v225, 0xffff0000, v126
    v_lshlrev_b32 v226, 16, v130
    v_and_b32 v227, 0xffff0000, v130
    v_lshlrev_b32 v228, 16, v134
    v_and_b32 v229, 0xffff0000, v134
    v_lshlrev_b32 v230, 16, v138
    v_and_b32 v231, 0xffff0000, v138
    v_lshlrev_b32 v232, 16, v142
    v_and_b32 v233, 0xffff0000, v142
    v_lshlrev_b32 v234, 16, v146
    v_and_b32 v235, 0xffff0000, v146
    v_lshlrev_b32 v236, 16, v150
    v_and_b32 v237, 0xffff0000, v150
    v_pk_mul_f32 v[216:217], v[216:217], v[206:207]
    v_lshlrev_b32 v238, 16, v154
    v_pk_fma_f32 v[216:217], v[218:219], v[204:205], v[216:217]
    v_and_b32 v239, 0xffff0000, v154
    v_pk_fma_f32 v[216:217], v[220:221], v[202:203], v[216:217]
    v_pk_fma_f32 v[216:217], v[222:223], v[200:201], v[216:217]
    v_pk_mul_f32 v[216:217], v[216:217], v[238:239]
    v_pk_mul_f32 v[218:219], v[218:219], v[206:207]
    v_lshlrev_b32 v240, 16, v158
    v_pk_fma_f32 v[218:219], v[220:221], v[204:205], v[218:219]
    v_and_b32 v241, 0xffff0000, v158
    v_pk_fma_f32 v[218:219], v[222:223], v[202:203], v[218:219]
    v_pk_fma_f32 v[218:219], v[224:225], v[200:201], v[218:219]
    v_pk_mul_f32 v[218:219], v[218:219], v[240:241]
    v_pk_mul_f32 v[220:221], v[220:221], v[206:207]
    v_lshlrev_b32 v238, 16, v162
    v_pk_fma_f32 v[220:221], v[222:223], v[204:205], v[220:221]
    v_and_b32 v239, 0xffff0000, v162
    v_pk_fma_f32 v[220:221], v[224:225], v[202:203], v[220:221]
    v_pk_fma_f32 v[220:221], v[226:227], v[200:201], v[220:221]
    v_pk_mul_f32 v[220:221], v[220:221], v[238:239]
    v_pk_mul_f32 v[222:223], v[222:223], v[206:207]
    v_lshlrev_b32 v240, 16, v166
    v_pk_fma_f32 v[222:223], v[224:225], v[204:205], v[222:223]
    v_and_b32 v241, 0xffff0000, v166
    v_pk_fma_f32 v[222:223], v[226:227], v[202:203], v[222:223]
    v_pk_fma_f32 v[222:223], v[228:229], v[200:201], v[222:223]
    v_pk_mul_f32 v[222:223], v[222:223], v[240:241]
    v_pk_mul_f32 v[224:225], v[224:225], v[206:207]
    v_lshlrev_b32 v238, 16, v170
    v_pk_fma_f32 v[224:225], v[226:227], v[204:205], v[224:225]
    v_and_b32 v239, 0xffff0000, v170
    v_pk_fma_f32 v[224:225], v[228:229], v[202:203], v[224:225]
    v_pk_fma_f32 v[224:225], v[230:231], v[200:201], v[224:225]
    v_pk_mul_f32 v[224:225], v[224:225], v[238:239]
    v_pk_mul_f32 v[226:227], v[226:227], v[206:207]
    v_lshlrev_b32 v240, 16, v174
    v_pk_fma_f32 v[226:227], v[228:229], v[204:205], v[226:227]
    v_and_b32 v241, 0xffff0000, v174
    v_pk_fma_f32 v[226:227], v[230:231], v[202:203], v[226:227]
    v_pk_fma_f32 v[226:227], v[232:233], v[200:201], v[226:227]
    v_pk_mul_f32 v[226:227], v[226:227], v[240:241]
    v_pk_mul_f32 v[228:229], v[228:229], v[206:207]
    v_lshlrev_b32 v238, 16, v178
    v_pk_fma_f32 v[228:229], v[230:231], v[204:205], v[228:229]
    v_and_b32 v239, 0xffff0000, v178
    v_pk_fma_f32 v[228:229], v[232:233], v[202:203], v[228:229]
    v_pk_fma_f32 v[228:229], v[234:235], v[200:201], v[228:229]
    v_pk_mul_f32 v[228:229], v[228:229], v[238:239]
    v_pk_mul_f32 v[230:231], v[230:231], v[206:207]
    v_lshlrev_b32 v240, 16, v182
    v_pk_fma_f32 v[230:231], v[232:233], v[204:205], v[230:231]
    v_and_b32 v241, 0xffff0000, v182
    v_pk_fma_f32 v[230:231], v[234:235], v[202:203], v[230:231]
    v_pk_fma_f32 v[230:231], v[236:237], v[200:201], v[230:231]
    v_pk_mul_f32 v[230:231], v[230:231], v[240:241]
    v_cvt_pk_bf16_f32 v242, v230, v228
    v_cvt_pk_bf16_f32 v243, v226, v224
    v_cvt_pk_bf16_f32 v244, v222, v220
    v_cvt_pk_bf16_f32 v245, v218, v216
    ds_write_b128 v12, v[242:245] offset:33280
    v_cvt_pk_bf16_f32 v246, v231, v229
    v_cvt_pk_bf16_f32 v247, v227, v225
    v_cvt_pk_bf16_f32 v248, v223, v221
    v_cvt_pk_bf16_f32 v249, v219, v217
    ds_write_b128 v12, v[246:249] offset:40960
    v_lshlrev_b32 v216, 16, v111
    v_and_b32 v217, 0xffff0000, v111
    v_lshlrev_b32 v218, 16, v115
    v_and_b32 v219, 0xffff0000, v115
    v_lshlrev_b32 v220, 16, v119
    v_and_b32 v221, 0xffff0000, v119
    v_lshlrev_b32 v222, 16, v123
    v_and_b32 v223, 0xffff0000, v123
    v_lshlrev_b32 v224, 16, v127
    v_and_b32 v225, 0xffff0000, v127
    v_lshlrev_b32 v226, 16, v131
    v_and_b32 v227, 0xffff0000, v131
    v_lshlrev_b32 v228, 16, v135
    v_and_b32 v229, 0xffff0000, v135
    v_lshlrev_b32 v230, 16, v139
    v_and_b32 v231, 0xffff0000, v139
    v_lshlrev_b32 v232, 16, v143
    v_and_b32 v233, 0xffff0000, v143
    v_lshlrev_b32 v234, 16, v147
    v_and_b32 v235, 0xffff0000, v147
    v_lshlrev_b32 v236, 16, v151
    v_and_b32 v237, 0xffff0000, v151
    v_pk_mul_f32 v[216:217], v[216:217], v[214:215]
    v_lshlrev_b32 v238, 16, v155
    v_pk_fma_f32 v[216:217], v[218:219], v[212:213], v[216:217]
    v_and_b32 v239, 0xffff0000, v155
    v_pk_fma_f32 v[216:217], v[220:221], v[210:211], v[216:217]
    v_pk_fma_f32 v[216:217], v[222:223], v[208:209], v[216:217]
    v_pk_mul_f32 v[216:217], v[216:217], v[238:239]
    v_pk_mul_f32 v[218:219], v[218:219], v[214:215]
    v_lshlrev_b32 v240, 16, v159
    v_pk_fma_f32 v[218:219], v[220:221], v[212:213], v[218:219]
    v_and_b32 v241, 0xffff0000, v159
    v_pk_fma_f32 v[218:219], v[222:223], v[210:211], v[218:219]
    v_pk_fma_f32 v[218:219], v[224:225], v[208:209], v[218:219]
    v_pk_mul_f32 v[218:219], v[218:219], v[240:241]
    v_pk_mul_f32 v[220:221], v[220:221], v[214:215]
    v_lshlrev_b32 v238, 16, v163
    v_pk_fma_f32 v[220:221], v[222:223], v[212:213], v[220:221]
    v_and_b32 v239, 0xffff0000, v163
    v_pk_fma_f32 v[220:221], v[224:225], v[210:211], v[220:221]
    v_pk_fma_f32 v[220:221], v[226:227], v[208:209], v[220:221]
    v_pk_mul_f32 v[220:221], v[220:221], v[238:239]
    v_pk_mul_f32 v[222:223], v[222:223], v[214:215]
    v_lshlrev_b32 v240, 16, v167
    v_pk_fma_f32 v[222:223], v[224:225], v[212:213], v[222:223]
    v_and_b32 v241, 0xffff0000, v167
    v_pk_fma_f32 v[222:223], v[226:227], v[210:211], v[222:223]
    v_pk_fma_f32 v[222:223], v[228:229], v[208:209], v[222:223]
    v_pk_mul_f32 v[222:223], v[222:223], v[240:241]
    v_pk_mul_f32 v[224:225], v[224:225], v[214:215]
    v_lshlrev_b32 v238, 16, v171
    v_pk_fma_f32 v[224:225], v[226:227], v[212:213], v[224:225]
    v_and_b32 v239, 0xffff0000, v171
    v_pk_fma_f32 v[224:225], v[228:229], v[210:211], v[224:225]
    v_pk_fma_f32 v[224:225], v[230:231], v[208:209], v[224:225]
    v_pk_mul_f32 v[224:225], v[224:225], v[238:239]
    v_pk_mul_f32 v[226:227], v[226:227], v[214:215]
    v_lshlrev_b32 v240, 16, v175
    v_pk_fma_f32 v[226:227], v[228:229], v[212:213], v[226:227]
    v_and_b32 v241, 0xffff0000, v175
    v_pk_fma_f32 v[226:227], v[230:231], v[210:211], v[226:227]
    v_pk_fma_f32 v[226:227], v[232:233], v[208:209], v[226:227]
    v_pk_mul_f32 v[226:227], v[226:227], v[240:241]
    v_pk_mul_f32 v[228:229], v[228:229], v[214:215]
    v_lshlrev_b32 v238, 16, v179
    v_pk_fma_f32 v[228:229], v[230:231], v[212:213], v[228:229]
    v_and_b32 v239, 0xffff0000, v179
    v_pk_fma_f32 v[228:229], v[232:233], v[210:211], v[228:229]
    v_pk_fma_f32 v[228:229], v[234:235], v[208:209], v[228:229]
    v_pk_mul_f32 v[228:229], v[228:229], v[238:239]
    v_pk_mul_f32 v[230:231], v[230:231], v[214:215]
    v_lshlrev_b32 v240, 16, v183
    v_pk_fma_f32 v[230:231], v[232:233], v[212:213], v[230:231]
    v_and_b32 v241, 0xffff0000, v183
    v_pk_fma_f32 v[230:231], v[234:235], v[210:211], v[230:231]
    v_pk_fma_f32 v[230:231], v[236:237], v[208:209], v[230:231]
    v_pk_mul_f32 v[230:231], v[230:231], v[240:241]
    v_cvt_pk_bf16_f32 v242, v230, v228
    v_cvt_pk_bf16_f32 v243, v226, v224
    v_cvt_pk_bf16_f32 v244, v222, v220
    v_cvt_pk_bf16_f32 v245, v218, v216
    ds_write_b128 v12, v[242:245] offset:48640
    v_cvt_pk_bf16_f32 v246, v231, v229
    v_cvt_pk_bf16_f32 v247, v227, v225
    v_cvt_pk_bf16_f32 v248, v223, v221
    v_cvt_pk_bf16_f32 v249, v219, v217
    ds_write_b128 v12, v[246:249] offset:56320
    s_lshl_b32 s4, s61, 12
    v_add_u32 v6, s4, v5
    buffer_load_dwordx4 v[184:187], v2, s[36:39], s4 offen offset:0
    buffer_load_dwordx4 v[188:191], v2, s[36:39], s4 offen offset:1024
    buffer_load_dwordx4 v[192:195], v2, s[36:39], s4 offen offset:2048
    buffer_load_dwordx4 v[196:199], v2, s[36:39], s4 offen offset:3072
    buffer_load_dword v200, v6, s[36:39], 0 offen
    buffer_load_dword v201, v2, s[36:39], s4 offen offset:1020
    buffer_load_dword v202, v2, s[36:39], s4 offen offset:2044
    buffer_load_dword v203, v2, s[36:39], s4 offen offset:3068
    s_waitcnt vmcnt(0)
    s_waitcnt lgkmcnt(0)
    s_barrier
    s_mov_b32 s64, 0
.chan_297:
    s_lshr_b32 s4, s61, 1
    s_lshl_b32 s4, s4, 2
    s_load_dword s65, s[50:51], s4
    s_lshl_b32 s7, s61, 12
    s_add_u32 s7, s7, 130023424
    v_writelane_b32 v200, 0, 0
    ds_write_b128 v9, v[184:187] offset:64
    v_alignbit_b32 v204, v184, v200, 16
    v_alignbit_b32 v205, v185, v184, 16
    v_alignbit_b32 v206, v186, v185, 16
    v_alignbit_b32 v207, v187, v186, 16
    ds_write_b128 v9, v[204:207] offset:4224
    ds_write_b128 v9, v[188:191] offset:1088
    v_alignbit_b32 v208, v188, v201, 16
    v_alignbit_b32 v209, v189, v188, 16
    v_alignbit_b32 v210, v190, v189, 16
    v_alignbit_b32 v211, v191, v190, 16
    ds_write_b128 v9, v[208:211] offset:5248
    ds_write_b128 v9, v[192:195] offset:2112
    v_alignbit_b32 v212, v192, v202, 16
    v_alignbit_b32 v213, v193, v192, 16
    v_alignbit_b32 v214, v194, v193, 16
    v_alignbit_b32 v215, v195, v194, 16
    ds_write_b128 v9, v[212:215] offset:6272
    ds_write_b128 v9, v[196:199] offset:3136
    v_alignbit_b32 v216, v196, v203, 16
    v_alignbit_b32 v217, v197, v196, 16
    v_alignbit_b32 v218, v198, v197, 16
    v_alignbit_b32 v219, v199, v198, 16
    ds_write_b128 v9, v[216:219] offset:7296
    s_and_b32 s4, s61, 1
    s_lshl_b32 s4, s4, 4
    s_waitcnt lgkmcnt(0)
    s_lshr_b32 s65, s65, s4
    s_pack_ll_b32_b16 s65, s65, s65
    s_add_u32 s61, s61, 4
    s_cmp_eq_u32 s64, 3
    s_cbranch_scc1 .chan_297_ns
    s_lshl_b32 s4, s61, 12
    v_add_u32 v6, s4, v5
    buffer_load_dwordx4 v[184:187], v2, s[36:39], s4 offen offset:0
    buffer_load_dwordx4 v[188:191], v2, s[36:39], s4 offen offset:1024
    buffer_load_dwordx4 v[192:195], v2, s[36:39], s4 offen offset:2048
    buffer_load_dwordx4 v[196:199], v2, s[36:39], s4 offen offset:3072
    buffer_load_dword v200, v6, s[36:39], 0 offen
    buffer_load_dword v201, v2, s[36:39], s4 offen offset:1020
    buffer_load_dword v202, v2, s[36:39], s4 offen offset:2044
    buffer_load_dword v203, v2, s[36:39], s4 offen offset:3068
.chan_297_ns:
    v_and_b32 v16, s65, v24
    v_and_b32 v17, s65, v25
    v_and_b32 v18, s65, v26
    v_and_b32 v19, s65, v27
    v_and_b32 v20, s65, v28
    v_and_b32 v21, s65, v29
    v_and_b32 v22, s65, v30
    v_and_b32 v23, s65, v31
    v_mov_b32 v14, v10
    ds_read2_b32 a[32:33], v14 offset0:0 offset1:1
    ds_read2_b32 a[34:35], v14 offset0:2 offset1:3
    ds_read_b128 a[56:59], v11 offset:7632
    ds_read_b128 a[60:63], v11 offset:5072
    ds_read2_b32 a[36:37], v14 offset0:8 offset1:9
    ds_read2_b32 a[38:39], v14 offset0:10 offset1:11
    ds_read_b128 a[64:67], v11 offset:7600
    ds_read_b128 a[68:71], v11 offset:5040
    ds_read2_b32 a[40:41], v14 offset0:16 offset1:17
    ds_read2_b32 a[42:43], v14 offset0:18 offset1:19
    ds_read_b128 a[72:75], v11 offset:7552
    ds_read_b128 a[76:79], v11 offset:4992
    s_waitcnt lgkmcnt(9)
    v_mfma_f32_32x32x16_bf16 a[16:31], a[32:35], a[56:59], 0
    v_mfma_f32_32x32x16_bf16 a[16:31], v[20:23], a[56:59], a[16:31]
    ds_read2_b32 a[44:45], v14 offset0:24 offset1:25
    ds_read2_b32 a[46:47], v14 offset0:26 offset1:27
    s_waitcnt lgkmcnt(10)
    v_mfma_f32_32x32x16_bf16 a[0:15], a[32:35], a[60:63], 0
    v_mfma_f32_32x32x16_bf16 a[0:15], v[20:23], a[60:63], a[0:15]
    ds_read_b128 a[80:83], v11 offset:7520
    ds_read_b128 a[84:87], v11 offset:4960
    s_waitcnt lgkmcnt(9)
    v_mfma_f32_32x32x16_bf16 a[16:31], a[36:39], a[64:67], a[16:31]
    v_mfma_f32_32x32x16_bf16 a[16:31], v[16:19], a[64:67], a[16:31]
    ds_read2_b32 a[48:49], v14 offset0:32 offset1:33
    ds_read2_b32 a[50:51], v14 offset0:34 offset1:35
    s_waitcnt lgkmcnt(10)
    v_mfma_f32_32x32x16_bf16 a[0:15], a[36:39], a[68:71], a[0:15]
    v_mfma_f32_32x32x16_bf16 a[0:15], v[16:19], a[68:71], a[0:15]
    ds_read_b128 a[56:59], v11 offset:7472
    ds_read_b128 a[60:63], v11 offset:4912
    s_waitcnt lgkmcnt(9)
    v_mfma_f32_32x32x16_bf16 a[16:31], a[40:43], a[72:75], a[16:31]
    ds_read2_b32 a[52:53], v14 offset0:40 offset1:41
    ds_read2_b32 a[54:55], v14 offset0:42 offset1:43
    s_waitcnt lgkmcnt(10)
    v_mfma_f32_32x32x16_bf16 a[0:15], a[40:43], a[76:79], a[0:15]
    ds_read_b128 a[64:67], v11 offset:7440
    ds_read_b128 a[68:71], v11 offset:4880
    s_waitcnt lgkmcnt(9)
    v_mfma_f32_32x32x16_bf16 a[16:31], a[44:47], a[80:83], a[16:31]
    ds_read2_b32 a[32:33], v14 offset0:48 offset1:49
    ds_read2_b32 a[34:35], v14 offset0:50 offset1:51
    s_waitcnt lgkmcnt(10)
    v_mfma_f32_32x32x16_bf16 a[0:15], a[44:47], a[84:87], a[0:15]
    ds_read_b128 a[72:75], v11 offset:7392
    ds_read_b128 a[76:79], v11 offset:4832
    s_waitcnt lgkmcnt(9)
    v_mfma_f32_32x32x16_bf16 a[16:31], a[48:51], a[56:59], a[16:31]
    ds_read2_b32 a[36:37], v14 offset0:56 offset1:57
    ds_read2_b32 a[38:39], v14 offset0:58 offset1:59
    s_waitcnt lgkmcnt(10)
    v_mfma_f32_32x32x16_bf16 a[0:15], a[48:51], a[60:63], a[0:15]
    ds_read_b128 a[80:83], v11 offset:7360
    ds_read_b128 a[84:87], v11 offset:4800
    s_waitcnt lgkmcnt(9)
    v_mfma_f32_32x32x16_bf16 a[16:31], a[52:55], a[64:67], a[16:31]
    ds_read2_b32 a[40:41], v14 offset0:64 offset1:65
    ds_read2_b32 a[42:43], v14 offset0:66 offset1:67
    s_waitcnt lgkmcnt(10)
    v_mfma_f32_32x32x16_bf16 a[0:15], a[52:55], a[68:71], a[0:15]
    ds_read_b128 a[56:59], v11 offset:7312
    ds_read_b128 a[60:63], v11 offset:4752
    s_waitcnt lgkmcnt(9)
    v_mfma_f32_32x32x16_bf16 a[16:31], a[32:35], a[72:75], a[16:31]
    ds_read2_b32 a[44:45], v14 offset0:72 offset1:73
    ds_read2_b32 a[46:47], v14 offset0:74 offset1:75
    s_waitcnt lgkmcnt(10)
    v_mfma_f32_32x32x16_bf16 a[0:15], a[32:35], a[76:79], a[0:15]
    ds_read_b128 a[64:67], v11 offset:7280
    ds_read_b128 a[68:71], v11 offset:4720
    s_waitcnt lgkmcnt(9)
    v_mfma_f32_32x32x16_bf16 a[16:31], a[36:39], a[80:83], a[16:31]
    ds_read2_b32 a[48:49], v14 offset0:80 offset1:81
    ds_read2_b32 a[50:51], v14 offset0:82 offset1:83
    s_waitcnt lgkmcnt(10)
    v_mfma_f32_32x32x16_bf16 a[0:15], a[36:39], a[84:87], a[0:15]
    ds_read_b128 a[72:75], v11 offset:7232
    ds_read_b128 a[76:79], v11 offset:4672
    s_waitcnt lgkmcnt(9)
    v_mfma_f32_32x32x16_bf16 a[16:31], a[40:43], a[56:59], a[16:31]
    ds_read2_b32 a[52:53], v14 offset0:88 offset1:89
    ds_read2_b32 a[54:55], v14 offset0:90 offset1:91
    s_waitcnt lgkmcnt(10)
    v_mfma_f32_32x32x16_bf16 a[0:15], a[40:43], a[60:63], a[0:15]
    ds_read_b128 a[80:83], v11 offset:7200
    ds_read_b128 a[84:87], v11 offset:4640
    s_waitcnt lgkmcnt(9)
    v_mfma_f32_32x32x16_bf16 a[16:31], a[44:47], a[64:67], a[16:31]
    ds_read2_b32 a[32:33], v14 offset0:96 offset1:97
    ds_read2_b32 a[34:35], v14 offset0:98 offset1:99
    s_waitcnt lgkmcnt(10)
    v_mfma_f32_32x32x16_bf16 a[0:15], a[44:47], a[68:71], a[0:15]
    ds_read_b128 a[56:59], v11 offset:7152
    ds_read_b128 a[60:63], v11 offset:4592
    s_waitcnt lgkmcnt(9)
    v_mfma_f32_32x32x16_bf16 a[16:31], a[48:51], a[72:75], a[16:31]
    ds_read2_b32 a[36:37], v14 offset0:104 offset1:105
    ds_read2_b32 a[38:39], v14 offset0:106 offset1:107
    s_waitcnt lgkmcnt(10)
    v_mfma_f32_32x32x16_bf16 a[0:15], a[48:51], a[76:79], a[0:15]
    ds_read_b128 a[64:67], v11 offset:7120
    ds_read_b128 a[68:71], v11 offset:4560
    s_waitcnt lgkmcnt(9)
    v_mfma_f32_32x32x16_bf16 a[16:31], a[52:55], a[80:83], a[16:31]
    ds_read2_b32 a[40:41], v14 offset0:112 offset1:113
    ds_read2_b32 a[42:43], v14 offset0:114 offset1:115
    s_waitcnt lgkmcnt(10)
    v_mfma_f32_32x32x16_bf16 a[0:15], a[52:55], a[84:87], a[0:15]
    ds_read_b128 a[72:75], v11 offset:7072
    ds_read_b128 a[76:79], v11 offset:4512
    s_waitcnt lgkmcnt(9)
    v_mfma_f32_32x32x16_bf16 a[16:31], a[32:35], a[56:59], a[16:31]
    ds_read2_b32 a[44:45], v14 offset0:120 offset1:121
    ds_read2_b32 a[46:47], v14 offset0:122 offset1:123
    s_waitcnt lgkmcnt(10)
    v_mfma_f32_32x32x16_bf16 a[0:15], a[32:35], a[60:63], a[0:15]
    ds_read_b128 a[80:83], v11 offset:7040
    ds_read_b128 a[84:87], v11 offset:4480
    s_waitcnt lgkmcnt(9)
    v_mfma_f32_32x32x16_bf16 a[16:31], a[36:39], a[64:67], a[16:31]
    ds_read2_b32 a[48:49], v14 offset0:128 offset1:129
    ds_read2_b32 a[50:51], v14 offset0:130 offset1:131
    s_waitcnt lgkmcnt(10)
    v_mfma_f32_32x32x16_bf16 a[0:15], a[36:39], a[68:71], a[0:15]
    ds_read_b128 a[56:59], v11 offset:6992
    ds_read_b128 a[60:63], v11 offset:4432
    s_waitcnt lgkmcnt(9)
    v_mfma_f32_32x32x16_bf16 a[16:31], a[40:43], a[72:75], a[16:31]
    ds_read2_b32 a[52:53], v14 offset0:136 offset1:137
    ds_read2_b32 a[54:55], v14 offset0:138 offset1:139
    s_waitcnt lgkmcnt(10)
    v_mfma_f32_32x32x16_bf16 a[0:15], a[40:43], a[76:79], a[0:15]
    ds_read_b128 a[64:67], v11 offset:6960
    ds_read_b128 a[68:71], v11 offset:4400
    s_waitcnt lgkmcnt(9)
    v_mfma_f32_32x32x16_bf16 a[16:31], a[44:47], a[80:83], a[16:31]
    ds_read2_b32 a[32:33], v14 offset0:144 offset1:145
    ds_read2_b32 a[34:35], v14 offset0:146 offset1:147
    s_waitcnt lgkmcnt(10)
    v_mfma_f32_32x32x16_bf16 a[0:15], a[44:47], a[84:87], a[0:15]
    ds_read_b128 a[72:75], v11 offset:6912
    ds_read_b128 a[76:79], v11 offset:4352
    s_waitcnt lgkmcnt(9)
    v_mfma_f32_32x32x16_bf16 a[16:31], a[48:51], a[56:59], a[16:31]
    ds_read2_b32 a[36:37], v14 offset0:152 offset1:153
    ds_read2_b32 a[38:39], v14 offset0:154 offset1:155
    s_waitcnt lgkmcnt(10)
    v_mfma_f32_32x32x16_bf16 a[0:15], a[48:51], a[60:63], a[0:15]
    ds_read_b128 a[80:83], v11 offset:6880
    ds_read_b128 a[84:87], v11 offset:4320
    s_waitcnt lgkmcnt(9)
    v_mfma_f32_32x32x16_bf16 a[16:31], a[52:55], a[64:67], a[16:31]
    ds_read2_b32 a[40:41], v14 offset0:160 offset1:161
    ds_read2_b32 a[42:43], v14 offset0:162 offset1:163
    s_waitcnt lgkmcnt(10)
    v_mfma_f32_32x32x16_bf16 a[0:15], a[52:55], a[68:71], a[0:15]
    ds_read_b128 a[56:59], v11 offset:6832
    ds_read_b128 a[60:63], v11 offset:4272
    s_waitcnt lgkmcnt(9)
    v_mfma_f32_32x32x16_bf16 a[16:31], a[32:35], a[72:75], a[16:31]
    ds_read2_b32 a[44:45], v14 offset0:168 offset1:169
    ds_read2_b32 a[46:47], v14 offset0:170 offset1:171
    s_waitcnt lgkmcnt(10)
    v_mfma_f32_32x32x16_bf16 a[0:15], a[32:35], a[76:79], a[0:15]
    ds_read_b128 a[64:67], v11 offset:6800
    ds_read_b128 a[68:71], v11 offset:4240
    s_waitcnt lgkmcnt(9)
    v_mfma_f32_32x32x16_bf16 a[16:31], a[36:39], a[80:83], a[16:31]
    ds_read2_b32 a[48:49], v14 offset0:176 offset1:177
    ds_read2_b32 a[50:51], v14 offset0:178 offset1:179
    s_waitcnt lgkmcnt(10)
    v_mfma_f32_32x32x16_bf16 a[0:15], a[36:39], a[84:87], a[0:15]
    ds_read_b128 a[72:75], v11 offset:6752
    ds_read_b128 a[76:79], v11 offset:4192
    s_waitcnt lgkmcnt(9)
    v_mfma_f32_32x32x16_bf16 a[16:31], a[40:43], a[56:59], a[16:31]
    ds_read2_b32 a[52:53], v14 offset0:184 offset1:185
    ds_read2_b32 a[54:55], v14 offset0:186 offset1:187
    s_waitcnt lgkmcnt(10)
    v_mfma_f32_32x32x16_bf16 a[0:15], a[40:43], a[60:63], a[0:15]
    ds_read_b128 a[80:83], v11 offset:6720
    ds_read_b128 a[84:87], v11 offset:4160
    s_waitcnt lgkmcnt(9)
    v_mfma_f32_32x32x16_bf16 a[16:31], a[44:47], a[64:67], a[16:31]
    ds_read2_b32 a[32:33], v14 offset0:192 offset1:193
    ds_read2_b32 a[34:35], v14 offset0:194 offset1:195
    s_waitcnt lgkmcnt(10)
    v_mfma_f32_32x32x16_bf16 a[0:15], a[44:47], a[68:71], a[0:15]
    ds_read_b128 a[56:59], v11 offset:6672
    ds_read_b128 a[60:63], v11 offset:4112
    s_waitcnt lgkmcnt(9)
    v_mfma_f32_32x32x16_bf16 a[16:31], a[48:51], a[72:75], a[16:31]
    ds_read2_b32 a[36:37], v14 offset0:200 offset1:201
    ds_read2_b32 a[38:39], v14 offset0:202 offset1:203
    s_waitcnt lgkmcnt(10)
    v_mfma_f32_32x32x16_bf16 a[0:15], a[48:51], a[76:79], a[0:15]
    ds_read_b128 a[64:67], v11 offset:6640
    ds_read_b128 a[68:71], v11 offset:4080
    s_waitcnt lgkmcnt(9)
    v_mfma_f32_32x32x16_bf16 a[16:31], a[52:55], a[80:83], a[16:31]
    ds_read2_b32 a[40:41], v14 offset0:208 offset1:209
    ds_read2_b32 a[42:43], v14 offset0:210 offset1:211
    s_waitcnt lgkmcnt(10)
    v_mfma_f32_32x32x16_bf16 a[0:15], a[52:55], a[84:87], a[0:15]
    ds_read_b128 a[72:75], v11 offset:6592
    ds_read_b128 a[76:79], v11 offset:4032
    s_waitcnt lgkmcnt(9)
    v_mfma_f32_32x32x16_bf16 a[16:31], a[32:35], a[56:59], a[16:31]
    ds_read2_b32 a[44:45], v14 offset0:216 offset1:217
    ds_read2_b32 a[46:47], v14 offset0:218 offset1:219
    s_waitcnt lgkmcnt(10)
    v_mfma_f32_32x32x16_bf16 a[0:15], a[32:35], a[60:63], a[0:15]
    ds_read_b128 a[80:83], v11 offset:6560
    ds_read_b128 a[84:87], v11 offset:4000
    s_waitcnt lgkmcnt(9)
    v_mfma_f32_32x32x16_bf16 a[16:31], a[36:39], a[64:67], a[16:31]
    ds_read2_b32 a[48:49], v14 offset0:224 offset1:225
    ds_read2_b32 a[50:51], v14 offset0:226 offset1:227
    s_waitcnt lgkmcnt(10)
    v_mfma_f32_32x32x16_bf16 a[0:15], a[36:39], a[68:71], a[0:15]
    ds_read_b128 a[56:59], v11 offset:6512
    ds_read_b128 a[60:63], v11 offset:3952
    s_waitcnt lgkmcnt(9)
    v_mfma_f32_32x32x16_bf16 a[16:31], a[40:43], a[72:75], a[16:31]
    ds_read2_b32 a[52:53], v14 offset0:232 offset1:233
    ds_read2_b32 a[54:55], v14 offset0:234 offset1:235
    s_waitcnt lgkmcnt(10)
    v_mfma_f32_32x32x16_bf16 a[0:15], a[40:43], a[76:79], a[0:15]
    ds_read_b128 a[64:67], v11 offset:6480
    ds_read_b128 a[68:71], v11 offset:3920
    s_waitcnt lgkmcnt(9)
    v_mfma_f32_32x32x16_bf16 a[16:31], a[44:47], a[80:83], a[16:31]
    ds_read2_b32 a[32:33], v14 offset0:240 offset1:241
    ds_read2_b32 a[34:35], v14 offset0:242 offset1:243
    s_waitcnt lgkmcnt(10)
    v_mfma_f32_32x32x16_bf16 a[0:15], a[44:47], a[84:87], a[0:15]
    ds_read_b128 a[72:75], v11 offset:6432
    ds_read_b128 a[76:79], v11 offset:3872
    s_waitcnt lgkmcnt(9)
    v_mfma_f32_32x32x16_bf16 a[16:31], a[48:51], a[56:59], a[16:31]
    ds_read2_b32 a[36:37], v14 offset0:248 offset1:249
    ds_read2_b32 a[38:39], v14 offset0:250 offset1:251
    v_add_u32 v14, 1024, v14
    s_waitcnt lgkmcnt(10)
    v_mfma_f32_32x32x16_bf16 a[0:15], a[48:51], a[60:63], a[0:15]
    ds_read_b128 a[80:83], v11 offset:6400
    ds_read_b128 a[84:87], v11 offset:3840
    s_waitcnt lgkmcnt(9)
    v_mfma_f32_32x32x16_bf16 a[16:31], a[52:55], a[64:67], a[16:31]
    ds_read2_b32 a[40:41], v14 offset0:0 offset1:1
    ds_read2_b32 a[42:43], v14 offset0:2 offset1:3
    s_waitcnt lgkmcnt(10)
    v_mfma_f32_32x32x16_bf16 a[0:15], a[52:55], a[68:71], a[0:15]
    ds_read_b128 a[56:59], v11 offset:6352
    ds_read_b128 a[60:63], v11 offset:3792
    s_waitcnt lgkmcnt(9)
    v_mfma_f32_32x32x16_bf16 a[16:31], a[32:35], a[72:75], a[16:31]
    ds_read2_b32 a[44:45], v14 offset0:8 offset1:9
    ds_read2_b32 a[46:47], v14 offset0:10 offset1:11
    s_waitcnt lgkmcnt(10)
    v_mfma_f32_32x32x16_bf16 a[0:15], a[32:35], a[76:79], a[0:15]
    ds_read_b128 a[64:67], v11 offset:6320
    ds_read_b128 a[68:71], v11 offset:3760
    s_waitcnt lgkmcnt(9)
    v_mfma_f32_32x32x16_bf16 a[16:31], a[36:39], a[80:83], a[16:31]
    ds_read2_b32 a[48:49], v14 offset0:16 offset1:17
    ds_read2_b32 a[50:51], v14 offset0:18 offset1:19
    s_waitcnt lgkmcnt(10)
    v_mfma_f32_32x32x16_bf16 a[0:15], a[36:39], a[84:87], a[0:15]
    ds_read_b128 a[72:75], v11 offset:6272
    ds_read_b128 a[76:79], v11 offset:3712
    s_waitcnt lgkmcnt(9)
    v_mfma_f32_32x32x16_bf16 a[16:31], a[40:43], a[56:59], a[16:31]
    ds_read2_b32 a[52:53], v14 offset0:24 offset1:25
    ds_read2_b32 a[54:55], v14 offset0:26 offset1:27
    s_waitcnt lgkmcnt(10)
    v_mfma_f32_32x32x16_bf16 a[0:15], a[40:43], a[60:63], a[0:15]
    ds_read_b128 a[80:83], v11 offset:6240
    ds_read_b128 a[84:87], v11 offset:3680
    s_waitcnt lgkmcnt(9)
    v_mfma_f32_32x32x16_bf16 a[16:31], a[44:47], a[64:67], a[16:31]
    ds_read2_b32 a[32:33], v14 offset0:32 offset1:33
    ds_read2_b32 a[34:35], v14 offset0:34 offset1:35
    s_waitcnt lgkmcnt(10)
    v_mfma_f32_32x32x16_bf16 a[0:15], a[44:47], a[68:71], a[0:15]
    ds_read_b128 a[56:59], v11 offset:6192
    ds_read_b128 a[60:63], v11 offset:3632
    s_waitcnt lgkmcnt(9)
    v_mfma_f32_32x32x16_bf16 a[16:31], a[48:51], a[72:75], a[16:31]
    ds_read2_b32 a[36:37], v14 offset0:40 offset1:41
    ds_read2_b32 a[38:39], v14 offset0:42 offset1:43
    s_waitcnt lgkmcnt(10)
    v_mfma_f32_32x32x16_bf16 a[0:15], a[48:51], a[76:79], a[0:15]
    ds_read_b128 a[64:67], v11 offset:6160
    ds_read_b128 a[68:71], v11 offset:3600
    s_waitcnt lgkmcnt(9)
    v_mfma_f32_32x32x16_bf16 a[16:31], a[52:55], a[80:83], a[16:31]
    ds_read2_b32 a[40:41], v14 offset0:48 offset1:49
    ds_read2_b32 a[42:43], v14 offset0:50 offset1:51
    s_waitcnt lgkmcnt(10)
    v_mfma_f32_32x32x16_bf16 a[0:15], a[52:55], a[84:87], a[0:15]
    ds_read_b128 a[72:75], v11 offset:6112
    ds_read_b128 a[76:79], v11 offset:3552
    s_waitcnt lgkmcnt(9)
    v_mfma_f32_32x32x16_bf16 a[16:31], a[32:35], a[56:59], a[16:31]
    ds_read2_b32 a[44:45], v14 offset0:56 offset1:57
    ds_read2_b32 a[46:47], v14 offset0:58 offset1:59
    s_waitcnt lgkmcnt(10)
    v_mfma_f32_32x32x16_bf16 a[0:15], a[32:35], a[60:63], a[0:15]
    ds_read_b128 a[80:83], v11 offset:6080
    ds_read_b128 a[84:87], v11 offset:3520
    s_waitcnt lgkmcnt(9)
    v_mfma_f32_32x32x16_bf16 a[16:31], a[36:39], a[64:67], a[16:31]
    ds_read2_b32 a[48:49], v14 offset0:64 offset1:65
    ds_read2_b32 a[50:51], v14 offset0:66 offset1:67
    s_waitcnt lgkmcnt(10)
    v_mfma_f32_32x32x16_bf16 a[0:15], a[36:39], a[68:71], a[0:15]
    ds_read_b128 a[56:59], v11 offset:6032
    ds_read_b128 a[60:63], v11 offset:3472
    s_waitcnt lgkmcnt(9)
    v_mfma_f32_32x32x16_bf16 a[16:31], a[40:43], a[72:75], a[16:31]
    ds_read2_b32 a[52:53], v14 offset0:72 offset1:73
    ds_read2_b32 a[54:55], v14 offset0:74 offset1:75
    s_waitcnt lgkmcnt(10)
    v_mfma_f32_32x32x16_bf16 a[0:15], a[40:43], a[76:79], a[0:15]
    ds_read_b128 a[64:67], v11 offset:6000
    ds_read_b128 a[68:71], v11 offset:3440
    s_waitcnt lgkmcnt(9)
    v_mfma_f32_32x32x16_bf16 a[16:31], a[44:47], a[80:83], a[16:31]
    ds_read2_b32 a[32:33], v14 offset0:80 offset1:81
    ds_read2_b32 a[34:35], v14 offset0:82 offset1:83
    s_waitcnt lgkmcnt(10)
    v_mfma_f32_32x32x16_bf16 a[0:15], a[44:47], a[84:87], a[0:15]
    ds_read_b128 a[72:75], v11 offset:5952
    ds_read_b128 a[76:79], v11 offset:3392
    s_waitcnt lgkmcnt(9)
    v_mfma_f32_32x32x16_bf16 a[16:31], a[48:51], a[56:59], a[16:31]
    ds_read2_b32 a[36:37], v14 offset0:88 offset1:89
    ds_read2_b32 a[38:39], v14 offset0:90 offset1:91
    s_waitcnt lgkmcnt(10)
    v_mfma_f32_32x32x16_bf16 a[0:15], a[48:51], a[60:63], a[0:15]
    ds_read_b128 a[80:83], v11 offset:5920
    ds_read_b128 a[84:87], v11 offset:3360
    s_waitcnt lgkmcnt(9)
    v_mfma_f32_32x32x16_bf16 a[16:31], a[52:55], a[64:67], a[16:31]
    ds_read2_b32 a[40:41], v14 offset0:96 offset1:97
    ds_read2_b32 a[42:43], v14 offset0:98 offset1:99
    s_waitcnt lgkmcnt(10)
    v_mfma_f32_32x32x16_bf16 a[0:15], a[52:55], a[68:71], a[0:15]
    ds_read_b128 a[56:59], v11 offset:5872
    ds_read_b128 a[60:63], v11 offset:3312
    s_waitcnt lgkmcnt(9)
    v_mfma_f32_32x32x16_bf16 a[16:31], a[32:35], a[72:75], a[16:31]
    ds_read2_b32 a[44:45], v14 offset0:104 offset1:105
    ds_read2_b32 a[46:47], v14 offset0:106 offset1:107
    s_waitcnt lgkmcnt(10)
    v_mfma_f32_32x32x16_bf16 a[0:15], a[32:35], a[76:79], a[0:15]
    ds_read_b128 a[64:67], v11 offset:5840
    ds_read_b128 a[68:71], v11 offset:3280
    s_waitcnt lgkmcnt(9)
    v_mfma_f32_32x32x16_bf16 a[16:31], a[36:39], a[80:83], a[16:31]
    ds_read2_b32 a[48:49], v14 offset0:112 offset1:113
    ds_read2_b32 a[50:51], v14 offset0:114 offset1:115
    s_waitcnt lgkmcnt(10)
    v_mfma_f32_32x32x16_bf16 a[0:15], a[36:39], a[84:87], a[0:15]
    ds_read_b128 a[72:75], v11 offset:5792
    ds_read_b128 a[76:79], v11 offset:3232
    s_waitcnt lgkmcnt(9)
    v_mfma_f32_32x32x16_bf16 a[16:31], a[40:43], a[56:59], a[16:31]
    ds_read2_b32 a[52:53], v14 offset0:120 offset1:121
    ds_read2_b32 a[54:55], v14 offset0:122 offset1:123
    s_waitcnt lgkmcnt(10)
    v_mfma_f32_32x32x16_bf16 a[0:15], a[40:43], a[60:63], a[0:15]
    ds_read_b128 a[80:83], v11 offset:5760
    ds_read_b128 a[84:87], v11 offset:3200
    s_waitcnt lgkmcnt(9)
    v_mfma_f32_32x32x16_bf16 a[16:31], a[44:47], a[64:67], a[16:31]
    ds_read2_b32 a[32:33], v14 offset0:128 offset1:129
    ds_read2_b32 a[34:35], v14 offset0:130 offset1:131
    s_waitcnt lgkmcnt(10)
    v_mfma_f32_32x32x16_bf16 a[0:15], a[44:47], a[68:71], a[0:15]
    ds_read_b128 a[56:59], v11 offset:5712
    ds_read_b128 a[60:63], v11 offset:3152
    s_waitcnt lgkmcnt(9)
    v_mfma_f32_32x32x16_bf16 a[16:31], a[48:51], a[72:75], a[16:31]
    ds_read2_b32 a[36:37], v14 offset0:136 offset1:137
    ds_read2_b32 a[38:39], v14 offset0:138 offset1:139
    s_waitcnt lgkmcnt(10)
    v_mfma_f32_32x32x16_bf16 a[0:15], a[48:51], a[76:79], a[0:15]
    ds_read_b128 a[64:67], v11 offset:5680
    ds_read_b128 a[68:71], v11 offset:3120
    s_waitcnt lgkmcnt(9)
    v_mfma_f32_32x32x16_bf16 a[16:31], a[52:55], a[80:83], a[16:31]
    ds_read2_b32 a[40:41], v14 offset0:144 offset1:145
    ds_read2_b32 a[42:43], v14 offset0:146 offset1:147
    s_waitcnt lgkmcnt(10)
    v_mfma_f32_32x32x16_bf16 a[0:15], a[52:55], a[84:87], a[0:15]
    ds_read_b128 a[72:75], v11 offset:5632
    ds_read_b128 a[76:79], v11 offset:3072
    s_waitcnt lgkmcnt(9)
    v_mfma_f32_32x32x16_bf16 a[16:31], a[32:35], a[56:59], a[16:31]
    ds_read2_b32 a[44:45], v14 offset0:152 offset1:153
    ds_read2_b32 a[46:47], v14 offset0:154 offset1:155
    s_waitcnt lgkmcnt(10)
    v_mfma_f32_32x32x16_bf16 a[0:15], a[32:35], a[60:63], a[0:15]
    ds_read_b128 a[80:83], v11 offset:5600
    ds_read_b128 a[84:87], v11 offset:3040
    s_waitcnt lgkmcnt(9)
    v_mfma_f32_32x32x16_bf16 a[16:31], a[36:39], a[64:67], a[16:31]
    ds_read2_b32 a[48:49], v14 offset0:160 offset1:161
    ds_read2_b32 a[50:51], v14 offset0:162 offset1:163
    s_waitcnt lgkmcnt(10)
    v_mfma_f32_32x32x16_bf16 a[0:15], a[36:39], a[68:71], a[0:15]
    ds_read_b128 a[56:59], v11 offset:5552
    ds_read_b128 a[60:63], v11 offset:2992
    s_waitcnt lgkmcnt(9)
    v_mfma_f32_32x32x16_bf16 a[16:31], a[40:43], a[72:75], a[16:31]
    ds_read2_b32 a[52:53], v14 offset0:168 offset1:169
    ds_read2_b32 a[54:55], v14 offset0:170 offset1:171
    s_waitcnt lgkmcnt(10)
    v_mfma_f32_32x32x16_bf16 a[0:15], a[40:43], a[76:79], a[0:15]
    ds_read_b128 a[64:67], v11 offset:5520
    ds_read_b128 a[68:71], v11 offset:2960
    s_waitcnt lgkmcnt(9)
    v_mfma_f32_32x32x16_bf16 a[16:31], a[44:47], a[80:83], a[16:31]
    ds_read2_b32 a[32:33], v14 offset0:176 offset1:177
    ds_read2_b32 a[34:35], v14 offset0:178 offset1:179
    s_waitcnt lgkmcnt(10)
    v_mfma_f32_32x32x16_bf16 a[0:15], a[44:47], a[84:87], a[0:15]
    ds_read_b128 a[72:75], v11 offset:5472
    ds_read_b128 a[76:79], v11 offset:2912
    s_waitcnt lgkmcnt(9)
    v_mfma_f32_32x32x16_bf16 a[16:31], a[48:51], a[56:59], a[16:31]
    ds_read2_b32 a[36:37], v14 offset0:184 offset1:185
    ds_read2_b32 a[38:39], v14 offset0:186 offset1:187
    s_waitcnt lgkmcnt(10)
    v_mfma_f32_32x32x16_bf16 a[0:15], a[48:51], a[60:63], a[0:15]
    ds_read_b128 a[80:83], v11 offset:5440
    ds_read_b128 a[84:87], v11 offset:2880
    s_waitcnt lgkmcnt(9)
    v_mfma_f32_32x32x16_bf16 a[16:31], a[52:55], a[64:67], a[16:31]
    ds_read2_b32 a[40:41], v14 offset0:192 offset1:193
    ds_read2_b32 a[42:43], v14 offset0:194 offset1:195
    s_waitcnt lgkmcnt(10)
    v_mfma_f32_32x32x16_bf16 a[0:15], a[52:55], a[68:71], a[0:15]
    ds_read_b128 a[56:59], v11 offset:5392
    ds_read_b128 a[60:63], v11 offset:2832
    s_waitcnt lgkmcnt(9)
    v_mfma_f32_32x32x16_bf16 a[16:31], a[32:35], a[72:75], a[16:31]
    ds_read2_b32 a[44:45], v14 offset0:200 offset1:201
    ds_read2_b32 a[46:47], v14 offset0:202 offset1:203
    s_waitcnt lgkmcnt(10)
    v_mfma_f32_32x32x16_bf16 a[0:15], a[32:35], a[76:79], a[0:15]
    ds_read_b128 a[64:67], v11 offset:5360
    ds_read_b128 a[68:71], v11 offset:2800
    s_waitcnt lgkmcnt(9)
    v_mfma_f32_32x32x16_bf16 a[16:31], a[36:39], a[80:83], a[16:31]
    ds_read2_b32 a[48:49], v14 offset0:208 offset1:209
    ds_read2_b32 a[50:51], v14 offset0:210 offset1:211
    s_waitcnt lgkmcnt(10)
    v_mfma_f32_32x32x16_bf16 a[0:15], a[36:39], a[84:87], a[0:15]
    ds_read_b128 a[72:75], v11 offset:5312
    ds_read_b128 a[76:79], v11 offset:2752
    s_waitcnt lgkmcnt(9)
    v_mfma_f32_32x32x16_bf16 a[16:31], a[40:43], a[56:59], a[16:31]
    ds_read2_b32 a[52:53], v14 offset0:216 offset1:217
    ds_read2_b32 a[54:55], v14 offset0:218 offset1:219
    s_waitcnt lgkmcnt(10)
    v_mfma_f32_32x32x16_bf16 a[0:15], a[40:43], a[60:63], a[0:15]
    ds_read_b128 a[80:83], v11 offset:5280
    ds_read_b128 a[84:87], v11 offset:2720
    s_waitcnt lgkmcnt(9)
    v_mfma_f32_32x32x16_bf16 a[16:31], a[44:47], a[64:67], a[16:31]
    ds_read2_b32 a[32:33], v14 offset0:224 offset1:225
    ds_read2_b32 a[34:35], v14 offset0:226 offset1:227
    s_waitcnt lgkmcnt(10)
    v_mfma_f32_32x32x16_bf16 a[0:15], a[44:47], a[68:71], a[0:15]
    ds_read_b128 a[56:59], v11 offset:5232
    ds_read_b128 a[60:63], v11 offset:2672
    s_waitcnt lgkmcnt(9)
    v_mfma_f32_32x32x16_bf16 a[16:31], a[48:51], a[72:75], a[16:31]
    ds_read2_b32 a[36:37], v14 offset0:232 offset1:233
    ds_read2_b32 a[38:39], v14 offset0:234 offset1:235
    s_waitcnt lgkmcnt(10)
    v_mfma_f32_32x32x16_bf16 a[0:15], a[48:51], a[76:79], a[0:15]
    ds_read_b128 a[64:67], v11 offset:5200
    ds_read_b128 a[68:71], v11 offset:2640
    s_waitcnt lgkmcnt(9)
    v_mfma_f32_32x32x16_bf16 a[16:31], a[52:55], a[80:83], a[16:31]
    ds_read2_b32 a[40:41], v14 offset0:240 offset1:241
    ds_read2_b32 a[42:43], v14 offset0:242 offset1:243
    s_waitcnt lgkmcnt(10)
    v_mfma_f32_32x32x16_bf16 a[0:15], a[52:55], a[84:87], a[0:15]
    ds_read_b128 a[72:75], v11 offset:5152
    ds_read_b128 a[76:79], v11 offset:2592
    s_waitcnt lgkmcnt(9)
    v_mfma_f32_32x32x16_bf16 a[16:31], a[32:35], a[56:59], a[16:31]
    ds_read2_b32 a[44:45], v14 offset0:248 offset1:249
    ds_read2_b32 a[46:47], v14 offset0:250 offset1:251
    v_add_u32 v14, 1024, v14
    s_waitcnt lgkmcnt(10)
    v_mfma_f32_32x32x16_bf16 a[0:15], a[32:35], a[60:63], a[0:15]
    ds_read_b128 a[80:83], v11 offset:5120
    ds_read_b128 a[84:87], v11 offset:2560
    s_waitcnt lgkmcnt(9)
    v_mfma_f32_32x32x16_bf16 a[16:31], a[36:39], a[64:67], a[16:31]
    ds_read2_b32 a[48:49], v14 offset0:0 offset1:1
    ds_read2_b32 a[50:51], v14 offset0:2 offset1:3
    s_waitcnt lgkmcnt(10)
    v_mfma_f32_32x32x16_bf16 a[0:15], a[36:39], a[68:71], a[0:15]
    ds_read_b128 a[56:59], v11 offset:5072
    ds_read2_b32 a[52:53], v14 offset0:8 offset1:9
    ds_read2_b32 a[54:55], v14 offset0:10 offset1:11
    s_waitcnt lgkmcnt(10)
    v_mfma_f32_32x32x16_bf16 a[16:31], a[40:43], a[72:75], a[16:31]
    ds_read_b128 a[60:63], v11 offset:5040
    s_waitcnt lgkmcnt(10)
    v_mfma_f32_32x32x16_bf16 a[0:15], a[40:43], a[76:79], a[0:15]
    ds_read2_b32 a[32:33], v14 offset0:16 offset1:17
    ds_read2_b32 a[34:35], v14 offset0:18 offset1:19
    ds_read_b128 a[64:67], v11 offset:4992
    s_waitcnt lgkmcnt(10)
    v_mfma_f32_32x32x16_bf16 a[16:31], a[44:47], a[80:83], a[16:31]
    ds_read2_b32 a[36:37], v14 offset0:24 offset1:25
    ds_read2_b32 a[38:39], v14 offset0:26 offset1:27
    s_waitcnt lgkmcnt(11)
    v_mfma_f32_32x32x16_bf16 a[0:15], a[44:47], a[84:87], a[0:15]
    ds_read_b128 a[68:71], v11 offset:4960
    ds_read2_b32 a[40:41], v14 offset0:32 offset1:33
    ds_read2_b32 a[42:43], v14 offset0:34 offset1:35
    s_waitcnt lgkmcnt(11)
    v_mfma_f32_32x32x16_bf16 a[16:31], a[48:51], a[56:59], a[16:31]
    ds_read_b128 a[72:75], v11 offset:4912
    ds_read2_b32 a[44:45], v14 offset0:40 offset1:41
    ds_read2_b32 a[46:47], v14 offset0:42 offset1:43
    s_waitcnt lgkmcnt(11)
    v_mfma_f32_32x32x16_bf16 a[16:31], a[52:55], a[60:63], a[16:31]
    ds_read_b128 a[76:79], v11 offset:4880
    ds_read2_b32 a[48:49], v14 offset0:48 offset1:49
    ds_read2_b32 a[50:51], v14 offset0:50 offset1:51
    s_waitcnt lgkmcnt(11)
    v_mfma_f32_32x32x16_bf16 a[16:31], a[32:35], a[64:67], a[16:31]
    ds_read_b128 a[80:83], v11 offset:4832
    ds_read2_b32 a[52:53], v14 offset0:56 offset1:57
    ds_read2_b32 a[54:55], v14 offset0:58 offset1:59
    s_waitcnt lgkmcnt(11)
    v_mfma_f32_32x32x16_bf16 a[16:31], a[36:39], a[68:71], a[16:31]
    ds_read_b128 a[84:87], v11 offset:4800
    ds_read2_b32 a[32:33], v14 offset0:64 offset1:65
    ds_read2_b32 a[34:35], v14 offset0:66 offset1:67
    s_waitcnt lgkmcnt(11)
    v_mfma_f32_32x32x16_bf16 a[16:31], a[40:43], a[72:75], a[16:31]
    ds_read_b128 a[56:59], v11 offset:4752
    ds_read2_b32 a[36:37], v14 offset0:72 offset1:73
    ds_read2_b32 a[38:39], v14 offset0:74 offset1:75
    s_waitcnt lgkmcnt(11)
    v_mfma_f32_32x32x16_bf16 a[16:31], a[44:47], a[76:79], a[16:31]
    ds_read_b128 a[60:63], v11 offset:4720
    ds_read2_b32 a[40:41], v14 offset0:80 offset1:81
    ds_read2_b32 a[42:43], v14 offset0:82 offset1:83
    s_waitcnt lgkmcnt(11)
    v_mfma_f32_32x32x16_bf16 a[16:31], a[48:51], a[80:83], a[16:31]
    ds_read_b128 a[64:67], v11 offset:4672
    ds_read2_b32 a[44:45], v14 offset0:88 offset1:89
    ds_read2_b32 a[46:47], v14 offset0:90 offset1:91
    s_waitcnt lgkmcnt(11)
    v_mfma_f32_32x32x16_bf16 a[16:31], a[52:55], a[84:87], a[16:31]
    ds_read_b128 a[68:71], v11 offset:4640
    ds_read2_b32 a[48:49], v14 offset0:96 offset1:97
    ds_read2_b32 a[50:51], v14 offset0:98 offset1:99
    s_waitcnt lgkmcnt(11)
    v_mfma_f32_32x32x16_bf16 a[16:31], a[32:35], a[56:59], a[16:31]
    ds_read_b128 a[72:75], v11 offset:4592
    ds_read2_b32 a[52:53], v14 offset0:104 offset1:105
    ds_read2_b32 a[54:55], v14 offset0:106 offset1:107
    s_waitcnt lgkmcnt(11)
    v_mfma_f32_32x32x16_bf16 a[16:31], a[36:39], a[60:63], a[16:31]
    ds_read_b128 a[76:79], v11 offset:4560
    ds_read2_b32 a[32:33], v14 offset0:112 offset1:113
    ds_read2_b32 a[34:35], v14 offset0:114 offset1:115
    s_waitcnt lgkmcnt(11)
    v_mfma_f32_32x32x16_bf16 a[16:31], a[40:43], a[64:67], a[16:31]
    ds_read_b128 a[80:83], v11 offset:4512
    ds_read2_b32 a[36:37], v14 offset0:120 offset1:121
    ds_read2_b32 a[38:39], v14 offset0:122 offset1:123
    s_waitcnt lgkmcnt(11)
    v_mfma_f32_32x32x16_bf16 a[16:31], a[44:47], a[68:71], a[16:31]
    ds_read_b128 a[84:87], v11 offset:4480
    ds_read2_b32 a[40:41], v14 offset0:128 offset1:129
    ds_read2_b32 a[42:43], v14 offset0:130 offset1:131
    s_waitcnt lgkmcnt(11)
    v_mfma_f32_32x32x16_bf16 a[16:31], a[48:51], a[72:75], a[16:31]
    ds_read_b128 a[56:59], v11 offset:4432
    ds_read2_b32 a[44:45], v14 offset0:136 offset1:137
    ds_read2_b32 a[46:47], v14 offset0:138 offset1:139
    s_waitcnt lgkmcnt(11)
    v_mfma_f32_32x32x16_bf16 a[16:31], a[52:55], a[76:79], a[16:31]
    ds_read_b128 a[60:63], v11 offset:4400
    ds_read2_b32 a[48:49], v14 offset0:144 offset1:145
    ds_read2_b32 a[50:51], v14 offset0:146 offset1:147
    s_waitcnt lgkmcnt(11)
    v_mfma_f32_32x32x16_bf16 a[16:31], a[32:35], a[80:83], a[16:31]
    ds_read_b128 a[64:67], v11 offset:4352
    ds_read2_b32 a[52:53], v14 offset0:152 offset1:153
    ds_read2_b32 a[54:55], v14 offset0:154 offset1:155
    s_waitcnt lgkmcnt(11)
    v_mfma_f32_32x32x16_bf16 a[16:31], a[36:39], a[84:87], a[16:31]
    ds_read_b128 a[68:71], v11 offset:4320
    ds_read2_b32 a[32:33], v14 offset0:160 offset1:161
    ds_read2_b32 a[34:35], v14 offset0:162 offset1:163
    s_waitcnt lgkmcnt(11)
    v_mfma_f32_32x32x16_bf16 a[16:31], a[40:43], a[56:59], a[16:31]
    ds_read_b128 a[72:75], v11 offset:4272
    ds_read2_b32 a[36:37], v14 offset0:168 offset1:169
    ds_read2_b32 a[38:39], v14 offset0:170 offset1:171
    s_waitcnt lgkmcnt(11)
    v_mfma_f32_32x32x16_bf16 a[16:31], a[44:47], a[60:63], a[16:31]
    ds_read_b128 a[76:79], v11 offset:4240
    ds_read2_b32 a[40:41], v14 offset0:176 offset1:177
    ds_read2_b32 a[42:43], v14 offset0:178 offset1:179
    s_waitcnt lgkmcnt(11)
    v_mfma_f32_32x32x16_bf16 a[16:31], a[48:51], a[64:67], a[16:31]
    ds_read_b128 a[80:83], v11 offset:4192
    ds_read2_b32 a[44:45], v14 offset0:184 offset1:185
    ds_read2_b32 a[46:47], v14 offset0:186 offset1:187
    s_waitcnt lgkmcnt(11)
    v_mfma_f32_32x32x16_bf16 a[16:31], a[52:55], a[68:71], a[16:31]
    ds_read_b128 a[84:87], v11 offset:4160
    ds_read2_b32 a[48:49], v14 offset0:192 offset1:193
    ds_read2_b32 a[50:51], v14 offset0:194 offset1:195
    s_waitcnt lgkmcnt(11)
    v_mfma_f32_32x32x16_bf16 a[16:31], a[32:35], a[72:75], a[16:31]
    ds_read_b128 a[56:59], v11 offset:4112
    ds_read2_b32 a[52:53], v14 offset0:200 offset1:201
    ds_read2_b32 a[54:55], v14 offset0:202 offset1:203
    s_waitcnt lgkmcnt(11)
    v_mfma_f32_32x32x16_bf16 a[16:31], a[36:39], a[76:79], a[16:31]
    ds_read_b128 a[60:63], v11 offset:4080
    ds_read2_b32 a[32:33], v14 offset0:208 offset1:209
    ds_read2_b32 a[34:35], v14 offset0:210 offset1:211
    s_waitcnt lgkmcnt(11)
    v_mfma_f32_32x32x16_bf16 a[16:31], a[40:43], a[80:83], a[16:31]
    ds_read_b128 a[64:67], v11 offset:4032
    ds_read2_b32 a[36:37], v14 offset0:216 offset1:217
    ds_read2_b32 a[38:39], v14 offset0:218 offset1:219
    s_waitcnt lgkmcnt(11)
    v_mfma_f32_32x32x16_bf16 a[16:31], a[44:47], a[84:87], a[16:31]
    ds_read_b128 a[68:71], v11 offset:4000
    ds_read2_b32 a[40:41], v14 offset0:224 offset1:225
    ds_read2_b32 a[42:43], v14 offset0:226 offset1:227
    s_waitcnt lgkmcnt(11)
    v_mfma_f32_32x32x16_bf16 a[16:31], a[48:51], a[56:59], a[16:31]
    ds_read_b128 a[72:75], v11 offset:3952
    ds_read2_b32 a[44:45], v14 offset0:232 offset1:233
    ds_read2_b32 a[46:47], v14 offset0:234 offset1:235
    s_waitcnt lgkmcnt(11)
    v_mfma_f32_32x32x16_bf16 a[16:31], a[52:55], a[60:63], a[16:31]
    ds_read_b128 a[76:79], v11 offset:3920
    ds_read2_b32 a[48:49], v14 offset0:240 offset1:241
    ds_read2_b32 a[50:51], v14 offset0:242 offset1:243
    s_waitcnt lgkmcnt(11)
    v_mfma_f32_32x32x16_bf16 a[16:31], a[32:35], a[64:67], a[16:31]
    ds_read_b128 a[80:83], v11 offset:3872
    ds_read2_b32 a[52:53], v14 offset0:248 offset1:249
    ds_read2_b32 a[54:55], v14 offset0:250 offset1:251
    v_add_u32 v14, 1024, v14
    s_waitcnt lgkmcnt(11)
    v_mfma_f32_32x32x16_bf16 a[16:31], a[36:39], a[68:71], a[16:31]
    ds_read_b128 a[84:87], v11 offset:3840
    ds_read2_b32 a[32:33], v14 offset0:0 offset1:1
    ds_read2_b32 a[34:35], v14 offset0:2 offset1:3
    s_waitcnt lgkmcnt(11)
    v_mfma_f32_32x32x16_bf16 a[16:31], a[40:43], a[72:75], a[16:31]
    ds_read_b128 a[56:59], v11 offset:3792
    ds_read2_b32 a[36:37], v14 offset0:8 offset1:9
    ds_read2_b32 a[38:39], v14 offset0:10 offset1:11
    s_waitcnt lgkmcnt(11)
    v_mfma_f32_32x32x16_bf16 a[16:31], a[44:47], a[76:79], a[16:31]
    ds_read_b128 a[60:63], v11 offset:3760
    ds_read2_b32 a[40:41], v14 offset0:16 offset1:17
    ds_read2_b32 a[42:43], v14 offset0:18 offset1:19
    s_waitcnt lgkmcnt(11)
    v_mfma_f32_32x32x16_bf16 a[16:31], a[48:51], a[80:83], a[16:31]
    ds_read_b128 a[64:67], v11 offset:3712
    ds_read2_b32 a[44:45], v14 offset0:24 offset1:25
    ds_read2_b32 a[46:47], v14 offset0:26 offset1:27
    s_waitcnt lgkmcnt(11)
    v_mfma_f32_32x32x16_bf16 a[16:31], a[52:55], a[84:87], a[16:31]
    ds_read_b128 a[68:71], v11 offset:3680
    ds_read2_b32 a[48:49], v14 offset0:32 offset1:33
    ds_read2_b32 a[50:51], v14 offset0:34 offset1:35
    s_waitcnt lgkmcnt(11)
    v_mfma_f32_32x32x16_bf16 a[16:31], a[32:35], a[56:59], a[16:31]
    ds_read_b128 a[72:75], v11 offset:3632
    ds_read2_b32 a[52:53], v14 offset0:40 offset1:41
    ds_read2_b32 a[54:55], v14 offset0:42 offset1:43
    s_waitcnt lgkmcnt(11)
    v_mfma_f32_32x32x16_bf16 a[16:31], a[36:39], a[60:63], a[16:31]
    ds_read_b128 a[76:79], v11 offset:3600
    ds_read2_b32 a[32:33], v14 offset0:48 offset1:49
    ds_read2_b32 a[34:35], v14 offset0:50 offset1:51
    s_waitcnt lgkmcnt(11)
    v_mfma_f32_32x32x16_bf16 a[16:31], a[40:43], a[64:67], a[16:31]
    ds_read_b128 a[80:83], v11 offset:3552
    ds_read2_b32 a[36:37], v14 offset0:56 offset1:57
    ds_read2_b32 a[38:39], v14 offset0:58 offset1:59
    s_waitcnt lgkmcnt(11)
    v_mfma_f32_32x32x16_bf16 a[16:31], a[44:47], a[68:71], a[16:31]
    ds_read_b128 a[84:87], v11 offset:3520
    ds_read2_b32 a[40:41], v14 offset0:64 offset1:65
    ds_read2_b32 a[42:43], v14 offset0:66 offset1:67
    s_waitcnt lgkmcnt(11)
    v_mfma_f32_32x32x16_bf16 a[16:31], a[48:51], a[72:75], a[16:31]
    ds_read_b128 a[56:59], v11 offset:3472
    ds_read2_b32 a[44:45], v14 offset0:72 offset1:73
    ds_read2_b32 a[46:47], v14 offset0:74 offset1:75
    s_waitcnt lgkmcnt(11)
    v_mfma_f32_32x32x16_bf16 a[16:31], a[52:55], a[76:79], a[16:31]
    ds_read_b128 a[60:63], v11 offset:3440
    ds_read2_b32 a[48:49], v14 offset0:80 offset1:81
    ds_read2_b32 a[50:51], v14 offset0:82 offset1:83
    s_waitcnt lgkmcnt(11)
    v_mfma_f32_32x32x16_bf16 a[16:31], a[32:35], a[80:83], a[16:31]
    ds_read_b128 a[64:67], v11 offset:3392
    ds_read2_b32 a[52:53], v14 offset0:88 offset1:89
    ds_read2_b32 a[54:55], v14 offset0:90 offset1:91
    s_waitcnt lgkmcnt(11)
    v_mfma_f32_32x32x16_bf16 a[16:31], a[36:39], a[84:87], a[16:31]
    ds_read_b128 a[68:71], v11 offset:3360
    ds_read2_b32 a[32:33], v14 offset0:96 offset1:97
    ds_read2_b32 a[34:35], v14 offset0:98 offset1:99
    s_waitcnt lgkmcnt(11)
    v_mfma_f32_32x32x16_bf16 a[16:31], a[40:43], a[56:59], a[16:31]
    ds_read_b128 a[72:75], v11 offset:3312
    ds_read2_b32 a[36:37], v14 offset0:104 offset1:105
    ds_read2_b32 a[38:39], v14 offset0:106 offset1:107
    s_waitcnt lgkmcnt(11)
    v_mfma_f32_32x32x16_bf16 a[16:31], a[44:47], a[60:63], a[16:31]
    ds_read_b128 a[76:79], v11 offset:3280
    ds_read2_b32 a[40:41], v14 offset0:112 offset1:113
    ds_read2_b32 a[42:43], v14 offset0:114 offset1:115
    s_waitcnt lgkmcnt(11)
    v_mfma_f32_32x32x16_bf16 a[16:31], a[48:51], a[64:67], a[16:31]
    ds_read_b128 a[80:83], v11 offset:3232
    ds_read2_b32 a[44:45], v14 offset0:120 offset1:121
    ds_read2_b32 a[46:47], v14 offset0:122 offset1:123
    s_waitcnt lgkmcnt(11)
    v_mfma_f32_32x32x16_bf16 a[16:31], a[52:55], a[68:71], a[16:31]
    ds_read_b128 a[84:87], v11 offset:3200
    ds_read2_b32 a[48:49], v14 offset0:128 offset1:129
    ds_read2_b32 a[50:51], v14 offset0:130 offset1:131
    s_waitcnt lgkmcnt(11)
    v_mfma_f32_32x32x16_bf16 a[16:31], a[32:35], a[72:75], a[16:31]
    ds_read_b128 a[56:59], v11 offset:3152
    ds_read2_b32 a[52:53], v14 offset0:136 offset1:137
    ds_read2_b32 a[54:55], v14 offset0:138 offset1:139
    s_waitcnt lgkmcnt(11)
    v_mfma_f32_32x32x16_bf16 a[16:31], a[36:39], a[76:79], a[16:31]
    ds_read_b128 a[60:63], v11 offset:3120
    ds_read2_b32 a[32:33], v14 offset0:144 offset1:145
    ds_read2_b32 a[34:35], v14 offset0:146 offset1:147
    s_waitcnt lgkmcnt(11)
    v_mfma_f32_32x32x16_bf16 a[16:31], a[40:43], a[80:83], a[16:31]
    ds_read_b128 a[64:67], v11 offset:3072
    ds_read2_b32 a[36:37], v14 offset0:152 offset1:153
    ds_read2_b32 a[38:39], v14 offset0:154 offset1:155
    s_waitcnt lgkmcnt(11)
    v_mfma_f32_32x32x16_bf16 a[16:31], a[44:47], a[84:87], a[16:31]
    ds_read_b128 a[68:71], v11 offset:3040
    ds_read2_b32 a[40:41], v14 offset0:160 offset1:161
    ds_read2_b32 a[42:43], v14 offset0:162 offset1:163
    s_waitcnt lgkmcnt(11)
    v_mfma_f32_32x32x16_bf16 a[16:31], a[48:51], a[56:59], a[16:31]
    ds_read_b128 a[72:75], v11 offset:2992
    ds_read2_b32 a[44:45], v14 offset0:168 offset1:169
    ds_read2_b32 a[46:47], v14 offset0:170 offset1:171
    s_waitcnt lgkmcnt(11)
    v_mfma_f32_32x32x16_bf16 a[16:31], a[52:55], a[60:63], a[16:31]
    ds_read_b128 a[76:79], v11 offset:2960
    ds_read2_b32 a[48:49], v14 offset0:176 offset1:177
    ds_read2_b32 a[50:51], v14 offset0:178 offset1:179
    s_waitcnt lgkmcnt(11)
    v_mfma_f32_32x32x16_bf16 a[16:31], a[32:35], a[64:67], a[16:31]
    ds_read_b128 a[80:83], v11 offset:2912
    ds_read2_b32 a[52:53], v14 offset0:184 offset1:185
    ds_read2_b32 a[54:55], v14 offset0:186 offset1:187
    s_waitcnt lgkmcnt(11)
    v_mfma_f32_32x32x16_bf16 a[16:31], a[36:39], a[68:71], a[16:31]
    ds_read_b128 a[84:87], v11 offset:2880
    ds_read2_b32 a[32:33], v14 offset0:192 offset1:193
    ds_read2_b32 a[34:35], v14 offset0:194 offset1:195
    s_waitcnt lgkmcnt(11)
    v_mfma_f32_32x32x16_bf16 a[16:31], a[40:43], a[72:75], a[16:31]
    ds_read_b128 a[56:59], v11 offset:2832
    ds_read2_b32 a[36:37], v14 offset0:200 offset1:201
    ds_read2_b32 a[38:39], v14 offset0:202 offset1:203
    s_waitcnt lgkmcnt(11)
    v_mfma_f32_32x32x16_bf16 a[16:31], a[44:47], a[76:79], a[16:31]
    ds_read_b128 a[60:63], v11 offset:2800
    ds_read2_b32 a[40:41], v14 offset0:208 offset1:209
    ds_read2_b32 a[42:43], v14 offset0:210 offset1:211
    s_waitcnt lgkmcnt(11)
    v_mfma_f32_32x32x16_bf16 a[16:31], a[48:51], a[80:83], a[16:31]
    ds_read_b128 a[64:67], v11 offset:2752
    ds_read2_b32 a[44:45], v14 offset0:216 offset1:217
    ds_read2_b32 a[46:47], v14 offset0:218 offset1:219
    s_waitcnt lgkmcnt(11)
    v_mfma_f32_32x32x16_bf16 a[16:31], a[52:55], a[84:87], a[16:31]
    ds_read_b128 a[68:71], v11 offset:2720
    ds_read2_b32 a[48:49], v14 offset0:224 offset1:225
    ds_read2_b32 a[50:51], v14 offset0:226 offset1:227
    s_waitcnt lgkmcnt(11)
    v_mfma_f32_32x32x16_bf16 a[16:31], a[32:35], a[56:59], a[16:31]
    ds_read_b128 a[72:75], v11 offset:2672
    ds_read2_b32 a[52:53], v14 offset0:232 offset1:233
    ds_read2_b32 a[54:55], v14 offset0:234 offset1:235
    s_waitcnt lgkmcnt(11)
    v_mfma_f32_32x32x16_bf16 a[16:31], a[36:39], a[60:63], a[16:31]
    ds_read_b128 a[76:79], v11 offset:2640
    ds_read2_b32 a[32:33], v14 offset0:240 offset1:241
    ds_read2_b32 a[34:35], v14 offset0:242 offset1:243
    s_waitcnt lgkmcnt(11)
    v_mfma_f32_32x32x16_bf16 a[16:31], a[40:43], a[64:67], a[16:31]
    ds_read_b128 a[80:83], v11 offset:2592
    ds_read2_b32 a[36:37], v14 offset0:248 offset1:249
    ds_read2_b32 a[38:39], v14 offset0:250 offset1:251
    v_add_u32 v14, 1024, v14
    s_waitcnt lgkmcnt(11)
    v_mfma_f32_32x32x16_bf16 a[16:31], a[44:47], a[68:71], a[16:31]
    ds_read_b128 a[84:87], v11 offset:2560
    s_waitcnt lgkmcnt(9)
    v_mfma_f32_32x32x16_bf16 a[16:31], a[48:51], a[72:75], a[16:31]
    s_waitcnt lgkmcnt(6)
    v_mfma_f32_32x32x16_bf16 a[16:31], a[52:55], a[76:79], a[16:31]
    s_waitcnt lgkmcnt(3)
    v_mfma_f32_32x32x16_bf16 a[16:31], a[32:35], a[80:83], a[16:31]
    s_waitcnt lgkmcnt(0)
    v_mfma_f32_32x32x16_bf16 a[16:31], a[36:39], a[84:87], a[16:31]
    v_accvgpr_read_b32 v220, a0
    v_accvgpr_read_b32 v221, a1
    v_accvgpr_read_b32 v222, a2
    v_accvgpr_read_b32 v223, a3
    v_accvgpr_read_b32 v224, a4
    v_accvgpr_read_b32 v225, a5
    v_accvgpr_read_b32 v226, a6
    v_accvgpr_read_b32 v227, a7
    v_accvgpr_read_b32 v228, a8
    v_accvgpr_read_b32 v229, a9
    v_accvgpr_read_b32 v230, a10
    v_accvgpr_read_b32 v231, a11
    v_accvgpr_read_b32 v232, a12
    v_accvgpr_read_b32 v233, a13
    v_accvgpr_read_b32 v234, a14
    v_accvgpr_read_b32 v235, a15
    v_cvt_pk_bf16_f32 v236, v220, v221
    v_cvt_pk_bf16_f32 v237, v222, v223
    v_cvt_pk_bf16_f32 v238, v224, v225
    v_cvt_pk_bf16_f32 v239, v226, v227
    v_cvt_pk_bf16_f32 v240, v228, v229
    v_cvt_pk_bf16_f32 v241, v230, v231
    v_cvt_pk_bf16_f32 v242, v232, v233
    v_cvt_pk_bf16_f32 v243, v234, v235
    s_nop 0
    v_permlane32_swap_b32 v236, v238
    v_permlane32_swap_b32 v237, v239
    v_permlane32_swap_b32 v240, v242
    v_permlane32_swap_b32 v241, v243
    buffer_store_dwordx4 v[236:239], v2, s[8:11], s7 offen offset:0 sc1
    buffer_store_dwordx4 v[240:243], v2, s[8:11], s7 offen offset:1024 sc1
    v_accvgpr_read_b32 v220, a16
    v_accvgpr_read_b32 v221, a17
    v_accvgpr_read_b32 v222, a18
    v_accvgpr_read_b32 v223, a19
    v_accvgpr_read_b32 v224, a20
    v_accvgpr_read_b32 v225, a21
    v_accvgpr_read_b32 v226, a22
    v_accvgpr_read_b32 v227, a23
    v_accvgpr_read_b32 v228, a24
    v_accvgpr_read_b32 v229, a25
    v_accvgpr_read_b32 v230, a26
    v_accvgpr_read_b32 v231, a27
    v_accvgpr_read_b32 v232, a28
    v_accvgpr_read_b32 v233, a29
    v_accvgpr_read_b32 v234, a30
    v_accvgpr_read_b32 v235, a31
    v_cvt_pk_bf16_f32 v236, v220, v221
    v_cvt_pk_bf16_f32 v237, v222, v223
    v_cvt_pk_bf16_f32 v238, v224, v225
    v_cvt_pk_bf16_f32 v239, v226, v227
    v_cvt_pk_bf16_f32 v240, v228, v229
    v_cvt_pk_bf16_f32 v241, v230, v231
    v_cvt_pk_bf16_f32 v242, v232, v233
    v_cvt_pk_bf16_f32 v243, v234, v235
    s_nop 0
    v_permlane32_swap_b32 v236, v238
    v_permlane32_swap_b32 v237, v239
    v_permlane32_swap_b32 v240, v242
    v_permlane32_swap_b32 v241, v243
    buffer_store_dwordx4 v[236:239], v2, s[8:11], s7 offen offset:2048 sc1
    buffer_store_dwordx4 v[240:243], v2, s[8:11], s7 offen offset:3072 sc1
    v_add_u32 v11, 30720, v11
    s_add_u32 s64, s64, 1
    s_cmp_lt_u32 s64, 4
    s_waitcnt vmcnt(4)
    s_cbranch_scc1 .chan_297
    s_waitcnt vmcnt(0)
    s_barrier
    s_cmp_lg_u32 s24, 0
    s_cbranch_scc1 .sg_302
    s_mov_b64 exec, 1
    v_mov_b32 v4, 1
    v_mov_b32 v5, 0
    buffer_atomic_add v4, v5, s[20:23], 0 offen offset:192 sc1
    s_mov_b64 exec, -1
.sg_302:
    s_cmp_eq_u32 s98, 3
    s_cbranch_scc1 .ph2_293
.qkv_294:
    s_lshl_b32 s4, s98, 3
    s_add_u32 s4, s4, 64
    s_load_dwordx2 s[40:41], s[0:1], 0
    s_load_dwordx2 s[42:43], s[0:1], s4
    s_lshl_b32 s4, s99, 8
    s_lshl_b32 s6, s24, 14
    s_mul_i32 s5, s24, 524288
    s_add_u32 s4, s4, s5
    v_bfe_u32 v2, v1, 4, 1
    v_lshlrev_b32 v2, 2, v2
    v_and_b32 v3, 7, v1
    v_xor_b32 v2, v2, v3
    v_lshlrev_b32 v2, 4, v2
    v_bfe_u32 v254, v1, 3, 2
    v_mul_u32_u24 v240, 8192, v254
    v_bfe_u32 v254, v1, 5, 1
    v_mul_u32_u24 v254, 128, v254
    v_add_u32 v240, v240, v254
    v_add_u32 v240, s4, v240
    v_add_u32 v240, v2, v240
    s_lshr_b32 s5, s24, 1
    s_lshl_b32 s5, s5, 9
    v_bfe_u32 v2, v1, 3, 1
    v_xor_b32 v2, s24, v2
    v_and_b32 v2, 1, v2
    v_lshlrev_b32 v2, 6, v2
    v_bfe_u32 v254, v1, 4, 2
    v_mul_u32_u24 v242, 2048, v254
    v_bfe_u32 v254, v1, 2, 2
    v_mul_u32_u24 v254, 128, v254
    v_add_u32 v242, v242, v254
    v_bfe_u32 v254, v1, 0, 2
    v_mul_u32_u24 v254, 16, v254
    v_add_u32 v242, v242, v254
    v_add_u32 v242, s5, v242
    v_add_u32 v242, v2, v242
    v_add_u32 v243, 0x10000, v242
    s_waitcnt lgkmcnt(0)
    s_mov_b32 s12, s40
    s_and_b32 s13, s41, 0xffff
    s_mov_b32 s14, 0x400000
    s_mov_b32 s15, 0x00020000
    s_mov_b32 s16, s42
    s_and_b32 s17, s43, 0xffff
    s_mov_b32 s18, 0x800000
    s_mov_b32 s19, 0x00020000
    s_add_u32 m0, s6, 0
    s_mov_b32 s5, 0
    buffer_load_dwordx4 v240, s[16:19], s5 offen nt lds
    s_add_u32 m0, s6, 1024
    s_mov_b32 s5, 32768
    buffer_load_dwordx4 v240, s[16:19], s5 offen nt lds
    s_add_u32 m0, s6, 2048
    s_mov_b32 s5, 65536
    buffer_load_dwordx4 v240, s[16:19], s5 offen nt lds
    s_add_u32 m0, s6, 3072
    s_mov_b32 s5, 98304
    buffer_load_dwordx4 v240, s[16:19], s5 offen nt lds
    s_add_u32 m0, s6, 4096
    s_mov_b32 s5, 131072
    buffer_load_dwordx4 v240, s[16:19], s5 offen nt lds
    s_add_u32 m0, s6, 5120
    s_mov_b32 s5, 163840
    buffer_load_dwordx4 v240, s[16:19], s5 offen nt lds
    s_add_u32 m0, s6, 6144
    s_mov_b32 s5, 196608
    buffer_load_dwordx4 v240, s[16:19], s5 offen nt lds
    s_add_u32 m0, s6, 7168
    s_mov_b32 s5, 229376
    buffer_load_dwordx4 v240, s[16:19], s5 offen nt lds
    s_add_u32 m0, s6, 8192
    s_mov_b32 s5, 262144
    buffer_load_dwordx4 v240, s[16:19], s5 offen nt lds
    s_add_u32 m0, s6, 9216
    s_mov_b32 s5, 294912
    buffer_load_dwordx4 v240, s[16:19], s5 offen nt lds
    s_add_u32 m0, s6, 10240
    s_mov_b32 s5, 327680
    buffer_load_dwordx4 v240, s[16:19], s5 offen nt lds
    s_add_u32 m0, s6, 11264
    s_mov_b32 s5, 360448
    buffer_load_dwordx4 v240, s[16:19], s5 offen nt lds
    s_add_u32 m0, s6, 12288
    s_mov_b32 s5, 393216
    buffer_load_dwordx4 v240, s[16:19], s5 offen nt lds
    s_add_u32 m0, s6, 13312
    s_mov_b32 s5, 425984
    buffer_load_dwordx4 v240, s[16:19], s5 offen nt lds
    s_add_u32 m0, s6, 14336
    s_mov_b32 s5, 458752
    buffer_load_dwordx4 v240, s[16:19], s5 offen nt lds
    s_add_u32 m0, s6, 15360
    s_mov_b32 s5, 491520
    buffer_load_dwordx4 v240, s[16:19], s5 offen nt lds
    s_waitcnt vmcnt(16)
    s_barrier
    s_cmp_lg_u32 s24, 1
    s_cbranch_scc1 .ns_303
    s_mov_b64 exec, 1
    v_mov_b32 v238, s3
    v_mov_b32 v239, 0
    buffer_atomic_add v238, v239, s[20:23], 0 offen offset:196 sc1
    s_mov_b64 exec, -1
.ns_303:
    s_add_u32 m0, s6, 65536
    s_mov_b32 s5, 2097152
    buffer_load_dwordx4 v240, s[16:19], s5 offen nt lds
    s_add_u32 m0, s6, 66560
    s_mov_b32 s5, 2129920
    buffer_load_dwordx4 v240, s[16:19], s5 offen nt lds
    s_add_u32 m0, s6, 67584
    s_mov_b32 s5, 2162688
    buffer_load_dwordx4 v240, s[16:19], s5 offen nt lds
    s_add_u32 m0, s6, 68608
    s_mov_b32 s5, 2195456
    buffer_load_dwordx4 v240, s[16:19], s5 offen nt lds
    s_add_u32 m0, s6, 69632
    s_mov_b32 s5, 2228224
    buffer_load_dwordx4 v240, s[16:19], s5 offen nt lds
    s_add_u32 m0, s6, 70656
    s_mov_b32 s5, 2260992
    buffer_load_dwordx4 v240, s[16:19], s5 offen nt lds
    s_add_u32 m0, s6, 71680
    s_mov_b32 s5, 2293760
    buffer_load_dwordx4 v240, s[16:19], s5 offen nt lds
    s_add_u32 m0, s6, 72704
    s_mov_b32 s5, 2326528
    buffer_load_dwordx4 v240, s[16:19], s5 offen nt lds
    s_add_u32 m0, s6, 73728
    s_mov_b32 s5, 2359296
    buffer_load_dwordx4 v240, s[16:19], s5 offen nt lds
    s_add_u32 m0, s6, 74752
    s_mov_b32 s5, 2392064
    buffer_load_dwordx4 v240, s[16:19], s5 offen nt lds
    s_add_u32 m0, s6, 75776
    s_mov_b32 s5, 2424832
    buffer_load_dwordx4 v240, s[16:19], s5 offen nt lds
    s_add_u32 m0, s6, 76800
    s_mov_b32 s5, 2457600
    buffer_load_dwordx4 v240, s[16:19], s5 offen nt lds
    s_add_u32 m0, s6, 77824
    s_mov_b32 s5, 2490368
    buffer_load_dwordx4 v240, s[16:19], s5 offen nt lds
    s_add_u32 m0, s6, 78848
    s_mov_b32 s5, 2523136
    buffer_load_dwordx4 v240, s[16:19], s5 offen nt lds
    s_add_u32 m0, s6, 79872
    s_mov_b32 s5, 2555904
    buffer_load_dwordx4 v240, s[16:19], s5 offen nt lds
    s_add_u32 m0, s6, 80896
    s_mov_b32 s5, 2588672
    buffer_load_dwordx4 v240, s[16:19], s5 offen nt lds
    v_and_b32 v2, 15, v1
    v_lshrrev_b32 v3, 4, v1
    v_lshlrev_b32 v4, 11, v2
    v_add_u32 v5, 0, v3
    v_xor_b32 v5, v5, v2
    v_lshl_add_u32 v8, v5, 4, v4
    v_add_u32 v12, 0x10000, v8
    v_add_u32 v5, 4, v3
    v_xor_b32 v5, v5, v2
    v_lshl_add_u32 v9, v5, 4, v4
    v_add_u32 v13, 0x10000, v9
    v_add_u32 v5, 8, v3
    v_xor_b32 v5, v5, v2
    v_lshl_add_u32 v10, v5, 4, v4
    v_add_u32 v14, 0x10000, v10
    v_add_u32 v5, 12, v3
    v_xor_b32 v5, v5, v2
    v_lshl_add_u32 v11, v5, 4, v4
    v_add_u32 v15, 0x10000, v11
    s_lshl_b32 s4, s24, 3
    s_and_b32 s4, s4, 8
    s_add_u32 s5, s4, 0
    v_xor_b32 v5, s5, v1
    s_add_u32 s5, s6, 0
    v_lshlrev_b32 v5, 4, v5
    v_add_u32 v16, s5, v5
    s_add_u32 s5, s4, 1
    v_xor_b32 v5, s5, v1
    s_add_u32 s5, s6, 0
    v_lshlrev_b32 v5, 4, v5
    v_add_u32 v17, s5, v5
    s_add_u32 s5, s4, 2
    v_xor_b32 v5, s5, v1
    s_add_u32 s5, s6, 4096
    v_lshlrev_b32 v5, 4, v5
    v_add_u32 v18, s5, v5
    s_add_u32 s5, s4, 3
    v_xor_b32 v5, s5, v1
    s_add_u32 s5, s6, 4096
    v_lshlrev_b32 v5, 4, v5
    v_add_u32 v19, s5, v5
    s_add_u32 s5, s4, 4
    v_xor_b32 v5, s5, v1
    s_add_u32 s5, s6, 8192
    v_lshlrev_b32 v5, 4, v5
    v_add_u32 v20, s5, v5
    s_add_u32 s5, s4, 5
    v_xor_b32 v5, s5, v1
    s_add_u32 s5, s6, 8192
    v_lshlrev_b32 v5, 4, v5
    v_add_u32 v21, s5, v5
    s_add_u32 s5, s4, 6
    v_xor_b32 v5, s5, v1
    s_add_u32 s5, s6, 12288
    v_lshlrev_b32 v5, 4, v5
    v_add_u32 v22, s5, v5
    s_add_u32 s5, s4, 7
    v_xor_b32 v5, s5, v1
    s_add_u32 s5, s6, 12288
    v_lshlrev_b32 v5, 4, v5
    v_add_u32 v23, s5, v5
    s_cmp_eq_u32 s98, 2
    s_cselect_b32 s4, 11, 10
    s_cselect_b32 s5, 1, 4
    s_lshl_b32 s5, s5, 10
    s_lshl_b32 s4, s24, s4
    v_lshlrev_b32 v24, 4, v1
    v_add_u32 v24, s4, v24
    v_add_u32 v25, s5, v24
    v_mov_b32 v26, 0
    s_and_b32 s4, s99, 7
    s_lshl_b32 s4, s4, 13
    s_lshl_b32 s5, s24, 11
    s_add_u32 s4, s4, s5
    s_add_u32 s4, s4, 196608
    v_lshlrev_b32 v28, 5, v1
    v_add_u32 v28, s4, v28
    s_lshl_b32 s31, s98, 24
    s_lshl_b32 s4, s99, 13
    s_add_u32 s31, s31, s4
    s_mov_b32 s30, 75497472
    s_mov_b32 s28, 0
    s_mov_b32 s29, 0
    s_waitcnt vmcnt(16)
    s_barrier
    ds_read_b64_tr_b16 a[0:1], v242 offset:0
    ds_read_b64_tr_b16 a[2:3], v242 offset:1024
    ds_read_b64_tr_b16 a[4:5], v242 offset:8
    ds_read_b64_tr_b16 a[6:7], v242 offset:1032
    ds_read_b64_tr_b16 a[8:9], v242 offset:8192
    ds_read_b64_tr_b16 a[10:11], v242 offset:9216
    ds_read_b64_tr_b16 a[12:13], v242 offset:8200
    ds_read_b64_tr_b16 a[14:15], v242 offset:9224
    ds_read_b64_tr_b16 a[16:17], v242 offset:16384
    ds_read_b64_tr_b16 a[18:19], v242 offset:17408
    ds_read_b64_tr_b16 a[20:21], v242 offset:16392
    ds_read_b64_tr_b16 a[22:23], v242 offset:17416
    ds_read_b64_tr_b16 a[24:25], v242 offset:24576
    ds_read_b64_tr_b16 a[26:27], v242 offset:25600
    ds_read_b64_tr_b16 a[28:29], v242 offset:24584
    ds_read_b64_tr_b16 a[30:31], v242 offset:25608
    ds_read_b64_tr_b16 a[32:33], v242 offset:32768
    ds_read_b64_tr_b16 a[34:35], v242 offset:33792
    ds_read_b64_tr_b16 a[36:37], v242 offset:32776
    ds_read_b64_tr_b16 a[38:39], v242 offset:33800
    ds_read_b64_tr_b16 a[40:41], v242 offset:40960
    ds_read_b64_tr_b16 a[42:43], v242 offset:41984
    ds_read_b64_tr_b16 a[44:45], v242 offset:40968
    ds_read_b64_tr_b16 a[46:47], v242 offset:41992
    ds_read_b64_tr_b16 a[48:49], v242 offset:49152
    ds_read_b64_tr_b16 a[50:51], v242 offset:50176
    ds_read_b64_tr_b16 a[52:53], v242 offset:49160
    ds_read_b64_tr_b16 a[54:55], v242 offset:50184
    ds_read_b64_tr_b16 a[56:57], v242 offset:57344
    ds_read_b64_tr_b16 a[58:59], v242 offset:58368
    ds_read_b64_tr_b16 a[60:61], v242 offset:57352
    ds_read_b64_tr_b16 a[62:63], v242 offset:58376
    s_waitcnt lgkmcnt(0)
    s_barrier
    s_add_u32 m0, s6, 0
    s_mov_b32 s5, 4194304
    buffer_load_dwordx4 v240, s[16:19], s5 offen nt lds
    s_add_u32 m0, s6, 1024
    s_mov_b32 s5, 4227072
    buffer_load_dwordx4 v240, s[16:19], s5 offen nt lds
    s_add_u32 m0, s6, 2048
    s_mov_b32 s5, 4259840
    buffer_load_dwordx4 v240, s[16:19], s5 offen nt lds
    s_add_u32 m0, s6, 3072
    s_mov_b32 s5, 4292608
    buffer_load_dwordx4 v240, s[16:19], s5 offen nt lds
    s_add_u32 m0, s6, 4096
    s_mov_b32 s5, 4325376
    buffer_load_dwordx4 v240, s[16:19], s5 offen nt lds
    s_add_u32 m0, s6, 5120
    s_mov_b32 s5, 4358144
    buffer_load_dwordx4 v240, s[16:19], s5 offen nt lds
    s_add_u32 m0, s6, 6144
    s_mov_b32 s5, 4390912
    buffer_load_dwordx4 v240, s[16:19], s5 offen nt lds
    s_add_u32 m0, s6, 7168
    s_mov_b32 s5, 4423680
    buffer_load_dwordx4 v240, s[16:19], s5 offen nt lds
    s_add_u32 m0, s6, 8192
    s_mov_b32 s5, 4456448
    buffer_load_dwordx4 v240, s[16:19], s5 offen nt lds
    s_add_u32 m0, s6, 9216
    s_mov_b32 s5, 4489216
    buffer_load_dwordx4 v240, s[16:19], s5 offen nt lds
    s_add_u32 m0, s6, 10240
    s_mov_b32 s5, 4521984
    buffer_load_dwordx4 v240, s[16:19], s5 offen nt lds
    s_add_u32 m0, s6, 11264
    s_mov_b32 s5, 4554752
    buffer_load_dwordx4 v240, s[16:19], s5 offen nt lds
    s_add_u32 m0, s6, 12288
    s_mov_b32 s5, 4587520
    buffer_load_dwordx4 v240, s[16:19], s5 offen nt lds
    s_add_u32 m0, s6, 13312
    s_mov_b32 s5, 4620288
    buffer_load_dwordx4 v240, s[16:19], s5 offen nt lds
    s_add_u32 m0, s6, 14336
    s_mov_b32 s5, 4653056
    buffer_load_dwordx4 v240, s[16:19], s5 offen nt lds
    s_add_u32 m0, s6, 15360
    s_mov_b32 s5, 4685824
    buffer_load_dwordx4 v240, s[16:19], s5 offen nt lds
    s_waitcnt vmcnt(16)
    s_lshl_b32 s4, s99, 9
    s_lshl_b32 s5, s24, 7
    s_add_u32 s4, s4, s5
    s_lshl_b32 s5, s98, 14
    s_add_u32 s4, s4, s5
    s_add_u32 s94, s4, 92274688
    s_barrier
    ds_read_b64_tr_b16 a[64:65], v243 offset:0
    ds_read_b64_tr_b16 a[66:67], v243 offset:1024
    ds_read_b64_tr_b16 a[68:69], v243 offset:8
    ds_read_b64_tr_b16 a[70:71], v243 offset:1032
    ds_read_b64_tr_b16 a[72:73], v243 offset:8192
    ds_read_b64_tr_b16 a[74:75], v243 offset:9216
    ds_read_b64_tr_b16 a[76:77], v243 offset:8200
    ds_read_b64_tr_b16 a[78:79], v243 offset:9224
    ds_read_b64_tr_b16 a[80:81], v243 offset:16384
    ds_read_b64_tr_b16 a[82:83], v243 offset:17408
    ds_read_b64_tr_b16 a[84:85], v243 offset:16392
    ds_read_b64_tr_b16 a[86:87], v243 offset:17416
    ds_read_b64_tr_b16 a[88:89], v243 offset:24576
    ds_read_b64_tr_b16 a[90:91], v243 offset:25600
    ds_read_b64_tr_b16 a[92:93], v243 offset:24584
    ds_read_b64_tr_b16 a[94:95], v243 offset:25608
    ds_read_b64_tr_b16 a[96:97], v243 offset:32768
    ds_read_b64_tr_b16 a[98:99], v243 offset:33792
    ds_read_b64_tr_b16 a[100:101], v243 offset:32776
    ds_read_b64_tr_b16 a[102:103], v243 offset:33800
    ds_read_b64_tr_b16 a[104:105], v243 offset:40960
    ds_read_b64_tr_b16 a[106:107], v243 offset:41984
    ds_read_b64_tr_b16 a[108:109], v243 offset:40968
    ds_read_b64_tr_b16 a[110:111], v243 offset:41992
    ds_read_b64_tr_b16 a[112:113], v243 offset:49152
    ds_read_b64_tr_b16 a[114:115], v243 offset:50176
    ds_read_b64_tr_b16 a[116:117], v243 offset:49160
    ds_read_b64_tr_b16 a[118:119], v243 offset:50184
    ds_read_b64_tr_b16 a[120:121], v243 offset:57344
    ds_read_b64_tr_b16 a[122:123], v243 offset:58368
    ds_read_b64_tr_b16 a[124:125], v243 offset:57352
    ds_read_b64_tr_b16 a[126:127], v243 offset:58376
    s_waitcnt lgkmcnt(0)
    s_barrier
    v_or_b32 v239, 32, v1
    v_lshlrev_b32 v239, 2, v239
    buffer_load_dword v238, v239, s[20:23], 0 offen sc1
    s_add_u32 m0, s6, 65536
    s_mov_b32 s5, 6291456
    buffer_load_dwordx4 v240, s[16:19], s5 offen nt lds
    s_add_u32 m0, s6, 66560
    s_mov_b32 s5, 6324224
    buffer_load_dwordx4 v240, s[16:19], s5 offen nt lds
    s_add_u32 m0, s6, 67584
    s_mov_b32 s5, 6356992
    buffer_load_dwordx4 v240, s[16:19], s5 offen nt lds
    s_add_u32 m0, s6, 68608
    s_mov_b32 s5, 6389760
    buffer_load_dwordx4 v240, s[16:19], s5 offen nt lds
    s_add_u32 m0, s6, 69632
    s_mov_b32 s5, 6422528
    buffer_load_dwordx4 v240, s[16:19], s5 offen nt lds
    s_add_u32 m0, s6, 70656
    s_mov_b32 s5, 6455296
    buffer_load_dwordx4 v240, s[16:19], s5 offen nt lds
    s_add_u32 m0, s6, 71680
    s_mov_b32 s5, 6488064
    buffer_load_dwordx4 v240, s[16:19], s5 offen nt lds
    s_add_u32 m0, s6, 72704
    s_mov_b32 s5, 6520832
    buffer_load_dwordx4 v240, s[16:19], s5 offen nt lds
    s_add_u32 m0, s6, 73728
    s_mov_b32 s5, 6553600
    buffer_load_dwordx4 v240, s[16:19], s5 offen nt lds
    s_add_u32 m0, s6, 74752
    s_mov_b32 s5, 6586368
    buffer_load_dwordx4 v240, s[16:19], s5 offen nt lds
    s_add_u32 m0, s6, 75776
    s_mov_b32 s5, 6619136
    buffer_load_dwordx4 v240, s[16:19], s5 offen nt lds
    s_add_u32 m0, s6, 76800
    s_mov_b32 s5, 6651904
    buffer_load_dwordx4 v240, s[16:19], s5 offen nt lds
    s_add_u32 m0, s6, 77824
    s_mov_b32 s5, 6684672
    buffer_load_dwordx4 v240, s[16:19], s5 offen nt lds
    s_add_u32 m0, s6, 78848
    s_mov_b32 s5, 6717440
    buffer_load_dwordx4 v240, s[16:19], s5 offen nt lds
    s_add_u32 m0, s6, 79872
    s_mov_b32 s5, 6750208
    buffer_load_dwordx4 v240, s[16:19], s5 offen nt lds
    s_add_u32 m0, s6, 80896
    s_mov_b32 s5, 6782976
    buffer_load_dwordx4 v240, s[16:19], s5 offen nt lds
    s_waitcnt vmcnt(16)
    s_cmp_lg_u32 s27, 0
    s_cbranch_scc1 .vd_305
    s_mov_b32 s62, 0
.vp_304:
    v_readlane_b32 s4, v238, 49
    s_and_b32 s5, s4, 0xffff
    s_cmp_ge_u32 s5, 256
    s_cbranch_scc1 .va_306
    s_add_u32 s62, s62, 1
    s_cmp_gt_u32 s62, 0x100000
    s_cbranch_scc1 .mg_end_1
    s_sleep 16
    buffer_load_dword v238, v239, s[20:23], 0 offen sc1
    s_waitcnt vmcnt(0)
    s_branch .vp_304
.va_306:
    s_lshr_b32 s4, s4, 16
    s_cbranch_scc0 .vd_305
    s_lshr_b32 s25, s2, 5
    s_and_b32 s26, s2, 31
    s_mov_b32 s27, 1
    s_waitcnt vmcnt(0) lgkmcnt(0)
    s_barrier
    s_branch .mg_role_3
.vd_305:
    s_barrier
    ds_read_b64_tr_b16 a[128:129], v242 offset:0
    ds_read_b64_tr_b16 a[130:131], v242 offset:1024
    ds_read_b64_tr_b16 a[132:133], v242 offset:8
    ds_read_b64_tr_b16 a[134:135], v242 offset:1032
    ds_read_b64_tr_b16 a[136:137], v242 offset:8192
    ds_read_b64_tr_b16 a[138:139], v242 offset:9216
    ds_read_b64_tr_b16 a[140:141], v242 offset:8200
    ds_read_b64_tr_b16 a[142:143], v242 offset:9224
    ds_read_b64_tr_b16 a[144:145], v242 offset:16384
    ds_read_b64_tr_b16 a[146:147], v242 offset:17408
    ds_read_b64_tr_b16 a[148:149], v242 offset:16392
    ds_read_b64_tr_b16 a[150:151], v242 offset:17416
    ds_read_b64_tr_b16 a[152:153], v242 offset:24576
    ds_read_b64_tr_b16 a[154:155], v242 offset:25600
    ds_read_b64_tr_b16 a[156:157], v242 offset:24584
    ds_read_b64_tr_b16 a[158:159], v242 offset:25608
    ds_read_b64_tr_b16 a[160:161], v242 offset:32768
    ds_read_b64_tr_b16 a[162:163], v242 offset:33792
    ds_read_b64_tr_b16 a[164:165], v242 offset:32776
    ds_read_b64_tr_b16 a[166:167], v242 offset:33800
    ds_read_b64_tr_b16 a[168:169], v242 offset:40960
    ds_read_b64_tr_b16 a[170:171], v242 offset:41984
    ds_read_b64_tr_b16 a[172:173], v242 offset:40968
    ds_read_b64_tr_b16 a[174:175], v242 offset:41992
    ds_read_b64_tr_b16 a[176:177], v242 offset:49152
    ds_read_b64_tr_b16 a[178:179], v242 offset:50176
    ds_read_b64_tr_b16 a[180:181], v242 offset:49160
    ds_read_b64_tr_b16 a[182:183], v242 offset:50184
    ds_read_b64_tr_b16 a[184:185], v242 offset:57344
    ds_read_b64_tr_b16 a[186:187], v242 offset:58368
    ds_read_b64_tr_b16 a[188:189], v242 offset:57352
    ds_read_b64_tr_b16 a[190:191], v242 offset:58376
    s_waitcnt lgkmcnt(0)
    s_barrier
    s_add_u32 m0, s6, 0
    s_nop 0
    buffer_load_dwordx4 v16, s[12:15], s29 offen offset:0 lds
    buffer_load_dwordx4 v16, s[12:15], s29 offen offset:1024 lds
    buffer_load_dwordx4 v17, s[12:15], s29 offen offset:2048 lds
    buffer_load_dwordx4 v17, s[12:15], s29 offen offset:3072 lds
    s_add_u32 m0, s6, 4096
    s_nop 0
    buffer_load_dwordx4 v18, s[12:15], s29 offen offset:0 lds
    buffer_load_dwordx4 v18, s[12:15], s29 offen offset:1024 lds
    buffer_load_dwordx4 v19, s[12:15], s29 offen offset:2048 lds
    buffer_load_dwordx4 v19, s[12:15], s29 offen offset:3072 lds
    s_add_u32 m0, s6, 8192
    s_nop 0
    buffer_load_dwordx4 v20, s[12:15], s29 offen offset:0 lds
    buffer_load_dwordx4 v20, s[12:15], s29 offen offset:1024 lds
    buffer_load_dwordx4 v21, s[12:15], s29 offen offset:2048 lds
    buffer_load_dwordx4 v21, s[12:15], s29 offen offset:3072 lds
    s_add_u32 m0, s6, 12288
    s_nop 0
    buffer_load_dwordx4 v22, s[12:15], s29 offen offset:0 lds
    buffer_load_dwordx4 v22, s[12:15], s29 offen offset:1024 lds
    buffer_load_dwordx4 v23, s[12:15], s29 offen offset:2048 lds
    buffer_load_dwordx4 v23, s[12:15], s29 offen offset:3072 lds
    s_waitcnt vmcnt(16)
    s_barrier
    ds_read_b64_tr_b16 a[192:193], v243 offset:0
    ds_read_b64_tr_b16 a[194:195], v243 offset:1024
    ds_read_b64_tr_b16 a[196:197], v243 offset:8
    ds_read_b64_tr_b16 a[198:199], v243 offset:1032
    ds_read_b64_tr_b16 a[200:201], v243 offset:8192
    ds_read_b64_tr_b16 a[202:203], v243 offset:9216
    ds_read_b64_tr_b16 a[204:205], v243 offset:8200
    ds_read_b64_tr_b16 a[206:207], v243 offset:9224
    ds_read_b64_tr_b16 a[208:209], v243 offset:16384
    ds_read_b64_tr_b16 a[210:211], v243 offset:17408
    ds_read_b64_tr_b16 a[212:213], v243 offset:16392
    ds_read_b64_tr_b16 a[214:215], v243 offset:17416
    ds_read_b64_tr_b16 a[216:217], v243 offset:24576
    ds_read_b64_tr_b16 a[218:219], v243 offset:25600
    ds_read_b64_tr_b16 a[220:221], v243 offset:24584
    ds_read_b64_tr_b16 a[222:223], v243 offset:25608
    ds_read_b64_tr_b16 a[224:225], v243 offset:32768
    ds_read_b64_tr_b16 a[226:227], v243 offset:33792
    ds_read_b64_tr_b16 a[228:229], v243 offset:32776
    ds_read_b64_tr_b16 a[230:231], v243 offset:33800
    ds_read_b64_tr_b16 a[232:233], v243 offset:40960
    ds_read_b64_tr_b16 a[234:235], v243 offset:41984
    ds_read_b64_tr_b16 a[236:237], v243 offset:40968
    ds_read_b64_tr_b16 a[238:239], v243 offset:41992
    ds_read_b64_tr_b16 a[240:241], v243 offset:49152
    ds_read_b64_tr_b16 a[242:243], v243 offset:50176
    ds_read_b64_tr_b16 a[244:245], v243 offset:49160
    ds_read_b64_tr_b16 a[246:247], v243 offset:50184
    ds_read_b64_tr_b16 a[248:249], v243 offset:57344
    ds_read_b64_tr_b16 a[250:251], v243 offset:58368
    ds_read_b64_tr_b16 a[252:253], v243 offset:57352
    ds_read_b64_tr_b16 a[254:255], v243 offset:58376
    s_waitcnt lgkmcnt(0)
    s_barrier
    s_waitcnt vmcnt(0)
    s_barrier
    s_mov_b32 s29, 0x10000
    ds_read_b128 v[64:67], v8 offset:0
    ds_read_b128 v[68:71], v8 offset:32768
    ds_read_b128 v[72:75], v9 offset:0
    ds_read_b128 v[76:79], v9 offset:32768
    ds_read_b128 v[80:83], v10 offset:0
    ds_read_b128 v[84:87], v10 offset:32768
    ds_read_b128 v[88:91], v11 offset:0
    ds_read_b128 v[92:95], v11 offset:32768
    ds_read_b128 v[96:99], v8 offset:256
    ds_read_b128 v[100:103], v8 offset:33024
    ds_read_b128 v[104:107], v9 offset:256
    ds_read_b128 v[108:111], v9 offset:33024
    ds_read_b128 v[112:115], v10 offset:256
    ds_read_b128 v[116:119], v10 offset:33024
    ds_read_b128 v[120:123], v11 offset:256
    ds_read_b128 v[124:127], v11 offset:33024
    s_add_u32 m0, s6, 65536
    s_nop 0
    buffer_load_dwordx4 v16, s[12:15], s29 offen offset:0 lds
    buffer_load_dwordx4 v16, s[12:15], s29 offen offset:1024 lds
    buffer_load_dwordx4 v17, s[12:15], s29 offen offset:2048 lds
    buffer_load_dwordx4 v17, s[12:15], s29 offen offset:3072 lds
    s_add_u32 m0, s6, 69632
    s_nop 0
    buffer_load_dwordx4 v18, s[12:15], s29 offen offset:0 lds
    buffer_load_dwordx4 v18, s[12:15], s29 offen offset:1024 lds
    s_cmp_eq_u32 s98, 0
    s_cbranch_scc1 .qa_307
    s_cmp_eq_u32 s98, 2
    s_cbranch_scc1 .vt_308
.p2align 6
.ql_310:
    s_waitcnt lgkmcnt(12)
    v_mfma_f32_16x16x32_bf16 v[192:195], a[0:3], v[64:67], 0
    ds_read_b128 v[128:131], v8 offset:512
    v_mfma_f32_16x16x32_bf16 v[196:199], a[4:7], v[64:67], 0
    v_mfma_f32_16x16x32_bf16 v[200:203], a[0:3], v[68:71], 0
    ds_read_b128 v[132:135], v8 offset:33280
    v_mfma_f32_16x16x32_bf16 v[204:207], a[4:7], v[68:71], 0
    buffer_load_dwordx4 v19, s[12:15], s29 offen offset:2048 lds
    v_mfma_f32_16x16x32_bf16 v[192:195], a[8:11], v[72:75], v[192:195]
    ds_read_b128 v[136:139], v9 offset:512
    v_mfma_f32_16x16x32_bf16 v[196:199], a[12:15], v[72:75], v[196:199]
    v_cvt_pk_bf16_f32 v224, v208, v209
    v_cvt_pk_bf16_f32 v225, v210, v211
    v_mfma_f32_16x16x32_bf16 v[200:203], a[8:11], v[76:79], v[200:203]
    ds_read_b128 v[140:143], v9 offset:33280
    v_mfma_f32_16x16x32_bf16 v[204:207], a[12:15], v[76:79], v[204:207]
    buffer_load_dwordx4 v19, s[12:15], s29 offen offset:3072 lds
    s_waitcnt lgkmcnt(12)
    v_mfma_f32_16x16x32_bf16 v[192:195], a[16:19], v[80:83], v[192:195]
    ds_read_b128 v[144:147], v10 offset:512
    v_mfma_f32_16x16x32_bf16 v[196:199], a[20:23], v[80:83], v[196:199]
    s_add_u32 m0, s6, 73728
    v_cvt_pk_bf16_f32 v226, v212, v213
    v_cvt_pk_bf16_f32 v227, v214, v215
    v_mfma_f32_16x16x32_bf16 v[200:203], a[16:19], v[84:87], v[200:203]
    ds_read_b128 v[148:151], v10 offset:33280
    v_mfma_f32_16x16x32_bf16 v[204:207], a[20:23], v[84:87], v[204:207]
    buffer_load_dwordx4 v20, s[12:15], s29 offen offset:0 lds
    v_mfma_f32_16x16x32_bf16 v[192:195], a[24:27], v[88:91], v[192:195]
    ds_read_b128 v[152:155], v11 offset:512
    v_cvt_pk_bf16_f32 v228, v216, v217
    v_mfma_f32_16x16x32_bf16 v[196:199], a[28:31], v[88:91], v[196:199]
    buffer_store_dwordx4 v[224:227], v24, s[8:11], s30 offen sc1
    v_mfma_f32_16x16x32_bf16 v[200:203], a[24:27], v[92:95], v[200:203]
    ds_read_b128 v[156:159], v11 offset:33280
    v_cvt_pk_bf16_f32 v229, v218, v219
    v_mfma_f32_16x16x32_bf16 v[204:207], a[28:31], v[92:95], v[204:207]
    buffer_load_dwordx4 v20, s[12:15], s29 offen offset:1024 lds
    s_waitcnt lgkmcnt(12)
    v_mfma_f32_16x16x32_bf16 v[192:195], a[32:35], v[96:99], v[192:195]
    ds_read_b128 v[160:163], v8 offset:768
    v_mfma_f32_16x16x32_bf16 v[196:199], a[36:39], v[96:99], v[196:199]
    v_cvt_pk_bf16_f32 v230, v220, v221
    v_cvt_pk_bf16_f32 v231, v222, v223
    v_mfma_f32_16x16x32_bf16 v[200:203], a[32:35], v[100:103], v[200:203]
    ds_read_b128 v[164:167], v8 offset:33536
    v_mfma_f32_16x16x32_bf16 v[204:207], a[36:39], v[100:103], v[204:207]
    buffer_load_dwordx4 v21, s[12:15], s29 offen offset:2048 lds
    v_mfma_f32_16x16x32_bf16 v[192:195], a[40:43], v[104:107], v[192:195]
    ds_read_b128 v[168:171], v9 offset:768
    v_mfma_f32_16x16x32_bf16 v[196:199], a[44:47], v[104:107], v[196:199]
    buffer_store_dwordx4 v[228:231], v25, s[8:11], s30 offen sc1
    v_mfma_f32_16x16x32_bf16 v[200:203], a[40:43], v[108:111], v[200:203]
    ds_read_b128 v[172:175], v9 offset:33536
    v_mfma_f32_16x16x32_bf16 v[204:207], a[44:47], v[108:111], v[204:207]
    buffer_load_dwordx4 v21, s[12:15], s29 offen offset:3072 lds
    s_waitcnt lgkmcnt(12)
    v_mfma_f32_16x16x32_bf16 v[192:195], a[48:51], v[112:115], v[192:195]
    ds_read_b128 v[176:179], v10 offset:768
    v_mfma_f32_16x16x32_bf16 v[196:199], a[52:55], v[112:115], v[196:199]
    s_add_u32 m0, s6, 77824
    s_mov_b32 s30, s31
    v_mfma_f32_16x16x32_bf16 v[200:203], a[48:51], v[116:119], v[200:203]
    ds_read_b128 v[180:183], v10 offset:33536
    v_mfma_f32_16x16x32_bf16 v[204:207], a[52:55], v[116:119], v[204:207]
    buffer_load_dwordx4 v22, s[12:15], s29 offen offset:0 lds
    v_mfma_f32_16x16x32_bf16 v[192:195], a[56:59], v[120:123], v[192:195]
    ds_read_b128 v[184:187], v11 offset:768
    v_mfma_f32_16x16x32_bf16 v[196:199], a[60:63], v[120:123], v[196:199]
    s_add_u32 s31, s31, 262144
    v_mfma_f32_16x16x32_bf16 v[200:203], a[56:59], v[124:127], v[200:203]
    ds_read_b128 v[188:191], v11 offset:33536
    v_mfma_f32_16x16x32_bf16 v[204:207], a[60:63], v[124:127], v[204:207]
    buffer_load_dwordx4 v22, s[12:15], s29 offen offset:1024 lds
    s_waitcnt lgkmcnt(12)
    v_mfma_f32_16x16x32_bf16 v[192:195], a[64:67], v[128:131], v[192:195]
    ds_read_b128 v[64:67], v8 offset:1024
    v_mfma_f32_16x16x32_bf16 v[196:199], a[68:71], v[128:131], v[196:199]
    v_mfma_f32_16x16x32_bf16 v[200:203], a[64:67], v[132:135], v[200:203]
    ds_read_b128 v[68:71], v8 offset:33792
    v_mfma_f32_16x16x32_bf16 v[204:207], a[68:71], v[132:135], v[204:207]
    buffer_load_dwordx4 v23, s[12:15], s29 offen offset:2048 lds
    v_mfma_f32_16x16x32_bf16 v[192:195], a[72:75], v[136:139], v[192:195]
    ds_read_b128 v[72:75], v9 offset:1024
    v_mfma_f32_16x16x32_bf16 v[196:199], a[76:79], v[136:139], v[196:199]
    v_mfma_f32_16x16x32_bf16 v[200:203], a[72:75], v[140:143], v[200:203]
    ds_read_b128 v[76:79], v9 offset:33792
    v_mfma_f32_16x16x32_bf16 v[204:207], a[76:79], v[140:143], v[204:207]
    buffer_load_dwordx4 v23, s[12:15], s29 offen offset:3072 lds
    s_waitcnt lgkmcnt(12)
    v_mfma_f32_16x16x32_bf16 v[192:195], a[80:83], v[144:147], v[192:195]
    ds_read_b128 v[80:83], v10 offset:1024
    v_mfma_f32_16x16x32_bf16 v[196:199], a[84:87], v[144:147], v[196:199]
    v_mfma_f32_16x16x32_bf16 v[200:203], a[80:83], v[148:151], v[200:203]
    ds_read_b128 v[84:87], v10 offset:33792
    v_mfma_f32_16x16x32_bf16 v[204:207], a[84:87], v[148:151], v[204:207]
    buffer_load_dword v29, v28, s[12:15], s29 offen
    v_mfma_f32_16x16x32_bf16 v[192:195], a[88:91], v[152:155], v[192:195]
    ds_read_b128 v[88:91], v11 offset:1024
    v_mfma_f32_16x16x32_bf16 v[196:199], a[92:95], v[152:155], v[196:199]
    v_mfma_f32_16x16x32_bf16 v[200:203], a[88:91], v[156:159], v[200:203]
    ds_read_b128 v[92:95], v11 offset:33792
    v_mfma_f32_16x16x32_bf16 v[204:207], a[92:95], v[156:159], v[204:207]
    s_waitcnt lgkmcnt(12)
    v_mfma_f32_16x16x32_bf16 v[192:195], a[96:99], v[160:163], v[192:195]
    ds_read_b128 v[96:99], v8 offset:1280
    v_mfma_f32_16x16x32_bf16 v[196:199], a[100:103], v[160:163], v[196:199]
    v_mfma_f32_16x16x32_bf16 v[200:203], a[96:99], v[164:167], v[200:203]
    ds_read_b128 v[100:103], v8 offset:34048
    v_mfma_f32_16x16x32_bf16 v[204:207], a[100:103], v[164:167], v[204:207]
    v_mfma_f32_16x16x32_bf16 v[192:195], a[104:107], v[168:171], v[192:195]
    ds_read_b128 v[104:107], v9 offset:1280
    v_mfma_f32_16x16x32_bf16 v[196:199], a[108:111], v[168:171], v[196:199]
    v_mfma_f32_16x16x32_bf16 v[200:203], a[104:107], v[172:175], v[200:203]
    ds_read_b128 v[108:111], v9 offset:34048
    v_mfma_f32_16x16x32_bf16 v[204:207], a[108:111], v[172:175], v[204:207]
    s_waitcnt lgkmcnt(12)
    v_mfma_f32_16x16x32_bf16 v[192:195], a[112:115], v[176:179], v[192:195]
    ds_read_b128 v[112:115], v10 offset:1280
    v_mfma_f32_16x16x32_bf16 v[196:199], a[116:119], v[176:179], v[196:199]
    v_mfma_f32_16x16x32_bf16 v[200:203], a[112:115], v[180:183], v[200:203]
    ds_read_b128 v[116:119], v10 offset:34048
    v_mfma_f32_16x16x32_bf16 v[204:207], a[116:119], v[180:183], v[204:207]
    v_mfma_f32_16x16x32_bf16 v[192:195], a[120:123], v[184:187], v[192:195]
    ds_read_b128 v[120:123], v11 offset:1280
    v_mfma_f32_16x16x32_bf16 v[196:199], a[124:127], v[184:187], v[196:199]
    v_mfma_f32_16x16x32_bf16 v[200:203], a[120:123], v[188:191], v[200:203]
    ds_read_b128 v[124:127], v11 offset:34048
    v_mfma_f32_16x16x32_bf16 v[204:207], a[124:127], v[188:191], v[204:207]
    s_waitcnt lgkmcnt(12)
    v_mfma_f32_16x16x32_bf16 v[192:195], a[128:131], v[64:67], v[192:195]
    ds_read_b128 v[128:131], v8 offset:1536
    v_mfma_f32_16x16x32_bf16 v[196:199], a[132:135], v[64:67], v[196:199]
    v_mfma_f32_16x16x32_bf16 v[200:203], a[128:131], v[68:71], v[200:203]
    ds_read_b128 v[132:135], v8 offset:34304
    v_mfma_f32_16x16x32_bf16 v[204:207], a[132:135], v[68:71], v[204:207]
    v_mfma_f32_16x16x32_bf16 v[192:195], a[136:139], v[72:75], v[192:195]
    ds_read_b128 v[136:139], v9 offset:1536
    v_mfma_f32_16x16x32_bf16 v[196:199], a[140:143], v[72:75], v[196:199]
    v_mfma_f32_16x16x32_bf16 v[200:203], a[136:139], v[76:79], v[200:203]
    ds_read_b128 v[140:143], v9 offset:34304
    v_mfma_f32_16x16x32_bf16 v[204:207], a[140:143], v[76:79], v[204:207]
    s_waitcnt lgkmcnt(12)
    v_mfma_f32_16x16x32_bf16 v[192:195], a[144:147], v[80:83], v[192:195]
    ds_read_b128 v[144:147], v10 offset:1536
    v_mfma_f32_16x16x32_bf16 v[196:199], a[148:151], v[80:83], v[196:199]
    v_mfma_f32_16x16x32_bf16 v[200:203], a[144:147], v[84:87], v[200:203]
    ds_read_b128 v[148:151], v10 offset:34304
    v_mfma_f32_16x16x32_bf16 v[204:207], a[148:151], v[84:87], v[204:207]
    v_mfma_f32_16x16x32_bf16 v[192:195], a[152:155], v[88:91], v[192:195]
    ds_read_b128 v[152:155], v11 offset:1536
    v_mfma_f32_16x16x32_bf16 v[196:199], a[156:159], v[88:91], v[196:199]
    v_mfma_f32_16x16x32_bf16 v[200:203], a[152:155], v[92:95], v[200:203]
    ds_read_b128 v[156:159], v11 offset:34304
    v_mfma_f32_16x16x32_bf16 v[204:207], a[156:159], v[92:95], v[204:207]
    s_waitcnt lgkmcnt(12)
    v_mfma_f32_16x16x32_bf16 v[192:195], a[160:163], v[96:99], v[192:195]
    ds_read_b128 v[160:163], v8 offset:1792
    v_mfma_f32_16x16x32_bf16 v[196:199], a[164:167], v[96:99], v[196:199]
    v_mfma_f32_16x16x32_bf16 v[200:203], a[160:163], v[100:103], v[200:203]
    ds_read_b128 v[164:167], v8 offset:34560
    v_mfma_f32_16x16x32_bf16 v[204:207], a[164:167], v[100:103], v[204:207]
    v_mfma_f32_16x16x32_bf16 v[192:195], a[168:171], v[104:107], v[192:195]
    ds_read_b128 v[168:171], v9 offset:1792
    v_mfma_f32_16x16x32_bf16 v[196:199], a[172:175], v[104:107], v[196:199]
    v_mfma_f32_16x16x32_bf16 v[200:203], a[168:171], v[108:111], v[200:203]
    ds_read_b128 v[172:175], v9 offset:34560
    v_mfma_f32_16x16x32_bf16 v[204:207], a[172:175], v[108:111], v[204:207]
    s_waitcnt lgkmcnt(12)
    v_mfma_f32_16x16x32_bf16 v[192:195], a[176:179], v[112:115], v[192:195]
    ds_read_b128 v[176:179], v10 offset:1792
    v_mfma_f32_16x16x32_bf16 v[196:199], a[180:183], v[112:115], v[196:199]
    s_waitcnt vmcnt(6)
    v_mov_b32 v27, s28
    s_mov_b64 exec, 1
    buffer_store_dword v27, v26, s[8:11], s94 offen sc1
    s_mov_b64 exec, -1
    v_mfma_f32_16x16x32_bf16 v[200:203], a[176:179], v[116:119], v[200:203]
    ds_read_b128 v[180:183], v10 offset:34560
    v_mfma_f32_16x16x32_bf16 v[204:207], a[180:183], v[116:119], v[204:207]
    v_mfma_f32_16x16x32_bf16 v[192:195], a[184:187], v[120:123], v[192:195]
    ds_read_b128 v[184:187], v11 offset:1792
    v_mfma_f32_16x16x32_bf16 v[196:199], a[188:191], v[120:123], v[196:199]
    s_add_u32 s28, s28, 1
    v_mfma_f32_16x16x32_bf16 v[200:203], a[184:187], v[124:127], v[200:203]
    ds_read_b128 v[188:191], v11 offset:34560
    v_mfma_f32_16x16x32_bf16 v[204:207], a[188:191], v[124:127], v[204:207]
    s_waitcnt lgkmcnt(12)
    v_mfma_f32_16x16x32_bf16 v[192:195], a[192:195], v[128:131], v[192:195]
    v_mfma_f32_16x16x32_bf16 v[196:199], a[196:199], v[128:131], v[196:199]
    v_mfma_f32_16x16x32_bf16 v[200:203], a[192:195], v[132:135], v[200:203]
    v_mfma_f32_16x16x32_bf16 v[204:207], a[196:199], v[132:135], v[204:207]
    v_mfma_f32_16x16x32_bf16 v[192:195], a[200:203], v[136:139], v[192:195]
    v_mfma_f32_16x16x32_bf16 v[196:199], a[204:207], v[136:139], v[196:199]
    s_add_u32 s29, s29, 0x10000
    s_min_u32 s29, s29, 0x3f0000
    v_mfma_f32_16x16x32_bf16 v[200:203], a[200:203], v[140:143], v[200:203]
    v_mfma_f32_16x16x32_bf16 v[204:207], a[204:207], v[140:143], v[204:207]
    s_waitcnt vmcnt(2) lgkmcnt(0)
    s_barrier
    v_mfma_f32_16x16x32_bf16 v[192:195], a[208:211], v[144:147], v[192:195]
    ds_read_b128 v[64:67], v12 offset:0
    ds_read_b128 v[68:71], v12 offset:32768
    v_mfma_f32_16x16x32_bf16 v[196:199], a[212:215], v[144:147], v[196:199]
    s_add_u32 m0, s6, 0
    v_mfma_f32_16x16x32_bf16 v[200:203], a[208:211], v[148:151], v[200:203]
    ds_read_b128 v[72:75], v13 offset:0
    ds_read_b128 v[76:79], v13 offset:32768
    v_mfma_f32_16x16x32_bf16 v[204:207], a[212:215], v[148:151], v[204:207]
    buffer_load_dwordx4 v16, s[12:15], s29 offen offset:0 lds
    v_mfma_f32_16x16x32_bf16 v[192:195], a[216:219], v[152:155], v[192:195]
    ds_read_b128 v[80:83], v14 offset:0
    ds_read_b128 v[84:87], v14 offset:32768
    v_mfma_f32_16x16x32_bf16 v[196:199], a[220:223], v[152:155], v[196:199]
    v_mfma_f32_16x16x32_bf16 v[200:203], a[216:219], v[156:159], v[200:203]
    ds_read_b128 v[88:91], v15 offset:0
    ds_read_b128 v[92:95], v15 offset:32768
    v_mfma_f32_16x16x32_bf16 v[204:207], a[220:223], v[156:159], v[204:207]
    buffer_load_dwordx4 v16, s[12:15], s29 offen offset:1024 lds
    v_mfma_f32_16x16x32_bf16 v[192:195], a[224:227], v[160:163], v[192:195]
    ds_read_b128 v[96:99], v12 offset:256
    v_mfma_f32_16x16x32_bf16 v[196:199], a[228:231], v[160:163], v[196:199]
    v_mfma_f32_16x16x32_bf16 v[200:203], a[224:227], v[164:167], v[200:203]
    ds_read_b128 v[100:103], v12 offset:33024
    v_mfma_f32_16x16x32_bf16 v[204:207], a[228:231], v[164:167], v[204:207]
    buffer_load_dwordx4 v17, s[12:15], s29 offen offset:2048 lds
    v_mfma_f32_16x16x32_bf16 v[192:195], a[232:235], v[168:171], v[192:195]
    ds_read_b128 v[104:107], v13 offset:256
    v_mfma_f32_16x16x32_bf16 v[196:199], a[236:239], v[168:171], v[196:199]
    v_mfma_f32_16x16x32_bf16 v[200:203], a[232:235], v[172:175], v[200:203]
    ds_read_b128 v[108:111], v13 offset:33024
    v_mfma_f32_16x16x32_bf16 v[204:207], a[236:239], v[172:175], v[204:207]
    buffer_load_dwordx4 v17, s[12:15], s29 offen offset:3072 lds
    v_mfma_f32_16x16x32_bf16 v[192:195], a[240:243], v[176:179], v[192:195]
    ds_read_b128 v[112:115], v14 offset:256
    v_mfma_f32_16x16x32_bf16 v[196:199], a[244:247], v[176:179], v[196:199]
    s_add_u32 m0, s6, 4096
    v_mfma_f32_16x16x32_bf16 v[200:203], a[240:243], v[180:183], v[200:203]
    ds_read_b128 v[116:119], v14 offset:33024
    v_mfma_f32_16x16x32_bf16 v[204:207], a[244:247], v[180:183], v[204:207]
    buffer_load_dwordx4 v18, s[12:15], s29 offen offset:0 lds
    v_mfma_f32_16x16x32_bf16 v[192:195], a[248:251], v[184:187], v[192:195]
    ds_read_b128 v[120:123], v15 offset:256
    v_mfma_f32_16x16x32_bf16 v[196:199], a[252:255], v[184:187], v[196:199]
    v_mfma_f32_16x16x32_bf16 v[200:203], a[248:251], v[188:191], v[200:203]
    ds_read_b128 v[124:127], v15 offset:33024
    v_mfma_f32_16x16x32_bf16 v[204:207], a[252:255], v[188:191], v[204:207]
    buffer_load_dwordx4 v18, s[12:15], s29 offen offset:1024 lds
    s_waitcnt lgkmcnt(12)
    v_mfma_f32_16x16x32_bf16 v[208:211], a[0:3], v[64:67], 0
    ds_read_b128 v[128:131], v12 offset:512
    v_mfma_f32_16x16x32_bf16 v[212:215], a[4:7], v[64:67], 0
    v_mfma_f32_16x16x32_bf16 v[216:219], a[0:3], v[68:71], 0
    ds_read_b128 v[132:135], v12 offset:33280
    v_mfma_f32_16x16x32_bf16 v[220:223], a[4:7], v[68:71], 0
    buffer_load_dwordx4 v19, s[12:15], s29 offen offset:2048 lds
    v_mfma_f32_16x16x32_bf16 v[208:211], a[8:11], v[72:75], v[208:211]
    ds_read_b128 v[136:139], v13 offset:512
    v_mfma_f32_16x16x32_bf16 v[212:215], a[12:15], v[72:75], v[212:215]
    v_cvt_pk_bf16_f32 v224, v192, v193
    v_cvt_pk_bf16_f32 v225, v194, v195
    v_mfma_f32_16x16x32_bf16 v[216:219], a[8:11], v[76:79], v[216:219]
    ds_read_b128 v[140:143], v13 offset:33280
    v_mfma_f32_16x16x32_bf16 v[220:223], a[12:15], v[76:79], v[220:223]
    buffer_load_dwordx4 v19, s[12:15], s29 offen offset:3072 lds
    s_waitcnt lgkmcnt(12)
    v_mfma_f32_16x16x32_bf16 v[208:211], a[16:19], v[80:83], v[208:211]
    ds_read_b128 v[144:147], v14 offset:512
    v_mfma_f32_16x16x32_bf16 v[212:215], a[20:23], v[80:83], v[212:215]
    s_add_u32 m0, s6, 8192
    v_cvt_pk_bf16_f32 v226, v196, v197
    v_cvt_pk_bf16_f32 v227, v198, v199
    v_mfma_f32_16x16x32_bf16 v[216:219], a[16:19], v[84:87], v[216:219]
    ds_read_b128 v[148:151], v14 offset:33280
    v_mfma_f32_16x16x32_bf16 v[220:223], a[20:23], v[84:87], v[220:223]
    buffer_load_dwordx4 v20, s[12:15], s29 offen offset:0 lds
    v_mfma_f32_16x16x32_bf16 v[208:211], a[24:27], v[88:91], v[208:211]
    ds_read_b128 v[152:155], v15 offset:512
    v_cvt_pk_bf16_f32 v228, v200, v201
    v_mfma_f32_16x16x32_bf16 v[212:215], a[28:31], v[88:91], v[212:215]
    buffer_store_dwordx4 v[224:227], v24, s[8:11], s30 offen sc1
    v_mfma_f32_16x16x32_bf16 v[216:219], a[24:27], v[92:95], v[216:219]
    ds_read_b128 v[156:159], v15 offset:33280
    v_cvt_pk_bf16_f32 v229, v202, v203
    v_mfma_f32_16x16x32_bf16 v[220:223], a[28:31], v[92:95], v[220:223]
    buffer_load_dwordx4 v20, s[12:15], s29 offen offset:1024 lds
    s_waitcnt lgkmcnt(12)
    v_mfma_f32_16x16x32_bf16 v[208:211], a[32:35], v[96:99], v[208:211]
    ds_read_b128 v[160:163], v12 offset:768
    v_mfma_f32_16x16x32_bf16 v[212:215], a[36:39], v[96:99], v[212:215]
    v_cvt_pk_bf16_f32 v230, v204, v205
    v_cvt_pk_bf16_f32 v231, v206, v207
    v_mfma_f32_16x16x32_bf16 v[216:219], a[32:35], v[100:103], v[216:219]
    ds_read_b128 v[164:167], v12 offset:33536
    v_mfma_f32_16x16x32_bf16 v[220:223], a[36:39], v[100:103], v[220:223]
    buffer_load_dwordx4 v21, s[12:15], s29 offen offset:2048 lds
    v_mfma_f32_16x16x32_bf16 v[208:211], a[40:43], v[104:107], v[208:211]
    ds_read_b128 v[168:171], v13 offset:768
    v_mfma_f32_16x16x32_bf16 v[212:215], a[44:47], v[104:107], v[212:215]
    buffer_store_dwordx4 v[228:231], v25, s[8:11], s30 offen sc1
    v_mfma_f32_16x16x32_bf16 v[216:219], a[40:43], v[108:111], v[216:219]
    ds_read_b128 v[172:175], v13 offset:33536
    v_mfma_f32_16x16x32_bf16 v[220:223], a[44:47], v[108:111], v[220:223]
    buffer_load_dwordx4 v21, s[12:15], s29 offen offset:3072 lds
    s_waitcnt lgkmcnt(12)
    v_mfma_f32_16x16x32_bf16 v[208:211], a[48:51], v[112:115], v[208:211]
    ds_read_b128 v[176:179], v14 offset:768
    v_mfma_f32_16x16x32_bf16 v[212:215], a[52:55], v[112:115], v[212:215]
    s_add_u32 m0, s6, 12288
    s_mov_b32 s30, s31
    v_mfma_f32_16x16x32_bf16 v[216:219], a[48:51], v[116:119], v[216:219]
    ds_read_b128 v[180:183], v14 offset:33536
    v_mfma_f32_16x16x32_bf16 v[220:223], a[52:55], v[116:119], v[220:223]
    buffer_load_dwordx4 v22, s[12:15], s29 offen offset:0 lds
    v_mfma_f32_16x16x32_bf16 v[208:211], a[56:59], v[120:123], v[208:211]
    ds_read_b128 v[184:187], v15 offset:768
    v_mfma_f32_16x16x32_bf16 v[212:215], a[60:63], v[120:123], v[212:215]
    s_add_u32 s31, s31, 262144
    v_mfma_f32_16x16x32_bf16 v[216:219], a[56:59], v[124:127], v[216:219]
    ds_read_b128 v[188:191], v15 offset:33536
    v_mfma_f32_16x16x32_bf16 v[220:223], a[60:63], v[124:127], v[220:223]
    buffer_load_dwordx4 v22, s[12:15], s29 offen offset:1024 lds
    s_waitcnt lgkmcnt(12)
    v_mfma_f32_16x16x32_bf16 v[208:211], a[64:67], v[128:131], v[208:211]
    ds_read_b128 v[64:67], v12 offset:1024
    v_mfma_f32_16x16x32_bf16 v[212:215], a[68:71], v[128:131], v[212:215]
    v_mfma_f32_16x16x32_bf16 v[216:219], a[64:67], v[132:135], v[216:219]
    ds_read_b128 v[68:71], v12 offset:33792
    v_mfma_f32_16x16x32_bf16 v[220:223], a[68:71], v[132:135], v[220:223]
    buffer_load_dwordx4 v23, s[12:15], s29 offen offset:2048 lds
    v_mfma_f32_16x16x32_bf16 v[208:211], a[72:75], v[136:139], v[208:211]
    ds_read_b128 v[72:75], v13 offset:1024
    v_mfma_f32_16x16x32_bf16 v[212:215], a[76:79], v[136:139], v[212:215]
    v_mfma_f32_16x16x32_bf16 v[216:219], a[72:75], v[140:143], v[216:219]
    ds_read_b128 v[76:79], v13 offset:33792
    v_mfma_f32_16x16x32_bf16 v[220:223], a[76:79], v[140:143], v[220:223]
    buffer_load_dwordx4 v23, s[12:15], s29 offen offset:3072 lds
    s_waitcnt lgkmcnt(12)
    v_mfma_f32_16x16x32_bf16 v[208:211], a[80:83], v[144:147], v[208:211]
    ds_read_b128 v[80:83], v14 offset:1024
    v_mfma_f32_16x16x32_bf16 v[212:215], a[84:87], v[144:147], v[212:215]
    v_mfma_f32_16x16x32_bf16 v[216:219], a[80:83], v[148:151], v[216:219]
    ds_read_b128 v[84:87], v14 offset:33792
    v_mfma_f32_16x16x32_bf16 v[220:223], a[84:87], v[148:151], v[220:223]
    buffer_load_dword v29, v28, s[12:15], s29 offen
    v_mfma_f32_16x16x32_bf16 v[208:211], a[88:91], v[152:155], v[208:211]
    ds_read_b128 v[88:91], v15 offset:1024
    v_mfma_f32_16x16x32_bf16 v[212:215], a[92:95], v[152:155], v[212:215]
    v_mfma_f32_16x16x32_bf16 v[216:219], a[88:91], v[156:159], v[216:219]
    ds_read_b128 v[92:95], v15 offset:33792
    v_mfma_f32_16x16x32_bf16 v[220:223], a[92:95], v[156:159], v[220:223]
    s_waitcnt lgkmcnt(12)
    v_mfma_f32_16x16x32_bf16 v[208:211], a[96:99], v[160:163], v[208:211]
    ds_read_b128 v[96:99], v12 offset:1280
    v_mfma_f32_16x16x32_bf16 v[212:215], a[100:103], v[160:163], v[212:215]
    v_mfma_f32_16x16x32_bf16 v[216:219], a[96:99], v[164:167], v[216:219]
    ds_read_b128 v[100:103], v12 offset:34048
    v_mfma_f32_16x16x32_bf16 v[220:223], a[100:103], v[164:167], v[220:223]
    v_mfma_f32_16x16x32_bf16 v[208:211], a[104:107], v[168:171], v[208:211]
    ds_read_b128 v[104:107], v13 offset:1280
    v_mfma_f32_16x16x32_bf16 v[212:215], a[108:111], v[168:171], v[212:215]
    v_mfma_f32_16x16x32_bf16 v[216:219], a[104:107], v[172:175], v[216:219]
    ds_read_b128 v[108:111], v13 offset:34048
    v_mfma_f32_16x16x32_bf16 v[220:223], a[108:111], v[172:175], v[220:223]
    s_waitcnt lgkmcnt(12)
    v_mfma_f32_16x16x32_bf16 v[208:211], a[112:115], v[176:179], v[208:211]
    ds_read_b128 v[112:115], v14 offset:1280
    v_mfma_f32_16x16x32_bf16 v[212:215], a[116:119], v[176:179], v[212:215]
    v_mfma_f32_16x16x32_bf16 v[216:219], a[112:115], v[180:183], v[216:219]
    ds_read_b128 v[116:119], v14 offset:34048
    v_mfma_f32_16x16x32_bf16 v[220:223], a[116:119], v[180:183], v[220:223]
    v_mfma_f32_16x16x32_bf16 v[208:211], a[120:123], v[184:187], v[208:211]
    ds_read_b128 v[120:123], v15 offset:1280
    v_mfma_f32_16x16x32_bf16 v[212:215], a[124:127], v[184:187], v[212:215]
    v_mfma_f32_16x16x32_bf16 v[216:219], a[120:123], v[188:191], v[216:219]
    ds_read_b128 v[124:127], v15 offset:34048
    v_mfma_f32_16x16x32_bf16 v[220:223], a[124:127], v[188:191], v[220:223]
    s_waitcnt lgkmcnt(12)
    v_mfma_f32_16x16x32_bf16 v[208:211], a[128:131], v[64:67], v[208:211]
    ds_read_b128 v[128:131], v12 offset:1536
    v_mfma_f32_16x16x32_bf16 v[212:215], a[132:135], v[64:67], v[212:215]
    v_mfma_f32_16x16x32_bf16 v[216:219], a[128:131], v[68:71], v[216:219]
    ds_read_b128 v[132:135], v12 offset:34304
    v_mfma_f32_16x16x32_bf16 v[220:223], a[132:135], v[68:71], v[220:223]
    v_mfma_f32_16x16x32_bf16 v[208:211], a[136:139], v[72:75], v[208:211]
    ds_read_b128 v[136:139], v13 offset:1536
    v_mfma_f32_16x16x32_bf16 v[212:215], a[140:143], v[72:75], v[212:215]
    v_mfma_f32_16x16x32_bf16 v[216:219], a[136:139], v[76:79], v[216:219]
    ds_read_b128 v[140:143], v13 offset:34304
    v_mfma_f32_16x16x32_bf16 v[220:223], a[140:143], v[76:79], v[220:223]
    s_waitcnt lgkmcnt(12)
    v_mfma_f32_16x16x32_bf16 v[208:211], a[144:147], v[80:83], v[208:211]
    ds_read_b128 v[144:147], v14 offset:1536
    v_mfma_f32_16x16x32_bf16 v[212:215], a[148:151], v[80:83], v[212:215]
    v_mfma_f32_16x16x32_bf16 v[216:219], a[144:147], v[84:87], v[216:219]
    ds_read_b128 v[148:151], v14 offset:34304
    v_mfma_f32_16x16x32_bf16 v[220:223], a[148:151], v[84:87], v[220:223]
    v_mfma_f32_16x16x32_bf16 v[208:211], a[152:155], v[88:91], v[208:211]
    ds_read_b128 v[152:155], v15 offset:1536
    v_mfma_f32_16x16x32_bf16 v[212:215], a[156:159], v[88:91], v[212:215]
    v_mfma_f32_16x16x32_bf16 v[216:219], a[152:155], v[92:95], v[216:219]
    ds_read_b128 v[156:159], v15 offset:34304
    v_mfma_f32_16x16x32_bf16 v[220:223], a[156:159], v[92:95], v[220:223]
    s_waitcnt lgkmcnt(12)
    v_mfma_f32_16x16x32_bf16 v[208:211], a[160:163], v[96:99], v[208:211]
    ds_read_b128 v[160:163], v12 offset:1792
    v_mfma_f32_16x16x32_bf16 v[212:215], a[164:167], v[96:99], v[212:215]
    v_mfma_f32_16x16x32_bf16 v[216:219], a[160:163], v[100:103], v[216:219]
    ds_read_b128 v[164:167], v12 offset:34560
    v_mfma_f32_16x16x32_bf16 v[220:223], a[164:167], v[100:103], v[220:223]
    v_mfma_f32_16x16x32_bf16 v[208:211], a[168:171], v[104:107], v[208:211]
    ds_read_b128 v[168:171], v13 offset:1792
    v_mfma_f32_16x16x32_bf16 v[212:215], a[172:175], v[104:107], v[212:215]
    v_mfma_f32_16x16x32_bf16 v[216:219], a[168:171], v[108:111], v[216:219]
    ds_read_b128 v[172:175], v13 offset:34560
    v_mfma_f32_16x16x32_bf16 v[220:223], a[172:175], v[108:111], v[220:223]
    s_waitcnt lgkmcnt(12)
    v_mfma_f32_16x16x32_bf16 v[208:211], a[176:179], v[112:115], v[208:211]
    ds_read_b128 v[176:179], v14 offset:1792
    v_mfma_f32_16x16x32_bf16 v[212:215], a[180:183], v[112:115], v[212:215]
    s_waitcnt vmcnt(6)
    v_mov_b32 v27, s28
    s_mov_b64 exec, 1
    buffer_store_dword v27, v26, s[8:11], s94 offen sc1
    s_mov_b64 exec, -1
    v_mfma_f32_16x16x32_bf16 v[216:219], a[176:179], v[116:119], v[216:219]
    ds_read_b128 v[180:183], v14 offset:34560
    v_mfma_f32_16x16x32_bf16 v[220:223], a[180:183], v[116:119], v[220:223]
    v_mfma_f32_16x16x32_bf16 v[208:211], a[184:187], v[120:123], v[208:211]
    ds_read_b128 v[184:187], v15 offset:1792
    v_mfma_f32_16x16x32_bf16 v[212:215], a[188:191], v[120:123], v[212:215]
    s_add_u32 s28, s28, 1
    v_mfma_f32_16x16x32_bf16 v[216:219], a[184:187], v[124:127], v[216:219]
    ds_read_b128 v[188:191], v15 offset:34560
    v_mfma_f32_16x16x32_bf16 v[220:223], a[188:191], v[124:127], v[220:223]
    s_waitcnt lgkmcnt(12)
    v_mfma_f32_16x16x32_bf16 v[208:211], a[192:195], v[128:131], v[208:211]
    v_mfma_f32_16x16x32_bf16 v[212:215], a[196:199], v[128:131], v[212:215]
    v_mfma_f32_16x16x32_bf16 v[216:219], a[192:195], v[132:135], v[216:219]
    v_mfma_f32_16x16x32_bf16 v[220:223], a[196:199], v[132:135], v[220:223]
    v_mfma_f32_16x16x32_bf16 v[208:211], a[200:203], v[136:139], v[208:211]
    v_mfma_f32_16x16x32_bf16 v[212:215], a[204:207], v[136:139], v[212:215]
    s_add_u32 s29, s29, 0x10000
    s_min_u32 s29, s29, 0x3f0000
    v_mfma_f32_16x16x32_bf16 v[216:219], a[200:203], v[140:143], v[216:219]
    v_mfma_f32_16x16x32_bf16 v[220:223], a[204:207], v[140:143], v[220:223]
    s_waitcnt vmcnt(2) lgkmcnt(0)
    s_barrier
    v_mfma_f32_16x16x32_bf16 v[208:211], a[208:211], v[144:147], v[208:211]
    ds_read_b128 v[64:67], v8 offset:0
    ds_read_b128 v[68:71], v8 offset:32768
    v_mfma_f32_16x16x32_bf16 v[212:215], a[212:215], v[144:147], v[212:215]
    s_add_u32 m0, s6, 65536
    v_mfma_f32_16x16x32_bf16 v[216:219], a[208:211], v[148:151], v[216:219]
    ds_read_b128 v[72:75], v9 offset:0
    ds_read_b128 v[76:79], v9 offset:32768
    v_mfma_f32_16x16x32_bf16 v[220:223], a[212:215], v[148:151], v[220:223]
    buffer_load_dwordx4 v16, s[12:15], s29 offen offset:0 lds
    v_mfma_f32_16x16x32_bf16 v[208:211], a[216:219], v[152:155], v[208:211]
    ds_read_b128 v[80:83], v10 offset:0
    ds_read_b128 v[84:87], v10 offset:32768
    v_mfma_f32_16x16x32_bf16 v[212:215], a[220:223], v[152:155], v[212:215]
    v_mfma_f32_16x16x32_bf16 v[216:219], a[216:219], v[156:159], v[216:219]
    ds_read_b128 v[88:91], v11 offset:0
    ds_read_b128 v[92:95], v11 offset:32768
    v_mfma_f32_16x16x32_bf16 v[220:223], a[220:223], v[156:159], v[220:223]
    buffer_load_dwordx4 v16, s[12:15], s29 offen offset:1024 lds
    v_mfma_f32_16x16x32_bf16 v[208:211], a[224:227], v[160:163], v[208:211]
    ds_read_b128 v[96:99], v8 offset:256
    v_mfma_f32_16x16x32_bf16 v[212:215], a[228:231], v[160:163], v[212:215]
    v_mfma_f32_16x16x32_bf16 v[216:219], a[224:227], v[164:167], v[216:219]
    ds_read_b128 v[100:103], v8 offset:33024
    v_mfma_f32_16x16x32_bf16 v[220:223], a[228:231], v[164:167], v[220:223]
    buffer_load_dwordx4 v17, s[12:15], s29 offen offset:2048 lds
    v_mfma_f32_16x16x32_bf16 v[208:211], a[232:235], v[168:171], v[208:211]
    ds_read_b128 v[104:107], v9 offset:256
    v_mfma_f32_16x16x32_bf16 v[212:215], a[236:239], v[168:171], v[212:215]
    v_mfma_f32_16x16x32_bf16 v[216:219], a[232:235], v[172:175], v[216:219]
    ds_read_b128 v[108:111], v9 offset:33024
    v_mfma_f32_16x16x32_bf16 v[220:223], a[236:239], v[172:175], v[220:223]
    buffer_load_dwordx4 v17, s[12:15], s29 offen offset:3072 lds
    v_mfma_f32_16x16x32_bf16 v[208:211], a[240:243], v[176:179], v[208:211]
    ds_read_b128 v[112:115], v10 offset:256
    v_mfma_f32_16x16x32_bf16 v[212:215], a[244:247], v[176:179], v[212:215]
    s_add_u32 m0, s6, 69632
    v_mfma_f32_16x16x32_bf16 v[216:219], a[240:243], v[180:183], v[216:219]
    ds_read_b128 v[116:119], v10 offset:33024
    v_mfma_f32_16x16x32_bf16 v[220:223], a[244:247], v[180:183], v[220:223]
    buffer_load_dwordx4 v18, s[12:15], s29 offen offset:0 lds
    v_mfma_f32_16x16x32_bf16 v[208:211], a[248:251], v[184:187], v[208:211]
    ds_read_b128 v[120:123], v11 offset:256
    v_mfma_f32_16x16x32_bf16 v[212:215], a[252:255], v[184:187], v[212:215]
    v_mfma_f32_16x16x32_bf16 v[216:219], a[248:251], v[188:191], v[216:219]
    ds_read_b128 v[124:127], v11 offset:33024
    v_mfma_f32_16x16x32_bf16 v[220:223], a[252:255], v[188:191], v[220:223]
    buffer_load_dwordx4 v18, s[12:15], s29 offen offset:1024 lds
    s_cmp_lt_u32 s28, 64
    s_cbranch_scc1 .ql_310
    s_branch .qe_309
.vt_308:
.p2align 6
.ql_311:
    s_waitcnt lgkmcnt(12)
    v_mfma_f32_16x16x32_bf16 v[192:195], v[64:67], a[0:3], 0
    ds_read_b128 v[128:131], v8 offset:512
    v_mfma_f32_16x16x32_bf16 v[200:203], v[64:67], a[4:7], 0
    v_mfma_f32_16x16x32_bf16 v[196:199], v[68:71], a[0:3], 0
    ds_read_b128 v[132:135], v8 offset:33280
    v_mfma_f32_16x16x32_bf16 v[204:207], v[68:71], a[4:7], 0
    buffer_load_dwordx4 v19, s[12:15], s29 offen offset:2048 lds
    v_mfma_f32_16x16x32_bf16 v[192:195], v[72:75], a[8:11], v[192:195]
    ds_read_b128 v[136:139], v9 offset:512
    v_mfma_f32_16x16x32_bf16 v[200:203], v[72:75], a[12:15], v[200:203]
    v_cvt_pk_bf16_f32 v224, v208, v209
    v_cvt_pk_bf16_f32 v225, v210, v211
    v_mfma_f32_16x16x32_bf16 v[196:199], v[76:79], a[8:11], v[196:199]
    ds_read_b128 v[140:143], v9 offset:33280
    v_mfma_f32_16x16x32_bf16 v[204:207], v[76:79], a[12:15], v[204:207]
    buffer_load_dwordx4 v19, s[12:15], s29 offen offset:3072 lds
    s_waitcnt lgkmcnt(12)
    v_mfma_f32_16x16x32_bf16 v[192:195], v[80:83], a[16:19], v[192:195]
    ds_read_b128 v[144:147], v10 offset:512
    v_mfma_f32_16x16x32_bf16 v[200:203], v[80:83], a[20:23], v[200:203]
    s_add_u32 m0, s6, 73728
    v_cvt_pk_bf16_f32 v226, v212, v213
    v_cvt_pk_bf16_f32 v227, v214, v215
    v_mfma_f32_16x16x32_bf16 v[196:199], v[84:87], a[16:19], v[196:199]
    ds_read_b128 v[148:151], v10 offset:33280
    v_mfma_f32_16x16x32_bf16 v[204:207], v[84:87], a[20:23], v[204:207]
    buffer_load_dwordx4 v20, s[12:15], s29 offen offset:0 lds
    v_mfma_f32_16x16x32_bf16 v[192:195], v[88:91], a[24:27], v[192:195]
    ds_read_b128 v[152:155], v11 offset:512
    v_cvt_pk_bf16_f32 v228, v216, v217
    v_mfma_f32_16x16x32_bf16 v[200:203], v[88:91], a[28:31], v[200:203]
    buffer_store_dwordx4 v[224:227], v24, s[8:11], s30 offen sc1
    v_mfma_f32_16x16x32_bf16 v[196:199], v[92:95], a[24:27], v[196:199]
    ds_read_b128 v[156:159], v11 offset:33280
    v_cvt_pk_bf16_f32 v229, v218, v219
    v_mfma_f32_16x16x32_bf16 v[204:207], v[92:95], a[28:31], v[204:207]
    buffer_load_dwordx4 v20, s[12:15], s29 offen offset:1024 lds
    s_waitcnt lgkmcnt(12)
    v_mfma_f32_16x16x32_bf16 v[192:195], v[96:99], a[32:35], v[192:195]
    ds_read_b128 v[160:163], v8 offset:768
    v_mfma_f32_16x16x32_bf16 v[200:203], v[96:99], a[36:39], v[200:203]
    v_cvt_pk_bf16_f32 v230, v220, v221
    v_cvt_pk_bf16_f32 v231, v222, v223
    v_mfma_f32_16x16x32_bf16 v[196:199], v[100:103], a[32:35], v[196:199]
    ds_read_b128 v[164:167], v8 offset:33536
    v_mfma_f32_16x16x32_bf16 v[204:207], v[100:103], a[36:39], v[204:207]
    buffer_load_dwordx4 v21, s[12:15], s29 offen offset:2048 lds
    v_mfma_f32_16x16x32_bf16 v[192:195], v[104:107], a[40:43], v[192:195]
    ds_read_b128 v[168:171], v9 offset:768
    v_mfma_f32_16x16x32_bf16 v[200:203], v[104:107], a[44:47], v[200:203]
    buffer_store_dwordx4 v[228:231], v25, s[8:11], s30 offen sc1
    v_mfma_f32_16x16x32_bf16 v[196:199], v[108:111], a[40:43], v[196:199]
    ds_read_b128 v[172:175], v9 offset:33536
    v_mfma_f32_16x16x32_bf16 v[204:207], v[108:111], a[44:47], v[204:207]
    buffer_load_dwordx4 v21, s[12:15], s29 offen offset:3072 lds
    s_waitcnt lgkmcnt(12)
    v_mfma_f32_16x16x32_bf16 v[192:195], v[112:115], a[48:51], v[192:195]
    ds_read_b128 v[176:179], v10 offset:768
    v_mfma_f32_16x16x32_bf16 v[200:203], v[112:115], a[52:55], v[200:203]
    s_add_u32 m0, s6, 77824
    s_mov_b32 s30, s31
    v_mfma_f32_16x16x32_bf16 v[196:199], v[116:119], a[48:51], v[196:199]
    ds_read_b128 v[180:183], v10 offset:33536
    v_mfma_f32_16x16x32_bf16 v[204:207], v[116:119], a[52:55], v[204:207]
    buffer_load_dwordx4 v22, s[12:15], s29 offen offset:0 lds
    v_mfma_f32_16x16x32_bf16 v[192:195], v[120:123], a[56:59], v[192:195]
    ds_read_b128 v[184:187], v11 offset:768
    v_mfma_f32_16x16x32_bf16 v[200:203], v[120:123], a[60:63], v[200:203]
    s_add_u32 s31, s31, 262144
    v_mfma_f32_16x16x32_bf16 v[196:199], v[124:127], a[56:59], v[196:199]
    ds_read_b128 v[188:191], v11 offset:33536
    v_mfma_f32_16x16x32_bf16 v[204:207], v[124:127], a[60:63], v[204:207]
    buffer_load_dwordx4 v22, s[12:15], s29 offen offset:1024 lds
    s_waitcnt lgkmcnt(12)
    v_mfma_f32_16x16x32_bf16 v[192:195], v[128:131], a[64:67], v[192:195]
    ds_read_b128 v[64:67], v8 offset:1024
    v_mfma_f32_16x16x32_bf16 v[200:203], v[128:131], a[68:71], v[200:203]
    v_mfma_f32_16x16x32_bf16 v[196:199], v[132:135], a[64:67], v[196:199]
    ds_read_b128 v[68:71], v8 offset:33792
    v_mfma_f32_16x16x32_bf16 v[204:207], v[132:135], a[68:71], v[204:207]
    buffer_load_dwordx4 v23, s[12:15], s29 offen offset:2048 lds
    v_mfma_f32_16x16x32_bf16 v[192:195], v[136:139], a[72:75], v[192:195]
    ds_read_b128 v[72:75], v9 offset:1024
    v_mfma_f32_16x16x32_bf16 v[200:203], v[136:139], a[76:79], v[200:203]
    v_mfma_f32_16x16x32_bf16 v[196:199], v[140:143], a[72:75], v[196:199]
    ds_read_b128 v[76:79], v9 offset:33792
    v_mfma_f32_16x16x32_bf16 v[204:207], v[140:143], a[76:79], v[204:207]
    buffer_load_dwordx4 v23, s[12:15], s29 offen offset:3072 lds
    s_waitcnt lgkmcnt(12)
    v_mfma_f32_16x16x32_bf16 v[192:195], v[144:147], a[80:83], v[192:195]
    ds_read_b128 v[80:83], v10 offset:1024
    v_mfma_f32_16x16x32_bf16 v[200:203], v[144:147], a[84:87], v[200:203]
    v_mfma_f32_16x16x32_bf16 v[196:199], v[148:151], a[80:83], v[196:199]
    ds_read_b128 v[84:87], v10 offset:33792
    v_mfma_f32_16x16x32_bf16 v[204:207], v[148:151], a[84:87], v[204:207]
    buffer_load_dword v29, v28, s[12:15], s29 offen
    v_mfma_f32_16x16x32_bf16 v[192:195], v[152:155], a[88:91], v[192:195]
    ds_read_b128 v[88:91], v11 offset:1024
    v_mfma_f32_16x16x32_bf16 v[200:203], v[152:155], a[92:95], v[200:203]
    v_mfma_f32_16x16x32_bf16 v[196:199], v[156:159], a[88:91], v[196:199]
    ds_read_b128 v[92:95], v11 offset:33792
    v_mfma_f32_16x16x32_bf16 v[204:207], v[156:159], a[92:95], v[204:207]
    s_waitcnt lgkmcnt(12)
    v_mfma_f32_16x16x32_bf16 v[192:195], v[160:163], a[96:99], v[192:195]
    ds_read_b128 v[96:99], v8 offset:1280
    v_mfma_f32_16x16x32_bf16 v[200:203], v[160:163], a[100:103], v[200:203]
    v_mfma_f32_16x16x32_bf16 v[196:199], v[164:167], a[96:99], v[196:199]
    ds_read_b128 v[100:103], v8 offset:34048
    v_mfma_f32_16x16x32_bf16 v[204:207], v[164:167], a[100:103], v[204:207]
    v_mfma_f32_16x16x32_bf16 v[192:195], v[168:171], a[104:107], v[192:195]
    ds_read_b128 v[104:107], v9 offset:1280
    v_mfma_f32_16x16x32_bf16 v[200:203], v[168:171], a[108:111], v[200:203]
    v_mfma_f32_16x16x32_bf16 v[196:199], v[172:175], a[104:107], v[196:199]
    ds_read_b128 v[108:111], v9 offset:34048
    v_mfma_f32_16x16x32_bf16 v[204:207], v[172:175], a[108:111], v[204:207]
    s_waitcnt lgkmcnt(12)
    v_mfma_f32_16x16x32_bf16 v[192:195], v[176:179], a[112:115], v[192:195]
    ds_read_b128 v[112:115], v10 offset:1280
    v_mfma_f32_16x16x32_bf16 v[200:203], v[176:179], a[116:119], v[200:203]
    v_mfma_f32_16x16x32_bf16 v[196:199], v[180:183], a[112:115], v[196:199]
    ds_read_b128 v[116:119], v10 offset:34048
    v_mfma_f32_16x16x32_bf16 v[204:207], v[180:183], a[116:119], v[204:207]
    v_mfma_f32_16x16x32_bf16 v[192:195], v[184:187], a[120:123], v[192:195]
    ds_read_b128 v[120:123], v11 offset:1280
    v_mfma_f32_16x16x32_bf16 v[200:203], v[184:187], a[124:127], v[200:203]
    v_mfma_f32_16x16x32_bf16 v[196:199], v[188:191], a[120:123], v[196:199]
    ds_read_b128 v[124:127], v11 offset:34048
    v_mfma_f32_16x16x32_bf16 v[204:207], v[188:191], a[124:127], v[204:207]
    s_waitcnt lgkmcnt(12)
    v_mfma_f32_16x16x32_bf16 v[192:195], v[64:67], a[128:131], v[192:195]
    ds_read_b128 v[128:131], v8 offset:1536
    v_mfma_f32_16x16x32_bf16 v[200:203], v[64:67], a[132:135], v[200:203]
    v_mfma_f32_16x16x32_bf16 v[196:199], v[68:71], a[128:131], v[196:199]
    ds_read_b128 v[132:135], v8 offset:34304
    v_mfma_f32_16x16x32_bf16 v[204:207], v[68:71], a[132:135], v[204:207]
    v_mfma_f32_16x16x32_bf16 v[192:195], v[72:75], a[136:139], v[192:195]
    ds_read_b128 v[136:139], v9 offset:1536
    v_mfma_f32_16x16x32_bf16 v[200:203], v[72:75], a[140:143], v[200:203]
    v_mfma_f32_16x16x32_bf16 v[196:199], v[76:79], a[136:139], v[196:199]
    ds_read_b128 v[140:143], v9 offset:34304
    v_mfma_f32_16x16x32_bf16 v[204:207], v[76:79], a[140:143], v[204:207]
    s_waitcnt lgkmcnt(12)
    v_mfma_f32_16x16x32_bf16 v[192:195], v[80:83], a[144:147], v[192:195]
    ds_read_b128 v[144:147], v10 offset:1536
    v_mfma_f32_16x16x32_bf16 v[200:203], v[80:83], a[148:151], v[200:203]
    v_mfma_f32_16x16x32_bf16 v[196:199], v[84:87], a[144:147], v[196:199]
    ds_read_b128 v[148:151], v10 offset:34304
    v_mfma_f32_16x16x32_bf16 v[204:207], v[84:87], a[148:151], v[204:207]
    v_mfma_f32_16x16x32_bf16 v[192:195], v[88:91], a[152:155], v[192:195]
    ds_read_b128 v[152:155], v11 offset:1536
    v_mfma_f32_16x16x32_bf16 v[200:203], v[88:91], a[156:159], v[200:203]
    v_mfma_f32_16x16x32_bf16 v[196:199], v[92:95], a[152:155], v[196:199]
    ds_read_b128 v[156:159], v11 offset:34304
    v_mfma_f32_16x16x32_bf16 v[204:207], v[92:95], a[156:159], v[204:207]
    s_waitcnt lgkmcnt(12)
    v_mfma_f32_16x16x32_bf16 v[192:195], v[96:99], a[160:163], v[192:195]
    ds_read_b128 v[160:163], v8 offset:1792
    v_mfma_f32_16x16x32_bf16 v[200:203], v[96:99], a[164:167], v[200:203]
    v_mfma_f32_16x16x32_bf16 v[196:199], v[100:103], a[160:163], v[196:199]
    ds_read_b128 v[164:167], v8 offset:34560
    v_mfma_f32_16x16x32_bf16 v[204:207], v[100:103], a[164:167], v[204:207]
    v_mfma_f32_16x16x32_bf16 v[192:195], v[104:107], a[168:171], v[192:195]
    ds_read_b128 v[168:171], v9 offset:1792
    v_mfma_f32_16x16x32_bf16 v[200:203], v[104:107], a[172:175], v[200:203]
    v_mfma_f32_16x16x32_bf16 v[196:199], v[108:111], a[168:171], v[196:199]
    ds_read_b128 v[172:175], v9 offset:34560
    v_mfma_f32_16x16x32_bf16 v[204:207], v[108:111], a[172:175], v[204:207]
    s_waitcnt lgkmcnt(12)
    v_mfma_f32_16x16x32_bf16 v[192:195], v[112:115], a[176:179], v[192:195]
    ds_read_b128 v[176:179], v10 offset:1792
    v_mfma_f32_16x16x32_bf16 v[200:203], v[112:115], a[180:183], v[200:203]
    s_waitcnt vmcnt(6)
    v_mov_b32 v27, s28
    s_mov_b64 exec, 1
    buffer_store_dword v27, v26, s[8:11], s94 offen sc1
    s_mov_b64 exec, -1
    v_mfma_f32_16x16x32_bf16 v[196:199], v[116:119], a[176:179], v[196:199]
    ds_read_b128 v[180:183], v10 offset:34560
    v_mfma_f32_16x16x32_bf16 v[204:207], v[116:119], a[180:183], v[204:207]
    v_mfma_f32_16x16x32_bf16 v[192:195], v[120:123], a[184:187], v[192:195]
    ds_read_b128 v[184:187], v11 offset:1792
    v_mfma_f32_16x16x32_bf16 v[200:203], v[120:123], a[188:191], v[200:203]
    s_add_u32 s28, s28, 1
    v_mfma_f32_16x16x32_bf16 v[196:199], v[124:127], a[184:187], v[196:199]
    ds_read_b128 v[188:191], v11 offset:34560
    v_mfma_f32_16x16x32_bf16 v[204:207], v[124:127], a[188:191], v[204:207]
    s_waitcnt lgkmcnt(12)
    v_mfma_f32_16x16x32_bf16 v[192:195], v[128:131], a[192:195], v[192:195]
    v_mfma_f32_16x16x32_bf16 v[200:203], v[128:131], a[196:199], v[200:203]
    v_mfma_f32_16x16x32_bf16 v[196:199], v[132:135], a[192:195], v[196:199]
    v_mfma_f32_16x16x32_bf16 v[204:207], v[132:135], a[196:199], v[204:207]
    v_mfma_f32_16x16x32_bf16 v[192:195], v[136:139], a[200:203], v[192:195]
    v_mfma_f32_16x16x32_bf16 v[200:203], v[136:139], a[204:207], v[200:203]
    s_add_u32 s29, s29, 0x10000
    s_min_u32 s29, s29, 0x3f0000
    v_mfma_f32_16x16x32_bf16 v[196:199], v[140:143], a[200:203], v[196:199]
    v_mfma_f32_16x16x32_bf16 v[204:207], v[140:143], a[204:207], v[204:207]
    s_waitcnt vmcnt(2) lgkmcnt(0)
    s_barrier
    v_mfma_f32_16x16x32_bf16 v[192:195], v[144:147], a[208:211], v[192:195]
    ds_read_b128 v[64:67], v12 offset:0
    ds_read_b128 v[68:71], v12 offset:32768
    v_mfma_f32_16x16x32_bf16 v[200:203], v[144:147], a[212:215], v[200:203]
    s_add_u32 m0, s6, 0
    v_mfma_f32_16x16x32_bf16 v[196:199], v[148:151], a[208:211], v[196:199]
    ds_read_b128 v[72:75], v13 offset:0
    ds_read_b128 v[76:79], v13 offset:32768
    v_mfma_f32_16x16x32_bf16 v[204:207], v[148:151], a[212:215], v[204:207]
    buffer_load_dwordx4 v16, s[12:15], s29 offen offset:0 lds
    v_mfma_f32_16x16x32_bf16 v[192:195], v[152:155], a[216:219], v[192:195]
    ds_read_b128 v[80:83], v14 offset:0
    ds_read_b128 v[84:87], v14 offset:32768
    v_mfma_f32_16x16x32_bf16 v[200:203], v[152:155], a[220:223], v[200:203]
    v_mfma_f32_16x16x32_bf16 v[196:199], v[156:159], a[216:219], v[196:199]
    ds_read_b128 v[88:91], v15 offset:0
    ds_read_b128 v[92:95], v15 offset:32768
    v_mfma_f32_16x16x32_bf16 v[204:207], v[156:159], a[220:223], v[204:207]
    buffer_load_dwordx4 v16, s[12:15], s29 offen offset:1024 lds
    v_mfma_f32_16x16x32_bf16 v[192:195], v[160:163], a[224:227], v[192:195]
    ds_read_b128 v[96:99], v12 offset:256
    v_mfma_f32_16x16x32_bf16 v[200:203], v[160:163], a[228:231], v[200:203]
    v_mfma_f32_16x16x32_bf16 v[196:199], v[164:167], a[224:227], v[196:199]
    ds_read_b128 v[100:103], v12 offset:33024
    v_mfma_f32_16x16x32_bf16 v[204:207], v[164:167], a[228:231], v[204:207]
    buffer_load_dwordx4 v17, s[12:15], s29 offen offset:2048 lds
    v_mfma_f32_16x16x32_bf16 v[192:195], v[168:171], a[232:235], v[192:195]
    ds_read_b128 v[104:107], v13 offset:256
    v_mfma_f32_16x16x32_bf16 v[200:203], v[168:171], a[236:239], v[200:203]
    v_mfma_f32_16x16x32_bf16 v[196:199], v[172:175], a[232:235], v[196:199]
    ds_read_b128 v[108:111], v13 offset:33024
    v_mfma_f32_16x16x32_bf16 v[204:207], v[172:175], a[236:239], v[204:207]
    buffer_load_dwordx4 v17, s[12:15], s29 offen offset:3072 lds
    v_mfma_f32_16x16x32_bf16 v[192:195], v[176:179], a[240:243], v[192:195]
    ds_read_b128 v[112:115], v14 offset:256
    v_mfma_f32_16x16x32_bf16 v[200:203], v[176:179], a[244:247], v[200:203]
    s_add_u32 m0, s6, 4096
    v_mfma_f32_16x16x32_bf16 v[196:199], v[180:183], a[240:243], v[196:199]
    ds_read_b128 v[116:119], v14 offset:33024
    v_mfma_f32_16x16x32_bf16 v[204:207], v[180:183], a[244:247], v[204:207]
    buffer_load_dwordx4 v18, s[12:15], s29 offen offset:0 lds
    v_mfma_f32_16x16x32_bf16 v[192:195], v[184:187], a[248:251], v[192:195]
    ds_read_b128 v[120:123], v15 offset:256
    v_mfma_f32_16x16x32_bf16 v[200:203], v[184:187], a[252:255], v[200:203]
    v_mfma_f32_16x16x32_bf16 v[196:199], v[188:191], a[248:251], v[196:199]
    ds_read_b128 v[124:127], v15 offset:33024
    v_mfma_f32_16x16x32_bf16 v[204:207], v[188:191], a[252:255], v[204:207]
    buffer_load_dwordx4 v18, s[12:15], s29 offen offset:1024 lds
    s_waitcnt lgkmcnt(12)
    v_mfma_f32_16x16x32_bf16 v[208:211], v[64:67], a[0:3], 0
    ds_read_b128 v[128:131], v12 offset:512
    v_mfma_f32_16x16x32_bf16 v[216:219], v[64:67], a[4:7], 0
    v_mfma_f32_16x16x32_bf16 v[212:215], v[68:71], a[0:3], 0
    ds_read_b128 v[132:135], v12 offset:33280
    v_mfma_f32_16x16x32_bf16 v[220:223], v[68:71], a[4:7], 0
    buffer_load_dwordx4 v19, s[12:15], s29 offen offset:2048 lds
    v_mfma_f32_16x16x32_bf16 v[208:211], v[72:75], a[8:11], v[208:211]
    ds_read_b128 v[136:139], v13 offset:512
    v_mfma_f32_16x16x32_bf16 v[216:219], v[72:75], a[12:15], v[216:219]
    v_cvt_pk_bf16_f32 v224, v192, v193
    v_cvt_pk_bf16_f32 v225, v194, v195
    v_mfma_f32_16x16x32_bf16 v[212:215], v[76:79], a[8:11], v[212:215]
    ds_read_b128 v[140:143], v13 offset:33280
    v_mfma_f32_16x16x32_bf16 v[220:223], v[76:79], a[12:15], v[220:223]
    buffer_load_dwordx4 v19, s[12:15], s29 offen offset:3072 lds
    s_waitcnt lgkmcnt(12)
    v_mfma_f32_16x16x32_bf16 v[208:211], v[80:83], a[16:19], v[208:211]
    ds_read_b128 v[144:147], v14 offset:512
    v_mfma_f32_16x16x32_bf16 v[216:219], v[80:83], a[20:23], v[216:219]
    s_add_u32 m0, s6, 8192
    v_cvt_pk_bf16_f32 v226, v196, v197
    v_cvt_pk_bf16_f32 v227, v198, v199
    v_mfma_f32_16x16x32_bf16 v[212:215], v[84:87], a[16:19], v[212:215]
    ds_read_b128 v[148:151], v14 offset:33280
    v_mfma_f32_16x16x32_bf16 v[220:223], v[84:87], a[20:23], v[220:223]
    buffer_load_dwordx4 v20, s[12:15], s29 offen offset:0 lds
    v_mfma_f32_16x16x32_bf16 v[208:211], v[88:91], a[24:27], v[208:211]
    ds_read_b128 v[152:155], v15 offset:512
    v_cvt_pk_bf16_f32 v228, v200, v201
    v_mfma_f32_16x16x32_bf16 v[216:219], v[88:91], a[28:31], v[216:219]
    buffer_store_dwordx4 v[224:227], v24, s[8:11], s30 offen sc1
    v_mfma_f32_16x16x32_bf16 v[212:215], v[92:95], a[24:27], v[212:215]
    ds_read_b128 v[156:159], v15 offset:33280
    v_cvt_pk_bf16_f32 v229, v202, v203
    v_mfma_f32_16x16x32_bf16 v[220:223], v[92:95], a[28:31], v[220:223]
    buffer_load_dwordx4 v20, s[12:15], s29 offen offset:1024 lds
    s_waitcnt lgkmcnt(12)
    v_mfma_f32_16x16x32_bf16 v[208:211], v[96:99], a[32:35], v[208:211]
    ds_read_b128 v[160:163], v12 offset:768
    v_mfma_f32_16x16x32_bf16 v[216:219], v[96:99], a[36:39], v[216:219]
    v_cvt_pk_bf16_f32 v230, v204, v205
    v_cvt_pk_bf16_f32 v231, v206, v207
    v_mfma_f32_16x16x32_bf16 v[212:215], v[100:103], a[32:35], v[212:215]
    ds_read_b128 v[164:167], v12 offset:33536
    v_mfma_f32_16x16x32_bf16 v[220:223], v[100:103], a[36:39], v[220:223]
    buffer_load_dwordx4 v21, s[12:15], s29 offen offset:2048 lds
    v_mfma_f32_16x16x32_bf16 v[208:211], v[104:107], a[40:43], v[208:211]
    ds_read_b128 v[168:171], v13 offset:768
    v_mfma_f32_16x16x32_bf16 v[216:219], v[104:107], a[44:47], v[216:219]
    buffer_store_dwordx4 v[228:231], v25, s[8:11], s30 offen sc1
    v_mfma_f32_16x16x32_bf16 v[212:215], v[108:111], a[40:43], v[212:215]
    ds_read_b128 v[172:175], v13 offset:33536
    v_mfma_f32_16x16x32_bf16 v[220:223], v[108:111], a[44:47], v[220:223]
    buffer_load_dwordx4 v21, s[12:15], s29 offen offset:3072 lds
    s_waitcnt lgkmcnt(12)
    v_mfma_f32_16x16x32_bf16 v[208:211], v[112:115], a[48:51], v[208:211]
    ds_read_b128 v[176:179], v14 offset:768
    v_mfma_f32_16x16x32_bf16 v[216:219], v[112:115], a[52:55], v[216:219]
    s_add_u32 m0, s6, 12288
    s_mov_b32 s30, s31
    v_mfma_f32_16x16x32_bf16 v[212:215], v[116:119], a[48:51], v[212:215]
    ds_read_b128 v[180:183], v14 offset:33536
    v_mfma_f32_16x16x32_bf16 v[220:223], v[116:119], a[52:55], v[220:223]
    buffer_load_dwordx4 v22, s[12:15], s29 offen offset:0 lds
    v_mfma_f32_16x16x32_bf16 v[208:211], v[120:123], a[56:59], v[208:211]
    ds_read_b128 v[184:187], v15 offset:768
    v_mfma_f32_16x16x32_bf16 v[216:219], v[120:123], a[60:63], v[216:219]
    s_add_u32 s31, s31, 262144
    v_mfma_f32_16x16x32_bf16 v[212:215], v[124:127], a[56:59], v[212:215]
    ds_read_b128 v[188:191], v15 offset:33536
    v_mfma_f32_16x16x32_bf16 v[220:223], v[124:127], a[60:63], v[220:223]
    buffer_load_dwordx4 v22, s[12:15], s29 offen offset:1024 lds
    s_waitcnt lgkmcnt(12)
    v_mfma_f32_16x16x32_bf16 v[208:211], v[128:131], a[64:67], v[208:211]
    ds_read_b128 v[64:67], v12 offset:1024
    v_mfma_f32_16x16x32_bf16 v[216:219], v[128:131], a[68:71], v[216:219]
    v_mfma_f32_16x16x32_bf16 v[212:215], v[132:135], a[64:67], v[212:215]
    ds_read_b128 v[68:71], v12 offset:33792
    v_mfma_f32_16x16x32_bf16 v[220:223], v[132:135], a[68:71], v[220:223]
    buffer_load_dwordx4 v23, s[12:15], s29 offen offset:2048 lds
    v_mfma_f32_16x16x32_bf16 v[208:211], v[136:139], a[72:75], v[208:211]
    ds_read_b128 v[72:75], v13 offset:1024
    v_mfma_f32_16x16x32_bf16 v[216:219], v[136:139], a[76:79], v[216:219]
    v_mfma_f32_16x16x32_bf16 v[212:215], v[140:143], a[72:75], v[212:215]
    ds_read_b128 v[76:79], v13 offset:33792
    v_mfma_f32_16x16x32_bf16 v[220:223], v[140:143], a[76:79], v[220:223]
    buffer_load_dwordx4 v23, s[12:15], s29 offen offset:3072 lds
    s_waitcnt lgkmcnt(12)
    v_mfma_f32_16x16x32_bf16 v[208:211], v[144:147], a[80:83], v[208:211]
    ds_read_b128 v[80:83], v14 offset:1024
    v_mfma_f32_16x16x32_bf16 v[216:219], v[144:147], a[84:87], v[216:219]
    v_mfma_f32_16x16x32_bf16 v[212:215], v[148:151], a[80:83], v[212:215]
    ds_read_b128 v[84:87], v14 offset:33792
    v_mfma_f32_16x16x32_bf16 v[220:223], v[148:151], a[84:87], v[220:223]
    buffer_load_dword v29, v28, s[12:15], s29 offen
    v_mfma_f32_16x16x32_bf16 v[208:211], v[152:155], a[88:91], v[208:211]
    ds_read_b128 v[88:91], v15 offset:1024
    v_mfma_f32_16x16x32_bf16 v[216:219], v[152:155], a[92:95], v[216:219]
    v_mfma_f32_16x16x32_bf16 v[212:215], v[156:159], a[88:91], v[212:215]
    ds_read_b128 v[92:95], v15 offset:33792
    v_mfma_f32_16x16x32_bf16 v[220:223], v[156:159], a[92:95], v[220:223]
    s_waitcnt lgkmcnt(12)
    v_mfma_f32_16x16x32_bf16 v[208:211], v[160:163], a[96:99], v[208:211]
    ds_read_b128 v[96:99], v12 offset:1280
    v_mfma_f32_16x16x32_bf16 v[216:219], v[160:163], a[100:103], v[216:219]
    v_mfma_f32_16x16x32_bf16 v[212:215], v[164:167], a[96:99], v[212:215]
    ds_read_b128 v[100:103], v12 offset:34048
    v_mfma_f32_16x16x32_bf16 v[220:223], v[164:167], a[100:103], v[220:223]
    v_mfma_f32_16x16x32_bf16 v[208:211], v[168:171], a[104:107], v[208:211]
    ds_read_b128 v[104:107], v13 offset:1280
    v_mfma_f32_16x16x32_bf16 v[216:219], v[168:171], a[108:111], v[216:219]
    v_mfma_f32_16x16x32_bf16 v[212:215], v[172:175], a[104:107], v[212:215]
    ds_read_b128 v[108:111], v13 offset:34048
    v_mfma_f32_16x16x32_bf16 v[220:223], v[172:175], a[108:111], v[220:223]
    s_waitcnt lgkmcnt(12)
    v_mfma_f32_16x16x32_bf16 v[208:211], v[176:179], a[112:115], v[208:211]
    ds_read_b128 v[112:115], v14 offset:1280
    v_mfma_f32_16x16x32_bf16 v[216:219], v[176:179], a[116:119], v[216:219]
    v_mfma_f32_16x16x32_bf16 v[212:215], v[180:183], a[112:115], v[212:215]
    ds_read_b128 v[116:119], v14 offset:34048
    v_mfma_f32_16x16x32_bf16 v[220:223], v[180:183], a[116:119], v[220:223]
    v_mfma_f32_16x16x32_bf16 v[208:211], v[184:187], a[120:123], v[208:211]
    ds_read_b128 v[120:123], v15 offset:1280
    v_mfma_f32_16x16x32_bf16 v[216:219], v[184:187], a[124:127], v[216:219]
    v_mfma_f32_16x16x32_bf16 v[212:215], v[188:191], a[120:123], v[212:215]
    ds_read_b128 v[124:127], v15 offset:34048
    v_mfma_f32_16x16x32_bf16 v[220:223], v[188:191], a[124:127], v[220:223]
    s_waitcnt lgkmcnt(12)
    v_mfma_f32_16x16x32_bf16 v[208:211], v[64:67], a[128:131], v[208:211]
    ds_read_b128 v[128:131], v12 offset:1536
    v_mfma_f32_16x16x32_bf16 v[216:219], v[64:67], a[132:135], v[216:219]
    v_mfma_f32_16x16x32_bf16 v[212:215], v[68:71], a[128:131], v[212:215]
    ds_read_b128 v[132:135], v12 offset:34304
    v_mfma_f32_16x16x32_bf16 v[220:223], v[68:71], a[132:135], v[220:223]
    v_mfma_f32_16x16x32_bf16 v[208:211], v[72:75], a[136:139], v[208:211]
    ds_read_b128 v[136:139], v13 offset:1536
    v_mfma_f32_16x16x32_bf16 v[216:219], v[72:75], a[140:143], v[216:219]
    v_mfma_f32_16x16x32_bf16 v[212:215], v[76:79], a[136:139], v[212:215]
    ds_read_b128 v[140:143], v13 offset:34304
    v_mfma_f32_16x16x32_bf16 v[220:223], v[76:79], a[140:143], v[220:223]
    s_waitcnt lgkmcnt(12)
    v_mfma_f32_16x16x32_bf16 v[208:211], v[80:83], a[144:147], v[208:211]
    ds_read_b128 v[144:147], v14 offset:1536
    v_mfma_f32_16x16x32_bf16 v[216:219], v[80:83], a[148:151], v[216:219]
    v_mfma_f32_16x16x32_bf16 v[212:215], v[84:87], a[144:147], v[212:215]
    ds_read_b128 v[148:151], v14 offset:34304
    v_mfma_f32_16x16x32_bf16 v[220:223], v[84:87], a[148:151], v[220:223]
    v_mfma_f32_16x16x32_bf16 v[208:211], v[88:91], a[152:155], v[208:211]
    ds_read_b128 v[152:155], v15 offset:1536
    v_mfma_f32_16x16x32_bf16 v[216:219], v[88:91], a[156:159], v[216:219]
    v_mfma_f32_16x16x32_bf16 v[212:215], v[92:95], a[152:155], v[212:215]
    ds_read_b128 v[156:159], v15 offset:34304
    v_mfma_f32_16x16x32_bf16 v[220:223], v[92:95], a[156:159], v[220:223]
    s_waitcnt lgkmcnt(12)
    v_mfma_f32_16x16x32_bf16 v[208:211], v[96:99], a[160:163], v[208:211]
    ds_read_b128 v[160:163], v12 offset:1792
    v_mfma_f32_16x16x32_bf16 v[216:219], v[96:99], a[164:167], v[216:219]
    v_mfma_f32_16x16x32_bf16 v[212:215], v[100:103], a[160:163], v[212:215]
    ds_read_b128 v[164:167], v12 offset:34560
    v_mfma_f32_16x16x32_bf16 v[220:223], v[100:103], a[164:167], v[220:223]
    v_mfma_f32_16x16x32_bf16 v[208:211], v[104:107], a[168:171], v[208:211]
    ds_read_b128 v[168:171], v13 offset:1792
    v_mfma_f32_16x16x32_bf16 v[216:219], v[104:107], a[172:175], v[216:219]
    v_mfma_f32_16x16x32_bf16 v[212:215], v[108:111], a[168:171], v[212:215]
    ds_read_b128 v[172:175], v13 offset:34560
    v_mfma_f32_16x16x32_bf16 v[220:223], v[108:111], a[172:175], v[220:223]
    s_waitcnt lgkmcnt(12)
    v_mfma_f32_16x16x32_bf16 v[208:211], v[112:115], a[176:179], v[208:211]
    ds_read_b128 v[176:179], v14 offset:1792
    v_mfma_f32_16x16x32_bf16 v[216:219], v[112:115], a[180:183], v[216:219]
    s_waitcnt vmcnt(6)
    v_mov_b32 v27, s28
    s_mov_b64 exec, 1
    buffer_store_dword v27, v26, s[8:11], s94 offen sc1
    s_mov_b64 exec, -1
    v_mfma_f32_16x16x32_bf16 v[212:215], v[116:119], a[176:179], v[212:215]
    ds_read_b128 v[180:183], v14 offset:34560
    v_mfma_f32_16x16x32_bf16 v[220:223], v[116:119], a[180:183], v[220:223]
    v_mfma_f32_16x16x32_bf16 v[208:211], v[120:123], a[184:187], v[208:211]
    ds_read_b128 v[184:187], v15 offset:1792
    v_mfma_f32_16x16x32_bf16 v[216:219], v[120:123], a[188:191], v[216:219]
    s_add_u32 s28, s28, 1
    v_mfma_f32_16x16x32_bf16 v[212:215], v[124:127], a[184:187], v[212:215]
    ds_read_b128 v[188:191], v15 offset:34560
    v_mfma_f32_16x16x32_bf16 v[220:223], v[124:127], a[188:191], v[220:223]
    s_waitcnt lgkmcnt(12)
    v_mfma_f32_16x16x32_bf16 v[208:211], v[128:131], a[192:195], v[208:211]
    v_mfma_f32_16x16x32_bf16 v[216:219], v[128:131], a[196:199], v[216:219]
    v_mfma_f32_16x16x32_bf16 v[212:215], v[132:135], a[192:195], v[212:215]
    v_mfma_f32_16x16x32_bf16 v[220:223], v[132:135], a[196:199], v[220:223]
    v_mfma_f32_16x16x32_bf16 v[208:211], v[136:139], a[200:203], v[208:211]
    v_mfma_f32_16x16x32_bf16 v[216:219], v[136:139], a[204:207], v[216:219]
    s_add_u32 s29, s29, 0x10000
    s_min_u32 s29, s29, 0x3f0000
    v_mfma_f32_16x16x32_bf16 v[212:215], v[140:143], a[200:203], v[212:215]
    v_mfma_f32_16x16x32_bf16 v[220:223], v[140:143], a[204:207], v[220:223]
    s_waitcnt vmcnt(2) lgkmcnt(0)
    s_barrier
    v_mfma_f32_16x16x32_bf16 v[208:211], v[144:147], a[208:211], v[208:211]
    ds_read_b128 v[64:67], v8 offset:0
    ds_read_b128 v[68:71], v8 offset:32768
    v_mfma_f32_16x16x32_bf16 v[216:219], v[144:147], a[212:215], v[216:219]
    s_add_u32 m0, s6, 65536
    v_mfma_f32_16x16x32_bf16 v[212:215], v[148:151], a[208:211], v[212:215]
    ds_read_b128 v[72:75], v9 offset:0
    ds_read_b128 v[76:79], v9 offset:32768
    v_mfma_f32_16x16x32_bf16 v[220:223], v[148:151], a[212:215], v[220:223]
    buffer_load_dwordx4 v16, s[12:15], s29 offen offset:0 lds
    v_mfma_f32_16x16x32_bf16 v[208:211], v[152:155], a[216:219], v[208:211]
    ds_read_b128 v[80:83], v10 offset:0
    ds_read_b128 v[84:87], v10 offset:32768
    v_mfma_f32_16x16x32_bf16 v[216:219], v[152:155], a[220:223], v[216:219]
    v_mfma_f32_16x16x32_bf16 v[212:215], v[156:159], a[216:219], v[212:215]
    ds_read_b128 v[88:91], v11 offset:0
    ds_read_b128 v[92:95], v11 offset:32768
    v_mfma_f32_16x16x32_bf16 v[220:223], v[156:159], a[220:223], v[220:223]
    buffer_load_dwordx4 v16, s[12:15], s29 offen offset:1024 lds
    v_mfma_f32_16x16x32_bf16 v[208:211], v[160:163], a[224:227], v[208:211]
    ds_read_b128 v[96:99], v8 offset:256
    v_mfma_f32_16x16x32_bf16 v[216:219], v[160:163], a[228:231], v[216:219]
    v_mfma_f32_16x16x32_bf16 v[212:215], v[164:167], a[224:227], v[212:215]
    ds_read_b128 v[100:103], v8 offset:33024
    v_mfma_f32_16x16x32_bf16 v[220:223], v[164:167], a[228:231], v[220:223]
    buffer_load_dwordx4 v17, s[12:15], s29 offen offset:2048 lds
    v_mfma_f32_16x16x32_bf16 v[208:211], v[168:171], a[232:235], v[208:211]
    ds_read_b128 v[104:107], v9 offset:256
    v_mfma_f32_16x16x32_bf16 v[216:219], v[168:171], a[236:239], v[216:219]
    v_mfma_f32_16x16x32_bf16 v[212:215], v[172:175], a[232:235], v[212:215]
    ds_read_b128 v[108:111], v9 offset:33024
    v_mfma_f32_16x16x32_bf16 v[220:223], v[172:175], a[236:239], v[220:223]
    buffer_load_dwordx4 v17, s[12:15], s29 offen offset:3072 lds
    v_mfma_f32_16x16x32_bf16 v[208:211], v[176:179], a[240:243], v[208:211]
    ds_read_b128 v[112:115], v10 offset:256
    v_mfma_f32_16x16x32_bf16 v[216:219], v[176:179], a[244:247], v[216:219]
    s_add_u32 m0, s6, 69632
    v_mfma_f32_16x16x32_bf16 v[212:215], v[180:183], a[240:243], v[212:215]
    ds_read_b128 v[116:119], v10 offset:33024
    v_mfma_f32_16x16x32_bf16 v[220:223], v[180:183], a[244:247], v[220:223]
    buffer_load_dwordx4 v18, s[12:15], s29 offen offset:0 lds
    v_mfma_f32_16x16x32_bf16 v[208:211], v[184:187], a[248:251], v[208:211]
    ds_read_b128 v[120:123], v11 offset:256
    v_mfma_f32_16x16x32_bf16 v[216:219], v[184:187], a[252:255], v[216:219]
    v_mfma_f32_16x16x32_bf16 v[212:215], v[188:191], a[248:251], v[212:215]
    ds_read_b128 v[124:127], v11 offset:33024
    v_mfma_f32_16x16x32_bf16 v[220:223], v[188:191], a[252:255], v[220:223]
    buffer_load_dwordx4 v18, s[12:15], s29 offen offset:1024 lds
    s_cmp_lt_u32 s28, 64
    s_cbranch_scc1 .ql_311
.qe_309:
    s_nop 7
    v_cvt_pk_bf16_f32 v224, v208, v209
    v_cvt_pk_bf16_f32 v225, v210, v211
    v_cvt_pk_bf16_f32 v226, v212, v213
    v_cvt_pk_bf16_f32 v227, v214, v215
    v_cvt_pk_bf16_f32 v228, v216, v217
    v_cvt_pk_bf16_f32 v229, v218, v219
    v_cvt_pk_bf16_f32 v230, v220, v221
    v_cvt_pk_bf16_f32 v231, v222, v223
    buffer_store_dwordx4 v[224:227], v24, s[8:11], s30 offen sc1
    buffer_store_dwordx4 v[228:231], v25, s[8:11], s30 offen sc1
    s_waitcnt vmcnt(0) lgkmcnt(0)
    v_mov_b32 v27, s28
    s_mov_b64 exec, 1
    buffer_store_dword v27, v26, s[8:11], s94 offen sc1
    s_mov_b64 exec, -1
    s_branch .fin_312
.qa_307:
    s_and_b32 s34, s24, 1
    s_lshr_b32 s35, s24, 1
    s_lshl_b32 s4, s35, 10
    s_add_u32 s4, s4, 2048
    v_lshlrev_b32 v2, 4, v1
    s_lshl_b32 s5, s24, 10
    s_add_u32 s5, s5, 131072
    v_add_u32 v24, s5, v2
    s_lshl_b32 s5, s34, 12
    s_add_u32 s5, s5, 131072
    v_add_u32 v25, s5, v2
    v_add_u32 v31, 139264, v2
    s_lshl_b32 s5, s35, 12
    v_add_u32 v5, s5, v31
    s_lshl_b32 s43, s24, 11
    v_bfe_u32 v254, v1, 4, 2
    v_mul_u32_u24 v3, 128, v254
    v_bfe_u32 v254, v1, 2, 2
    v_mul_u32_u24 v254, 32, v254
    v_add_u32 v3, v3, v254
    v_bfe_u32 v254, v1, 0, 1
    v_mul_u32_u24 v254, 16, v254
    v_add_u32 v3, v3, v254
    v_add_u32 v3, 155648, v3
    v_bfe_u32 v254, v1, 2, 2
    v_mul_u32_u24 v6, 128, v254
    v_bfe_u32 v254, v1, 0, 2
    v_mul_u32_u24 v254, 16, v254
    v_add_u32 v6, v6, v254
    v_bfe_u32 v254, v1, 4, 2
    v_mul_u32_u24 v254, 4, v254
    v_add_u32 v6, v6, v254
    v_add_u32 v6, 155648, v6
    v_add_u32 v6, s4, v6
    s_lshl_b32 s4, s99, 9
    s_add_u32 s4, s4, 92274688
    v_bfe_u32 v254, v1, 0, 2
    v_mul_u32_u24 v7, 128, v254
    v_add_u32 v7, s4, v7
    v_mov_b32 v232, 0
    v_mov_b32 v233, 0
    v_mov_b32 v234, 0
    v_mov_b32 v235, 0
    v_mov_b32 v236, 0
    v_mov_b32 v237, 0
    v_mov_b32 v238, 0
    v_mov_b32 v239, 0
    v_mov_b32 v240, 0
    v_mov_b32 v241, 0
    v_mov_b32 v40, 0
    v_mov_b32 v44, 0x3f803f80
    v_mov_b32 v41, 0
    v_mov_b32 v45, 0x3f803f80
    v_mov_b32 v42, 0
    v_mov_b32 v46, 0x3f803f80
    v_mov_b32 v43, 0
    v_mov_b32 v47, 0x3f803f80
    s_lshl_b32 s4, s34, 4
    v_and_b32 v48, 15, v1
    v_add_u32 v48, s4, v48
    v_lshrrev_b32 v49, 4, v1
    v_lshlrev_b32 v49, 2, v49
    v_mov_b32 v51, 0xff800000
    v_add_u32 v50, 0, v49
    v_cmp_le_u32 vcc, v50, v48
    s_nop 1
    v_cndmask_b32 v32, v51, v40, vcc
    v_add_u32 v50, 1, v49
    v_cmp_le_u32 vcc, v50, v48
    s_nop 1
    v_cndmask_b32 v33, v51, v40, vcc
    v_add_u32 v50, 2, v49
    v_cmp_le_u32 vcc, v50, v48
    s_nop 1
    v_cndmask_b32 v34, v51, v40, vcc
    v_add_u32 v50, 3, v49
    v_cmp_le_u32 vcc, v50, v48
    s_nop 1
    v_cndmask_b32 v35, v51, v40, vcc
    v_add_u32 v50, 16, v49
    v_cmp_le_u32 vcc, v50, v48
    s_nop 1
    v_cndmask_b32 v36, v51, v40, vcc
    v_add_u32 v50, 17, v49
    v_cmp_le_u32 vcc, v50, v48
    s_nop 1
    v_cndmask_b32 v37, v51, v40, vcc
    v_add_u32 v50, 18, v49
    v_cmp_le_u32 vcc, v50, v48
    s_nop 1
    v_cndmask_b32 v38, v51, v40, vcc
    v_add_u32 v50, 19, v49
    v_cmp_le_u32 vcc, v50, v48
    s_nop 1
    v_cndmask_b32 v39, v51, v40, vcc
    s_lshl_b32 s4, s99, 7
    s_lshl_b32 s5, s24, 2
    s_add_u32 s4, s4, s5
    s_add_u32 s94, s4, 92340224
    s_mov_b32 s46, 16384
    s_mov_b32 s47, 32768
    s_mov_b32 s30, -1
    s_mov_b32 s32, 0
    s_mov_b32 s33, 0
    s_mov_b32 s42, 0
    s_mov_b32 s53, 75497472
    s_mov_b32 s45, 0x3e0293ee
    s_lshl_b32 s36, s99, 13
    s_add_u32 s36, s36, s43
    s_add_u32 s36, s36, 16777216
    s_add_u32 s43, s43, 139264
    s_sub_u32 s37, s36, 0x40000
    v_and_b32 v255, 15, v1
    v_bfe_u32 v254, v1, 4, 1
    v_lshlrev_b32 v255, 7, v255
    v_lshl_add_u32 v255, v254, 24, v255
    s_lshl_b32 s39, s99, 12
    s_lshl_b32 s4, s34, 12
    s_lshl_b32 s40, s99, 13
    s_add_u32 s40, s40, s4
    s_lshl_b32 s4, s35, 11
    s_add_u32 s40, s40, s4
    s_add_u32 s40, s40, 16777216
    s_add_u32 s39, s39, 67108864
    s_lshl_b32 s52, s24, 10
    s_add_u32 s39, s39, s52
    s_add_u32 s52, s52, 155648
    s_mov_b32 s31, 1
    s_sub_u32 s48, s39, 0x20000
    s_mov_b32 s49, s37
    s_mov_b32 vcc_lo, s27
    s_mov_b32 vcc_hi, 0
    s_cmp_gt_u32 s32, 0
    s_cbranch_scc1 .ndd_328
    s_mov_b32 s62, 0
.nd_327:
    buffer_load_dword v29, v7, s[8:11], s46 offen sc1
    buffer_load_dword v30, v7, s[8:11], s47 offen sc1
    s_add_u32 s62, s62, 1
    s_cmp_gt_u32 s62, 0x200000
    s_cbranch_scc1 .mg_end_1
    s_waitcnt vmcnt(0)
    v_min_u32 v29, v29, v30
    s_nop 1
    v_min_u32_dpp v29, v29, v29 quad_perm:[1,0,3,2] row_mask:0xf bank_mask:0xf
    s_nop 1
    v_min_u32_dpp v29, v29, v29 quad_perm:[2,3,0,1] row_mask:0xf bank_mask:0xf
    s_nop 1
    v_readfirstlane_b32 s32, v29
    s_lshl_b32 s55, s32, 18
    s_add_u32 s55, s55, s37
    s_cmp_gt_u32 s32, 0
    s_cbranch_scc1 .ndd_328
    s_sleep 4
    s_branch .nd_327
.ndd_328:
    s_waitcnt lgkmcnt(0)
.p2align 6
.ql_329:
    s_waitcnt lgkmcnt(8)
    v_mfma_f32_16x16x32_bf16 v[192:195], a[0:3], v[64:67], 0
    buffer_load_dwordx4 v19, s[12:15], s29 offen offset:2048 lds
    v_mfma_f32_16x16x32_bf16 v[196:199], a[4:7], v[64:67], 0
    ds_read_b128 v[112:115], v10 offset:256
    ds_read_b128 v[116:119], v10 offset:33024
    v_mfma_f32_16x16x32_bf16 v[200:203], a[0:3], v[68:71], 0
    ds_read_b128 v[120:123], v11 offset:256
    ds_read_b128 v[124:127], v11 offset:33024
    v_mfma_f32_16x16x32_bf16 v[204:207], a[4:7], v[68:71], 0
    ds_read_b128 v[64:67], v8 offset:512
    ds_read_b128 v[68:71], v8 offset:33280
    v_mfma_f32_16x16x32_bf16 v[192:195], a[8:11], v[72:75], v[192:195]
    buffer_load_dwordx4 v19, s[12:15], s29 offen offset:3072 lds
    v_mfma_f32_16x16x32_bf16 v[196:199], a[12:15], v[72:75], v[196:199]
    v_cvt_pk_bf16_f32 v224, v208, v209
    v_cvt_pk_bf16_f32 v225, v210, v211
    v_mfma_f32_16x16x32_bf16 v[200:203], a[8:11], v[76:79], v[200:203]
    v_cvt_pk_bf16_f32 v226, v212, v213
    v_cvt_pk_bf16_f32 v227, v214, v215
    v_mfma_f32_16x16x32_bf16 v[204:207], a[12:15], v[76:79], v[204:207]
    ds_write_b128 v24, v[224:227] offset:0
    s_waitcnt lgkmcnt(11)
    v_mfma_f32_16x16x32_bf16 v[192:195], a[16:19], v[80:83], v[192:195]
    s_add_u32 m0, s6, 73728
    v_cvt_pk_bf16_f32 v228, v216, v217
    v_mfma_f32_16x16x32_bf16 v[196:199], a[20:23], v[80:83], v[196:199]
    buffer_load_dwordx4 v20, s[12:15], s29 offen offset:0 lds
    v_mfma_f32_16x16x32_bf16 v[200:203], a[16:19], v[84:87], v[200:203]
    v_cvt_pk_bf16_f32 v229, v218, v219
    v_cvt_pk_bf16_f32 v230, v220, v221
    v_mfma_f32_16x16x32_bf16 v[204:207], a[20:23], v[84:87], v[204:207]
    v_cvt_pk_bf16_f32 v231, v222, v223
    ds_write_b128 v24, v[228:231] offset:4096
    v_mfma_f32_16x16x32_bf16 v[192:195], a[24:27], v[88:91], v[192:195]
    ds_read_b128 v[72:75], v9 offset:512
    ds_read_b128 v[76:79], v9 offset:33280
    v_mfma_f32_16x16x32_bf16 v[196:199], a[28:31], v[88:91], v[196:199]
    buffer_load_dwordx4 v20, s[12:15], s29 offen offset:1024 lds
    v_mfma_f32_16x16x32_bf16 v[200:203], a[24:27], v[92:95], v[200:203]
    ds_read_b128 v[80:83], v10 offset:512
    ds_read_b128 v[84:87], v10 offset:33280
    v_mfma_f32_16x16x32_bf16 v[204:207], a[28:31], v[92:95], v[204:207]
    ds_read_b128 v[88:91], v11 offset:512
    s_waitcnt lgkmcnt(13)
    v_mfma_f32_16x16x32_bf16 v[192:195], a[32:35], v[96:99], v[192:195]
    s_waitcnt vmcnt(13) lgkmcnt(5)
    s_barrier
    v_mfma_f32_16x16x32_bf16 v[196:199], a[36:39], v[96:99], v[196:199]
    buffer_load_dwordx4 v21, s[12:15], s29 offen offset:2048 lds
    v_mfma_f32_16x16x32_bf16 v[200:203], a[32:35], v[100:103], v[200:203]
    ds_read_b128 v[208:211], v25 offset:0
    ds_read_b128 v[128:131], v31 offset:0
    v_mfma_f32_16x16x32_bf16 v[204:207], a[36:39], v[100:103], v[204:207]
    ds_read_b128 v[144:147], v31 offset:4096
    ds_read_b128 v[212:215], v25 offset:1024
    v_mfma_f32_16x16x32_bf16 v[192:195], a[40:43], v[104:107], v[192:195]
    ds_read_b128 v[132:135], v31 offset:1024
    ds_read_b128 v[148:151], v31 offset:5120
    v_mfma_f32_16x16x32_bf16 v[196:199], a[44:47], v[104:107], v[196:199]
    buffer_load_dwordx4 v21, s[12:15], s29 offen offset:3072 lds
    v_mfma_f32_16x16x32_bf16 v[200:203], a[40:43], v[108:111], v[200:203]
    ds_read_b128 v[92:95], v11 offset:33280
    ds_read_b128 v[216:219], v25 offset:2048
    v_mfma_f32_16x16x32_bf16 v[204:207], a[44:47], v[108:111], v[204:207]
    ds_read_b128 v[136:139], v31 offset:2048
    ds_read_b128 v[152:155], v31 offset:6144
    v_mfma_f32_16x16x32_bf16 v[192:195], a[48:51], v[112:115], v[192:195]
    ds_read_b128 v[220:223], v25 offset:3072
    ds_read_b128 v[140:143], v31 offset:3072
    v_mfma_f32_16x16x32_bf16 v[196:199], a[52:55], v[112:115], v[196:199]
    s_add_u32 m0, s6, 77824
    s_waitcnt lgkmcnt(9)
    v_mfma_f32_16x16x32_bf16 v[48:51], v[128:131], v[208:211], v[32:35]
    buffer_load_dwordx4 v22, s[12:15], s29 offen offset:0 lds
    v_mfma_f32_16x16x32_bf16 v[52:55], v[144:147], v[208:211], v[36:39]
    ds_read_b128 v[156:159], v31 offset:7168
    s_waitcnt lgkmcnt(7)
    v_mfma_f32_16x16x32_bf16 v[48:51], v[132:135], v[212:215], v[48:51]
    ds_read_b128 v[160:163], v5 offset:8192
    ds_read_b128 v[164:167], v5 offset:9216
    v_mfma_f32_16x16x32_bf16 v[52:55], v[148:151], v[212:215], v[52:55]
    ds_read_b128 v[96:99], v8 offset:768
    s_waitcnt lgkmcnt(6)
    v_mfma_f32_16x16x32_bf16 v[48:51], v[136:139], v[216:219], v[48:51]
    buffer_load_dwordx4 v22, s[12:15], s29 offen offset:1024 lds
    v_mfma_f32_16x16x32_bf16 v[52:55], v[152:155], v[216:219], v[52:55]
    ds_read_b128 v[100:103], v8 offset:33536
    ds_read_b128 v[104:107], v9 offset:768
    v_mfma_f32_16x16x32_bf16 v[200:203], a[48:51], v[116:119], v[200:203]
    ds_read_b128 v[108:111], v9 offset:33536
    ds_read_b128 v[168:171], v5 offset:10240
    v_mfma_f32_16x16x32_bf16 v[204:207], a[52:55], v[116:119], v[204:207]
    ds_read_b128 v[172:175], v5 offset:11264
    s_waitcnt lgkmcnt(8)
    v_mfma_f32_16x16x32_bf16 v[48:51], v[140:143], v[220:223], v[48:51]
    buffer_load_dwordx4 v23, s[12:15], s29 offen offset:2048 lds
    v_mfma_f32_16x16x32_bf16 v[52:55], v[156:159], v[220:223], v[52:55]
    v_max_i32 v27, s30, v26
    ds_read_b128 v[112:115], v10 offset:768
    v_mfma_f32_16x16x32_bf16 v[192:195], a[56:59], v[120:123], v[192:195]
    s_waitcnt vmcnt(12)
    s_cbranch_vccnz .cp_335
    buffer_store_dword v27, v26, s[8:11], s94 offen
.cb_336:
    v_mfma_f32_16x16x32_bf16 v[196:199], a[60:63], v[120:123], v[196:199]
    ds_read_b128 v[116:119], v10 offset:33536
    ds_read_b128 v[120:123], v11 offset:768
    v_mfma_f32_16x16x32_bf16 v[200:203], a[56:59], v[124:127], v[200:203]
    buffer_load_dwordx4 v23, s[12:15], s29 offen offset:3072 lds
    v_mfma_f32_16x16x32_bf16 v[204:207], a[60:63], v[124:127], v[204:207]
    s_cmp_eq_u32 s31, 0
    s_cbranch_scc1 .cp_339
.cb_340:
    v_mfma_f32_16x16x32_bf16 v[192:195], a[64:67], v[64:67], v[192:195]
    s_waitcnt lgkmcnt(3)
    s_barrier
    v_mfma_f32_16x16x32_bf16 v[196:199], a[68:71], v[64:67], v[196:199]
    ds_read_b128 v[124:127], v11 offset:33536
    ds_read_b128 v[176:179], v3 offset:0
    v_mfma_f32_16x16x32_bf16 v[200:203], a[64:67], v[68:71], v[200:203]
    ds_read_b128 v[180:183], v3 offset:512
    ds_read_b128 v[184:187], v3 offset:1024
    v_mfma_f32_16x16x32_bf16 v[204:207], a[68:71], v[68:71], v[204:207]
    ds_read_b128 v[188:191], v3 offset:1536
    ds_read_b128 v[64:67], v8 offset:1024
    v_mfma_f32_16x16x32_bf16 v[192:195], a[72:75], v[72:75], v[192:195]
    ds_read_b128 v[68:71], v8 offset:33792
    v_max3_f32 v248, v48, v49, v50
    v_mfma_f32_16x16x32_bf16 v[196:199], a[76:79], v[72:75], v[196:199]
    ds_read_b128 v[72:75], v9 offset:1024
    v_max3_f32 v248, v248, v51, v52
    v_mfma_f32_16x16x32_bf16 v[200:203], a[72:75], v[76:79], v[200:203]
    v_max3_f32 v249, v53, v54, v55
    s_add_u32 m0, s52, 4096
    v_mfma_f32_16x16x32_bf16 v[204:207], a[76:79], v[76:79], v[204:207]
    ds_read_b128 v[76:79], v9 offset:33792
    s_add_u32 s48, s48, 0x20000
    v_mfma_f32_16x16x32_bf16 v[192:195], a[80:83], v[80:83], v[192:195]
    s_mov_b32 s31, 1
    buffer_load_dword v29, v28, s[12:15], s29 offen
    v_mfma_f32_16x16x32_bf16 v[196:199], a[84:87], v[80:83], v[196:199]
    s_cmp_gt_u32 s33, s42
    s_cbranch_scc0 .pp_341
    buffer_load_dwordx4 v2, s[8:11], s48 offen lds
.pb_342:
    s_waitcnt lgkmcnt(4)
    v_mfma_f32_16x16x32_bf16 v[56:59], v[176:179], v[208:211], 0
    ds_read_b128 v[80:83], v10 offset:1024
    s_add_u32 s29, s29, 0x10000
    v_mfma_f32_16x16x32_bf16 v[56:59], v[180:183], v[212:215], v[56:59]
    s_cmp_gt_u32 s32, s42
    s_cbranch_scc0 .cp_337
.cb_338:
    v_mfma_f32_16x16x32_bf16 v[56:59], v[184:187], v[216:219], v[56:59]
    ds_read_b32 v232, v6 offset:0
    ds_read_b32 v234, v6 offset:64
    v_mfma_f32_16x16x32_bf16 v[56:59], v[188:191], v[220:223], v[56:59]
    ds_read_b32 v236, v6 offset:512
    ds_read_b32 v238, v6 offset:576
    v_mfma_f32_16x16x32_bf16 v[200:203], a[80:83], v[84:87], v[200:203]
    s_mov_b32 m0, s43
    s_add_u32 s49, s49, 0x40000
    v_mfma_f32_16x16x32_bf16 v[204:207], a[84:87], v[84:87], v[204:207]
    ds_read_b128 v[84:87], v10 offset:33792
    v_mfma_f32_16x16x32_bf16 v[192:195], a[88:91], v[88:91], v[192:195]
    buffer_load_dwordx4 v2, s[8:11], s49 offen lds
    v_mfma_f32_16x16x32_bf16 v[196:199], a[92:95], v[88:91], v[196:199]
    ds_read_b128 v[88:91], v11 offset:1024
    v_max3_f32 v248, v248, v56, v57
    v_mfma_f32_16x16x32_bf16 v[200:203], a[88:91], v[92:95], v[200:203]
    v_max_f32 v30, v248, v249
    v_max_f32 v249, v248, v249
    v_mfma_f32_16x16x32_bf16 v[204:207], a[92:95], v[92:95], v[204:207]
    ds_read_b128 v[92:95], v11 offset:33792
    s_add_u32 s50, s49, 16777216
    v_mfma_f32_16x16x32_bf16 v[192:195], a[96:99], v[96:99], v[192:195]
    v_permlane16_swap_b32 v249, v30
    v_max_f32 v248, v249, v30
    v_mfma_f32_16x16x32_bf16 v[196:199], a[100:103], v[96:99], v[196:199]
    v_max_f32 v249, v249, v30
    ds_read_b128 v[96:99], v8 offset:1280
    v_mfma_f32_16x16x32_bf16 v[200:203], a[96:99], v[100:103], v[200:203]
    buffer_load_dwordx4 v2, s[8:11], s49 offen offset:1024 lds
    v_mfma_f32_16x16x32_bf16 v[204:207], a[100:103], v[100:103], v[204:207]
    v_permlane32_swap_b32 v248, v249
    v_max_f32 v248, v248, v249
    v_mfma_f32_16x16x32_bf16 v[192:195], a[104:107], v[104:107], v[192:195]
    v_mul_f32 v248, s45, v248
    ds_read_b128 v[100:103], v8 offset:34048
    v_mfma_f32_16x16x32_bf16 v[196:199], a[108:111], v[104:107], v[196:199]
    ds_read_b128 v[104:107], v9 offset:1280
    v_fma_f32 v60, v48, s45, -v248
    v_mfma_f32_16x16x32_bf16 v[200:203], a[104:107], v[108:111], v[200:203]
    v_fma_f32 v61, v49, s45, -v248
    v_fma_f32 v62, v50, s45, -v248
    v_mfma_f32_16x16x32_bf16 v[204:207], a[108:111], v[108:111], v[204:207]
    ds_read_b128 v[108:111], v9 offset:34048
    v_fma_f32 v63, v51, s45, -v248
    v_mfma_f32_16x16x32_bf16 v[192:195], a[112:115], v[112:115], v[192:195]
    v_fma_f32 v242, v52, s45, -v248
    v_fma_f32 v243, v53, s45, -v248
    v_mfma_f32_16x16x32_bf16 v[196:199], a[116:119], v[112:115], v[196:199]
    v_fma_f32 v244, v54, s45, -v248
    v_fma_f32 v245, v55, s45, -v248
    v_mfma_f32_16x16x32_bf16 v[200:203], a[112:115], v[116:119], v[200:203]
    v_fma_f32 v246, v56, s45, -v248
    v_fma_f32 v247, v57, s45, -v248
    v_mfma_f32_16x16x32_bf16 v[204:207], a[116:119], v[116:119], v[204:207]
    ds_read_b128 v[112:115], v10 offset:1280
    ds_read_b128 v[116:119], v10 offset:34048
    v_mfma_f32_16x16x32_bf16 v[192:195], a[120:123], v[120:123], v[192:195]
    s_add_u32 m0, s43, 8192
    s_add_u32 s5, s49, 0x40000
    v_mfma_f32_16x16x32_bf16 v[196:199], a[124:127], v[120:123], v[196:199]
    ds_read_b128 v[120:123], v11 offset:1280
    v_mfma_f32_16x16x32_bf16 v[200:203], a[120:123], v[124:127], v[200:203]
    buffer_load_dwordx4 v2, s[8:11], s50 offen lds
    v_mfma_f32_16x16x32_bf16 v[204:207], a[124:127], v[124:127], v[204:207]
    ds_read_b128 v[124:127], v11 offset:34048
    s_waitcnt lgkmcnt(15)
    v_mfma_f32_16x16x32_bf16 v[192:195], a[128:131], v[64:67], v[192:195]
    s_min_u32 s5, s5, s55
    v_mfma_f32_16x16x32_bf16 v[196:199], a[132:135], v[64:67], v[196:199]
    v_exp_f32 v60, v60
    v_mfma_f32_16x16x32_bf16 v[200:203], a[128:131], v[68:71], v[200:203]
    v_exp_f32 v61, v61
    v_mfma_f32_16x16x32_bf16 v[204:207], a[132:135], v[68:71], v[204:207]
    v_exp_f32 v62, v62
    v_mfma_f32_16x16x32_bf16 v[192:195], a[136:139], v[72:75], v[192:195]
    v_exp_f32 v63, v63
    v_mfma_f32_16x16x32_bf16 v[196:199], a[140:143], v[72:75], v[196:199]
    v_exp_f32 v242, v242
    v_mfma_f32_16x16x32_bf16 v[200:203], a[136:139], v[76:79], v[200:203]
    v_exp_f32 v243, v243
    v_mfma_f32_16x16x32_bf16 v[204:207], a[140:143], v[76:79], v[204:207]
    ds_read_b128 v[64:67], v8 offset:1536
    s_waitcnt lgkmcnt(9)
    v_mfma_f32_16x16x32_bf16 v[192:195], a[144:147], v[80:83], v[192:195]
    v_exp_f32 v244, v244
    v_mfma_f32_16x16x32_bf16 v[196:199], a[148:151], v[80:83], v[196:199]
    v_exp_f32 v245, v245
    v_mfma_f32_16x16x32_bf16 v[200:203], a[144:147], v[84:87], v[200:203]
    v_exp_f32 v246, v246
    v_mfma_f32_16x16x32_bf16 v[204:207], a[148:151], v[84:87], v[204:207]
    v_exp_f32 v247, v247
    v_mfma_f32_16x16x32_bf16 v[192:195], a[152:155], v[88:91], v[192:195]
    ds_read_b128 v[68:71], v8 offset:34304
    ds_read_b128 v[72:75], v9 offset:1536
    v_mfma_f32_16x16x32_bf16 v[196:199], a[156:159], v[88:91], v[196:199]
    ds_read_b128 v[76:79], v9 offset:34304
    v_cvt_pk_bf16_f32 v48, v60, v61
    v_mfma_f32_16x16x32_bf16 v[200:203], a[152:155], v[92:95], v[200:203]
    buffer_load_dwordx4 v2, s[8:11], s50 offen offset:1024 lds
    v_mfma_f32_16x16x32_bf16 v[204:207], a[156:159], v[92:95], v[204:207]
    v_cvt_pk_bf16_f32 v49, v62, v63
    s_waitcnt lgkmcnt(8)
    v_mfma_f32_16x16x32_bf16 v[192:195], a[160:163], v[96:99], v[192:195]
    v_cvt_pk_bf16_f32 v50, v242, v243
    v_cvt_pk_bf16_f32 v51, v244, v245
    v_mfma_f32_16x16x32_bf16 v[196:199], a[164:167], v[96:99], v[196:199]
    v_cvt_pk_bf16_f32 v40, v246, v247
    buffer_load_dword v29, v255, s[8:11], s5 offen
    v_mfma_f32_16x16x32_bf16 v[200:203], a[160:163], v[100:103], v[200:203]
    ds_read_b128 v[80:83], v10 offset:1536
    ds_read_b128 v[84:87], v10 offset:34304
    v_mfma_f32_16x16x32_bf16 v[52:55], v[44:47], v[48:51], 0
    ds_read_b128 v[88:91], v11 offset:1536
    ds_read_b128 v[92:95], v11 offset:34304
    v_mfma_f32_16x16x32_bf16 v[52:55], v[44:47], v[40:43], v[52:55]
    ds_read_b128 v[96:99], v8 offset:1792
    v_mfma_f32_16x16x32_bf16 v[208:211], v[160:163], v[48:51], 0
    v_mfma_f32_16x16x32_bf16 v[208:211], v[232:235], v[40:43], v[208:211]
    v_mfma_f32_16x16x32_bf16 v[212:215], v[164:167], v[48:51], 0
    v_mfma_f32_16x16x32_bf16 v[212:215], v[234:237], v[40:43], v[212:215]
    v_mfma_f32_16x16x32_bf16 v[216:219], v[168:171], v[48:51], 0
    v_mfma_f32_16x16x32_bf16 v[216:219], v[236:239], v[40:43], v[216:219]
    v_mfma_f32_16x16x32_bf16 v[220:223], v[172:175], v[48:51], 0
    v_mfma_f32_16x16x32_bf16 v[220:223], v[238:241], v[40:43], v[220:223]
    v_rcp_f32 v248, v52
    v_mfma_f32_16x16x32_bf16 v[204:207], a[164:167], v[100:103], v[204:207]
    ds_read_b128 v[100:103], v8 offset:34560
    v_mul_f32 v208, v248, v208
    v_mfma_f32_16x16x32_bf16 v[192:195], a[168:171], v[104:107], v[192:195]
    v_mul_f32 v209, v248, v209
    v_mul_f32 v210, v248, v210
    v_mfma_f32_16x16x32_bf16 v[196:199], a[172:175], v[104:107], v[196:199]
    ds_read_b128 v[104:107], v9 offset:1792
    v_mul_f32 v211, v248, v211
    v_mfma_f32_16x16x32_bf16 v[200:203], a[168:171], v[108:111], v[200:203]
    v_cvt_pk_bf16_f32 v224, v208, v209
    v_cvt_pk_bf16_f32 v225, v210, v211
    v_mfma_f32_16x16x32_bf16 v[204:207], a[172:175], v[108:111], v[204:207]
    ds_read_b128 v[108:111], v9 offset:34560
    s_waitcnt lgkmcnt(12)
    v_mfma_f32_16x16x32_bf16 v[192:195], a[176:179], v[112:115], v[192:195]
    v_mul_f32 v212, v248, v212
    v_mul_f32 v213, v248, v213
    v_mfma_f32_16x16x32_bf16 v[196:199], a[180:183], v[112:115], v[196:199]
    ds_read_b128 v[112:115], v10 offset:1792
    v_mul_f32 v214, v248, v214
    v_mfma_f32_16x16x32_bf16 v[200:203], a[176:179], v[116:119], v[200:203]
    v_mul_f32 v215, v248, v215
    v_cvt_pk_bf16_f32 v226, v212, v213
    v_mfma_f32_16x16x32_bf16 v[204:207], a[180:183], v[116:119], v[204:207]
    ds_read_b128 v[116:119], v10 offset:34560
    v_cvt_pk_bf16_f32 v227, v214, v215
    v_mfma_f32_16x16x32_bf16 v[192:195], a[184:187], v[120:123], v[192:195]
    v_mfma_f32_16x16x32_bf16 v[196:199], a[188:191], v[120:123], v[196:199]
    ds_read_b128 v[120:123], v11 offset:1792
    v_mfma_f32_16x16x32_bf16 v[200:203], a[184:187], v[124:127], v[200:203]
    v_mfma_f32_16x16x32_bf16 v[204:207], a[188:191], v[124:127], v[204:207]
    ds_read_b128 v[124:127], v11 offset:34560
    s_waitcnt lgkmcnt(12)
    v_mfma_f32_16x16x32_bf16 v[192:195], a[192:195], v[64:67], v[192:195]
    v_mfma_f32_16x16x32_bf16 v[196:199], a[196:199], v[64:67], v[196:199]
    v_mfma_f32_16x16x32_bf16 v[200:203], a[192:195], v[68:71], v[200:203]
    s_cmp_eq_u32 s31, 0
    s_cbranch_scc1 .cp_343
.cb_344:
    v_mfma_f32_16x16x32_bf16 v[204:207], a[196:199], v[68:71], v[204:207]
    s_cbranch_vccnz .cp_331
    buffer_store_dwordx4 v[224:227], v2, s[8:11], s53 offen offset:0
.cb_332:
    v_mfma_f32_16x16x32_bf16 v[192:195], a[200:203], v[72:75], v[192:195]
    s_waitcnt vmcnt(8) lgkmcnt(0)
    s_barrier
    v_mfma_f32_16x16x32_bf16 v[196:199], a[204:207], v[72:75], v[196:199]
    s_add_u32 m0, s6, 0
    ds_read_b128 v[64:67], v12 offset:0
    v_mfma_f32_16x16x32_bf16 v[200:203], a[200:203], v[76:79], v[200:203]
    buffer_load_dwordx4 v16, s[12:15], s29 offen offset:0 lds
    v_mfma_f32_16x16x32_bf16 v[204:207], a[204:207], v[76:79], v[204:207]
    ds_read_b128 v[68:71], v12 offset:32768
    ds_read_b128 v[72:75], v13 offset:0
    v_mfma_f32_16x16x32_bf16 v[192:195], a[208:211], v[80:83], v[192:195]
    ds_read_b128 v[76:79], v13 offset:32768
    v_mul_f32 v216, v248, v216
    v_mfma_f32_16x16x32_bf16 v[196:199], a[212:215], v[80:83], v[196:199]
    v_mul_f32 v217, v248, v217
    v_mul_f32 v218, v248, v218
    v_mfma_f32_16x16x32_bf16 v[200:203], a[208:211], v[84:87], v[200:203]
    buffer_load_dwordx4 v16, s[12:15], s29 offen offset:1024 lds
    v_mfma_f32_16x16x32_bf16 v[204:207], a[212:215], v[84:87], v[204:207]
    v_mul_f32 v219, v248, v219
    v_cvt_pk_bf16_f32 v228, v216, v217
    v_mfma_f32_16x16x32_bf16 v[192:195], a[216:219], v[88:91], v[192:195]
    v_cvt_pk_bf16_f32 v229, v218, v219
    v_mul_f32 v220, v248, v220
    v_mfma_f32_16x16x32_bf16 v[196:199], a[220:223], v[88:91], v[196:199]
    v_mul_f32 v221, v248, v221
    v_mul_f32 v222, v248, v222
    v_mfma_f32_16x16x32_bf16 v[200:203], a[216:219], v[92:95], v[200:203]
    buffer_load_dwordx4 v17, s[12:15], s29 offen offset:2048 lds
    v_mfma_f32_16x16x32_bf16 v[204:207], a[220:223], v[92:95], v[204:207]
    v_mul_f32 v223, v248, v223
    v_cvt_pk_bf16_f32 v230, v220, v221
    v_mfma_f32_16x16x32_bf16 v[192:195], a[224:227], v[96:99], v[192:195]
    v_cvt_pk_bf16_f32 v231, v222, v223
    ds_read_b128 v[80:83], v14 offset:0
    v_mfma_f32_16x16x32_bf16 v[196:199], a[228:231], v[96:99], v[196:199]
    s_cbranch_vccnz .cp_333
    buffer_store_dwordx4 v[228:231], v2, s[8:11], s53 offen offset:1024
.cb_334:
    v_mfma_f32_16x16x32_bf16 v[200:203], a[224:227], v[100:103], v[200:203]
    buffer_load_dwordx4 v17, s[12:15], s29 offen offset:3072 lds
    v_mfma_f32_16x16x32_bf16 v[204:207], a[228:231], v[100:103], v[204:207]
    ds_read_b128 v[84:87], v14 offset:32768
    ds_read_b128 v[88:91], v15 offset:0
    v_mfma_f32_16x16x32_bf16 v[192:195], a[232:235], v[104:107], v[192:195]
    ds_read_b128 v[92:95], v15 offset:32768
    ds_read_b128 v[96:99], v12 offset:256
    v_mfma_f32_16x16x32_bf16 v[196:199], a[236:239], v[104:107], v[196:199]
    ds_read_b128 v[100:103], v12 offset:33024
    ds_read_b128 v[104:107], v13 offset:256
    v_mfma_f32_16x16x32_bf16 v[200:203], a[232:235], v[108:111], v[200:203]
    s_add_u32 m0, s6, 4096
    s_mov_b32 s53, s40
    v_mfma_f32_16x16x32_bf16 v[204:207], a[236:239], v[108:111], v[204:207]
    buffer_load_dwordx4 v18, s[12:15], s29 offen offset:0 lds
    v_mfma_f32_16x16x32_bf16 v[192:195], a[240:243], v[112:115], v[192:195]
    ds_read_b128 v[108:111], v13 offset:33024
    s_add_u32 s40, s40, 0x40000
    v_mfma_f32_16x16x32_bf16 v[196:199], a[244:247], v[112:115], v[196:199]
    s_mov_b32 s30, s42
    s_add_u32 s42, s42, 1
    v_mfma_f32_16x16x32_bf16 v[200:203], a[240:243], v[116:119], v[200:203]
    v_mfma_f32_16x16x32_bf16 v[204:207], a[244:247], v[116:119], v[204:207]
    buffer_load_dwordx4 v18, s[12:15], s29 offen offset:1024 lds
    v_mfma_f32_16x16x32_bf16 v[192:195], a[248:251], v[120:123], v[192:195]
    v_mfma_f32_16x16x32_bf16 v[196:199], a[252:255], v[120:123], v[196:199]
    v_mfma_f32_16x16x32_bf16 v[200:203], a[248:251], v[124:127], v[200:203]
    v_mfma_f32_16x16x32_bf16 v[204:207], a[252:255], v[124:127], v[204:207]
    s_cmp_eq_u32 s42, 63
    s_cbranch_scc1 .ql_330
    s_waitcnt lgkmcnt(8)
    v_mfma_f32_16x16x32_bf16 v[208:211], a[0:3], v[64:67], 0
    buffer_load_dwordx4 v19, s[12:15], s29 offen offset:2048 lds
    v_mfma_f32_16x16x32_bf16 v[212:215], a[4:7], v[64:67], 0
    ds_read_b128 v[112:115], v14 offset:256
    ds_read_b128 v[116:119], v14 offset:33024
    v_mfma_f32_16x16x32_bf16 v[216:219], a[0:3], v[68:71], 0
    ds_read_b128 v[120:123], v15 offset:256
    ds_read_b128 v[124:127], v15 offset:33024
    v_mfma_f32_16x16x32_bf16 v[220:223], a[4:7], v[68:71], 0
    ds_read_b128 v[64:67], v12 offset:512
    ds_read_b128 v[68:71], v12 offset:33280
    v_mfma_f32_16x16x32_bf16 v[208:211], a[8:11], v[72:75], v[208:211]
    buffer_load_dwordx4 v19, s[12:15], s29 offen offset:3072 lds
    v_mfma_f32_16x16x32_bf16 v[212:215], a[12:15], v[72:75], v[212:215]
    v_cvt_pk_bf16_f32 v224, v192, v193
    v_cvt_pk_bf16_f32 v225, v194, v195
    v_mfma_f32_16x16x32_bf16 v[216:219], a[8:11], v[76:79], v[216:219]
    v_cvt_pk_bf16_f32 v226, v196, v197
    v_cvt_pk_bf16_f32 v227, v198, v199
    v_mfma_f32_16x16x32_bf16 v[220:223], a[12:15], v[76:79], v[220:223]
    ds_write_b128 v24, v[224:227] offset:0
    s_waitcnt lgkmcnt(11)
    v_mfma_f32_16x16x32_bf16 v[208:211], a[16:19], v[80:83], v[208:211]
    s_add_u32 m0, s6, 8192
    v_cvt_pk_bf16_f32 v228, v200, v201
    v_mfma_f32_16x16x32_bf16 v[212:215], a[20:23], v[80:83], v[212:215]
    buffer_load_dwordx4 v20, s[12:15], s29 offen offset:0 lds
    v_mfma_f32_16x16x32_bf16 v[216:219], a[16:19], v[84:87], v[216:219]
    v_cvt_pk_bf16_f32 v229, v202, v203
    v_cvt_pk_bf16_f32 v230, v204, v205
    v_mfma_f32_16x16x32_bf16 v[220:223], a[20:23], v[84:87], v[220:223]
    v_cvt_pk_bf16_f32 v231, v206, v207
    ds_write_b128 v24, v[228:231] offset:4096
    v_mfma_f32_16x16x32_bf16 v[208:211], a[24:27], v[88:91], v[208:211]
    ds_read_b128 v[72:75], v13 offset:512
    ds_read_b128 v[76:79], v13 offset:33280
    v_mfma_f32_16x16x32_bf16 v[212:215], a[28:31], v[88:91], v[212:215]
    buffer_load_dwordx4 v20, s[12:15], s29 offen offset:1024 lds
    v_mfma_f32_16x16x32_bf16 v[216:219], a[24:27], v[92:95], v[216:219]
    ds_read_b128 v[80:83], v14 offset:512
    ds_read_b128 v[84:87], v14 offset:33280
    v_mfma_f32_16x16x32_bf16 v[220:223], a[28:31], v[92:95], v[220:223]
    ds_read_b128 v[88:91], v15 offset:512
    s_waitcnt lgkmcnt(13)
    v_mfma_f32_16x16x32_bf16 v[208:211], a[32:35], v[96:99], v[208:211]
    s_waitcnt vmcnt(13) lgkmcnt(5)
    s_barrier
    v_mfma_f32_16x16x32_bf16 v[212:215], a[36:39], v[96:99], v[212:215]
    buffer_load_dwordx4 v21, s[12:15], s29 offen offset:2048 lds
    v_mfma_f32_16x16x32_bf16 v[216:219], a[32:35], v[100:103], v[216:219]
    ds_read_b128 v[192:195], v25 offset:0
    ds_read_b128 v[128:131], v31 offset:0
    v_mfma_f32_16x16x32_bf16 v[220:223], a[36:39], v[100:103], v[220:223]
    ds_read_b128 v[144:147], v31 offset:4096
    ds_read_b128 v[196:199], v25 offset:1024
    v_mfma_f32_16x16x32_bf16 v[208:211], a[40:43], v[104:107], v[208:211]
    ds_read_b128 v[132:135], v31 offset:1024
    ds_read_b128 v[148:151], v31 offset:5120
    v_mfma_f32_16x16x32_bf16 v[212:215], a[44:47], v[104:107], v[212:215]
    buffer_load_dwordx4 v21, s[12:15], s29 offen offset:3072 lds
    v_mfma_f32_16x16x32_bf16 v[216:219], a[40:43], v[108:111], v[216:219]
    ds_read_b128 v[92:95], v15 offset:33280
    ds_read_b128 v[200:203], v25 offset:2048
    v_mfma_f32_16x16x32_bf16 v[220:223], a[44:47], v[108:111], v[220:223]
    ds_read_b128 v[136:139], v31 offset:2048
    ds_read_b128 v[152:155], v31 offset:6144
    v_mfma_f32_16x16x32_bf16 v[208:211], a[48:51], v[112:115], v[208:211]
    ds_read_b128 v[204:207], v25 offset:3072
    ds_read_b128 v[140:143], v31 offset:3072
    v_mfma_f32_16x16x32_bf16 v[212:215], a[52:55], v[112:115], v[212:215]
    s_add_u32 m0, s6, 12288
    s_waitcnt lgkmcnt(9)
    v_mfma_f32_16x16x32_bf16 v[48:51], v[128:131], v[192:195], v[32:35]
    buffer_load_dwordx4 v22, s[12:15], s29 offen offset:0 lds
    v_mfma_f32_16x16x32_bf16 v[52:55], v[144:147], v[192:195], v[36:39]
    ds_read_b128 v[156:159], v31 offset:7168
    s_waitcnt lgkmcnt(7)
    v_mfma_f32_16x16x32_bf16 v[48:51], v[132:135], v[196:199], v[48:51]
    ds_read_b128 v[160:163], v5 offset:8192
    ds_read_b128 v[164:167], v5 offset:9216
    v_mfma_f32_16x16x32_bf16 v[52:55], v[148:151], v[196:199], v[52:55]
    ds_read_b128 v[96:99], v12 offset:768
    s_waitcnt lgkmcnt(6)
    v_mfma_f32_16x16x32_bf16 v[48:51], v[136:139], v[200:203], v[48:51]
    buffer_load_dwordx4 v22, s[12:15], s29 offen offset:1024 lds
    v_mfma_f32_16x16x32_bf16 v[52:55], v[152:155], v[200:203], v[52:55]
    ds_read_b128 v[100:103], v12 offset:33536
    ds_read_b128 v[104:107], v13 offset:768
    v_mfma_f32_16x16x32_bf16 v[216:219], a[48:51], v[116:119], v[216:219]
    ds_read_b128 v[108:111], v13 offset:33536
    ds_read_b128 v[168:171], v5 offset:10240
    v_mfma_f32_16x16x32_bf16 v[220:223], a[52:55], v[116:119], v[220:223]
    ds_read_b128 v[172:175], v5 offset:11264
    s_waitcnt lgkmcnt(8)
    v_mfma_f32_16x16x32_bf16 v[48:51], v[140:143], v[204:207], v[48:51]
    buffer_load_dwordx4 v23, s[12:15], s29 offen offset:2048 lds
    v_mfma_f32_16x16x32_bf16 v[52:55], v[156:159], v[204:207], v[52:55]
    v_max_i32 v27, s30, v26
    ds_read_b128 v[112:115], v14 offset:768
    v_mfma_f32_16x16x32_bf16 v[208:211], a[56:59], v[120:123], v[208:211]
    s_waitcnt vmcnt(12)
    s_cbranch_vccnz .cp_349
    buffer_store_dword v27, v26, s[8:11], s94 offen
.cb_350:
    v_mfma_f32_16x16x32_bf16 v[212:215], a[60:63], v[120:123], v[212:215]
    ds_read_b128 v[116:119], v14 offset:33536
    ds_read_b128 v[120:123], v15 offset:768
    v_mfma_f32_16x16x32_bf16 v[216:219], a[56:59], v[124:127], v[216:219]
    buffer_load_dwordx4 v23, s[12:15], s29 offen offset:3072 lds
    v_mfma_f32_16x16x32_bf16 v[220:223], a[60:63], v[124:127], v[220:223]
    s_cmp_eq_u32 s31, 0
    s_cbranch_scc1 .cp_353
.cb_354:
    v_mfma_f32_16x16x32_bf16 v[208:211], a[64:67], v[64:67], v[208:211]
    s_waitcnt lgkmcnt(3)
    s_barrier
    v_mfma_f32_16x16x32_bf16 v[212:215], a[68:71], v[64:67], v[212:215]
    ds_read_b128 v[124:127], v15 offset:33536
    ds_read_b128 v[176:179], v3 offset:4096
    v_mfma_f32_16x16x32_bf16 v[216:219], a[64:67], v[68:71], v[216:219]
    ds_read_b128 v[180:183], v3 offset:4608
    ds_read_b128 v[184:187], v3 offset:5120
    v_mfma_f32_16x16x32_bf16 v[220:223], a[68:71], v[68:71], v[220:223]
    ds_read_b128 v[188:191], v3 offset:5632
    ds_read_b128 v[64:67], v12 offset:1024
    v_mfma_f32_16x16x32_bf16 v[208:211], a[72:75], v[72:75], v[208:211]
    ds_read_b128 v[68:71], v12 offset:33792
    v_max3_f32 v248, v48, v49, v50
    v_mfma_f32_16x16x32_bf16 v[212:215], a[76:79], v[72:75], v[212:215]
    ds_read_b128 v[72:75], v13 offset:1024
    v_max3_f32 v248, v248, v51, v52
    v_mfma_f32_16x16x32_bf16 v[216:219], a[72:75], v[76:79], v[216:219]
    v_max3_f32 v249, v53, v54, v55
    s_add_u32 m0, s52, 0
    v_mfma_f32_16x16x32_bf16 v[220:223], a[76:79], v[76:79], v[220:223]
    ds_read_b128 v[76:79], v13 offset:33792
    s_add_u32 s48, s48, 0x20000
    v_mfma_f32_16x16x32_bf16 v[208:211], a[80:83], v[80:83], v[208:211]
    s_mov_b32 s31, 1
    buffer_load_dword v29, v28, s[12:15], s29 offen
    v_mfma_f32_16x16x32_bf16 v[212:215], a[84:87], v[80:83], v[212:215]
    s_cmp_gt_u32 s33, s42
    s_cbranch_scc0 .pp_355
    buffer_load_dwordx4 v2, s[8:11], s48 offen lds
.pb_356:
    s_waitcnt lgkmcnt(4)
    v_mfma_f32_16x16x32_bf16 v[56:59], v[176:179], v[192:195], 0
    ds_read_b128 v[80:83], v14 offset:1024
    s_add_u32 s29, s29, 0x10000
    v_mfma_f32_16x16x32_bf16 v[56:59], v[180:183], v[196:199], v[56:59]
    s_cmp_gt_u32 s32, s42
    s_cbranch_scc0 .cp_351
.cb_352:
    v_mfma_f32_16x16x32_bf16 v[56:59], v[184:187], v[200:203], v[56:59]
    ds_read_b32 v232, v6 offset:4096
    ds_read_b32 v234, v6 offset:4160
    v_mfma_f32_16x16x32_bf16 v[56:59], v[188:191], v[204:207], v[56:59]
    ds_read_b32 v236, v6 offset:4608
    ds_read_b32 v238, v6 offset:4672
    v_mfma_f32_16x16x32_bf16 v[216:219], a[80:83], v[84:87], v[216:219]
    s_mov_b32 m0, s43
    s_add_u32 s49, s49, 0x40000
    v_mfma_f32_16x16x32_bf16 v[220:223], a[84:87], v[84:87], v[220:223]
    ds_read_b128 v[84:87], v14 offset:33792
    v_mfma_f32_16x16x32_bf16 v[208:211], a[88:91], v[88:91], v[208:211]
    buffer_load_dwordx4 v2, s[8:11], s49 offen lds
    v_mfma_f32_16x16x32_bf16 v[212:215], a[92:95], v[88:91], v[212:215]
    ds_read_b128 v[88:91], v15 offset:1024
    v_max3_f32 v248, v248, v56, v57
    v_mfma_f32_16x16x32_bf16 v[216:219], a[88:91], v[92:95], v[216:219]
    v_max_f32 v30, v248, v249
    v_max_f32 v249, v248, v249
    v_mfma_f32_16x16x32_bf16 v[220:223], a[92:95], v[92:95], v[220:223]
    ds_read_b128 v[92:95], v15 offset:33792
    s_add_u32 s50, s49, 16777216
    v_mfma_f32_16x16x32_bf16 v[208:211], a[96:99], v[96:99], v[208:211]
    v_permlane16_swap_b32 v249, v30
    v_max_f32 v248, v249, v30
    v_mfma_f32_16x16x32_bf16 v[212:215], a[100:103], v[96:99], v[212:215]
    v_max_f32 v249, v249, v30
    ds_read_b128 v[96:99], v12 offset:1280
    v_mfma_f32_16x16x32_bf16 v[216:219], a[96:99], v[100:103], v[216:219]
    buffer_load_dwordx4 v2, s[8:11], s49 offen offset:1024 lds
    v_mfma_f32_16x16x32_bf16 v[220:223], a[100:103], v[100:103], v[220:223]
    v_permlane32_swap_b32 v248, v249
    v_max_f32 v248, v248, v249
    v_mfma_f32_16x16x32_bf16 v[208:211], a[104:107], v[104:107], v[208:211]
    v_mul_f32 v248, s45, v248
    ds_read_b128 v[100:103], v12 offset:34048
    v_mfma_f32_16x16x32_bf16 v[212:215], a[108:111], v[104:107], v[212:215]
    ds_read_b128 v[104:107], v13 offset:1280
    v_fma_f32 v60, v48, s45, -v248
    v_mfma_f32_16x16x32_bf16 v[216:219], a[104:107], v[108:111], v[216:219]
    v_fma_f32 v61, v49, s45, -v248
    v_fma_f32 v62, v50, s45, -v248
    v_mfma_f32_16x16x32_bf16 v[220:223], a[108:111], v[108:111], v[220:223]
    ds_read_b128 v[108:111], v13 offset:34048
    v_fma_f32 v63, v51, s45, -v248
    v_mfma_f32_16x16x32_bf16 v[208:211], a[112:115], v[112:115], v[208:211]
    v_fma_f32 v242, v52, s45, -v248
    v_fma_f32 v243, v53, s45, -v248
    v_mfma_f32_16x16x32_bf16 v[212:215], a[116:119], v[112:115], v[212:215]
    v_fma_f32 v244, v54, s45, -v248
    v_fma_f32 v245, v55, s45, -v248
    v_mfma_f32_16x16x32_bf16 v[216:219], a[112:115], v[116:119], v[216:219]
    v_fma_f32 v246, v56, s45, -v248
    v_fma_f32 v247, v57, s45, -v248
    v_mfma_f32_16x16x32_bf16 v[220:223], a[116:119], v[116:119], v[220:223]
    ds_read_b128 v[112:115], v14 offset:1280
    ds_read_b128 v[116:119], v14 offset:34048
    v_mfma_f32_16x16x32_bf16 v[208:211], a[120:123], v[120:123], v[208:211]
    s_add_u32 m0, s43, 8192
    s_add_u32 s5, s49, 0x40000
    v_mfma_f32_16x16x32_bf16 v[212:215], a[124:127], v[120:123], v[212:215]
    ds_read_b128 v[120:123], v15 offset:1280
    v_mfma_f32_16x16x32_bf16 v[216:219], a[120:123], v[124:127], v[216:219]
    buffer_load_dwordx4 v2, s[8:11], s50 offen lds
    v_mfma_f32_16x16x32_bf16 v[220:223], a[124:127], v[124:127], v[220:223]
    ds_read_b128 v[124:127], v15 offset:34048
    s_waitcnt lgkmcnt(15)
    v_mfma_f32_16x16x32_bf16 v[208:211], a[128:131], v[64:67], v[208:211]
    s_min_u32 s5, s5, s55
    v_mfma_f32_16x16x32_bf16 v[212:215], a[132:135], v[64:67], v[212:215]
    v_exp_f32 v60, v60
    v_mfma_f32_16x16x32_bf16 v[216:219], a[128:131], v[68:71], v[216:219]
    v_exp_f32 v61, v61
    v_mfma_f32_16x16x32_bf16 v[220:223], a[132:135], v[68:71], v[220:223]
    v_exp_f32 v62, v62
    v_mfma_f32_16x16x32_bf16 v[208:211], a[136:139], v[72:75], v[208:211]
    v_exp_f32 v63, v63
    v_mfma_f32_16x16x32_bf16 v[212:215], a[140:143], v[72:75], v[212:215]
    v_exp_f32 v242, v242
    v_mfma_f32_16x16x32_bf16 v[216:219], a[136:139], v[76:79], v[216:219]
    v_exp_f32 v243, v243
    v_mfma_f32_16x16x32_bf16 v[220:223], a[140:143], v[76:79], v[220:223]
    ds_read_b128 v[64:67], v12 offset:1536
    s_waitcnt lgkmcnt(9)
    v_mfma_f32_16x16x32_bf16 v[208:211], a[144:147], v[80:83], v[208:211]
    v_exp_f32 v244, v244
    v_mfma_f32_16x16x32_bf16 v[212:215], a[148:151], v[80:83], v[212:215]
    v_exp_f32 v245, v245
    v_mfma_f32_16x16x32_bf16 v[216:219], a[144:147], v[84:87], v[216:219]
    v_exp_f32 v246, v246
    v_mfma_f32_16x16x32_bf16 v[220:223], a[148:151], v[84:87], v[220:223]
    v_exp_f32 v247, v247
    v_mfma_f32_16x16x32_bf16 v[208:211], a[152:155], v[88:91], v[208:211]
    ds_read_b128 v[68:71], v12 offset:34304
    ds_read_b128 v[72:75], v13 offset:1536
    v_mfma_f32_16x16x32_bf16 v[212:215], a[156:159], v[88:91], v[212:215]
    ds_read_b128 v[76:79], v13 offset:34304
    v_cvt_pk_bf16_f32 v48, v60, v61
    v_mfma_f32_16x16x32_bf16 v[216:219], a[152:155], v[92:95], v[216:219]
    buffer_load_dwordx4 v2, s[8:11], s50 offen offset:1024 lds
    v_mfma_f32_16x16x32_bf16 v[220:223], a[156:159], v[92:95], v[220:223]
    v_cvt_pk_bf16_f32 v49, v62, v63
    s_waitcnt lgkmcnt(8)
    v_mfma_f32_16x16x32_bf16 v[208:211], a[160:163], v[96:99], v[208:211]
    v_cvt_pk_bf16_f32 v50, v242, v243
    v_cvt_pk_bf16_f32 v51, v244, v245
    v_mfma_f32_16x16x32_bf16 v[212:215], a[164:167], v[96:99], v[212:215]
    v_cvt_pk_bf16_f32 v40, v246, v247
    buffer_load_dword v29, v255, s[8:11], s5 offen
    v_mfma_f32_16x16x32_bf16 v[216:219], a[160:163], v[100:103], v[216:219]
    ds_read_b128 v[80:83], v14 offset:1536
    ds_read_b128 v[84:87], v14 offset:34304
    v_mfma_f32_16x16x32_bf16 v[52:55], v[44:47], v[48:51], 0
    ds_read_b128 v[88:91], v15 offset:1536
    ds_read_b128 v[92:95], v15 offset:34304
    v_mfma_f32_16x16x32_bf16 v[52:55], v[44:47], v[40:43], v[52:55]
    ds_read_b128 v[96:99], v12 offset:1792
    v_mfma_f32_16x16x32_bf16 v[192:195], v[160:163], v[48:51], 0
    v_mfma_f32_16x16x32_bf16 v[192:195], v[232:235], v[40:43], v[192:195]
    v_mfma_f32_16x16x32_bf16 v[196:199], v[164:167], v[48:51], 0
    v_mfma_f32_16x16x32_bf16 v[196:199], v[234:237], v[40:43], v[196:199]
    v_mfma_f32_16x16x32_bf16 v[200:203], v[168:171], v[48:51], 0
    v_mfma_f32_16x16x32_bf16 v[200:203], v[236:239], v[40:43], v[200:203]
    v_mfma_f32_16x16x32_bf16 v[204:207], v[172:175], v[48:51], 0
    v_mfma_f32_16x16x32_bf16 v[204:207], v[238:241], v[40:43], v[204:207]
    v_rcp_f32 v248, v52
    v_mfma_f32_16x16x32_bf16 v[220:223], a[164:167], v[100:103], v[220:223]
    ds_read_b128 v[100:103], v12 offset:34560
    v_mul_f32 v192, v248, v192
    v_mfma_f32_16x16x32_bf16 v[208:211], a[168:171], v[104:107], v[208:211]
    v_mul_f32 v193, v248, v193
    v_mul_f32 v194, v248, v194
    v_mfma_f32_16x16x32_bf16 v[212:215], a[172:175], v[104:107], v[212:215]
    ds_read_b128 v[104:107], v13 offset:1792
    v_mul_f32 v195, v248, v195
    v_mfma_f32_16x16x32_bf16 v[216:219], a[168:171], v[108:111], v[216:219]
    v_cvt_pk_bf16_f32 v224, v192, v193
    v_cvt_pk_bf16_f32 v225, v194, v195
    v_mfma_f32_16x16x32_bf16 v[220:223], a[172:175], v[108:111], v[220:223]
    ds_read_b128 v[108:111], v13 offset:34560
    s_waitcnt lgkmcnt(12)
    v_mfma_f32_16x16x32_bf16 v[208:211], a[176:179], v[112:115], v[208:211]
    v_mul_f32 v196, v248, v196
    v_mul_f32 v197, v248, v197
    v_mfma_f32_16x16x32_bf16 v[212:215], a[180:183], v[112:115], v[212:215]
    ds_read_b128 v[112:115], v14 offset:1792
    v_mul_f32 v198, v248, v198
    v_mfma_f32_16x16x32_bf16 v[216:219], a[176:179], v[116:119], v[216:219]
    v_mul_f32 v199, v248, v199
    v_cvt_pk_bf16_f32 v226, v196, v197
    v_mfma_f32_16x16x32_bf16 v[220:223], a[180:183], v[116:119], v[220:223]
    ds_read_b128 v[116:119], v14 offset:34560
    v_cvt_pk_bf16_f32 v227, v198, v199
    v_mfma_f32_16x16x32_bf16 v[208:211], a[184:187], v[120:123], v[208:211]
    v_mfma_f32_16x16x32_bf16 v[212:215], a[188:191], v[120:123], v[212:215]
    ds_read_b128 v[120:123], v15 offset:1792
    v_mfma_f32_16x16x32_bf16 v[216:219], a[184:187], v[124:127], v[216:219]
    v_mfma_f32_16x16x32_bf16 v[220:223], a[188:191], v[124:127], v[220:223]
    ds_read_b128 v[124:127], v15 offset:34560
    s_waitcnt lgkmcnt(12)
    v_mfma_f32_16x16x32_bf16 v[208:211], a[192:195], v[64:67], v[208:211]
    v_mfma_f32_16x16x32_bf16 v[212:215], a[196:199], v[64:67], v[212:215]
    v_mfma_f32_16x16x32_bf16 v[216:219], a[192:195], v[68:71], v[216:219]
    s_cmp_eq_u32 s31, 0
    s_cbranch_scc1 .cp_357
.cb_358:
    v_mfma_f32_16x16x32_bf16 v[220:223], a[196:199], v[68:71], v[220:223]
    s_cbranch_vccnz .cp_345
    buffer_store_dwordx4 v[224:227], v2, s[8:11], s53 offen offset:0
.cb_346:
    v_mfma_f32_16x16x32_bf16 v[208:211], a[200:203], v[72:75], v[208:211]
    s_waitcnt vmcnt(8) lgkmcnt(0)
    s_barrier
    v_mfma_f32_16x16x32_bf16 v[212:215], a[204:207], v[72:75], v[212:215]
    s_add_u32 m0, s6, 65536
    ds_read_b128 v[64:67], v8 offset:0
    v_mfma_f32_16x16x32_bf16 v[216:219], a[200:203], v[76:79], v[216:219]
    buffer_load_dwordx4 v16, s[12:15], s29 offen offset:0 lds
    v_mfma_f32_16x16x32_bf16 v[220:223], a[204:207], v[76:79], v[220:223]
    ds_read_b128 v[68:71], v8 offset:32768
    ds_read_b128 v[72:75], v9 offset:0
    v_mfma_f32_16x16x32_bf16 v[208:211], a[208:211], v[80:83], v[208:211]
    ds_read_b128 v[76:79], v9 offset:32768
    v_mul_f32 v200, v248, v200
    v_mfma_f32_16x16x32_bf16 v[212:215], a[212:215], v[80:83], v[212:215]
    v_mul_f32 v201, v248, v201
    v_mul_f32 v202, v248, v202
    v_mfma_f32_16x16x32_bf16 v[216:219], a[208:211], v[84:87], v[216:219]
    buffer_load_dwordx4 v16, s[12:15], s29 offen offset:1024 lds
    v_mfma_f32_16x16x32_bf16 v[220:223], a[212:215], v[84:87], v[220:223]
    v_mul_f32 v203, v248, v203
    v_cvt_pk_bf16_f32 v228, v200, v201
    v_mfma_f32_16x16x32_bf16 v[208:211], a[216:219], v[88:91], v[208:211]
    v_cvt_pk_bf16_f32 v229, v202, v203
    v_mul_f32 v204, v248, v204
    v_mfma_f32_16x16x32_bf16 v[212:215], a[220:223], v[88:91], v[212:215]
    v_mul_f32 v205, v248, v205
    v_mul_f32 v206, v248, v206
    v_mfma_f32_16x16x32_bf16 v[216:219], a[216:219], v[92:95], v[216:219]
    buffer_load_dwordx4 v17, s[12:15], s29 offen offset:2048 lds
    v_mfma_f32_16x16x32_bf16 v[220:223], a[220:223], v[92:95], v[220:223]
    v_mul_f32 v207, v248, v207
    v_cvt_pk_bf16_f32 v230, v204, v205
    v_mfma_f32_16x16x32_bf16 v[208:211], a[224:227], v[96:99], v[208:211]
    v_cvt_pk_bf16_f32 v231, v206, v207
    ds_read_b128 v[80:83], v10 offset:0
    v_mfma_f32_16x16x32_bf16 v[212:215], a[228:231], v[96:99], v[212:215]
    s_cbranch_vccnz .cp_347
    buffer_store_dwordx4 v[228:231], v2, s[8:11], s53 offen offset:1024
.cb_348:
    v_mfma_f32_16x16x32_bf16 v[216:219], a[224:227], v[100:103], v[216:219]
    buffer_load_dwordx4 v17, s[12:15], s29 offen offset:3072 lds
    v_mfma_f32_16x16x32_bf16 v[220:223], a[228:231], v[100:103], v[220:223]
    ds_read_b128 v[84:87], v10 offset:32768
    ds_read_b128 v[88:91], v11 offset:0
    v_mfma_f32_16x16x32_bf16 v[208:211], a[232:235], v[104:107], v[208:211]
    ds_read_b128 v[92:95], v11 offset:32768
    ds_read_b128 v[96:99], v8 offset:256
    v_mfma_f32_16x16x32_bf16 v[212:215], a[236:239], v[104:107], v[212:215]
    ds_read_b128 v[100:103], v8 offset:33024
    ds_read_b128 v[104:107], v9 offset:256
    v_mfma_f32_16x16x32_bf16 v[216:219], a[232:235], v[108:111], v[216:219]
    s_add_u32 m0, s6, 69632
    s_mov_b32 s53, s40
    v_mfma_f32_16x16x32_bf16 v[220:223], a[236:239], v[108:111], v[220:223]
    buffer_load_dwordx4 v18, s[12:15], s29 offen offset:0 lds
    v_mfma_f32_16x16x32_bf16 v[208:211], a[240:243], v[112:115], v[208:211]
    ds_read_b128 v[108:111], v9 offset:33024
    s_add_u32 s40, s40, 0x40000
    v_mfma_f32_16x16x32_bf16 v[212:215], a[244:247], v[112:115], v[212:215]
    s_mov_b32 s30, s42
    s_add_u32 s42, s42, 1
    v_mfma_f32_16x16x32_bf16 v[216:219], a[240:243], v[116:119], v[216:219]
    v_mfma_f32_16x16x32_bf16 v[220:223], a[244:247], v[116:119], v[220:223]
    buffer_load_dwordx4 v18, s[12:15], s29 offen offset:1024 lds
    v_mfma_f32_16x16x32_bf16 v[208:211], a[248:251], v[120:123], v[208:211]
    v_mfma_f32_16x16x32_bf16 v[212:215], a[252:255], v[120:123], v[212:215]
    v_mfma_f32_16x16x32_bf16 v[216:219], a[248:251], v[124:127], v[216:219]
    v_mfma_f32_16x16x32_bf16 v[220:223], a[252:255], v[124:127], v[220:223]
    s_branch .ql_329
.ql_330:
    s_waitcnt lgkmcnt(8)
    v_mfma_f32_16x16x32_bf16 v[208:211], a[0:3], v[64:67], 0
    ds_read_b128 v[112:115], v14 offset:256
    ds_read_b128 v[116:119], v14 offset:33024
    v_mfma_f32_16x16x32_bf16 v[212:215], a[4:7], v[64:67], 0
    ds_read_b128 v[120:123], v15 offset:256
    ds_read_b128 v[124:127], v15 offset:33024
    v_mfma_f32_16x16x32_bf16 v[216:219], a[0:3], v[68:71], 0
    ds_read_b128 v[64:67], v12 offset:512
    v_mfma_f32_16x16x32_bf16 v[220:223], a[4:7], v[68:71], 0
    ds_read_b128 v[68:71], v12 offset:33280
    v_mfma_f32_16x16x32_bf16 v[208:211], a[8:11], v[72:75], v[208:211]
    v_cvt_pk_bf16_f32 v224, v192, v193
    v_cvt_pk_bf16_f32 v225, v194, v195
    v_mfma_f32_16x16x32_bf16 v[212:215], a[12:15], v[72:75], v[212:215]
    v_cvt_pk_bf16_f32 v226, v196, v197
    v_cvt_pk_bf16_f32 v227, v198, v199
    v_mfma_f32_16x16x32_bf16 v[216:219], a[8:11], v[76:79], v[216:219]
    ds_write_b128 v24, v[224:227] offset:0
    v_cvt_pk_bf16_f32 v228, v200, v201
    v_mfma_f32_16x16x32_bf16 v[220:223], a[12:15], v[76:79], v[220:223]
    v_cvt_pk_bf16_f32 v229, v202, v203
    s_waitcnt lgkmcnt(11)
    v_mfma_f32_16x16x32_bf16 v[208:211], a[16:19], v[80:83], v[208:211]
    v_cvt_pk_bf16_f32 v230, v204, v205
    v_cvt_pk_bf16_f32 v231, v206, v207
    v_mfma_f32_16x16x32_bf16 v[212:215], a[20:23], v[80:83], v[212:215]
    ds_write_b128 v24, v[228:231] offset:4096
    ds_read_b128 v[72:75], v13 offset:512
    v_mfma_f32_16x16x32_bf16 v[216:219], a[16:19], v[84:87], v[216:219]
    ds_read_b128 v[76:79], v13 offset:33280
    ds_read_b128 v[80:83], v14 offset:512
    v_mfma_f32_16x16x32_bf16 v[220:223], a[20:23], v[84:87], v[220:223]
    ds_read_b128 v[84:87], v14 offset:33280
    v_mfma_f32_16x16x32_bf16 v[208:211], a[24:27], v[88:91], v[208:211]
    v_mfma_f32_16x16x32_bf16 v[212:215], a[28:31], v[88:91], v[212:215]
    ds_read_b128 v[88:91], v15 offset:512
    v_mfma_f32_16x16x32_bf16 v[216:219], a[24:27], v[92:95], v[216:219]
    s_waitcnt vmcnt(9) lgkmcnt(5)
    s_barrier
    v_mfma_f32_16x16x32_bf16 v[220:223], a[28:31], v[92:95], v[220:223]
    ds_read_b128 v[192:195], v25 offset:0
    ds_read_b128 v[128:131], v31 offset:0
    v_mfma_f32_16x16x32_bf16 v[208:211], a[32:35], v[96:99], v[208:211]
    ds_read_b128 v[144:147], v31 offset:4096
    ds_read_b128 v[196:199], v25 offset:1024
    v_mfma_f32_16x16x32_bf16 v[212:215], a[36:39], v[96:99], v[212:215]
    ds_read_b128 v[132:135], v31 offset:1024
    ds_read_b128 v[148:151], v31 offset:5120
    v_mfma_f32_16x16x32_bf16 v[216:219], a[32:35], v[100:103], v[216:219]
    ds_read_b128 v[92:95], v15 offset:33280
    ds_read_b128 v[200:203], v25 offset:2048
    v_mfma_f32_16x16x32_bf16 v[220:223], a[36:39], v[100:103], v[220:223]
    ds_read_b128 v[136:139], v31 offset:2048
    ds_read_b128 v[152:155], v31 offset:6144
    v_mfma_f32_16x16x32_bf16 v[208:211], a[40:43], v[104:107], v[208:211]
    ds_read_b128 v[204:207], v25 offset:3072
    ds_read_b128 v[140:143], v31 offset:3072
    v_mfma_f32_16x16x32_bf16 v[212:215], a[44:47], v[104:107], v[212:215]
    ds_read_b128 v[156:159], v31 offset:7168
    ds_read_b128 v[160:163], v5 offset:8192
    v_mfma_f32_16x16x32_bf16 v[216:219], a[40:43], v[108:111], v[216:219]
    ds_read_b128 v[164:167], v5 offset:9216
    s_waitcnt lgkmcnt(12)
    v_mfma_f32_16x16x32_bf16 v[48:51], v[128:131], v[192:195], v[32:35]
    ds_read_b128 v[96:99], v12 offset:768
    ds_read_b128 v[100:103], v12 offset:33536
    v_mfma_f32_16x16x32_bf16 v[52:55], v[144:147], v[192:195], v[36:39]
    ds_read_b128 v[104:107], v13 offset:768
    s_waitcnt lgkmcnt(12)
    v_mfma_f32_16x16x32_bf16 v[48:51], v[132:135], v[196:199], v[48:51]
    ds_read_b128 v[168:171], v5 offset:10240
    ds_read_b128 v[172:175], v5 offset:11264
    v_mfma_f32_16x16x32_bf16 v[52:55], v[148:151], v[196:199], v[52:55]
    v_max_i32 v27, s30, v26
    s_waitcnt lgkmcnt(10)
    v_mfma_f32_16x16x32_bf16 v[48:51], v[136:139], v[200:203], v[48:51]
    s_waitcnt vmcnt(3)
    s_cbranch_vccnz .cp_363
    buffer_store_dword v27, v26, s[8:11], s94 offen
.cb_364:
    v_mfma_f32_16x16x32_bf16 v[52:55], v[152:155], v[200:203], v[52:55]
    s_waitcnt lgkmcnt(7)
    v_mfma_f32_16x16x32_bf16 v[48:51], v[140:143], v[204:207], v[48:51]
    s_waitcnt lgkmcnt(0)
    s_barrier
    v_mfma_f32_16x16x32_bf16 v[52:55], v[156:159], v[204:207], v[52:55]
    s_cmp_gt_u32 s32, s42
    s_cbranch_scc0 .cp_365
.cb_366:
    v_mfma_f32_16x16x32_bf16 v[220:223], a[44:47], v[108:111], v[220:223]
    ds_read_b128 v[108:111], v13 offset:33536
    s_mov_b32 m0, s43
    v_mfma_f32_16x16x32_bf16 v[208:211], a[48:51], v[112:115], v[208:211]
    s_add_u32 s49, s49, 0x40000
    v_mfma_f32_16x16x32_bf16 v[212:215], a[52:55], v[112:115], v[212:215]
    ds_read_b128 v[112:115], v14 offset:768
    v_mfma_f32_16x16x32_bf16 v[216:219], a[48:51], v[116:119], v[216:219]
    buffer_load_dwordx4 v2, s[8:11], s49 offen lds
    v_mfma_f32_16x16x32_bf16 v[220:223], a[52:55], v[116:119], v[220:223]
    ds_read_b128 v[116:119], v14 offset:33536
    s_add_u32 s50, s49, 16777216
    v_mfma_f32_16x16x32_bf16 v[208:211], a[56:59], v[120:123], v[208:211]
    v_mfma_f32_16x16x32_bf16 v[212:215], a[60:63], v[120:123], v[212:215]
    ds_read_b128 v[120:123], v15 offset:768
    v_mfma_f32_16x16x32_bf16 v[216:219], a[56:59], v[124:127], v[216:219]
    buffer_load_dwordx4 v2, s[8:11], s49 offen offset:1024 lds
    v_mfma_f32_16x16x32_bf16 v[220:223], a[60:63], v[124:127], v[220:223]
    ds_read_b128 v[124:127], v15 offset:33536
    s_add_u32 m0, s43, 8192
    v_mfma_f32_16x16x32_bf16 v[208:211], a[64:67], v[64:67], v[208:211]
    s_add_u32 s5, s49, 0x40000
    v_mfma_f32_16x16x32_bf16 v[212:215], a[68:71], v[64:67], v[212:215]
    ds_read_b128 v[64:67], v12 offset:1024
    v_mfma_f32_16x16x32_bf16 v[216:219], a[64:67], v[68:71], v[216:219]
    buffer_load_dwordx4 v2, s[8:11], s50 offen lds
    v_mfma_f32_16x16x32_bf16 v[220:223], a[68:71], v[68:71], v[220:223]
    ds_read_b128 v[68:71], v12 offset:33792
    s_min_u32 s5, s5, s55
    v_mfma_f32_16x16x32_bf16 v[208:211], a[72:75], v[72:75], v[208:211]
    v_mfma_f32_16x16x32_bf16 v[212:215], a[76:79], v[72:75], v[212:215]
    ds_read_b128 v[72:75], v13 offset:1024
    v_mfma_f32_16x16x32_bf16 v[216:219], a[72:75], v[76:79], v[216:219]
    buffer_load_dwordx4 v2, s[8:11], s50 offen offset:1024 lds
    v_mfma_f32_16x16x32_bf16 v[220:223], a[76:79], v[76:79], v[220:223]
    ds_read_b128 v[76:79], v13 offset:33792
    v_mfma_f32_16x16x32_bf16 v[208:211], a[80:83], v[80:83], v[208:211]
    v_mfma_f32_16x16x32_bf16 v[212:215], a[84:87], v[80:83], v[212:215]
    ds_read_b128 v[80:83], v14 offset:1024
    v_mfma_f32_16x16x32_bf16 v[216:219], a[80:83], v[84:87], v[216:219]
    v_mfma_f32_16x16x32_bf16 v[220:223], a[84:87], v[84:87], v[220:223]
    ds_read_b128 v[84:87], v14 offset:33792
    v_mfma_f32_16x16x32_bf16 v[208:211], a[88:91], v[88:91], v[208:211]
    v_mfma_f32_16x16x32_bf16 v[212:215], a[92:95], v[88:91], v[212:215]
    ds_read_b128 v[88:91], v15 offset:1024
    v_mfma_f32_16x16x32_bf16 v[216:219], a[88:91], v[92:95], v[216:219]
    v_mfma_f32_16x16x32_bf16 v[220:223], a[92:95], v[92:95], v[220:223]
    ds_read_b128 v[92:95], v15 offset:33792
    s_waitcnt lgkmcnt(12)
    v_mfma_f32_16x16x32_bf16 v[208:211], a[96:99], v[96:99], v[208:211]
    v_mfma_f32_16x16x32_bf16 v[212:215], a[100:103], v[96:99], v[212:215]
    ds_read_b128 v[96:99], v12 offset:1280
    v_mfma_f32_16x16x32_bf16 v[216:219], a[96:99], v[100:103], v[216:219]
    v_mfma_f32_16x16x32_bf16 v[220:223], a[100:103], v[100:103], v[220:223]
    ds_read_b128 v[100:103], v12 offset:34048
    v_mfma_f32_16x16x32_bf16 v[208:211], a[104:107], v[104:107], v[208:211]
    v_mfma_f32_16x16x32_bf16 v[212:215], a[108:111], v[104:107], v[212:215]
    ds_read_b128 v[104:107], v13 offset:1280
    v_mfma_f32_16x16x32_bf16 v[216:219], a[104:107], v[108:111], v[216:219]
    v_mfma_f32_16x16x32_bf16 v[220:223], a[108:111], v[108:111], v[220:223]
    ds_read_b128 v[108:111], v13 offset:34048
    s_waitcnt lgkmcnt(12)
    v_mfma_f32_16x16x32_bf16 v[208:211], a[112:115], v[112:115], v[208:211]
    v_mfma_f32_16x16x32_bf16 v[212:215], a[116:119], v[112:115], v[212:215]
    ds_read_b128 v[112:115], v14 offset:1280
    v_mfma_f32_16x16x32_bf16 v[216:219], a[112:115], v[116:119], v[216:219]
    v_mfma_f32_16x16x32_bf16 v[220:223], a[116:119], v[116:119], v[220:223]
    ds_read_b128 v[116:119], v14 offset:34048
    v_mfma_f32_16x16x32_bf16 v[208:211], a[120:123], v[120:123], v[208:211]
    v_mfma_f32_16x16x32_bf16 v[212:215], a[124:127], v[120:123], v[212:215]
    ds_read_b128 v[120:123], v15 offset:1280
    v_mfma_f32_16x16x32_bf16 v[216:219], a[120:123], v[124:127], v[216:219]
    v_mfma_f32_16x16x32_bf16 v[220:223], a[124:127], v[124:127], v[220:223]
    ds_read_b128 v[124:127], v15 offset:34048
    s_waitcnt lgkmcnt(12)
    v_mfma_f32_16x16x32_bf16 v[208:211], a[128:131], v[64:67], v[208:211]
    v_mfma_f32_16x16x32_bf16 v[212:215], a[132:135], v[64:67], v[212:215]
    ds_read_b128 v[64:67], v12 offset:1536
    v_mfma_f32_16x16x32_bf16 v[216:219], a[128:131], v[68:71], v[216:219]
    v_mfma_f32_16x16x32_bf16 v[220:223], a[132:135], v[68:71], v[220:223]
    ds_read_b128 v[68:71], v12 offset:34304
    v_mfma_f32_16x16x32_bf16 v[208:211], a[136:139], v[72:75], v[208:211]
    v_mfma_f32_16x16x32_bf16 v[212:215], a[140:143], v[72:75], v[212:215]
    ds_read_b128 v[72:75], v13 offset:1536
    v_mfma_f32_16x16x32_bf16 v[216:219], a[136:139], v[76:79], v[216:219]
    v_mfma_f32_16x16x32_bf16 v[220:223], a[140:143], v[76:79], v[220:223]
    ds_read_b128 v[76:79], v13 offset:34304
    s_waitcnt lgkmcnt(12)
    v_mfma_f32_16x16x32_bf16 v[208:211], a[144:147], v[80:83], v[208:211]
    v_mfma_f32_16x16x32_bf16 v[212:215], a[148:151], v[80:83], v[212:215]
    ds_read_b128 v[80:83], v14 offset:1536
    v_mfma_f32_16x16x32_bf16 v[216:219], a[144:147], v[84:87], v[216:219]
    v_mfma_f32_16x16x32_bf16 v[220:223], a[148:151], v[84:87], v[220:223]
    ds_read_b128 v[84:87], v14 offset:34304
    v_mfma_f32_16x16x32_bf16 v[208:211], a[152:155], v[88:91], v[208:211]
    v_mfma_f32_16x16x32_bf16 v[212:215], a[156:159], v[88:91], v[212:215]
    ds_read_b128 v[88:91], v15 offset:1536
    v_mfma_f32_16x16x32_bf16 v[216:219], a[152:155], v[92:95], v[216:219]
    v_mfma_f32_16x16x32_bf16 v[220:223], a[156:159], v[92:95], v[220:223]
    ds_read_b128 v[92:95], v15 offset:34304
    s_waitcnt lgkmcnt(12)
    v_mfma_f32_16x16x32_bf16 v[208:211], a[160:163], v[96:99], v[208:211]
    v_mfma_f32_16x16x32_bf16 v[212:215], a[164:167], v[96:99], v[212:215]
    ds_read_b128 v[96:99], v12 offset:1792
    v_mfma_f32_16x16x32_bf16 v[216:219], a[160:163], v[100:103], v[216:219]
    v_mfma_f32_16x16x32_bf16 v[220:223], a[164:167], v[100:103], v[220:223]
    ds_read_b128 v[100:103], v12 offset:34560
    v_mfma_f32_16x16x32_bf16 v[208:211], a[168:171], v[104:107], v[208:211]
    v_mfma_f32_16x16x32_bf16 v[212:215], a[172:175], v[104:107], v[212:215]
    ds_read_b128 v[104:107], v13 offset:1792
    v_mfma_f32_16x16x32_bf16 v[216:219], a[168:171], v[108:111], v[216:219]
    v_mfma_f32_16x16x32_bf16 v[220:223], a[172:175], v[108:111], v[220:223]
    ds_read_b128 v[108:111], v13 offset:34560
    s_waitcnt lgkmcnt(12)
    v_mfma_f32_16x16x32_bf16 v[208:211], a[176:179], v[112:115], v[208:211]
    v_mfma_f32_16x16x32_bf16 v[212:215], a[180:183], v[112:115], v[212:215]
    ds_read_b128 v[112:115], v14 offset:1792
    v_mfma_f32_16x16x32_bf16 v[216:219], a[176:179], v[116:119], v[216:219]
    v_mfma_f32_16x16x32_bf16 v[220:223], a[180:183], v[116:119], v[220:223]
    ds_read_b128 v[116:119], v14 offset:34560
    v_mfma_f32_16x16x32_bf16 v[208:211], a[184:187], v[120:123], v[208:211]
    v_mfma_f32_16x16x32_bf16 v[212:215], a[188:191], v[120:123], v[212:215]
    ds_read_b128 v[120:123], v15 offset:1792
    v_mfma_f32_16x16x32_bf16 v[216:219], a[184:187], v[124:127], v[216:219]
    v_mfma_f32_16x16x32_bf16 v[220:223], a[188:191], v[124:127], v[220:223]
    ds_read_b128 v[124:127], v15 offset:34560
    s_waitcnt lgkmcnt(12)
    v_mfma_f32_16x16x32_bf16 v[208:211], a[192:195], v[64:67], v[208:211]
    v_mfma_f32_16x16x32_bf16 v[212:215], a[196:199], v[64:67], v[212:215]
    v_mfma_f32_16x16x32_bf16 v[216:219], a[192:195], v[68:71], v[216:219]
    v_mfma_f32_16x16x32_bf16 v[220:223], a[196:199], v[68:71], v[220:223]
    v_mfma_f32_16x16x32_bf16 v[208:211], a[200:203], v[72:75], v[208:211]
    v_mfma_f32_16x16x32_bf16 v[212:215], a[204:207], v[72:75], v[212:215]
    v_mfma_f32_16x16x32_bf16 v[216:219], a[200:203], v[76:79], v[216:219]
    v_mfma_f32_16x16x32_bf16 v[220:223], a[204:207], v[76:79], v[220:223]
    s_waitcnt lgkmcnt(8)
    v_mfma_f32_16x16x32_bf16 v[208:211], a[208:211], v[80:83], v[208:211]
    v_mfma_f32_16x16x32_bf16 v[212:215], a[212:215], v[80:83], v[212:215]
    v_mfma_f32_16x16x32_bf16 v[216:219], a[208:211], v[84:87], v[216:219]
    v_mfma_f32_16x16x32_bf16 v[220:223], a[212:215], v[84:87], v[220:223]
    v_mfma_f32_16x16x32_bf16 v[208:211], a[216:219], v[88:91], v[208:211]
    v_mfma_f32_16x16x32_bf16 v[212:215], a[220:223], v[88:91], v[212:215]
    v_mfma_f32_16x16x32_bf16 v[216:219], a[216:219], v[92:95], v[216:219]
    v_mfma_f32_16x16x32_bf16 v[220:223], a[220:223], v[92:95], v[220:223]
    s_waitcnt lgkmcnt(4)
    v_mfma_f32_16x16x32_bf16 v[208:211], a[224:227], v[96:99], v[208:211]
    v_mfma_f32_16x16x32_bf16 v[212:215], a[228:231], v[96:99], v[212:215]
    v_mfma_f32_16x16x32_bf16 v[216:219], a[224:227], v[100:103], v[216:219]
    v_mfma_f32_16x16x32_bf16 v[220:223], a[228:231], v[100:103], v[220:223]
    v_mfma_f32_16x16x32_bf16 v[208:211], a[232:235], v[104:107], v[208:211]
    v_mfma_f32_16x16x32_bf16 v[212:215], a[236:239], v[104:107], v[212:215]
    v_mfma_f32_16x16x32_bf16 v[216:219], a[232:235], v[108:111], v[216:219]
    v_mfma_f32_16x16x32_bf16 v[220:223], a[236:239], v[108:111], v[220:223]
    s_waitcnt lgkmcnt(0)
    v_mfma_f32_16x16x32_bf16 v[208:211], a[240:243], v[112:115], v[208:211]
    v_mfma_f32_16x16x32_bf16 v[212:215], a[244:247], v[112:115], v[212:215]
    v_mfma_f32_16x16x32_bf16 v[216:219], a[240:243], v[116:119], v[216:219]
    v_mfma_f32_16x16x32_bf16 v[220:223], a[244:247], v[116:119], v[220:223]
    v_mfma_f32_16x16x32_bf16 v[208:211], a[248:251], v[120:123], v[208:211]
    v_mfma_f32_16x16x32_bf16 v[212:215], a[252:255], v[120:123], v[212:215]
    v_mfma_f32_16x16x32_bf16 v[216:219], a[248:251], v[124:127], v[216:219]
    v_mfma_f32_16x16x32_bf16 v[220:223], a[252:255], v[124:127], v[220:223]
    s_cmp_eq_u32 s31, 0
    s_cbranch_scc1 .cp_371
.cb_372:
    s_barrier
    ds_read_b128 v[176:179], v3 offset:4096
    ds_read_b128 v[180:183], v3 offset:4608
    ds_read_b128 v[184:187], v3 offset:5120
    ds_read_b128 v[188:191], v3 offset:5632
    ds_read_b32 v232, v6 offset:4096
    ds_read_b32 v234, v6 offset:4160
    ds_read_b32 v236, v6 offset:4608
    ds_read_b32 v238, v6 offset:4672
    v_max3_f32 v248, v48, v49, v50
    v_max3_f32 v248, v248, v51, v52
    v_max3_f32 v249, v53, v54, v55
    s_waitcnt lgkmcnt(4)
    v_mfma_f32_16x16x32_bf16 v[56:59], v[176:179], v[192:195], 0
    v_mfma_f32_16x16x32_bf16 v[56:59], v[180:183], v[196:199], v[56:59]
    v_mfma_f32_16x16x32_bf16 v[56:59], v[184:187], v[200:203], v[56:59]
    v_mfma_f32_16x16x32_bf16 v[56:59], v[188:191], v[204:207], v[56:59]
    s_nop 7
    v_max3_f32 v248, v248, v56, v57
    v_max_f32 v30, v248, v249
    v_max_f32 v249, v248, v249
    s_nop 1
    v_permlane16_swap_b32 v249, v30
    v_max_f32 v248, v249, v30
    v_max_f32 v249, v249, v30
    s_nop 1
    v_permlane32_swap_b32 v248, v249
    v_max_f32 v248, v248, v249
    v_mul_f32 v248, s45, v248
    v_fma_f32 v60, v48, s45, -v248
    v_fma_f32 v61, v49, s45, -v248
    v_fma_f32 v62, v50, s45, -v248
    v_fma_f32 v63, v51, s45, -v248
    v_fma_f32 v242, v52, s45, -v248
    v_fma_f32 v243, v53, s45, -v248
    v_fma_f32 v244, v54, s45, -v248
    v_fma_f32 v245, v55, s45, -v248
    v_fma_f32 v246, v56, s45, -v248
    v_fma_f32 v247, v57, s45, -v248
    v_exp_f32 v60, v60
    v_exp_f32 v61, v61
    v_exp_f32 v62, v62
    v_exp_f32 v63, v63
    v_exp_f32 v242, v242
    v_exp_f32 v243, v243
    v_exp_f32 v244, v244
    v_exp_f32 v245, v245
    v_exp_f32 v246, v246
    v_exp_f32 v247, v247
    v_cvt_pk_bf16_f32 v48, v60, v61
    v_cvt_pk_bf16_f32 v49, v62, v63
    v_cvt_pk_bf16_f32 v50, v242, v243
    v_cvt_pk_bf16_f32 v51, v244, v245
    v_cvt_pk_bf16_f32 v40, v246, v247
    s_waitcnt lgkmcnt(0)
    v_mfma_f32_16x16x32_bf16 v[52:55], v[44:47], v[48:51], 0
    v_mfma_f32_16x16x32_bf16 v[52:55], v[44:47], v[40:43], v[52:55]
    v_mfma_f32_16x16x32_bf16 v[192:195], v[160:163], v[48:51], 0
    v_mfma_f32_16x16x32_bf16 v[192:195], v[232:235], v[40:43], v[192:195]
    v_mfma_f32_16x16x32_bf16 v[196:199], v[164:167], v[48:51], 0
    v_mfma_f32_16x16x32_bf16 v[196:199], v[234:237], v[40:43], v[196:199]
    v_mfma_f32_16x16x32_bf16 v[200:203], v[168:171], v[48:51], 0
    v_mfma_f32_16x16x32_bf16 v[200:203], v[236:239], v[40:43], v[200:203]
    v_mfma_f32_16x16x32_bf16 v[204:207], v[172:175], v[48:51], 0
    v_mfma_f32_16x16x32_bf16 v[204:207], v[238:241], v[40:43], v[204:207]
    v_rcp_f32 v248, v52
    s_nop 0
    v_mul_f32 v192, v248, v192
    v_mul_f32 v193, v248, v193
    v_mul_f32 v194, v248, v194
    v_mul_f32 v195, v248, v195
    v_cvt_pk_bf16_f32 v224, v192, v193
    v_cvt_pk_bf16_f32 v225, v194, v195
    v_mul_f32 v196, v248, v196
    v_mul_f32 v197, v248, v197
    v_mul_f32 v198, v248, v198
    v_mul_f32 v199, v248, v199
    v_cvt_pk_bf16_f32 v226, v196, v197
    v_cvt_pk_bf16_f32 v227, v198, v199
    s_cbranch_vccnz .cp_367
    buffer_store_dwordx4 v[224:227], v2, s[8:11], s53 offen offset:0
.cb_368:
    v_mul_f32 v200, v248, v200
    v_mul_f32 v201, v248, v201
    v_mul_f32 v202, v248, v202
    v_mul_f32 v203, v248, v203
    v_cvt_pk_bf16_f32 v228, v200, v201
    v_cvt_pk_bf16_f32 v229, v202, v203
    v_mul_f32 v204, v248, v204
    v_mul_f32 v205, v248, v205
    v_mul_f32 v206, v248, v206
    v_mul_f32 v207, v248, v207
    v_cvt_pk_bf16_f32 v230, v204, v205
    v_cvt_pk_bf16_f32 v231, v206, v207
    s_cbranch_vccnz .cp_369
    buffer_store_dwordx4 v[228:231], v2, s[8:11], s53 offen offset:1024
.cb_370:
    s_add_u32 s30, s30, 1
    s_mov_b32 s53, s40
    s_waitcnt vmcnt(0)
    v_max_i32 v27, s30, v26
    s_cbranch_vccnz .cp_373
    buffer_store_dword v27, v26, s[8:11], s94 offen
.cb_374:
    s_add_u32 s48, s48, 0x20000
    s_mov_b32 s31, 0
    v_cvt_pk_bf16_f32 v224, v208, v209
    v_cvt_pk_bf16_f32 v225, v210, v211
    v_cvt_pk_bf16_f32 v226, v212, v213
    v_cvt_pk_bf16_f32 v227, v214, v215
    v_cvt_pk_bf16_f32 v228, v216, v217
    v_cvt_pk_bf16_f32 v229, v218, v219
    v_cvt_pk_bf16_f32 v230, v220, v221
    v_cvt_pk_bf16_f32 v231, v222, v223
    ds_write_b128 v24, v[224:227] offset:0
    ds_write_b128 v24, v[228:231] offset:4096
    s_waitcnt lgkmcnt(0)
    s_barrier
    ds_read_b128 v[208:211], v25 offset:0
    ds_read_b128 v[128:131], v31 offset:0
    ds_read_b128 v[144:147], v31 offset:4096
    ds_read_b128 v[212:215], v25 offset:1024
    ds_read_b128 v[132:135], v31 offset:1024
    ds_read_b128 v[148:151], v31 offset:5120
    ds_read_b128 v[216:219], v25 offset:2048
    ds_read_b128 v[136:139], v31 offset:2048
    ds_read_b128 v[152:155], v31 offset:6144
    ds_read_b128 v[220:223], v25 offset:3072
    ds_read_b128 v[140:143], v31 offset:3072
    ds_read_b128 v[156:159], v31 offset:7168
    ds_read_b128 v[160:163], v5 offset:8192
    ds_read_b128 v[164:167], v5 offset:9216
    ds_read_b128 v[168:171], v5 offset:10240
    ds_read_b128 v[172:175], v5 offset:11264
    s_waitcnt lgkmcnt(4)
    v_mfma_f32_16x16x32_bf16 v[48:51], v[128:131], v[208:211], v[32:35]
    v_mfma_f32_16x16x32_bf16 v[52:55], v[144:147], v[208:211], v[36:39]
    v_mfma_f32_16x16x32_bf16 v[48:51], v[132:135], v[212:215], v[48:51]
    v_mfma_f32_16x16x32_bf16 v[52:55], v[148:151], v[212:215], v[52:55]
    v_mfma_f32_16x16x32_bf16 v[48:51], v[136:139], v[216:219], v[48:51]
    v_mfma_f32_16x16x32_bf16 v[52:55], v[152:155], v[216:219], v[52:55]
    v_mfma_f32_16x16x32_bf16 v[48:51], v[140:143], v[220:223], v[48:51]
    v_mfma_f32_16x16x32_bf16 v[52:55], v[156:159], v[220:223], v[52:55]
    s_cmp_eq_u32 s31, 0
    s_cbranch_scc1 .cp_383
.cb_384:
    s_barrier
    ds_read_b128 v[176:179], v3 offset:0
    ds_read_b128 v[180:183], v3 offset:512
    ds_read_b128 v[184:187], v3 offset:1024
    ds_read_b128 v[188:191], v3 offset:1536
    ds_read_b32 v232, v6 offset:0
    ds_read_b32 v234, v6 offset:64
    ds_read_b32 v236, v6 offset:512
    ds_read_b32 v238, v6 offset:576
    v_max3_f32 v248, v48, v49, v50
    v_max3_f32 v248, v248, v51, v52
    v_max3_f32 v249, v53, v54, v55
    s_waitcnt lgkmcnt(4)
    v_mfma_f32_16x16x32_bf16 v[56:59], v[176:179], v[208:211], 0
    v_mfma_f32_16x16x32_bf16 v[56:59], v[180:183], v[212:215], v[56:59]
    v_mfma_f32_16x16x32_bf16 v[56:59], v[184:187], v[216:219], v[56:59]
    v_mfma_f32_16x16x32_bf16 v[56:59], v[188:191], v[220:223], v[56:59]
    s_nop 7
    v_max3_f32 v248, v248, v56, v57
    v_max_f32 v30, v248, v249
    v_max_f32 v249, v248, v249
    s_nop 1
    v_permlane16_swap_b32 v249, v30
    v_max_f32 v248, v249, v30
    v_max_f32 v249, v249, v30
    s_nop 1
    v_permlane32_swap_b32 v248, v249
    v_max_f32 v248, v248, v249
    v_mul_f32 v248, s45, v248
    v_fma_f32 v60, v48, s45, -v248
    v_fma_f32 v61, v49, s45, -v248
    v_fma_f32 v62, v50, s45, -v248
    v_fma_f32 v63, v51, s45, -v248
    v_fma_f32 v242, v52, s45, -v248
    v_fma_f32 v243, v53, s45, -v248
    v_fma_f32 v244, v54, s45, -v248
    v_fma_f32 v245, v55, s45, -v248
    v_fma_f32 v246, v56, s45, -v248
    v_fma_f32 v247, v57, s45, -v248
    v_exp_f32 v60, v60
    v_exp_f32 v61, v61
    v_exp_f32 v62, v62
    v_exp_f32 v63, v63
    v_exp_f32 v242, v242
    v_exp_f32 v243, v243
    v_exp_f32 v244, v244
    v_exp_f32 v245, v245
    v_exp_f32 v246, v246
    v_exp_f32 v247, v247
    v_cvt_pk_bf16_f32 v48, v60, v61
    v_cvt_pk_bf16_f32 v49, v62, v63
    v_cvt_pk_bf16_f32 v50, v242, v243
    v_cvt_pk_bf16_f32 v51, v244, v245
    v_cvt_pk_bf16_f32 v40, v246, v247
    s_waitcnt lgkmcnt(0)
    v_mfma_f32_16x16x32_bf16 v[52:55], v[44:47], v[48:51], 0
    v_mfma_f32_16x16x32_bf16 v[52:55], v[44:47], v[40:43], v[52:55]
    v_mfma_f32_16x16x32_bf16 v[208:211], v[160:163], v[48:51], 0
    v_mfma_f32_16x16x32_bf16 v[208:211], v[232:235], v[40:43], v[208:211]
    v_mfma_f32_16x16x32_bf16 v[212:215], v[164:167], v[48:51], 0
    v_mfma_f32_16x16x32_bf16 v[212:215], v[234:237], v[40:43], v[212:215]
    v_mfma_f32_16x16x32_bf16 v[216:219], v[168:171], v[48:51], 0
    v_mfma_f32_16x16x32_bf16 v[216:219], v[236:239], v[40:43], v[216:219]
    v_mfma_f32_16x16x32_bf16 v[220:223], v[172:175], v[48:51], 0
    v_mfma_f32_16x16x32_bf16 v[220:223], v[238:241], v[40:43], v[220:223]
    v_rcp_f32 v248, v52
    s_nop 0
    v_mul_f32 v208, v248, v208
    v_mul_f32 v209, v248, v209
    v_mul_f32 v210, v248, v210
    v_mul_f32 v211, v248, v211
    v_cvt_pk_bf16_f32 v224, v208, v209
    v_cvt_pk_bf16_f32 v225, v210, v211
    v_mul_f32 v212, v248, v212
    v_mul_f32 v213, v248, v213
    v_mul_f32 v214, v248, v214
    v_mul_f32 v215, v248, v215
    v_cvt_pk_bf16_f32 v226, v212, v213
    v_cvt_pk_bf16_f32 v227, v214, v215
    s_cbranch_vccnz .cp_379
    buffer_store_dwordx4 v[224:227], v2, s[8:11], s53 offen offset:0
.cb_380:
    v_mul_f32 v216, v248, v216
    v_mul_f32 v217, v248, v217
    v_mul_f32 v218, v248, v218
    v_mul_f32 v219, v248, v219
    v_cvt_pk_bf16_f32 v228, v216, v217
    v_cvt_pk_bf16_f32 v229, v218, v219
    v_mul_f32 v220, v248, v220
    v_mul_f32 v221, v248, v221
    v_mul_f32 v222, v248, v222
    v_mul_f32 v223, v248, v223
    v_cvt_pk_bf16_f32 v230, v220, v221
    v_cvt_pk_bf16_f32 v231, v222, v223
    s_cbranch_vccnz .cp_381
    buffer_store_dwordx4 v[228:231], v2, s[8:11], s53 offen offset:1024
.cb_382:
    s_add_u32 s30, s30, 1
    s_mov_b32 s53, s40
    s_waitcnt vmcnt(0)
    v_max_i32 v27, s30, v26
    s_cbranch_vccnz .cp_385
    buffer_store_dword v27, v26, s[8:11], s94 offen
.cb_386:
    s_endpgm
.cp_331:
    buffer_store_dwordx4 v[224:227], v2, s[8:11], s53 offen offset:0 sc1
    s_branch .cb_332
.cp_333:
    buffer_store_dwordx4 v[228:231], v2, s[8:11], s53 offen offset:1024 sc1
    s_branch .cb_334
.cp_335:
    buffer_store_dword v27, v26, s[8:11], s94 offen sc1
    s_branch .cb_336
.cp_337:
    s_cmp_gt_u32 s32, s42
    s_cbranch_scc1 .ndd_388
    s_mov_b32 s62, 0
.nd_387:
    buffer_load_dword v29, v7, s[8:11], s46 offen sc1
    buffer_load_dword v30, v7, s[8:11], s47 offen sc1
    s_add_u32 s62, s62, 1
    s_cmp_gt_u32 s62, 0x200000
    s_cbranch_scc1 .mg_end_1
    s_waitcnt vmcnt(0)
    v_min_u32 v29, v29, v30
    s_nop 1
    v_min_u32_dpp v29, v29, v29 quad_perm:[1,0,3,2] row_mask:0xf bank_mask:0xf
    s_nop 1
    v_min_u32_dpp v29, v29, v29 quad_perm:[2,3,0,1] row_mask:0xf bank_mask:0xf
    s_nop 1
    v_readfirstlane_b32 s32, v29
    s_lshl_b32 s55, s32, 18
    s_add_u32 s55, s55, s37
    s_cmp_gt_u32 s32, s42
    s_cbranch_scc1 .ndd_388
    s_sleep 4
    s_branch .nd_387
.ndd_388:
    s_branch .cb_338
.cp_339:
    s_cmp_gt_u32 s33, s30
    s_cbranch_scc1 .ndd_390
    s_mov_b32 s62, 0
.nd_389:
    buffer_load_dword v4, v7, s[8:11], 0 offen sc1
    s_add_u32 s62, s62, 1
    s_cmp_gt_u32 s62, 0x200000
    s_cbranch_scc1 .mg_end_1
    s_waitcnt vmcnt(0)
    v_min_u32_dpp v4, v4, v4 quad_perm:[1,0,3,2] row_mask:0xf bank_mask:0xf
    s_nop 1
    v_min_u32_dpp v4, v4, v4 quad_perm:[2,3,0,1] row_mask:0xf bank_mask:0xf
    s_nop 1
    v_readfirstlane_b32 s33, v4
    s_cmp_gt_u32 s33, s30
    s_cbranch_scc1 .ndd_390
    s_sleep 4
    s_branch .nd_389
.ndd_390:
    s_add_u32 m0, s52, 0
    s_nop 0
    buffer_load_dwordx4 v2, s[8:11], s48 offen lds
    s_waitcnt vmcnt(0)
    s_branch .cb_340
.pp_341:
    buffer_load_dword v4, v7, s[8:11], 0 offen sc1
    s_mov_b32 s31, 0
    s_branch .pb_342
.cp_343:
    s_waitcnt vmcnt(1)
    v_min_u32_dpp v4, v4, v4 quad_perm:[1,0,3,2] row_mask:0xf bank_mask:0xf
    s_nop 1
    v_min_u32_dpp v4, v4, v4 quad_perm:[2,3,0,1] row_mask:0xf bank_mask:0xf
    s_nop 1
    v_readfirstlane_b32 s33, v4
    s_cmp_gt_u32 s33, s42
    s_cbranch_scc0 .cb_344
    s_mov_b32 s31, 1
    s_add_u32 m0, s52, 4096
    s_nop 0
    buffer_load_dwordx4 v2, s[8:11], s48 offen lds
    s_branch .cb_344
.cp_345:
    buffer_store_dwordx4 v[224:227], v2, s[8:11], s53 offen offset:0 sc1
    s_branch .cb_346
.cp_347:
    buffer_store_dwordx4 v[228:231], v2, s[8:11], s53 offen offset:1024 sc1
    s_branch .cb_348
.cp_349:
    buffer_store_dword v27, v26, s[8:11], s94 offen sc1
    s_branch .cb_350
.cp_351:
    s_cmp_gt_u32 s32, s42
    s_cbranch_scc1 .ndd_392
    s_mov_b32 s62, 0
.nd_391:
    buffer_load_dword v29, v7, s[8:11], s46 offen sc1
    buffer_load_dword v30, v7, s[8:11], s47 offen sc1
    s_add_u32 s62, s62, 1
    s_cmp_gt_u32 s62, 0x200000
    s_cbranch_scc1 .mg_end_1
    s_waitcnt vmcnt(0)
    v_min_u32 v29, v29, v30
    s_nop 1
    v_min_u32_dpp v29, v29, v29 quad_perm:[1,0,3,2] row_mask:0xf bank_mask:0xf
    s_nop 1
    v_min_u32_dpp v29, v29, v29 quad_perm:[2,3,0,1] row_mask:0xf bank_mask:0xf
    s_nop 1
    v_readfirstlane_b32 s32, v29
    s_lshl_b32 s55, s32, 18
    s_add_u32 s55, s55, s37
    s_cmp_gt_u32 s32, s42
    s_cbranch_scc1 .ndd_392
    s_sleep 4
    s_branch .nd_391
.ndd_392:
    s_branch .cb_352
.cp_353:
    s_cmp_gt_u32 s33, s30
    s_cbranch_scc1 .ndd_394
    s_mov_b32 s62, 0
.nd_393:
    buffer_load_dword v4, v7, s[8:11], 0 offen sc1
    s_add_u32 s62, s62, 1
    s_cmp_gt_u32 s62, 0x200000
    s_cbranch_scc1 .mg_end_1
    s_waitcnt vmcnt(0)
    v_min_u32_dpp v4, v4, v4 quad_perm:[1,0,3,2] row_mask:0xf bank_mask:0xf
    s_nop 1
    v_min_u32_dpp v4, v4, v4 quad_perm:[2,3,0,1] row_mask:0xf bank_mask:0xf
    s_nop 1
    v_readfirstlane_b32 s33, v4
    s_cmp_gt_u32 s33, s30
    s_cbranch_scc1 .ndd_394
    s_sleep 4
    s_branch .nd_393
.ndd_394:
    s_add_u32 m0, s52, 4096
    s_nop 0
    buffer_load_dwordx4 v2, s[8:11], s48 offen lds
    s_waitcnt vmcnt(0)
    s_branch .cb_354
.pp_355:
    buffer_load_dword v4, v7, s[8:11], 0 offen sc1
    s_mov_b32 s31, 0
    s_branch .pb_356
.cp_357:
    s_waitcnt vmcnt(1)
    v_min_u32_dpp v4, v4, v4 quad_perm:[1,0,3,2] row_mask:0xf bank_mask:0xf
    s_nop 1
    v_min_u32_dpp v4, v4, v4 quad_perm:[2,3,0,1] row_mask:0xf bank_mask:0xf
    s_nop 1
    v_readfirstlane_b32 s33, v4
    s_cmp_gt_u32 s33, s42
    s_cbranch_scc0 .cb_358
    s_mov_b32 s31, 1
    s_add_u32 m0, s52, 0
    s_nop 0
    buffer_load_dwordx4 v2, s[8:11], s48 offen lds
    s_branch .cb_358
.cp_363:
    buffer_store_dword v27, v26, s[8:11], s94 offen sc1
    s_branch .cb_364
.cp_365:
    s_cmp_gt_u32 s32, s42
    s_cbranch_scc1 .ndd_396
    s_mov_b32 s62, 0
.nd_395:
    buffer_load_dword v29, v7, s[8:11], s46 offen sc1
    buffer_load_dword v30, v7, s[8:11], s47 offen sc1
    s_add_u32 s62, s62, 1
    s_cmp_gt_u32 s62, 0x200000
    s_cbranch_scc1 .mg_end_1
    s_waitcnt vmcnt(0)
    v_min_u32 v29, v29, v30
    s_nop 1
    v_min_u32_dpp v29, v29, v29 quad_perm:[1,0,3,2] row_mask:0xf bank_mask:0xf
    s_nop 1
    v_min_u32_dpp v29, v29, v29 quad_perm:[2,3,0,1] row_mask:0xf bank_mask:0xf
    s_nop 1
    v_readfirstlane_b32 s32, v29
    s_lshl_b32 s55, s32, 18
    s_add_u32 s55, s55, s37
    s_cmp_gt_u32 s32, s42
    s_cbranch_scc1 .ndd_396
    s_sleep 4
    s_branch .nd_395
.ndd_396:
    s_branch .cb_366
.cp_367:
    buffer_store_dwordx4 v[224:227], v2, s[8:11], s53 offen offset:0 sc1
    s_branch .cb_368
.cp_369:
    buffer_store_dwordx4 v[228:231], v2, s[8:11], s53 offen offset:1024 sc1
    s_branch .cb_370
.cp_371:
    s_cmp_gt_u32 s33, s30
    s_cbranch_scc1 .ndd_398
    s_mov_b32 s62, 0
.nd_397:
    buffer_load_dword v4, v7, s[8:11], 0 offen sc1
    s_add_u32 s62, s62, 1
    s_cmp_gt_u32 s62, 0x200000
    s_cbranch_scc1 .mg_end_1
    s_waitcnt vmcnt(0)
    v_min_u32_dpp v4, v4, v4 quad_perm:[1,0,3,2] row_mask:0xf bank_mask:0xf
    s_nop 1
    v_min_u32_dpp v4, v4, v4 quad_perm:[2,3,0,1] row_mask:0xf bank_mask:0xf
    s_nop 1
    v_readfirstlane_b32 s33, v4
    s_cmp_gt_u32 s33, s30
    s_cbranch_scc1 .ndd_398
    s_sleep 4
    s_branch .nd_397
.ndd_398:
    s_add_u32 m0, s52, 4096
    s_nop 0
    buffer_load_dwordx4 v2, s[8:11], s48 offen lds
    s_waitcnt vmcnt(0)
    s_branch .cb_372
.cp_373:
    buffer_store_dword v27, v26, s[8:11], s94 offen sc1
    s_branch .cb_374
.cp_379:
    buffer_store_dwordx4 v[224:227], v2, s[8:11], s53 offen offset:0 sc1
    s_branch .cb_380
.cp_381:
    buffer_store_dwordx4 v[228:231], v2, s[8:11], s53 offen offset:1024 sc1
    s_branch .cb_382
.cp_383:
    s_cmp_gt_u32 s33, s30
    s_cbranch_scc1 .ndd_400
    s_mov_b32 s62, 0
.nd_399:
    buffer_load_dword v4, v7, s[8:11], 0 offen sc1
    s_add_u32 s62, s62, 1
    s_cmp_gt_u32 s62, 0x200000
    s_cbranch_scc1 .mg_end_1
    s_waitcnt vmcnt(0)
    v_min_u32_dpp v4, v4, v4 quad_perm:[1,0,3,2] row_mask:0xf bank_mask:0xf
    s_nop 1
    v_min_u32_dpp v4, v4, v4 quad_perm:[2,3,0,1] row_mask:0xf bank_mask:0xf
    s_nop 1
    v_readfirstlane_b32 s33, v4
    s_cmp_gt_u32 s33, s30
    s_cbranch_scc1 .ndd_400
    s_sleep 4
    s_branch .nd_399
.ndd_400:
    s_add_u32 m0, s52, 0
    s_nop 0
    buffer_load_dwordx4 v2, s[8:11], s48 offen lds
    s_waitcnt vmcnt(0)
    s_branch .cb_384
.cp_385:
    buffer_store_dword v27, v26, s[8:11], s94 offen sc1
    s_branch .cb_386
.ph2_293:
    s_load_dwordx2 s[42:43], s[0:1], 88
    s_lshr_b32 s34, s99, 3
    s_and_b32 s35, s99, 7
    s_lshl_b32 s4, s34, 21
    s_lshl_b32 s5, s35, 8
    s_add_u32 s4, s4, s5
    s_lshl_b32 s6, s24, 14
    s_mul_i32 s5, s24, 131072
    s_add_u32 s4, s4, s5
    v_bfe_u32 v2, v1, 4, 1
    v_lshlrev_b32 v2, 2, v2
    v_and_b32 v3, 7, v1
    v_xor_b32 v2, v2, v3
    v_lshlrev_b32 v2, 4, v2
    v_bfe_u32 v254, v1, 3, 2
    v_mul_u32_u24 v240, 2048, v254
    v_bfe_u32 v254, v1, 5, 1
    v_mul_u32_u24 v254, 128, v254
    v_add_u32 v240, v240, v254
    v_add_u32 v240, s4, v240
    v_add_u32 v240, v2, v240
    s_lshr_b32 s5, s24, 1
    s_lshl_b32 s5, s5, 9
    v_bfe_u32 v2, v1, 3, 1
    v_xor_b32 v2, s24, v2
    v_and_b32 v2, 1, v2
    v_lshlrev_b32 v2, 6, v2
    v_bfe_u32 v254, v1, 4, 2
    v_mul_u32_u24 v242, 2048, v254
    v_bfe_u32 v254, v1, 2, 2
    v_mul_u32_u24 v254, 128, v254
    v_add_u32 v242, v242, v254
    v_bfe_u32 v254, v1, 0, 2
    v_mul_u32_u24 v254, 16, v254
    v_add_u32 v242, v242, v254
    v_add_u32 v242, s5, v242
    v_add_u32 v242, v2, v242
    v_add_u32 v243, 0x10000, v242
    s_waitcnt lgkmcnt(0)
    s_mov_b32 s16, s42
    s_and_b32 s17, s43, 0xffff
    s_mov_b32 s18, 0x800000
    s_mov_b32 s19, 0x00020000
    s_add_u32 m0, s6, 0
    s_mov_b32 s5, 0
    buffer_load_dwordx4 v240, s[16:19], s5 offen nt lds
    s_add_u32 m0, s6, 1024
    s_mov_b32 s5, 8192
    buffer_load_dwordx4 v240, s[16:19], s5 offen nt lds
    s_add_u32 m0, s6, 2048
    s_mov_b32 s5, 16384
    buffer_load_dwordx4 v240, s[16:19], s5 offen nt lds
    s_add_u32 m0, s6, 3072
    s_mov_b32 s5, 24576
    buffer_load_dwordx4 v240, s[16:19], s5 offen nt lds
    s_add_u32 m0, s6, 4096
    s_mov_b32 s5, 32768
    buffer_load_dwordx4 v240, s[16:19], s5 offen nt lds
    s_add_u32 m0, s6, 5120
    s_mov_b32 s5, 40960
    buffer_load_dwordx4 v240, s[16:19], s5 offen nt lds
    s_add_u32 m0, s6, 6144
    s_mov_b32 s5, 49152
    buffer_load_dwordx4 v240, s[16:19], s5 offen nt lds
    s_add_u32 m0, s6, 7168
    s_mov_b32 s5, 57344
    buffer_load_dwordx4 v240, s[16:19], s5 offen nt lds
    s_add_u32 m0, s6, 8192
    s_mov_b32 s5, 65536
    buffer_load_dwordx4 v240, s[16:19], s5 offen nt lds
    s_add_u32 m0, s6, 9216
    s_mov_b32 s5, 73728
    buffer_load_dwordx4 v240, s[16:19], s5 offen nt lds
    s_add_u32 m0, s6, 10240
    s_mov_b32 s5, 81920
    buffer_load_dwordx4 v240, s[16:19], s5 offen nt lds
    s_add_u32 m0, s6, 11264
    s_mov_b32 s5, 90112
    buffer_load_dwordx4 v240, s[16:19], s5 offen nt lds
    s_add_u32 m0, s6, 12288
    s_mov_b32 s5, 98304
    buffer_load_dwordx4 v240, s[16:19], s5 offen nt lds
    s_add_u32 m0, s6, 13312
    s_mov_b32 s5, 106496
    buffer_load_dwordx4 v240, s[16:19], s5 offen nt lds
    s_add_u32 m0, s6, 14336
    s_mov_b32 s5, 114688
    buffer_load_dwordx4 v240, s[16:19], s5 offen nt lds
    s_add_u32 m0, s6, 15360
    s_mov_b32 s5, 122880
    buffer_load_dwordx4 v240, s[16:19], s5 offen nt lds
    s_add_u32 m0, s6, 65536
    s_mov_b32 s5, 524288
    buffer_load_dwordx4 v240, s[16:19], s5 offen nt lds
    s_add_u32 m0, s6, 66560
    s_mov_b32 s5, 532480
    buffer_load_dwordx4 v240, s[16:19], s5 offen nt lds
    s_add_u32 m0, s6, 67584
    s_mov_b32 s5, 540672
    buffer_load_dwordx4 v240, s[16:19], s5 offen nt lds
    s_add_u32 m0, s6, 68608
    s_mov_b32 s5, 548864
    buffer_load_dwordx4 v240, s[16:19], s5 offen nt lds
    s_add_u32 m0, s6, 69632
    s_mov_b32 s5, 557056
    buffer_load_dwordx4 v240, s[16:19], s5 offen nt lds
    s_add_u32 m0, s6, 70656
    s_mov_b32 s5, 565248
    buffer_load_dwordx4 v240, s[16:19], s5 offen nt lds
    s_add_u32 m0, s6, 71680
    s_mov_b32 s5, 573440
    buffer_load_dwordx4 v240, s[16:19], s5 offen nt lds
    s_add_u32 m0, s6, 72704
    s_mov_b32 s5, 581632
    buffer_load_dwordx4 v240, s[16:19], s5 offen nt lds
    s_add_u32 m0, s6, 73728
    s_mov_b32 s5, 589824
    buffer_load_dwordx4 v240, s[16:19], s5 offen nt lds
    s_add_u32 m0, s6, 74752
    s_mov_b32 s5, 598016
    buffer_load_dwordx4 v240, s[16:19], s5 offen nt lds
    s_add_u32 m0, s6, 75776
    s_mov_b32 s5, 606208
    buffer_load_dwordx4 v240, s[16:19], s5 offen nt lds
    s_add_u32 m0, s6, 76800
    s_mov_b32 s5, 614400
    buffer_load_dwordx4 v240, s[16:19], s5 offen nt lds
    s_add_u32 m0, s6, 77824
    s_mov_b32 s5, 622592
    buffer_load_dwordx4 v240, s[16:19], s5 offen nt lds
    s_add_u32 m0, s6, 78848
    s_mov_b32 s5, 630784
    buffer_load_dwordx4 v240, s[16:19], s5 offen nt lds
    s_add_u32 m0, s6, 79872
    s_mov_b32 s5, 638976
    buffer_load_dwordx4 v240, s[16:19], s5 offen nt lds
    s_add_u32 m0, s6, 80896
    s_mov_b32 s5, 647168
    buffer_load_dwordx4 v240, s[16:19], s5 offen nt lds
    v_lshlrev_b32 v2, 4, v1
    v_mov_b32 v8, v2
    s_lshl_b32 s36, s24, 12
    s_lshl_b32 s4, s34, 16
    s_add_u32 s4, s4, s36
    v_add_u32 v9, s4, v2
    s_lshl_b32 s4, s34, 10
    s_add_u32 s4, s4, 92340224
    v_bfe_u32 v254, v1, 0, 3
    v_mul_u32_u24 v7, 128, v254
    v_add_u32 v7, s4, v7
    s_lshl_b32 s4, s35, 2
    s_add_u32 s4, s4, s24
    s_lshl_b32 s5, s4, 9
    s_lshl_b32 s94, s34, 7
    s_add_u32 s94, s94, s5
    s_add_u32 s94, s94, 92323840
    s_lshl_b32 s38, s4, 1
    s_and_b32 s5, s34, 1
    s_or_b32 s38, s38, s5
    s_lshl_b32 s4, s35, 22
    s_lshl_b32 s37, s34, 20
    s_add_u32 s37, s37, s4
    s_lshl_b32 s4, s24, 18
    s_add_u32 s37, s37, s4
    s_add_u32 s37, s37, 150994944
    s_mov_b32 s29, 16777216
    s_mov_b32 s28, 0
    s_mov_b32 s33, 0
    s_mov_b32 s39, 0
    v_mov_b32 v26, 0
    s_waitcnt vmcnt(16)
    s_barrier
    ds_read_b64_tr_b16 a[0:1], v242 offset:0
    ds_read_b64_tr_b16 a[2:3], v242 offset:1024
    ds_read_b64_tr_b16 a[4:5], v242 offset:8
    ds_read_b64_tr_b16 a[6:7], v242 offset:1032
    ds_read_b64_tr_b16 a[8:9], v242 offset:8192
    ds_read_b64_tr_b16 a[10:11], v242 offset:9216
    ds_read_b64_tr_b16 a[12:13], v242 offset:8200
    ds_read_b64_tr_b16 a[14:15], v242 offset:9224
    ds_read_b64_tr_b16 a[16:17], v242 offset:16384
    ds_read_b64_tr_b16 a[18:19], v242 offset:17408
    ds_read_b64_tr_b16 a[20:21], v242 offset:16392
    ds_read_b64_tr_b16 a[22:23], v242 offset:17416
    ds_read_b64_tr_b16 a[24:25], v242 offset:24576
    ds_read_b64_tr_b16 a[26:27], v242 offset:25600
    ds_read_b64_tr_b16 a[28:29], v242 offset:24584
    ds_read_b64_tr_b16 a[30:31], v242 offset:25608
    ds_read_b64_tr_b16 a[32:33], v242 offset:32768
    ds_read_b64_tr_b16 a[34:35], v242 offset:33792
    ds_read_b64_tr_b16 a[36:37], v242 offset:32776
    ds_read_b64_tr_b16 a[38:39], v242 offset:33800
    ds_read_b64_tr_b16 a[40:41], v242 offset:40960
    ds_read_b64_tr_b16 a[42:43], v242 offset:41984
    ds_read_b64_tr_b16 a[44:45], v242 offset:40968
    ds_read_b64_tr_b16 a[46:47], v242 offset:41992
    ds_read_b64_tr_b16 a[48:49], v242 offset:49152
    ds_read_b64_tr_b16 a[50:51], v242 offset:50176
    ds_read_b64_tr_b16 a[52:53], v242 offset:49160
    ds_read_b64_tr_b16 a[54:55], v242 offset:50184
    ds_read_b64_tr_b16 a[56:57], v242 offset:57344
    ds_read_b64_tr_b16 a[58:59], v242 offset:58368
    ds_read_b64_tr_b16 a[60:61], v242 offset:57352
    ds_read_b64_tr_b16 a[62:63], v242 offset:58376
    s_waitcnt lgkmcnt(0)
    s_barrier
    s_add_u32 m0, s6, 0
    s_mov_b32 s5, 1048576
    buffer_load_dwordx4 v240, s[16:19], s5 offen nt lds
    s_add_u32 m0, s6, 1024
    s_mov_b32 s5, 1056768
    buffer_load_dwordx4 v240, s[16:19], s5 offen nt lds
    s_add_u32 m0, s6, 2048
    s_mov_b32 s5, 1064960
    buffer_load_dwordx4 v240, s[16:19], s5 offen nt lds
    s_add_u32 m0, s6, 3072
    s_mov_b32 s5, 1073152
    buffer_load_dwordx4 v240, s[16:19], s5 offen nt lds
    s_add_u32 m0, s6, 4096
    s_mov_b32 s5, 1081344
    buffer_load_dwordx4 v240, s[16:19], s5 offen nt lds
    s_add_u32 m0, s6, 5120
    s_mov_b32 s5, 1089536
    buffer_load_dwordx4 v240, s[16:19], s5 offen nt lds
    s_add_u32 m0, s6, 6144
    s_mov_b32 s5, 1097728
    buffer_load_dwordx4 v240, s[16:19], s5 offen nt lds
    s_add_u32 m0, s6, 7168
    s_mov_b32 s5, 1105920
    buffer_load_dwordx4 v240, s[16:19], s5 offen nt lds
    s_add_u32 m0, s6, 8192
    s_mov_b32 s5, 1114112
    buffer_load_dwordx4 v240, s[16:19], s5 offen nt lds
    s_add_u32 m0, s6, 9216
    s_mov_b32 s5, 1122304
    buffer_load_dwordx4 v240, s[16:19], s5 offen nt lds
    s_add_u32 m0, s6, 10240
    s_mov_b32 s5, 1130496
    buffer_load_dwordx4 v240, s[16:19], s5 offen nt lds
    s_add_u32 m0, s6, 11264
    s_mov_b32 s5, 1138688
    buffer_load_dwordx4 v240, s[16:19], s5 offen nt lds
    s_add_u32 m0, s6, 12288
    s_mov_b32 s5, 1146880
    buffer_load_dwordx4 v240, s[16:19], s5 offen nt lds
    s_add_u32 m0, s6, 13312
    s_mov_b32 s5, 1155072
    buffer_load_dwordx4 v240, s[16:19], s5 offen nt lds
    s_add_u32 m0, s6, 14336
    s_mov_b32 s5, 1163264
    buffer_load_dwordx4 v240, s[16:19], s5 offen nt lds
    s_add_u32 m0, s6, 15360
    s_mov_b32 s5, 1171456
    buffer_load_dwordx4 v240, s[16:19], s5 offen nt lds
    s_waitcnt vmcnt(16)
    s_barrier
    ds_read_b64_tr_b16 a[64:65], v243 offset:0
    ds_read_b64_tr_b16 a[66:67], v243 offset:1024
    ds_read_b64_tr_b16 a[68:69], v243 offset:8
    ds_read_b64_tr_b16 a[70:71], v243 offset:1032
    ds_read_b64_tr_b16 a[72:73], v243 offset:8192
    ds_read_b64_tr_b16 a[74:75], v243 offset:9216
    ds_read_b64_tr_b16 a[76:77], v243 offset:8200
    ds_read_b64_tr_b16 a[78:79], v243 offset:9224
    ds_read_b64_tr_b16 a[80:81], v243 offset:16384
    ds_read_b64_tr_b16 a[82:83], v243 offset:17408
    ds_read_b64_tr_b16 a[84:85], v243 offset:16392
    ds_read_b64_tr_b16 a[86:87], v243 offset:17416
    ds_read_b64_tr_b16 a[88:89], v243 offset:24576
    ds_read_b64_tr_b16 a[90:91], v243 offset:25600
    ds_read_b64_tr_b16 a[92:93], v243 offset:24584
    ds_read_b64_tr_b16 a[94:95], v243 offset:25608
    ds_read_b64_tr_b16 a[96:97], v243 offset:32768
    ds_read_b64_tr_b16 a[98:99], v243 offset:33792
    ds_read_b64_tr_b16 a[100:101], v243 offset:32776
    ds_read_b64_tr_b16 a[102:103], v243 offset:33800
    ds_read_b64_tr_b16 a[104:105], v243 offset:40960
    ds_read_b64_tr_b16 a[106:107], v243 offset:41984
    ds_read_b64_tr_b16 a[108:109], v243 offset:40968
    ds_read_b64_tr_b16 a[110:111], v243 offset:41992
    ds_read_b64_tr_b16 a[112:113], v243 offset:49152
    ds_read_b64_tr_b16 a[114:115], v243 offset:50176
    ds_read_b64_tr_b16 a[116:117], v243 offset:49160
    ds_read_b64_tr_b16 a[118:119], v243 offset:50184
    ds_read_b64_tr_b16 a[120:121], v243 offset:57344
    ds_read_b64_tr_b16 a[122:123], v243 offset:58368
    ds_read_b64_tr_b16 a[124:125], v243 offset:57352
    ds_read_b64_tr_b16 a[126:127], v243 offset:58376
    s_waitcnt lgkmcnt(0)
    s_barrier
    s_add_u32 m0, s6, 65536
    s_mov_b32 s5, 1572864
    buffer_load_dwordx4 v240, s[16:19], s5 offen nt lds
    s_add_u32 m0, s6, 66560
    s_mov_b32 s5, 1581056
    buffer_load_dwordx4 v240, s[16:19], s5 offen nt lds
    s_add_u32 m0, s6, 67584
    s_mov_b32 s5, 1589248
    buffer_load_dwordx4 v240, s[16:19], s5 offen nt lds
    s_add_u32 m0, s6, 68608
    s_mov_b32 s5, 1597440
    buffer_load_dwordx4 v240, s[16:19], s5 offen nt lds
    s_add_u32 m0, s6, 69632
    s_mov_b32 s5, 1605632
    buffer_load_dwordx4 v240, s[16:19], s5 offen nt lds
    s_add_u32 m0, s6, 70656
    s_mov_b32 s5, 1613824
    buffer_load_dwordx4 v240, s[16:19], s5 offen nt lds
    s_add_u32 m0, s6, 71680
    s_mov_b32 s5, 1622016
    buffer_load_dwordx4 v240, s[16:19], s5 offen nt lds
    s_add_u32 m0, s6, 72704
    s_mov_b32 s5, 1630208
    buffer_load_dwordx4 v240, s[16:19], s5 offen nt lds
    s_add_u32 m0, s6, 73728
    s_mov_b32 s5, 1638400
    buffer_load_dwordx4 v240, s[16:19], s5 offen nt lds
    s_add_u32 m0, s6, 74752
    s_mov_b32 s5, 1646592
    buffer_load_dwordx4 v240, s[16:19], s5 offen nt lds
    s_add_u32 m0, s6, 75776
    s_mov_b32 s5, 1654784
    buffer_load_dwordx4 v240, s[16:19], s5 offen nt lds
    s_add_u32 m0, s6, 76800
    s_mov_b32 s5, 1662976
    buffer_load_dwordx4 v240, s[16:19], s5 offen nt lds
    s_add_u32 m0, s6, 77824
    s_mov_b32 s5, 1671168
    buffer_load_dwordx4 v240, s[16:19], s5 offen nt lds
    s_add_u32 m0, s6, 78848
    s_mov_b32 s5, 1679360
    buffer_load_dwordx4 v240, s[16:19], s5 offen nt lds
    s_add_u32 m0, s6, 79872
    s_mov_b32 s5, 1687552
    buffer_load_dwordx4 v240, s[16:19], s5 offen nt lds
    s_add_u32 m0, s6, 80896
    s_mov_b32 s5, 1695744
    buffer_load_dwordx4 v240, s[16:19], s5 offen nt lds
    s_waitcnt vmcnt(16)
    s_barrier
    ds_read_b64_tr_b16 a[128:129], v242 offset:0
    ds_read_b64_tr_b16 a[130:131], v242 offset:1024
    ds_read_b64_tr_b16 a[132:133], v242 offset:8
    ds_read_b64_tr_b16 a[134:135], v242 offset:1032
    ds_read_b64_tr_b16 a[136:137], v242 offset:8192
    ds_read_b64_tr_b16 a[138:139], v242 offset:9216
    ds_read_b64_tr_b16 a[140:141], v242 offset:8200
    ds_read_b64_tr_b16 a[142:143], v242 offset:9224
    ds_read_b64_tr_b16 a[144:145], v242 offset:16384
    ds_read_b64_tr_b16 a[146:147], v242 offset:17408
    ds_read_b64_tr_b16 a[148:149], v242 offset:16392
    ds_read_b64_tr_b16 a[150:151], v242 offset:17416
    ds_read_b64_tr_b16 a[152:153], v242 offset:24576
    ds_read_b64_tr_b16 a[154:155], v242 offset:25600
    ds_read_b64_tr_b16 a[156:157], v242 offset:24584
    ds_read_b64_tr_b16 a[158:159], v242 offset:25608
    ds_read_b64_tr_b16 a[160:161], v242 offset:32768
    ds_read_b64_tr_b16 a[162:163], v242 offset:33792
    ds_read_b64_tr_b16 a[164:165], v242 offset:32776
    ds_read_b64_tr_b16 a[166:167], v242 offset:33800
    ds_read_b64_tr_b16 a[168:169], v242 offset:40960
    ds_read_b64_tr_b16 a[170:171], v242 offset:41984
    ds_read_b64_tr_b16 a[172:173], v242 offset:40968
    ds_read_b64_tr_b16 a[174:175], v242 offset:41992
    ds_read_b64_tr_b16 a[176:177], v242 offset:49152
    ds_read_b64_tr_b16 a[178:179], v242 offset:50176
    ds_read_b64_tr_b16 a[180:181], v242 offset:49160
    ds_read_b64_tr_b16 a[182:183], v242 offset:50184
    ds_read_b64_tr_b16 a[184:185], v242 offset:57344
    ds_read_b64_tr_b16 a[186:187], v242 offset:58368
    ds_read_b64_tr_b16 a[188:189], v242 offset:57352
    ds_read_b64_tr_b16 a[190:191], v242 offset:58376
    s_waitcnt lgkmcnt(0)
    s_barrier
    s_waitcnt vmcnt(0)
    s_barrier
    ds_read_b64_tr_b16 a[192:193], v243 offset:0
    ds_read_b64_tr_b16 a[194:195], v243 offset:1024
    ds_read_b64_tr_b16 a[196:197], v243 offset:8
    ds_read_b64_tr_b16 a[198:199], v243 offset:1032
    ds_read_b64_tr_b16 a[200:201], v243 offset:8192
    ds_read_b64_tr_b16 a[202:203], v243 offset:9216
    ds_read_b64_tr_b16 a[204:205], v243 offset:8200
    ds_read_b64_tr_b16 a[206:207], v243 offset:9224
    ds_read_b64_tr_b16 a[208:209], v243 offset:16384
    ds_read_b64_tr_b16 a[210:211], v243 offset:17408
    ds_read_b64_tr_b16 a[212:213], v243 offset:16392
    ds_read_b64_tr_b16 a[214:215], v243 offset:17416
    ds_read_b64_tr_b16 a[216:217], v243 offset:24576
    ds_read_b64_tr_b16 a[218:219], v243 offset:25600
    ds_read_b64_tr_b16 a[220:221], v243 offset:24584
    ds_read_b64_tr_b16 a[222:223], v243 offset:25608
    ds_read_b64_tr_b16 a[224:225], v243 offset:32768
    ds_read_b64_tr_b16 a[226:227], v243 offset:33792
    ds_read_b64_tr_b16 a[228:229], v243 offset:32776
    ds_read_b64_tr_b16 a[230:231], v243 offset:33800
    ds_read_b64_tr_b16 a[232:233], v243 offset:40960
    ds_read_b64_tr_b16 a[234:235], v243 offset:41984
    ds_read_b64_tr_b16 a[236:237], v243 offset:40968
    ds_read_b64_tr_b16 a[238:239], v243 offset:41992
    ds_read_b64_tr_b16 a[240:241], v243 offset:49152
    ds_read_b64_tr_b16 a[242:243], v243 offset:50176
    ds_read_b64_tr_b16 a[244:245], v243 offset:49160
    ds_read_b64_tr_b16 a[246:247], v243 offset:50184
    ds_read_b64_tr_b16 a[248:249], v243 offset:57344
    ds_read_b64_tr_b16 a[250:251], v243 offset:58368
    ds_read_b64_tr_b16 a[252:253], v243 offset:57352
    ds_read_b64_tr_b16 a[254:255], v243 offset:58376
    s_waitcnt lgkmcnt(0)
    s_barrier
.cold_401:
    s_mov_b32 s62, 0
.gp_405:
    buffer_load_dwordx4 v[12:15], v7, s[8:11], 0 offen sc1
    s_add_u32 s62, s62, 1
    s_cmp_gt_u32 s62, 0x200000
    s_cbranch_scc1 .mg_end_1
    s_waitcnt vmcnt(0)
    v_min3_u32 v4, v12, v13, v14
    v_min_u32 v4, v4, v15
    s_nop 1
    v_min_u32_dpp v4, v4, v4 quad_perm:[1,0,3,2] row_mask:0xf bank_mask:0xf
    s_nop 1
    v_min_u32_dpp v4, v4, v4 quad_perm:[2,3,0,1] row_mask:0xf bank_mask:0xf
    s_nop 1
    v_min_u32_dpp v4, v4, v4 row_half_mirror row_mask:0xf bank_mask:0xf
    s_nop 1
    v_readfirstlane_b32 s33, v4
    s_cmp_gt_u32 s33, s28
    s_cbranch_scc1 .go_402
    s_sleep 4
    s_branch .gp_405
.go_402:
    s_add_u32 m0, s36, 0
    s_add_u32 s31, s29, 0
    buffer_load_dwordx4 v9, s[8:11], s31 offen offset:0 sc1 lds
    buffer_load_dwordx4 v9, s[8:11], s31 offen offset:1024 sc1 lds
    buffer_load_dwordx4 v9, s[8:11], s31 offen offset:2048 sc1 lds
    buffer_load_dwordx4 v9, s[8:11], s31 offen offset:3072 sc1 lds
    s_add_u32 m0, s36, 16384
    s_add_u32 s31, s29, 16384
    buffer_load_dwordx4 v9, s[8:11], s31 offen offset:0 sc1 lds
    buffer_load_dwordx4 v9, s[8:11], s31 offen offset:1024 sc1 lds
    buffer_load_dwordx4 v9, s[8:11], s31 offen offset:2048 sc1 lds
    buffer_load_dwordx4 v9, s[8:11], s31 offen offset:3072 sc1 lds
.body_403:
    s_waitcnt vmcnt(4)
    s_barrier
    ds_read_b128 v[64:67], v8 offset:0
    ds_read_b128 v[68:71], v8 offset:4096
    ds_read_b128 v[72:75], v8 offset:1024
    ds_read_b128 v[76:79], v8 offset:5120
    ds_read_b128 v[80:83], v8 offset:2048
    ds_read_b128 v[84:87], v8 offset:6144
    ds_read_b128 v[88:91], v8 offset:3072
    ds_read_b128 v[92:95], v8 offset:7168
    s_waitcnt lgkmcnt(6)
    v_mfma_f32_16x16x32_bf16 v[192:195], a[0:3], v[64:67], 0
    s_add_u32 m0, s36, 32768
    s_add_u32 s31, s29, 32768
    v_mfma_f32_16x16x32_bf16 v[196:199], a[4:7], v[64:67], 0
    buffer_load_dwordx4 v9, s[8:11], s31 offen offset:0 sc1 lds
    v_mfma_f32_16x16x32_bf16 v[200:203], a[0:3], v[68:71], 0
    ds_read_b128 v[96:99], v8 offset:8192
    ds_read_b128 v[100:103], v8 offset:12288
    v_mfma_f32_16x16x32_bf16 v[204:207], a[4:7], v[68:71], 0
    ds_read_b128 v[104:107], v8 offset:9216
    s_waitcnt lgkmcnt(7)
    v_mfma_f32_16x16x32_bf16 v[192:195], a[8:11], v[72:75], v[192:195]
    ds_read_b128 v[108:111], v8 offset:13312
    ds_read_b128 v[112:115], v8 offset:10240
    v_mfma_f32_16x16x32_bf16 v[196:199], a[12:15], v[72:75], v[196:199]
    buffer_load_dwordx4 v9, s[8:11], s31 offen offset:1024 sc1 lds
    v_mfma_f32_16x16x32_bf16 v[200:203], a[8:11], v[76:79], v[200:203]
    ds_read_b128 v[116:119], v8 offset:14336
    ds_read_b128 v[120:123], v8 offset:11264
    v_mfma_f32_16x16x32_bf16 v[204:207], a[12:15], v[76:79], v[204:207]
    ds_read_b128 v[124:127], v8 offset:15360
    s_waitcnt lgkmcnt(10)
    v_mfma_f32_16x16x32_bf16 v[192:195], a[16:19], v[80:83], v[192:195]
    buffer_load_dwordx4 v9, s[8:11], s31 offen offset:2048 sc1 lds
    v_mfma_f32_16x16x32_bf16 v[196:199], a[20:23], v[80:83], v[196:199]
    v_mfma_f32_16x16x32_bf16 v[200:203], a[16:19], v[84:87], v[200:203]
    v_mfma_f32_16x16x32_bf16 v[204:207], a[20:23], v[84:87], v[204:207]
    s_waitcnt lgkmcnt(8)
    v_mfma_f32_16x16x32_bf16 v[192:195], a[24:27], v[88:91], v[192:195]
    buffer_load_dwordx4 v9, s[8:11], s31 offen offset:3072 sc1 lds
    v_mfma_f32_16x16x32_bf16 v[196:199], a[28:31], v[88:91], v[196:199]
    v_mfma_f32_16x16x32_bf16 v[200:203], a[24:27], v[92:95], v[200:203]
    s_waitcnt vmcnt(4)
    s_barrier
    v_mfma_f32_16x16x32_bf16 v[204:207], a[28:31], v[92:95], v[204:207]
    ds_read_b128 v[128:131], v8 offset:16384
    s_waitcnt lgkmcnt(5)
    v_mfma_f32_16x16x32_bf16 v[192:195], a[32:35], v[96:99], v[192:195]
    s_add_u32 m0, s36, 49152
    s_add_u32 s31, s29, 49152
    v_mfma_f32_16x16x32_bf16 v[196:199], a[36:39], v[96:99], v[196:199]
    buffer_load_dwordx4 v9, s[8:11], s31 offen offset:0 sc1 lds
    v_mfma_f32_16x16x32_bf16 v[200:203], a[32:35], v[100:103], v[200:203]
    ds_read_b128 v[132:135], v8 offset:20480
    ds_read_b128 v[136:139], v8 offset:17408
    v_mfma_f32_16x16x32_bf16 v[204:207], a[36:39], v[100:103], v[204:207]
    ds_read_b128 v[140:143], v8 offset:21504
    ds_read_b128 v[144:147], v8 offset:18432
    v_mfma_f32_16x16x32_bf16 v[192:195], a[40:43], v[104:107], v[192:195]
    buffer_load_dwordx4 v9, s[8:11], s31 offen offset:1024 sc1 lds
    v_mfma_f32_16x16x32_bf16 v[196:199], a[44:47], v[104:107], v[196:199]
    ds_read_b128 v[148:151], v8 offset:22528
    ds_read_b128 v[152:155], v8 offset:19456
    v_mfma_f32_16x16x32_bf16 v[200:203], a[40:43], v[108:111], v[200:203]
    ds_read_b128 v[156:159], v8 offset:23552
    ds_read_b128 v[160:163], v8 offset:24576
    v_mfma_f32_16x16x32_bf16 v[204:207], a[44:47], v[108:111], v[204:207]
    ds_read_b128 v[164:167], v8 offset:28672
    s_waitcnt lgkmcnt(10)
    v_mfma_f32_16x16x32_bf16 v[192:195], a[48:51], v[112:115], v[192:195]
    buffer_load_dwordx4 v9, s[8:11], s31 offen offset:2048 sc1 lds
    v_mfma_f32_16x16x32_bf16 v[196:199], a[52:55], v[112:115], v[196:199]
    ds_read_b128 v[168:171], v8 offset:25600
    ds_read_b128 v[172:175], v8 offset:29696
    v_mfma_f32_16x16x32_bf16 v[200:203], a[48:51], v[116:119], v[200:203]
    ds_read_b128 v[176:179], v8 offset:26624
    ds_read_b128 v[180:183], v8 offset:30720
    v_mfma_f32_16x16x32_bf16 v[204:207], a[52:55], v[116:119], v[204:207]
    buffer_load_dwordx4 v9, s[8:11], s31 offen offset:3072 sc1 lds
    v_mfma_f32_16x16x32_bf16 v[192:195], a[56:59], v[120:123], v[192:195]
    ds_read_b128 v[184:187], v8 offset:27648
    ds_read_b128 v[188:191], v8 offset:31744
    v_mfma_f32_16x16x32_bf16 v[196:199], a[60:63], v[120:123], v[196:199]
    buffer_load_dwordx4 v[12:15], v7, s[8:11], 0 offen sc1
    s_xor_b32 s36, s36, 0x10000
    v_mfma_f32_16x16x32_bf16 v[200:203], a[56:59], v[124:127], v[200:203]
    s_add_u32 s29, s29, 0x40000
    v_mfma_f32_16x16x32_bf16 v[204:207], a[60:63], v[124:127], v[204:207]
    s_waitcnt lgkmcnt(12)
    v_mfma_f32_16x16x32_bf16 v[192:195], a[64:67], v[128:131], v[192:195]
    v_mfma_f32_16x16x32_bf16 v[196:199], a[68:71], v[128:131], v[196:199]
    v_mfma_f32_16x16x32_bf16 v[200:203], a[64:67], v[132:135], v[200:203]
    v_mfma_f32_16x16x32_bf16 v[204:207], a[68:71], v[132:135], v[204:207]
    v_mfma_f32_16x16x32_bf16 v[192:195], a[72:75], v[136:139], v[192:195]
    v_mfma_f32_16x16x32_bf16 v[196:199], a[76:79], v[136:139], v[196:199]
    v_mfma_f32_16x16x32_bf16 v[200:203], a[72:75], v[140:143], v[200:203]
    v_mfma_f32_16x16x32_bf16 v[204:207], a[76:79], v[140:143], v[204:207]
    s_waitcnt lgkmcnt(8)
    v_mfma_f32_16x16x32_bf16 v[192:195], a[80:83], v[144:147], v[192:195]
    v_mfma_f32_16x16x32_bf16 v[196:199], a[84:87], v[144:147], v[196:199]
    v_mfma_f32_16x16x32_bf16 v[200:203], a[80:83], v[148:151], v[200:203]
    v_mfma_f32_16x16x32_bf16 v[204:207], a[84:87], v[148:151], v[204:207]
    v_mfma_f32_16x16x32_bf16 v[192:195], a[88:91], v[152:155], v[192:195]
    v_mfma_f32_16x16x32_bf16 v[196:199], a[92:95], v[152:155], v[196:199]
    v_mfma_f32_16x16x32_bf16 v[200:203], a[88:91], v[156:159], v[200:203]
    v_mfma_f32_16x16x32_bf16 v[204:207], a[92:95], v[156:159], v[204:207]
    s_waitcnt lgkmcnt(4)
    v_mfma_f32_16x16x32_bf16 v[192:195], a[96:99], v[160:163], v[192:195]
    v_mfma_f32_16x16x32_bf16 v[196:199], a[100:103], v[160:163], v[196:199]
    v_mfma_f32_16x16x32_bf16 v[200:203], a[96:99], v[164:167], v[200:203]
    s_waitcnt vmcnt(0)
    s_barrier
    v_mfma_f32_16x16x32_bf16 v[204:207], a[100:103], v[164:167], v[204:207]
    ds_read_b128 v[64:67], v8 offset:32768
    ds_read_b128 v[68:71], v8 offset:36864
    v_mfma_f32_16x16x32_bf16 v[192:195], a[104:107], v[168:171], v[192:195]
    ds_read_b128 v[72:75], v8 offset:33792
    ds_read_b128 v[76:79], v8 offset:37888
    v_mfma_f32_16x16x32_bf16 v[196:199], a[108:111], v[168:171], v[196:199]
    ds_read_b128 v[80:83], v8 offset:34816
    ds_read_b128 v[84:87], v8 offset:38912
    v_mfma_f32_16x16x32_bf16 v[200:203], a[104:107], v[172:175], v[200:203]
    s_cmp_lg_u32 s39, 0
    s_cbranch_scc1 .pd_407
.pdb_408:
    v_mfma_f32_16x16x32_bf16 v[204:207], a[108:111], v[172:175], v[204:207]
    ds_read_b128 v[88:91], v8 offset:35840
    s_waitcnt lgkmcnt(7)
    v_mfma_f32_16x16x32_bf16 v[192:195], a[112:115], v[176:179], v[192:195]
    ds_read_b128 v[92:95], v8 offset:39936
    s_xor_b32 s30, s28, s38
    v_mfma_f32_16x16x32_bf16 v[196:199], a[116:119], v[176:179], v[196:199]
    s_lshl_b32 s30, s30, 12
    s_add_u32 s30, s30, s37
    v_mfma_f32_16x16x32_bf16 v[200:203], a[112:115], v[180:183], v[200:203]
    s_add_u32 s28, s28, 1
    v_min3_u32 v4, v12, v13, v14
    v_min_u32 v4, v4, v15
    v_mfma_f32_16x16x32_bf16 v[204:207], a[116:119], v[180:183], v[204:207]
    ds_read_b128 v[96:99], v8 offset:40960
    ds_read_b128 v[100:103], v8 offset:45056
    v_mfma_f32_16x16x32_bf16 v[192:195], a[120:123], v[184:187], v[192:195]
    v_min_u32_dpp v4, v4, v4 quad_perm:[1,0,3,2] row_mask:0xf bank_mask:0xf
    ds_read_b128 v[104:107], v8 offset:41984
    v_mfma_f32_16x16x32_bf16 v[196:199], a[124:127], v[184:187], v[196:199]
    ds_read_b128 v[108:111], v8 offset:46080
    ds_read_b128 v[112:115], v8 offset:43008
    v_mfma_f32_16x16x32_bf16 v[200:203], a[120:123], v[188:191], v[200:203]
    v_min_u32_dpp v4, v4, v4 quad_perm:[2,3,0,1] row_mask:0xf bank_mask:0xf
    ds_read_b128 v[116:119], v8 offset:47104
    v_mfma_f32_16x16x32_bf16 v[204:207], a[124:127], v[188:191], v[204:207]
    ds_read_b128 v[120:123], v8 offset:44032
    s_waitcnt lgkmcnt(11)
    v_mfma_f32_16x16x32_bf16 v[192:195], a[128:131], v[64:67], v[192:195]
    v_min_u32_dpp v4, v4, v4 row_half_mirror row_mask:0xf bank_mask:0xf
    ds_read_b128 v[124:127], v8 offset:48128
    v_mfma_f32_16x16x32_bf16 v[196:199], a[132:135], v[64:67], v[196:199]
    ds_read_b128 v[128:131], v8 offset:49152
    ds_read_b128 v[132:135], v8 offset:53248
    v_mfma_f32_16x16x32_bf16 v[200:203], a[128:131], v[68:71], v[200:203]
    v_readfirstlane_b32 s33, v4
    s_cmp_gt_u32 s33, s28
    s_cbranch_scc1 .hot_404
    v_mfma_f32_16x16x32_bf16 v[204:207], a[132:135], v[68:71], v[204:207]
    ds_read_b128 v[136:139], v8 offset:50176
    ds_read_b128 v[140:143], v8 offset:54272
    v_mfma_f32_16x16x32_bf16 v[192:195], a[136:139], v[72:75], v[192:195]
    ds_read_b128 v[144:147], v8 offset:51200
    ds_read_b128 v[148:151], v8 offset:55296
    v_mfma_f32_16x16x32_bf16 v[196:199], a[140:143], v[72:75], v[196:199]
    ds_read_b128 v[152:155], v8 offset:52224
    ds_read_b128 v[156:159], v8 offset:56320
    v_mfma_f32_16x16x32_bf16 v[200:203], a[136:139], v[76:79], v[200:203]
    ds_read_b128 v[160:163], v8 offset:57344
    ds_read_b128 v[164:167], v8 offset:61440
    v_mfma_f32_16x16x32_bf16 v[204:207], a[140:143], v[76:79], v[204:207]
    ds_read_b128 v[168:171], v8 offset:58368
    s_waitcnt lgkmcnt(15)
    v_mfma_f32_16x16x32_bf16 v[192:195], a[144:147], v[80:83], v[192:195]
    ds_read_b128 v[172:175], v8 offset:62464
    ds_read_b128 v[176:179], v8 offset:59392
    v_mfma_f32_16x16x32_bf16 v[196:199], a[148:151], v[80:83], v[196:199]
    ds_read_b128 v[180:183], v8 offset:63488
    ds_read_b128 v[184:187], v8 offset:60416
    v_mfma_f32_16x16x32_bf16 v[200:203], a[144:147], v[84:87], v[200:203]
    ds_read_b128 v[188:191], v8 offset:64512
    v_xor_b32 v8, 0x10000, v8
    v_mfma_f32_16x16x32_bf16 v[204:207], a[148:151], v[84:87], v[204:207]
    v_mfma_f32_16x16x32_bf16 v[192:195], a[152:155], v[88:91], v[192:195]
    v_mfma_f32_16x16x32_bf16 v[196:199], a[156:159], v[88:91], v[196:199]
    v_mfma_f32_16x16x32_bf16 v[200:203], a[152:155], v[92:95], v[200:203]
    v_mfma_f32_16x16x32_bf16 v[204:207], a[156:159], v[92:95], v[204:207]
    v_mfma_f32_16x16x32_bf16 v[192:195], a[160:163], v[96:99], v[192:195]
    v_mfma_f32_16x16x32_bf16 v[196:199], a[164:167], v[96:99], v[196:199]
    v_mfma_f32_16x16x32_bf16 v[200:203], a[160:163], v[100:103], v[200:203]
    v_mfma_f32_16x16x32_bf16 v[204:207], a[164:167], v[100:103], v[204:207]
    v_mfma_f32_16x16x32_bf16 v[192:195], a[168:171], v[104:107], v[192:195]
    v_mfma_f32_16x16x32_bf16 v[196:199], a[172:175], v[104:107], v[196:199]
    v_mfma_f32_16x16x32_bf16 v[200:203], a[168:171], v[108:111], v[200:203]
    v_mfma_f32_16x16x32_bf16 v[204:207], a[172:175], v[108:111], v[204:207]
    s_waitcnt lgkmcnt(15)
    v_mfma_f32_16x16x32_bf16 v[192:195], a[176:179], v[112:115], v[192:195]
    v_mfma_f32_16x16x32_bf16 v[196:199], a[180:183], v[112:115], v[196:199]
    v_mfma_f32_16x16x32_bf16 v[200:203], a[176:179], v[116:119], v[200:203]
    v_mfma_f32_16x16x32_bf16 v[204:207], a[180:183], v[116:119], v[204:207]
    v_mfma_f32_16x16x32_bf16 v[192:195], a[184:187], v[120:123], v[192:195]
    buffer_load_dwordx4 v[12:15], v7, s[8:11], 0 offen sc1
    v_mfma_f32_16x16x32_bf16 v[196:199], a[188:191], v[120:123], v[196:199]
    v_mfma_f32_16x16x32_bf16 v[200:203], a[184:187], v[124:127], v[200:203]
    v_mfma_f32_16x16x32_bf16 v[204:207], a[188:191], v[124:127], v[204:207]
    s_waitcnt lgkmcnt(12)
    v_mfma_f32_16x16x32_bf16 v[192:195], a[192:195], v[128:131], v[192:195]
    v_mfma_f32_16x16x32_bf16 v[196:199], a[196:199], v[128:131], v[196:199]
    v_mfma_f32_16x16x32_bf16 v[200:203], a[192:195], v[132:135], v[200:203]
    v_mfma_f32_16x16x32_bf16 v[204:207], a[196:199], v[132:135], v[204:207]
    v_mfma_f32_16x16x32_bf16 v[192:195], a[200:203], v[136:139], v[192:195]
    v_mfma_f32_16x16x32_bf16 v[196:199], a[204:207], v[136:139], v[196:199]
    v_mfma_f32_16x16x32_bf16 v[200:203], a[200:203], v[140:143], v[200:203]
    v_mfma_f32_16x16x32_bf16 v[204:207], a[204:207], v[140:143], v[204:207]
    s_waitcnt lgkmcnt(8)
    v_mfma_f32_16x16x32_bf16 v[192:195], a[208:211], v[144:147], v[192:195]
    v_mfma_f32_16x16x32_bf16 v[196:199], a[212:215], v[144:147], v[196:199]
    v_mfma_f32_16x16x32_bf16 v[200:203], a[208:211], v[148:151], v[200:203]
    v_mfma_f32_16x16x32_bf16 v[204:207], a[212:215], v[148:151], v[204:207]
    v_mfma_f32_16x16x32_bf16 v[192:195], a[216:219], v[152:155], v[192:195]
    v_mfma_f32_16x16x32_bf16 v[196:199], a[220:223], v[152:155], v[196:199]
    v_mfma_f32_16x16x32_bf16 v[200:203], a[216:219], v[156:159], v[200:203]
    v_mfma_f32_16x16x32_bf16 v[204:207], a[220:223], v[156:159], v[204:207]
    s_waitcnt lgkmcnt(4)
    v_mfma_f32_16x16x32_bf16 v[192:195], a[224:227], v[160:163], v[192:195]
    v_mfma_f32_16x16x32_bf16 v[196:199], a[228:231], v[160:163], v[196:199]
    v_mfma_f32_16x16x32_bf16 v[200:203], a[224:227], v[164:167], v[200:203]
    v_mfma_f32_16x16x32_bf16 v[204:207], a[228:231], v[164:167], v[204:207]
    v_mfma_f32_16x16x32_bf16 v[192:195], a[232:235], v[168:171], v[192:195]
    v_mfma_f32_16x16x32_bf16 v[196:199], a[236:239], v[168:171], v[196:199]
    v_mfma_f32_16x16x32_bf16 v[200:203], a[232:235], v[172:175], v[200:203]
    s_waitcnt vmcnt(0)
    v_min3_u32 v4, v12, v13, v14
    v_min_u32 v4, v4, v15
    v_mfma_f32_16x16x32_bf16 v[204:207], a[236:239], v[172:175], v[204:207]
    s_waitcnt lgkmcnt(0)
    v_mfma_f32_16x16x32_bf16 v[192:195], a[240:243], v[176:179], v[192:195]
    v_min_u32_dpp v4, v4, v4 quad_perm:[1,0,3,2] row_mask:0xf bank_mask:0xf
    v_mfma_f32_16x16x32_bf16 v[196:199], a[244:247], v[176:179], v[196:199]
    v_mfma_f32_16x16x32_bf16 v[200:203], a[240:243], v[180:183], v[200:203]
    v_min_u32_dpp v4, v4, v4 quad_perm:[2,3,0,1] row_mask:0xf bank_mask:0xf
    v_mfma_f32_16x16x32_bf16 v[204:207], a[244:247], v[180:183], v[204:207]
    v_mfma_f32_16x16x32_bf16 v[192:195], a[248:251], v[184:187], v[192:195]
    v_min_u32_dpp v4, v4, v4 row_half_mirror row_mask:0xf bank_mask:0xf
    v_mfma_f32_16x16x32_bf16 v[196:199], a[252:255], v[184:187], v[196:199]
    v_mfma_f32_16x16x32_bf16 v[200:203], a[248:251], v[188:191], v[200:203]
    v_readfirstlane_b32 s33, v4
    v_mfma_f32_16x16x32_bf16 v[204:207], a[252:255], v[188:191], v[204:207]
    s_cmp_gt_u32 s33, s28
    s_cbranch_scc1 .gx_406
    s_nop 5
    buffer_store_dwordx4 v[192:195], v2, s[8:11], s30 offen offset:0 sc1
    buffer_store_dwordx4 v[196:199], v2, s[8:11], s30 offen offset:1024 sc1
    buffer_store_dwordx4 v[200:203], v2, s[8:11], s30 offen offset:2048 sc1
    buffer_store_dwordx4 v[204:207], v2, s[8:11], s30 offen offset:3072 sc1
    s_mov_b32 s39, 0
    s_waitcnt vmcnt(0)
    v_mov_b32 v27, s28
    s_mov_b64 exec, 1
    buffer_store_dword v27, v26, s[8:11], s94 offen sc1
    s_mov_b64 exec, -1
    s_cmp_lt_u32 s28, 64
    s_cbranch_scc1 .cold_401
    s_endpgm
.gx_406:
    s_add_u32 m0, s36, 0
    s_add_u32 s31, s29, 0
    buffer_load_dwordx4 v9, s[8:11], s31 offen offset:0 sc1 lds
    buffer_load_dwordx4 v9, s[8:11], s31 offen offset:1024 sc1 lds
    buffer_load_dwordx4 v9, s[8:11], s31 offen offset:2048 sc1 lds
    buffer_load_dwordx4 v9, s[8:11], s31 offen offset:3072 sc1 lds
    s_add_u32 m0, s36, 16384
    s_add_u32 s31, s29, 16384
    buffer_load_dwordx4 v9, s[8:11], s31 offen offset:0 sc1 lds
    buffer_load_dwordx4 v9, s[8:11], s31 offen offset:1024 sc1 lds
    buffer_load_dwordx4 v9, s[8:11], s31 offen offset:2048 sc1 lds
    buffer_load_dwordx4 v9, s[8:11], s31 offen offset:3072 sc1 lds
    s_branch .cpy_409
.hot_404:
    v_mfma_f32_16x16x32_bf16 v[204:207], a[132:135], v[68:71], v[204:207]
    s_add_u32 m0, s36, 0
    s_add_u32 s31, s29, 0
    v_mfma_f32_16x16x32_bf16 v[192:195], a[136:139], v[72:75], v[192:195]
    buffer_load_dwordx4 v9, s[8:11], s31 offen offset:0 sc1 lds
    v_mfma_f32_16x16x32_bf16 v[196:199], a[140:143], v[72:75], v[196:199]
    ds_read_b128 v[136:139], v8 offset:50176
    ds_read_b128 v[140:143], v8 offset:54272
    v_mfma_f32_16x16x32_bf16 v[200:203], a[136:139], v[76:79], v[200:203]
    ds_read_b128 v[144:147], v8 offset:51200
    ds_read_b128 v[148:151], v8 offset:55296
    v_mfma_f32_16x16x32_bf16 v[204:207], a[140:143], v[76:79], v[204:207]
    ds_read_b128 v[152:155], v8 offset:52224
    s_waitcnt lgkmcnt(15)
    v_mfma_f32_16x16x32_bf16 v[192:195], a[144:147], v[80:83], v[192:195]
    ds_read_b128 v[156:159], v8 offset:56320
    ds_read_b128 v[160:163], v8 offset:57344
    v_mfma_f32_16x16x32_bf16 v[196:199], a[148:151], v[80:83], v[196:199]
    buffer_load_dwordx4 v9, s[8:11], s31 offen offset:1024 sc1 lds
    v_mfma_f32_16x16x32_bf16 v[200:203], a[144:147], v[84:87], v[200:203]
    ds_read_b128 v[164:167], v8 offset:61440
    ds_read_b128 v[168:171], v8 offset:58368
    v_mfma_f32_16x16x32_bf16 v[204:207], a[148:151], v[84:87], v[204:207]
    ds_read_b128 v[172:175], v8 offset:62464
    ds_read_b128 v[176:179], v8 offset:59392
    v_mfma_f32_16x16x32_bf16 v[192:195], a[152:155], v[88:91], v[192:195]
    ds_read_b128 v[180:183], v8 offset:63488
    ds_read_b128 v[184:187], v8 offset:60416
    v_mfma_f32_16x16x32_bf16 v[196:199], a[156:159], v[88:91], v[196:199]
    ds_read_b128 v[188:191], v8 offset:64512
    v_xor_b32 v8, 0x10000, v8
    v_mfma_f32_16x16x32_bf16 v[200:203], a[152:155], v[92:95], v[200:203]
    buffer_load_dwordx4 v9, s[8:11], s31 offen offset:2048 sc1 lds
    v_mfma_f32_16x16x32_bf16 v[204:207], a[156:159], v[92:95], v[204:207]
    s_waitcnt lgkmcnt(15)
    v_mfma_f32_16x16x32_bf16 v[192:195], a[160:163], v[96:99], v[192:195]
    v_mfma_f32_16x16x32_bf16 v[196:199], a[164:167], v[96:99], v[196:199]
    v_mfma_f32_16x16x32_bf16 v[200:203], a[160:163], v[100:103], v[200:203]
    v_mfma_f32_16x16x32_bf16 v[204:207], a[164:167], v[100:103], v[204:207]
    buffer_load_dwordx4 v9, s[8:11], s31 offen offset:3072 sc1 lds
    v_mfma_f32_16x16x32_bf16 v[192:195], a[168:171], v[104:107], v[192:195]
    v_mfma_f32_16x16x32_bf16 v[196:199], a[172:175], v[104:107], v[196:199]
    v_mfma_f32_16x16x32_bf16 v[200:203], a[168:171], v[108:111], v[200:203]
    v_mfma_f32_16x16x32_bf16 v[204:207], a[172:175], v[108:111], v[204:207]
    v_mfma_f32_16x16x32_bf16 v[192:195], a[176:179], v[112:115], v[192:195]
    s_add_u32 m0, s36, 16384
    s_add_u32 s31, s29, 16384
    v_mfma_f32_16x16x32_bf16 v[196:199], a[180:183], v[112:115], v[196:199]
    buffer_load_dwordx4 v9, s[8:11], s31 offen offset:0 sc1 lds
    v_mfma_f32_16x16x32_bf16 v[200:203], a[176:179], v[116:119], v[200:203]
    v_mfma_f32_16x16x32_bf16 v[204:207], a[180:183], v[116:119], v[204:207]
    v_mfma_f32_16x16x32_bf16 v[192:195], a[184:187], v[120:123], v[192:195]
    v_mfma_f32_16x16x32_bf16 v[196:199], a[188:191], v[120:123], v[196:199]
    v_mfma_f32_16x16x32_bf16 v[200:203], a[184:187], v[124:127], v[200:203]
    buffer_load_dwordx4 v9, s[8:11], s31 offen offset:1024 sc1 lds
    v_mfma_f32_16x16x32_bf16 v[204:207], a[188:191], v[124:127], v[204:207]
    s_waitcnt lgkmcnt(12)
    v_mfma_f32_16x16x32_bf16 v[192:195], a[192:195], v[128:131], v[192:195]
    v_mfma_f32_16x16x32_bf16 v[196:199], a[196:199], v[128:131], v[196:199]
    v_mfma_f32_16x16x32_bf16 v[200:203], a[192:195], v[132:135], v[200:203]
    v_mfma_f32_16x16x32_bf16 v[204:207], a[196:199], v[132:135], v[204:207]
    buffer_load_dwordx4 v9, s[8:11], s31 offen offset:2048 sc1 lds
    v_mfma_f32_16x16x32_bf16 v[192:195], a[200:203], v[136:139], v[192:195]
    v_mfma_f32_16x16x32_bf16 v[196:199], a[204:207], v[136:139], v[196:199]
    v_mfma_f32_16x16x32_bf16 v[200:203], a[200:203], v[140:143], v[200:203]
    v_mfma_f32_16x16x32_bf16 v[204:207], a[204:207], v[140:143], v[204:207]
    s_waitcnt lgkmcnt(8)
    v_mfma_f32_16x16x32_bf16 v[192:195], a[208:211], v[144:147], v[192:195]
    buffer_load_dwordx4 v9, s[8:11], s31 offen offset:3072 sc1 lds
    v_mfma_f32_16x16x32_bf16 v[196:199], a[212:215], v[144:147], v[196:199]
    v_mfma_f32_16x16x32_bf16 v[200:203], a[208:211], v[148:151], v[200:203]
    v_mfma_f32_16x16x32_bf16 v[204:207], a[212:215], v[148:151], v[204:207]
    v_mfma_f32_16x16x32_bf16 v[192:195], a[216:219], v[152:155], v[192:195]
    v_mfma_f32_16x16x32_bf16 v[196:199], a[220:223], v[152:155], v[196:199]
    v_mfma_f32_16x16x32_bf16 v[200:203], a[216:219], v[156:159], v[200:203]
    v_mfma_f32_16x16x32_bf16 v[204:207], a[220:223], v[156:159], v[204:207]
    s_waitcnt lgkmcnt(4)
    v_mfma_f32_16x16x32_bf16 v[192:195], a[224:227], v[160:163], v[192:195]
    v_mfma_f32_16x16x32_bf16 v[196:199], a[228:231], v[160:163], v[196:199]
    v_mfma_f32_16x16x32_bf16 v[200:203], a[224:227], v[164:167], v[200:203]
    v_mfma_f32_16x16x32_bf16 v[204:207], a[228:231], v[164:167], v[204:207]
    v_mfma_f32_16x16x32_bf16 v[192:195], a[232:235], v[168:171], v[192:195]
    v_mfma_f32_16x16x32_bf16 v[196:199], a[236:239], v[168:171], v[196:199]
    v_mfma_f32_16x16x32_bf16 v[200:203], a[232:235], v[172:175], v[200:203]
    v_mfma_f32_16x16x32_bf16 v[204:207], a[236:239], v[172:175], v[204:207]
    s_waitcnt lgkmcnt(0)
    v_mfma_f32_16x16x32_bf16 v[192:195], a[240:243], v[176:179], v[192:195]
    v_mfma_f32_16x16x32_bf16 v[196:199], a[244:247], v[176:179], v[196:199]
    v_mfma_f32_16x16x32_bf16 v[200:203], a[240:243], v[180:183], v[200:203]
    v_mfma_f32_16x16x32_bf16 v[204:207], a[244:247], v[180:183], v[204:207]
    v_mfma_f32_16x16x32_bf16 v[192:195], a[248:251], v[184:187], v[192:195]
    v_mfma_f32_16x16x32_bf16 v[196:199], a[252:255], v[184:187], v[196:199]
    v_mfma_f32_16x16x32_bf16 v[200:203], a[248:251], v[188:191], v[200:203]
    v_mfma_f32_16x16x32_bf16 v[204:207], a[252:255], v[188:191], v[204:207]
.cpy_409:
    s_mov_b32 s39, 1
    s_nop 2
    v_pk_mov_b32 v[208:209], v[192:193], v[192:193] op_sel:[0,1]
    v_pk_mov_b32 v[210:211], v[194:195], v[194:195] op_sel:[0,1]
    v_pk_mov_b32 v[212:213], v[196:197], v[196:197] op_sel:[0,1]
    v_pk_mov_b32 v[214:215], v[198:199], v[198:199] op_sel:[0,1]
    v_pk_mov_b32 v[216:217], v[200:201], v[200:201] op_sel:[0,1]
    v_pk_mov_b32 v[218:219], v[202:203], v[202:203] op_sel:[0,1]
    v_pk_mov_b32 v[220:221], v[204:205], v[204:205] op_sel:[0,1]
    v_pk_mov_b32 v[222:223], v[206:207], v[206:207] op_sel:[0,1]
    s_branch .body_403
.pd_407:
    s_sub_u32 s4, s28, 1
    v_mov_b32 v27, s4
    s_mov_b64 exec, 1
    buffer_store_dword v27, v26, s[8:11], s94 offen sc1
    s_mov_b64 exec, -1
    buffer_store_dwordx4 v[208:211], v2, s[8:11], s30 offen offset:0 sc1
    buffer_store_dwordx4 v[212:215], v2, s[8:11], s30 offen offset:1024 sc1
    buffer_store_dwordx4 v[216:219], v2, s[8:11], s30 offen offset:2048 sc1
    buffer_store_dwordx4 v[220:223], v2, s[8:11], s30 offen offset:3072 sc1
    s_branch .pdb_408
.fin_312:
    s_load_dwordx2 s[44:45], s[0:1], 112
    s_sub_u32 s34, s98, 1
    s_lshl_b32 s4, s34, 11
    s_lshr_b32 s5, s99, 2
    s_lshl_b32 s5, s5, 22
    s_add_u32 s4, s4, s5
    s_and_b32 s5, s99, 3
    s_lshl_b32 s5, s5, 18
    s_add_u32 s4, s4, s5
    s_lshl_b32 s38, s99, 1
    v_lshlrev_b32 v2, 4, v1
    v_add_u32 v2, s4, v2
    s_lshl_b32 s4, s34, 15
    s_lshl_b32 s5, s99, 6
    s_add_u32 s4, s4, s5
    v_bfe_u32 v254, v1, 0, 4
    v_mul_u32_u24 v13, 2048, v254
    v_bfe_u32 v254, v1, 4, 2
    v_mul_u32_u24 v254, 16, v254
    v_add_u32 v13, v13, v254
    v_add_u32 v13, s4, v13
    s_lshl_b32 s4, s99, 17
    s_lshl_b32 s5, s34, 10
    s_add_u32 s4, s4, s5
    v_bfe_u32 v254, v1, 4, 2
    v_mul_u32_u24 v14, 32768, v254
    v_bfe_u32 v254, v1, 3, 1
    v_mul_u32_u24 v254, 512, v254
    v_add_u32 v14, v14, v254
    v_bfe_u32 v254, v1, 0, 3
    v_mul_u32_u24 v254, 2, v254
    v_add_u32 v14, v14, v254
    v_add_u32 v14, s4, v14
    v_add_u32 v15, 4096, v14
    v_add_u32 v16, 8192, v14
    v_add_u32 v17, 12288, v14
    v_add_u32 v18, 16384, v14
    v_add_u32 v19, 20480, v14
    v_add_u32 v20, 24576, v14
    v_add_u32 v21, 28672, v14
    s_lshl_b32 s4, s34, 6
    v_bfe_u32 v254, v1, 0, 4
    v_mul_u32_u24 v22, 4, v254
    v_add_u32 v22, s4, v22
    s_lshl_b32 s4, s99, 9
    s_add_u32 s4, s4, 92323840
    v_bfe_u32 v254, v1, 0, 2
    v_mul_u32_u24 v7, 128, v254
    v_add_u32 v7, s4, v7
    s_mov_b32 s28, s24
    s_mov_b32 s33, 0
    s_waitcnt lgkmcnt(0)
    s_mov_b32 s84, s44
    s_and_b32 s85, s45, 0xffff
    s_mov_b32 s86, 0x400000
    s_mov_b32 s87, 0x00020000
    s_mov_b32 s62, 0
    v_mov_b32 v5, 0
.wc_410:
    buffer_load_dword v4, v5, s[20:23], 0 offen offset:192 sc1
    s_add_u32 s62, s62, 1
    s_cmp_gt_u32 s62, 0x200000
    s_cbranch_scc1 .mg_end_1
    s_waitcnt vmcnt(0)
    v_readfirstlane_b32 s4, v4
    s_cmp_ge_u32 s4, 64
    s_cbranch_scc1 .wd_411
    s_sleep 8
    s_branch .wc_410
.wd_411:
.fl_412:
    s_lshl_b32 s57, s28, 16
    s_and_b32 s4, s28, 31
    s_lshl_b32 s4, s4, 4
    s_lshr_b32 s5, s28, 5
    s_lshl_b32 s5, s5, 11
    s_add_u32 s58, s4, s5
    s_add_u32 s58, s58, 130023424
    s_lshl_b32 s59, s28, 7
    s_add_u32 s59, s59, 121634816
    buffer_load_dwordx4 v[32:35], v13, s[12:15], s57 offen
    buffer_load_dword v44, v22, s[8:11], s59 offen
    buffer_load_ushort v36, v14, s[8:11], s58 offen
    buffer_load_ushort v37, v15, s[8:11], s58 offen
    buffer_load_ushort v38, v16, s[8:11], s58 offen
    buffer_load_ushort v39, v17, s[8:11], s58 offen
    buffer_load_ushort v40, v18, s[8:11], s58 offen
    buffer_load_ushort v41, v19, s[8:11], s58 offen
    buffer_load_ushort v42, v20, s[8:11], s58 offen
    buffer_load_ushort v43, v21, s[8:11], s58 offen
    s_xor_b32 s48, s28, s38
    s_lshl_b32 s48, s48, 12
    s_add_u32 s48, s48, 150994944
    s_xor_b32 s49, s48, 0x101000
    s_add_u32 s50, s48, 0x200000
    s_add_u32 s51, s49, 0x200000
    s_cmp_gt_u32 s33, s28
    s_cbranch_scc1 .fd_414
    s_mov_b32 s62, 0
.fp_413:
    buffer_load_dword v4, v7, s[8:11], 0 offen sc1
    s_add_u32 s62, s62, 1
    s_cmp_gt_u32 s62, 0x200000
    s_cbranch_scc1 .mg_end_1
    s_waitcnt vmcnt(0)
    v_min_u32_dpp v4, v4, v4 quad_perm:[1,0,3,2] row_mask:0xf bank_mask:0xf
    s_nop 1
    v_min_u32_dpp v4, v4, v4 quad_perm:[2,3,0,1] row_mask:0xf bank_mask:0xf
    s_nop 1
    v_readfirstlane_b32 s33, v4
    s_cmp_gt_u32 s33, s28
    s_cbranch_scc1 .fd_414
    s_sleep 4
    s_add_u32 s4, s33, 1
    s_cmp_ge_u32 s4, s28
    s_cbranch_scc1 .fp_413
    s_sleep 12
    s_branch .fp_413
.fd_414:
    buffer_load_dwordx4 v[64:67], v2, s[8:11], s48 offen offset:0
    buffer_load_dwordx4 v[68:71], v2, s[8:11], s48 offen offset:1024
    buffer_load_dwordx4 v[72:75], v2, s[8:11], s49 offen offset:0
    buffer_load_dwordx4 v[76:79], v2, s[8:11], s49 offen offset:1024
    buffer_load_dwordx4 v[80:83], v2, s[8:11], s50 offen offset:0
    buffer_load_dwordx4 v[84:87], v2, s[8:11], s50 offen offset:1024
    buffer_load_dwordx4 v[88:91], v2, s[8:11], s51 offen offset:0
    buffer_load_dwordx4 v[92:95], v2, s[8:11], s51 offen offset:1024
    s_waitcnt vmcnt(8)
    v_lshlrev_b32 v48, 16, v32
    v_lshlrev_b32 v36, 16, v36
    v_and_b32 v49, 0xffff0000, v32
    v_lshlrev_b32 v37, 16, v37
    v_lshlrev_b32 v50, 16, v33
    v_lshlrev_b32 v38, 16, v38
    v_and_b32 v51, 0xffff0000, v33
    v_lshlrev_b32 v39, 16, v39
    v_lshlrev_b32 v52, 16, v34
    v_lshlrev_b32 v40, 16, v40
    v_and_b32 v53, 0xffff0000, v34
    v_lshlrev_b32 v41, 16, v41
    v_lshlrev_b32 v54, 16, v35
    v_lshlrev_b32 v42, 16, v42
    v_and_b32 v55, 0xffff0000, v35
    v_lshlrev_b32 v43, 16, v43
    v_mul_f32 v48, v48, v36
    v_mul_f32 v49, v49, v37
    v_mul_f32 v50, v50, v38
    v_mul_f32 v51, v51, v39
    v_mul_f32 v52, v52, v40
    v_mul_f32 v53, v53, v41
    v_mul_f32 v54, v54, v42
    v_mul_f32 v55, v55, v43
    v_mul_f32 v48, v48, v44
    v_mul_f32 v49, v49, v44
    v_mul_f32 v50, v50, v44
    v_mul_f32 v51, v51, v44
    v_mul_f32 v52, v52, v44
    v_mul_f32 v53, v53, v44
    v_mul_f32 v54, v54, v44
    v_mul_f32 v55, v55, v44
    v_sub_f32 v44, 1.0, v44
    s_waitcnt vmcnt(4)
    v_add_f32 v64, v64, v72
    v_add_f32 v65, v65, v73
    v_add_f32 v66, v66, v74
    v_add_f32 v67, v67, v75
    v_add_f32 v68, v68, v76
    v_add_f32 v69, v69, v77
    v_add_f32 v70, v70, v78
    v_add_f32 v71, v71, v79
    s_waitcnt vmcnt(0)
    v_add_f32 v80, v80, v88
    v_add_f32 v81, v81, v89
    v_add_f32 v82, v82, v90
    v_add_f32 v83, v83, v91
    v_add_f32 v84, v84, v92
    v_add_f32 v85, v85, v93
    v_add_f32 v86, v86, v94
    v_add_f32 v87, v87, v95
    v_add_f32 v64, v64, v80
    v_add_f32 v65, v65, v81
    v_add_f32 v66, v66, v82
    v_add_f32 v67, v67, v83
    v_add_f32 v68, v68, v84
    v_add_f32 v69, v69, v85
    v_add_f32 v70, v70, v86
    v_add_f32 v71, v71, v87
    v_fma_f32 v64, v64, v44, v48
    v_fma_f32 v65, v65, v44, v49
    v_fma_f32 v66, v66, v44, v50
    v_fma_f32 v67, v67, v44, v51
    v_fma_f32 v68, v68, v44, v52
    v_fma_f32 v69, v69, v44, v53
    v_fma_f32 v70, v70, v44, v54
    v_fma_f32 v71, v71, v44, v55
    v_cvt_pk_bf16_f32 v56, v64, v65
    v_cvt_pk_bf16_f32 v57, v66, v67
    v_cvt_pk_bf16_f32 v58, v68, v69
    v_cvt_pk_bf16_f32 v59, v70, v71
    buffer_store_dwordx4 v[56:59], v13, s[84:87], s57 offen
    s_add_u32 s28, s28, 4
    s_cmp_lt_u32 s28, 64
    s_cbranch_scc1 .fl_412
    s_endpgm
.mg_end_1:
    s_endpgm
.section .rodata,"a"
.p2align 6
.amdhsa_kernel mega_kernel
  .amdhsa_next_free_vgpr 512
  .amdhsa_next_free_sgpr 102
  .amdhsa_accum_offset 256
  .amdhsa_group_segment_fixed_size 0
  .amdhsa_kernarg_size 136
  .amdhsa_user_sgpr_count 2
  .amdhsa_user_sgpr_kernarg_segment_ptr 1
  .amdhsa_system_sgpr_workgroup_id_x 1
.end_amdhsa_kernel
```

```asm
; @launch kernel=mega_kernel grid=(256,1,1) block=(256,1,1) lds=163840
.amdgcn_target "amdgcn-amd-amdhsa--gfx950"
.text
.globl mega_kernel
.p2align 8
.type mega_kernel,@function
mega_kernel:
    s_cmp_ge_u32 s2, 256
    s_cbranch_scc1 .mg_end_1
    s_load_dwordx4 s[52:55], s[0:1], 120
    s_getreg_b32 s3, hwreg(HW_REG_XCC_ID)
    v_and_b32 v1, 63, v0
    v_lshrrev_b32 v4, 6, v0
    s_and_b32 s3, s3, 7
    v_readfirstlane_b32 s24, v4
    s_waitcnt lgkmcnt(0)
    s_mov_b32 s8, s54
    s_and_b32 s9, s55, 0xffff
    s_mov_b32 s10, 0x10000000
    s_mov_b32 s11, 0x00020000
    s_mov_b32 s20, s52
    s_and_b32 s21, s53, 0xffff
    s_mov_b32 s22, 0x100
    s_mov_b32 s23, 0x00020000
    s_mov_b32 s100, s54
    v_mov_b32 v7, 163832
    s_cmp_lg_u32 s24, 0
    s_cbranch_scc1 .noat_4
    s_mov_b64 exec, 1
    v_mov_b32 v5, 1
    s_lshl_b32 s4, s3, 3
    s_mov_b32 s6, 0x60402000
    s_mov_b32 s7, 0xe4e08480
    s_lshr_b64 s[6:7], s[6:7], s4
    s_and_b32 s4, s6, 0xff
    v_mov_b32 v6, s4
    buffer_atomic_add v5, v6, s[20:23], 0 offen sc0 sc1
    s_mov_b64 exec, -1
.noat_4:
    s_sub_u32 s101, 0, s100
    s_and_b32 s101, s101, 0x1fffff
    s_add_u32 s101, s101, 100663296
    s_lshl_b32 s4, s2, 2
    s_add_u32 s4, s4, s24
    s_lshl_b32 s5, s4, 11
    s_add_u32 s5, s5, s101
    v_lshlrev_b32 v8, 4, v1
    v_mov_b32 v20, -1
    v_mov_b32 v21, -1
    v_mov_b32 v22, -1
    v_mov_b32 v23, -1
    s_lshl_b32 s4, s4, 10
    s_add_u32 s4, s4, 83886080
    buffer_store_dwordx4 v[20:23], v8, s[8:11], s5 offen sc1
    buffer_store_dwordx4 v[20:23], v8, s[8:11], s5 offen offset:1024 sc1
    buffer_store_dwordx4 v[20:23], v8, s[8:11], s4 offen sc1
    s_cmp_eq_u32 s24, 2
    s_cselect_b32 s6, s2, -1
    s_cmp_ge_u32 s6, 128
    s_cbranch_scc1 .nr_7
    s_lshl_b32 s6, s6, 10
    s_add_u32 s6, s6, 84934656
    buffer_store_dwordx4 v[20:23], v8, s[8:11], s6 offen sc1
.nr_7:
    s_cmp_eq_u32 s24, 3
    s_cselect_b32 s6, s2, -1
    s_cmp_ge_u32 s6, 68
    s_cbranch_scc1 .nf_5
    v_mov_b32 v24, 0
    v_mov_b32 v25, 0
    v_mov_b32 v26, 0
    v_mov_b32 v27, 0
    s_lshl_b32 s6, s6, 10
    s_add_u32 s6, s6, 92274688
    buffer_store_dwordx4 v[24:27], v8, s[8:11], s6 offen sc1
.nf_5:
    s_cmp_lg_u32 s24, 0
    s_cbranch_scc1 .nw_6
    s_mov_b64 exec, 1
    s_waitcnt vmcnt(3)
    ds_write_b32 v7, v5
    s_waitcnt lgkmcnt(0)
    s_mov_b64 exec, -1
.nw_6:
    s_barrier
    ds_read_b32 v5, v7
    s_mov_b32 s25, s3
    s_mov_b32 s27, 0
    s_waitcnt lgkmcnt(0)
    v_readfirstlane_b32 s26, v5
    s_cmp_ge_u32 s26, 32
    s_cselect_b32 s3, 0x10001, 1
    s_and_b32 s26, s26, 31
.mg_role_3:
    s_cmp_ge_u32 s25, 4
    s_cbranch_scc1 .mg_bg_2
    s_load_dwordx8 s[84:91], s[0:1], 64
    s_load_dwordx2 s[40:41], s[0:1], 56
    v_and_b32 v1, 63, v0
    s_lshl_b32 s4, s25, 3
    s_and_b32 s5, s26, 4
    s_or_b32 s4, s4, s5
    s_cbranch_scc1 .nocal_8
    s_cmp_lg_u32 s24, 3
    s_cbranch_scc1 .calb_9
    s_lshr_b32 s4, s26, 1
    s_and_b32 s4, s4, 12
    s_and_b32 s5, s26, 3
    s_or_b32 s4, s4, s5
    s_lshl_b32 s5, s4, 11
    s_add_u32 s5, s5, s101
    s_mov_b64 exec, 1
    v_mov_b32 v4, -1
    v_mov_b32 v5, 0
    s_mov_b32 s7, 0xffff
    s_memtime s[72:73]
    s_waitcnt lgkmcnt(0)
    buffer_store_dword v4, v5, s[8:11], s5 offen sc1
    s_waitcnt vmcnt(0)
    s_memtime s[74:75]
    s_waitcnt lgkmcnt(0)
    s_sub_u32 s74, s74, s72
    s_min_u32 s7, s7, s74
    s_memtime s[72:73]
    s_waitcnt lgkmcnt(0)
    buffer_store_dword v4, v5, s[8:11], s5 offen sc1
    s_waitcnt vmcnt(0)
    s_memtime s[74:75]
    s_waitcnt lgkmcnt(0)
    s_sub_u32 s74, s74, s72
    s_min_u32 s7, s7, s74
    s_memtime s[72:73]
    s_waitcnt lgkmcnt(0)
    buffer_store_dword v4, v5, s[8:11], s5 offen sc1
    s_waitcnt vmcnt(0)
    s_memtime s[74:75]
    s_waitcnt lgkmcnt(0)
    s_sub_u32 s74, s74, s72
    s_min_u32 s7, s7, s74
    s_lshl_b32 s5, s4, 1
    s_add_u32 s5, s5, 160
    v_mov_b32 v4, s7
    buffer_store_short v4, v5, s[20:23], s5 offen sc1
    s_mov_b64 exec, -1
.calb_9:
    s_barrier
.nocal_8:
    s_lshl_b32 s4, s25, 11
    s_lshl_b32 s5, s26, 6
    s_add_u32 s4, s4, s5
    s_lshl_b32 s6, s24, 21
    s_add_u32 s4, s4, s6
    s_lshl_b32 s7, s25, 21
    s_lshl_b32 s6, s24, 19
    s_add_u32 s7, s7, s6
    s_add_u32 s7, s7, s5
    s_lshl_b32 s6, s24, 15
    v_bfe_u32 v4, v1, 4, 1
    v_lshlrev_b32 v4, 1, v4
    v_and_b32 v5, 3, v1
    v_xor_b32 v4, v4, v5
    v_lshlrev_b32 v4, 4, v4
    v_bfe_u32 v254, v1, 2, 1
    v_mul_u32_u24 v5, 1, v254
    v_bfe_u32 v254, v1, 3, 1
    v_mul_u32_u24 v254, 8, v254
    v_add_u32 v5, v5, v254
    v_bfe_u32 v254, v1, 4, 1
    v_mul_u32_u24 v254, 4, v254
    v_add_u32 v5, v5, v254
    v_bfe_u32 v254, v1, 5, 1
    v_mul_u32_u24 v254, 2, v254
    v_add_u32 v5, v5, v254
    v_lshlrev_b32 v6, 13, v5
    v_add_u32 v6, v6, v4
    v_add_u32 v240, s4, v6
    v_lshlrev_b32 v6, 11, v5
    v_add_u32 v6, v6, v4
    v_add_u32 v241, s7, v6
    v_xor_b32 v241, 256, v241
    v_bfe_u32 v254, v1, 2, 2
    v_mul_u32_u24 v242, 64, v254
    v_bfe_u32 v254, v1, 4, 1
    v_mul_u32_u24 v254, 288, v254
    v_add_u32 v242, v242, v254
    v_bfe_u32 v254, v1, 5, 1
    v_mul_u32_u24 v254, 1024, v254
    v_add_u32 v242, v242, v254
    v_bfe_u32 v254, v1, 0, 2
    v_mul_u32_u24 v254, 8, v254
    v_add_u32 v242, v242, v254
    v_add_u32 v242, s6, v242
    v_xor_b32 v243, 32, v242
    s_waitcnt lgkmcnt(0)
    s_mov_b32 s16, s84
    s_and_b32 s17, s85, 0xffff
    s_mov_b32 s18, 0x800000
    s_mov_b32 s19, 0x00020000
    v_xor_b32 v240, 128, v240
    s_and_b32 s4, s26, 1
    s_lshl_b32 s98, s4, 11
    s_lshl_b32 s99, s4, 18
    s_add_u32 s98, s98, s6
    s_xor_b32 m0, s98, 0
    s_xor_b32 s5, s99, 0
    buffer_load_dwordx4 v240, s[16:19], s5 offen nt lds
    s_xor_b32 m0, s98, 1024
    s_xor_b32 s5, s99, 131072
    buffer_load_dwordx4 v240, s[16:19], s5 offen nt lds
    s_xor_b32 m0, s98, 2048
    s_xor_b32 s5, s99, 262144
    buffer_load_dwordx4 v240, s[16:19], s5 offen nt lds
    s_xor_b32 m0, s98, 3072
    s_xor_b32 s5, s99, 393216
    buffer_load_dwordx4 v240, s[16:19], s5 offen nt lds
    s_xor_b32 m0, s98, 4096
    s_xor_b32 s5, s99, 524288
    buffer_load_dwordx4 v240, s[16:19], s5 offen nt lds
    s_xor_b32 m0, s98, 5120
    s_xor_b32 s5, s99, 655360
    buffer_load_dwordx4 v240, s[16:19], s5 offen nt lds
    s_xor_b32 m0, s98, 6144
    s_xor_b32 s5, s99, 786432
    buffer_load_dwordx4 v240, s[16:19], s5 offen nt lds
    s_xor_b32 m0, s98, 7168
    s_xor_b32 s5, s99, 917504
    buffer_load_dwordx4 v240, s[16:19], s5 offen nt lds
    s_xor_b32 m0, s98, 8192
    s_xor_b32 s5, s99, 1048576
    buffer_load_dwordx4 v240, s[16:19], s5 offen nt lds
    s_xor_b32 m0, s98, 9216
    s_xor_b32 s5, s99, 1179648
    buffer_load_dwordx4 v240, s[16:19], s5 offen nt lds
    s_xor_b32 m0, s98, 10240
    s_xor_b32 s5, s99, 1310720
    buffer_load_dwordx4 v240, s[16:19], s5 offen nt lds
    s_xor_b32 m0, s98, 11264
    s_xor_b32 s5, s99, 1441792
    buffer_load_dwordx4 v240, s[16:19], s5 offen nt lds
    s_xor_b32 m0, s98, 12288
    s_xor_b32 s5, s99, 1572864
    buffer_load_dwordx4 v240, s[16:19], s5 offen nt lds
    s_xor_b32 m0, s98, 13312
    s_xor_b32 s5, s99, 1703936
    buffer_load_dwordx4 v240, s[16:19], s5 offen nt lds
    s_xor_b32 m0, s98, 14336
    s_xor_b32 s5, s99, 1835008
    buffer_load_dwordx4 v240, s[16:19], s5 offen nt lds
    s_xor_b32 m0, s98, 15360
    s_xor_b32 s5, s99, 1966080
    buffer_load_dwordx4 v240, s[16:19], s5 offen nt lds
    s_waitcnt vmcnt(16)
    s_barrier
    s_cmp_lg_u32 s24, 1
    s_cbranch_scc1 .ns_10
    s_mov_b64 exec, 1
    v_mov_b32 v238, s3
    v_mov_b32 v239, 0
    buffer_atomic_add v238, v239, s[20:23], 0 offen offset:196 sc1
    s_mov_b64 exec, -1
.ns_10:
    s_mov_b32 s16, s86
    s_and_b32 s17, s87, 0xffff
    s_mov_b32 s18, 0x800000
    s_mov_b32 s19, 0x00020000
    v_xor_b32 v240, 0, v240
    s_and_b32 s4, s26, 1
    s_lshl_b32 s98, s4, 11
    s_lshl_b32 s99, s4, 18
    s_add_u32 s98, s98, s6
    s_xor_b32 m0, s98, 16384
    s_xor_b32 s5, s99, 0
    buffer_load_dwordx4 v240, s[16:19], s5 offen nt lds
    s_xor_b32 m0, s98, 17408
    s_xor_b32 s5, s99, 131072
    buffer_load_dwordx4 v240, s[16:19], s5 offen nt lds
    s_xor_b32 m0, s98, 18432
    s_xor_b32 s5, s99, 262144
    buffer_load_dwordx4 v240, s[16:19], s5 offen nt lds
    s_xor_b32 m0, s98, 19456
    s_xor_b32 s5, s99, 393216
    buffer_load_dwordx4 v240, s[16:19], s5 offen nt lds
    s_xor_b32 m0, s98, 20480
    s_xor_b32 s5, s99, 524288
    buffer_load_dwordx4 v240, s[16:19], s5 offen nt lds
    s_xor_b32 m0, s98, 21504
    s_xor_b32 s5, s99, 655360
    buffer_load_dwordx4 v240, s[16:19], s5 offen nt lds
    s_xor_b32 m0, s98, 22528
    s_xor_b32 s5, s99, 786432
    buffer_load_dwordx4 v240, s[16:19], s5 offen nt lds
    s_xor_b32 m0, s98, 23552
    s_xor_b32 s5, s99, 917504
    buffer_load_dwordx4 v240, s[16:19], s5 offen nt lds
    s_xor_b32 m0, s98, 24576
    s_xor_b32 s5, s99, 1048576
    buffer_load_dwordx4 v240, s[16:19], s5 offen nt lds
    s_xor_b32 m0, s98, 25600
    s_xor_b32 s5, s99, 1179648
    buffer_load_dwordx4 v240, s[16:19], s5 offen nt lds
    s_xor_b32 m0, s98, 26624
    s_xor_b32 s5, s99, 1310720
    buffer_load_dwordx4 v240, s[16:19], s5 offen nt lds
    s_xor_b32 m0, s98, 27648
    s_xor_b32 s5, s99, 1441792
    buffer_load_dwordx4 v240, s[16:19], s5 offen nt lds
    s_xor_b32 m0, s98, 28672
    s_xor_b32 s5, s99, 1572864
    buffer_load_dwordx4 v240, s[16:19], s5 offen nt lds
    s_xor_b32 m0, s98, 29696
    s_xor_b32 s5, s99, 1703936
    buffer_load_dwordx4 v240, s[16:19], s5 offen nt lds
    s_xor_b32 m0, s98, 30720
    s_xor_b32 s5, s99, 1835008
    buffer_load_dwordx4 v240, s[16:19], s5 offen nt lds
    s_xor_b32 m0, s98, 31744
    s_xor_b32 s5, s99, 1966080
    buffer_load_dwordx4 v240, s[16:19], s5 offen nt lds
    s_lshr_b32 s52, s26, 2
    s_and_b32 s53, s26, 3
    s_lshl_b32 s54, s25, 14
    s_lshl_b32 s55, s26, 9
    s_add_u32 s55, s55, s54
    s_lshl_b32 s56, s25, 3
    s_add_u32 s56, s56, s52
    s_lshl_b32 s57, s56, 12
    s_lshl_b32 s58, s53, 9
    s_add_u32 s58, s58, s57
    s_mov_b32 s48, 0x00ff00ff
    s_mov_b32 s49, 0x00ff00ff
    s_mov_b32 s50, 0xff00ff00
    s_mov_b32 s51, 0xff00ff00
    v_mov_b32 v2, 0x4444
    v_mov_b32 v4, 0xeeee
    s_lshl_b32 s4, s24, 12
    s_add_u32 s4, s4, s54
    v_cndmask_b32 v2, v4, v2, s[48:49]
    v_bfe_u32 v254, v1, 0, 6
    v_mul_u32_u24 v3, 16, v254
    v_add_u32 v3, s4, v3
    v_add_u32 v4, 0x10000, v3
    s_mul_i32 s4, s24, 1152
    v_bfe_u32 v254, v1, 4, 1
    v_mul_u32_u24 v5, 576, v254
    v_bfe_u32 v254, v1, 5, 1
    v_mul_u32_u24 v254, 64, v254
    v_add_u32 v5, v5, v254
    v_bfe_u32 v254, v1, 0, 4
    v_mul_u32_u24 v254, 4, v254
    v_add_u32 v5, v5, v254
    v_add_u32 v5, s4, v5
    v_add_u32 v6, 4736, v5
    v_add_u32 v7, 9472, v5
    s_lshl_b32 s4, s24, 10
    v_bfe_u32 v254, v1, 0, 6
    v_mul_u32_u24 v8, 16, v254
    v_add_u32 v8, 14080, v8
    v_add_u32 v8, s4, v8
    s_and_b32 s4, s24, 1
    s_lshr_b32 s5, s24, 1
    s_lshl_b32 s59, s4, 6
    s_mul_i32 s60, s5, 4736
    s_add_u32 s59, s59, s60
    s_lshl_b32 s4, s4, 8
    s_add_u32 s60, s58, s4
    s_lshl_b32 s5, s5, 11
    s_add_u32 s61, s60, s5
    s_cmp_lt_u32 s24, 2
    s_cselect_b32 s5, 8, 1
    s_lshl_b32 s5, s5, 10
    s_xor_b32 s61, s61, s5
    v_bfe_u32 v254, v1, 2, 3
    v_mul_u32_u24 v9, 144, v254
    v_bfe_u32 v254, v1, 5, 1
    v_mul_u32_u24 v254, 32, v254
    v_add_u32 v9, v9, v254
    v_bfe_u32 v254, v1, 0, 2
    v_mul_u32_u24 v254, 8, v254
    v_add_u32 v9, v9, v254
    v_add_u32 v9, s59, v9
    v_bfe_u32 v254, v1, 0, 6
    v_mul_u32_u24 v10, 4, v254
    v_add_u32 v10, 131072, v10
    v_add_u32 v10, s61, v10
    v_bfe_u32 v254, v1, 0, 6
    v_mul_u32_u24 v11, 4, v254
    v_add_u32 v11, 18176, v11
    v_add_u32 v11, s4, v11
    s_lshl_b32 s4, s24, 2
    v_bfe_u32 v254, v1, 2, 1
    v_mul_u32_u24 v255, 1024, v254
    v_bfe_u32 v254, v1, 4, 1
    v_mul_u32_u24 v254, 512, v254
    v_add_u32 v255, v255, v254
    v_bfe_u32 v254, v1, 5, 1
    v_mul_u32_u24 v254, 128, v254
    v_add_u32 v255, v255, v254
    v_bfe_u32 v254, v1, 3, 1
    v_mul_u32_u24 v254, 64, v254
    v_add_u32 v255, v255, v254
    v_bfe_u32 v254, v1, 0, 2
    v_mul_u32_u24 v254, 16, v254
    v_add_u32 v255, v255, v254
    v_add_u32 v255, 20224, v255
    v_add_u32 v255, s4, v255
    v_mov_b32 v20, -1
    v_mov_b32 v21, -1
    v_mov_b32 v22, -1
    v_mov_b32 v23, -1
    v_mov_b32 v40, 0
    v_mov_b32 v41, 0
    v_mov_b32 v42, 0
    v_mov_b32 v43, 0
    v_mov_b32 v44, 0
    v_mov_b32 v45, 0
    v_mov_b32 v46, 0
    v_mov_b32 v47, 0
    v_mov_b32 v48, 0
    v_mov_b32 v49, 0
    v_mov_b32 v50, 0
    v_mov_b32 v51, 0
    v_mov_b32 v52, 0
    v_mov_b32 v53, 0
    v_mov_b32 v54, 0
    v_mov_b32 v55, 0
    v_mov_b32 v56, 0
    v_mov_b32 v57, 0
    v_mov_b32 v58, 0
    v_mov_b32 v59, 0
    v_mov_b32 v60, 0
    v_mov_b32 v61, 0
    v_mov_b32 v62, 0
    v_mov_b32 v63, 0
    v_mov_b32 v64, 0
    v_mov_b32 v65, 0
    v_mov_b32 v66, 0
    v_mov_b32 v67, 0
    v_mov_b32 v68, 0
    v_mov_b32 v69, 0
    v_mov_b32 v70, 0
    v_mov_b32 v71, 0
    v_bfe_u32 v254, v1, 0, 5
    v_mul_u32_u24 v244, 16, v254
    v_bfe_u32 v254, v1, 5, 1
    v_mul_u32_u24 v254, 2048, v254
    v_add_u32 v244, v244, v254
    v_add_u32 v244, 131072, v244
    v_add_u32 v244, s58, v244
    v_bfe_u32 v254, v1, 0, 5
    v_mul_u32_u24 v245, 16, v254
    v_bfe_u32 v254, v1, 5, 1
    v_mul_u32_u24 v254, 65536, v254
    v_add_u32 v245, v245, v254
    v_add_u32 v245, s55, v245
    s_lshl_b32 s4, s53, 10
    s_add_u32 s4, s4, s57
    v_bfe_u32 v254, v1, 0, 6
    v_mul_u32_u24 v246, 16, v254
    v_add_u32 v246, 131072, v246
    v_add_u32 v246, s4, v246
    v_subrev_u32 v237, 0x20000, v246
    v_lshrrev_b32 v237, 2, v237
    v_add_u32 v237, 262144, v237
    s_waitcnt vmcnt(16)
    ds_read_b64_tr_b16 a[0:1], v242 offset:0
    ds_read_b64_tr_b16 a[2:3], v242 offset:512
    ds_read_b64_tr_b16 a[4:5], v242 offset:2048
    ds_read_b64_tr_b16 a[6:7], v242 offset:2560
    ds_read_b64_tr_b16 a[8:9], v242 offset:4096
    ds_read_b64_tr_b16 a[10:11], v242 offset:4608
    ds_read_b64_tr_b16 a[12:13], v242 offset:6144
    ds_read_b64_tr_b16 a[14:15], v242 offset:6656
    ds_read_b64_tr_b16 a[16:17], v242 offset:8192
    ds_read_b64_tr_b16 a[18:19], v242 offset:8704
    ds_read_b64_tr_b16 a[20:21], v242 offset:10240
    ds_read_b64_tr_b16 a[22:23], v242 offset:10752
    ds_read_b64_tr_b16 a[24:25], v242 offset:12288
    ds_read_b64_tr_b16 a[26:27], v242 offset:12800
    ds_read_b64_tr_b16 a[28:29], v242 offset:14336
    ds_read_b64_tr_b16 a[30:31], v242 offset:14848
    ds_read_b64_tr_b16 a[32:33], v243 offset:0
    ds_read_b64_tr_b16 a[34:35], v243 offset:512
    ds_read_b64_tr_b16 a[36:37], v243 offset:2048
    ds_read_b64_tr_b16 a[38:39], v243 offset:2560
    ds_read_b64_tr_b16 a[40:41], v243 offset:4096
    ds_read_b64_tr_b16 a[42:43], v243 offset:4608
    ds_read_b64_tr_b16 a[44:45], v243 offset:6144
    ds_read_b64_tr_b16 a[46:47], v243 offset:6656
    ds_read_b64_tr_b16 a[48:49], v243 offset:8192
    ds_read_b64_tr_b16 a[50:51], v243 offset:8704
    ds_read_b64_tr_b16 a[52:53], v243 offset:10240
    ds_read_b64_tr_b16 a[54:55], v243 offset:10752
    ds_read_b64_tr_b16 a[56:57], v243 offset:12288
    ds_read_b64_tr_b16 a[58:59], v243 offset:12800
    ds_read_b64_tr_b16 a[60:61], v243 offset:14336
    ds_read_b64_tr_b16 a[62:63], v243 offset:14848
    s_waitcnt lgkmcnt(0)
    s_mov_b32 s16, s88
    s_and_b32 s17, s89, 0xffff
    s_mov_b32 s18, 0x800000
    s_mov_b32 s19, 0x00020000
    v_xor_b32 v240, 128, v240
    s_and_b32 s4, s26, 1
    s_lshl_b32 s98, s4, 11
    s_lshl_b32 s99, s4, 18
    s_add_u32 s98, s98, s6
    s_xor_b32 m0, s98, 0
    s_xor_b32 s5, s99, 0
    buffer_load_dwordx4 v240, s[16:19], s5 offen nt lds
    s_xor_b32 m0, s98, 1024
    s_xor_b32 s5, s99, 131072
    buffer_load_dwordx4 v240, s[16:19], s5 offen nt lds
    s_xor_b32 m0, s98, 2048
    s_xor_b32 s5, s99, 262144
    buffer_load_dwordx4 v240, s[16:19], s5 offen nt lds
    s_xor_b32 m0, s98, 3072
    s_xor_b32 s5, s99, 393216
    buffer_load_dwordx4 v240, s[16:19], s5 offen nt lds
    s_xor_b32 m0, s98, 4096
    s_xor_b32 s5, s99, 524288
    buffer_load_dwordx4 v240, s[16:19], s5 offen nt lds
    s_xor_b32 m0, s98, 5120
    s_xor_b32 s5, s99, 655360
    buffer_load_dwordx4 v240, s[16:19], s5 offen nt lds
    s_xor_b32 m0, s98, 6144
    s_xor_b32 s5, s99, 786432
    buffer_load_dwordx4 v240, s[16:19], s5 offen nt lds
    s_xor_b32 m0, s98, 7168
    s_xor_b32 s5, s99, 917504
    buffer_load_dwordx4 v240, s[16:19], s5 offen nt lds
    s_xor_b32 m0, s98, 8192
    s_xor_b32 s5, s99, 1048576
    buffer_load_dwordx4 v240, s[16:19], s5 offen nt lds
    s_xor_b32 m0, s98, 9216
    s_xor_b32 s5, s99, 1179648
    buffer_load_dwordx4 v240, s[16:19], s5 offen nt lds
    s_xor_b32 m0, s98, 10240
    s_xor_b32 s5, s99, 1310720
    buffer_load_dwordx4 v240, s[16:19], s5 offen nt lds
    s_xor_b32 m0, s98, 11264
    s_xor_b32 s5, s99, 1441792
    buffer_load_dwordx4 v240, s[16:19], s5 offen nt lds
    s_xor_b32 m0, s98, 12288
    s_xor_b32 s5, s99, 1572864
    buffer_load_dwordx4 v240, s[16:19], s5 offen nt lds
    s_xor_b32 m0, s98, 13312
    s_xor_b32 s5, s99, 1703936
    buffer_load_dwordx4 v240, s[16:19], s5 offen nt lds
    s_xor_b32 m0, s98, 14336
    s_xor_b32 s5, s99, 1835008
    buffer_load_dwordx4 v240, s[16:19], s5 offen nt lds
    s_xor_b32 m0, s98, 15360
    s_xor_b32 s5, s99, 1966080
    buffer_load_dwordx4 v240, s[16:19], s5 offen nt lds
    s_waitcnt vmcnt(16)
    ds_read_b64_tr_b16 a[64:65], v242 offset:16384
    ds_read_b64_tr_b16 a[66:67], v242 offset:16896
    ds_read_b64_tr_b16 a[68:69], v242 offset:18432
    ds_read_b64_tr_b16 a[70:71], v242 offset:18944
    ds_read_b64_tr_b16 a[72:73], v242 offset:20480
    ds_read_b64_tr_b16 a[74:75], v242 offset:20992
    ds_read_b64_tr_b16 a[76:77], v242 offset:22528
    ds_read_b64_tr_b16 a[78:79], v242 offset:23040
    ds_read_b64_tr_b16 a[80:81], v242 offset:24576
    ds_read_b64_tr_b16 a[82:83], v242 offset:25088
    ds_read_b64_tr_b16 a[84:85], v242 offset:26624
    ds_read_b64_tr_b16 a[86:87], v242 offset:27136
    ds_read_b64_tr_b16 a[88:89], v242 offset:28672
    ds_read_b64_tr_b16 a[90:91], v242 offset:29184
    ds_read_b64_tr_b16 a[92:93], v242 offset:30720
    ds_read_b64_tr_b16 a[94:95], v242 offset:31232
    ds_read_b64_tr_b16 a[96:97], v243 offset:16384
    ds_read_b64_tr_b16 a[98:99], v243 offset:16896
    ds_read_b64_tr_b16 a[100:101], v243 offset:18432
    ds_read_b64_tr_b16 a[102:103], v243 offset:18944
    ds_read_b64_tr_b16 a[104:105], v243 offset:20480
    ds_read_b64_tr_b16 a[106:107], v243 offset:20992
    ds_read_b64_tr_b16 a[108:109], v243 offset:22528
    ds_read_b64_tr_b16 a[110:111], v243 offset:23040
    ds_read_b64_tr_b16 a[112:113], v243 offset:24576
    ds_read_b64_tr_b16 a[114:115], v243 offset:25088
    ds_read_b64_tr_b16 a[116:117], v243 offset:26624
    ds_read_b64_tr_b16 a[118:119], v243 offset:27136
    ds_read_b64_tr_b16 a[120:121], v243 offset:28672
    ds_read_b64_tr_b16 a[122:123], v243 offset:29184
    ds_read_b64_tr_b16 a[124:125], v243 offset:30720
    ds_read_b64_tr_b16 a[126:127], v243 offset:31232
    s_waitcnt lgkmcnt(0)
    v_or_b32 v239, 32, v1
    v_lshlrev_b32 v239, 2, v239
    buffer_load_dword v238, v239, s[20:23], 0 offen sc1
    s_mov_b32 s12, s40
    s_and_b32 s13, s41, 0xffff
    s_mov_b32 s14, 0x4000
    s_mov_b32 s15, 0x00020000
    s_xor_b32 s4, s26, 4
    s_lshl_b32 s4, s4, 6
    v_bfe_u32 v254, v1, 1, 3
    v_mul_u32_u24 v247, 2048, v254
    v_bfe_u32 v254, v1, 4, 2
    v_mul_u32_u24 v254, 16, v254
    v_add_u32 v247, v247, v254
    v_bfe_u32 v254, v1, 0, 1
    v_mul_u32_u24 v254, 8, v254
    v_add_u32 v247, v247, v254
    buffer_load_dwordx2 v[248:249], v247, s[12:15], s4 offen
    s_mov_b32 s16, s90
    s_and_b32 s17, s91, 0xffff
    s_mov_b32 s18, 0x800000
    s_mov_b32 s19, 0x00020000
    s_and_b32 s4, s26, 1
    s_lshl_b32 s98, s4, 11
    s_lshl_b32 s99, s4, 16
    s_add_u32 s98, s98, s6
    s_xor_b32 m0, s98, 16384
    s_xor_b32 s5, s99, 0
    buffer_load_dwordx4 v241, s[16:19], s5 offen nt lds
    s_xor_b32 m0, s98, 17408
    s_xor_b32 s5, s99, 32768
    buffer_load_dwordx4 v241, s[16:19], s5 offen nt lds
    s_xor_b32 m0, s98, 18432
    s_xor_b32 s5, s99, 65536
    buffer_load_dwordx4 v241, s[16:19], s5 offen nt lds
    s_xor_b32 m0, s98, 19456
    s_xor_b32 s5, s99, 98304
    buffer_load_dwordx4 v241, s[16:19], s5 offen nt lds
    s_xor_b32 m0, s98, 20480
    s_xor_b32 s5, s99, 131072
    buffer_load_dwordx4 v241, s[16:19], s5 offen nt lds
    s_xor_b32 m0, s98, 21504
    s_xor_b32 s5, s99, 163840
    buffer_load_dwordx4 v241, s[16:19], s5 offen nt lds
    s_xor_b32 m0, s98, 22528
    s_xor_b32 s5, s99, 196608
    buffer_load_dwordx4 v241, s[16:19], s5 offen nt lds
    s_xor_b32 m0, s98, 23552
    s_xor_b32 s5, s99, 229376
    buffer_load_dwordx4 v241, s[16:19], s5 offen nt lds
    s_xor_b32 m0, s98, 24576
    s_xor_b32 s5, s99, 262144
    buffer_load_dwordx4 v241, s[16:19], s5 offen nt lds
    s_xor_b32 m0, s98, 25600
    s_xor_b32 s5, s99, 294912
    buffer_load_dwordx4 v241, s[16:19], s5 offen nt lds
    s_xor_b32 m0, s98, 26624
    s_xor_b32 s5, s99, 327680
    buffer_load_dwordx4 v241, s[16:19], s5 offen nt lds
    s_xor_b32 m0, s98, 27648
    s_xor_b32 s5, s99, 360448
    buffer_load_dwordx4 v241, s[16:19], s5 offen nt lds
    s_xor_b32 m0, s98, 28672
    s_xor_b32 s5, s99, 393216
    buffer_load_dwordx4 v241, s[16:19], s5 offen nt lds
    s_xor_b32 m0, s98, 29696
    s_xor_b32 s5, s99, 425984
    buffer_load_dwordx4 v241, s[16:19], s5 offen nt lds
    s_xor_b32 m0, s98, 30720
    s_xor_b32 s5, s99, 458752
    buffer_load_dwordx4 v241, s[16:19], s5 offen nt lds
    s_xor_b32 m0, s98, 31744
    s_xor_b32 s5, s99, 491520
    buffer_load_dwordx4 v241, s[16:19], s5 offen nt lds
    s_waitcnt vmcnt(16)
    s_cmp_lg_u32 s27, 0
    s_cbranch_scc1 .vd_12
    s_mov_b32 s62, 0
.vp_11:
    v_readlane_b32 s4, v238, 49
    s_and_b32 s5, s4, 0xffff
    s_cmp_ge_u32 s5, 256
    s_cbranch_scc1 .va_13
    s_add_u32 s62, s62, 1
    s_cmp_gt_u32 s62, 0x100000
    s_cbranch_scc1 .mg_end_1
    s_sleep 16
    buffer_load_dword v238, v239, s[20:23], 0 offen sc1
    s_waitcnt vmcnt(0)
    s_branch .vp_11
.va_13:
    s_lshr_b32 s4, s4, 16
    s_cbranch_scc0 .vd_12
    s_lshr_b32 s25, s2, 5
    s_and_b32 s26, s2, 31
    s_mov_b32 s27, 1
    s_waitcnt vmcnt(0) lgkmcnt(0)
    s_barrier
    s_branch .mg_role_3
.vd_12:
    ds_read_b64_tr_b16 a[128:129], v242 offset:0
    ds_read_b64_tr_b16 a[130:131], v242 offset:512
    ds_read_b64_tr_b16 a[132:133], v242 offset:2048
    ds_read_b64_tr_b16 a[134:135], v242 offset:2560
    ds_read_b64_tr_b16 a[136:137], v242 offset:4096
    ds_read_b64_tr_b16 a[138:139], v242 offset:4608
    ds_read_b64_tr_b16 a[140:141], v242 offset:6144
    ds_read_b64_tr_b16 a[142:143], v242 offset:6656
    ds_read_b64_tr_b16 a[144:145], v242 offset:8192
    ds_read_b64_tr_b16 a[146:147], v242 offset:8704
    ds_read_b64_tr_b16 a[148:149], v242 offset:10240
    ds_read_b64_tr_b16 a[150:151], v242 offset:10752
    ds_read_b64_tr_b16 a[152:153], v242 offset:12288
    ds_read_b64_tr_b16 a[154:155], v242 offset:12800
    ds_read_b64_tr_b16 a[156:157], v242 offset:14336
    ds_read_b64_tr_b16 a[158:159], v242 offset:14848
    ds_read_b64_tr_b16 a[160:161], v243 offset:0
    ds_read_b64_tr_b16 a[162:163], v243 offset:512
    ds_read_b64_tr_b16 a[164:165], v243 offset:2048
    ds_read_b64_tr_b16 a[166:167], v243 offset:2560
    ds_read_b64_tr_b16 a[168:169], v243 offset:4096
    ds_read_b64_tr_b16 a[170:171], v243 offset:4608
    ds_read_b64_tr_b16 a[172:173], v243 offset:6144
    ds_read_b64_tr_b16 a[174:175], v243 offset:6656
    ds_read_b64_tr_b16 a[176:177], v243 offset:8192
    ds_read_b64_tr_b16 a[178:179], v243 offset:8704
    ds_read_b64_tr_b16 a[180:181], v243 offset:10240
    ds_read_b64_tr_b16 a[182:183], v243 offset:10752
    ds_read_b64_tr_b16 a[184:185], v243 offset:12288
    ds_read_b64_tr_b16 a[186:187], v243 offset:12800
    ds_read_b64_tr_b16 a[188:189], v243 offset:14336
    ds_read_b64_tr_b16 a[190:191], v243 offset:14848
    s_waitcnt lgkmcnt(0)
    s_mov_b32 s47, 0
    s_cmp_lg_u32 s27, 0
    s_cbranch_scc1 .cd_15
    s_mov_b32 s62, 0
.cp_14:
    v_and_b32 v18, 0xffff, v238
    v_lshrrev_b32 v19, 16, v238
    v_min_u32 v17, v18, v19
    v_cmp_eq_u32 vcc, 0, v17
    s_and_b32 s4, vcc_hi, 65280
    s_cbranch_scc0 .cg_16
    s_add_u32 s62, s62, 1
    s_cmp_gt_u32 s62, 0x100000
    s_cbranch_scc1 .mg_end_1
    s_sleep 16
    buffer_load_dword v238, v239, s[20:23], 0 offen sc1
    s_waitcnt vmcnt(0)
    s_branch .cp_14
.cg_16:
    v_readlane_b32 s66, v18, 40
    v_readlane_b32 s67, v19, 40
    v_readlane_b32 s68, v18, 41
    v_readlane_b32 s69, v19, 41
    v_readlane_b32 s70, v18, 42
    v_readlane_b32 s71, v19, 42
    v_readlane_b32 s72, v18, 43
    v_readlane_b32 s73, v19, 43
    v_readlane_b32 s74, v18, 44
    v_readlane_b32 s75, v19, 44
    v_readlane_b32 s76, v18, 45
    v_readlane_b32 s77, v19, 45
    v_readlane_b32 s78, v18, 46
    v_readlane_b32 s79, v19, 46
    v_readlane_b32 s80, v18, 47
    v_readlane_b32 s81, v19, 47
    s_nop 3
    s_add_u32 s4, s66, s67
    s_add_u32 s4, s4, s68
    s_add_u32 s4, s4, s69
    s_add_u32 s4, s4, s74
    s_add_u32 s4, s4, s75
    s_add_u32 s4, s4, s76
    s_add_u32 s4, s4, s77
    s_add_u32 s5, s70, s71
    s_add_u32 s5, s5, s72
    s_add_u32 s5, s5, s73
    s_add_u32 s5, s5, s78
    s_add_u32 s5, s5, s79
    s_add_u32 s5, s5, s80
    s_add_u32 s5, s5, s81
    s_cmp_lt_u32 s5, s4
    s_cselect_b32 s47, 0x2000, 0
    s_cselect_b32 s66, s70, s66
    s_cselect_b32 s67, s71, s67
    s_cselect_b32 s68, s72, s68
    s_cselect_b32 s69, s73, s69
    s_cselect_b32 s74, s78, s74
    s_cselect_b32 s75, s79, s75
    s_cselect_b32 s76, s80, s76
    s_cselect_b32 s77, s81, s77
    s_add_u32 s4, s66, s68
    s_add_u32 s4, s4, s74
    s_add_u32 s4, s4, s76
    s_add_u32 s5, s67, s69
    s_add_u32 s5, s5, s75
    s_add_u32 s5, s5, s77
    s_cmp_lt_u32 s5, s4
    s_cselect_b32 s4, 2048, 0
    s_or_b32 s47, s47, s4
    s_add_u32 s4, s66, s67
    s_add_u32 s4, s4, s74
    s_add_u32 s4, s4, s75
    s_add_u32 s5, s68, s69
    s_add_u32 s5, s5, s76
    s_add_u32 s5, s5, s77
    s_cmp_lt_u32 s5, s4
    s_cselect_b32 s4, 4096, 0
    s_or_b32 s47, s47, s4
    s_add_u32 s4, s66, s67
    s_add_u32 s4, s4, s68
    s_add_u32 s4, s4, s69
    s_add_u32 s5, s74, s75
    s_add_u32 s5, s5, s76
    s_add_u32 s5, s5, s77
    s_cmp_lt_u32 s5, s4
    s_cselect_b32 s4, 16384, 0
    s_or_b32 s47, s47, s4
.cd_15:
    s_cmp_lg_u32 s27, 0
    s_cbranch_scc1 .slowv_17
    s_mov_b32 s28, 0
    s_mov_b32 s30, 83886080
    s_mov_b32 s31, 84180992
    s_mov_b32 s32, 84475904
    s_mov_b32 s33, 84770816
    s_mov_b32 s41, 66977792
    s_lshl_b32 s42, s56, 13
    s_lshl_b32 s4, s53, 11
    s_add_u32 s44, s42, s4
    s_add_u32 s44, s44, 33554432
    s_add_u32 s42, s42, 16777216
    s_xor_b32 s4, s53, 2
    s_lshl_b32 s4, s4, 10
    s_add_u32 s42, s42, s4
    s_add_u32 s43, s42, 4096
    s_add_u32 s96, s44, 524288
    s_sub_u32 s95, s96, 16777216
    s_mov_b32 s62, 0
    s_mov_b32 s45, 0x3e0293ee
    s_mov_b32 s46, 0
    s_and_b32 s4, s25, 1
    s_lshl_b32 s4, s4, 14
    s_lshr_b32 s5, s25, 1
    s_lshl_b32 s5, s5, 12
    s_or_b32 s4, s4, s5
    s_xor_b32 s47, s47, s4
    s_and_b32 s5, s26, 1
    s_lshl_b32 s5, s5, 10
    s_lshr_b32 s4, s26, 1
    s_lshl_b32 s4, s4, 15
    s_or_b32 s5, s5, s4
    s_bfe_u32 s4, s26, 0x10004
    s_lshl_b32 s4, s4, 11
    s_xor_b32 s5, s5, s4
    s_xor_b32 s34, s5, s47
    s_xor_b32 s35, s34, 0x84000
    s_xor_b32 s36, s34, 0x101000
    s_xor_b32 s37, s34, 0x185000
    s_cmp_eq_u32 s24, 1
    s_cbranch_scc1 .w1_19
    s_cmp_eq_u32 s24, 2
    s_cbranch_scc1 .w2_20
    s_cmp_eq_u32 s24, 3
    s_cbranch_scc1 .w3_21
.w0_18:
    v_bfe_u32 v254, v1, 0, 3
    v_mul_u32_u24 v9, 144, v254
    v_bfe_u32 v254, v1, 3, 1
    v_mul_u32_u24 v254, 1152, v254
    v_add_u32 v9, v9, v254
    v_bfe_u32 v254, v1, 4, 2
    v_mul_u32_u24 v254, 32, v254
    v_add_u32 v9, v9, v254
    s_lshl_b32 s4, s56, 10
    v_bfe_u32 v254, v1, 0, 6
    v_mul_u32_u24 v13, 16, v254
    v_add_u32 v13, 262144, v13
    v_add_u32 v13, s4, v13
    v_xor_b32 v156, 1024, v246
    v_xor_b32 v157, 2048, v246
    v_xor_b32 v158, 3072, v246
    v_bfe_u32 v254, v1, 4, 2
    v_mul_u32_u24 v14, 128, v254
    v_bfe_u32 v254, v1, 0, 4
    v_mul_u32_u24 v254, 16, v254
    v_add_u32 v14, v14, v254
    v_add_u32 v14, 65536, v14
    v_add_u32 v14, s55, v14
    v_bfe_u32 v254, v1, 0, 6
    v_mul_u32_u24 v15, 16, v254
    v_bfe_u32 v254, v1, 2, 2
    v_mul_u32_u24 v16, 128, v254
    v_bfe_u32 v254, v1, 0, 2
    v_mul_u32_u24 v254, 16, v254
    v_add_u32 v16, v16, v254
    v_bfe_u32 v254, v1, 4, 2
    v_mul_u32_u24 v254, 4, v254
    v_add_u32 v16, v16, v254
    v_add_u32 v16, 18688, v16
    v_mov_b32 v208, 0
    v_mov_b32 v209, 0
    v_mov_b32 v210, 0
    v_mov_b32 v211, 0
    v_mov_b32 v212, 0
    v_mov_b32 v213, 0
    v_mov_b32 v214, 0
    v_mov_b32 v215, 0
    v_mov_b32 v216, 0
    v_mov_b32 v217, 0
    v_mov_b32 v218, 0
    v_mov_b32 v219, 0
    s_mov_b64 s[50:51], s[48:49]
    v_mov_b32 v164, 0
    v_mov_b32 v165, 0
    v_mov_b32 v166, 0
    v_mov_b32 v167, 0
    v_mov_b32 v164, 0x3f803f80
    v_mov_b32 v200, s45
    v_mov_b32 v220, 0x3f803f80
    v_mov_b32 v201, s45
    v_mov_b32 v221, 0x3f803f80
    v_mov_b32 v202, s45
    v_mov_b32 v222, 0x3f803f80
    v_mov_b32 v203, s45
    v_mov_b32 v223, 0x3f803f80
    buffer_load_dwordx4 v[24:27], v246, s[8:11], s30 offen sc1
    buffer_load_dwordx4 v[28:31], v245, s[8:11], s30 offen sc1
    buffer_load_dword v32, v237, s[8:11], s30 offen sc1
    s_waitcnt vmcnt(0)
    ds_read_b64_tr_b16 a[192:193], v242 offset:16384
    ds_read_b64_tr_b16 a[194:195], v242 offset:16896
    ds_read_b64_tr_b16 a[196:197], v242 offset:18432
    ds_read_b64_tr_b16 a[198:199], v242 offset:18944
    ds_read_b64_tr_b16 a[200:201], v242 offset:20480
    ds_read_b64_tr_b16 a[202:203], v242 offset:20992
    ds_read_b64_tr_b16 a[204:205], v242 offset:22528
    ds_read_b64_tr_b16 a[206:207], v242 offset:23040
    ds_read_b64_tr_b16 a[208:209], v242 offset:24576
    ds_read_b64_tr_b16 a[210:211], v242 offset:25088
    ds_read_b64_tr_b16 a[212:213], v242 offset:26624
    ds_read_b64_tr_b16 a[214:215], v242 offset:27136
    ds_read_b64_tr_b16 a[216:217], v242 offset:28672
    ds_read_b64_tr_b16 a[218:219], v242 offset:29184
    ds_read_b64_tr_b16 a[220:221], v242 offset:30720
    ds_read_b64_tr_b16 a[222:223], v242 offset:31232
    ds_read_b64_tr_b16 a[224:225], v243 offset:16384
    ds_read_b64_tr_b16 a[226:227], v243 offset:16896
    ds_read_b64_tr_b16 a[228:229], v243 offset:18432
    ds_read_b64_tr_b16 a[230:231], v243 offset:18944
    ds_read_b64_tr_b16 a[232:233], v243 offset:20480
    ds_read_b64_tr_b16 a[234:235], v243 offset:20992
    ds_read_b64_tr_b16 a[236:237], v243 offset:22528
    ds_read_b64_tr_b16 a[238:239], v243 offset:23040
    ds_read_b64_tr_b16 a[240:241], v243 offset:24576
    ds_read_b64_tr_b16 a[242:243], v243 offset:25088
    ds_read_b64_tr_b16 a[244:245], v243 offset:26624
    ds_read_b64_tr_b16 a[246:247], v243 offset:27136
    ds_read_b64_tr_b16 a[248:249], v243 offset:28672
    ds_read_b64_tr_b16 a[250:251], v243 offset:29184
    ds_read_b64_tr_b16 a[252:253], v243 offset:30720
    ds_read_b64_tr_b16 a[254:255], v243 offset:31232
    s_waitcnt lgkmcnt(0)
    s_barrier
    buffer_load_dwordx4 v[104:107], v15, s[8:11], s42 offen offset:0
    buffer_load_dwordx4 v[120:123], v15, s[8:11], s43 offen offset:0
    buffer_load_dwordx4 v[136:139], v15, s[8:11], s44 offen offset:0
    buffer_load_dwordx4 v[140:143], v15, s[8:11], s44 offen offset:1024
    s_add_u32 s42, s42, 262144
    s_add_u32 s43, s43, 262144
    s_add_u32 s44, s44, 262144
.p2align 6
.step_24:
    s_barrier
    s_setprio 3
    buffer_load_dwordx4 v[24:27], v3, s[8:11], s30 offen offset:0 sc1
    s_setprio 2
    buffer_load_dwordx4 v[28:31], v3, s[8:11], s30 offen offset:1024 sc1
    s_setprio 1
    buffer_load_dwordx4 v[32:35], v3, s[8:11], s30 offen offset:2048 sc1
    s_setprio 0
    buffer_load_dwordx4 v[36:39], v3, s[8:11], s30 offen offset:3072 sc1
    s_call_b64 s[98:99], .gm_22
    v_permlane32_swap_b32 v40, v44
    v_permlane32_swap_b32 v41, v45
    v_permlane32_swap_b32 v42, v46
    v_permlane32_swap_b32 v43, v47
    v_add_f32 v40, v40, v44
    v_add_f32 v41, v41, v45
    v_add_f32 v42, v42, v46
    v_add_f32 v43, v43, v47
    ds_write2_b32 v5, v40, v41 offset0:0 offset1:36
    ds_write2_b32 v5, v42, v43 offset0:72 offset1:108
    v_permlane32_swap_b32 v48, v52
    v_permlane32_swap_b32 v49, v53
    v_permlane32_swap_b32 v50, v54
    v_permlane32_swap_b32 v51, v55
    v_pk_add_f32 v[48:49], v[48:49], v[52:53]
    v_pk_add_f32 v[50:51], v[50:51], v[54:55]
    ds_write2_b32 v6, v48, v49 offset0:0 offset1:36
    ds_write2_b32 v6, v50, v51 offset0:72 offset1:108
    s_waitcnt lgkmcnt(2)
    s_barrier
    ds_read_b128 v[72:75], v9 offset:0
    ds_read_b128 v[76:79], v9 offset:2304
    ds_read_b128 v[80:83], v9 offset:16
    ds_read_b128 v[84:87], v9 offset:2320
    v_smfmac_f32_16x16x64_bf16 v[56:59], v[24:27], a[128:135], v2
    v_smfmac_f32_16x16x64_bf16 v[60:63], v[24:27], a[160:167], v2
    s_waitcnt lgkmcnt(4)
    s_barrier
    v_smfmac_f32_16x16x64_bf16 v[56:59], v[28:31], a[136:143], v2
    s_waitcnt lgkmcnt(2)
    v_pk_add_f32 v[72:73], v[72:73], v[76:77]
    v_pk_add_f32 v[74:75], v[74:75], v[78:79]
    v_cvt_pk_bf16_f32 v144, v72, v73
    v_cvt_pk_bf16_f32 v145, v74, v75
    s_waitcnt lgkmcnt(0)
    v_pk_add_f32 v[80:81], v[80:81], v[84:85]
    v_pk_add_f32 v[82:83], v[82:83], v[86:87]
    v_cvt_pk_bf16_f32 v146, v80, v81
    v_cvt_pk_bf16_f32 v147, v82, v83
    s_nop 1
    v_mfma_f32_16x16x32_bf16 v[192:195], v[104:107], v[144:147], 0
    v_mfma_f32_16x16x32_bf16 v[160:163], v[120:123], v[144:147], 0
    v_smfmac_f32_16x16x64_bf16 v[60:63], v[28:31], a[168:175], v2
    v_add_f32_dpp v151, v195, v195 row_ror:8 row_mask:0xf bank_mask:0x3
    v_add_f32_dpp v148, v192, v192 row_ror:8 row_mask:0xf bank_mask:0x3
    v_add_f32_dpp v149, v193, v193 row_ror:8 row_mask:0xf bank_mask:0x3
    v_add_f32_dpp v150, v194, v194 row_ror:8 row_mask:0xf bank_mask:0x3
    v_add_f32_dpp v151, v163, v163 row_ror:8 row_mask:0xf bank_mask:0xc
    v_add_f32_dpp v148, v160, v160 row_ror:8 row_mask:0xf bank_mask:0xc
    v_add_f32_dpp v149, v161, v161 row_ror:8 row_mask:0xf bank_mask:0xc
    v_add_f32_dpp v150, v162, v162 row_ror:8 row_mask:0xf bank_mask:0xc
    v_min_u32 v151, 0xfffffffe, v151
    buffer_store_dwordx4 v[148:151], v246, s[8:11], s30 offen
    v_smfmac_f32_16x16x64_bf16 v[56:59], v[32:35], a[144:151], v2
    v_smfmac_f32_16x16x64_bf16 v[60:63], v[32:35], a[176:183], v2
    v_smfmac_f32_16x16x64_bf16 v[56:59], v[36:39], a[152:159], v2
    v_smfmac_f32_16x16x64_bf16 v[60:63], v[36:39], a[184:191], v2
    v_mov_b32 v40, 0
    v_mov_b32 v41, 0
    v_mov_b32 v42, 0
    v_mov_b32 v43, 0
    v_mov_b32 v44, 0
    v_mov_b32 v45, 0
    v_mov_b32 v46, 0
    v_mov_b32 v47, 0
    v_permlane32_swap_b32 v56, v60
    v_permlane32_swap_b32 v57, v61
    v_permlane32_swap_b32 v58, v62
    v_permlane32_swap_b32 v59, v63
    v_pk_add_f32 v[56:57], v[56:57], v[60:61]
    v_pk_add_f32 v[58:59], v[58:59], v[62:63]
    v_cvt_pk_bf16_f32 v60, v56, v57
    v_cvt_pk_bf16_f32 v61, v58, v59
    ds_write2_b32 v255, v60, v61 offset0:0 offset1:64
    ds_write_b128 v8, v[56:59]
    s_cmp_eq_u32 s28, 63
    s_cbranch_scc1 .fin_25
    buffer_load_dwordx4 v[176:179], v13, s[8:11], s30 offen sc1
    buffer_load_dwordx4 v[180:183], v156, s[8:11], s30 offen sc1
    buffer_load_dwordx4 v[184:187], v157, s[8:11], s30 offen sc1
    buffer_load_dwordx4 v[188:191], v158, s[8:11], s30 offen sc1
    s_waitcnt lgkmcnt(0)
    s_barrier
    ds_read_b128 v[212:215], v15 offset:20224
    ds_read_b128 v[216:219], v15 offset:21248
    buffer_load_dwordx4 v[72:75], v13, s[8:11], s30 offen sc1
    buffer_load_dwordx4 v[76:79], v156, s[8:11], s30 offen sc1
    buffer_load_dwordx4 v[80:83], v157, s[8:11], s30 offen sc1
    buffer_load_dwordx4 v[84:87], v158, s[8:11], s30 offen sc1
.mf_26:
    s_waitcnt vmcnt(7)
    v_max3_u32 v18, v176, v177, v178
    v_pk_add_f32 v[196:197], v[176:177], v[178:179]
    s_waitcnt vmcnt(6)
    v_max3_u32 v18, v18, v179, v183
    v_pk_add_f32 v[192:193], v[148:149], v[180:181]
    v_pk_add_f32 v[194:195], v[150:151], v[182:183]
    v_add_f32 v196, v196, v197
    s_waitcnt vmcnt(5)
    v_pk_add_f32 v[192:193], v[192:193], v[184:185]
    v_pk_add_f32 v[194:195], v[194:195], v[186:187]
    s_waitcnt vmcnt(4)
    v_max3_u32 v18, v18, v187, v191
    v_pk_add_f32 v[192:193], v[192:193], v[188:189]
    v_pk_add_f32 v[194:195], v[194:195], v[190:191]
    v_cmp_eq_u32 vcc, -1, v18
    v_max3_f32 v19, v192, v193, v196
    v_max3_f32 v19, v19, v194, v195
    s_cbranch_vccnz .re_27
.sj_28:
    s_nop 0
    v_max_f32_dpp v18, v19, v19 row_ror:8 row_mask:0xf bank_mask:0xf
    v_max_f32_dpp v17, v19, v19 row_ror:8 row_mask:0xf bank_mask:0xf
    s_nop 1
    v_permlane16_swap_b32 v18, v17
    v_max_f32 v19, v18, v17
    v_max_f32 v18, v18, v17
    s_nop 1
    v_permlane32_swap_b32 v18, v19
    v_max_f32 v18, v18, v19
    v_mul_f32 v18, s45, v18
    v_fma_f32 v244, v196, s45, -v18
    v_pk_fma_f32 v[240:241], v[192:193], v[200:201], v[18:19] op_sel_hi:[1,1,0] neg_lo:[0,0,1] neg_hi:[0,0,1]
    v_exp_f32 v244, v244
    v_pk_fma_f32 v[242:243], v[194:195], v[200:201], v[18:19] op_sel_hi:[1,1,0] neg_lo:[0,0,1] neg_hi:[0,0,1]
    v_exp_f32 v240, v240
    v_mov_b32_dpp v245, v244 row_ror:8 row_mask:0xf bank_mask:0xf
    v_cvt_pk_bf16_f32 v208, v244, v245
    v_cvt_pk_bf16_f32 v209, v244, v245
    v_pk_mov_b32 v[210:211], v[208:209], v[208:209] op_sel:[0,1]
    v_exp_f32 v241, v241
    s_waitcnt lgkmcnt(0)
    v_mfma_f32_16x16x32_bf16 v[228:231], v[212:215], v[208:211], 0
    v_exp_f32 v242, v242
    v_mfma_f32_16x16x32_bf16 v[224:227], v[164:167], v[208:211], 0
    v_exp_f32 v243, v243
    v_cvt_pk_bf16_f32 v204, v240, v241
    v_cvt_pk_bf16_f32 v205, v242, v243
    v_mfma_f32_16x16x32_bf16 v[232:235], v[216:219], v[208:211], 0
    v_mov_b32_dpp v206, v204 row_ror:8 row_mask:0xf bank_mask:0xf
    v_mov_b32_dpp v207, v205 row_ror:8 row_mask:0xf bank_mask:0xf
    s_nop 1
    v_mfma_f32_16x16x32_bf16 v[224:227], v[220:223], v[204:207], v[224:227]
    v_mfma_f32_16x16x32_bf16 v[228:231], v[136:139], v[204:207], v[228:231]
    v_mfma_f32_16x16x32_bf16 v[232:235], v[140:143], v[204:207], v[232:235]
    s_mov_b64 exec, s[50:51]
    v_rcp_f32 v18, v224
    s_nop 1
    v_mul_f32 v228, v18, v228
    v_mul_f32 v229, v18, v229
    v_mul_f32 v230, v18, v230
    v_mul_f32 v231, v18, v231
    v_pk_mul_f32 v[232:233], v[18:19], v[232:233] op_sel_hi:[0,1]
    v_pk_mul_f32 v[234:235], v[18:19], v[234:235] op_sel_hi:[0,1]
    v_cvt_pk_bf16_f32 v236, v228, v229
    v_cvt_pk_bf16_f32 v239, v234, v235
    v_cvt_pk_bf16_f32 v237, v230, v231
    v_cvt_pk_bf16_f32 v238, v232, v233
    v_min_u32 v239, 0xfffffffe, v239
    buffer_store_dwordx4 v[236:239], v14, s[8:11], s30 offen
    s_mov_b64 exec, -1
    v_mov_b32 v48, 0
    v_mov_b32 v49, 0
    v_mov_b32 v50, 0
    v_mov_b32 v51, 0
    v_mov_b32 v52, 0
    v_mov_b32 v53, 0
    v_mov_b32 v54, 0
    v_mov_b32 v55, 0
    v_mov_b32 v56, 0
    v_mov_b32 v57, 0
    v_mov_b32 v58, 0
    v_mov_b32 v59, 0
    v_mov_b32 v60, 0
    v_mov_b32 v61, 0
    v_mov_b32 v62, 0
    v_mov_b32 v63, 0
    s_waitcnt vmcnt(0)
    s_barrier
    s_setprio 3
    buffer_load_dwordx4 v[24:27], v4, s[8:11], s30 offen offset:0 sc1
    s_setprio 2
    buffer_load_dwordx4 v[28:31], v4, s[8:11], s30 offen offset:1024 sc1
    s_setprio 1
    buffer_load_dwordx4 v[32:35], v4, s[8:11], s30 offen offset:2048 sc1
    s_setprio 0
    buffer_load_dwordx4 v[36:39], v4, s[8:11], s30 offen offset:3072 sc1
    s_call_b64 s[98:99], .gm_23
    s_nop 6
    v_permlane32_swap_b32 v64, v68
    v_permlane32_swap_b32 v65, v69
    v_permlane32_swap_b32 v66, v70
    v_permlane32_swap_b32 v67, v71
    v_pk_add_f32 v[64:65], v[64:65], v[68:69]
    v_pk_add_f32 v[66:67], v[66:67], v[70:71]
    ds_write2_b32 v7, v64, v65 offset0:0 offset1:36
    ds_write2_b32 v7, v66, v67 offset0:72 offset1:108
    s_waitcnt lgkmcnt(0)
    s_barrier
    buffer_load_dwordx4 v[104:107], v15, s[8:11], s42 offen offset:0
    buffer_load_dwordx4 v[120:123], v15, s[8:11], s43 offen offset:0
    buffer_load_dwordx4 v[136:139], v15, s[8:11], s44 offen offset:0
    buffer_load_dwordx4 v[140:143], v15, s[8:11], s44 offen offset:1024
    s_add_u32 s42, s42, 262144
    s_add_u32 s43, s43, 262144
    s_add_u32 s44, s44, 262144
    v_mov_b32 v64, 0
    v_mov_b32 v65, 0
    v_mov_b32 v66, 0
    v_mov_b32 v67, 0
    v_mov_b32 v68, 0
    v_mov_b32 v69, 0
    v_mov_b32 v70, 0
    v_mov_b32 v71, 0
    s_mov_b32 s4, s30
    s_mov_b32 s30, s31
    s_mov_b32 s31, s32
    s_mov_b32 s32, s33
    s_mov_b32 s33, s4
    s_add_u32 s28, s28, 1
    s_mov_b32 s62, 0
    s_branch .step_24
.fin_25:
    s_waitcnt lgkmcnt(0)
    s_barrier
    s_barrier
    s_endpgm
.re_27:
    buffer_load_dwordx4 v[176:179], v13, s[8:11], s30 offen sc1
    buffer_load_dwordx4 v[180:183], v156, s[8:11], s30 offen sc1
    buffer_load_dwordx4 v[184:187], v157, s[8:11], s30 offen sc1
    buffer_load_dwordx4 v[188:191], v158, s[8:11], s30 offen sc1
    s_waitcnt vmcnt(7)
    v_max3_u32 v18, v72, v73, v74
    v_pk_add_f32 v[196:197], v[72:73], v[74:75]
    s_waitcnt vmcnt(6)
    v_max3_u32 v18, v18, v75, v79
    v_pk_add_f32 v[192:193], v[148:149], v[76:77]
    v_pk_add_f32 v[194:195], v[150:151], v[78:79]
    v_add_f32 v196, v196, v197
    s_waitcnt vmcnt(5)
    v_pk_add_f32 v[192:193], v[192:193], v[80:81]
    v_pk_add_f32 v[194:195], v[194:195], v[82:83]
    s_waitcnt vmcnt(4)
    v_max3_u32 v18, v18, v83, v87
    v_pk_add_f32 v[192:193], v[192:193], v[84:85]
    v_pk_add_f32 v[194:195], v[194:195], v[86:87]
    v_cmp_eq_u32 vcc, -1, v18
    v_max3_f32 v19, v192, v193, v196
    v_max3_f32 v19, v19, v194, v195
    s_cbranch_vccnz .re_29
    s_branch .sj_28
.re_29:
    buffer_load_dwordx4 v[72:75], v13, s[8:11], s30 offen sc1
    buffer_load_dwordx4 v[76:79], v156, s[8:11], s30 offen sc1
    buffer_load_dwordx4 v[80:83], v157, s[8:11], s30 offen sc1
    buffer_load_dwordx4 v[84:87], v158, s[8:11], s30 offen sc1
    s_add_u32 s62, s62, 1
    s_cmp_gt_u32 s62, 0x100000
    s_cbranch_scc1 .mg_end_1
    s_branch .mf_26
.w1_19:
    v_bfe_u32 v254, v1, 0, 3
    v_mul_u32_u24 v9, 144, v254
    v_bfe_u32 v254, v1, 3, 1
    v_mul_u32_u24 v254, 1152, v254
    v_add_u32 v9, v9, v254
    v_bfe_u32 v254, v1, 4, 2
    v_mul_u32_u24 v254, 32, v254
    v_add_u32 v9, v9, v254
    v_bfe_u32 v254, v1, 0, 1
    v_mul_u32_u24 v11, 144, v254
    v_bfe_u32 v254, v1, 2, 2
    v_mul_u32_u24 v254, 288, v254
    v_add_u32 v11, v11, v254
    v_bfe_u32 v254, v1, 1, 1
    v_mul_u32_u24 v254, 1152, v254
    v_add_u32 v11, v11, v254
    v_bfe_u32 v254, v1, 4, 2
    v_mul_u32_u24 v254, 32, v254
    v_add_u32 v11, v11, v254
    v_add_u32 v11, 4736, v11
    s_lshl_b32 s4, s56, 10
    s_lshl_b32 s5, s53, 2
    v_bfe_u32 v254, v1, 0, 6
    v_mul_u32_u24 v10, 16, v254
    v_add_u32 v10, 262144, v10
    v_add_u32 v10, s4, v10
    v_add_u32 v10, s5, v10
    v_bfe_u32 v254, v1, 1, 3
    v_mul_u32_u24 v12, 144, v254
    v_bfe_u32 v254, v1, 4, 2
    v_mul_u32_u24 v254, 32, v254
    v_add_u32 v12, v12, v254
    v_bfe_u32 v254, v1, 0, 1
    v_mul_u32_u24 v254, 16, v254
    v_add_u32 v12, v12, v254
    v_add_u32 v12, 9472, v12
    v_bfe_u32 v254, v1, 0, 6
    v_mul_u32_u24 v13, 16, v254
    v_add_u32 v13, s101, v13
    v_bfe_u32 v254, v1, 0, 6
    v_mul_u32_u24 v14, 8, v254
    v_add_u32 v14, s55, v14
    v_xor_b32 v14, 2048, v14
    v_min_u32 v249, 0xfffffffe, v249
    buffer_store_dwordx2 v[248:249], v14, s[8:11], s30 offen
    v_bfe_u32 v254, v1, 0, 6
    v_mul_u32_u24 v15, 16, v254
    s_add_u32 s42, s42, 262144
    s_add_u32 s43, s43, 262144
    s_add_u32 s44, s44, 262144
    buffer_load_dwordx4 v[24:27], v246, s[8:11], s31 offen sc1
    buffer_load_dwordx4 v[28:31], v245, s[8:11], s31 offen sc1
    buffer_load_dword v32, v237, s[8:11], s31 offen sc1
    s_waitcnt vmcnt(0)
    ds_read_b64_tr_b16 a[192:193], v242 offset:16384
    ds_read_b64_tr_b16 a[194:195], v242 offset:16896
    ds_read_b64_tr_b16 a[196:197], v242 offset:18432
    ds_read_b64_tr_b16 a[198:199], v242 offset:18944
    ds_read_b64_tr_b16 a[200:201], v242 offset:20480
    ds_read_b64_tr_b16 a[202:203], v242 offset:20992
    ds_read_b64_tr_b16 a[204:205], v242 offset:22528
    ds_read_b64_tr_b16 a[206:207], v242 offset:23040
    ds_read_b64_tr_b16 a[208:209], v242 offset:24576
    ds_read_b64_tr_b16 a[210:211], v242 offset:25088
    ds_read_b64_tr_b16 a[212:213], v242 offset:26624
    ds_read_b64_tr_b16 a[214:215], v242 offset:27136
    ds_read_b64_tr_b16 a[216:217], v242 offset:28672
    ds_read_b64_tr_b16 a[218:219], v242 offset:29184
    ds_read_b64_tr_b16 a[220:221], v242 offset:30720
    ds_read_b64_tr_b16 a[222:223], v242 offset:31232
    ds_read_b64_tr_b16 a[224:225], v243 offset:16384
    ds_read_b64_tr_b16 a[226:227], v243 offset:16896
    ds_read_b64_tr_b16 a[228:229], v243 offset:18432
    ds_read_b64_tr_b16 a[230:231], v243 offset:18944
    ds_read_b64_tr_b16 a[232:233], v243 offset:20480
    ds_read_b64_tr_b16 a[234:235], v243 offset:20992
    ds_read_b64_tr_b16 a[236:237], v243 offset:22528
    ds_read_b64_tr_b16 a[238:239], v243 offset:23040
    ds_read_b64_tr_b16 a[240:241], v243 offset:24576
    ds_read_b64_tr_b16 a[242:243], v243 offset:25088
    ds_read_b64_tr_b16 a[244:245], v243 offset:26624
    ds_read_b64_tr_b16 a[246:247], v243 offset:27136
    ds_read_b64_tr_b16 a[248:249], v243 offset:28672
    ds_read_b64_tr_b16 a[250:251], v243 offset:29184
    ds_read_b64_tr_b16 a[252:253], v243 offset:30720
    ds_read_b64_tr_b16 a[254:255], v243 offset:31232
    s_waitcnt lgkmcnt(0)
    s_barrier
.p2align 6
.step_30:
    s_barrier
    s_setprio 3
    buffer_load_dwordx4 v[24:27], v3, s[8:11], s30 offen offset:0 sc1
    s_setprio 2
    buffer_load_dwordx4 v[28:31], v3, s[8:11], s30 offen offset:1024 sc1
    s_setprio 1
    buffer_load_dwordx4 v[32:35], v3, s[8:11], s30 offen offset:2048 sc1
    s_setprio 0
    buffer_load_dwordx4 v[36:39], v3, s[8:11], s30 offen offset:3072 sc1
    s_call_b64 s[98:99], .gm_22
    v_permlane32_swap_b32 v40, v44
    v_permlane32_swap_b32 v41, v45
    v_permlane32_swap_b32 v42, v46
    v_permlane32_swap_b32 v43, v47
    v_add_f32 v40, v40, v44
    v_add_f32 v41, v41, v45
    v_add_f32 v42, v42, v46
    v_add_f32 v43, v43, v47
    ds_write2_b32 v5, v40, v41 offset0:0 offset1:36
    ds_write2_b32 v5, v42, v43 offset0:72 offset1:108
    v_permlane32_swap_b32 v48, v52
    v_permlane32_swap_b32 v49, v53
    v_permlane32_swap_b32 v50, v54
    v_permlane32_swap_b32 v51, v55
    v_pk_add_f32 v[48:49], v[48:49], v[52:53]
    v_pk_add_f32 v[50:51], v[50:51], v[54:55]
    ds_write2_b32 v6, v48, v49 offset0:0 offset1:36
    ds_write2_b32 v6, v50, v51 offset0:72 offset1:108
    s_waitcnt lgkmcnt(2)
    s_barrier
    ds_read_b128 v[72:75], v9 offset:0
    ds_read_b128 v[76:79], v9 offset:2304
    ds_read_b128 v[80:83], v9 offset:16
    ds_read_b128 v[84:87], v9 offset:2320
    v_smfmac_f32_16x16x64_bf16 v[56:59], v[24:27], a[128:135], v2
    v_smfmac_f32_16x16x64_bf16 v[60:63], v[24:27], a[160:167], v2
    s_waitcnt lgkmcnt(4)
    s_barrier
    ds_read_b128 v[88:91], v11 offset:0
    ds_read_b128 v[92:95], v11 offset:2304
    ds_read_b128 v[96:99], v11 offset:16
    ds_read_b128 v[100:103], v11 offset:2320
    v_smfmac_f32_16x16x64_bf16 v[56:59], v[28:31], a[136:143], v2
    s_waitcnt lgkmcnt(6)
    v_pk_add_f32 v[72:73], v[72:73], v[76:77]
    v_pk_add_f32 v[74:75], v[74:75], v[78:79]
    v_cvt_pk_bf16_f32 v144, v72, v73
    v_cvt_pk_bf16_f32 v145, v74, v75
    s_waitcnt lgkmcnt(4)
    v_pk_add_f32 v[80:81], v[80:81], v[84:85]
    v_pk_add_f32 v[82:83], v[82:83], v[86:87]
    v_cvt_pk_bf16_f32 v146, v80, v81
    v_cvt_pk_bf16_f32 v147, v82, v83
    s_waitcnt lgkmcnt(2)
    v_pk_add_f32 v[88:89], v[88:89], v[92:93]
    v_pk_add_f32 v[90:91], v[90:91], v[94:95]
    v_cvt_pk_bf16_f32 v148, v88, v89
    v_cvt_pk_bf16_f32 v149, v90, v91
    s_waitcnt lgkmcnt(0)
    v_pk_add_f32 v[96:97], v[96:97], v[100:101]
    v_pk_add_f32 v[98:99], v[98:99], v[102:103]
    v_cvt_pk_bf16_f32 v150, v96, v97
    v_cvt_pk_bf16_f32 v151, v98, v99
    s_nop 1
    v_mfma_f32_16x16x32_bf16 v[196:199], v[148:151], v[144:147], 0
    v_smfmac_f32_16x16x64_bf16 v[60:63], v[28:31], a[168:175], v2
    v_smfmac_f32_16x16x64_bf16 v[56:59], v[32:35], a[144:151], v2
    v_pk_add_f32 v[196:197], v[196:197], v[198:199]
    s_nop 1
    v_add_f32_dpp v198, v196, v196 row_ror:8 row_mask:0xf bank_mask:0xf
    v_add_f32_dpp v199, v197, v197 row_ror:8 row_mask:0xf bank_mask:0xf
    v_cndmask_b32 v198, v199, v198, s[48:49]
    v_min_u32 v198, 0xfffffffe, v198
    buffer_store_dword v198, v10, s[8:11], s30 offen
    v_smfmac_f32_16x16x64_bf16 v[60:63], v[32:35], a[176:183], v2
    v_smfmac_f32_16x16x64_bf16 v[56:59], v[36:39], a[152:159], v2
    v_smfmac_f32_16x16x64_bf16 v[60:63], v[36:39], a[184:191], v2
    v_mov_b32 v40, 0
    v_mov_b32 v41, 0
    v_mov_b32 v42, 0
    v_mov_b32 v43, 0
    v_mov_b32 v44, 0
    v_mov_b32 v45, 0
    v_mov_b32 v46, 0
    v_mov_b32 v47, 0
    v_permlane32_swap_b32 v56, v60
    v_permlane32_swap_b32 v57, v61
    v_permlane32_swap_b32 v58, v62
    v_permlane32_swap_b32 v59, v63
    v_pk_add_f32 v[56:57], v[56:57], v[60:61]
    v_pk_add_f32 v[58:59], v[58:59], v[62:63]
    v_cvt_pk_bf16_f32 v60, v56, v57
    v_cvt_pk_bf16_f32 v61, v58, v59
    ds_write2_b32 v255, v60, v61 offset0:0 offset1:64
    ds_write_b128 v8, v[56:59]
    s_waitcnt lgkmcnt(0)
    s_barrier
    s_cmp_eq_u32 s28, 63
    s_cbranch_scc1 .fin_31
    s_xor_b32 s38, s34, 0x4000
    s_xor_b32 s39, s34, 0x1000
    s_xor_b32 s40, s34, 0x5000
    v_mov_b32 v48, 0
    v_mov_b32 v49, 0
    v_mov_b32 v50, 0
    v_mov_b32 v51, 0
    v_mov_b32 v52, 0
    v_mov_b32 v53, 0
    v_mov_b32 v54, 0
    v_mov_b32 v55, 0
    v_mov_b32 v56, 0
    v_mov_b32 v57, 0
    v_mov_b32 v58, 0
    v_mov_b32 v59, 0
    v_mov_b32 v60, 0
    v_mov_b32 v61, 0
    v_mov_b32 v62, 0
    v_mov_b32 v63, 0
    s_barrier
    s_setprio 3
    buffer_load_dwordx4 v[24:27], v4, s[8:11], s30 offen offset:0 sc1
    s_setprio 2
    buffer_load_dwordx4 v[28:31], v4, s[8:11], s30 offen offset:1024 sc1
    s_setprio 1
    buffer_load_dwordx4 v[32:35], v4, s[8:11], s30 offen offset:2048 sc1
    s_setprio 0
    buffer_load_dwordx4 v[36:39], v4, s[8:11], s30 offen offset:3072 sc1
    s_call_b64 s[98:99], .gm_23
    s_nop 6
    v_permlane32_swap_b32 v64, v68
    v_permlane32_swap_b32 v65, v69
    v_permlane32_swap_b32 v66, v70
    v_permlane32_swap_b32 v67, v71
    v_pk_add_f32 v[64:65], v[64:65], v[68:69]
    v_pk_add_f32 v[66:67], v[66:67], v[70:71]
    ds_write2_b32 v7, v64, v65 offset0:0 offset1:36
    ds_write2_b32 v7, v66, v67 offset0:72 offset1:108
    s_waitcnt lgkmcnt(0)
    s_barrier
    ds_read_b128 v[72:75], v12 offset:0
    ds_read_b128 v[76:79], v12 offset:1152
    ds_read_b128 v[80:83], v12 offset:2304
    ds_read_b128 v[84:87], v12 offset:3456
    s_waitcnt lgkmcnt(2)
    v_pk_add_f32 v[72:73], v[72:73], v[76:77]
    v_pk_add_f32 v[74:75], v[74:75], v[78:79]
    s_waitcnt lgkmcnt(0)
    v_pk_add_f32 v[80:81], v[80:81], v[84:85]
    v_pk_add_f32 v[82:83], v[82:83], v[86:87]
    v_pk_add_f32 v[72:73], v[72:73], v[80:81]
    v_pk_add_f32 v[74:75], v[74:75], v[82:83]
    v_min_u32 v75, 0xfffffffe, v75
    buffer_store_dwordx4 v[72:75], v13, s[8:11], s34 offen sc1
    v_mov_b32 v64, 0
    v_mov_b32 v65, 0
    v_mov_b32 v66, 0
    v_mov_b32 v67, 0
    v_mov_b32 v68, 0
    v_mov_b32 v69, 0
    v_mov_b32 v70, 0
    v_mov_b32 v71, 0
    s_waitcnt vmcnt(0)
.pl_32:
    buffer_load_dwordx4 v[76:79], v13, s[8:11], s38 offen sc1
    buffer_load_dwordx4 v[80:83], v13, s[8:11], s39 offen sc1
    buffer_load_dwordx4 v[84:87], v13, s[8:11], s40 offen sc1
    s_waitcnt vmcnt(2)
    v_pk_add_f32 v[88:89], v[72:73], v[76:77]
    v_pk_add_f32 v[90:91], v[74:75], v[78:79]
    s_waitcnt vmcnt(0)
    v_max3_u32 v18, v79, v83, v87
    v_cmp_eq_u32 vcc, -1, v18
    v_pk_add_f32 v[80:81], v[80:81], v[84:85]
    v_pk_add_f32 v[82:83], v[82:83], v[86:87]
    v_pk_add_f32 v[88:89], v[88:89], v[80:81]
    v_pk_add_f32 v[90:91], v[90:91], v[82:83]
    v_cvt_pk_bf16_f32 v92, v88, v89
    v_cvt_pk_bf16_f32 v93, v90, v91
    v_min_u32 v93, 0xfffffffe, v93
    s_cbranch_vccnz .pr_33
    buffer_store_dwordx2 v[92:93], v14, s[8:11], s31 offen
    s_mov_b32 s4, s30
    s_mov_b32 s30, s31
    s_mov_b32 s31, s32
    s_mov_b32 s32, s33
    s_mov_b32 s33, s4
    s_add_u32 s28, s28, 1
    s_mov_b32 s62, 0
    s_mov_b32 s4, s34
    s_mov_b32 s34, s35
    s_mov_b32 s35, s36
    s_mov_b32 s36, s37
    s_mov_b32 s37, s4
    s_branch .step_30
.fin_31:
    s_barrier
    s_waitcnt vmcnt(0)
    s_endpgm
.pr_33:
    s_add_u32 s62, s62, 1
    s_cmp_gt_u32 s62, 0x100000
    s_cbranch_scc1 .mg_end_1
    s_branch .pl_32
.w2_20:
    s_lshl_b32 s4, s56, 9
    s_lshl_b32 s5, s53, 7
    s_add_u32 s4, s4, s5
    s_add_u32 s4, s4, 92274688
    v_mov_b32 v14, s4
    v_bfe_u32 v254, v1, 0, 6
    v_mul_u32_u24 v12, 16, v254
    v_add_u32 v12, 18176, v12
    v_bfe_u32 v254, v1, 0, 6
    v_mul_u32_u24 v15, 16, v254
    s_add_u32 s42, s42, 262144
    s_add_u32 s43, s43, 262144
    s_add_u32 s44, s44, 262144
    s_mov_b32 exec_hi, 0
    v_xor_b32 v244, 1024, v244
    s_mov_b32 exec_hi, -1
    buffer_load_dwordx4 v[24:27], v246, s[8:11], s32 offen sc1
    buffer_load_dwordx4 v[28:31], v245, s[8:11], s32 offen sc1
    buffer_load_dword v32, v237, s[8:11], s32 offen sc1
    s_waitcnt vmcnt(0)
    ds_read_b64_tr_b16 a[192:193], v242 offset:16384
    ds_read_b64_tr_b16 a[194:195], v242 offset:16896
    ds_read_b64_tr_b16 a[196:197], v242 offset:18432
    ds_read_b64_tr_b16 a[198:199], v242 offset:18944
    ds_read_b64_tr_b16 a[200:201], v242 offset:20480
    ds_read_b64_tr_b16 a[202:203], v242 offset:20992
    ds_read_b64_tr_b16 a[204:205], v242 offset:22528
    ds_read_b64_tr_b16 a[206:207], v242 offset:23040
    ds_read_b64_tr_b16 a[208:209], v242 offset:24576
    ds_read_b64_tr_b16 a[210:211], v242 offset:25088
    ds_read_b64_tr_b16 a[212:213], v242 offset:26624
    ds_read_b64_tr_b16 a[214:215], v242 offset:27136
    ds_read_b64_tr_b16 a[216:217], v242 offset:28672
    ds_read_b64_tr_b16 a[218:219], v242 offset:29184
    ds_read_b64_tr_b16 a[220:221], v242 offset:30720
    ds_read_b64_tr_b16 a[222:223], v242 offset:31232
    ds_read_b64_tr_b16 a[224:225], v243 offset:16384
    ds_read_b64_tr_b16 a[226:227], v243 offset:16896
    ds_read_b64_tr_b16 a[228:229], v243 offset:18432
    ds_read_b64_tr_b16 a[230:231], v243 offset:18944
    ds_read_b64_tr_b16 a[232:233], v243 offset:20480
    ds_read_b64_tr_b16 a[234:235], v243 offset:20992
    ds_read_b64_tr_b16 a[236:237], v243 offset:22528
    ds_read_b64_tr_b16 a[238:239], v243 offset:23040
    ds_read_b64_tr_b16 a[240:241], v243 offset:24576
    ds_read_b64_tr_b16 a[242:243], v243 offset:25088
    ds_read_b64_tr_b16 a[244:245], v243 offset:26624
    ds_read_b64_tr_b16 a[246:247], v243 offset:27136
    ds_read_b64_tr_b16 a[248:249], v243 offset:28672
    ds_read_b64_tr_b16 a[250:251], v243 offset:29184
    ds_read_b64_tr_b16 a[252:253], v243 offset:30720
    ds_read_b64_tr_b16 a[254:255], v243 offset:31232
    s_waitcnt lgkmcnt(0)
    s_barrier
.p2align 6
.step_34:
    s_barrier
    s_setprio 3
    buffer_load_dwordx4 v[24:27], v3, s[8:11], s30 offen offset:0 sc1
    s_setprio 2
    buffer_load_dwordx4 v[28:31], v3, s[8:11], s30 offen offset:1024 sc1
    s_setprio 1
    buffer_load_dwordx4 v[32:35], v3, s[8:11], s30 offen offset:2048 sc1
    s_setprio 0
    buffer_load_dwordx4 v[36:39], v3, s[8:11], s30 offen offset:3072 sc1
    s_call_b64 s[98:99], .gm_22
    v_permlane32_swap_b32 v40, v44
    v_permlane32_swap_b32 v41, v45
    v_permlane32_swap_b32 v42, v46
    v_permlane32_swap_b32 v43, v47
    v_add_f32 v40, v40, v44
    v_add_f32 v41, v41, v45
    v_add_f32 v42, v42, v46
    v_add_f32 v43, v43, v47
    ds_write2_b32 v5, v40, v41 offset0:0 offset1:36
    ds_write2_b32 v5, v42, v43 offset0:72 offset1:108
    v_permlane32_swap_b32 v48, v52
    v_permlane32_swap_b32 v49, v53
    v_permlane32_swap_b32 v50, v54
    v_permlane32_swap_b32 v51, v55
    v_pk_add_f32 v[48:49], v[48:49], v[52:53]
    v_pk_add_f32 v[50:51], v[50:51], v[54:55]
    ds_write2_b32 v6, v48, v49 offset0:0 offset1:36
    ds_write2_b32 v6, v50, v51 offset0:72 offset1:108
    s_waitcnt lgkmcnt(2)
    s_barrier
    s_waitcnt lgkmcnt(0)
    s_barrier
    v_smfmac_f32_16x16x64_bf16 v[56:59], v[24:27], a[128:135], v2
    v_smfmac_f32_16x16x64_bf16 v[60:63], v[24:27], a[160:167], v2
    v_smfmac_f32_16x16x64_bf16 v[56:59], v[28:31], a[136:143], v2
    v_smfmac_f32_16x16x64_bf16 v[60:63], v[28:31], a[168:175], v2
    v_smfmac_f32_16x16x64_bf16 v[56:59], v[32:35], a[144:151], v2
    v_smfmac_f32_16x16x64_bf16 v[60:63], v[32:35], a[176:183], v2
    v_smfmac_f32_16x16x64_bf16 v[56:59], v[36:39], a[152:159], v2
    v_smfmac_f32_16x16x64_bf16 v[60:63], v[36:39], a[184:191], v2
    ds_read_b64 v[72:73], v9 offset:0
    ds_read_b64 v[74:75], v9 offset:1152
    ds_read_b64 v[76:77], v9 offset:2304
    ds_read_b64 v[78:79], v9 offset:3456
    s_waitcnt lgkmcnt(0)
    v_pk_add_f32 v[72:73], v[72:73], v[74:75]
    v_pk_add_f32 v[76:77], v[76:77], v[78:79]
    v_pk_add_f32 v[72:73], v[72:73], v[76:77]
    v_cvt_pk_bf16_f32 v72, v72, v73
    ds_write_b32 v11, v72
    v_mov_b32 v40, 0
    v_mov_b32 v41, 0
    v_mov_b32 v42, 0
    v_mov_b32 v43, 0
    v_mov_b32 v44, 0
    v_mov_b32 v45, 0
    v_mov_b32 v46, 0
    v_mov_b32 v47, 0
    v_permlane32_swap_b32 v56, v60
    v_permlane32_swap_b32 v57, v61
    v_permlane32_swap_b32 v58, v62
    v_permlane32_swap_b32 v59, v63
    v_pk_add_f32 v[56:57], v[56:57], v[60:61]
    v_pk_add_f32 v[58:59], v[58:59], v[62:63]
    v_cvt_pk_bf16_f32 v60, v56, v57
    v_cvt_pk_bf16_f32 v61, v58, v59
    ds_write2_b32 v255, v60, v61 offset0:0 offset1:64
    ds_write_b128 v8, v[56:59]
    s_waitcnt lgkmcnt(0)
    s_barrier
    s_cmp_eq_u32 s28, 63
    s_cbranch_scc1 .fin_35
    s_waitcnt lgkmcnt(0)
    v_mov_b32 v48, 0
    v_mov_b32 v49, 0
    v_mov_b32 v50, 0
    v_mov_b32 v51, 0
    v_mov_b32 v52, 0
    v_mov_b32 v53, 0
    v_mov_b32 v54, 0
    v_mov_b32 v55, 0
    v_mov_b32 v56, 0
    v_mov_b32 v57, 0
    v_mov_b32 v58, 0
    v_mov_b32 v59, 0
    v_mov_b32 v60, 0
    v_mov_b32 v61, 0
    v_mov_b32 v62, 0
    v_mov_b32 v63, 0
    s_barrier
    ds_read_b128 v[72:75], v12
    s_setprio 3
    buffer_load_dwordx4 v[24:27], v4, s[8:11], s30 offen offset:0 sc1
    s_setprio 2
    buffer_load_dwordx4 v[28:31], v4, s[8:11], s30 offen offset:1024 sc1
    s_setprio 1
    buffer_load_dwordx4 v[32:35], v4, s[8:11], s30 offen offset:2048 sc1
    s_setprio 0
    buffer_load_dwordx4 v[36:39], v4, s[8:11], s30 offen offset:3072 sc1
    s_call_b64 s[98:99], .gm_23
    s_waitcnt lgkmcnt(0)
    buffer_store_dwordx4 v[72:75], v244, s[8:11], s41 offen sc1
    s_nop 5
    v_permlane32_swap_b32 v64, v68
    v_permlane32_swap_b32 v65, v69
    v_permlane32_swap_b32 v66, v70
    v_permlane32_swap_b32 v67, v71
    v_pk_add_f32 v[64:65], v[64:65], v[68:69]
    v_pk_add_f32 v[66:67], v[66:67], v[70:71]
    ds_write2_b32 v7, v64, v65 offset0:0 offset1:36
    ds_write2_b32 v7, v66, v67 offset0:72 offset1:108
    s_waitcnt lgkmcnt(0)
    s_barrier
    s_cmp_lt_u32 s28, 52
    s_cselect_b32 s4, 1, 0
    s_andn2_b32 s4, s4, s28
    s_cbranch_scc1 .nl_36
    v_mov_b32 v18, s28
    v_add_u32 v18, 1, v18
    s_mov_b64 exec, 1
    s_waitcnt vmcnt(0)
    buffer_store_dword v18, v14, s[8:11], 0 offen sc1
    s_mov_b64 exec, -1
.nl_36:
    v_mov_b32 v64, 0
    v_mov_b32 v65, 0
    v_mov_b32 v66, 0
    v_mov_b32 v67, 0
    v_mov_b32 v68, 0
    v_mov_b32 v69, 0
    v_mov_b32 v70, 0
    v_mov_b32 v71, 0
    s_mov_b32 s4, s30
    s_mov_b32 s30, s31
    s_mov_b32 s31, s32
    s_mov_b32 s32, s33
    s_mov_b32 s33, s4
    s_add_u32 s28, s28, 1
    s_mov_b32 s62, 0
    s_add_u32 s41, s41, 0x20000
    s_branch .step_34
.fin_35:
    s_barrier
    ds_read_b128 v[72:75], v12
    s_waitcnt lgkmcnt(0)
    buffer_store_dwordx4 v[72:75], v244, s[8:11], s41 offen sc1
    s_waitcnt vmcnt(0)
    v_mov_b32 v18, 64
    s_mov_b64 exec, 1
    buffer_store_dword v18, v14, s[8:11], 0 offen sc1
    s_mov_b64 exec, -1
    s_endpgm
.w3_21:
    v_bfe_u32 v254, v1, 3, 1
    v_mul_u32_u24 v12, 512, v254
    v_bfe_u32 v254, v1, 5, 1
    v_mul_u32_u24 v254, 256, v254
    v_add_u32 v12, v12, v254
    v_bfe_u32 v254, v1, 2, 1
    v_mul_u32_u24 v254, 128, v254
    v_add_u32 v12, v12, v254
    v_bfe_u32 v254, v1, 0, 2
    v_mul_u32_u24 v254, 16, v254
    v_add_u32 v12, v12, v254
    v_bfe_u32 v254, v1, 4, 1
    v_mul_u32_u24 v254, 8, v254
    v_add_u32 v12, v12, v254
    v_add_u32 v12, 14080, v12
    v_bfe_u32 v254, v1, 2, 2
    v_mul_u32_u24 v14, 128, v254
    v_bfe_u32 v254, v1, 0, 2
    v_mul_u32_u24 v254, 16, v254
    v_add_u32 v14, v14, v254
    v_bfe_u32 v254, v1, 4, 2
    v_mul_u32_u24 v254, 4, v254
    v_add_u32 v14, v14, v254
    v_add_u32 v14, 18688, v14
    v_bfe_u32 v254, v1, 0, 6
    v_mul_u32_u24 v15, 16, v254
    v_add_u32 v15, s101, v15
    v_bfe_u32 v254, v1, 2, 2
    v_mul_u32_u24 v16, 128, v254
    v_bfe_u32 v254, v1, 0, 2
    v_mul_u32_u24 v254, 16, v254
    v_add_u32 v16, v16, v254
    v_bfe_u32 v254, v1, 4, 2
    v_mul_u32_u24 v254, 4, v254
    v_add_u32 v16, v16, v254
    v_add_u32 v16, 135168, v16
    v_add_u32 v16, s58, v16
    s_lshl_b32 s4, s56, 9
    s_add_u32 s4, s4, 92291072
    v_bfe_u32 v254, v1, 0, 2
    v_mul_u32_u24 v13, 128, v254
    v_bfe_u32 v254, v1, 2, 1
    v_mul_u32_u24 v254, 16384, v254
    v_add_u32 v13, v13, v254
    v_add_u32 v13, s4, v13
    buffer_load_dwordx4 v[24:27], v246, s[8:11], s33 offen sc1
    buffer_load_dwordx4 v[28:31], v245, s[8:11], s33 offen sc1
    buffer_load_dword v32, v237, s[8:11], s33 offen sc1
    s_waitcnt vmcnt(0)
    ds_read_b64_tr_b16 a[192:193], v242 offset:16384
    ds_read_b64_tr_b16 a[194:195], v242 offset:16896
    ds_read_b64_tr_b16 a[196:197], v242 offset:18432
    ds_read_b64_tr_b16 a[198:199], v242 offset:18944
    ds_read_b64_tr_b16 a[200:201], v242 offset:20480
    ds_read_b64_tr_b16 a[202:203], v242 offset:20992
    ds_read_b64_tr_b16 a[204:205], v242 offset:22528
    ds_read_b64_tr_b16 a[206:207], v242 offset:23040
    ds_read_b64_tr_b16 a[208:209], v242 offset:24576
    ds_read_b64_tr_b16 a[210:211], v242 offset:25088
    ds_read_b64_tr_b16 a[212:213], v242 offset:26624
    ds_read_b64_tr_b16 a[214:215], v242 offset:27136
    ds_read_b64_tr_b16 a[216:217], v242 offset:28672
    ds_read_b64_tr_b16 a[218:219], v242 offset:29184
    ds_read_b64_tr_b16 a[220:221], v242 offset:30720
    ds_read_b64_tr_b16 a[222:223], v242 offset:31232
    ds_read_b64_tr_b16 a[224:225], v243 offset:16384
    ds_read_b64_tr_b16 a[226:227], v243 offset:16896
    ds_read_b64_tr_b16 a[228:229], v243 offset:18432
    ds_read_b64_tr_b16 a[230:231], v243 offset:18944
    ds_read_b64_tr_b16 a[232:233], v243 offset:20480
    ds_read_b64_tr_b16 a[234:235], v243 offset:20992
    ds_read_b64_tr_b16 a[236:237], v243 offset:22528
    ds_read_b64_tr_b16 a[238:239], v243 offset:23040
    ds_read_b64_tr_b16 a[240:241], v243 offset:24576
    ds_read_b64_tr_b16 a[242:243], v243 offset:25088
    ds_read_b64_tr_b16 a[244:245], v243 offset:26624
    ds_read_b64_tr_b16 a[246:247], v243 offset:27136
    ds_read_b64_tr_b16 a[248:249], v243 offset:28672
    ds_read_b64_tr_b16 a[250:251], v243 offset:29184
    ds_read_b64_tr_b16 a[252:253], v243 offset:30720
    ds_read_b64_tr_b16 a[254:255], v243 offset:31232
    s_waitcnt lgkmcnt(0)
    s_cmp_ge_u32 s46, 1
    s_cbranch_scc1 .kvd_38
    s_mov_b32 s62, 0
.kv_37:
    buffer_load_dword v18, v13, s[8:11], 0 offen sc1
    s_add_u32 s62, s62, 1
    s_cmp_gt_u32 s62, 0x100000
    s_cbranch_scc1 .mg_end_1
    s_waitcnt vmcnt(0)
    v_min_u32_dpp v18, v18, v18 quad_perm:[1,0,3,2] row_mask:0xf bank_mask:0xf
    s_nop 1
    v_min_u32_dpp v18, v18, v18 quad_perm:[2,3,0,1] row_mask:0xf bank_mask:0xf
    s_nop 1
    v_min_u32_dpp v18, v18, v18 row_half_mirror row_mask:0xf bank_mask:0xf
    s_nop 0
    v_readfirstlane_b32 s46, v18
    s_cmp_lt_u32 s46, 1
    s_cbranch_scc1 .kv_37
.kvd_38:
    s_barrier
.p2align 6
.step_39:
    s_barrier
    s_setprio 3
    buffer_load_dwordx4 v[24:27], v3, s[8:11], s30 offen offset:0 sc1
    s_setprio 2
    buffer_load_dwordx4 v[28:31], v3, s[8:11], s30 offen offset:1024 sc1
    s_setprio 1
    buffer_load_dwordx4 v[32:35], v3, s[8:11], s30 offen offset:2048 sc1
    s_setprio 0
    buffer_load_dwordx4 v[36:39], v3, s[8:11], s30 offen offset:3072 sc1
    s_call_b64 s[98:99], .gm_22
    v_permlane32_swap_b32 v40, v44
    v_permlane32_swap_b32 v41, v45
    v_permlane32_swap_b32 v42, v46
    v_permlane32_swap_b32 v43, v47
    v_add_f32 v40, v40, v44
    v_add_f32 v41, v41, v45
    v_add_f32 v42, v42, v46
    v_add_f32 v43, v43, v47
    ds_write2_b32 v5, v40, v41 offset0:0 offset1:36
    ds_write2_b32 v5, v42, v43 offset0:72 offset1:108
    v_permlane32_swap_b32 v48, v52
    v_permlane32_swap_b32 v49, v53
    v_permlane32_swap_b32 v50, v54
    v_permlane32_swap_b32 v51, v55
    v_pk_add_f32 v[48:49], v[48:49], v[52:53]
    v_pk_add_f32 v[50:51], v[50:51], v[54:55]
    ds_write2_b32 v6, v48, v49 offset0:0 offset1:36
    ds_write2_b32 v6, v50, v51 offset0:72 offset1:108
    s_waitcnt lgkmcnt(2)
    s_barrier
    s_waitcnt lgkmcnt(0)
    s_barrier
    v_smfmac_f32_16x16x64_bf16 v[56:59], v[24:27], a[128:135], v2
    v_smfmac_f32_16x16x64_bf16 v[60:63], v[24:27], a[160:167], v2
    v_smfmac_f32_16x16x64_bf16 v[56:59], v[28:31], a[136:143], v2
    v_smfmac_f32_16x16x64_bf16 v[60:63], v[28:31], a[168:175], v2
    v_smfmac_f32_16x16x64_bf16 v[56:59], v[32:35], a[144:151], v2
    v_smfmac_f32_16x16x64_bf16 v[60:63], v[32:35], a[176:183], v2
    v_smfmac_f32_16x16x64_bf16 v[56:59], v[36:39], a[152:159], v2
    v_smfmac_f32_16x16x64_bf16 v[60:63], v[36:39], a[184:191], v2
    ds_read_b64 v[72:73], v9 offset:0
    ds_read_b64 v[74:75], v9 offset:1152
    ds_read_b64 v[76:77], v9 offset:2304
    ds_read_b64 v[78:79], v9 offset:3456
    s_waitcnt lgkmcnt(0)
    v_pk_add_f32 v[72:73], v[72:73], v[74:75]
    v_pk_add_f32 v[76:77], v[76:77], v[78:79]
    v_pk_add_f32 v[72:73], v[72:73], v[76:77]
    v_cvt_pk_bf16_f32 v72, v72, v73
    ds_write_b32 v11, v72
    v_mov_b32 v40, 0
    v_mov_b32 v41, 0
    v_mov_b32 v42, 0
    v_mov_b32 v43, 0
    v_mov_b32 v44, 0
    v_mov_b32 v45, 0
    v_mov_b32 v46, 0
    v_mov_b32 v47, 0
    v_permlane32_swap_b32 v56, v60
    v_permlane32_swap_b32 v57, v61
    v_permlane32_swap_b32 v58, v62
    v_permlane32_swap_b32 v59, v63
    v_pk_add_f32 v[56:57], v[56:57], v[60:61]
    v_pk_add_f32 v[58:59], v[58:59], v[62:63]
    v_cvt_pk_bf16_f32 v60, v56, v57
    v_cvt_pk_bf16_f32 v61, v58, v59
    ds_write2_b32 v255, v60, v61 offset0:0 offset1:64
    ds_write_b128 v8, v[56:59]
    s_waitcnt lgkmcnt(0)
    s_barrier
    ds_read_b64 v[72:73], v12 offset:0
    ds_read_b64 v[74:75], v12 offset:1024
    ds_read_b64 v[76:77], v12 offset:2048
    ds_read_b64 v[78:79], v12 offset:3072
    ds_read_b64 v[80:81], v12 offset:64
    ds_read_b64 v[82:83], v12 offset:1088
    ds_read_b64 v[84:85], v12 offset:2112
    ds_read_b64 v[86:87], v12 offset:3136
    s_waitcnt lgkmcnt(4)
    v_add_f32 v72, v72, v74
    v_add_f32 v73, v73, v75
    v_add_f32 v76, v76, v78
    v_add_f32 v77, v77, v79
    v_add_f32 v72, v72, v76
    v_add_f32 v73, v73, v77
    v_cvt_pk_bf16_f32 v72, v72, v73
    s_waitcnt lgkmcnt(0)
    v_add_f32 v80, v80, v82
    v_add_f32 v81, v81, v83
    v_add_f32 v84, v84, v86
    v_add_f32 v85, v85, v87
    v_add_f32 v80, v80, v84
    v_add_f32 v81, v81, v85
    v_cvt_pk_bf16_f32 v80, v80, v81
    ds_write_b32 v14, v72
    ds_write_b32 v14, v80 offset:64
    s_waitcnt lgkmcnt(0)
    s_cmp_eq_u32 s28, 63
    s_cbranch_scc1 .fin_40
    buffer_store_dwordx4 v[20:23], v246, s[8:11], s32 offen
    buffer_store_dwordx4 v[20:23], v245, s[8:11], s32 offen
    buffer_store_dword v20, v237, s[8:11], s32 offen
    s_add_u32 s5, s28, 2
    s_cmp_ge_u32 s46, s5
    s_cbranch_scc1 .kvd_42
    s_mov_b32 s62, 0
.kv_41:
    buffer_load_dword v18, v13, s[8:11], 0 offen sc1
    s_add_u32 s62, s62, 1
    s_cmp_gt_u32 s62, 0x100000
    s_cbranch_scc1 .mg_end_1
    s_waitcnt vmcnt(0)
    v_min_u32_dpp v18, v18, v18 quad_perm:[1,0,3,2] row_mask:0xf bank_mask:0xf
    s_nop 1
    v_min_u32_dpp v18, v18, v18 quad_perm:[2,3,0,1] row_mask:0xf bank_mask:0xf
    s_nop 1
    v_min_u32_dpp v18, v18, v18 row_half_mirror row_mask:0xf bank_mask:0xf
    s_nop 0
    v_readfirstlane_b32 s46, v18
    s_cmp_lt_u32 s46, s5
    s_cbranch_scc1 .kv_41
.kvd_42:
    v_mov_b32 v48, 0
    v_mov_b32 v49, 0
    v_mov_b32 v50, 0
    v_mov_b32 v51, 0
    v_mov_b32 v52, 0
    v_mov_b32 v53, 0
    v_mov_b32 v54, 0
    v_mov_b32 v55, 0
    v_mov_b32 v56, 0
    v_mov_b32 v57, 0
    v_mov_b32 v58, 0
    v_mov_b32 v59, 0
    v_mov_b32 v60, 0
    v_mov_b32 v61, 0
    v_mov_b32 v62, 0
    v_mov_b32 v63, 0
    s_barrier
    s_setprio 3
    buffer_load_dwordx4 v[24:27], v4, s[8:11], s30 offen offset:0 sc1
    s_setprio 2
    buffer_load_dwordx4 v[28:31], v4, s[8:11], s30 offen offset:1024 sc1
    s_setprio 1
    buffer_load_dwordx4 v[32:35], v4, s[8:11], s30 offen offset:2048 sc1
    s_setprio 0
    buffer_load_dwordx4 v[36:39], v4, s[8:11], s30 offen offset:3072 sc1
    s_call_b64 s[98:99], .gm_23
    buffer_store_dwordx4 v[20:23], v15, s[8:11], s36 offen sc1
    s_nop 5
    v_permlane32_swap_b32 v64, v68
    v_permlane32_swap_b32 v65, v69
    v_permlane32_swap_b32 v66, v70
    v_permlane32_swap_b32 v67, v71
    v_pk_add_f32 v[64:65], v[64:65], v[68:69]
    v_pk_add_f32 v[66:67], v[66:67], v[70:71]
    ds_write2_b32 v7, v64, v65 offset0:0 offset1:36
    ds_write2_b32 v7, v66, v67 offset0:72 offset1:108
    s_waitcnt lgkmcnt(0)
    s_barrier
    s_add_u32 s5, s28, 3
    s_min_u32 s5, s5, 64
    s_cmp_ge_u32 s46, s5
    s_cbranch_scc1 .kvd_44
    s_mov_b32 s62, 0
.kv_43:
    buffer_load_dword v18, v13, s[8:11], 0 offen sc1
    s_add_u32 s62, s62, 1
    s_cmp_gt_u32 s62, 0x100000
    s_cbranch_scc1 .mg_end_1
    s_waitcnt vmcnt(0)
    v_min_u32_dpp v18, v18, v18 quad_perm:[1,0,3,2] row_mask:0xf bank_mask:0xf
    s_nop 1
    v_min_u32_dpp v18, v18, v18 quad_perm:[2,3,0,1] row_mask:0xf bank_mask:0xf
    s_nop 1
    v_min_u32_dpp v18, v18, v18 row_half_mirror row_mask:0xf bank_mask:0xf
    s_nop 0
    v_readfirstlane_b32 s46, v18
.kvd_44:
    v_mov_b32 v64, 0
    v_mov_b32 v65, 0
    v_mov_b32 v66, 0
    v_mov_b32 v67, 0
    v_mov_b32 v68, 0
    v_mov_b32 v69, 0
    v_mov_b32 v70, 0
    v_mov_b32 v71, 0
    s_mov_b32 s4, s30
    s_mov_b32 s30, s31
    s_mov_b32 s31, s32
    s_mov_b32 s32, s33
    s_mov_b32 s33, s4
    s_add_u32 s28, s28, 1
    s_mov_b32 s62, 0
    s_mov_b32 s4, s34
    s_mov_b32 s34, s35
    s_mov_b32 s35, s36
    s_mov_b32 s36, s37
    s_mov_b32 s37, s4
    s_add_u32 s41, s41, 0x20000
    s_branch .step_39
.fin_40:
    s_barrier
    s_endpgm
.p2align 6
.gm_22:
    s_waitcnt vmcnt(3)
    v_max_u32 v18, v25, v27
    v_cmp_eq_u32 vcc, -1, v18
    s_cbranch_vccnz .nk_45
.ok_46:
    v_smfmac_f32_16x16x64_bf16 v[40:43], v[24:27], a[0:7], v2
    v_smfmac_f32_16x16x64_bf16 v[44:47], v[24:27], a[32:39], v2
    s_waitcnt vmcnt(2)
    v_max_u32 v18, v29, v31
    v_cmp_eq_u32 vcc, -1, v18
    v_smfmac_f32_16x16x64_bf16 v[48:51], v[24:27], a[64:71], v2
    v_smfmac_f32_16x16x64_bf16 v[52:55], v[24:27], a[96:103], v2
    s_cbranch_vccnz .nk_47
.ok_48:
    v_smfmac_f32_16x16x64_bf16 v[40:43], v[28:31], a[8:15], v2
    v_smfmac_f32_16x16x64_bf16 v[44:47], v[28:31], a[40:47], v2
    s_waitcnt vmcnt(1)
    v_max_u32 v18, v33, v35
    v_cmp_eq_u32 vcc, -1, v18
    v_smfmac_f32_16x16x64_bf16 v[48:51], v[28:31], a[72:79], v2
    v_smfmac_f32_16x16x64_bf16 v[52:55], v[28:31], a[104:111], v2
    s_cbranch_vccnz .nk_49
.ok_50:
    v_smfmac_f32_16x16x64_bf16 v[40:43], v[32:35], a[16:23], v2
    v_smfmac_f32_16x16x64_bf16 v[44:47], v[32:35], a[48:55], v2
    s_waitcnt vmcnt(0)
    v_max_u32 v18, v37, v39
    v_cmp_eq_u32 vcc, -1, v18
    v_smfmac_f32_16x16x64_bf16 v[48:51], v[32:35], a[80:87], v2
    v_smfmac_f32_16x16x64_bf16 v[52:55], v[32:35], a[112:119], v2
    s_cbranch_vccnz .nk_51
.ok_52:
    v_smfmac_f32_16x16x64_bf16 v[40:43], v[36:39], a[24:31], v2
    v_smfmac_f32_16x16x64_bf16 v[44:47], v[36:39], a[56:63], v2
    v_smfmac_f32_16x16x64_bf16 v[48:51], v[36:39], a[88:95], v2
    v_smfmac_f32_16x16x64_bf16 v[52:55], v[36:39], a[120:127], v2
    s_setpc_b64 s[98:99]
.nk_45:
    buffer_load_dwordx4 v[24:27], v3, s[8:11], s30 offen offset:0 sc1
    s_add_u32 s62, s62, 1
    s_cmp_gt_u32 s62, 0x100000
    s_cbranch_scc1 .mg_end_1
    s_waitcnt vmcnt(3)
    v_max_u32 v18, v29, v31
    v_cmp_eq_u32 vcc, -1, v18
    s_cbranch_vccnz .nk_53
.ok_54:
    v_smfmac_f32_16x16x64_bf16 v[40:43], v[28:31], a[8:15], v2
    v_smfmac_f32_16x16x64_bf16 v[44:47], v[28:31], a[40:47], v2
    s_waitcnt vmcnt(2)
    v_max_u32 v18, v33, v35
    v_cmp_eq_u32 vcc, -1, v18
    v_smfmac_f32_16x16x64_bf16 v[48:51], v[28:31], a[72:79], v2
    v_smfmac_f32_16x16x64_bf16 v[52:55], v[28:31], a[104:111], v2
    s_cbranch_vccnz .nk_55
.ok_56:
    v_smfmac_f32_16x16x64_bf16 v[40:43], v[32:35], a[16:23], v2
    v_smfmac_f32_16x16x64_bf16 v[44:47], v[32:35], a[48:55], v2
    s_waitcnt vmcnt(1)
    v_max_u32 v18, v37, v39
    v_cmp_eq_u32 vcc, -1, v18
    v_smfmac_f32_16x16x64_bf16 v[48:51], v[32:35], a[80:87], v2
    v_smfmac_f32_16x16x64_bf16 v[52:55], v[32:35], a[112:119], v2
    s_cbranch_vccnz .nk_57
.ok_58:
    v_smfmac_f32_16x16x64_bf16 v[40:43], v[36:39], a[24:31], v2
    v_smfmac_f32_16x16x64_bf16 v[44:47], v[36:39], a[56:63], v2
    s_waitcnt vmcnt(0)
    v_max_u32 v18, v25, v27
    v_cmp_eq_u32 vcc, -1, v18
    v_smfmac_f32_16x16x64_bf16 v[48:51], v[36:39], a[88:95], v2
    v_smfmac_f32_16x16x64_bf16 v[52:55], v[36:39], a[120:127], v2
    s_cbranch_vccnz .nk_59
.ok_60:
    v_smfmac_f32_16x16x64_bf16 v[40:43], v[24:27], a[0:7], v2
    v_smfmac_f32_16x16x64_bf16 v[44:47], v[24:27], a[32:39], v2
    v_smfmac_f32_16x16x64_bf16 v[48:51], v[24:27], a[64:71], v2
    v_smfmac_f32_16x16x64_bf16 v[52:55], v[24:27], a[96:103], v2
    s_setpc_b64 s[98:99]
.nk_47:
    buffer_load_dwordx4 v[28:31], v3, s[8:11], s30 offen offset:1024 sc1
    s_add_u32 s62, s62, 1
    s_cmp_gt_u32 s62, 0x100000
    s_cbranch_scc1 .mg_end_1
    s_waitcnt vmcnt(2)
    v_max_u32 v18, v33, v35
    v_cmp_eq_u32 vcc, -1, v18
    s_cbranch_vccnz .nk_61
.ok_62:
    v_smfmac_f32_16x16x64_bf16 v[40:43], v[32:35], a[16:23], v2
    v_smfmac_f32_16x16x64_bf16 v[44:47], v[32:35], a[48:55], v2
    s_waitcnt vmcnt(1)
    v_max_u32 v18, v37, v39
    v_cmp_eq_u32 vcc, -1, v18
    v_smfmac_f32_16x16x64_bf16 v[48:51], v[32:35], a[80:87], v2
    v_smfmac_f32_16x16x64_bf16 v[52:55], v[32:35], a[112:119], v2
    s_cbranch_vccnz .nk_63
.ok_64:
    v_smfmac_f32_16x16x64_bf16 v[40:43], v[36:39], a[24:31], v2
    v_smfmac_f32_16x16x64_bf16 v[44:47], v[36:39], a[56:63], v2
    s_waitcnt vmcnt(0)
    v_max_u32 v18, v29, v31
    v_cmp_eq_u32 vcc, -1, v18
    v_smfmac_f32_16x16x64_bf16 v[48:51], v[36:39], a[88:95], v2
    v_smfmac_f32_16x16x64_bf16 v[52:55], v[36:39], a[120:127], v2
    s_cbranch_vccnz .nk_65
.ok_66:
    v_smfmac_f32_16x16x64_bf16 v[40:43], v[28:31], a[8:15], v2
    v_smfmac_f32_16x16x64_bf16 v[44:47], v[28:31], a[40:47], v2
    v_smfmac_f32_16x16x64_bf16 v[48:51], v[28:31], a[72:79], v2
    v_smfmac_f32_16x16x64_bf16 v[52:55], v[28:31], a[104:111], v2
    s_setpc_b64 s[98:99]
.nk_49:
    buffer_load_dwordx4 v[32:35], v3, s[8:11], s30 offen offset:2048 sc1
    s_add_u32 s62, s62, 1
    s_cmp_gt_u32 s62, 0x100000
    s_cbranch_scc1 .mg_end_1
    s_waitcnt vmcnt(1)
    v_max_u32 v18, v37, v39
    v_cmp_eq_u32 vcc, -1, v18
    s_cbranch_vccnz .nk_67
.ok_68:
    v_smfmac_f32_16x16x64_bf16 v[40:43], v[36:39], a[24:31], v2
    v_smfmac_f32_16x16x64_bf16 v[44:47], v[36:39], a[56:63], v2
    s_waitcnt vmcnt(0)
    v_max_u32 v18, v33, v35
    v_cmp_eq_u32 vcc, -1, v18
    v_smfmac_f32_16x16x64_bf16 v[48:51], v[36:39], a[88:95], v2
    v_smfmac_f32_16x16x64_bf16 v[52:55], v[36:39], a[120:127], v2
    s_cbranch_vccnz .nk_69
.ok_70:
    v_smfmac_f32_16x16x64_bf16 v[40:43], v[32:35], a[16:23], v2
    v_smfmac_f32_16x16x64_bf16 v[44:47], v[32:35], a[48:55], v2
    v_smfmac_f32_16x16x64_bf16 v[48:51], v[32:35], a[80:87], v2
    v_smfmac_f32_16x16x64_bf16 v[52:55], v[32:35], a[112:119], v2
    s_setpc_b64 s[98:99]
.nk_51:
    buffer_load_dwordx4 v[36:39], v3, s[8:11], s30 offen offset:3072 sc1
    s_add_u32 s62, s62, 1
    s_cmp_gt_u32 s62, 0x100000
    s_cbranch_scc1 .mg_end_1
    s_waitcnt vmcnt(0)
    v_max_u32 v18, v37, v39
    v_cmp_eq_u32 vcc, -1, v18
    s_cbranch_vccnz .nk_51
    s_branch .ok_52
.nk_53:
    buffer_load_dwordx4 v[28:31], v3, s[8:11], s30 offen offset:1024 sc1
    s_add_u32 s62, s62, 1
    s_cmp_gt_u32 s62, 0x100000
    s_cbranch_scc1 .mg_end_1
    s_waitcnt vmcnt(3)
    v_max_u32 v18, v33, v35
    v_cmp_eq_u32 vcc, -1, v18
    s_cbranch_vccnz .nk_71
.ok_72:
    v_smfmac_f32_16x16x64_bf16 v[40:43], v[32:35], a[16:23], v2
    v_smfmac_f32_16x16x64_bf16 v[44:47], v[32:35], a[48:55], v2
    s_waitcnt vmcnt(2)
    v_max_u32 v18, v37, v39
    v_cmp_eq_u32 vcc, -1, v18
    v_smfmac_f32_16x16x64_bf16 v[48:51], v[32:35], a[80:87], v2
    v_smfmac_f32_16x16x64_bf16 v[52:55], v[32:35], a[112:119], v2
    s_cbranch_vccnz .nk_73
.ok_74:
    v_smfmac_f32_16x16x64_bf16 v[40:43], v[36:39], a[24:31], v2
    v_smfmac_f32_16x16x64_bf16 v[44:47], v[36:39], a[56:63], v2
    s_waitcnt vmcnt(1)
    v_max_u32 v18, v25, v27
    v_cmp_eq_u32 vcc, -1, v18
    v_smfmac_f32_16x16x64_bf16 v[48:51], v[36:39], a[88:95], v2
    v_smfmac_f32_16x16x64_bf16 v[52:55], v[36:39], a[120:127], v2
    s_cbranch_vccnz .nk_75
.ok_76:
    v_smfmac_f32_16x16x64_bf16 v[40:43], v[24:27], a[0:7], v2
    v_smfmac_f32_16x16x64_bf16 v[44:47], v[24:27], a[32:39], v2
    s_waitcnt vmcnt(0)
    v_max_u32 v18, v29, v31
    v_cmp_eq_u32 vcc, -1, v18
    v_smfmac_f32_16x16x64_bf16 v[48:51], v[24:27], a[64:71], v2
    v_smfmac_f32_16x16x64_bf16 v[52:55], v[24:27], a[96:103], v2
    s_cbranch_vccnz .nk_65
    s_branch .ok_66
.nk_55:
    buffer_load_dwordx4 v[32:35], v3, s[8:11], s30 offen offset:2048 sc1
    s_add_u32 s62, s62, 1
    s_cmp_gt_u32 s62, 0x100000
    s_cbranch_scc1 .mg_end_1
    s_waitcnt vmcnt(2)
    v_max_u32 v18, v37, v39
    v_cmp_eq_u32 vcc, -1, v18
    s_cbranch_vccnz .nk_77
.ok_78:
    v_smfmac_f32_16x16x64_bf16 v[40:43], v[36:39], a[24:31], v2
    v_smfmac_f32_16x16x64_bf16 v[44:47], v[36:39], a[56:63], v2
    s_waitcnt vmcnt(1)
    v_max_u32 v18, v25, v27
    v_cmp_eq_u32 vcc, -1, v18
    v_smfmac_f32_16x16x64_bf16 v[48:51], v[36:39], a[88:95], v2
    v_smfmac_f32_16x16x64_bf16 v[52:55], v[36:39], a[120:127], v2
    s_cbranch_vccnz .nk_79
.ok_80:
    v_smfmac_f32_16x16x64_bf16 v[40:43], v[24:27], a[0:7], v2
    v_smfmac_f32_16x16x64_bf16 v[44:47], v[24:27], a[32:39], v2
    s_waitcnt vmcnt(0)
    v_max_u32 v18, v33, v35
    v_cmp_eq_u32 vcc, -1, v18
    v_smfmac_f32_16x16x64_bf16 v[48:51], v[24:27], a[64:71], v2
    v_smfmac_f32_16x16x64_bf16 v[52:55], v[24:27], a[96:103], v2
    s_cbranch_vccnz .nk_69
    s_branch .ok_70
.nk_57:
    buffer_load_dwordx4 v[36:39], v3, s[8:11], s30 offen offset:3072 sc1
    s_add_u32 s62, s62, 1
    s_cmp_gt_u32 s62, 0x100000
    s_cbranch_scc1 .mg_end_1
    s_waitcnt vmcnt(1)
    v_max_u32 v18, v25, v27
    v_cmp_eq_u32 vcc, -1, v18
    s_cbranch_vccnz .nk_81
.ok_82:
    v_smfmac_f32_16x16x64_bf16 v[40:43], v[24:27], a[0:7], v2
    v_smfmac_f32_16x16x64_bf16 v[44:47], v[24:27], a[32:39], v2
    s_waitcnt vmcnt(0)
    v_max_u32 v18, v37, v39
    v_cmp_eq_u32 vcc, -1, v18
    v_smfmac_f32_16x16x64_bf16 v[48:51], v[24:27], a[64:71], v2
    v_smfmac_f32_16x16x64_bf16 v[52:55], v[24:27], a[96:103], v2
    s_cbranch_vccnz .nk_51
    s_branch .ok_52
.nk_59:
    buffer_load_dwordx4 v[24:27], v3, s[8:11], s30 offen offset:0 sc1
    s_add_u32 s62, s62, 1
    s_cmp_gt_u32 s62, 0x100000
    s_cbranch_scc1 .mg_end_1
    s_waitcnt vmcnt(0)
    v_max_u32 v18, v25, v27
    v_cmp_eq_u32 vcc, -1, v18
    s_cbranch_vccnz .nk_59
    s_branch .ok_60
.nk_61:
    buffer_load_dwordx4 v[32:35], v3, s[8:11], s30 offen offset:2048 sc1
    s_add_u32 s62, s62, 1
    s_cmp_gt_u32 s62, 0x100000
    s_cbranch_scc1 .mg_end_1
    s_waitcnt vmcnt(2)
    v_max_u32 v18, v37, v39
    v_cmp_eq_u32 vcc, -1, v18
    s_cbranch_vccnz .nk_83
.ok_84:
    v_smfmac_f32_16x16x64_bf16 v[40:43], v[36:39], a[24:31], v2
    v_smfmac_f32_16x16x64_bf16 v[44:47], v[36:39], a[56:63], v2
    s_waitcnt vmcnt(1)
    v_max_u32 v18, v29, v31
    v_cmp_eq_u32 vcc, -1, v18
    v_smfmac_f32_16x16x64_bf16 v[48:51], v[36:39], a[88:95], v2
    v_smfmac_f32_16x16x64_bf16 v[52:55], v[36:39], a[120:127], v2
    s_cbranch_vccnz .nk_85
.ok_86:
    v_smfmac_f32_16x16x64_bf16 v[40:43], v[28:31], a[8:15], v2
    v_smfmac_f32_16x16x64_bf16 v[44:47], v[28:31], a[40:47], v2
    s_waitcnt vmcnt(0)
    v_max_u32 v18, v33, v35
    v_cmp_eq_u32 vcc, -1, v18
    v_smfmac_f32_16x16x64_bf16 v[48:51], v[28:31], a[72:79], v2
    v_smfmac_f32_16x16x64_bf16 v[52:55], v[28:31], a[104:111], v2
    s_cbranch_vccnz .nk_69
    s_branch .ok_70
.nk_63:
    buffer_load_dwordx4 v[36:39], v3, s[8:11], s30 offen offset:3072 sc1
    s_add_u32 s62, s62, 1
    s_cmp_gt_u32 s62, 0x100000
    s_cbranch_scc1 .mg_end_1
    s_waitcnt vmcnt(1)
    v_max_u32 v18, v29, v31
    v_cmp_eq_u32 vcc, -1, v18
    s_cbranch_vccnz .nk_87
.ok_88:
    v_smfmac_f32_16x16x64_bf16 v[40:43], v[28:31], a[8:15], v2
    v_smfmac_f32_16x16x64_bf16 v[44:47], v[28:31], a[40:47], v2
    s_waitcnt vmcnt(0)
    v_max_u32 v18, v37, v39
    v_cmp_eq_u32 vcc, -1, v18
    v_smfmac_f32_16x16x64_bf16 v[48:51], v[28:31], a[72:79], v2
    v_smfmac_f32_16x16x64_bf16 v[52:55], v[28:31], a[104:111], v2
    s_cbranch_vccnz .nk_51
    s_branch .ok_52
.nk_65:
    buffer_load_dwordx4 v[28:31], v3, s[8:11], s30 offen offset:1024 sc1
    s_add_u32 s62, s62, 1
    s_cmp_gt_u32 s62, 0x100000
    s_cbranch_scc1 .mg_end_1
    s_waitcnt vmcnt(0)
    v_max_u32 v18, v29, v31
    v_cmp_eq_u32 vcc, -1, v18
    s_cbranch_vccnz .nk_65
    s_branch .ok_66
.nk_67:
    buffer_load_dwordx4 v[36:39], v3, s[8:11], s30 offen offset:3072 sc1
    s_add_u32 s62, s62, 1
    s_cmp_gt_u32 s62, 0x100000
    s_cbranch_scc1 .mg_end_1
    s_waitcnt vmcnt(1)
    v_max_u32 v18, v33, v35
    v_cmp_eq_u32 vcc, -1, v18
    s_cbranch_vccnz .nk_49
    s_branch .ok_50
.nk_69:
    buffer_load_dwordx4 v[32:35], v3, s[8:11], s30 offen offset:2048 sc1
    s_add_u32 s62, s62, 1
    s_cmp_gt_u32 s62, 0x100000
    s_cbranch_scc1 .mg_end_1
    s_waitcnt vmcnt(0)
    v_max_u32 v18, v33, v35
    v_cmp_eq_u32 vcc, -1, v18
    s_cbranch_vccnz .nk_69
    s_branch .ok_70
.nk_71:
    buffer_load_dwordx4 v[32:35], v3, s[8:11], s30 offen offset:2048 sc1
    s_add_u32 s62, s62, 1
    s_cmp_gt_u32 s62, 0x100000
    s_cbranch_scc1 .mg_end_1
    s_waitcnt vmcnt(3)
    v_max_u32 v18, v37, v39
    v_cmp_eq_u32 vcc, -1, v18
    s_cbranch_vccnz .nk_89
.ok_90:
    v_smfmac_f32_16x16x64_bf16 v[40:43], v[36:39], a[24:31], v2
    v_smfmac_f32_16x16x64_bf16 v[44:47], v[36:39], a[56:63], v2
    s_waitcnt vmcnt(2)
    v_max_u32 v18, v25, v27
    v_cmp_eq_u32 vcc, -1, v18
    v_smfmac_f32_16x16x64_bf16 v[48:51], v[36:39], a[88:95], v2
    v_smfmac_f32_16x16x64_bf16 v[52:55], v[36:39], a[120:127], v2
    s_cbranch_vccnz .nk_91
.ok_92:
    v_smfmac_f32_16x16x64_bf16 v[40:43], v[24:27], a[0:7], v2
    v_smfmac_f32_16x16x64_bf16 v[44:47], v[24:27], a[32:39], v2
    s_waitcnt vmcnt(1)
    v_max_u32 v18, v29, v31
    v_cmp_eq_u32 vcc, -1, v18
    v_smfmac_f32_16x16x64_bf16 v[48:51], v[24:27], a[64:71], v2
    v_smfmac_f32_16x16x64_bf16 v[52:55], v[24:27], a[96:103], v2
    s_cbranch_vccnz .nk_85
    s_branch .ok_86
.nk_73:
    buffer_load_dwordx4 v[36:39], v3, s[8:11], s30 offen offset:3072 sc1
    s_add_u32 s62, s62, 1
    s_cmp_gt_u32 s62, 0x100000
    s_cbranch_scc1 .mg_end_1
    s_waitcnt vmcnt(2)
    v_max_u32 v18, v25, v27
    v_cmp_eq_u32 vcc, -1, v18
    s_cbranch_vccnz .nk_93
.ok_94:
    v_smfmac_f32_16x16x64_bf16 v[40:43], v[24:27], a[0:7], v2
    v_smfmac_f32_16x16x64_bf16 v[44:47], v[24:27], a[32:39], v2
    s_waitcnt vmcnt(1)
    v_max_u32 v18, v29, v31
    v_cmp_eq_u32 vcc, -1, v18
    v_smfmac_f32_16x16x64_bf16 v[48:51], v[24:27], a[64:71], v2
    v_smfmac_f32_16x16x64_bf16 v[52:55], v[24:27], a[96:103], v2
    s_cbranch_vccnz .nk_87
    s_branch .ok_88
.nk_75:
    buffer_load_dwordx4 v[24:27], v3, s[8:11], s30 offen offset:0 sc1
    s_add_u32 s62, s62, 1
    s_cmp_gt_u32 s62, 0x100000
    s_cbranch_scc1 .mg_end_1
    s_waitcnt vmcnt(1)
    v_max_u32 v18, v29, v31
    v_cmp_eq_u32 vcc, -1, v18
    s_cbranch_vccnz .nk_95
.ok_96:
    v_smfmac_f32_16x16x64_bf16 v[40:43], v[28:31], a[8:15], v2
    v_smfmac_f32_16x16x64_bf16 v[44:47], v[28:31], a[40:47], v2
    s_waitcnt vmcnt(0)
    v_max_u32 v18, v25, v27
    v_cmp_eq_u32 vcc, -1, v18
    v_smfmac_f32_16x16x64_bf16 v[48:51], v[28:31], a[72:79], v2
    v_smfmac_f32_16x16x64_bf16 v[52:55], v[28:31], a[104:111], v2
    s_cbranch_vccnz .nk_59
    s_branch .ok_60
.nk_77:
    buffer_load_dwordx4 v[36:39], v3, s[8:11], s30 offen offset:3072 sc1
    s_add_u32 s62, s62, 1
    s_cmp_gt_u32 s62, 0x100000
    s_cbranch_scc1 .mg_end_1
    s_waitcnt vmcnt(2)
    v_max_u32 v18, v25, v27
    v_cmp_eq_u32 vcc, -1, v18
    s_cbranch_vccnz .nk_97
.ok_98:
    v_smfmac_f32_16x16x64_bf16 v[40:43], v[24:27], a[0:7], v2
    v_smfmac_f32_16x16x64_bf16 v[44:47], v[24:27], a[32:39], v2
    s_waitcnt vmcnt(1)
    v_max_u32 v18, v33, v35
    v_cmp_eq_u32 vcc, -1, v18
    v_smfmac_f32_16x16x64_bf16 v[48:51], v[24:27], a[64:71], v2
    v_smfmac_f32_16x16x64_bf16 v[52:55], v[24:27], a[96:103], v2
    s_cbranch_vccnz .nk_49
    s_branch .ok_50
.nk_79:
    buffer_load_dwordx4 v[24:27], v3, s[8:11], s30 offen offset:0 sc1
    s_add_u32 s62, s62, 1
    s_cmp_gt_u32 s62, 0x100000
    s_cbranch_scc1 .mg_end_1
    s_waitcnt vmcnt(1)
    v_max_u32 v18, v33, v35
    v_cmp_eq_u32 vcc, -1, v18
    s_cbranch_vccnz .nk_99
.ok_100:
    v_smfmac_f32_16x16x64_bf16 v[40:43], v[32:35], a[16:23], v2
    v_smfmac_f32_16x16x64_bf16 v[44:47], v[32:35], a[48:55], v2
    s_waitcnt vmcnt(0)
    v_max_u32 v18, v25, v27
    v_cmp_eq_u32 vcc, -1, v18
    v_smfmac_f32_16x16x64_bf16 v[48:51], v[32:35], a[80:87], v2
    v_smfmac_f32_16x16x64_bf16 v[52:55], v[32:35], a[112:119], v2
    s_cbranch_vccnz .nk_59
    s_branch .ok_60
.nk_81:
    buffer_load_dwordx4 v[24:27], v3, s[8:11], s30 offen offset:0 sc1
    s_add_u32 s62, s62, 1
    s_cmp_gt_u32 s62, 0x100000
    s_cbranch_scc1 .mg_end_1
    s_waitcnt vmcnt(1)
    v_max_u32 v18, v37, v39
    v_cmp_eq_u32 vcc, -1, v18
    s_cbranch_vccnz .nk_57
    s_branch .ok_58
.nk_83:
    buffer_load_dwordx4 v[36:39], v3, s[8:11], s30 offen offset:3072 sc1
    s_add_u32 s62, s62, 1
    s_cmp_gt_u32 s62, 0x100000
    s_cbranch_scc1 .mg_end_1
    s_waitcnt vmcnt(2)
    v_max_u32 v18, v29, v31
    v_cmp_eq_u32 vcc, -1, v18
    s_cbranch_vccnz .nk_47
    s_branch .ok_48
.nk_85:
    buffer_load_dwordx4 v[28:31], v3, s[8:11], s30 offen offset:1024 sc1
    s_add_u32 s62, s62, 1
    s_cmp_gt_u32 s62, 0x100000
    s_cbranch_scc1 .mg_end_1
    s_waitcnt vmcnt(1)
    v_max_u32 v18, v33, v35
    v_cmp_eq_u32 vcc, -1, v18
    s_cbranch_vccnz .nk_101
.ok_102:
    v_smfmac_f32_16x16x64_bf16 v[40:43], v[32:35], a[16:23], v2
    v_smfmac_f32_16x16x64_bf16 v[44:47], v[32:35], a[48:55], v2
    s_waitcnt vmcnt(0)
    v_max_u32 v18, v29, v31
    v_cmp_eq_u32 vcc, -1, v18
    v_smfmac_f32_16x16x64_bf16 v[48:51], v[32:35], a[80:87], v2
    v_smfmac_f32_16x16x64_bf16 v[52:55], v[32:35], a[112:119], v2
    s_cbranch_vccnz .nk_65
    s_branch .ok_66
.nk_87:
    buffer_load_dwordx4 v[28:31], v3, s[8:11], s30 offen offset:1024 sc1
    s_add_u32 s62, s62, 1
    s_cmp_gt_u32 s62, 0x100000
    s_cbranch_scc1 .mg_end_1
    s_waitcnt vmcnt(1)
    v_max_u32 v18, v37, v39
    v_cmp_eq_u32 vcc, -1, v18
    s_cbranch_vccnz .nk_63
    s_branch .ok_64
.nk_89:
    buffer_load_dwordx4 v[36:39], v3, s[8:11], s30 offen offset:3072 sc1
    s_add_u32 s62, s62, 1
    s_cmp_gt_u32 s62, 0x100000
    s_cbranch_scc1 .mg_end_1
    s_waitcnt vmcnt(3)
    v_max_u32 v18, v25, v27
    v_cmp_eq_u32 vcc, -1, v18
    s_cbranch_vccnz .nk_45
    s_branch .ok_46
.nk_91:
    buffer_load_dwordx4 v[24:27], v3, s[8:11], s30 offen offset:0 sc1
    s_add_u32 s62, s62, 1
    s_cmp_gt_u32 s62, 0x100000
    s_cbranch_scc1 .mg_end_1
    s_waitcnt vmcnt(2)
    v_max_u32 v18, v29, v31
    v_cmp_eq_u32 vcc, -1, v18
    s_cbranch_vccnz .nk_103
.ok_104:
    v_smfmac_f32_16x16x64_bf16 v[40:43], v[28:31], a[8:15], v2
    v_smfmac_f32_16x16x64_bf16 v[44:47], v[28:31], a[40:47], v2
    s_waitcnt vmcnt(1)
    v_max_u32 v18, v33, v35
    v_cmp_eq_u32 vcc, -1, v18
    v_smfmac_f32_16x16x64_bf16 v[48:51], v[28:31], a[72:79], v2
    v_smfmac_f32_16x16x64_bf16 v[52:55], v[28:31], a[104:111], v2
    s_cbranch_vccnz .nk_99
    s_branch .ok_100
.nk_93:
    buffer_load_dwordx4 v[24:27], v3, s[8:11], s30 offen offset:0 sc1
    s_add_u32 s62, s62, 1
    s_cmp_gt_u32 s62, 0x100000
    s_cbranch_scc1 .mg_end_1
    s_waitcnt vmcnt(2)
    v_max_u32 v18, v29, v31
    v_cmp_eq_u32 vcc, -1, v18
    s_cbranch_vccnz .nk_105
.ok_106:
    v_smfmac_f32_16x16x64_bf16 v[40:43], v[28:31], a[8:15], v2
    v_smfmac_f32_16x16x64_bf16 v[44:47], v[28:31], a[40:47], v2
    s_waitcnt vmcnt(1)
    v_max_u32 v18, v37, v39
    v_cmp_eq_u32 vcc, -1, v18
    v_smfmac_f32_16x16x64_bf16 v[48:51], v[28:31], a[72:79], v2
    v_smfmac_f32_16x16x64_bf16 v[52:55], v[28:31], a[104:111], v2
    s_cbranch_vccnz .nk_57
    s_branch .ok_58
.nk_95:
    buffer_load_dwordx4 v[28:31], v3, s[8:11], s30 offen offset:1024 sc1
    s_add_u32 s62, s62, 1
    s_cmp_gt_u32 s62, 0x100000
    s_cbranch_scc1 .mg_end_1
    s_waitcnt vmcnt(1)
    v_max_u32 v18, v25, v27
    v_cmp_eq_u32 vcc, -1, v18
    s_cbranch_vccnz .nk_75
    s_branch .ok_76
.nk_97:
    buffer_load_dwordx4 v[24:27], v3, s[8:11], s30 offen offset:0 sc1
    s_add_u32 s62, s62, 1
    s_cmp_gt_u32 s62, 0x100000
    s_cbranch_scc1 .mg_end_1
    s_waitcnt vmcnt(2)
    v_max_u32 v18, v33, v35
    v_cmp_eq_u32 vcc, -1, v18
    s_cbranch_vccnz .nk_55
    s_branch .ok_56
.nk_99:
    buffer_load_dwordx4 v[32:35], v3, s[8:11], s30 offen offset:2048 sc1
    s_add_u32 s62, s62, 1
    s_cmp_gt_u32 s62, 0x100000
    s_cbranch_scc1 .mg_end_1
    s_waitcnt vmcnt(1)
    v_max_u32 v18, v25, v27
    v_cmp_eq_u32 vcc, -1, v18
    s_cbranch_vccnz .nk_79
    s_branch .ok_80
.nk_101:
    buffer_load_dwordx4 v[32:35], v3, s[8:11], s30 offen offset:2048 sc1
    s_add_u32 s62, s62, 1
    s_cmp_gt_u32 s62, 0x100000
    s_cbranch_scc1 .mg_end_1
    s_waitcnt vmcnt(1)
    v_max_u32 v18, v29, v31
    v_cmp_eq_u32 vcc, -1, v18
    s_cbranch_vccnz .nk_85
    s_branch .ok_86
.nk_103:
    buffer_load_dwordx4 v[28:31], v3, s[8:11], s30 offen offset:1024 sc1
    s_add_u32 s62, s62, 1
    s_cmp_gt_u32 s62, 0x100000
    s_cbranch_scc1 .mg_end_1
    s_waitcnt vmcnt(2)
    v_max_u32 v18, v33, v35
    v_cmp_eq_u32 vcc, -1, v18
    s_cbranch_vccnz .nk_107
.ok_108:
    v_smfmac_f32_16x16x64_bf16 v[40:43], v[32:35], a[16:23], v2
    v_smfmac_f32_16x16x64_bf16 v[44:47], v[32:35], a[48:55], v2
    s_waitcnt vmcnt(1)
    v_max_u32 v18, v25, v27
    v_cmp_eq_u32 vcc, -1, v18
    v_smfmac_f32_16x16x64_bf16 v[48:51], v[32:35], a[80:87], v2
    v_smfmac_f32_16x16x64_bf16 v[52:55], v[32:35], a[112:119], v2
    s_cbranch_vccnz .nk_75
    s_branch .ok_76
.nk_105:
    buffer_load_dwordx4 v[28:31], v3, s[8:11], s30 offen offset:1024 sc1
    s_add_u32 s62, s62, 1
    s_cmp_gt_u32 s62, 0x100000
    s_cbranch_scc1 .mg_end_1
    s_waitcnt vmcnt(2)
    v_max_u32 v18, v37, v39
    v_cmp_eq_u32 vcc, -1, v18
    s_cbranch_vccnz .nk_73
    s_branch .ok_74
.nk_107:
    buffer_load_dwordx4 v[32:35], v3, s[8:11], s30 offen offset:2048 sc1
    s_add_u32 s62, s62, 1
    s_cmp_gt_u32 s62, 0x100000
    s_cbranch_scc1 .mg_end_1
    s_waitcnt vmcnt(2)
    v_max_u32 v18, v25, v27
    v_cmp_eq_u32 vcc, -1, v18
    s_cbranch_vccnz .nk_91
    s_branch .ok_92
.p2align 6
.gm_23:
    s_waitcnt vmcnt(3)
    v_cmp_eq_u32 vcc, -1, v27
    s_cbranch_vccnz .nk_109
.ok_110:
    v_smfmac_f32_16x16x64_bf16 v[64:67], v[24:27], a[192:199], v2
    s_waitcnt vmcnt(2)
    v_cmp_eq_u32 vcc, -1, v31
    v_smfmac_f32_16x16x64_bf16 v[68:71], v[24:27], a[224:231], v2
    s_cbranch_vccnz .nk_111
.ok_112:
    v_smfmac_f32_16x16x64_bf16 v[64:67], v[28:31], a[200:207], v2
    s_waitcnt vmcnt(1)
    v_cmp_eq_u32 vcc, -1, v35
    v_smfmac_f32_16x16x64_bf16 v[68:71], v[28:31], a[232:239], v2
    s_cbranch_vccnz .nk_113
.ok_114:
    v_smfmac_f32_16x16x64_bf16 v[64:67], v[32:35], a[208:215], v2
    s_waitcnt vmcnt(0)
    v_cmp_eq_u32 vcc, -1, v39
    v_smfmac_f32_16x16x64_bf16 v[68:71], v[32:35], a[240:247], v2
    s_cbranch_vccnz .nk_115
.ok_116:
    v_smfmac_f32_16x16x64_bf16 v[64:67], v[36:39], a[216:223], v2
    v_smfmac_f32_16x16x64_bf16 v[68:71], v[36:39], a[248:255], v2
    s_setpc_b64 s[98:99]
.nk_109:
    buffer_load_dwordx4 v[24:27], v4, s[8:11], s30 offen offset:0 sc1
    s_add_u32 s62, s62, 1
    s_cmp_gt_u32 s62, 0x100000
    s_cbranch_scc1 .mg_end_1
    s_waitcnt vmcnt(3)
    v_cmp_eq_u32 vcc, -1, v31
    s_cbranch_vccnz .nk_117
.ok_118:
    v_smfmac_f32_16x16x64_bf16 v[64:67], v[28:31], a[200:207], v2
    s_waitcnt vmcnt(2)
    v_cmp_eq_u32 vcc, -1, v35
    v_smfmac_f32_16x16x64_bf16 v[68:71], v[28:31], a[232:239], v2
    s_cbranch_vccnz .nk_119
.ok_120:
    v_smfmac_f32_16x16x64_bf16 v[64:67], v[32:35], a[208:215], v2
    s_waitcnt vmcnt(1)
    v_cmp_eq_u32 vcc, -1, v39
    v_smfmac_f32_16x16x64_bf16 v[68:71], v[32:35], a[240:247], v2
    s_cbranch_vccnz .nk_121
.ok_122:
    v_smfmac_f32_16x16x64_bf16 v[64:67], v[36:39], a[216:223], v2
    s_waitcnt vmcnt(0)
    v_cmp_eq_u32 vcc, -1, v27
    v_smfmac_f32_16x16x64_bf16 v[68:71], v[36:39], a[248:255], v2
    s_cbranch_vccnz .nk_123
.ok_124:
    v_smfmac_f32_16x16x64_bf16 v[64:67], v[24:27], a[192:199], v2
    v_smfmac_f32_16x16x64_bf16 v[68:71], v[24:27], a[224:231], v2
    s_setpc_b64 s[98:99]
.nk_111:
    buffer_load_dwordx4 v[28:31], v4, s[8:11], s30 offen offset:1024 sc1
    s_add_u32 s62, s62, 1
    s_cmp_gt_u32 s62, 0x100000
    s_cbranch_scc1 .mg_end_1
    s_waitcnt vmcnt(2)
    v_cmp_eq_u32 vcc, -1, v35
    s_cbranch_vccnz .nk_125
.ok_126:
    v_smfmac_f32_16x16x64_bf16 v[64:67], v[32:35], a[208:215], v2
    s_waitcnt vmcnt(1)
    v_cmp_eq_u32 vcc, -1, v39
    v_smfmac_f32_16x16x64_bf16 v[68:71], v[32:35], a[240:247], v2
    s_cbranch_vccnz .nk_127
.ok_128:
    v_smfmac_f32_16x16x64_bf16 v[64:67], v[36:39], a[216:223], v2
    s_waitcnt vmcnt(0)
    v_cmp_eq_u32 vcc, -1, v31
    v_smfmac_f32_16x16x64_bf16 v[68:71], v[36:39], a[248:255], v2
    s_cbranch_vccnz .nk_129
.ok_130:
    v_smfmac_f32_16x16x64_bf16 v[64:67], v[28:31], a[200:207], v2
    v_smfmac_f32_16x16x64_bf16 v[68:71], v[28:31], a[232:239], v2
    s_setpc_b64 s[98:99]
.nk_113:
    buffer_load_dwordx4 v[32:35], v4, s[8:11], s30 offen offset:2048 sc1
    s_add_u32 s62, s62, 1
    s_cmp_gt_u32 s62, 0x100000
    s_cbranch_scc1 .mg_end_1
    s_waitcnt vmcnt(1)
    v_cmp_eq_u32 vcc, -1, v39
    s_cbranch_vccnz .nk_131
.ok_132:
    v_smfmac_f32_16x16x64_bf16 v[64:67], v[36:39], a[216:223], v2
    s_waitcnt vmcnt(0)
    v_cmp_eq_u32 vcc, -1, v35
    v_smfmac_f32_16x16x64_bf16 v[68:71], v[36:39], a[248:255], v2
    s_cbranch_vccnz .nk_133
.ok_134:
    v_smfmac_f32_16x16x64_bf16 v[64:67], v[32:35], a[208:215], v2
    v_smfmac_f32_16x16x64_bf16 v[68:71], v[32:35], a[240:247], v2
    s_setpc_b64 s[98:99]
.nk_115:
    buffer_load_dwordx4 v[36:39], v4, s[8:11], s30 offen offset:3072 sc1
    s_add_u32 s62, s62, 1
    s_cmp_gt_u32 s62, 0x100000
    s_cbranch_scc1 .mg_end_1
    s_waitcnt vmcnt(0)
    v_cmp_eq_u32 vcc, -1, v39
    s_cbranch_vccnz .nk_115
    s_branch .ok_116
.nk_117:
    buffer_load_dwordx4 v[28:31], v4, s[8:11], s30 offen offset:1024 sc1
    s_add_u32 s62, s62, 1
    s_cmp_gt_u32 s62, 0x100000
    s_cbranch_scc1 .mg_end_1
    s_waitcnt vmcnt(3)
    v_cmp_eq_u32 vcc, -1, v35
    s_cbranch_vccnz .nk_135
.ok_136:
    v_smfmac_f32_16x16x64_bf16 v[64:67], v[32:35], a[208:215], v2
    s_waitcnt vmcnt(2)
    v_cmp_eq_u32 vcc, -1, v39
    v_smfmac_f32_16x16x64_bf16 v[68:71], v[32:35], a[240:247], v2
    s_cbranch_vccnz .nk_137
.ok_138:
    v_smfmac_f32_16x16x64_bf16 v[64:67], v[36:39], a[216:223], v2
    s_waitcnt vmcnt(1)
    v_cmp_eq_u32 vcc, -1, v27
    v_smfmac_f32_16x16x64_bf16 v[68:71], v[36:39], a[248:255], v2
    s_cbranch_vccnz .nk_139
.ok_140:
    v_smfmac_f32_16x16x64_bf16 v[64:67], v[24:27], a[192:199], v2
    s_waitcnt vmcnt(0)
    v_cmp_eq_u32 vcc, -1, v31
    v_smfmac_f32_16x16x64_bf16 v[68:71], v[24:27], a[224:231], v2
    s_cbranch_vccnz .nk_129
    s_branch .ok_130
.nk_119:
    buffer_load_dwordx4 v[32:35], v4, s[8:11], s30 offen offset:2048 sc1
    s_add_u32 s62, s62, 1
    s_cmp_gt_u32 s62, 0x100000
    s_cbranch_scc1 .mg_end_1
    s_waitcnt vmcnt(2)
    v_cmp_eq_u32 vcc, -1, v39
    s_cbranch_vccnz .nk_141
.ok_142:
    v_smfmac_f32_16x16x64_bf16 v[64:67], v[36:39], a[216:223], v2
    s_waitcnt vmcnt(1)
    v_cmp_eq_u32 vcc, -1, v27
    v_smfmac_f32_16x16x64_bf16 v[68:71], v[36:39], a[248:255], v2
    s_cbranch_vccnz .nk_143
.ok_144:
    v_smfmac_f32_16x16x64_bf16 v[64:67], v[24:27], a[192:199], v2
    s_waitcnt vmcnt(0)
    v_cmp_eq_u32 vcc, -1, v35
    v_smfmac_f32_16x16x64_bf16 v[68:71], v[24:27], a[224:231], v2
    s_cbranch_vccnz .nk_133
    s_branch .ok_134
.nk_121:
    buffer_load_dwordx4 v[36:39], v4, s[8:11], s30 offen offset:3072 sc1
    s_add_u32 s62, s62, 1
    s_cmp_gt_u32 s62, 0x100000
    s_cbranch_scc1 .mg_end_1
    s_waitcnt vmcnt(1)
    v_cmp_eq_u32 vcc, -1, v27
    s_cbranch_vccnz .nk_145
.ok_146:
    v_smfmac_f32_16x16x64_bf16 v[64:67], v[24:27], a[192:199], v2
    s_waitcnt vmcnt(0)
    v_cmp_eq_u32 vcc, -1, v39
    v_smfmac_f32_16x16x64_bf16 v[68:71], v[24:27], a[224:231], v2
    s_cbranch_vccnz .nk_115
    s_branch .ok_116
.nk_123:
    buffer_load_dwordx4 v[24:27], v4, s[8:11], s30 offen offset:0 sc1
    s_add_u32 s62, s62, 1
    s_cmp_gt_u32 s62, 0x100000
    s_cbranch_scc1 .mg_end_1
    s_waitcnt vmcnt(0)
    v_cmp_eq_u32 vcc, -1, v27
    s_cbranch_vccnz .nk_123
    s_branch .ok_124
.nk_125:
    buffer_load_dwordx4 v[32:35], v4, s[8:11], s30 offen offset:2048 sc1
    s_add_u32 s62, s62, 1
    s_cmp_gt_u32 s62, 0x100000
    s_cbranch_scc1 .mg_end_1
    s_waitcnt vmcnt(2)
    v_cmp_eq_u32 vcc, -1, v39
    s_cbranch_vccnz .nk_147
.ok_148:
    v_smfmac_f32_16x16x64_bf16 v[64:67], v[36:39], a[216:223], v2
    s_waitcnt vmcnt(1)
    v_cmp_eq_u32 vcc, -1, v31
    v_smfmac_f32_16x16x64_bf16 v[68:71], v[36:39], a[248:255], v2
    s_cbranch_vccnz .nk_149
.ok_150:
    v_smfmac_f32_16x16x64_bf16 v[64:67], v[28:31], a[200:207], v2
    s_waitcnt vmcnt(0)
    v_cmp_eq_u32 vcc, -1, v35
    v_smfmac_f32_16x16x64_bf16 v[68:71], v[28:31], a[232:239], v2
    s_cbranch_vccnz .nk_133
    s_branch .ok_134
.nk_127:
    buffer_load_dwordx4 v[36:39], v4, s[8:11], s30 offen offset:3072 sc1
    s_add_u32 s62, s62, 1
    s_cmp_gt_u32 s62, 0x100000
    s_cbranch_scc1 .mg_end_1
    s_waitcnt vmcnt(1)
    v_cmp_eq_u32 vcc, -1, v31
    s_cbranch_vccnz .nk_151
.ok_152:
    v_smfmac_f32_16x16x64_bf16 v[64:67], v[28:31], a[200:207], v2
    s_waitcnt vmcnt(0)
    v_cmp_eq_u32 vcc, -1, v39
    v_smfmac_f32_16x16x64_bf16 v[68:71], v[28:31], a[232:239], v2
    s_cbranch_vccnz .nk_115
    s_branch .ok_116
.nk_129:
    buffer_load_dwordx4 v[28:31], v4, s[8:11], s30 offen offset:1024 sc1
    s_add_u32 s62, s62, 1
    s_cmp_gt_u32 s62, 0x100000
    s_cbranch_scc1 .mg_end_1
    s_waitcnt vmcnt(0)
    v_cmp_eq_u32 vcc, -1, v31
    s_cbranch_vccnz .nk_129
    s_branch .ok_130
.nk_131:
    buffer_load_dwordx4 v[36:39], v4, s[8:11], s30 offen offset:3072 sc1
    s_add_u32 s62, s62, 1
    s_cmp_gt_u32 s62, 0x100000
    s_cbranch_scc1 .mg_end_1
    s_waitcnt vmcnt(1)
    v_cmp_eq_u32 vcc, -1, v35
    s_cbranch_vccnz .nk_113
    s_branch .ok_114
.nk_133:
    buffer_load_dwordx4 v[32:35], v4, s[8:11], s30 offen offset:2048 sc1
    s_add_u32 s62, s62, 1
    s_cmp_gt_u32 s62, 0x100000
    s_cbranch_scc1 .mg_end_1
    s_waitcnt vmcnt(0)
    v_cmp_eq_u32 vcc, -1, v35
    s_cbranch_vccnz .nk_133
    s_branch .ok_134
.nk_135:
    buffer_load_dwordx4 v[32:35], v4, s[8:11], s30 offen offset:2048 sc1
    s_add_u32 s62, s62, 1
    s_cmp_gt_u32 s62, 0x100000
    s_cbranch_scc1 .mg_end_1
    s_waitcnt vmcnt(3)
    v_cmp_eq_u32 vcc, -1, v39
    s_cbranch_vccnz .nk_153
.ok_154:
    v_smfmac_f32_16x16x64_bf16 v[64:67], v[36:39], a[216:223], v2
    s_waitcnt vmcnt(2)
    v_cmp_eq_u32 vcc, -1, v27
    v_smfmac_f32_16x16x64_bf16 v[68:71], v[36:39], a[248:255], v2
    s_cbranch_vccnz .nk_155
.ok_156:
    v_smfmac_f32_16x16x64_bf16 v[64:67], v[24:27], a[192:199], v2
    s_waitcnt vmcnt(1)
    v_cmp_eq_u32 vcc, -1, v31
    v_smfmac_f32_16x16x64_bf16 v[68:71], v[24:27], a[224:231], v2
    s_cbranch_vccnz .nk_149
    s_branch .ok_150
.nk_137:
    buffer_load_dwordx4 v[36:39], v4, s[8:11], s30 offen offset:3072 sc1
    s_add_u32 s62, s62, 1
    s_cmp_gt_u32 s62, 0x100000
    s_cbranch_scc1 .mg_end_1
    s_waitcnt vmcnt(2)
    v_cmp_eq_u32 vcc, -1, v27
    s_cbranch_vccnz .nk_157
.ok_158:
    v_smfmac_f32_16x16x64_bf16 v[64:67], v[24:27], a[192:199], v2
    s_waitcnt vmcnt(1)
    v_cmp_eq_u32 vcc, -1, v31
    v_smfmac_f32_16x16x64_bf16 v[68:71], v[24:27], a[224:231], v2
    s_cbranch_vccnz .nk_151
    s_branch .ok_152
.nk_139:
    buffer_load_dwordx4 v[24:27], v4, s[8:11], s30 offen offset:0 sc1
    s_add_u32 s62, s62, 1
    s_cmp_gt_u32 s62, 0x100000
    s_cbranch_scc1 .mg_end_1
    s_waitcnt vmcnt(1)
    v_cmp_eq_u32 vcc, -1, v31
    s_cbranch_vccnz .nk_159
.ok_160:
    v_smfmac_f32_16x16x64_bf16 v[64:67], v[28:31], a[200:207], v2
    s_waitcnt vmcnt(0)
    v_cmp_eq_u32 vcc, -1, v27
    v_smfmac_f32_16x16x64_bf16 v[68:71], v[28:31], a[232:239], v2
    s_cbranch_vccnz .nk_123
    s_branch .ok_124
.nk_141:
    buffer_load_dwordx4 v[36:39], v4, s[8:11], s30 offen offset:3072 sc1
    s_add_u32 s62, s62, 1
    s_cmp_gt_u32 s62, 0x100000
    s_cbranch_scc1 .mg_end_1
    s_waitcnt vmcnt(2)
    v_cmp_eq_u32 vcc, -1, v27
    s_cbranch_vccnz .nk_161
.ok_162:
    v_smfmac_f32_16x16x64_bf16 v[64:67], v[24:27], a[192:199], v2
    s_waitcnt vmcnt(1)
    v_cmp_eq_u32 vcc, -1, v35
    v_smfmac_f32_16x16x64_bf16 v[68:71], v[24:27], a[224:231], v2
    s_cbranch_vccnz .nk_113
    s_branch .ok_114
.nk_143:
    buffer_load_dwordx4 v[24:27], v4, s[8:11], s30 offen offset:0 sc1
    s_add_u32 s62, s62, 1
    s_cmp_gt_u32 s62, 0x100000
    s_cbranch_scc1 .mg_end_1
    s_waitcnt vmcnt(1)
    v_cmp_eq_u32 vcc, -1, v35
    s_cbranch_vccnz .nk_163
.ok_164:
    v_smfmac_f32_16x16x64_bf16 v[64:67], v[32:35], a[208:215], v2
    s_waitcnt vmcnt(0)
    v_cmp_eq_u32 vcc, -1, v27
    v_smfmac_f32_16x16x64_bf16 v[68:71], v[32:35], a[240:247], v2
    s_cbranch_vccnz .nk_123
    s_branch .ok_124
.nk_145:
    buffer_load_dwordx4 v[24:27], v4, s[8:11], s30 offen offset:0 sc1
    s_add_u32 s62, s62, 1
    s_cmp_gt_u32 s62, 0x100000
    s_cbranch_scc1 .mg_end_1
    s_waitcnt vmcnt(1)
    v_cmp_eq_u32 vcc, -1, v39
    s_cbranch_vccnz .nk_121
    s_branch .ok_122
.nk_147:
    buffer_load_dwordx4 v[36:39], v4, s[8:11], s30 offen offset:3072 sc1
    s_add_u32 s62, s62, 1
    s_cmp_gt_u32 s62, 0x100000
    s_cbranch_scc1 .mg_end_1
    s_waitcnt vmcnt(2)
    v_cmp_eq_u32 vcc, -1, v31
    s_cbranch_vccnz .nk_111
    s_branch .ok_112
.nk_149:
    buffer_load_dwordx4 v[28:31], v4, s[8:11], s30 offen offset:1024 sc1
    s_add_u32 s62, s62, 1
    s_cmp_gt_u32 s62, 0x100000
    s_cbranch_scc1 .mg_end_1
    s_waitcnt vmcnt(1)
    v_cmp_eq_u32 vcc, -1, v35
    s_cbranch_vccnz .nk_165
.ok_166:
    v_smfmac_f32_16x16x64_bf16 v[64:67], v[32:35], a[208:215], v2
    s_waitcnt vmcnt(0)
    v_cmp_eq_u32 vcc, -1, v31
    v_smfmac_f32_16x16x64_bf16 v[68:71], v[32:35], a[240:247], v2
    s_cbranch_vccnz .nk_129
    s_branch .ok_130
.nk_151:
    buffer_load_dwordx4 v[28:31], v4, s[8:11], s30 offen offset:1024 sc1
    s_add_u32 s62, s62, 1
    s_cmp_gt_u32 s62, 0x100000
    s_cbranch_scc1 .mg_end_1
    s_waitcnt vmcnt(1)
    v_cmp_eq_u32 vcc, -1, v39
    s_cbranch_vccnz .nk_127
    s_branch .ok_128
.nk_153:
    buffer_load_dwordx4 v[36:39], v4, s[8:11], s30 offen offset:3072 sc1
    s_add_u32 s62, s62, 1
    s_cmp_gt_u32 s62, 0x100000
    s_cbranch_scc1 .mg_end_1
    s_waitcnt vmcnt(3)
    v_cmp_eq_u32 vcc, -1, v27
    s_cbranch_vccnz .nk_109
    s_branch .ok_110
.nk_155:
    buffer_load_dwordx4 v[24:27], v4, s[8:11], s30 offen offset:0 sc1
    s_add_u32 s62, s62, 1
    s_cmp_gt_u32 s62, 0x100000
    s_cbranch_scc1 .mg_end_1
    s_waitcnt vmcnt(2)
    v_cmp_eq_u32 vcc, -1, v31
    s_cbranch_vccnz .nk_167
.ok_168:
    v_smfmac_f32_16x16x64_bf16 v[64:67], v[28:31], a[200:207], v2
    s_waitcnt vmcnt(1)
    v_cmp_eq_u32 vcc, -1, v35
    v_smfmac_f32_16x16x64_bf16 v[68:71], v[28:31], a[232:239], v2
    s_cbranch_vccnz .nk_163
    s_branch .ok_164
.nk_157:
    buffer_load_dwordx4 v[24:27], v4, s[8:11], s30 offen offset:0 sc1
    s_add_u32 s62, s62, 1
    s_cmp_gt_u32 s62, 0x100000
    s_cbranch_scc1 .mg_end_1
    s_waitcnt vmcnt(2)
    v_cmp_eq_u32 vcc, -1, v31
    s_cbranch_vccnz .nk_169
.ok_170:
    v_smfmac_f32_16x16x64_bf16 v[64:67], v[28:31], a[200:207], v2
    s_waitcnt vmcnt(1)
    v_cmp_eq_u32 vcc, -1, v39
    v_smfmac_f32_16x16x64_bf16 v[68:71], v[28:31], a[232:239], v2
    s_cbranch_vccnz .nk_121
    s_branch .ok_122
.nk_159:
    buffer_load_dwordx4 v[28:31], v4, s[8:11], s30 offen offset:1024 sc1
    s_add_u32 s62, s62, 1
    s_cmp_gt_u32 s62, 0x100000
    s_cbranch_scc1 .mg_end_1
    s_waitcnt vmcnt(1)
    v_cmp_eq_u32 vcc, -1, v27
    s_cbranch_vccnz .nk_139
    s_branch .ok_140
.nk_161:
    buffer_load_dwordx4 v[24:27], v4, s[8:11], s30 offen offset:0 sc1
    s_add_u32 s62, s62, 1
    s_cmp_gt_u32 s62, 0x100000
    s_cbranch_scc1 .mg_end_1
    s_waitcnt vmcnt(2)
    v_cmp_eq_u32 vcc, -1, v35
    s_cbranch_vccnz .nk_119
    s_branch .ok_120
.nk_163:
    buffer_load_dwordx4 v[32:35], v4, s[8:11], s30 offen offset:2048 sc1
    s_add_u32 s62, s62, 1
    s_cmp_gt_u32 s62, 0x100000
    s_cbranch_scc1 .mg_end_1
    s_waitcnt vmcnt(1)
    v_cmp_eq_u32 vcc, -1, v27
    s_cbranch_vccnz .nk_143
    s_branch .ok_144
.nk_165:
    buffer_load_dwordx4 v[32:35], v4, s[8:11], s30 offen offset:2048 sc1
    s_add_u32 s62, s62, 1
    s_cmp_gt_u32 s62, 0x100000
    s_cbranch_scc1 .mg_end_1
    s_waitcnt vmcnt(1)
    v_cmp_eq_u32 vcc, -1, v31
    s_cbranch_vccnz .nk_149
    s_branch .ok_150
.nk_167:
    buffer_load_dwordx4 v[28:31], v4, s[8:11], s30 offen offset:1024 sc1
    s_add_u32 s62, s62, 1
    s_cmp_gt_u32 s62, 0x100000
    s_cbranch_scc1 .mg_end_1
    s_waitcnt vmcnt(2)
    v_cmp_eq_u32 vcc, -1, v35
    s_cbranch_vccnz .nk_171
.ok_172:
    v_smfmac_f32_16x16x64_bf16 v[64:67], v[32:35], a[208:215], v2
    s_waitcnt vmcnt(1)
    v_cmp_eq_u32 vcc, -1, v27
    v_smfmac_f32_16x16x64_bf16 v[68:71], v[32:35], a[240:247], v2
    s_cbranch_vccnz .nk_139
    s_branch .ok_140
.nk_169:
    buffer_load_dwordx4 v[28:31], v4, s[8:11], s30 offen offset:1024 sc1
    s_add_u32 s62, s62, 1
    s_cmp_gt_u32 s62, 0x100000
    s_cbranch_scc1 .mg_end_1
    s_waitcnt vmcnt(2)
    v_cmp_eq_u32 vcc, -1, v39
    s_cbranch_vccnz .nk_137
    s_branch .ok_138
.nk_171:
    buffer_load_dwordx4 v[32:35], v4, s[8:11], s30 offen offset:2048 sc1
    s_add_u32 s62, s62, 1
    s_cmp_gt_u32 s62, 0x100000
    s_cbranch_scc1 .mg_end_1
    s_waitcnt vmcnt(2)
    v_cmp_eq_u32 vcc, -1, v27
    s_cbranch_vccnz .nk_155
    s_branch .ok_156
.slowv_17:
    s_mov_b32 s28, 0
    s_mov_b32 s30, 83886080
    s_mov_b32 s31, 84180992
    s_mov_b32 s32, 84475904
    s_mov_b32 s33, 84770816
    s_mov_b32 s41, 66977792
    s_lshl_b32 s42, s56, 13
    s_lshl_b32 s4, s53, 11
    s_add_u32 s44, s42, s4
    s_add_u32 s44, s44, 33554432
    s_add_u32 s42, s42, 16777216
    s_xor_b32 s4, s53, 2
    s_lshl_b32 s4, s4, 10
    s_add_u32 s42, s42, s4
    s_add_u32 s43, s42, 4096
    s_add_u32 s96, s44, 524288
    s_sub_u32 s95, s96, 16777216
    s_mov_b32 s62, 0
    s_mov_b32 s45, 0x3e0293ee
    s_mov_b32 s46, 0
    s_and_b32 s4, s25, 1
    s_lshl_b32 s4, s4, 14
    s_lshr_b32 s5, s25, 1
    s_lshl_b32 s5, s5, 12
    s_or_b32 s4, s4, s5
    s_xor_b32 s47, s47, s4
    s_and_b32 s5, s26, 1
    s_lshl_b32 s5, s5, 10
    s_lshr_b32 s4, s26, 1
    s_lshl_b32 s4, s4, 15
    s_or_b32 s5, s5, s4
    s_bfe_u32 s4, s26, 0x10004
    s_lshl_b32 s4, s4, 11
    s_xor_b32 s5, s5, s4
    s_xor_b32 s34, s5, s47
    s_xor_b32 s35, s34, 0x84000
    s_xor_b32 s36, s34, 0x101000
    s_xor_b32 s37, s34, 0x185000
    s_cmp_eq_u32 s24, 1
    s_cbranch_scc1 .w1_174
    s_cmp_eq_u32 s24, 2
    s_cbranch_scc1 .w2_175
    s_cmp_eq_u32 s24, 3
    s_cbranch_scc1 .w3_176
.w0_173:
    v_bfe_u32 v254, v1, 0, 3
    v_mul_u32_u24 v9, 144, v254
    v_bfe_u32 v254, v1, 3, 1
    v_mul_u32_u24 v254, 1152, v254
    v_add_u32 v9, v9, v254
    v_bfe_u32 v254, v1, 4, 2
    v_mul_u32_u24 v254, 32, v254
    v_add_u32 v9, v9, v254
    s_lshl_b32 s4, s56, 10
    v_bfe_u32 v254, v1, 0, 6
    v_mul_u32_u24 v13, 16, v254
    v_add_u32 v13, 262144, v13
    v_add_u32 v13, s4, v13
    v_xor_b32 v156, 1024, v246
    v_xor_b32 v157, 2048, v246
    v_xor_b32 v158, 3072, v246
    v_bfe_u32 v254, v1, 4, 2
    v_mul_u32_u24 v14, 128, v254
    v_bfe_u32 v254, v1, 0, 4
    v_mul_u32_u24 v254, 16, v254
    v_add_u32 v14, v14, v254
    v_add_u32 v14, 65536, v14
    v_add_u32 v14, s55, v14
    v_bfe_u32 v254, v1, 0, 6
    v_mul_u32_u24 v15, 16, v254
    v_bfe_u32 v254, v1, 2, 2
    v_mul_u32_u24 v16, 128, v254
    v_bfe_u32 v254, v1, 0, 2
    v_mul_u32_u24 v254, 16, v254
    v_add_u32 v16, v16, v254
    v_bfe_u32 v254, v1, 4, 2
    v_mul_u32_u24 v254, 4, v254
    v_add_u32 v16, v16, v254
    v_add_u32 v16, 18688, v16
    v_mov_b32 v208, 0
    v_mov_b32 v209, 0
    v_mov_b32 v210, 0
    v_mov_b32 v211, 0
    v_mov_b32 v212, 0
    v_mov_b32 v213, 0
    v_mov_b32 v214, 0
    v_mov_b32 v215, 0
    v_mov_b32 v216, 0
    v_mov_b32 v217, 0
    v_mov_b32 v218, 0
    v_mov_b32 v219, 0
    s_mov_b64 s[50:51], s[48:49]
    v_mov_b32 v164, 0
    v_mov_b32 v165, 0
    v_mov_b32 v166, 0
    v_mov_b32 v167, 0
    v_mov_b32 v164, 0x3f803f80
    v_mov_b32 v200, s45
    v_mov_b32 v220, 0x3f803f80
    v_mov_b32 v201, s45
    v_mov_b32 v221, 0x3f803f80
    v_mov_b32 v202, s45
    v_mov_b32 v222, 0x3f803f80
    v_mov_b32 v203, s45
    v_mov_b32 v223, 0x3f803f80
    s_waitcnt vmcnt(0)
    ds_read_b64_tr_b16 a[192:193], v242 offset:16384
    ds_read_b64_tr_b16 a[194:195], v242 offset:16896
    ds_read_b64_tr_b16 a[196:197], v242 offset:18432
    ds_read_b64_tr_b16 a[198:199], v242 offset:18944
    ds_read_b64_tr_b16 a[200:201], v242 offset:20480
    ds_read_b64_tr_b16 a[202:203], v242 offset:20992
    ds_read_b64_tr_b16 a[204:205], v242 offset:22528
    ds_read_b64_tr_b16 a[206:207], v242 offset:23040
    ds_read_b64_tr_b16 a[208:209], v242 offset:24576
    ds_read_b64_tr_b16 a[210:211], v242 offset:25088
    ds_read_b64_tr_b16 a[212:213], v242 offset:26624
    ds_read_b64_tr_b16 a[214:215], v242 offset:27136
    ds_read_b64_tr_b16 a[216:217], v242 offset:28672
    ds_read_b64_tr_b16 a[218:219], v242 offset:29184
    ds_read_b64_tr_b16 a[220:221], v242 offset:30720
    ds_read_b64_tr_b16 a[222:223], v242 offset:31232
    ds_read_b64_tr_b16 a[224:225], v243 offset:16384
    ds_read_b64_tr_b16 a[226:227], v243 offset:16896
    ds_read_b64_tr_b16 a[228:229], v243 offset:18432
    ds_read_b64_tr_b16 a[230:231], v243 offset:18944
    ds_read_b64_tr_b16 a[232:233], v243 offset:20480
    ds_read_b64_tr_b16 a[234:235], v243 offset:20992
    ds_read_b64_tr_b16 a[236:237], v243 offset:22528
    ds_read_b64_tr_b16 a[238:239], v243 offset:23040
    ds_read_b64_tr_b16 a[240:241], v243 offset:24576
    ds_read_b64_tr_b16 a[242:243], v243 offset:25088
    ds_read_b64_tr_b16 a[244:245], v243 offset:26624
    ds_read_b64_tr_b16 a[246:247], v243 offset:27136
    ds_read_b64_tr_b16 a[248:249], v243 offset:28672
    ds_read_b64_tr_b16 a[250:251], v243 offset:29184
    ds_read_b64_tr_b16 a[252:253], v243 offset:30720
    ds_read_b64_tr_b16 a[254:255], v243 offset:31232
    s_waitcnt lgkmcnt(0)
    s_barrier
    buffer_load_dwordx4 v[104:107], v15, s[8:11], s42 offen offset:0
    buffer_load_dwordx4 v[120:123], v15, s[8:11], s43 offen offset:0
    buffer_load_dwordx4 v[136:139], v15, s[8:11], s44 offen offset:0
    buffer_load_dwordx4 v[140:143], v15, s[8:11], s44 offen offset:1024
    s_add_u32 s42, s42, 262144
    s_add_u32 s43, s43, 262144
    s_add_u32 s44, s44, 262144
.p2align 6
.step_179:
    s_barrier
    s_setprio 3
    buffer_load_dwordx4 v[24:27], v3, s[8:11], s30 offen offset:0 sc1
    s_setprio 2
    buffer_load_dwordx4 v[28:31], v3, s[8:11], s30 offen offset:1024 sc1
    s_setprio 1
    buffer_load_dwordx4 v[32:35], v3, s[8:11], s30 offen offset:2048 sc1
    s_setprio 0
    buffer_load_dwordx4 v[36:39], v3, s[8:11], s30 offen offset:3072 sc1
    s_call_b64 s[98:99], .gm_177
    v_permlane32_swap_b32 v40, v44
    v_permlane32_swap_b32 v41, v45
    v_permlane32_swap_b32 v42, v46
    v_permlane32_swap_b32 v43, v47
    v_add_f32 v40, v40, v44
    v_add_f32 v41, v41, v45
    v_add_f32 v42, v42, v46
    v_add_f32 v43, v43, v47
    ds_write2_b32 v5, v40, v41 offset0:0 offset1:36
    ds_write2_b32 v5, v42, v43 offset0:72 offset1:108
    v_permlane32_swap_b32 v48, v52
    v_permlane32_swap_b32 v49, v53
    v_permlane32_swap_b32 v50, v54
    v_permlane32_swap_b32 v51, v55
    v_pk_add_f32 v[48:49], v[48:49], v[52:53]
    v_pk_add_f32 v[50:51], v[50:51], v[54:55]
    ds_write2_b32 v6, v48, v49 offset0:0 offset1:36
    ds_write2_b32 v6, v50, v51 offset0:72 offset1:108
    s_waitcnt lgkmcnt(2)
    s_barrier
    ds_read_b128 v[72:75], v9 offset:0
    ds_read_b128 v[76:79], v9 offset:2304
    ds_read_b128 v[80:83], v9 offset:16
    ds_read_b128 v[84:87], v9 offset:2320
    v_smfmac_f32_16x16x64_bf16 v[56:59], v[24:27], a[128:135], v2
    v_smfmac_f32_16x16x64_bf16 v[60:63], v[24:27], a[160:167], v2
    s_waitcnt lgkmcnt(4)
    s_barrier
    v_smfmac_f32_16x16x64_bf16 v[56:59], v[28:31], a[136:143], v2
    s_waitcnt lgkmcnt(2)
    v_pk_add_f32 v[72:73], v[72:73], v[76:77]
    v_pk_add_f32 v[74:75], v[74:75], v[78:79]
    v_cvt_pk_bf16_f32 v144, v72, v73
    v_cvt_pk_bf16_f32 v145, v74, v75
    s_waitcnt lgkmcnt(0)
    v_pk_add_f32 v[80:81], v[80:81], v[84:85]
    v_pk_add_f32 v[82:83], v[82:83], v[86:87]
    v_cvt_pk_bf16_f32 v146, v80, v81
    v_cvt_pk_bf16_f32 v147, v82, v83
    s_nop 1
    v_mfma_f32_16x16x32_bf16 v[192:195], v[104:107], v[144:147], 0
    v_mfma_f32_16x16x32_bf16 v[160:163], v[120:123], v[144:147], 0
    v_smfmac_f32_16x16x64_bf16 v[60:63], v[28:31], a[168:175], v2
    v_add_f32_dpp v151, v195, v195 row_ror:8 row_mask:0xf bank_mask:0x3
    v_add_f32_dpp v148, v192, v192 row_ror:8 row_mask:0xf bank_mask:0x3
    v_add_f32_dpp v149, v193, v193 row_ror:8 row_mask:0xf bank_mask:0x3
    v_add_f32_dpp v150, v194, v194 row_ror:8 row_mask:0xf bank_mask:0x3
    v_add_f32_dpp v151, v163, v163 row_ror:8 row_mask:0xf bank_mask:0xc
    v_add_f32_dpp v148, v160, v160 row_ror:8 row_mask:0xf bank_mask:0xc
    v_add_f32_dpp v149, v161, v161 row_ror:8 row_mask:0xf bank_mask:0xc
    v_add_f32_dpp v150, v162, v162 row_ror:8 row_mask:0xf bank_mask:0xc
    v_min_u32 v151, 0xfffffffe, v151
    buffer_store_dwordx4 v[148:151], v246, s[8:11], s30 offen sc1
    v_smfmac_f32_16x16x64_bf16 v[56:59], v[32:35], a[144:151], v2
    v_smfmac_f32_16x16x64_bf16 v[60:63], v[32:35], a[176:183], v2
    v_smfmac_f32_16x16x64_bf16 v[56:59], v[36:39], a[152:159], v2
    v_smfmac_f32_16x16x64_bf16 v[60:63], v[36:39], a[184:191], v2
    v_mov_b32 v40, 0
    v_mov_b32 v41, 0
    v_mov_b32 v42, 0
    v_mov_b32 v43, 0
    v_mov_b32 v44, 0
    v_mov_b32 v45, 0
    v_mov_b32 v46, 0
    v_mov_b32 v47, 0
    v_permlane32_swap_b32 v56, v60
    v_permlane32_swap_b32 v57, v61
    v_permlane32_swap_b32 v58, v62
    v_permlane32_swap_b32 v59, v63
    v_pk_add_f32 v[56:57], v[56:57], v[60:61]
    v_pk_add_f32 v[58:59], v[58:59], v[62:63]
    v_cvt_pk_bf16_f32 v60, v56, v57
    v_cvt_pk_bf16_f32 v61, v58, v59
    ds_write2_b32 v255, v60, v61 offset0:0 offset1:64
    ds_write_b128 v8, v[56:59]
    s_cmp_eq_u32 s28, 63
    s_cbranch_scc1 .fin_180
    buffer_load_dwordx4 v[176:179], v13, s[8:11], s30 offen sc1
    buffer_load_dwordx4 v[180:183], v156, s[8:11], s30 offen sc1
    buffer_load_dwordx4 v[184:187], v157, s[8:11], s30 offen sc1
    buffer_load_dwordx4 v[188:191], v158, s[8:11], s30 offen sc1
    s_waitcnt lgkmcnt(0)
    s_barrier
    ds_read_b128 v[212:215], v15 offset:20224
    ds_read_b128 v[216:219], v15 offset:21248
    buffer_load_dwordx4 v[72:75], v13, s[8:11], s30 offen sc1
    buffer_load_dwordx4 v[76:79], v156, s[8:11], s30 offen sc1
    buffer_load_dwordx4 v[80:83], v157, s[8:11], s30 offen sc1
    buffer_load_dwordx4 v[84:87], v158, s[8:11], s30 offen sc1
.mf_181:
    s_waitcnt vmcnt(7)
    v_max3_u32 v18, v176, v177, v178
    v_pk_add_f32 v[196:197], v[176:177], v[178:179]
    s_waitcnt vmcnt(6)
    v_max3_u32 v18, v18, v179, v183
    v_pk_add_f32 v[192:193], v[148:149], v[180:181]
    v_pk_add_f32 v[194:195], v[150:151], v[182:183]
    v_add_f32 v196, v196, v197
    s_waitcnt vmcnt(5)
    v_pk_add_f32 v[192:193], v[192:193], v[184:185]
    v_pk_add_f32 v[194:195], v[194:195], v[186:187]
    s_waitcnt vmcnt(4)
    v_max3_u32 v18, v18, v187, v191
    v_pk_add_f32 v[192:193], v[192:193], v[188:189]
    v_pk_add_f32 v[194:195], v[194:195], v[190:191]
    v_cmp_eq_u32 vcc, -1, v18
    v_max3_f32 v19, v192, v193, v196
    v_max3_f32 v19, v19, v194, v195
    s_cbranch_vccnz .re_182
.sj_183:
    s_nop 0
    v_max_f32_dpp v18, v19, v19 row_ror:8 row_mask:0xf bank_mask:0xf
    v_max_f32_dpp v17, v19, v19 row_ror:8 row_mask:0xf bank_mask:0xf
    s_nop 1
    v_permlane16_swap_b32 v18, v17
    v_max_f32 v19, v18, v17
    v_max_f32 v18, v18, v17
    s_nop 1
    v_permlane32_swap_b32 v18, v19
    v_max_f32 v18, v18, v19
    v_mul_f32 v18, s45, v18
    v_fma_f32 v244, v196, s45, -v18
    v_pk_fma_f32 v[240:241], v[192:193], v[200:201], v[18:19] op_sel_hi:[1,1,0] neg_lo:[0,0,1] neg_hi:[0,0,1]
    v_exp_f32 v244, v244
    v_pk_fma_f32 v[242:243], v[194:195], v[200:201], v[18:19] op_sel_hi:[1,1,0] neg_lo:[0,0,1] neg_hi:[0,0,1]
    v_exp_f32 v240, v240
    v_mov_b32_dpp v245, v244 row_ror:8 row_mask:0xf bank_mask:0xf
    v_cvt_pk_bf16_f32 v208, v244, v245
    v_cvt_pk_bf16_f32 v209, v244, v245
    v_pk_mov_b32 v[210:211], v[208:209], v[208:209] op_sel:[0,1]
    v_exp_f32 v241, v241
    s_waitcnt lgkmcnt(0)
    v_mfma_f32_16x16x32_bf16 v[228:231], v[212:215], v[208:211], 0
    v_exp_f32 v242, v242
    v_mfma_f32_16x16x32_bf16 v[224:227], v[164:167], v[208:211], 0
    v_exp_f32 v243, v243
    v_cvt_pk_bf16_f32 v204, v240, v241
    v_cvt_pk_bf16_f32 v205, v242, v243
    v_mfma_f32_16x16x32_bf16 v[232:235], v[216:219], v[208:211], 0
    v_mov_b32_dpp v206, v204 row_ror:8 row_mask:0xf bank_mask:0xf
    v_mov_b32_dpp v207, v205 row_ror:8 row_mask:0xf bank_mask:0xf
    s_nop 1
    v_mfma_f32_16x16x32_bf16 v[224:227], v[220:223], v[204:207], v[224:227]
    v_mfma_f32_16x16x32_bf16 v[228:231], v[136:139], v[204:207], v[228:231]
    v_mfma_f32_16x16x32_bf16 v[232:235], v[140:143], v[204:207], v[232:235]
    s_mov_b64 exec, s[50:51]
    v_rcp_f32 v18, v224
    s_nop 1
    v_mul_f32 v228, v18, v228
    v_mul_f32 v229, v18, v229
    v_mul_f32 v230, v18, v230
    v_mul_f32 v231, v18, v231
    v_pk_mul_f32 v[232:233], v[18:19], v[232:233] op_sel_hi:[0,1]
    v_pk_mul_f32 v[234:235], v[18:19], v[234:235] op_sel_hi:[0,1]
    v_cvt_pk_bf16_f32 v236, v228, v229
    v_cvt_pk_bf16_f32 v239, v234, v235
    v_cvt_pk_bf16_f32 v237, v230, v231
    v_cvt_pk_bf16_f32 v238, v232, v233
    v_min_u32 v239, 0xfffffffe, v239
    buffer_store_dwordx4 v[236:239], v14, s[8:11], s30 offen sc1
    s_mov_b64 exec, -1
    v_mov_b32 v48, 0
    v_mov_b32 v49, 0
    v_mov_b32 v50, 0
    v_mov_b32 v51, 0
    v_mov_b32 v52, 0
    v_mov_b32 v53, 0
    v_mov_b32 v54, 0
    v_mov_b32 v55, 0
    v_mov_b32 v56, 0
    v_mov_b32 v57, 0
    v_mov_b32 v58, 0
    v_mov_b32 v59, 0
    v_mov_b32 v60, 0
    v_mov_b32 v61, 0
    v_mov_b32 v62, 0
    v_mov_b32 v63, 0
    s_waitcnt vmcnt(0)
    s_barrier
    s_setprio 3
    buffer_load_dwordx4 v[24:27], v4, s[8:11], s30 offen offset:0 sc1
    s_setprio 2
    buffer_load_dwordx4 v[28:31], v4, s[8:11], s30 offen offset:1024 sc1
    s_setprio 1
    buffer_load_dwordx4 v[32:35], v4, s[8:11], s30 offen offset:2048 sc1
    s_setprio 0
    buffer_load_dwordx4 v[36:39], v4, s[8:11], s30 offen offset:3072 sc1
    s_call_b64 s[98:99], .gm_178
    s_nop 6
    v_permlane32_swap_b32 v64, v68
    v_permlane32_swap_b32 v65, v69
    v_permlane32_swap_b32 v66, v70
    v_permlane32_swap_b32 v67, v71
    v_pk_add_f32 v[64:65], v[64:65], v[68:69]
    v_pk_add_f32 v[66:67], v[66:67], v[70:71]
    ds_write2_b32 v7, v64, v65 offset0:0 offset1:36
    ds_write2_b32 v7, v66, v67 offset0:72 offset1:108
    s_waitcnt lgkmcnt(0)
    s_barrier
    buffer_load_dwordx4 v[104:107], v15, s[8:11], s42 offen offset:0
    buffer_load_dwordx4 v[120:123], v15, s[8:11], s43 offen offset:0
    buffer_load_dwordx4 v[136:139], v15, s[8:11], s44 offen offset:0
    buffer_load_dwordx4 v[140:143], v15, s[8:11], s44 offen offset:1024
    s_add_u32 s42, s42, 262144
    s_add_u32 s43, s43, 262144
    s_add_u32 s44, s44, 262144
    v_mov_b32 v64, 0
    v_mov_b32 v65, 0
    v_mov_b32 v66, 0
    v_mov_b32 v67, 0
    v_mov_b32 v68, 0
    v_mov_b32 v69, 0
    v_mov_b32 v70, 0
    v_mov_b32 v71, 0
    s_mov_b32 s4, s30
    s_mov_b32 s30, s31
    s_mov_b32 s31, s32
    s_mov_b32 s32, s33
    s_mov_b32 s33, s4
    s_add_u32 s28, s28, 1
    s_mov_b32 s62, 0
    s_branch .step_179
.fin_180:
    s_waitcnt lgkmcnt(0)
    s_barrier
    s_barrier
    s_endpgm
.re_182:
    buffer_load_dwordx4 v[176:179], v13, s[8:11], s30 offen sc1
    buffer_load_dwordx4 v[180:183], v156, s[8:11], s30 offen sc1
    buffer_load_dwordx4 v[184:187], v157, s[8:11], s30 offen sc1
    buffer_load_dwordx4 v[188:191], v158, s[8:11], s30 offen sc1
    s_waitcnt vmcnt(7)
    v_max3_u32 v18, v72, v73, v74
    v_pk_add_f32 v[196:197], v[72:73], v[74:75]
    s_waitcnt vmcnt(6)
    v_max3_u32 v18, v18, v75, v79
    v_pk_add_f32 v[192:193], v[148:149], v[76:77]
    v_pk_add_f32 v[194:195], v[150:151], v[78:79]
    v_add_f32 v196, v196, v197
    s_waitcnt vmcnt(5)
    v_pk_add_f32 v[192:193], v[192:193], v[80:81]
    v_pk_add_f32 v[194:195], v[194:195], v[82:83]
    s_waitcnt vmcnt(4)
    v_max3_u32 v18, v18, v83, v87
    v_pk_add_f32 v[192:193], v[192:193], v[84:85]
    v_pk_add_f32 v[194:195], v[194:195], v[86:87]
    v_cmp_eq_u32 vcc, -1, v18
    v_max3_f32 v19, v192, v193, v196
    v_max3_f32 v19, v19, v194, v195
    s_cbranch_vccnz .re_184
    s_branch .sj_183
.re_184:
    buffer_load_dwordx4 v[72:75], v13, s[8:11], s30 offen sc1
    buffer_load_dwordx4 v[76:79], v156, s[8:11], s30 offen sc1
    buffer_load_dwordx4 v[80:83], v157, s[8:11], s30 offen sc1
    buffer_load_dwordx4 v[84:87], v158, s[8:11], s30 offen sc1
    s_add_u32 s62, s62, 1
    s_cmp_gt_u32 s62, 0x100000
    s_cbranch_scc1 .mg_end_1
    s_branch .mf_181
.w1_174:
    v_bfe_u32 v254, v1, 0, 3
    v_mul_u32_u24 v9, 144, v254
    v_bfe_u32 v254, v1, 3, 1
    v_mul_u32_u24 v254, 1152, v254
    v_add_u32 v9, v9, v254
    v_bfe_u32 v254, v1, 4, 2
    v_mul_u32_u24 v254, 32, v254
    v_add_u32 v9, v9, v254
    v_bfe_u32 v254, v1, 0, 1
    v_mul_u32_u24 v11, 144, v254
    v_bfe_u32 v254, v1, 2, 2
    v_mul_u32_u24 v254, 288, v254
    v_add_u32 v11, v11, v254
    v_bfe_u32 v254, v1, 1, 1
    v_mul_u32_u24 v254, 1152, v254
    v_add_u32 v11, v11, v254
    v_bfe_u32 v254, v1, 4, 2
    v_mul_u32_u24 v254, 32, v254
    v_add_u32 v11, v11, v254
    v_add_u32 v11, 4736, v11
    s_lshl_b32 s4, s56, 10
    s_lshl_b32 s5, s53, 2
    v_bfe_u32 v254, v1, 0, 6
    v_mul_u32_u24 v10, 16, v254
    v_add_u32 v10, 262144, v10
    v_add_u32 v10, s4, v10
    v_add_u32 v10, s5, v10
    v_bfe_u32 v254, v1, 1, 3
    v_mul_u32_u24 v12, 144, v254
    v_bfe_u32 v254, v1, 4, 2
    v_mul_u32_u24 v254, 32, v254
    v_add_u32 v12, v12, v254
    v_bfe_u32 v254, v1, 0, 1
    v_mul_u32_u24 v254, 16, v254
    v_add_u32 v12, v12, v254
    v_add_u32 v12, 9472, v12
    v_bfe_u32 v254, v1, 0, 6
    v_mul_u32_u24 v13, 16, v254
    v_add_u32 v13, s101, v13
    v_bfe_u32 v254, v1, 0, 6
    v_mul_u32_u24 v14, 8, v254
    v_add_u32 v14, s55, v14
    v_xor_b32 v14, 2048, v14
    v_min_u32 v249, 0xfffffffe, v249
    buffer_store_dwordx2 v[248:249], v14, s[8:11], s30 offen sc1
    v_bfe_u32 v254, v1, 0, 6
    v_mul_u32_u24 v15, 16, v254
    s_add_u32 s42, s42, 262144
    s_add_u32 s43, s43, 262144
    s_add_u32 s44, s44, 262144
    s_waitcnt vmcnt(0)
    ds_read_b64_tr_b16 a[192:193], v242 offset:16384
    ds_read_b64_tr_b16 a[194:195], v242 offset:16896
    ds_read_b64_tr_b16 a[196:197], v242 offset:18432
    ds_read_b64_tr_b16 a[198:199], v242 offset:18944
    ds_read_b64_tr_b16 a[200:201], v242 offset:20480
    ds_read_b64_tr_b16 a[202:203], v242 offset:20992
    ds_read_b64_tr_b16 a[204:205], v242 offset:22528
    ds_read_b64_tr_b16 a[206:207], v242 offset:23040
    ds_read_b64_tr_b16 a[208:209], v242 offset:24576
    ds_read_b64_tr_b16 a[210:211], v242 offset:25088
    ds_read_b64_tr_b16 a[212:213], v242 offset:26624
    ds_read_b64_tr_b16 a[214:215], v242 offset:27136
    ds_read_b64_tr_b16 a[216:217], v242 offset:28672
    ds_read_b64_tr_b16 a[218:219], v242 offset:29184
    ds_read_b64_tr_b16 a[220:221], v242 offset:30720
    ds_read_b64_tr_b16 a[222:223], v242 offset:31232
    ds_read_b64_tr_b16 a[224:225], v243 offset:16384
    ds_read_b64_tr_b16 a[226:227], v243 offset:16896
    ds_read_b64_tr_b16 a[228:229], v243 offset:18432
    ds_read_b64_tr_b16 a[230:231], v243 offset:18944
    ds_read_b64_tr_b16 a[232:233], v243 offset:20480
    ds_read_b64_tr_b16 a[234:235], v243 offset:20992
    ds_read_b64_tr_b16 a[236:237], v243 offset:22528
    ds_read_b64_tr_b16 a[238:239], v243 offset:23040
    ds_read_b64_tr_b16 a[240:241], v243 offset:24576
    ds_read_b64_tr_b16 a[242:243], v243 offset:25088
    ds_read_b64_tr_b16 a[244:245], v243 offset:26624
    ds_read_b64_tr_b16 a[246:247], v243 offset:27136
    ds_read_b64_tr_b16 a[248:249], v243 offset:28672
    ds_read_b64_tr_b16 a[250:251], v243 offset:29184
    ds_read_b64_tr_b16 a[252:253], v243 offset:30720
    ds_read_b64_tr_b16 a[254:255], v243 offset:31232
    s_waitcnt lgkmcnt(0)
    s_barrier
.p2align 6
.step_185:
    s_barrier
    s_setprio 3
    buffer_load_dwordx4 v[24:27], v3, s[8:11], s30 offen offset:0 sc1
    s_setprio 2
    buffer_load_dwordx4 v[28:31], v3, s[8:11], s30 offen offset:1024 sc1
    s_setprio 1
    buffer_load_dwordx4 v[32:35], v3, s[8:11], s30 offen offset:2048 sc1
    s_setprio 0
    buffer_load_dwordx4 v[36:39], v3, s[8:11], s30 offen offset:3072 sc1
    s_call_b64 s[98:99], .gm_177
    v_permlane32_swap_b32 v40, v44
    v_permlane32_swap_b32 v41, v45
    v_permlane32_swap_b32 v42, v46
    v_permlane32_swap_b32 v43, v47
    v_add_f32 v40, v40, v44
    v_add_f32 v41, v41, v45
    v_add_f32 v42, v42, v46
    v_add_f32 v43, v43, v47
    ds_write2_b32 v5, v40, v41 offset0:0 offset1:36
    ds_write2_b32 v5, v42, v43 offset0:72 offset1:108
    v_permlane32_swap_b32 v48, v52
    v_permlane32_swap_b32 v49, v53
    v_permlane32_swap_b32 v50, v54
    v_permlane32_swap_b32 v51, v55
    v_pk_add_f32 v[48:49], v[48:49], v[52:53]
    v_pk_add_f32 v[50:51], v[50:51], v[54:55]
    ds_write2_b32 v6, v48, v49 offset0:0 offset1:36
    ds_write2_b32 v6, v50, v51 offset0:72 offset1:108
    s_waitcnt lgkmcnt(2)
    s_barrier
    ds_read_b128 v[72:75], v9 offset:0
    ds_read_b128 v[76:79], v9 offset:2304
    ds_read_b128 v[80:83], v9 offset:16
    ds_read_b128 v[84:87], v9 offset:2320
    v_smfmac_f32_16x16x64_bf16 v[56:59], v[24:27], a[128:135], v2
    v_smfmac_f32_16x16x64_bf16 v[60:63], v[24:27], a[160:167], v2
    s_waitcnt lgkmcnt(4)
    s_barrier
    ds_read_b128 v[88:91], v11 offset:0
    ds_read_b128 v[92:95], v11 offset:2304
    ds_read_b128 v[96:99], v11 offset:16
    ds_read_b128 v[100:103], v11 offset:2320
    v_smfmac_f32_16x16x64_bf16 v[56:59], v[28:31], a[136:143], v2
    s_waitcnt lgkmcnt(6)
    v_pk_add_f32 v[72:73], v[72:73], v[76:77]
    v_pk_add_f32 v[74:75], v[74:75], v[78:79]
    v_cvt_pk_bf16_f32 v144, v72, v73
    v_cvt_pk_bf16_f32 v145, v74, v75
    s_waitcnt lgkmcnt(4)
    v_pk_add_f32 v[80:81], v[80:81], v[84:85]
    v_pk_add_f32 v[82:83], v[82:83], v[86:87]
    v_cvt_pk_bf16_f32 v146, v80, v81
    v_cvt_pk_bf16_f32 v147, v82, v83
    s_waitcnt lgkmcnt(2)
    v_pk_add_f32 v[88:89], v[88:89], v[92:93]
    v_pk_add_f32 v[90:91], v[90:91], v[94:95]
    v_cvt_pk_bf16_f32 v148, v88, v89
    v_cvt_pk_bf16_f32 v149, v90, v91
    s_waitcnt lgkmcnt(0)
    v_pk_add_f32 v[96:97], v[96:97], v[100:101]
    v_pk_add_f32 v[98:99], v[98:99], v[102:103]
    v_cvt_pk_bf16_f32 v150, v96, v97
    v_cvt_pk_bf16_f32 v151, v98, v99
    s_nop 1
    v_mfma_f32_16x16x32_bf16 v[196:199], v[148:151], v[144:147], 0
    v_smfmac_f32_16x16x64_bf16 v[60:63], v[28:31], a[168:175], v2
    v_smfmac_f32_16x16x64_bf16 v[56:59], v[32:35], a[144:151], v2
    v_pk_add_f32 v[196:197], v[196:197], v[198:199]
    s_nop 1
    v_add_f32_dpp v198, v196, v196 row_ror:8 row_mask:0xf bank_mask:0xf
    v_add_f32_dpp v199, v197, v197 row_ror:8 row_mask:0xf bank_mask:0xf
    v_cndmask_b32 v198, v199, v198, s[48:49]
    v_min_u32 v198, 0xfffffffe, v198
    buffer_store_dword v198, v10, s[8:11], s30 offen sc1
    v_smfmac_f32_16x16x64_bf16 v[60:63], v[32:35], a[176:183], v2
    v_smfmac_f32_16x16x64_bf16 v[56:59], v[36:39], a[152:159], v2
    v_smfmac_f32_16x16x64_bf16 v[60:63], v[36:39], a[184:191], v2
    v_mov_b32 v40, 0
    v_mov_b32 v41, 0
    v_mov_b32 v42, 0
    v_mov_b32 v43, 0
    v_mov_b32 v44, 0
    v_mov_b32 v45, 0
    v_mov_b32 v46, 0
    v_mov_b32 v47, 0
    v_permlane32_swap_b32 v56, v60
    v_permlane32_swap_b32 v57, v61
    v_permlane32_swap_b32 v58, v62
    v_permlane32_swap_b32 v59, v63
    v_pk_add_f32 v[56:57], v[56:57], v[60:61]
    v_pk_add_f32 v[58:59], v[58:59], v[62:63]
    v_cvt_pk_bf16_f32 v60, v56, v57
    v_cvt_pk_bf16_f32 v61, v58, v59
    ds_write2_b32 v255, v60, v61 offset0:0 offset1:64
    ds_write_b128 v8, v[56:59]
    s_waitcnt lgkmcnt(0)
    s_barrier
    s_cmp_eq_u32 s28, 63
    s_cbranch_scc1 .fin_186
    s_xor_b32 s38, s34, 0x4000
    s_xor_b32 s39, s34, 0x1000
    s_xor_b32 s40, s34, 0x5000
    v_mov_b32 v48, 0
    v_mov_b32 v49, 0
    v_mov_b32 v50, 0
    v_mov_b32 v51, 0
    v_mov_b32 v52, 0
    v_mov_b32 v53, 0
    v_mov_b32 v54, 0
    v_mov_b32 v55, 0
    v_mov_b32 v56, 0
    v_mov_b32 v57, 0
    v_mov_b32 v58, 0
    v_mov_b32 v59, 0
    v_mov_b32 v60, 0
    v_mov_b32 v61, 0
    v_mov_b32 v62, 0
    v_mov_b32 v63, 0
    s_barrier
    s_setprio 3
    buffer_load_dwordx4 v[24:27], v4, s[8:11], s30 offen offset:0 sc1
    s_setprio 2
    buffer_load_dwordx4 v[28:31], v4, s[8:11], s30 offen offset:1024 sc1
    s_setprio 1
    buffer_load_dwordx4 v[32:35], v4, s[8:11], s30 offen offset:2048 sc1
    s_setprio 0
    buffer_load_dwordx4 v[36:39], v4, s[8:11], s30 offen offset:3072 sc1
    s_call_b64 s[98:99], .gm_178
    s_nop 6
    v_permlane32_swap_b32 v64, v68
    v_permlane32_swap_b32 v65, v69
    v_permlane32_swap_b32 v66, v70
    v_permlane32_swap_b32 v67, v71
    v_pk_add_f32 v[64:65], v[64:65], v[68:69]
    v_pk_add_f32 v[66:67], v[66:67], v[70:71]
    ds_write2_b32 v7, v64, v65 offset0:0 offset1:36
    ds_write2_b32 v7, v66, v67 offset0:72 offset1:108
    s_waitcnt lgkmcnt(0)
    s_barrier
    ds_read_b128 v[72:75], v12 offset:0
    ds_read_b128 v[76:79], v12 offset:1152
    ds_read_b128 v[80:83], v12 offset:2304
    ds_read_b128 v[84:87], v12 offset:3456
    s_waitcnt lgkmcnt(2)
    v_pk_add_f32 v[72:73], v[72:73], v[76:77]
    v_pk_add_f32 v[74:75], v[74:75], v[78:79]
    s_waitcnt lgkmcnt(0)
    v_pk_add_f32 v[80:81], v[80:81], v[84:85]
    v_pk_add_f32 v[82:83], v[82:83], v[86:87]
    v_pk_add_f32 v[72:73], v[72:73], v[80:81]
    v_pk_add_f32 v[74:75], v[74:75], v[82:83]
    v_min_u32 v75, 0xfffffffe, v75
    buffer_store_dwordx4 v[72:75], v13, s[8:11], s34 offen sc1
    v_mov_b32 v64, 0
    v_mov_b32 v65, 0
    v_mov_b32 v66, 0
    v_mov_b32 v67, 0
    v_mov_b32 v68, 0
    v_mov_b32 v69, 0
    v_mov_b32 v70, 0
    v_mov_b32 v71, 0
    s_waitcnt vmcnt(0)
.pl_187:
    buffer_load_dwordx4 v[76:79], v13, s[8:11], s38 offen sc1
    buffer_load_dwordx4 v[80:83], v13, s[8:11], s39 offen sc1
    buffer_load_dwordx4 v[84:87], v13, s[8:11], s40 offen sc1
    s_waitcnt vmcnt(2)
    v_pk_add_f32 v[88:89], v[72:73], v[76:77]
    v_pk_add_f32 v[90:91], v[74:75], v[78:79]
    s_waitcnt vmcnt(0)
    v_max3_u32 v18, v79, v83, v87
    v_cmp_eq_u32 vcc, -1, v18
    v_pk_add_f32 v[80:81], v[80:81], v[84:85]
    v_pk_add_f32 v[82:83], v[82:83], v[86:87]
    v_pk_add_f32 v[88:89], v[88:89], v[80:81]
    v_pk_add_f32 v[90:91], v[90:91], v[82:83]
    v_cvt_pk_bf16_f32 v92, v88, v89
    v_cvt_pk_bf16_f32 v93, v90, v91
    v_min_u32 v93, 0xfffffffe, v93
    s_cbranch_vccnz .pr_188
    buffer_store_dwordx2 v[92:93], v14, s[8:11], s31 offen sc1
    s_mov_b32 s4, s30
    s_mov_b32 s30, s31
    s_mov_b32 s31, s32
    s_mov_b32 s32, s33
    s_mov_b32 s33, s4
    s_add_u32 s28, s28, 1
    s_mov_b32 s62, 0
    s_mov_b32 s4, s34
    s_mov_b32 s34, s35
    s_mov_b32 s35, s36
    s_mov_b32 s36, s37
    s_mov_b32 s37, s4
    s_branch .step_185
.fin_186:
    s_barrier
    s_waitcnt vmcnt(0)
    s_endpgm
.pr_188:
    s_add_u32 s62, s62, 1
    s_cmp_gt_u32 s62, 0x100000
    s_cbranch_scc1 .mg_end_1
    s_branch .pl_187
.w2_175:
    s_lshl_b32 s4, s56, 9
    s_lshl_b32 s5, s53, 7
    s_add_u32 s4, s4, s5
    s_add_u32 s4, s4, 92274688
    v_mov_b32 v14, s4
    v_bfe_u32 v254, v1, 0, 6
    v_mul_u32_u24 v12, 16, v254
    v_add_u32 v12, 18176, v12
    v_bfe_u32 v254, v1, 0, 6
    v_mul_u32_u24 v15, 16, v254
    s_add_u32 s42, s42, 262144
    s_add_u32 s43, s43, 262144
    s_add_u32 s44, s44, 262144
    s_mov_b32 exec_hi, 0
    v_xor_b32 v244, 1024, v244
    s_mov_b32 exec_hi, -1
    s_waitcnt vmcnt(0)
    ds_read_b64_tr_b16 a[192:193], v242 offset:16384
    ds_read_b64_tr_b16 a[194:195], v242 offset:16896
    ds_read_b64_tr_b16 a[196:197], v242 offset:18432
    ds_read_b64_tr_b16 a[198:199], v242 offset:18944
    ds_read_b64_tr_b16 a[200:201], v242 offset:20480
    ds_read_b64_tr_b16 a[202:203], v242 offset:20992
    ds_read_b64_tr_b16 a[204:205], v242 offset:22528
    ds_read_b64_tr_b16 a[206:207], v242 offset:23040
    ds_read_b64_tr_b16 a[208:209], v242 offset:24576
    ds_read_b64_tr_b16 a[210:211], v242 offset:25088
    ds_read_b64_tr_b16 a[212:213], v242 offset:26624
    ds_read_b64_tr_b16 a[214:215], v242 offset:27136
    ds_read_b64_tr_b16 a[216:217], v242 offset:28672
    ds_read_b64_tr_b16 a[218:219], v242 offset:29184
    ds_read_b64_tr_b16 a[220:221], v242 offset:30720
    ds_read_b64_tr_b16 a[222:223], v242 offset:31232
    ds_read_b64_tr_b16 a[224:225], v243 offset:16384
    ds_read_b64_tr_b16 a[226:227], v243 offset:16896
    ds_read_b64_tr_b16 a[228:229], v243 offset:18432
    ds_read_b64_tr_b16 a[230:231], v243 offset:18944
    ds_read_b64_tr_b16 a[232:233], v243 offset:20480
    ds_read_b64_tr_b16 a[234:235], v243 offset:20992
    ds_read_b64_tr_b16 a[236:237], v243 offset:22528
    ds_read_b64_tr_b16 a[238:239], v243 offset:23040
    ds_read_b64_tr_b16 a[240:241], v243 offset:24576
    ds_read_b64_tr_b16 a[242:243], v243 offset:25088
    ds_read_b64_tr_b16 a[244:245], v243 offset:26624
    ds_read_b64_tr_b16 a[246:247], v243 offset:27136
    ds_read_b64_tr_b16 a[248:249], v243 offset:28672
    ds_read_b64_tr_b16 a[250:251], v243 offset:29184
    ds_read_b64_tr_b16 a[252:253], v243 offset:30720
    ds_read_b64_tr_b16 a[254:255], v243 offset:31232
    s_waitcnt lgkmcnt(0)
    s_barrier
.p2align 6
.step_189:
    s_barrier
    s_setprio 3
    buffer_load_dwordx4 v[24:27], v3, s[8:11], s30 offen offset:0 sc1
    s_setprio 2
    buffer_load_dwordx4 v[28:31], v3, s[8:11], s30 offen offset:1024 sc1
    s_setprio 1
    buffer_load_dwordx4 v[32:35], v3, s[8:11], s30 offen offset:2048 sc1
    s_setprio 0
    buffer_load_dwordx4 v[36:39], v3, s[8:11], s30 offen offset:3072 sc1
    s_call_b64 s[98:99], .gm_177
    v_permlane32_swap_b32 v40, v44
    v_permlane32_swap_b32 v41, v45
    v_permlane32_swap_b32 v42, v46
    v_permlane32_swap_b32 v43, v47
    v_add_f32 v40, v40, v44
    v_add_f32 v41, v41, v45
    v_add_f32 v42, v42, v46
    v_add_f32 v43, v43, v47
    ds_write2_b32 v5, v40, v41 offset0:0 offset1:36
    ds_write2_b32 v5, v42, v43 offset0:72 offset1:108
    v_permlane32_swap_b32 v48, v52
    v_permlane32_swap_b32 v49, v53
    v_permlane32_swap_b32 v50, v54
    v_permlane32_swap_b32 v51, v55
    v_pk_add_f32 v[48:49], v[48:49], v[52:53]
    v_pk_add_f32 v[50:51], v[50:51], v[54:55]
    ds_write2_b32 v6, v48, v49 offset0:0 offset1:36
    ds_write2_b32 v6, v50, v51 offset0:72 offset1:108
    s_waitcnt lgkmcnt(2)
    s_barrier
    s_waitcnt lgkmcnt(0)
    s_barrier
    v_smfmac_f32_16x16x64_bf16 v[56:59], v[24:27], a[128:135], v2
    v_smfmac_f32_16x16x64_bf16 v[60:63], v[24:27], a[160:167], v2
    v_smfmac_f32_16x16x64_bf16 v[56:59], v[28:31], a[136:143], v2
    v_smfmac_f32_16x16x64_bf16 v[60:63], v[28:31], a[168:175], v2
    v_smfmac_f32_16x16x64_bf16 v[56:59], v[32:35], a[144:151], v2
    v_smfmac_f32_16x16x64_bf16 v[60:63], v[32:35], a[176:183], v2
    v_smfmac_f32_16x16x64_bf16 v[56:59], v[36:39], a[152:159], v2
    v_smfmac_f32_16x16x64_bf16 v[60:63], v[36:39], a[184:191], v2
    ds_read_b64 v[72:73], v9 offset:0
    ds_read_b64 v[74:75], v9 offset:1152
    ds_read_b64 v[76:77], v9 offset:2304
    ds_read_b64 v[78:79], v9 offset:3456
    s_waitcnt lgkmcnt(0)
    v_pk_add_f32 v[72:73], v[72:73], v[74:75]
    v_pk_add_f32 v[76:77], v[76:77], v[78:79]
    v_pk_add_f32 v[72:73], v[72:73], v[76:77]
    v_cvt_pk_bf16_f32 v72, v72, v73
    ds_write_b32 v11, v72
    v_mov_b32 v40, 0
    v_mov_b32 v41, 0
    v_mov_b32 v42, 0
    v_mov_b32 v43, 0
    v_mov_b32 v44, 0
    v_mov_b32 v45, 0
    v_mov_b32 v46, 0
    v_mov_b32 v47, 0
    v_permlane32_swap_b32 v56, v60
    v_permlane32_swap_b32 v57, v61
    v_permlane32_swap_b32 v58, v62
    v_permlane32_swap_b32 v59, v63
    v_pk_add_f32 v[56:57], v[56:57], v[60:61]
    v_pk_add_f32 v[58:59], v[58:59], v[62:63]
    v_cvt_pk_bf16_f32 v60, v56, v57
    v_cvt_pk_bf16_f32 v61, v58, v59
    ds_write2_b32 v255, v60, v61 offset0:0 offset1:64
    ds_write_b128 v8, v[56:59]
    s_waitcnt lgkmcnt(0)
    s_barrier
    s_cmp_eq_u32 s28, 63
    s_cbranch_scc1 .fin_190
    s_waitcnt lgkmcnt(0)
    v_mov_b32 v48, 0
    v_mov_b32 v49, 0
    v_mov_b32 v50, 0
    v_mov_b32 v51, 0
    v_mov_b32 v52, 0
    v_mov_b32 v53, 0
    v_mov_b32 v54, 0
    v_mov_b32 v55, 0
    v_mov_b32 v56, 0
    v_mov_b32 v57, 0
    v_mov_b32 v58, 0
    v_mov_b32 v59, 0
    v_mov_b32 v60, 0
    v_mov_b32 v61, 0
    v_mov_b32 v62, 0
    v_mov_b32 v63, 0
    s_barrier
    ds_read_b128 v[72:75], v12
    s_setprio 3
    buffer_load_dwordx4 v[24:27], v4, s[8:11], s30 offen offset:0 sc1
    s_setprio 2
    buffer_load_dwordx4 v[28:31], v4, s[8:11], s30 offen offset:1024 sc1
    s_setprio 1
    buffer_load_dwordx4 v[32:35], v4, s[8:11], s30 offen offset:2048 sc1
    s_setprio 0
    buffer_load_dwordx4 v[36:39], v4, s[8:11], s30 offen offset:3072 sc1
    s_call_b64 s[98:99], .gm_178
    s_waitcnt lgkmcnt(0)
    buffer_store_dwordx4 v[72:75], v244, s[8:11], s41 offen sc1
    s_nop 5
    v_permlane32_swap_b32 v64, v68
    v_permlane32_swap_b32 v65, v69
    v_permlane32_swap_b32 v66, v70
    v_permlane32_swap_b32 v67, v71
    v_pk_add_f32 v[64:65], v[64:65], v[68:69]
    v_pk_add_f32 v[66:67], v[66:67], v[70:71]
    ds_write2_b32 v7, v64, v65 offset0:0 offset1:36
    ds_write2_b32 v7, v66, v67 offset0:72 offset1:108
    s_waitcnt lgkmcnt(0)
    s_barrier
    s_cmp_lt_u32 s28, 52
    s_cselect_b32 s4, 1, 0
    s_andn2_b32 s4, s4, s28
    s_cbranch_scc1 .nl_191
    v_mov_b32 v18, s28
    v_add_u32 v18, 1, v18
    s_mov_b64 exec, 1
    s_waitcnt vmcnt(0)
    buffer_store_dword v18, v14, s[8:11], 0 offen sc1
    s_mov_b64 exec, -1
.nl_191:
    v_mov_b32 v64, 0
    v_mov_b32 v65, 0
    v_mov_b32 v66, 0
    v_mov_b32 v67, 0
    v_mov_b32 v68, 0
    v_mov_b32 v69, 0
    v_mov_b32 v70, 0
    v_mov_b32 v71, 0
    s_mov_b32 s4, s30
    s_mov_b32 s30, s31
    s_mov_b32 s31, s32
    s_mov_b32 s32, s33
    s_mov_b32 s33, s4
    s_add_u32 s28, s28, 1
    s_mov_b32 s62, 0
    s_add_u32 s41, s41, 0x20000
    s_branch .step_189
.fin_190:
    s_barrier
    ds_read_b128 v[72:75], v12
    s_waitcnt lgkmcnt(0)
    buffer_store_dwordx4 v[72:75], v244, s[8:11], s41 offen sc1
    s_waitcnt vmcnt(0)
    v_mov_b32 v18, 64
    s_mov_b64 exec, 1
    buffer_store_dword v18, v14, s[8:11], 0 offen sc1
    s_mov_b64 exec, -1
    s_endpgm
.w3_176:
    v_bfe_u32 v254, v1, 3, 1
    v_mul_u32_u24 v12, 512, v254
    v_bfe_u32 v254, v1, 5, 1
    v_mul_u32_u24 v254, 256, v254
    v_add_u32 v12, v12, v254
    v_bfe_u32 v254, v1, 2, 1
    v_mul_u32_u24 v254, 128, v254
    v_add_u32 v12, v12, v254
    v_bfe_u32 v254, v1, 0, 2
    v_mul_u32_u24 v254, 16, v254
    v_add_u32 v12, v12, v254
    v_bfe_u32 v254, v1, 4, 1
    v_mul_u32_u24 v254, 8, v254
    v_add_u32 v12, v12, v254
    v_add_u32 v12, 14080, v12
    v_bfe_u32 v254, v1, 2, 2
    v_mul_u32_u24 v14, 128, v254
    v_bfe_u32 v254, v1, 0, 2
    v_mul_u32_u24 v254, 16, v254
    v_add_u32 v14, v14, v254
    v_bfe_u32 v254, v1, 4, 2
    v_mul_u32_u24 v254, 4, v254
    v_add_u32 v14, v14, v254
    v_add_u32 v14, 18688, v14
    v_bfe_u32 v254, v1, 0, 6
    v_mul_u32_u24 v15, 16, v254
    v_add_u32 v15, s101, v15
    v_bfe_u32 v254, v1, 2, 2
    v_mul_u32_u24 v16, 128, v254
    v_bfe_u32 v254, v1, 0, 2
    v_mul_u32_u24 v254, 16, v254
    v_add_u32 v16, v16, v254
    v_bfe_u32 v254, v1, 4, 2
    v_mul_u32_u24 v254, 4, v254
    v_add_u32 v16, v16, v254
    v_add_u32 v16, 135168, v16
    v_add_u32 v16, s58, v16
    s_lshl_b32 s4, s56, 9
    s_add_u32 s4, s4, 92291072
    v_bfe_u32 v254, v1, 0, 2
    v_mul_u32_u24 v13, 128, v254
    v_bfe_u32 v254, v1, 2, 1
    v_mul_u32_u24 v254, 16384, v254
    v_add_u32 v13, v13, v254
    v_add_u32 v13, s4, v13
    s_waitcnt vmcnt(0)
    ds_read_b64_tr_b16 a[192:193], v242 offset:16384
    ds_read_b64_tr_b16 a[194:195], v242 offset:16896
    ds_read_b64_tr_b16 a[196:197], v242 offset:18432
    ds_read_b64_tr_b16 a[198:199], v242 offset:18944
    ds_read_b64_tr_b16 a[200:201], v242 offset:20480
    ds_read_b64_tr_b16 a[202:203], v242 offset:20992
    ds_read_b64_tr_b16 a[204:205], v242 offset:22528
    ds_read_b64_tr_b16 a[206:207], v242 offset:23040
    ds_read_b64_tr_b16 a[208:209], v242 offset:24576
    ds_read_b64_tr_b16 a[210:211], v242 offset:25088
    ds_read_b64_tr_b16 a[212:213], v242 offset:26624
    ds_read_b64_tr_b16 a[214:215], v242 offset:27136
    ds_read_b64_tr_b16 a[216:217], v242 offset:28672
    ds_read_b64_tr_b16 a[218:219], v242 offset:29184
    ds_read_b64_tr_b16 a[220:221], v242 offset:30720
    ds_read_b64_tr_b16 a[222:223], v242 offset:31232
    ds_read_b64_tr_b16 a[224:225], v243 offset:16384
    ds_read_b64_tr_b16 a[226:227], v243 offset:16896
    ds_read_b64_tr_b16 a[228:229], v243 offset:18432
    ds_read_b64_tr_b16 a[230:231], v243 offset:18944
    ds_read_b64_tr_b16 a[232:233], v243 offset:20480
    ds_read_b64_tr_b16 a[234:235], v243 offset:20992
    ds_read_b64_tr_b16 a[236:237], v243 offset:22528
    ds_read_b64_tr_b16 a[238:239], v243 offset:23040
    ds_read_b64_tr_b16 a[240:241], v243 offset:24576
    ds_read_b64_tr_b16 a[242:243], v243 offset:25088
    ds_read_b64_tr_b16 a[244:245], v243 offset:26624
    ds_read_b64_tr_b16 a[246:247], v243 offset:27136
    ds_read_b64_tr_b16 a[248:249], v243 offset:28672
    ds_read_b64_tr_b16 a[250:251], v243 offset:29184
    ds_read_b64_tr_b16 a[252:253], v243 offset:30720
    ds_read_b64_tr_b16 a[254:255], v243 offset:31232
    s_waitcnt lgkmcnt(0)
    s_cmp_ge_u32 s46, 1
    s_cbranch_scc1 .kvd_193
    s_mov_b32 s62, 0
.kv_192:
    buffer_load_dword v18, v13, s[8:11], 0 offen sc1
    s_add_u32 s62, s62, 1
    s_cmp_gt_u32 s62, 0x100000
    s_cbranch_scc1 .mg_end_1
    s_waitcnt vmcnt(0)
    v_min_u32_dpp v18, v18, v18 quad_perm:[1,0,3,2] row_mask:0xf bank_mask:0xf
    s_nop 1
    v_min_u32_dpp v18, v18, v18 quad_perm:[2,3,0,1] row_mask:0xf bank_mask:0xf
    s_nop 1
    v_min_u32_dpp v18, v18, v18 row_half_mirror row_mask:0xf bank_mask:0xf
    s_nop 0
    v_readfirstlane_b32 s46, v18
    s_cmp_lt_u32 s46, 1
    s_cbranch_scc1 .kv_192
.kvd_193:
    s_barrier
.p2align 6
.step_194:
    s_barrier
    s_setprio 3
    buffer_load_dwordx4 v[24:27], v3, s[8:11], s30 offen offset:0 sc1
    s_setprio 2
    buffer_load_dwordx4 v[28:31], v3, s[8:11], s30 offen offset:1024 sc1
    s_setprio 1
    buffer_load_dwordx4 v[32:35], v3, s[8:11], s30 offen offset:2048 sc1
    s_setprio 0
    buffer_load_dwordx4 v[36:39], v3, s[8:11], s30 offen offset:3072 sc1
    s_call_b64 s[98:99], .gm_177
    v_permlane32_swap_b32 v40, v44
    v_permlane32_swap_b32 v41, v45
    v_permlane32_swap_b32 v42, v46
    v_permlane32_swap_b32 v43, v47
    v_add_f32 v40, v40, v44
    v_add_f32 v41, v41, v45
    v_add_f32 v42, v42, v46
    v_add_f32 v43, v43, v47
    ds_write2_b32 v5, v40, v41 offset0:0 offset1:36
    ds_write2_b32 v5, v42, v43 offset0:72 offset1:108
    v_permlane32_swap_b32 v48, v52
    v_permlane32_swap_b32 v49, v53
    v_permlane32_swap_b32 v50, v54
    v_permlane32_swap_b32 v51, v55
    v_pk_add_f32 v[48:49], v[48:49], v[52:53]
    v_pk_add_f32 v[50:51], v[50:51], v[54:55]
    ds_write2_b32 v6, v48, v49 offset0:0 offset1:36
    ds_write2_b32 v6, v50, v51 offset0:72 offset1:108
    s_waitcnt lgkmcnt(2)
    s_barrier
    s_waitcnt lgkmcnt(0)
    s_barrier
    v_smfmac_f32_16x16x64_bf16 v[56:59], v[24:27], a[128:135], v2
    v_smfmac_f32_16x16x64_bf16 v[60:63], v[24:27], a[160:167], v2
    v_smfmac_f32_16x16x64_bf16 v[56:59], v[28:31], a[136:143], v2
    v_smfmac_f32_16x16x64_bf16 v[60:63], v[28:31], a[168:175], v2
    v_smfmac_f32_16x16x64_bf16 v[56:59], v[32:35], a[144:151], v2
    v_smfmac_f32_16x16x64_bf16 v[60:63], v[32:35], a[176:183], v2
    v_smfmac_f32_16x16x64_bf16 v[56:59], v[36:39], a[152:159], v2
    v_smfmac_f32_16x16x64_bf16 v[60:63], v[36:39], a[184:191], v2
    ds_read_b64 v[72:73], v9 offset:0
    ds_read_b64 v[74:75], v9 offset:1152
    ds_read_b64 v[76:77], v9 offset:2304
    ds_read_b64 v[78:79], v9 offset:3456
    s_waitcnt lgkmcnt(0)
    v_pk_add_f32 v[72:73], v[72:73], v[74:75]
    v_pk_add_f32 v[76:77], v[76:77], v[78:79]
    v_pk_add_f32 v[72:73], v[72:73], v[76:77]
    v_cvt_pk_bf16_f32 v72, v72, v73
    ds_write_b32 v11, v72
    v_mov_b32 v40, 0
    v_mov_b32 v41, 0
    v_mov_b32 v42, 0
    v_mov_b32 v43, 0
    v_mov_b32 v44, 0
    v_mov_b32 v45, 0
    v_mov_b32 v46, 0
    v_mov_b32 v47, 0
    v_permlane32_swap_b32 v56, v60
    v_permlane32_swap_b32 v57, v61
    v_permlane32_swap_b32 v58, v62
    v_permlane32_swap_b32 v59, v63
    v_pk_add_f32 v[56:57], v[56:57], v[60:61]
    v_pk_add_f32 v[58:59], v[58:59], v[62:63]
    v_cvt_pk_bf16_f32 v60, v56, v57
    v_cvt_pk_bf16_f32 v61, v58, v59
    ds_write2_b32 v255, v60, v61 offset0:0 offset1:64
    ds_write_b128 v8, v[56:59]
    s_waitcnt lgkmcnt(0)
    s_barrier
    ds_read_b64 v[72:73], v12 offset:0
    ds_read_b64 v[74:75], v12 offset:1024
    ds_read_b64 v[76:77], v12 offset:2048
    ds_read_b64 v[78:79], v12 offset:3072
    ds_read_b64 v[80:81], v12 offset:64
    ds_read_b64 v[82:83], v12 offset:1088
    ds_read_b64 v[84:85], v12 offset:2112
    ds_read_b64 v[86:87], v12 offset:3136
    s_waitcnt lgkmcnt(4)
    v_add_f32 v72, v72, v74
    v_add_f32 v73, v73, v75
    v_add_f32 v76, v76, v78
    v_add_f32 v77, v77, v79
    v_add_f32 v72, v72, v76
    v_add_f32 v73, v73, v77
    v_cvt_pk_bf16_f32 v72, v72, v73
    s_waitcnt lgkmcnt(0)
    v_add_f32 v80, v80, v82
    v_add_f32 v81, v81, v83
    v_add_f32 v84, v84, v86
    v_add_f32 v85, v85, v87
    v_add_f32 v80, v80, v84
    v_add_f32 v81, v81, v85
    v_cvt_pk_bf16_f32 v80, v80, v81
    ds_write_b32 v14, v72
    ds_write_b32 v14, v80 offset:64
    s_waitcnt lgkmcnt(0)
    s_cmp_eq_u32 s28, 63
    s_cbranch_scc1 .fin_195
    buffer_store_dwordx4 v[20:23], v246, s[8:11], s32 offen sc1
    buffer_store_dwordx4 v[20:23], v245, s[8:11], s32 offen sc1
    buffer_store_dword v20, v237, s[8:11], s32 offen sc1
    s_add_u32 s5, s28, 2
    s_cmp_ge_u32 s46, s5
    s_cbranch_scc1 .kvd_197
    s_mov_b32 s62, 0
.kv_196:
    buffer_load_dword v18, v13, s[8:11], 0 offen sc1
    s_add_u32 s62, s62, 1
    s_cmp_gt_u32 s62, 0x100000
    s_cbranch_scc1 .mg_end_1
    s_waitcnt vmcnt(0)
    v_min_u32_dpp v18, v18, v18 quad_perm:[1,0,3,2] row_mask:0xf bank_mask:0xf
    s_nop 1
    v_min_u32_dpp v18, v18, v18 quad_perm:[2,3,0,1] row_mask:0xf bank_mask:0xf
    s_nop 1
    v_min_u32_dpp v18, v18, v18 row_half_mirror row_mask:0xf bank_mask:0xf
    s_nop 0
    v_readfirstlane_b32 s46, v18
    s_cmp_lt_u32 s46, s5
    s_cbranch_scc1 .kv_196
.kvd_197:
    v_mov_b32 v48, 0
    v_mov_b32 v49, 0
    v_mov_b32 v50, 0
    v_mov_b32 v51, 0
    v_mov_b32 v52, 0
    v_mov_b32 v53, 0
    v_mov_b32 v54, 0
    v_mov_b32 v55, 0
    v_mov_b32 v56, 0
    v_mov_b32 v57, 0
    v_mov_b32 v58, 0
    v_mov_b32 v59, 0
    v_mov_b32 v60, 0
    v_mov_b32 v61, 0
    v_mov_b32 v62, 0
    v_mov_b32 v63, 0
    s_barrier
    s_setprio 3
    buffer_load_dwordx4 v[24:27], v4, s[8:11], s30 offen offset:0 sc1
    s_setprio 2
    buffer_load_dwordx4 v[28:31], v4, s[8:11], s30 offen offset:1024 sc1
    s_setprio 1
    buffer_load_dwordx4 v[32:35], v4, s[8:11], s30 offen offset:2048 sc1
    s_setprio 0
    buffer_load_dwordx4 v[36:39], v4, s[8:11], s30 offen offset:3072 sc1
    s_call_b64 s[98:99], .gm_178
    buffer_store_dwordx4 v[20:23], v15, s[8:11], s36 offen sc1
    s_nop 5
    v_permlane32_swap_b32 v64, v68
    v_permlane32_swap_b32 v65, v69
    v_permlane32_swap_b32 v66, v70
    v_permlane32_swap_b32 v67, v71
    v_pk_add_f32 v[64:65], v[64:65], v[68:69]
    v_pk_add_f32 v[66:67], v[66:67], v[70:71]
    ds_write2_b32 v7, v64, v65 offset0:0 offset1:36
    ds_write2_b32 v7, v66, v67 offset0:72 offset1:108
    s_waitcnt lgkmcnt(0)
    s_barrier
    s_add_u32 s5, s28, 3
    s_min_u32 s5, s5, 64
    s_cmp_ge_u32 s46, s5
    s_cbranch_scc1 .kvd_199
    s_mov_b32 s62, 0
.kv_198:
    buffer_load_dword v18, v13, s[8:11], 0 offen sc1
    s_add_u32 s62, s62, 1
    s_cmp_gt_u32 s62, 0x100000
    s_cbranch_scc1 .mg_end_1
    s_waitcnt vmcnt(0)
    v_min_u32_dpp v18, v18, v18 quad_perm:[1,0,3,2] row_mask:0xf bank_mask:0xf
    s_nop 1
    v_min_u32_dpp v18, v18, v18 quad_perm:[2,3,0,1] row_mask:0xf bank_mask:0xf
    s_nop 1
    v_min_u32_dpp v18, v18, v18 row_half_mirror row_mask:0xf bank_mask:0xf
    s_nop 0
    v_readfirstlane_b32 s46, v18
.kvd_199:
    v_mov_b32 v64, 0
    v_mov_b32 v65, 0
    v_mov_b32 v66, 0
    v_mov_b32 v67, 0
    v_mov_b32 v68, 0
    v_mov_b32 v69, 0
    v_mov_b32 v70, 0
    v_mov_b32 v71, 0
    s_mov_b32 s4, s30
    s_mov_b32 s30, s31
    s_mov_b32 s31, s32
    s_mov_b32 s32, s33
    s_mov_b32 s33, s4
    s_add_u32 s28, s28, 1
    s_mov_b32 s62, 0
    s_mov_b32 s4, s34
    s_mov_b32 s34, s35
    s_mov_b32 s35, s36
    s_mov_b32 s36, s37
    s_mov_b32 s37, s4
    s_add_u32 s41, s41, 0x20000
    s_branch .step_194
.fin_195:
    s_barrier
    s_endpgm
.p2align 6
.gm_177:
    s_waitcnt vmcnt(3)
    v_max_u32 v18, v25, v27
    v_cmp_eq_u32 vcc, -1, v18
    s_cbranch_vccnz .nk_200
.ok_201:
    v_smfmac_f32_16x16x64_bf16 v[40:43], v[24:27], a[0:7], v2
    v_smfmac_f32_16x16x64_bf16 v[44:47], v[24:27], a[32:39], v2
    s_waitcnt vmcnt(2)
    v_max_u32 v18, v29, v31
    v_cmp_eq_u32 vcc, -1, v18
    v_smfmac_f32_16x16x64_bf16 v[48:51], v[24:27], a[64:71], v2
    v_smfmac_f32_16x16x64_bf16 v[52:55], v[24:27], a[96:103], v2
    s_cbranch_vccnz .nk_202
.ok_203:
    v_smfmac_f32_16x16x64_bf16 v[40:43], v[28:31], a[8:15], v2
    v_smfmac_f32_16x16x64_bf16 v[44:47], v[28:31], a[40:47], v2
    s_waitcnt vmcnt(1)
    v_max_u32 v18, v33, v35
    v_cmp_eq_u32 vcc, -1, v18
    v_smfmac_f32_16x16x64_bf16 v[48:51], v[28:31], a[72:79], v2
    v_smfmac_f32_16x16x64_bf16 v[52:55], v[28:31], a[104:111], v2
    s_cbranch_vccnz .nk_204
.ok_205:
    v_smfmac_f32_16x16x64_bf16 v[40:43], v[32:35], a[16:23], v2
    v_smfmac_f32_16x16x64_bf16 v[44:47], v[32:35], a[48:55], v2
    s_waitcnt vmcnt(0)
    v_max_u32 v18, v37, v39
    v_cmp_eq_u32 vcc, -1, v18
    v_smfmac_f32_16x16x64_bf16 v[48:51], v[32:35], a[80:87], v2
    v_smfmac_f32_16x16x64_bf16 v[52:55], v[32:35], a[112:119], v2
    s_cbranch_vccnz .nk_206
.ok_207:
    v_smfmac_f32_16x16x64_bf16 v[40:43], v[36:39], a[24:31], v2
    v_smfmac_f32_16x16x64_bf16 v[44:47], v[36:39], a[56:63], v2
    v_smfmac_f32_16x16x64_bf16 v[48:51], v[36:39], a[88:95], v2
    v_smfmac_f32_16x16x64_bf16 v[52:55], v[36:39], a[120:127], v2
    s_setpc_b64 s[98:99]
.nk_200:
    buffer_load_dwordx4 v[24:27], v3, s[8:11], s30 offen offset:0 sc1
    s_add_u32 s62, s62, 1
    s_cmp_gt_u32 s62, 0x100000
    s_cbranch_scc1 .mg_end_1
    s_waitcnt vmcnt(3)
    v_max_u32 v18, v29, v31
    v_cmp_eq_u32 vcc, -1, v18
    s_cbranch_vccnz .nk_208
.ok_209:
    v_smfmac_f32_16x16x64_bf16 v[40:43], v[28:31], a[8:15], v2
    v_smfmac_f32_16x16x64_bf16 v[44:47], v[28:31], a[40:47], v2
    s_waitcnt vmcnt(2)
    v_max_u32 v18, v33, v35
    v_cmp_eq_u32 vcc, -1, v18
    v_smfmac_f32_16x16x64_bf16 v[48:51], v[28:31], a[72:79], v2
    v_smfmac_f32_16x16x64_bf16 v[52:55], v[28:31], a[104:111], v2
    s_cbranch_vccnz .nk_210
.ok_211:
    v_smfmac_f32_16x16x64_bf16 v[40:43], v[32:35], a[16:23], v2
    v_smfmac_f32_16x16x64_bf16 v[44:47], v[32:35], a[48:55], v2
    s_waitcnt vmcnt(1)
    v_max_u32 v18, v37, v39
    v_cmp_eq_u32 vcc, -1, v18
    v_smfmac_f32_16x16x64_bf16 v[48:51], v[32:35], a[80:87], v2
    v_smfmac_f32_16x16x64_bf16 v[52:55], v[32:35], a[112:119], v2
    s_cbranch_vccnz .nk_212
.ok_213:
    v_smfmac_f32_16x16x64_bf16 v[40:43], v[36:39], a[24:31], v2
    v_smfmac_f32_16x16x64_bf16 v[44:47], v[36:39], a[56:63], v2
    s_waitcnt vmcnt(0)
    v_max_u32 v18, v25, v27
    v_cmp_eq_u32 vcc, -1, v18
    v_smfmac_f32_16x16x64_bf16 v[48:51], v[36:39], a[88:95], v2
    v_smfmac_f32_16x16x64_bf16 v[52:55], v[36:39], a[120:127], v2
    s_cbranch_vccnz .nk_214
.ok_215:
    v_smfmac_f32_16x16x64_bf16 v[40:43], v[24:27], a[0:7], v2
    v_smfmac_f32_16x16x64_bf16 v[44:47], v[24:27], a[32:39], v2
    v_smfmac_f32_16x16x64_bf16 v[48:51], v[24:27], a[64:71], v2
    v_smfmac_f32_16x16x64_bf16 v[52:55], v[24:27], a[96:103], v2
    s_setpc_b64 s[98:99]
.nk_202:
    buffer_load_dwordx4 v[28:31], v3, s[8:11], s30 offen offset:1024 sc1
    s_add_u32 s62, s62, 1
    s_cmp_gt_u32 s62, 0x100000
    s_cbranch_scc1 .mg_end_1
    s_waitcnt vmcnt(2)
    v_max_u32 v18, v33, v35
    v_cmp_eq_u32 vcc, -1, v18
    s_cbranch_vccnz .nk_216
.ok_217:
    v_smfmac_f32_16x16x64_bf16 v[40:43], v[32:35], a[16:23], v2
    v_smfmac_f32_16x16x64_bf16 v[44:47], v[32:35], a[48:55], v2
    s_waitcnt vmcnt(1)
    v_max_u32 v18, v37, v39
    v_cmp_eq_u32 vcc, -1, v18
    v_smfmac_f32_16x16x64_bf16 v[48:51], v[32:35], a[80:87], v2
    v_smfmac_f32_16x16x64_bf16 v[52:55], v[32:35], a[112:119], v2
    s_cbranch_vccnz .nk_218
.ok_219:
    v_smfmac_f32_16x16x64_bf16 v[40:43], v[36:39], a[24:31], v2
    v_smfmac_f32_16x16x64_bf16 v[44:47], v[36:39], a[56:63], v2
    s_waitcnt vmcnt(0)
    v_max_u32 v18, v29, v31
    v_cmp_eq_u32 vcc, -1, v18
    v_smfmac_f32_16x16x64_bf16 v[48:51], v[36:39], a[88:95], v2
    v_smfmac_f32_16x16x64_bf16 v[52:55], v[36:39], a[120:127], v2
    s_cbranch_vccnz .nk_220
.ok_221:
    v_smfmac_f32_16x16x64_bf16 v[40:43], v[28:31], a[8:15], v2
    v_smfmac_f32_16x16x64_bf16 v[44:47], v[28:31], a[40:47], v2
    v_smfmac_f32_16x16x64_bf16 v[48:51], v[28:31], a[72:79], v2
    v_smfmac_f32_16x16x64_bf16 v[52:55], v[28:31], a[104:111], v2
    s_setpc_b64 s[98:99]
.nk_204:
    buffer_load_dwordx4 v[32:35], v3, s[8:11], s30 offen offset:2048 sc1
    s_add_u32 s62, s62, 1
    s_cmp_gt_u32 s62, 0x100000
    s_cbranch_scc1 .mg_end_1
    s_waitcnt vmcnt(1)
    v_max_u32 v18, v37, v39
    v_cmp_eq_u32 vcc, -1, v18
    s_cbranch_vccnz .nk_222
.ok_223:
    v_smfmac_f32_16x16x64_bf16 v[40:43], v[36:39], a[24:31], v2
    v_smfmac_f32_16x16x64_bf16 v[44:47], v[36:39], a[56:63], v2
    s_waitcnt vmcnt(0)
    v_max_u32 v18, v33, v35
    v_cmp_eq_u32 vcc, -1, v18
    v_smfmac_f32_16x16x64_bf16 v[48:51], v[36:39], a[88:95], v2
    v_smfmac_f32_16x16x64_bf16 v[52:55], v[36:39], a[120:127], v2
    s_cbranch_vccnz .nk_224
.ok_225:
    v_smfmac_f32_16x16x64_bf16 v[40:43], v[32:35], a[16:23], v2
    v_smfmac_f32_16x16x64_bf16 v[44:47], v[32:35], a[48:55], v2
    v_smfmac_f32_16x16x64_bf16 v[48:51], v[32:35], a[80:87], v2
    v_smfmac_f32_16x16x64_bf16 v[52:55], v[32:35], a[112:119], v2
    s_setpc_b64 s[98:99]
.nk_206:
    buffer_load_dwordx4 v[36:39], v3, s[8:11], s30 offen offset:3072 sc1
    s_add_u32 s62, s62, 1
    s_cmp_gt_u32 s62, 0x100000
    s_cbranch_scc1 .mg_end_1
    s_waitcnt vmcnt(0)
    v_max_u32 v18, v37, v39
    v_cmp_eq_u32 vcc, -1, v18
    s_cbranch_vccnz .nk_206
    s_branch .ok_207
.nk_208:
    buffer_load_dwordx4 v[28:31], v3, s[8:11], s30 offen offset:1024 sc1
    s_add_u32 s62, s62, 1
    s_cmp_gt_u32 s62, 0x100000
    s_cbranch_scc1 .mg_end_1
    s_waitcnt vmcnt(3)
    v_max_u32 v18, v33, v35
    v_cmp_eq_u32 vcc, -1, v18
    s_cbranch_vccnz .nk_226
.ok_227:
    v_smfmac_f32_16x16x64_bf16 v[40:43], v[32:35], a[16:23], v2
    v_smfmac_f32_16x16x64_bf16 v[44:47], v[32:35], a[48:55], v2
    s_waitcnt vmcnt(2)
    v_max_u32 v18, v37, v39
    v_cmp_eq_u32 vcc, -1, v18
    v_smfmac_f32_16x16x64_bf16 v[48:51], v[32:35], a[80:87], v2
    v_smfmac_f32_16x16x64_bf16 v[52:55], v[32:35], a[112:119], v2
    s_cbranch_vccnz .nk_228
.ok_229:
    v_smfmac_f32_16x16x64_bf16 v[40:43], v[36:39], a[24:31], v2
    v_smfmac_f32_16x16x64_bf16 v[44:47], v[36:39], a[56:63], v2
    s_waitcnt vmcnt(1)
    v_max_u32 v18, v25, v27
    v_cmp_eq_u32 vcc, -1, v18
    v_smfmac_f32_16x16x64_bf16 v[48:51], v[36:39], a[88:95], v2
    v_smfmac_f32_16x16x64_bf16 v[52:55], v[36:39], a[120:127], v2
    s_cbranch_vccnz .nk_230
.ok_231:
    v_smfmac_f32_16x16x64_bf16 v[40:43], v[24:27], a[0:7], v2
    v_smfmac_f32_16x16x64_bf16 v[44:47], v[24:27], a[32:39], v2
    s_waitcnt vmcnt(0)
    v_max_u32 v18, v29, v31
    v_cmp_eq_u32 vcc, -1, v18
    v_smfmac_f32_16x16x64_bf16 v[48:51], v[24:27], a[64:71], v2
    v_smfmac_f32_16x16x64_bf16 v[52:55], v[24:27], a[96:103], v2
    s_cbranch_vccnz .nk_220
    s_branch .ok_221
.nk_210:
    buffer_load_dwordx4 v[32:35], v3, s[8:11], s30 offen offset:2048 sc1
    s_add_u32 s62, s62, 1
    s_cmp_gt_u32 s62, 0x100000
    s_cbranch_scc1 .mg_end_1
    s_waitcnt vmcnt(2)
    v_max_u32 v18, v37, v39
    v_cmp_eq_u32 vcc, -1, v18
    s_cbranch_vccnz .nk_232
.ok_233:
    v_smfmac_f32_16x16x64_bf16 v[40:43], v[36:39], a[24:31], v2
    v_smfmac_f32_16x16x64_bf16 v[44:47], v[36:39], a[56:63], v2
    s_waitcnt vmcnt(1)
    v_max_u32 v18, v25, v27
    v_cmp_eq_u32 vcc, -1, v18
    v_smfmac_f32_16x16x64_bf16 v[48:51], v[36:39], a[88:95], v2
    v_smfmac_f32_16x16x64_bf16 v[52:55], v[36:39], a[120:127], v2
    s_cbranch_vccnz .nk_234
.ok_235:
    v_smfmac_f32_16x16x64_bf16 v[40:43], v[24:27], a[0:7], v2
    v_smfmac_f32_16x16x64_bf16 v[44:47], v[24:27], a[32:39], v2
    s_waitcnt vmcnt(0)
    v_max_u32 v18, v33, v35
    v_cmp_eq_u32 vcc, -1, v18
    v_smfmac_f32_16x16x64_bf16 v[48:51], v[24:27], a[64:71], v2
    v_smfmac_f32_16x16x64_bf16 v[52:55], v[24:27], a[96:103], v2
    s_cbranch_vccnz .nk_224
    s_branch .ok_225
.nk_212:
    buffer_load_dwordx4 v[36:39], v3, s[8:11], s30 offen offset:3072 sc1
    s_add_u32 s62, s62, 1
    s_cmp_gt_u32 s62, 0x100000
    s_cbranch_scc1 .mg_end_1
    s_waitcnt vmcnt(1)
    v_max_u32 v18, v25, v27
    v_cmp_eq_u32 vcc, -1, v18
    s_cbranch_vccnz .nk_236
.ok_237:
    v_smfmac_f32_16x16x64_bf16 v[40:43], v[24:27], a[0:7], v2
    v_smfmac_f32_16x16x64_bf16 v[44:47], v[24:27], a[32:39], v2
    s_waitcnt vmcnt(0)
    v_max_u32 v18, v37, v39
    v_cmp_eq_u32 vcc, -1, v18
    v_smfmac_f32_16x16x64_bf16 v[48:51], v[24:27], a[64:71], v2
    v_smfmac_f32_16x16x64_bf16 v[52:55], v[24:27], a[96:103], v2
    s_cbranch_vccnz .nk_206
    s_branch .ok_207
.nk_214:
    buffer_load_dwordx4 v[24:27], v3, s[8:11], s30 offen offset:0 sc1
    s_add_u32 s62, s62, 1
    s_cmp_gt_u32 s62, 0x100000
    s_cbranch_scc1 .mg_end_1
    s_waitcnt vmcnt(0)
    v_max_u32 v18, v25, v27
    v_cmp_eq_u32 vcc, -1, v18
    s_cbranch_vccnz .nk_214
    s_branch .ok_215
.nk_216:
    buffer_load_dwordx4 v[32:35], v3, s[8:11], s30 offen offset:2048 sc1
    s_add_u32 s62, s62, 1
    s_cmp_gt_u32 s62, 0x100000
    s_cbranch_scc1 .mg_end_1
    s_waitcnt vmcnt(2)
    v_max_u32 v18, v37, v39
    v_cmp_eq_u32 vcc, -1, v18
    s_cbranch_vccnz .nk_238
.ok_239:
    v_smfmac_f32_16x16x64_bf16 v[40:43], v[36:39], a[24:31], v2
    v_smfmac_f32_16x16x64_bf16 v[44:47], v[36:39], a[56:63], v2
    s_waitcnt vmcnt(1)
    v_max_u32 v18, v29, v31
    v_cmp_eq_u32 vcc, -1, v18
    v_smfmac_f32_16x16x64_bf16 v[48:51], v[36:39], a[88:95], v2
    v_smfmac_f32_16x16x64_bf16 v[52:55], v[36:39], a[120:127], v2
    s_cbranch_vccnz .nk_240
.ok_241:
    v_smfmac_f32_16x16x64_bf16 v[40:43], v[28:31], a[8:15], v2
    v_smfmac_f32_16x16x64_bf16 v[44:47], v[28:31], a[40:47], v2
    s_waitcnt vmcnt(0)
    v_max_u32 v18, v33, v35
    v_cmp_eq_u32 vcc, -1, v18
    v_smfmac_f32_16x16x64_bf16 v[48:51], v[28:31], a[72:79], v2
    v_smfmac_f32_16x16x64_bf16 v[52:55], v[28:31], a[104:111], v2
    s_cbranch_vccnz .nk_224
    s_branch .ok_225
.nk_218:
    buffer_load_dwordx4 v[36:39], v3, s[8:11], s30 offen offset:3072 sc1
    s_add_u32 s62, s62, 1
    s_cmp_gt_u32 s62, 0x100000
    s_cbranch_scc1 .mg_end_1
    s_waitcnt vmcnt(1)
    v_max_u32 v18, v29, v31
    v_cmp_eq_u32 vcc, -1, v18
    s_cbranch_vccnz .nk_242
.ok_243:
    v_smfmac_f32_16x16x64_bf16 v[40:43], v[28:31], a[8:15], v2
    v_smfmac_f32_16x16x64_bf16 v[44:47], v[28:31], a[40:47], v2
    s_waitcnt vmcnt(0)
    v_max_u32 v18, v37, v39
    v_cmp_eq_u32 vcc, -1, v18
    v_smfmac_f32_16x16x64_bf16 v[48:51], v[28:31], a[72:79], v2
    v_smfmac_f32_16x16x64_bf16 v[52:55], v[28:31], a[104:111], v2
    s_cbranch_vccnz .nk_206
    s_branch .ok_207
.nk_220:
    buffer_load_dwordx4 v[28:31], v3, s[8:11], s30 offen offset:1024 sc1
    s_add_u32 s62, s62, 1
    s_cmp_gt_u32 s62, 0x100000
    s_cbranch_scc1 .mg_end_1
    s_waitcnt vmcnt(0)
    v_max_u32 v18, v29, v31
    v_cmp_eq_u32 vcc, -1, v18
    s_cbranch_vccnz .nk_220
    s_branch .ok_221
.nk_222:
    buffer_load_dwordx4 v[36:39], v3, s[8:11], s30 offen offset:3072 sc1
    s_add_u32 s62, s62, 1
    s_cmp_gt_u32 s62, 0x100000
    s_cbranch_scc1 .mg_end_1
    s_waitcnt vmcnt(1)
    v_max_u32 v18, v33, v35
    v_cmp_eq_u32 vcc, -1, v18
    s_cbranch_vccnz .nk_204
    s_branch .ok_205
.nk_224:
    buffer_load_dwordx4 v[32:35], v3, s[8:11], s30 offen offset:2048 sc1
    s_add_u32 s62, s62, 1
    s_cmp_gt_u32 s62, 0x100000
    s_cbranch_scc1 .mg_end_1
    s_waitcnt vmcnt(0)
    v_max_u32 v18, v33, v35
    v_cmp_eq_u32 vcc, -1, v18
    s_cbranch_vccnz .nk_224
    s_branch .ok_225
.nk_226:
    buffer_load_dwordx4 v[32:35], v3, s[8:11], s30 offen offset:2048 sc1
    s_add_u32 s62, s62, 1
    s_cmp_gt_u32 s62, 0x100000
    s_cbranch_scc1 .mg_end_1
    s_waitcnt vmcnt(3)
    v_max_u32 v18, v37, v39
    v_cmp_eq_u32 vcc, -1, v18
    s_cbranch_vccnz .nk_244
.ok_245:
    v_smfmac_f32_16x16x64_bf16 v[40:43], v[36:39], a[24:31], v2
    v_smfmac_f32_16x16x64_bf16 v[44:47], v[36:39], a[56:63], v2
    s_waitcnt vmcnt(2)
    v_max_u32 v18, v25, v27
    v_cmp_eq_u32 vcc, -1, v18
    v_smfmac_f32_16x16x64_bf16 v[48:51], v[36:39], a[88:95], v2
    v_smfmac_f32_16x16x64_bf16 v[52:55], v[36:39], a[120:127], v2
    s_cbranch_vccnz .nk_246
.ok_247:
    v_smfmac_f32_16x16x64_bf16 v[40:43], v[24:27], a[0:7], v2
    v_smfmac_f32_16x16x64_bf16 v[44:47], v[24:27], a[32:39], v2
    s_waitcnt vmcnt(1)
    v_max_u32 v18, v29, v31
    v_cmp_eq_u32 vcc, -1, v18
    v_smfmac_f32_16x16x64_bf16 v[48:51], v[24:27], a[64:71], v2
    v_smfmac_f32_16x16x64_bf16 v[52:55], v[24:27], a[96:103], v2
    s_cbranch_vccnz .nk_240
    s_branch .ok_241
.nk_228:
    buffer_load_dwordx4 v[36:39], v3, s[8:11], s30 offen offset:3072 sc1
    s_add_u32 s62, s62, 1
    s_cmp_gt_u32 s62, 0x100000
    s_cbranch_scc1 .mg_end_1
    s_waitcnt vmcnt(2)
    v_max_u32 v18, v25, v27
    v_cmp_eq_u32 vcc, -1, v18
    s_cbranch_vccnz .nk_248
.ok_249:
    v_smfmac_f32_16x16x64_bf16 v[40:43], v[24:27], a[0:7], v2
    v_smfmac_f32_16x16x64_bf16 v[44:47], v[24:27], a[32:39], v2
    s_waitcnt vmcnt(1)
    v_max_u32 v18, v29, v31
    v_cmp_eq_u32 vcc, -1, v18
    v_smfmac_f32_16x16x64_bf16 v[48:51], v[24:27], a[64:71], v2
    v_smfmac_f32_16x16x64_bf16 v[52:55], v[24:27], a[96:103], v2
    s_cbranch_vccnz .nk_242
    s_branch .ok_243
.nk_230:
    buffer_load_dwordx4 v[24:27], v3, s[8:11], s30 offen offset:0 sc1
    s_add_u32 s62, s62, 1
    s_cmp_gt_u32 s62, 0x100000
    s_cbranch_scc1 .mg_end_1
    s_waitcnt vmcnt(1)
    v_max_u32 v18, v29, v31
    v_cmp_eq_u32 vcc, -1, v18
    s_cbranch_vccnz .nk_250
.ok_251:
    v_smfmac_f32_16x16x64_bf16 v[40:43], v[28:31], a[8:15], v2
    v_smfmac_f32_16x16x64_bf16 v[44:47], v[28:31], a[40:47], v2
    s_waitcnt vmcnt(0)
    v_max_u32 v18, v25, v27
    v_cmp_eq_u32 vcc, -1, v18
    v_smfmac_f32_16x16x64_bf16 v[48:51], v[28:31], a[72:79], v2
    v_smfmac_f32_16x16x64_bf16 v[52:55], v[28:31], a[104:111], v2
    s_cbranch_vccnz .nk_214
    s_branch .ok_215
.nk_232:
    buffer_load_dwordx4 v[36:39], v3, s[8:11], s30 offen offset:3072 sc1
    s_add_u32 s62, s62, 1
    s_cmp_gt_u32 s62, 0x100000
    s_cbranch_scc1 .mg_end_1
    s_waitcnt vmcnt(2)
    v_max_u32 v18, v25, v27
    v_cmp_eq_u32 vcc, -1, v18
    s_cbranch_vccnz .nk_252
.ok_253:
    v_smfmac_f32_16x16x64_bf16 v[40:43], v[24:27], a[0:7], v2
    v_smfmac_f32_16x16x64_bf16 v[44:47], v[24:27], a[32:39], v2
    s_waitcnt vmcnt(1)
    v_max_u32 v18, v33, v35
    v_cmp_eq_u32 vcc, -1, v18
    v_smfmac_f32_16x16x64_bf16 v[48:51], v[24:27], a[64:71], v2
    v_smfmac_f32_16x16x64_bf16 v[52:55], v[24:27], a[96:103], v2
    s_cbranch_vccnz .nk_204
    s_branch .ok_205
.nk_234:
    buffer_load_dwordx4 v[24:27], v3, s[8:11], s30 offen offset:0 sc1
    s_add_u32 s62, s62, 1
    s_cmp_gt_u32 s62, 0x100000
    s_cbranch_scc1 .mg_end_1
    s_waitcnt vmcnt(1)
    v_max_u32 v18, v33, v35
    v_cmp_eq_u32 vcc, -1, v18
    s_cbranch_vccnz .nk_254
.ok_255:
    v_smfmac_f32_16x16x64_bf16 v[40:43], v[32:35], a[16:23], v2
    v_smfmac_f32_16x16x64_bf16 v[44:47], v[32:35], a[48:55], v2
    s_waitcnt vmcnt(0)
    v_max_u32 v18, v25, v27
    v_cmp_eq_u32 vcc, -1, v18
    v_smfmac_f32_16x16x64_bf16 v[48:51], v[32:35], a[80:87], v2
    v_smfmac_f32_16x16x64_bf16 v[52:55], v[32:35], a[112:119], v2
    s_cbranch_vccnz .nk_214
    s_branch .ok_215
.nk_236:
    buffer_load_dwordx4 v[24:27], v3, s[8:11], s30 offen offset:0 sc1
    s_add_u32 s62, s62, 1
    s_cmp_gt_u32 s62, 0x100000
    s_cbranch_scc1 .mg_end_1
    s_waitcnt vmcnt(1)
    v_max_u32 v18, v37, v39
    v_cmp_eq_u32 vcc, -1, v18
    s_cbranch_vccnz .nk_212
    s_branch .ok_213
.nk_238:
    buffer_load_dwordx4 v[36:39], v3, s[8:11], s30 offen offset:3072 sc1
    s_add_u32 s62, s62, 1
    s_cmp_gt_u32 s62, 0x100000
    s_cbranch_scc1 .mg_end_1
    s_waitcnt vmcnt(2)
    v_max_u32 v18, v29, v31
    v_cmp_eq_u32 vcc, -1, v18
    s_cbranch_vccnz .nk_202
    s_branch .ok_203
.nk_240:
    buffer_load_dwordx4 v[28:31], v3, s[8:11], s30 offen offset:1024 sc1
    s_add_u32 s62, s62, 1
    s_cmp_gt_u32 s62, 0x100000
    s_cbranch_scc1 .mg_end_1
    s_waitcnt vmcnt(1)
    v_max_u32 v18, v33, v35
    v_cmp_eq_u32 vcc, -1, v18
    s_cbranch_vccnz .nk_256
.ok_257:
    v_smfmac_f32_16x16x64_bf16 v[40:43], v[32:35], a[16:23], v2
    v_smfmac_f32_16x16x64_bf16 v[44:47], v[32:35], a[48:55], v2
    s_waitcnt vmcnt(0)
    v_max_u32 v18, v29, v31
    v_cmp_eq_u32 vcc, -1, v18
    v_smfmac_f32_16x16x64_bf16 v[48:51], v[32:35], a[80:87], v2
    v_smfmac_f32_16x16x64_bf16 v[52:55], v[32:35], a[112:119], v2
    s_cbranch_vccnz .nk_220
    s_branch .ok_221
.nk_242:
    buffer_load_dwordx4 v[28:31], v3, s[8:11], s30 offen offset:1024 sc1
    s_add_u32 s62, s62, 1
    s_cmp_gt_u32 s62, 0x100000
    s_cbranch_scc1 .mg_end_1
    s_waitcnt vmcnt(1)
    v_max_u32 v18, v37, v39
    v_cmp_eq_u32 vcc, -1, v18
    s_cbranch_vccnz .nk_218
    s_branch .ok_219
.nk_244:
    buffer_load_dwordx4 v[36:39], v3, s[8:11], s30 offen offset:3072 sc1
    s_add_u32 s62, s62, 1
    s_cmp_gt_u32 s62, 0x100000
    s_cbranch_scc1 .mg_end_1
    s_waitcnt vmcnt(3)
    v_max_u32 v18, v25, v27
    v_cmp_eq_u32 vcc, -1, v18
    s_cbranch_vccnz .nk_200
    s_branch .ok_201
.nk_246:
    buffer_load_dwordx4 v[24:27], v3, s[8:11], s30 offen offset:0 sc1
    s_add_u32 s62, s62, 1
    s_cmp_gt_u32 s62, 0x100000
    s_cbranch_scc1 .mg_end_1
    s_waitcnt vmcnt(2)
    v_max_u32 v18, v29, v31
    v_cmp_eq_u32 vcc, -1, v18
    s_cbranch_vccnz .nk_258
.ok_259:
    v_smfmac_f32_16x16x64_bf16 v[40:43], v[28:31], a[8:15], v2
    v_smfmac_f32_16x16x64_bf16 v[44:47], v[28:31], a[40:47], v2
    s_waitcnt vmcnt(1)
    v_max_u32 v18, v33, v35
    v_cmp_eq_u32 vcc, -1, v18
    v_smfmac_f32_16x16x64_bf16 v[48:51], v[28:31], a[72:79], v2
    v_smfmac_f32_16x16x64_bf16 v[52:55], v[28:31], a[104:111], v2
    s_cbranch_vccnz .nk_254
    s_branch .ok_255
.nk_248:
    buffer_load_dwordx4 v[24:27], v3, s[8:11], s30 offen offset:0 sc1
    s_add_u32 s62, s62, 1
    s_cmp_gt_u32 s62, 0x100000
    s_cbranch_scc1 .mg_end_1
    s_waitcnt vmcnt(2)
    v_max_u32 v18, v29, v31
    v_cmp_eq_u32 vcc, -1, v18
    s_cbranch_vccnz .nk_260
.ok_261:
    v_smfmac_f32_16x16x64_bf16 v[40:43], v[28:31], a[8:15], v2
    v_smfmac_f32_16x16x64_bf16 v[44:47], v[28:31], a[40:47], v2
    s_waitcnt vmcnt(1)
    v_max_u32 v18, v37, v39
    v_cmp_eq_u32 vcc, -1, v18
    v_smfmac_f32_16x16x64_bf16 v[48:51], v[28:31], a[72:79], v2
    v_smfmac_f32_16x16x64_bf16 v[52:55], v[28:31], a[104:111], v2
    s_cbranch_vccnz .nk_212
    s_branch .ok_213
.nk_250:
    buffer_load_dwordx4 v[28:31], v3, s[8:11], s30 offen offset:1024 sc1
    s_add_u32 s62, s62, 1
    s_cmp_gt_u32 s62, 0x100000
    s_cbranch_scc1 .mg_end_1
    s_waitcnt vmcnt(1)
    v_max_u32 v18, v25, v27
    v_cmp_eq_u32 vcc, -1, v18
    s_cbranch_vccnz .nk_230
    s_branch .ok_231
.nk_252:
    buffer_load_dwordx4 v[24:27], v3, s[8:11], s30 offen offset:0 sc1
    s_add_u32 s62, s62, 1
    s_cmp_gt_u32 s62, 0x100000
    s_cbranch_scc1 .mg_end_1
    s_waitcnt vmcnt(2)
    v_max_u32 v18, v33, v35
    v_cmp_eq_u32 vcc, -1, v18
    s_cbranch_vccnz .nk_210
    s_branch .ok_211
.nk_254:
    buffer_load_dwordx4 v[32:35], v3, s[8:11], s30 offen offset:2048 sc1
    s_add_u32 s62, s62, 1
    s_cmp_gt_u32 s62, 0x100000
    s_cbranch_scc1 .mg_end_1
    s_waitcnt vmcnt(1)
    v_max_u32 v18, v25, v27
    v_cmp_eq_u32 vcc, -1, v18
    s_cbranch_vccnz .nk_234
    s_branch .ok_235
.nk_256:
    buffer_load_dwordx4 v[32:35], v3, s[8:11], s30 offen offset:2048 sc1
    s_add_u32 s62, s62, 1
    s_cmp_gt_u32 s62, 0x100000
    s_cbranch_scc1 .mg_end_1
    s_waitcnt vmcnt(1)
    v_max_u32 v18, v29, v31
    v_cmp_eq_u32 vcc, -1, v18
    s_cbranch_vccnz .nk_240
    s_branch .ok_241
.nk_258:
    buffer_load_dwordx4 v[28:31], v3, s[8:11], s30 offen offset:1024 sc1
    s_add_u32 s62, s62, 1
    s_cmp_gt_u32 s62, 0x100000
    s_cbranch_scc1 .mg_end_1
    s_waitcnt vmcnt(2)
    v_max_u32 v18, v33, v35
    v_cmp_eq_u32 vcc, -1, v18
    s_cbranch_vccnz .nk_262
.ok_263:
    v_smfmac_f32_16x16x64_bf16 v[40:43], v[32:35], a[16:23], v2
    v_smfmac_f32_16x16x64_bf16 v[44:47], v[32:35], a[48:55], v2
    s_waitcnt vmcnt(1)
    v_max_u32 v18, v25, v27
    v_cmp_eq_u32 vcc, -1, v18
    v_smfmac_f32_16x16x64_bf16 v[48:51], v[32:35], a[80:87], v2
    v_smfmac_f32_16x16x64_bf16 v[52:55], v[32:35], a[112:119], v2
    s_cbranch_vccnz .nk_230
    s_branch .ok_231
.nk_260:
    buffer_load_dwordx4 v[28:31], v3, s[8:11], s30 offen offset:1024 sc1
    s_add_u32 s62, s62, 1
    s_cmp_gt_u32 s62, 0x100000
    s_cbranch_scc1 .mg_end_1
    s_waitcnt vmcnt(2)
    v_max_u32 v18, v37, v39
    v_cmp_eq_u32 vcc, -1, v18
    s_cbranch_vccnz .nk_228
    s_branch .ok_229
.nk_262:
    buffer_load_dwordx4 v[32:35], v3, s[8:11], s30 offen offset:2048 sc1
    s_add_u32 s62, s62, 1
    s_cmp_gt_u32 s62, 0x100000
    s_cbranch_scc1 .mg_end_1
    s_waitcnt vmcnt(2)
    v_max_u32 v18, v25, v27
    v_cmp_eq_u32 vcc, -1, v18
    s_cbranch_vccnz .nk_246
    s_branch .ok_247
.p2align 6
.gm_178:
    s_waitcnt vmcnt(3)
    v_cmp_eq_u32 vcc, -1, v27
    s_cbranch_vccnz .nk_264
.ok_265:
    v_smfmac_f32_16x16x64_bf16 v[64:67], v[24:27], a[192:199], v2
    s_waitcnt vmcnt(2)
    v_cmp_eq_u32 vcc, -1, v31
    v_smfmac_f32_16x16x64_bf16 v[68:71], v[24:27], a[224:231], v2
    s_cbranch_vccnz .nk_266
.ok_267:
    v_smfmac_f32_16x16x64_bf16 v[64:67], v[28:31], a[200:207], v2
    s_waitcnt vmcnt(1)
    v_cmp_eq_u32 vcc, -1, v35
    v_smfmac_f32_16x16x64_bf16 v[68:71], v[28:31], a[232:239], v2
    s_cbranch_vccnz .nk_268
.ok_269:
    v_smfmac_f32_16x16x64_bf16 v[64:67], v[32:35], a[208:215], v2
    s_waitcnt vmcnt(0)
    v_cmp_eq_u32 vcc, -1, v39
    v_smfmac_f32_16x16x64_bf16 v[68:71], v[32:35], a[240:247], v2
    s_cbranch_vccnz .nk_270
.ok_271:
    v_smfmac_f32_16x16x64_bf16 v[64:67], v[36:39], a[216:223], v2
    v_smfmac_f32_16x16x64_bf16 v[68:71], v[36:39], a[248:255], v2
    s_setpc_b64 s[98:99]
.nk_264:
    buffer_load_dwordx4 v[24:27], v4, s[8:11], s30 offen offset:0 sc1
    s_add_u32 s62, s62, 1
    s_cmp_gt_u32 s62, 0x100000
    s_cbranch_scc1 .mg_end_1
    s_waitcnt vmcnt(3)
    v_cmp_eq_u32 vcc, -1, v31
    s_cbranch_vccnz .nk_272
.ok_273:
    v_smfmac_f32_16x16x64_bf16 v[64:67], v[28:31], a[200:207], v2
    s_waitcnt vmcnt(2)
    v_cmp_eq_u32 vcc, -1, v35
    v_smfmac_f32_16x16x64_bf16 v[68:71], v[28:31], a[232:239], v2
    s_cbranch_vccnz .nk_274
.ok_275:
    v_smfmac_f32_16x16x64_bf16 v[64:67], v[32:35], a[208:215], v2
    s_waitcnt vmcnt(1)
    v_cmp_eq_u32 vcc, -1, v39
    v_smfmac_f32_16x16x64_bf16 v[68:71], v[32:35], a[240:247], v2
    s_cbranch_vccnz .nk_276
.ok_277:
    v_smfmac_f32_16x16x64_bf16 v[64:67], v[36:39], a[216:223], v2
    s_waitcnt vmcnt(0)
    v_cmp_eq_u32 vcc, -1, v27
    v_smfmac_f32_16x16x64_bf16 v[68:71], v[36:39], a[248:255], v2
    s_cbranch_vccnz .nk_278
.ok_279:
    v_smfmac_f32_16x16x64_bf16 v[64:67], v[24:27], a[192:199], v2
    v_smfmac_f32_16x16x64_bf16 v[68:71], v[24:27], a[224:231], v2
    s_setpc_b64 s[98:99]
.nk_266:
    buffer_load_dwordx4 v[28:31], v4, s[8:11], s30 offen offset:1024 sc1
    s_add_u32 s62, s62, 1
    s_cmp_gt_u32 s62, 0x100000
    s_cbranch_scc1 .mg_end_1
    s_waitcnt vmcnt(2)
    v_cmp_eq_u32 vcc, -1, v35
    s_cbranch_vccnz .nk_280
.ok_281:
    v_smfmac_f32_16x16x64_bf16 v[64:67], v[32:35], a[208:215], v2
    s_waitcnt vmcnt(1)
    v_cmp_eq_u32 vcc, -1, v39
    v_smfmac_f32_16x16x64_bf16 v[68:71], v[32:35], a[240:247], v2
    s_cbranch_vccnz .nk_282
.ok_283:
    v_smfmac_f32_16x16x64_bf16 v[64:67], v[36:39], a[216:223], v2
    s_waitcnt vmcnt(0)
    v_cmp_eq_u32 vcc, -1, v31
    v_smfmac_f32_16x16x64_bf16 v[68:71], v[36:39], a[248:255], v2
    s_cbranch_vccnz .nk_284
.ok_285:
    v_smfmac_f32_16x16x64_bf16 v[64:67], v[28:31], a[200:207], v2
    v_smfmac_f32_16x16x64_bf16 v[68:71], v[28:31], a[232:239], v2
    s_setpc_b64 s[98:99]
.nk_268:
    buffer_load_dwordx4 v[32:35], v4, s[8:11], s30 offen offset:2048 sc1
    s_add_u32 s62, s62, 1
    s_cmp_gt_u32 s62, 0x100000
    s_cbranch_scc1 .mg_end_1
    s_waitcnt vmcnt(1)
    v_cmp_eq_u32 vcc, -1, v39
    s_cbranch_vccnz .nk_286
.ok_287:
    v_smfmac_f32_16x16x64_bf16 v[64:67], v[36:39], a[216:223], v2
    s_waitcnt vmcnt(0)
    v_cmp_eq_u32 vcc, -1, v35
    v_smfmac_f32_16x16x64_bf16 v[68:71], v[36:39], a[248:255], v2
    s_cbranch_vccnz .nk_288
.ok_289:
    v_smfmac_f32_16x16x64_bf16 v[64:67], v[32:35], a[208:215], v2
    v_smfmac_f32_16x16x64_bf16 v[68:71], v[32:35], a[240:247], v2
    s_setpc_b64 s[98:99]
.nk_270:
    buffer_load_dwordx4 v[36:39], v4, s[8:11], s30 offen offset:3072 sc1
    s_add_u32 s62, s62, 1
    s_cmp_gt_u32 s62, 0x100000
    s_cbranch_scc1 .mg_end_1
    s_waitcnt vmcnt(0)
    v_cmp_eq_u32 vcc, -1, v39
    s_cbranch_vccnz .nk_270
    s_branch .ok_271
.nk_272:
    buffer_load_dwordx4 v[28:31], v4, s[8:11], s30 offen offset:1024 sc1
    s_add_u32 s62, s62, 1
    s_cmp_gt_u32 s62, 0x100000
    s_cbranch_scc1 .mg_end_1
    s_waitcnt vmcnt(3)
    v_cmp_eq_u32 vcc, -1, v35
    s_cbranch_vccnz .nk_290
.ok_291:
    v_smfmac_f32_16x16x64_bf16 v[64:67], v[32:35], a[208:215], v2
    s_waitcnt vmcnt(2)
    v_cmp_eq_u32 vcc, -1, v39
    v_smfmac_f32_16x16x64_bf16 v[68:71], v[32:35], a[240:247], v2
    s_cbranch_vccnz .nk_292
.ok_293:
    v_smfmac_f32_16x16x64_bf16 v[64:67], v[36:39], a[216:223], v2
    s_waitcnt vmcnt(1)
    v_cmp_eq_u32 vcc, -1, v27
    v_smfmac_f32_16x16x64_bf16 v[68:71], v[36:39], a[248:255], v2
    s_cbranch_vccnz .nk_294
.ok_295:
    v_smfmac_f32_16x16x64_bf16 v[64:67], v[24:27], a[192:199], v2
    s_waitcnt vmcnt(0)
    v_cmp_eq_u32 vcc, -1, v31
    v_smfmac_f32_16x16x64_bf16 v[68:71], v[24:27], a[224:231], v2
    s_cbranch_vccnz .nk_284
    s_branch .ok_285
.nk_274:
    buffer_load_dwordx4 v[32:35], v4, s[8:11], s30 offen offset:2048 sc1
    s_add_u32 s62, s62, 1
    s_cmp_gt_u32 s62, 0x100000
    s_cbranch_scc1 .mg_end_1
    s_waitcnt vmcnt(2)
    v_cmp_eq_u32 vcc, -1, v39
    s_cbranch_vccnz .nk_296
.ok_297:
    v_smfmac_f32_16x16x64_bf16 v[64:67], v[36:39], a[216:223], v2
    s_waitcnt vmcnt(1)
    v_cmp_eq_u32 vcc, -1, v27
    v_smfmac_f32_16x16x64_bf16 v[68:71], v[36:39], a[248:255], v2
    s_cbranch_vccnz .nk_298
.ok_299:
    v_smfmac_f32_16x16x64_bf16 v[64:67], v[24:27], a[192:199], v2
    s_waitcnt vmcnt(0)
    v_cmp_eq_u32 vcc, -1, v35
    v_smfmac_f32_16x16x64_bf16 v[68:71], v[24:27], a[224:231], v2
    s_cbranch_vccnz .nk_288
    s_branch .ok_289
.nk_276:
    buffer_load_dwordx4 v[36:39], v4, s[8:11], s30 offen offset:3072 sc1
    s_add_u32 s62, s62, 1
    s_cmp_gt_u32 s62, 0x100000
    s_cbranch_scc1 .mg_end_1
    s_waitcnt vmcnt(1)
    v_cmp_eq_u32 vcc, -1, v27
    s_cbranch_vccnz .nk_300
.ok_301:
    v_smfmac_f32_16x16x64_bf16 v[64:67], v[24:27], a[192:199], v2
    s_waitcnt vmcnt(0)
    v_cmp_eq_u32 vcc, -1, v39
    v_smfmac_f32_16x16x64_bf16 v[68:71], v[24:27], a[224:231], v2
    s_cbranch_vccnz .nk_270
    s_branch .ok_271
.nk_278:
    buffer_load_dwordx4 v[24:27], v4, s[8:11], s30 offen offset:0 sc1
    s_add_u32 s62, s62, 1
    s_cmp_gt_u32 s62, 0x100000
    s_cbranch_scc1 .mg_end_1
    s_waitcnt vmcnt(0)
    v_cmp_eq_u32 vcc, -1, v27
    s_cbranch_vccnz .nk_278
    s_branch .ok_279
.nk_280:
    buffer_load_dwordx4 v[32:35], v4, s[8:11], s30 offen offset:2048 sc1
    s_add_u32 s62, s62, 1
    s_cmp_gt_u32 s62, 0x100000
    s_cbranch_scc1 .mg_end_1
    s_waitcnt vmcnt(2)
    v_cmp_eq_u32 vcc, -1, v39
    s_cbranch_vccnz .nk_302
.ok_303:
    v_smfmac_f32_16x16x64_bf16 v[64:67], v[36:39], a[216:223], v2
    s_waitcnt vmcnt(1)
    v_cmp_eq_u32 vcc, -1, v31
    v_smfmac_f32_16x16x64_bf16 v[68:71], v[36:39], a[248:255], v2
    s_cbranch_vccnz .nk_304
.ok_305:
    v_smfmac_f32_16x16x64_bf16 v[64:67], v[28:31], a[200:207], v2
    s_waitcnt vmcnt(0)
    v_cmp_eq_u32 vcc, -1, v35
    v_smfmac_f32_16x16x64_bf16 v[68:71], v[28:31], a[232:239], v2
    s_cbranch_vccnz .nk_288
    s_branch .ok_289
.nk_282:
    buffer_load_dwordx4 v[36:39], v4, s[8:11], s30 offen offset:3072 sc1
    s_add_u32 s62, s62, 1
    s_cmp_gt_u32 s62, 0x100000
    s_cbranch_scc1 .mg_end_1
    s_waitcnt vmcnt(1)
    v_cmp_eq_u32 vcc, -1, v31
    s_cbranch_vccnz .nk_306
.ok_307:
    v_smfmac_f32_16x16x64_bf16 v[64:67], v[28:31], a[200:207], v2
    s_waitcnt vmcnt(0)
    v_cmp_eq_u32 vcc, -1, v39
    v_smfmac_f32_16x16x64_bf16 v[68:71], v[28:31], a[232:239], v2
    s_cbranch_vccnz .nk_270
    s_branch .ok_271
.nk_284:
    buffer_load_dwordx4 v[28:31], v4, s[8:11], s30 offen offset:1024 sc1
    s_add_u32 s62, s62, 1
    s_cmp_gt_u32 s62, 0x100000
    s_cbranch_scc1 .mg_end_1
    s_waitcnt vmcnt(0)
    v_cmp_eq_u32 vcc, -1, v31
    s_cbranch_vccnz .nk_284
    s_branch .ok_285
.nk_286:
    buffer_load_dwordx4 v[36:39], v4, s[8:11], s30 offen offset:3072 sc1
    s_add_u32 s62, s62, 1
    s_cmp_gt_u32 s62, 0x100000
    s_cbranch_scc1 .mg_end_1
    s_waitcnt vmcnt(1)
    v_cmp_eq_u32 vcc, -1, v35
    s_cbranch_vccnz .nk_268
    s_branch .ok_269
.nk_288:
    buffer_load_dwordx4 v[32:35], v4, s[8:11], s30 offen offset:2048 sc1
    s_add_u32 s62, s62, 1
    s_cmp_gt_u32 s62, 0x100000
    s_cbranch_scc1 .mg_end_1
    s_waitcnt vmcnt(0)
    v_cmp_eq_u32 vcc, -1, v35
    s_cbranch_vccnz .nk_288
    s_branch .ok_289
.nk_290:
    buffer_load_dwordx4 v[32:35], v4, s[8:11], s30 offen offset:2048 sc1
    s_add_u32 s62, s62, 1
    s_cmp_gt_u32 s62, 0x100000
    s_cbranch_scc1 .mg_end_1
    s_waitcnt vmcnt(3)
    v_cmp_eq_u32 vcc, -1, v39
    s_cbranch_vccnz .nk_308
.ok_309:
    v_smfmac_f32_16x16x64_bf16 v[64:67], v[36:39], a[216:223], v2
    s_waitcnt vmcnt(2)
    v_cmp_eq_u32 vcc, -1, v27
    v_smfmac_f32_16x16x64_bf16 v[68:71], v[36:39], a[248:255], v2
    s_cbranch_vccnz .nk_310
.ok_311:
    v_smfmac_f32_16x16x64_bf16 v[64:67], v[24:27], a[192:199], v2
    s_waitcnt vmcnt(1)
    v_cmp_eq_u32 vcc, -1, v31
    v_smfmac_f32_16x16x64_bf16 v[68:71], v[24:27], a[224:231], v2
    s_cbranch_vccnz .nk_304
    s_branch .ok_305
.nk_292:
    buffer_load_dwordx4 v[36:39], v4, s[8:11], s30 offen offset:3072 sc1
    s_add_u32 s62, s62, 1
    s_cmp_gt_u32 s62, 0x100000
    s_cbranch_scc1 .mg_end_1
    s_waitcnt vmcnt(2)
    v_cmp_eq_u32 vcc, -1, v27
    s_cbranch_vccnz .nk_312
.ok_313:
    v_smfmac_f32_16x16x64_bf16 v[64:67], v[24:27], a[192:199], v2
    s_waitcnt vmcnt(1)
    v_cmp_eq_u32 vcc, -1, v31
    v_smfmac_f32_16x16x64_bf16 v[68:71], v[24:27], a[224:231], v2
    s_cbranch_vccnz .nk_306
    s_branch .ok_307
.nk_294:
    buffer_load_dwordx4 v[24:27], v4, s[8:11], s30 offen offset:0 sc1
    s_add_u32 s62, s62, 1
    s_cmp_gt_u32 s62, 0x100000
    s_cbranch_scc1 .mg_end_1
    s_waitcnt vmcnt(1)
    v_cmp_eq_u32 vcc, -1, v31
    s_cbranch_vccnz .nk_314
.ok_315:
    v_smfmac_f32_16x16x64_bf16 v[64:67], v[28:31], a[200:207], v2
    s_waitcnt vmcnt(0)
    v_cmp_eq_u32 vcc, -1, v27
    v_smfmac_f32_16x16x64_bf16 v[68:71], v[28:31], a[232:239], v2
    s_cbranch_vccnz .nk_278
    s_branch .ok_279
.nk_296:
    buffer_load_dwordx4 v[36:39], v4, s[8:11], s30 offen offset:3072 sc1
    s_add_u32 s62, s62, 1
    s_cmp_gt_u32 s62, 0x100000
    s_cbranch_scc1 .mg_end_1
    s_waitcnt vmcnt(2)
    v_cmp_eq_u32 vcc, -1, v27
    s_cbranch_vccnz .nk_316
.ok_317:
    v_smfmac_f32_16x16x64_bf16 v[64:67], v[24:27], a[192:199], v2
    s_waitcnt vmcnt(1)
    v_cmp_eq_u32 vcc, -1, v35
    v_smfmac_f32_16x16x64_bf16 v[68:71], v[24:27], a[224:231], v2
    s_cbranch_vccnz .nk_268
    s_branch .ok_269
.nk_298:
    buffer_load_dwordx4 v[24:27], v4, s[8:11], s30 offen offset:0 sc1
    s_add_u32 s62, s62, 1
    s_cmp_gt_u32 s62, 0x100000
    s_cbranch_scc1 .mg_end_1
    s_waitcnt vmcnt(1)
    v_cmp_eq_u32 vcc, -1, v35
    s_cbranch_vccnz .nk_318
.ok_319:
    v_smfmac_f32_16x16x64_bf16 v[64:67], v[32:35], a[208:215], v2
    s_waitcnt vmcnt(0)
    v_cmp_eq_u32 vcc, -1, v27
    v_smfmac_f32_16x16x64_bf16 v[68:71], v[32:35], a[240:247], v2
    s_cbranch_vccnz .nk_278
    s_branch .ok_279
.nk_300:
    buffer_load_dwordx4 v[24:27], v4, s[8:11], s30 offen offset:0 sc1
    s_add_u32 s62, s62, 1
    s_cmp_gt_u32 s62, 0x100000
    s_cbranch_scc1 .mg_end_1
    s_waitcnt vmcnt(1)
    v_cmp_eq_u32 vcc, -1, v39
    s_cbranch_vccnz .nk_276
    s_branch .ok_277
.nk_302:
    buffer_load_dwordx4 v[36:39], v4, s[8:11], s30 offen offset:3072 sc1
    s_add_u32 s62, s62, 1
    s_cmp_gt_u32 s62, 0x100000
    s_cbranch_scc1 .mg_end_1
    s_waitcnt vmcnt(2)
    v_cmp_eq_u32 vcc, -1, v31
    s_cbranch_vccnz .nk_266
    s_branch .ok_267
.nk_304:
    buffer_load_dwordx4 v[28:31], v4, s[8:11], s30 offen offset:1024 sc1
    s_add_u32 s62, s62, 1
    s_cmp_gt_u32 s62, 0x100000
    s_cbranch_scc1 .mg_end_1
    s_waitcnt vmcnt(1)
    v_cmp_eq_u32 vcc, -1, v35
    s_cbranch_vccnz .nk_320
.ok_321:
    v_smfmac_f32_16x16x64_bf16 v[64:67], v[32:35], a[208:215], v2
    s_waitcnt vmcnt(0)
    v_cmp_eq_u32 vcc, -1, v31
    v_smfmac_f32_16x16x64_bf16 v[68:71], v[32:35], a[240:247], v2
    s_cbranch_vccnz .nk_284
    s_branch .ok_285
.nk_306:
    buffer_load_dwordx4 v[28:31], v4, s[8:11], s30 offen offset:1024 sc1
    s_add_u32 s62, s62, 1
    s_cmp_gt_u32 s62, 0x100000
    s_cbranch_scc1 .mg_end_1
    s_waitcnt vmcnt(1)
    v_cmp_eq_u32 vcc, -1, v39
    s_cbranch_vccnz .nk_282
    s_branch .ok_283
.nk_308:
    buffer_load_dwordx4 v[36:39], v4, s[8:11], s30 offen offset:3072 sc1
    s_add_u32 s62, s62, 1
    s_cmp_gt_u32 s62, 0x100000
    s_cbranch_scc1 .mg_end_1
    s_waitcnt vmcnt(3)
    v_cmp_eq_u32 vcc, -1, v27
    s_cbranch_vccnz .nk_264
    s_branch .ok_265
.nk_310:
    buffer_load_dwordx4 v[24:27], v4, s[8:11], s30 offen offset:0 sc1
    s_add_u32 s62, s62, 1
    s_cmp_gt_u32 s62, 0x100000
    s_cbranch_scc1 .mg_end_1
    s_waitcnt vmcnt(2)
    v_cmp_eq_u32 vcc, -1, v31
    s_cbranch_vccnz .nk_322
.ok_323:
    v_smfmac_f32_16x16x64_bf16 v[64:67], v[28:31], a[200:207], v2
    s_waitcnt vmcnt(1)
    v_cmp_eq_u32 vcc, -1, v35
    v_smfmac_f32_16x16x64_bf16 v[68:71], v[28:31], a[232:239], v2
    s_cbranch_vccnz .nk_318
    s_branch .ok_319
.nk_312:
    buffer_load_dwordx4 v[24:27], v4, s[8:11], s30 offen offset:0 sc1
    s_add_u32 s62, s62, 1
    s_cmp_gt_u32 s62, 0x100000
    s_cbranch_scc1 .mg_end_1
    s_waitcnt vmcnt(2)
    v_cmp_eq_u32 vcc, -1, v31
    s_cbranch_vccnz .nk_324
.ok_325:
    v_smfmac_f32_16x16x64_bf16 v[64:67], v[28:31], a[200:207], v2
    s_waitcnt vmcnt(1)
    v_cmp_eq_u32 vcc, -1, v39
    v_smfmac_f32_16x16x64_bf16 v[68:71], v[28:31], a[232:239], v2
    s_cbranch_vccnz .nk_276
    s_branch .ok_277
.nk_314:
    buffer_load_dwordx4 v[28:31], v4, s[8:11], s30 offen offset:1024 sc1
    s_add_u32 s62, s62, 1
    s_cmp_gt_u32 s62, 0x100000
    s_cbranch_scc1 .mg_end_1
    s_waitcnt vmcnt(1)
    v_cmp_eq_u32 vcc, -1, v27
    s_cbranch_vccnz .nk_294
    s_branch .ok_295
.nk_316:
    buffer_load_dwordx4 v[24:27], v4, s[8:11], s30 offen offset:0 sc1
    s_add_u32 s62, s62, 1
    s_cmp_gt_u32 s62, 0x100000
    s_cbranch_scc1 .mg_end_1
    s_waitcnt vmcnt(2)
    v_cmp_eq_u32 vcc, -1, v35
    s_cbranch_vccnz .nk_274
    s_branch .ok_275
.nk_318:
    buffer_load_dwordx4 v[32:35], v4, s[8:11], s30 offen offset:2048 sc1
    s_add_u32 s62, s62, 1
    s_cmp_gt_u32 s62, 0x100000
    s_cbranch_scc1 .mg_end_1
    s_waitcnt vmcnt(1)
    v_cmp_eq_u32 vcc, -1, v27
    s_cbranch_vccnz .nk_298
    s_branch .ok_299
.nk_320:
    buffer_load_dwordx4 v[32:35], v4, s[8:11], s30 offen offset:2048 sc1
    s_add_u32 s62, s62, 1
    s_cmp_gt_u32 s62, 0x100000
    s_cbranch_scc1 .mg_end_1
    s_waitcnt vmcnt(1)
    v_cmp_eq_u32 vcc, -1, v31
    s_cbranch_vccnz .nk_304
    s_branch .ok_305
.nk_322:
    buffer_load_dwordx4 v[28:31], v4, s[8:11], s30 offen offset:1024 sc1
    s_add_u32 s62, s62, 1
    s_cmp_gt_u32 s62, 0x100000
    s_cbranch_scc1 .mg_end_1
    s_waitcnt vmcnt(2)
    v_cmp_eq_u32 vcc, -1, v35
    s_cbranch_vccnz .nk_326
.ok_327:
    v_smfmac_f32_16x16x64_bf16 v[64:67], v[32:35], a[208:215], v2
    s_waitcnt vmcnt(1)
    v_cmp_eq_u32 vcc, -1, v27
    v_smfmac_f32_16x16x64_bf16 v[68:71], v[32:35], a[240:247], v2
    s_cbranch_vccnz .nk_294
    s_branch .ok_295
.nk_324:
    buffer_load_dwordx4 v[28:31], v4, s[8:11], s30 offen offset:1024 sc1
    s_add_u32 s62, s62, 1
    s_cmp_gt_u32 s62, 0x100000
    s_cbranch_scc1 .mg_end_1
    s_waitcnt vmcnt(2)
    v_cmp_eq_u32 vcc, -1, v39
    s_cbranch_vccnz .nk_292
    s_branch .ok_293
.nk_326:
    buffer_load_dwordx4 v[32:35], v4, s[8:11], s30 offen offset:2048 sc1
    s_add_u32 s62, s62, 1
    s_cmp_gt_u32 s62, 0x100000
    s_cbranch_scc1 .mg_end_1
    s_waitcnt vmcnt(2)
    v_cmp_eq_u32 vcc, -1, v27
    s_cbranch_vccnz .nk_310
    s_branch .ok_311
.mg_bg_2:
    s_lshr_b32 s98, s26, 3
    s_add_u32 s98, s98, 1
    s_and_b32 s98, s98, 3
    s_and_b32 s99, s25, 3
    s_lshl_b32 s99, s99, 3
    s_and_b32 s4, s26, 7
    s_add_u32 s99, s99, s4
    s_mov_b32 s96, 0
    v_and_b32 v1, 63, v0
    v_mov_b32 v250, 0
    v_mov_b32 v251, 0
    s_bitcmp0_b32 s26, 4
    s_cbranch_scc1 .qkv_329
    s_bfe_u32 s95, s26, 0x10003
    s_load_dwordx2 s[40:41], s[0:1], 0
    s_waitcnt vmcnt(0)
    s_barrier
    s_cmp_lg_u32 s24, 1
    s_cbranch_scc1 .ns_330
    s_mov_b64 exec, 1
    v_mov_b32 v238, s3
    v_mov_b32 v239, 0
    buffer_atomic_add v238, v239, s[20:23], 0 offen offset:196 sc1
    s_mov_b64 exec, -1
.ns_330:
    s_and_b32 s4, s26, 15
    s_lshl_b32 s4, s4, 2
    s_add_u32 s4, s4, s24
    s_lshl_b32 s5, s4, 13
    v_lshlrev_b32 v6, 7, v1
    s_waitcnt lgkmcnt(0)
    s_mov_b32 s12, s40
    s_and_b32 s13, s41, 0xffff
    s_mov_b32 s14, 0x400000
    s_mov_b32 s15, 0x00020000
    buffer_load_dword v7, v6, s[12:15], s5 offen
    s_and_b32 s5, s25, 3
    s_lshl_b32 s5, s5, 6
    s_add_u32 s4, s4, s5
    s_lshl_b32 s4, s4, 14
    s_add_u32 s4, s4, 0x80000
    v_add_u32 v6, s4, v6
    v_add_u32 v8, 0x2000, v6
    s_cmp_lg_u32 s24, 0
    s_cbranch_scc1 .aw_331
    s_mov_b32 s62, 0
.aw_332:
    s_sleep 64
    s_add_u32 s62, s62, 1
    s_cmp_gt_u32 s62, 0x200000
    s_cbranch_scc1 .mg_end_1
    v_or_b32 v239, 32, v1
    v_lshlrev_b32 v239, 2, v239
    buffer_load_dword v238, v239, s[20:23], 0 offen sc1
    s_waitcnt vmcnt(0)
    v_readlane_b32 s4, v238, 49
    s_and_b32 s5, s4, 0xffff
    s_cmp_lt_u32 s5, 256
    s_cbranch_scc1 .aw_332
    s_lshr_b32 s4, s4, 16
    s_cbranch_scc1 .aw_331
    s_and_b32 s4, s99, 30
    s_lshl_b32 s4, s4, 9
    s_lshl_b32 s5, s95, 14
    s_add_u32 s4, s4, s5
    s_and_b32 s5, s99, 1
    s_lshl_b32 s5, s5, 7
    s_add_u32 s4, s4, s5
    s_lshl_b32 s4, s99, 9
    s_add_u32 s4, s4, 92291072
    v_mov_b32 v5, 0
    s_mov_b32 s62, 0
.aw_333:
    buffer_load_dword v4, v5, s[8:11], s4 offen sc1
    s_add_u32 s62, s62, 1
    s_cmp_gt_u32 s62, 0x200000
    s_cbranch_scc1 .mg_end_1
    s_waitcnt vmcnt(0)
    v_readfirstlane_b32 s5, v4
    s_cmp_ge_u32 s5, 2
    s_cbranch_scc1 .aw_331
    s_sleep 16
    s_branch .aw_333
.aw_331:
    s_barrier
    v_or_b32 v239, 32, v1
    v_lshlrev_b32 v239, 2, v239
    buffer_load_dword v238, v239, s[20:23], 0 offen sc1
    s_waitcnt vmcnt(0)
    s_cmp_lg_u32 s27, 0
    s_cbranch_scc1 .vd_335
    s_mov_b32 s62, 0
.vp_334:
    v_readlane_b32 s4, v238, 49
    s_and_b32 s5, s4, 0xffff
    s_cmp_ge_u32 s5, 256
    s_cbranch_scc1 .va_336
    s_add_u32 s62, s62, 1
    s_cmp_gt_u32 s62, 0x100000
    s_cbranch_scc1 .mg_end_1
    s_sleep 16
    buffer_load_dword v238, v239, s[20:23], 0 offen sc1
    s_waitcnt vmcnt(0)
    s_branch .vp_334
.va_336:
    s_lshr_b32 s4, s4, 16
    s_cbranch_scc0 .vd_335
    s_lshr_b32 s25, s2, 5
    s_and_b32 s26, s2, 31
    s_mov_b32 s27, 1
    s_waitcnt vmcnt(0) lgkmcnt(0)
    s_barrier
    s_branch .mg_role_3
.vd_335:
    s_cmp_eq_u32 s98, 3
    s_cbranch_scc1 .ph2_328
.qkv_329:
    s_lshl_b32 s4, s98, 3
    s_add_u32 s4, s4, 64
    s_load_dwordx2 s[40:41], s[0:1], 0
    s_load_dwordx2 s[42:43], s[0:1], s4
    s_lshl_b32 s4, s99, 8
    s_lshl_b32 s6, s24, 14
    s_mul_i32 s5, s24, 524288
    s_add_u32 s4, s4, s5
    v_bfe_u32 v2, v1, 4, 1
    v_lshlrev_b32 v2, 2, v2
    v_and_b32 v3, 7, v1
    v_xor_b32 v2, v2, v3
    v_lshlrev_b32 v2, 4, v2
    v_bfe_u32 v254, v1, 3, 2
    v_mul_u32_u24 v240, 8192, v254
    v_bfe_u32 v254, v1, 5, 1
    v_mul_u32_u24 v254, 128, v254
    v_add_u32 v240, v240, v254
    v_add_u32 v240, s4, v240
    v_add_u32 v240, v2, v240
    s_lshr_b32 s5, s24, 1
    s_lshl_b32 s5, s5, 9
    v_bfe_u32 v2, v1, 3, 1
    v_xor_b32 v2, s24, v2
    v_and_b32 v2, 1, v2
    v_lshlrev_b32 v2, 6, v2
    v_bfe_u32 v254, v1, 4, 2
    v_mul_u32_u24 v242, 2048, v254
    v_bfe_u32 v254, v1, 2, 2
    v_mul_u32_u24 v254, 128, v254
    v_add_u32 v242, v242, v254
    v_bfe_u32 v254, v1, 0, 2
    v_mul_u32_u24 v254, 16, v254
    v_add_u32 v242, v242, v254
    v_add_u32 v242, s5, v242
    v_add_u32 v242, v2, v242
    v_add_u32 v243, 0x10000, v242
    s_waitcnt lgkmcnt(0)
    s_mov_b32 s12, s40
    s_and_b32 s13, s41, 0xffff
    s_mov_b32 s14, 0x400000
    s_mov_b32 s15, 0x00020000
    s_mov_b32 s16, s42
    s_and_b32 s17, s43, 0xffff
    s_mov_b32 s18, 0x800000
    s_mov_b32 s19, 0x00020000
    s_add_u32 m0, s6, 0
    s_mov_b32 s5, 0
    buffer_load_dwordx4 v240, s[16:19], s5 offen nt lds
    s_add_u32 m0, s6, 1024
    s_mov_b32 s5, 32768
    buffer_load_dwordx4 v240, s[16:19], s5 offen nt lds
    s_add_u32 m0, s6, 2048
    s_mov_b32 s5, 65536
    buffer_load_dwordx4 v240, s[16:19], s5 offen nt lds
    s_add_u32 m0, s6, 3072
    s_mov_b32 s5, 98304
    buffer_load_dwordx4 v240, s[16:19], s5 offen nt lds
    s_add_u32 m0, s6, 4096
    s_mov_b32 s5, 131072
    buffer_load_dwordx4 v240, s[16:19], s5 offen nt lds
    s_add_u32 m0, s6, 5120
    s_mov_b32 s5, 163840
    buffer_load_dwordx4 v240, s[16:19], s5 offen nt lds
    s_add_u32 m0, s6, 6144
    s_mov_b32 s5, 196608
    buffer_load_dwordx4 v240, s[16:19], s5 offen nt lds
    s_add_u32 m0, s6, 7168
    s_mov_b32 s5, 229376
    buffer_load_dwordx4 v240, s[16:19], s5 offen nt lds
    s_add_u32 m0, s6, 8192
    s_mov_b32 s5, 262144
    buffer_load_dwordx4 v240, s[16:19], s5 offen nt lds
    s_add_u32 m0, s6, 9216
    s_mov_b32 s5, 294912
    buffer_load_dwordx4 v240, s[16:19], s5 offen nt lds
    s_add_u32 m0, s6, 10240
    s_mov_b32 s5, 327680
    buffer_load_dwordx4 v240, s[16:19], s5 offen nt lds
    s_add_u32 m0, s6, 11264
    s_mov_b32 s5, 360448
    buffer_load_dwordx4 v240, s[16:19], s5 offen nt lds
    s_add_u32 m0, s6, 12288
    s_mov_b32 s5, 393216
    buffer_load_dwordx4 v240, s[16:19], s5 offen nt lds
    s_add_u32 m0, s6, 13312
    s_mov_b32 s5, 425984
    buffer_load_dwordx4 v240, s[16:19], s5 offen nt lds
    s_add_u32 m0, s6, 14336
    s_mov_b32 s5, 458752
    buffer_load_dwordx4 v240, s[16:19], s5 offen nt lds
    s_add_u32 m0, s6, 15360
    s_mov_b32 s5, 491520
    buffer_load_dwordx4 v240, s[16:19], s5 offen nt lds
    s_waitcnt vmcnt(16)
    s_barrier
    s_cmp_lg_u32 s24, 1
    s_cbranch_scc1 .ns_337
    s_mov_b64 exec, 1
    v_mov_b32 v238, s3
    v_mov_b32 v239, 0
    buffer_atomic_add v238, v239, s[20:23], 0 offen offset:196 sc1
    s_mov_b64 exec, -1
.ns_337:
    s_add_u32 m0, s6, 65536
    s_mov_b32 s5, 2097152
    buffer_load_dwordx4 v240, s[16:19], s5 offen nt lds
    s_add_u32 m0, s6, 66560
    s_mov_b32 s5, 2129920
    buffer_load_dwordx4 v240, s[16:19], s5 offen nt lds
    s_add_u32 m0, s6, 67584
    s_mov_b32 s5, 2162688
    buffer_load_dwordx4 v240, s[16:19], s5 offen nt lds
    s_add_u32 m0, s6, 68608
    s_mov_b32 s5, 2195456
    buffer_load_dwordx4 v240, s[16:19], s5 offen nt lds
    s_add_u32 m0, s6, 69632
    s_mov_b32 s5, 2228224
    buffer_load_dwordx4 v240, s[16:19], s5 offen nt lds
    s_add_u32 m0, s6, 70656
    s_mov_b32 s5, 2260992
    buffer_load_dwordx4 v240, s[16:19], s5 offen nt lds
    s_add_u32 m0, s6, 71680
    s_mov_b32 s5, 2293760
    buffer_load_dwordx4 v240, s[16:19], s5 offen nt lds
    s_add_u32 m0, s6, 72704
    s_mov_b32 s5, 2326528
    buffer_load_dwordx4 v240, s[16:19], s5 offen nt lds
    s_add_u32 m0, s6, 73728
    s_mov_b32 s5, 2359296
    buffer_load_dwordx4 v240, s[16:19], s5 offen nt lds
    s_add_u32 m0, s6, 74752
    s_mov_b32 s5, 2392064
    buffer_load_dwordx4 v240, s[16:19], s5 offen nt lds
    s_add_u32 m0, s6, 75776
    s_mov_b32 s5, 2424832
    buffer_load_dwordx4 v240, s[16:19], s5 offen nt lds
    s_add_u32 m0, s6, 76800
    s_mov_b32 s5, 2457600
    buffer_load_dwordx4 v240, s[16:19], s5 offen nt lds
    s_add_u32 m0, s6, 77824
    s_mov_b32 s5, 2490368
    buffer_load_dwordx4 v240, s[16:19], s5 offen nt lds
    s_add_u32 m0, s6, 78848
    s_mov_b32 s5, 2523136
    buffer_load_dwordx4 v240, s[16:19], s5 offen nt lds
    s_add_u32 m0, s6, 79872
    s_mov_b32 s5, 2555904
    buffer_load_dwordx4 v240, s[16:19], s5 offen nt lds
    s_add_u32 m0, s6, 80896
    s_mov_b32 s5, 2588672
    buffer_load_dwordx4 v240, s[16:19], s5 offen nt lds
    v_and_b32 v2, 15, v1
    v_lshrrev_b32 v3, 4, v1
    v_lshlrev_b32 v4, 11, v2
    v_add_u32 v5, 0, v3
    v_xor_b32 v5, v5, v2
    v_lshl_add_u32 v8, v5, 4, v4
    v_add_u32 v12, 0x10000, v8
    v_add_u32 v5, 4, v3
    v_xor_b32 v5, v5, v2
    v_lshl_add_u32 v9, v5, 4, v4
    v_add_u32 v13, 0x10000, v9
    v_add_u32 v5, 8, v3
    v_xor_b32 v5, v5, v2
    v_lshl_add_u32 v10, v5, 4, v4
    v_add_u32 v14, 0x10000, v10
    v_add_u32 v5, 12, v3
    v_xor_b32 v5, v5, v2
    v_lshl_add_u32 v11, v5, 4, v4
    v_add_u32 v15, 0x10000, v11
    s_lshl_b32 s4, s24, 3
    s_and_b32 s4, s4, 8
    s_add_u32 s5, s4, 0
    v_xor_b32 v5, s5, v1
    s_add_u32 s5, s6, 0
    v_lshlrev_b32 v5, 4, v5
    v_add_u32 v16, s5, v5
    s_add_u32 s5, s4, 1
    v_xor_b32 v5, s5, v1
    s_add_u32 s5, s6, 0
    v_lshlrev_b32 v5, 4, v5
    v_add_u32 v17, s5, v5
    s_add_u32 s5, s4, 2
    v_xor_b32 v5, s5, v1
    s_add_u32 s5, s6, 4096
    v_lshlrev_b32 v5, 4, v5
    v_add_u32 v18, s5, v5
    s_add_u32 s5, s4, 3
    v_xor_b32 v5, s5, v1
    s_add_u32 s5, s6, 4096
    v_lshlrev_b32 v5, 4, v5
    v_add_u32 v19, s5, v5
    s_add_u32 s5, s4, 4
    v_xor_b32 v5, s5, v1
    s_add_u32 s5, s6, 8192
    v_lshlrev_b32 v5, 4, v5
    v_add_u32 v20, s5, v5
    s_add_u32 s5, s4, 5
    v_xor_b32 v5, s5, v1
    s_add_u32 s5, s6, 8192
    v_lshlrev_b32 v5, 4, v5
    v_add_u32 v21, s5, v5
    s_add_u32 s5, s4, 6
    v_xor_b32 v5, s5, v1
    s_add_u32 s5, s6, 12288
    v_lshlrev_b32 v5, 4, v5
    v_add_u32 v22, s5, v5
    s_add_u32 s5, s4, 7
    v_xor_b32 v5, s5, v1
    s_add_u32 s5, s6, 12288
    v_lshlrev_b32 v5, 4, v5
    v_add_u32 v23, s5, v5
    s_cmp_eq_u32 s98, 2
    s_cselect_b32 s4, 11, 10
    s_cselect_b32 s5, 1, 4
    s_lshl_b32 s5, s5, 10
    s_lshl_b32 s4, s24, s4
    v_lshlrev_b32 v24, 4, v1
    v_add_u32 v24, s4, v24
    v_add_u32 v25, s5, v24
    v_mov_b32 v26, 0
    s_and_b32 s4, s99, 7
    s_lshl_b32 s4, s4, 13
    s_lshl_b32 s5, s24, 11
    s_add_u32 s4, s4, s5
    s_add_u32 s4, s4, 196608
    v_lshlrev_b32 v28, 5, v1
    v_add_u32 v28, s4, v28
    s_lshl_b32 s31, s98, 24
    s_lshl_b32 s4, s99, 13
    s_add_u32 s31, s31, s4
    s_mov_b32 s30, 75497472
    s_mov_b32 s28, 0
    s_mov_b32 s29, 0
    s_waitcnt vmcnt(16)
    s_barrier
    ds_read_b64_tr_b16 a[0:1], v242 offset:0
    ds_read_b64_tr_b16 a[2:3], v242 offset:1024
    ds_read_b64_tr_b16 a[4:5], v242 offset:8
    ds_read_b64_tr_b16 a[6:7], v242 offset:1032
    ds_read_b64_tr_b16 a[8:9], v242 offset:8192
    ds_read_b64_tr_b16 a[10:11], v242 offset:9216
    ds_read_b64_tr_b16 a[12:13], v242 offset:8200
    ds_read_b64_tr_b16 a[14:15], v242 offset:9224
    ds_read_b64_tr_b16 a[16:17], v242 offset:16384
    ds_read_b64_tr_b16 a[18:19], v242 offset:17408
    ds_read_b64_tr_b16 a[20:21], v242 offset:16392
    ds_read_b64_tr_b16 a[22:23], v242 offset:17416
    ds_read_b64_tr_b16 a[24:25], v242 offset:24576
    ds_read_b64_tr_b16 a[26:27], v242 offset:25600
    ds_read_b64_tr_b16 a[28:29], v242 offset:24584
    ds_read_b64_tr_b16 a[30:31], v242 offset:25608
    ds_read_b64_tr_b16 a[32:33], v242 offset:32768
    ds_read_b64_tr_b16 a[34:35], v242 offset:33792
    ds_read_b64_tr_b16 a[36:37], v242 offset:32776
    ds_read_b64_tr_b16 a[38:39], v242 offset:33800
    ds_read_b64_tr_b16 a[40:41], v242 offset:40960
    ds_read_b64_tr_b16 a[42:43], v242 offset:41984
    ds_read_b64_tr_b16 a[44:45], v242 offset:40968
    ds_read_b64_tr_b16 a[46:47], v242 offset:41992
    ds_read_b64_tr_b16 a[48:49], v242 offset:49152
    ds_read_b64_tr_b16 a[50:51], v242 offset:50176
    ds_read_b64_tr_b16 a[52:53], v242 offset:49160
    ds_read_b64_tr_b16 a[54:55], v242 offset:50184
    ds_read_b64_tr_b16 a[56:57], v242 offset:57344
    ds_read_b64_tr_b16 a[58:59], v242 offset:58368
    ds_read_b64_tr_b16 a[60:61], v242 offset:57352
    ds_read_b64_tr_b16 a[62:63], v242 offset:58376
    s_waitcnt lgkmcnt(0)
    s_barrier
    s_add_u32 m0, s6, 0
    s_mov_b32 s5, 4194304
    buffer_load_dwordx4 v240, s[16:19], s5 offen nt lds
    s_add_u32 m0, s6, 1024
    s_mov_b32 s5, 4227072
    buffer_load_dwordx4 v240, s[16:19], s5 offen nt lds
    s_add_u32 m0, s6, 2048
    s_mov_b32 s5, 4259840
    buffer_load_dwordx4 v240, s[16:19], s5 offen nt lds
    s_add_u32 m0, s6, 3072
    s_mov_b32 s5, 4292608
    buffer_load_dwordx4 v240, s[16:19], s5 offen nt lds
    s_add_u32 m0, s6, 4096
    s_mov_b32 s5, 4325376
    buffer_load_dwordx4 v240, s[16:19], s5 offen nt lds
    s_add_u32 m0, s6, 5120
    s_mov_b32 s5, 4358144
    buffer_load_dwordx4 v240, s[16:19], s5 offen nt lds
    s_add_u32 m0, s6, 6144
    s_mov_b32 s5, 4390912
    buffer_load_dwordx4 v240, s[16:19], s5 offen nt lds
    s_add_u32 m0, s6, 7168
    s_mov_b32 s5, 4423680
    buffer_load_dwordx4 v240, s[16:19], s5 offen nt lds
    s_add_u32 m0, s6, 8192
    s_mov_b32 s5, 4456448
    buffer_load_dwordx4 v240, s[16:19], s5 offen nt lds
    s_add_u32 m0, s6, 9216
    s_mov_b32 s5, 4489216
    buffer_load_dwordx4 v240, s[16:19], s5 offen nt lds
    s_add_u32 m0, s6, 10240
    s_mov_b32 s5, 4521984
    buffer_load_dwordx4 v240, s[16:19], s5 offen nt lds
    s_add_u32 m0, s6, 11264
    s_mov_b32 s5, 4554752
    buffer_load_dwordx4 v240, s[16:19], s5 offen nt lds
    s_add_u32 m0, s6, 12288
    s_mov_b32 s5, 4587520
    buffer_load_dwordx4 v240, s[16:19], s5 offen nt lds
    s_add_u32 m0, s6, 13312
    s_mov_b32 s5, 4620288
    buffer_load_dwordx4 v240, s[16:19], s5 offen nt lds
    s_add_u32 m0, s6, 14336
    s_mov_b32 s5, 4653056
    buffer_load_dwordx4 v240, s[16:19], s5 offen nt lds
    s_add_u32 m0, s6, 15360
    s_mov_b32 s5, 4685824
    buffer_load_dwordx4 v240, s[16:19], s5 offen nt lds
    s_waitcnt vmcnt(16)
    s_lshl_b32 s4, s99, 9
    s_lshl_b32 s5, s24, 7
    s_add_u32 s4, s4, s5
    s_lshl_b32 s5, s98, 14
    s_add_u32 s4, s4, s5
    s_add_u32 s94, s4, 92274688
    s_barrier
    ds_read_b64_tr_b16 a[64:65], v243 offset:0
    ds_read_b64_tr_b16 a[66:67], v243 offset:1024
    ds_read_b64_tr_b16 a[68:69], v243 offset:8
    ds_read_b64_tr_b16 a[70:71], v243 offset:1032
    ds_read_b64_tr_b16 a[72:73], v243 offset:8192
    ds_read_b64_tr_b16 a[74:75], v243 offset:9216
    ds_read_b64_tr_b16 a[76:77], v243 offset:8200
    ds_read_b64_tr_b16 a[78:79], v243 offset:9224
    ds_read_b64_tr_b16 a[80:81], v243 offset:16384
    ds_read_b64_tr_b16 a[82:83], v243 offset:17408
    ds_read_b64_tr_b16 a[84:85], v243 offset:16392
    ds_read_b64_tr_b16 a[86:87], v243 offset:17416
    ds_read_b64_tr_b16 a[88:89], v243 offset:24576
    ds_read_b64_tr_b16 a[90:91], v243 offset:25600
    ds_read_b64_tr_b16 a[92:93], v243 offset:24584
    ds_read_b64_tr_b16 a[94:95], v243 offset:25608
    ds_read_b64_tr_b16 a[96:97], v243 offset:32768
    ds_read_b64_tr_b16 a[98:99], v243 offset:33792
    ds_read_b64_tr_b16 a[100:101], v243 offset:32776
    ds_read_b64_tr_b16 a[102:103], v243 offset:33800
    ds_read_b64_tr_b16 a[104:105], v243 offset:40960
    ds_read_b64_tr_b16 a[106:107], v243 offset:41984
    ds_read_b64_tr_b16 a[108:109], v243 offset:40968
    ds_read_b64_tr_b16 a[110:111], v243 offset:41992
    ds_read_b64_tr_b16 a[112:113], v243 offset:49152
    ds_read_b64_tr_b16 a[114:115], v243 offset:50176
    ds_read_b64_tr_b16 a[116:117], v243 offset:49160
    ds_read_b64_tr_b16 a[118:119], v243 offset:50184
    ds_read_b64_tr_b16 a[120:121], v243 offset:57344
    ds_read_b64_tr_b16 a[122:123], v243 offset:58368
    ds_read_b64_tr_b16 a[124:125], v243 offset:57352
    ds_read_b64_tr_b16 a[126:127], v243 offset:58376
    s_waitcnt lgkmcnt(0)
    s_barrier
    v_or_b32 v239, 32, v1
    v_lshlrev_b32 v239, 2, v239
    buffer_load_dword v238, v239, s[20:23], 0 offen sc1
    s_add_u32 m0, s6, 65536
    s_mov_b32 s5, 6291456
    buffer_load_dwordx4 v240, s[16:19], s5 offen nt lds
    s_add_u32 m0, s6, 66560
    s_mov_b32 s5, 6324224
    buffer_load_dwordx4 v240, s[16:19], s5 offen nt lds
    s_add_u32 m0, s6, 67584
    s_mov_b32 s5, 6356992
    buffer_load_dwordx4 v240, s[16:19], s5 offen nt lds
    s_add_u32 m0, s6, 68608
    s_mov_b32 s5, 6389760
    buffer_load_dwordx4 v240, s[16:19], s5 offen nt lds
    s_add_u32 m0, s6, 69632
    s_mov_b32 s5, 6422528
    buffer_load_dwordx4 v240, s[16:19], s5 offen nt lds
    s_add_u32 m0, s6, 70656
    s_mov_b32 s5, 6455296
    buffer_load_dwordx4 v240, s[16:19], s5 offen nt lds
    s_add_u32 m0, s6, 71680
    s_mov_b32 s5, 6488064
    buffer_load_dwordx4 v240, s[16:19], s5 offen nt lds
    s_add_u32 m0, s6, 72704
    s_mov_b32 s5, 6520832
    buffer_load_dwordx4 v240, s[16:19], s5 offen nt lds
    s_add_u32 m0, s6, 73728
    s_mov_b32 s5, 6553600
    buffer_load_dwordx4 v240, s[16:19], s5 offen nt lds
    s_add_u32 m0, s6, 74752
    s_mov_b32 s5, 6586368
    buffer_load_dwordx4 v240, s[16:19], s5 offen nt lds
    s_add_u32 m0, s6, 75776
    s_mov_b32 s5, 6619136
    buffer_load_dwordx4 v240, s[16:19], s5 offen nt lds
    s_add_u32 m0, s6, 76800
    s_mov_b32 s5, 6651904
    buffer_load_dwordx4 v240, s[16:19], s5 offen nt lds
    s_add_u32 m0, s6, 77824
    s_mov_b32 s5, 6684672
    buffer_load_dwordx4 v240, s[16:19], s5 offen nt lds
    s_add_u32 m0, s6, 78848
    s_mov_b32 s5, 6717440
    buffer_load_dwordx4 v240, s[16:19], s5 offen nt lds
    s_add_u32 m0, s6, 79872
    s_mov_b32 s5, 6750208
    buffer_load_dwordx4 v240, s[16:19], s5 offen nt lds
    s_add_u32 m0, s6, 80896
    s_mov_b32 s5, 6782976
    buffer_load_dwordx4 v240, s[16:19], s5 offen nt lds
    s_waitcnt vmcnt(16)
    s_cmp_lg_u32 s27, 0
    s_cbranch_scc1 .vd_339
    s_mov_b32 s62, 0
.vp_338:
    v_readlane_b32 s4, v238, 49
    s_and_b32 s5, s4, 0xffff
    s_cmp_ge_u32 s5, 256
    s_cbranch_scc1 .va_340
    s_add_u32 s62, s62, 1
    s_cmp_gt_u32 s62, 0x100000
    s_cbranch_scc1 .mg_end_1
    s_sleep 16
    buffer_load_dword v238, v239, s[20:23], 0 offen sc1
    s_waitcnt vmcnt(0)
    s_branch .vp_338
.va_340:
    s_lshr_b32 s4, s4, 16
    s_cbranch_scc0 .vd_339
    s_lshr_b32 s25, s2, 5
    s_and_b32 s26, s2, 31
    s_mov_b32 s27, 1
    s_waitcnt vmcnt(0) lgkmcnt(0)
    s_barrier
    s_branch .mg_role_3
.vd_339:
    s_barrier
    ds_read_b64_tr_b16 a[128:129], v242 offset:0
    ds_read_b64_tr_b16 a[130:131], v242 offset:1024
    ds_read_b64_tr_b16 a[132:133], v242 offset:8
    ds_read_b64_tr_b16 a[134:135], v242 offset:1032
    ds_read_b64_tr_b16 a[136:137], v242 offset:8192
    ds_read_b64_tr_b16 a[138:139], v242 offset:9216
    ds_read_b64_tr_b16 a[140:141], v242 offset:8200
    ds_read_b64_tr_b16 a[142:143], v242 offset:9224
    ds_read_b64_tr_b16 a[144:145], v242 offset:16384
    ds_read_b64_tr_b16 a[146:147], v242 offset:17408
    ds_read_b64_tr_b16 a[148:149], v242 offset:16392
    ds_read_b64_tr_b16 a[150:151], v242 offset:17416
    ds_read_b64_tr_b16 a[152:153], v242 offset:24576
    ds_read_b64_tr_b16 a[154:155], v242 offset:25600
    ds_read_b64_tr_b16 a[156:157], v242 offset:24584
    ds_read_b64_tr_b16 a[158:159], v242 offset:25608
    ds_read_b64_tr_b16 a[160:161], v242 offset:32768
    ds_read_b64_tr_b16 a[162:163], v242 offset:33792
    ds_read_b64_tr_b16 a[164:165], v242 offset:32776
    ds_read_b64_tr_b16 a[166:167], v242 offset:33800
    ds_read_b64_tr_b16 a[168:169], v242 offset:40960
    ds_read_b64_tr_b16 a[170:171], v242 offset:41984
    ds_read_b64_tr_b16 a[172:173], v242 offset:40968
    ds_read_b64_tr_b16 a[174:175], v242 offset:41992
    ds_read_b64_tr_b16 a[176:177], v242 offset:49152
    ds_read_b64_tr_b16 a[178:179], v242 offset:50176
    ds_read_b64_tr_b16 a[180:181], v242 offset:49160
    ds_read_b64_tr_b16 a[182:183], v242 offset:50184
    ds_read_b64_tr_b16 a[184:185], v242 offset:57344
    ds_read_b64_tr_b16 a[186:187], v242 offset:58368
    ds_read_b64_tr_b16 a[188:189], v242 offset:57352
    ds_read_b64_tr_b16 a[190:191], v242 offset:58376
    s_waitcnt lgkmcnt(0)
    s_barrier
    s_add_u32 m0, s6, 0
    s_nop 0
    buffer_load_dwordx4 v16, s[12:15], s29 offen offset:0 lds
    buffer_load_dwordx4 v16, s[12:15], s29 offen offset:1024 lds
    buffer_load_dwordx4 v17, s[12:15], s29 offen offset:2048 lds
    buffer_load_dwordx4 v17, s[12:15], s29 offen offset:3072 lds
    s_add_u32 m0, s6, 4096
    s_nop 0
    buffer_load_dwordx4 v18, s[12:15], s29 offen offset:0 lds
    buffer_load_dwordx4 v18, s[12:15], s29 offen offset:1024 lds
    buffer_load_dwordx4 v19, s[12:15], s29 offen offset:2048 lds
    buffer_load_dwordx4 v19, s[12:15], s29 offen offset:3072 lds
    s_add_u32 m0, s6, 8192
    s_nop 0
    buffer_load_dwordx4 v20, s[12:15], s29 offen offset:0 lds
    buffer_load_dwordx4 v20, s[12:15], s29 offen offset:1024 lds
    buffer_load_dwordx4 v21, s[12:15], s29 offen offset:2048 lds
    buffer_load_dwordx4 v21, s[12:15], s29 offen offset:3072 lds
    s_add_u32 m0, s6, 12288
    s_nop 0
    buffer_load_dwordx4 v22, s[12:15], s29 offen offset:0 lds
    buffer_load_dwordx4 v22, s[12:15], s29 offen offset:1024 lds
    buffer_load_dwordx4 v23, s[12:15], s29 offen offset:2048 lds
    buffer_load_dwordx4 v23, s[12:15], s29 offen offset:3072 lds
    s_waitcnt vmcnt(16)
    s_barrier
    ds_read_b64_tr_b16 a[192:193], v243 offset:0
    ds_read_b64_tr_b16 a[194:195], v243 offset:1024
    ds_read_b64_tr_b16 a[196:197], v243 offset:8
    ds_read_b64_tr_b16 a[198:199], v243 offset:1032
    ds_read_b64_tr_b16 a[200:201], v243 offset:8192
    ds_read_b64_tr_b16 a[202:203], v243 offset:9216
    ds_read_b64_tr_b16 a[204:205], v243 offset:8200
    ds_read_b64_tr_b16 a[206:207], v243 offset:9224
    ds_read_b64_tr_b16 a[208:209], v243 offset:16384
    ds_read_b64_tr_b16 a[210:211], v243 offset:17408
    ds_read_b64_tr_b16 a[212:213], v243 offset:16392
    ds_read_b64_tr_b16 a[214:215], v243 offset:17416
    ds_read_b64_tr_b16 a[216:217], v243 offset:24576
    ds_read_b64_tr_b16 a[218:219], v243 offset:25600
    ds_read_b64_tr_b16 a[220:221], v243 offset:24584
    ds_read_b64_tr_b16 a[222:223], v243 offset:25608
    ds_read_b64_tr_b16 a[224:225], v243 offset:32768
    ds_read_b64_tr_b16 a[226:227], v243 offset:33792
    ds_read_b64_tr_b16 a[228:229], v243 offset:32776
    ds_read_b64_tr_b16 a[230:231], v243 offset:33800
    ds_read_b64_tr_b16 a[232:233], v243 offset:40960
    ds_read_b64_tr_b16 a[234:235], v243 offset:41984
    ds_read_b64_tr_b16 a[236:237], v243 offset:40968
    ds_read_b64_tr_b16 a[238:239], v243 offset:41992
    ds_read_b64_tr_b16 a[240:241], v243 offset:49152
    ds_read_b64_tr_b16 a[242:243], v243 offset:50176
    ds_read_b64_tr_b16 a[244:245], v243 offset:49160
    ds_read_b64_tr_b16 a[246:247], v243 offset:50184
    ds_read_b64_tr_b16 a[248:249], v243 offset:57344
    ds_read_b64_tr_b16 a[250:251], v243 offset:58368
    ds_read_b64_tr_b16 a[252:253], v243 offset:57352
    ds_read_b64_tr_b16 a[254:255], v243 offset:58376
    s_waitcnt lgkmcnt(0)
    s_barrier
    s_waitcnt vmcnt(0)
    s_barrier
    s_mov_b32 s29, 0x10000
    ds_read_b128 v[64:67], v8 offset:0
    ds_read_b128 v[68:71], v8 offset:32768
    ds_read_b128 v[72:75], v9 offset:0
    ds_read_b128 v[76:79], v9 offset:32768
    ds_read_b128 v[80:83], v10 offset:0
    ds_read_b128 v[84:87], v10 offset:32768
    ds_read_b128 v[88:91], v11 offset:0
    ds_read_b128 v[92:95], v11 offset:32768
    ds_read_b128 v[96:99], v8 offset:256
    ds_read_b128 v[100:103], v8 offset:33024
    ds_read_b128 v[104:107], v9 offset:256
    ds_read_b128 v[108:111], v9 offset:33024
    ds_read_b128 v[112:115], v10 offset:256
    ds_read_b128 v[116:119], v10 offset:33024
    ds_read_b128 v[120:123], v11 offset:256
    ds_read_b128 v[124:127], v11 offset:33024
    s_add_u32 m0, s6, 65536
    s_nop 0
    buffer_load_dwordx4 v16, s[12:15], s29 offen offset:0 lds
    buffer_load_dwordx4 v16, s[12:15], s29 offen offset:1024 lds
    buffer_load_dwordx4 v17, s[12:15], s29 offen offset:2048 lds
    buffer_load_dwordx4 v17, s[12:15], s29 offen offset:3072 lds
    s_add_u32 m0, s6, 69632
    s_nop 0
    buffer_load_dwordx4 v18, s[12:15], s29 offen offset:0 lds
    buffer_load_dwordx4 v18, s[12:15], s29 offen offset:1024 lds
    s_cmp_eq_u32 s98, 0
    s_cbranch_scc1 .qa_341
    s_cmp_eq_u32 s98, 2
    s_cbranch_scc1 .vt_342
.p2align 6
.ql_344:
    s_waitcnt lgkmcnt(12)
    v_mfma_f32_16x16x32_bf16 v[192:195], a[0:3], v[64:67], 0
    ds_read_b128 v[128:131], v8 offset:512
    v_mfma_f32_16x16x32_bf16 v[196:199], a[4:7], v[64:67], 0
    v_mfma_f32_16x16x32_bf16 v[200:203], a[0:3], v[68:71], 0
    ds_read_b128 v[132:135], v8 offset:33280
    v_mfma_f32_16x16x32_bf16 v[204:207], a[4:7], v[68:71], 0
    buffer_load_dwordx4 v19, s[12:15], s29 offen offset:2048 lds
    v_mfma_f32_16x16x32_bf16 v[192:195], a[8:11], v[72:75], v[192:195]
    ds_read_b128 v[136:139], v9 offset:512
    v_mfma_f32_16x16x32_bf16 v[196:199], a[12:15], v[72:75], v[196:199]
    v_cvt_pk_bf16_f32 v224, v208, v209
    v_cvt_pk_bf16_f32 v225, v210, v211
    v_mfma_f32_16x16x32_bf16 v[200:203], a[8:11], v[76:79], v[200:203]
    ds_read_b128 v[140:143], v9 offset:33280
    v_mfma_f32_16x16x32_bf16 v[204:207], a[12:15], v[76:79], v[204:207]
    buffer_load_dwordx4 v19, s[12:15], s29 offen offset:3072 lds
    s_waitcnt lgkmcnt(12)
    v_mfma_f32_16x16x32_bf16 v[192:195], a[16:19], v[80:83], v[192:195]
    ds_read_b128 v[144:147], v10 offset:512
    v_mfma_f32_16x16x32_bf16 v[196:199], a[20:23], v[80:83], v[196:199]
    s_add_u32 m0, s6, 73728
    v_cvt_pk_bf16_f32 v226, v212, v213
    v_cvt_pk_bf16_f32 v227, v214, v215
    v_mfma_f32_16x16x32_bf16 v[200:203], a[16:19], v[84:87], v[200:203]
    ds_read_b128 v[148:151], v10 offset:33280
    v_mfma_f32_16x16x32_bf16 v[204:207], a[20:23], v[84:87], v[204:207]
    buffer_load_dwordx4 v20, s[12:15], s29 offen offset:0 lds
    v_mfma_f32_16x16x32_bf16 v[192:195], a[24:27], v[88:91], v[192:195]
    ds_read_b128 v[152:155], v11 offset:512
    v_cvt_pk_bf16_f32 v228, v216, v217
    v_mfma_f32_16x16x32_bf16 v[196:199], a[28:31], v[88:91], v[196:199]
    buffer_store_dwordx4 v[224:227], v24, s[8:11], s30 offen sc1
    v_mfma_f32_16x16x32_bf16 v[200:203], a[24:27], v[92:95], v[200:203]
    ds_read_b128 v[156:159], v11 offset:33280
    v_cvt_pk_bf16_f32 v229, v218, v219
    v_mfma_f32_16x16x32_bf16 v[204:207], a[28:31], v[92:95], v[204:207]
    buffer_load_dwordx4 v20, s[12:15], s29 offen offset:1024 lds
    s_waitcnt lgkmcnt(12)
    v_mfma_f32_16x16x32_bf16 v[192:195], a[32:35], v[96:99], v[192:195]
    ds_read_b128 v[160:163], v8 offset:768
    v_mfma_f32_16x16x32_bf16 v[196:199], a[36:39], v[96:99], v[196:199]
    v_cvt_pk_bf16_f32 v230, v220, v221
    v_cvt_pk_bf16_f32 v231, v222, v223
    v_mfma_f32_16x16x32_bf16 v[200:203], a[32:35], v[100:103], v[200:203]
    ds_read_b128 v[164:167], v8 offset:33536
    v_mfma_f32_16x16x32_bf16 v[204:207], a[36:39], v[100:103], v[204:207]
    buffer_load_dwordx4 v21, s[12:15], s29 offen offset:2048 lds
    v_mfma_f32_16x16x32_bf16 v[192:195], a[40:43], v[104:107], v[192:195]
    ds_read_b128 v[168:171], v9 offset:768
    v_mfma_f32_16x16x32_bf16 v[196:199], a[44:47], v[104:107], v[196:199]
    buffer_store_dwordx4 v[228:231], v25, s[8:11], s30 offen sc1
    v_mfma_f32_16x16x32_bf16 v[200:203], a[40:43], v[108:111], v[200:203]
    ds_read_b128 v[172:175], v9 offset:33536
    v_mfma_f32_16x16x32_bf16 v[204:207], a[44:47], v[108:111], v[204:207]
    buffer_load_dwordx4 v21, s[12:15], s29 offen offset:3072 lds
    s_waitcnt lgkmcnt(12)
    v_mfma_f32_16x16x32_bf16 v[192:195], a[48:51], v[112:115], v[192:195]
    ds_read_b128 v[176:179], v10 offset:768
    v_mfma_f32_16x16x32_bf16 v[196:199], a[52:55], v[112:115], v[196:199]
    s_add_u32 m0, s6, 77824
    s_mov_b32 s30, s31
    v_mfma_f32_16x16x32_bf16 v[200:203], a[48:51], v[116:119], v[200:203]
    ds_read_b128 v[180:183], v10 offset:33536
    v_mfma_f32_16x16x32_bf16 v[204:207], a[52:55], v[116:119], v[204:207]
    buffer_load_dwordx4 v22, s[12:15], s29 offen offset:0 lds
    v_mfma_f32_16x16x32_bf16 v[192:195], a[56:59], v[120:123], v[192:195]
    ds_read_b128 v[184:187], v11 offset:768
    v_mfma_f32_16x16x32_bf16 v[196:199], a[60:63], v[120:123], v[196:199]
    s_add_u32 s31, s31, 262144
    v_mfma_f32_16x16x32_bf16 v[200:203], a[56:59], v[124:127], v[200:203]
    ds_read_b128 v[188:191], v11 offset:33536
    v_mfma_f32_16x16x32_bf16 v[204:207], a[60:63], v[124:127], v[204:207]
    buffer_load_dwordx4 v22, s[12:15], s29 offen offset:1024 lds
    s_waitcnt lgkmcnt(12)
    v_mfma_f32_16x16x32_bf16 v[192:195], a[64:67], v[128:131], v[192:195]
    ds_read_b128 v[64:67], v8 offset:1024
    v_mfma_f32_16x16x32_bf16 v[196:199], a[68:71], v[128:131], v[196:199]
    v_mfma_f32_16x16x32_bf16 v[200:203], a[64:67], v[132:135], v[200:203]
    ds_read_b128 v[68:71], v8 offset:33792
    v_mfma_f32_16x16x32_bf16 v[204:207], a[68:71], v[132:135], v[204:207]
    buffer_load_dwordx4 v23, s[12:15], s29 offen offset:2048 lds
    v_mfma_f32_16x16x32_bf16 v[192:195], a[72:75], v[136:139], v[192:195]
    ds_read_b128 v[72:75], v9 offset:1024
    v_mfma_f32_16x16x32_bf16 v[196:199], a[76:79], v[136:139], v[196:199]
    v_mfma_f32_16x16x32_bf16 v[200:203], a[72:75], v[140:143], v[200:203]
    ds_read_b128 v[76:79], v9 offset:33792
    v_mfma_f32_16x16x32_bf16 v[204:207], a[76:79], v[140:143], v[204:207]
    buffer_load_dwordx4 v23, s[12:15], s29 offen offset:3072 lds
    s_waitcnt lgkmcnt(12)
    v_mfma_f32_16x16x32_bf16 v[192:195], a[80:83], v[144:147], v[192:195]
    ds_read_b128 v[80:83], v10 offset:1024
    v_mfma_f32_16x16x32_bf16 v[196:199], a[84:87], v[144:147], v[196:199]
    v_mfma_f32_16x16x32_bf16 v[200:203], a[80:83], v[148:151], v[200:203]
    ds_read_b128 v[84:87], v10 offset:33792
    v_mfma_f32_16x16x32_bf16 v[204:207], a[84:87], v[148:151], v[204:207]
    buffer_load_dword v29, v28, s[12:15], s29 offen
    v_mfma_f32_16x16x32_bf16 v[192:195], a[88:91], v[152:155], v[192:195]
    ds_read_b128 v[88:91], v11 offset:1024
    v_mfma_f32_16x16x32_bf16 v[196:199], a[92:95], v[152:155], v[196:199]
    v_mfma_f32_16x16x32_bf16 v[200:203], a[88:91], v[156:159], v[200:203]
    ds_read_b128 v[92:95], v11 offset:33792
    v_mfma_f32_16x16x32_bf16 v[204:207], a[92:95], v[156:159], v[204:207]
    s_waitcnt lgkmcnt(12)
    v_mfma_f32_16x16x32_bf16 v[192:195], a[96:99], v[160:163], v[192:195]
    ds_read_b128 v[96:99], v8 offset:1280
    v_mfma_f32_16x16x32_bf16 v[196:199], a[100:103], v[160:163], v[196:199]
    v_mfma_f32_16x16x32_bf16 v[200:203], a[96:99], v[164:167], v[200:203]
    ds_read_b128 v[100:103], v8 offset:34048
    v_mfma_f32_16x16x32_bf16 v[204:207], a[100:103], v[164:167], v[204:207]
    v_mfma_f32_16x16x32_bf16 v[192:195], a[104:107], v[168:171], v[192:195]
    ds_read_b128 v[104:107], v9 offset:1280
    v_mfma_f32_16x16x32_bf16 v[196:199], a[108:111], v[168:171], v[196:199]
    v_mfma_f32_16x16x32_bf16 v[200:203], a[104:107], v[172:175], v[200:203]
    ds_read_b128 v[108:111], v9 offset:34048
    v_mfma_f32_16x16x32_bf16 v[204:207], a[108:111], v[172:175], v[204:207]
    s_waitcnt lgkmcnt(12)
    v_mfma_f32_16x16x32_bf16 v[192:195], a[112:115], v[176:179], v[192:195]
    ds_read_b128 v[112:115], v10 offset:1280
    v_mfma_f32_16x16x32_bf16 v[196:199], a[116:119], v[176:179], v[196:199]
    v_mfma_f32_16x16x32_bf16 v[200:203], a[112:115], v[180:183], v[200:203]
    ds_read_b128 v[116:119], v10 offset:34048
    v_mfma_f32_16x16x32_bf16 v[204:207], a[116:119], v[180:183], v[204:207]
    v_mfma_f32_16x16x32_bf16 v[192:195], a[120:123], v[184:187], v[192:195]
    ds_read_b128 v[120:123], v11 offset:1280
    v_mfma_f32_16x16x32_bf16 v[196:199], a[124:127], v[184:187], v[196:199]
    v_mfma_f32_16x16x32_bf16 v[200:203], a[120:123], v[188:191], v[200:203]
    ds_read_b128 v[124:127], v11 offset:34048
    v_mfma_f32_16x16x32_bf16 v[204:207], a[124:127], v[188:191], v[204:207]
    s_waitcnt lgkmcnt(12)
    v_mfma_f32_16x16x32_bf16 v[192:195], a[128:131], v[64:67], v[192:195]
    ds_read_b128 v[128:131], v8 offset:1536
    v_mfma_f32_16x16x32_bf16 v[196:199], a[132:135], v[64:67], v[196:199]
    v_mfma_f32_16x16x32_bf16 v[200:203], a[128:131], v[68:71], v[200:203]
    ds_read_b128 v[132:135], v8 offset:34304
    v_mfma_f32_16x16x32_bf16 v[204:207], a[132:135], v[68:71], v[204:207]
    v_mfma_f32_16x16x32_bf16 v[192:195], a[136:139], v[72:75], v[192:195]
    ds_read_b128 v[136:139], v9 offset:1536
    v_mfma_f32_16x16x32_bf16 v[196:199], a[140:143], v[72:75], v[196:199]
    v_mfma_f32_16x16x32_bf16 v[200:203], a[136:139], v[76:79], v[200:203]
    ds_read_b128 v[140:143], v9 offset:34304
    v_mfma_f32_16x16x32_bf16 v[204:207], a[140:143], v[76:79], v[204:207]
    s_waitcnt lgkmcnt(12)
    v_mfma_f32_16x16x32_bf16 v[192:195], a[144:147], v[80:83], v[192:195]
    ds_read_b128 v[144:147], v10 offset:1536
    v_mfma_f32_16x16x32_bf16 v[196:199], a[148:151], v[80:83], v[196:199]
    v_mfma_f32_16x16x32_bf16 v[200:203], a[144:147], v[84:87], v[200:203]
    ds_read_b128 v[148:151], v10 offset:34304
    v_mfma_f32_16x16x32_bf16 v[204:207], a[148:151], v[84:87], v[204:207]
    v_mfma_f32_16x16x32_bf16 v[192:195], a[152:155], v[88:91], v[192:195]
    ds_read_b128 v[152:155], v11 offset:1536
    v_mfma_f32_16x16x32_bf16 v[196:199], a[156:159], v[88:91], v[196:199]
    v_mfma_f32_16x16x32_bf16 v[200:203], a[152:155], v[92:95], v[200:203]
    ds_read_b128 v[156:159], v11 offset:34304
    v_mfma_f32_16x16x32_bf16 v[204:207], a[156:159], v[92:95], v[204:207]
    s_waitcnt lgkmcnt(12)
    v_mfma_f32_16x16x32_bf16 v[192:195], a[160:163], v[96:99], v[192:195]
    ds_read_b128 v[160:163], v8 offset:1792
    v_mfma_f32_16x16x32_bf16 v[196:199], a[164:167], v[96:99], v[196:199]
    v_mfma_f32_16x16x32_bf16 v[200:203], a[160:163], v[100:103], v[200:203]
    ds_read_b128 v[164:167], v8 offset:34560
    v_mfma_f32_16x16x32_bf16 v[204:207], a[164:167], v[100:103], v[204:207]
    v_mfma_f32_16x16x32_bf16 v[192:195], a[168:171], v[104:107], v[192:195]
    ds_read_b128 v[168:171], v9 offset:1792
    v_mfma_f32_16x16x32_bf16 v[196:199], a[172:175], v[104:107], v[196:199]
    v_mfma_f32_16x16x32_bf16 v[200:203], a[168:171], v[108:111], v[200:203]
    ds_read_b128 v[172:175], v9 offset:34560
    v_mfma_f32_16x16x32_bf16 v[204:207], a[172:175], v[108:111], v[204:207]
    s_waitcnt lgkmcnt(12)
    v_mfma_f32_16x16x32_bf16 v[192:195], a[176:179], v[112:115], v[192:195]
    ds_read_b128 v[176:179], v10 offset:1792
    v_mfma_f32_16x16x32_bf16 v[196:199], a[180:183], v[112:115], v[196:199]
    s_waitcnt vmcnt(6)
    v_mov_b32 v27, s28
    s_mov_b64 exec, 1
    buffer_store_dword v27, v26, s[8:11], s94 offen sc1
    s_mov_b64 exec, -1
    v_mfma_f32_16x16x32_bf16 v[200:203], a[176:179], v[116:119], v[200:203]
    ds_read_b128 v[180:183], v10 offset:34560
    v_mfma_f32_16x16x32_bf16 v[204:207], a[180:183], v[116:119], v[204:207]
    v_mfma_f32_16x16x32_bf16 v[192:195], a[184:187], v[120:123], v[192:195]
    ds_read_b128 v[184:187], v11 offset:1792
    v_mfma_f32_16x16x32_bf16 v[196:199], a[188:191], v[120:123], v[196:199]
    s_add_u32 s28, s28, 1
    v_mfma_f32_16x16x32_bf16 v[200:203], a[184:187], v[124:127], v[200:203]
    ds_read_b128 v[188:191], v11 offset:34560
    v_mfma_f32_16x16x32_bf16 v[204:207], a[188:191], v[124:127], v[204:207]
    s_waitcnt lgkmcnt(12)
    v_mfma_f32_16x16x32_bf16 v[192:195], a[192:195], v[128:131], v[192:195]
    v_mfma_f32_16x16x32_bf16 v[196:199], a[196:199], v[128:131], v[196:199]
    v_mfma_f32_16x16x32_bf16 v[200:203], a[192:195], v[132:135], v[200:203]
    v_mfma_f32_16x16x32_bf16 v[204:207], a[196:199], v[132:135], v[204:207]
    v_mfma_f32_16x16x32_bf16 v[192:195], a[200:203], v[136:139], v[192:195]
    v_mfma_f32_16x16x32_bf16 v[196:199], a[204:207], v[136:139], v[196:199]
    s_add_u32 s29, s29, 0x10000
    s_min_u32 s29, s29, 0x3f0000
    v_mfma_f32_16x16x32_bf16 v[200:203], a[200:203], v[140:143], v[200:203]
    v_mfma_f32_16x16x32_bf16 v[204:207], a[204:207], v[140:143], v[204:207]
    s_waitcnt vmcnt(2) lgkmcnt(0)
    s_barrier
    v_mfma_f32_16x16x32_bf16 v[192:195], a[208:211], v[144:147], v[192:195]
    ds_read_b128 v[64:67], v12 offset:0
    ds_read_b128 v[68:71], v12 offset:32768
    v_mfma_f32_16x16x32_bf16 v[196:199], a[212:215], v[144:147], v[196:199]
    s_add_u32 m0, s6, 0
    v_mfma_f32_16x16x32_bf16 v[200:203], a[208:211], v[148:151], v[200:203]
    ds_read_b128 v[72:75], v13 offset:0
    ds_read_b128 v[76:79], v13 offset:32768
    v_mfma_f32_16x16x32_bf16 v[204:207], a[212:215], v[148:151], v[204:207]
    buffer_load_dwordx4 v16, s[12:15], s29 offen offset:0 lds
    v_mfma_f32_16x16x32_bf16 v[192:195], a[216:219], v[152:155], v[192:195]
    ds_read_b128 v[80:83], v14 offset:0
    ds_read_b128 v[84:87], v14 offset:32768
    v_mfma_f32_16x16x32_bf16 v[196:199], a[220:223], v[152:155], v[196:199]
    v_mfma_f32_16x16x32_bf16 v[200:203], a[216:219], v[156:159], v[200:203]
    ds_read_b128 v[88:91], v15 offset:0
    ds_read_b128 v[92:95], v15 offset:32768
    v_mfma_f32_16x16x32_bf16 v[204:207], a[220:223], v[156:159], v[204:207]
    buffer_load_dwordx4 v16, s[12:15], s29 offen offset:1024 lds
    v_mfma_f32_16x16x32_bf16 v[192:195], a[224:227], v[160:163], v[192:195]
    ds_read_b128 v[96:99], v12 offset:256
    v_mfma_f32_16x16x32_bf16 v[196:199], a[228:231], v[160:163], v[196:199]
    v_mfma_f32_16x16x32_bf16 v[200:203], a[224:227], v[164:167], v[200:203]
    ds_read_b128 v[100:103], v12 offset:33024
    v_mfma_f32_16x16x32_bf16 v[204:207], a[228:231], v[164:167], v[204:207]
    buffer_load_dwordx4 v17, s[12:15], s29 offen offset:2048 lds
    v_mfma_f32_16x16x32_bf16 v[192:195], a[232:235], v[168:171], v[192:195]
    ds_read_b128 v[104:107], v13 offset:256
    v_mfma_f32_16x16x32_bf16 v[196:199], a[236:239], v[168:171], v[196:199]
    v_mfma_f32_16x16x32_bf16 v[200:203], a[232:235], v[172:175], v[200:203]
    ds_read_b128 v[108:111], v13 offset:33024
    v_mfma_f32_16x16x32_bf16 v[204:207], a[236:239], v[172:175], v[204:207]
    buffer_load_dwordx4 v17, s[12:15], s29 offen offset:3072 lds
    v_mfma_f32_16x16x32_bf16 v[192:195], a[240:243], v[176:179], v[192:195]
    ds_read_b128 v[112:115], v14 offset:256
    v_mfma_f32_16x16x32_bf16 v[196:199], a[244:247], v[176:179], v[196:199]
    s_add_u32 m0, s6, 4096
    v_mfma_f32_16x16x32_bf16 v[200:203], a[240:243], v[180:183], v[200:203]
    ds_read_b128 v[116:119], v14 offset:33024
    v_mfma_f32_16x16x32_bf16 v[204:207], a[244:247], v[180:183], v[204:207]
    buffer_load_dwordx4 v18, s[12:15], s29 offen offset:0 lds
    v_mfma_f32_16x16x32_bf16 v[192:195], a[248:251], v[184:187], v[192:195]
    ds_read_b128 v[120:123], v15 offset:256
    v_mfma_f32_16x16x32_bf16 v[196:199], a[252:255], v[184:187], v[196:199]
    v_mfma_f32_16x16x32_bf16 v[200:203], a[248:251], v[188:191], v[200:203]
    ds_read_b128 v[124:127], v15 offset:33024
    v_mfma_f32_16x16x32_bf16 v[204:207], a[252:255], v[188:191], v[204:207]
    buffer_load_dwordx4 v18, s[12:15], s29 offen offset:1024 lds
    s_waitcnt lgkmcnt(12)
    v_mfma_f32_16x16x32_bf16 v[208:211], a[0:3], v[64:67], 0
    ds_read_b128 v[128:131], v12 offset:512
    v_mfma_f32_16x16x32_bf16 v[212:215], a[4:7], v[64:67], 0
    v_mfma_f32_16x16x32_bf16 v[216:219], a[0:3], v[68:71], 0
    ds_read_b128 v[132:135], v12 offset:33280
    v_mfma_f32_16x16x32_bf16 v[220:223], a[4:7], v[68:71], 0
    buffer_load_dwordx4 v19, s[12:15], s29 offen offset:2048 lds
    v_mfma_f32_16x16x32_bf16 v[208:211], a[8:11], v[72:75], v[208:211]
    ds_read_b128 v[136:139], v13 offset:512
    v_mfma_f32_16x16x32_bf16 v[212:215], a[12:15], v[72:75], v[212:215]
    v_cvt_pk_bf16_f32 v224, v192, v193
    v_cvt_pk_bf16_f32 v225, v194, v195
    v_mfma_f32_16x16x32_bf16 v[216:219], a[8:11], v[76:79], v[216:219]
    ds_read_b128 v[140:143], v13 offset:33280
    v_mfma_f32_16x16x32_bf16 v[220:223], a[12:15], v[76:79], v[220:223]
    buffer_load_dwordx4 v19, s[12:15], s29 offen offset:3072 lds
    s_waitcnt lgkmcnt(12)
    v_mfma_f32_16x16x32_bf16 v[208:211], a[16:19], v[80:83], v[208:211]
    ds_read_b128 v[144:147], v14 offset:512
    v_mfma_f32_16x16x32_bf16 v[212:215], a[20:23], v[80:83], v[212:215]
    s_add_u32 m0, s6, 8192
    v_cvt_pk_bf16_f32 v226, v196, v197
    v_cvt_pk_bf16_f32 v227, v198, v199
    v_mfma_f32_16x16x32_bf16 v[216:219], a[16:19], v[84:87], v[216:219]
    ds_read_b128 v[148:151], v14 offset:33280
    v_mfma_f32_16x16x32_bf16 v[220:223], a[20:23], v[84:87], v[220:223]
    buffer_load_dwordx4 v20, s[12:15], s29 offen offset:0 lds
    v_mfma_f32_16x16x32_bf16 v[208:211], a[24:27], v[88:91], v[208:211]
    ds_read_b128 v[152:155], v15 offset:512
    v_cvt_pk_bf16_f32 v228, v200, v201
    v_mfma_f32_16x16x32_bf16 v[212:215], a[28:31], v[88:91], v[212:215]
    buffer_store_dwordx4 v[224:227], v24, s[8:11], s30 offen sc1
    v_mfma_f32_16x16x32_bf16 v[216:219], a[24:27], v[92:95], v[216:219]
    ds_read_b128 v[156:159], v15 offset:33280
    v_cvt_pk_bf16_f32 v229, v202, v203
    v_mfma_f32_16x16x32_bf16 v[220:223], a[28:31], v[92:95], v[220:223]
    buffer_load_dwordx4 v20, s[12:15], s29 offen offset:1024 lds
    s_waitcnt lgkmcnt(12)
    v_mfma_f32_16x16x32_bf16 v[208:211], a[32:35], v[96:99], v[208:211]
    ds_read_b128 v[160:163], v12 offset:768
    v_mfma_f32_16x16x32_bf16 v[212:215], a[36:39], v[96:99], v[212:215]
    v_cvt_pk_bf16_f32 v230, v204, v205
    v_cvt_pk_bf16_f32 v231, v206, v207
    v_mfma_f32_16x16x32_bf16 v[216:219], a[32:35], v[100:103], v[216:219]
    ds_read_b128 v[164:167], v12 offset:33536
    v_mfma_f32_16x16x32_bf16 v[220:223], a[36:39], v[100:103], v[220:223]
    buffer_load_dwordx4 v21, s[12:15], s29 offen offset:2048 lds
    v_mfma_f32_16x16x32_bf16 v[208:211], a[40:43], v[104:107], v[208:211]
    ds_read_b128 v[168:171], v13 offset:768
    v_mfma_f32_16x16x32_bf16 v[212:215], a[44:47], v[104:107], v[212:215]
    buffer_store_dwordx4 v[228:231], v25, s[8:11], s30 offen sc1
    v_mfma_f32_16x16x32_bf16 v[216:219], a[40:43], v[108:111], v[216:219]
    ds_read_b128 v[172:175], v13 offset:33536
    v_mfma_f32_16x16x32_bf16 v[220:223], a[44:47], v[108:111], v[220:223]
    buffer_load_dwordx4 v21, s[12:15], s29 offen offset:3072 lds
    s_waitcnt lgkmcnt(12)
    v_mfma_f32_16x16x32_bf16 v[208:211], a[48:51], v[112:115], v[208:211]
    ds_read_b128 v[176:179], v14 offset:768
    v_mfma_f32_16x16x32_bf16 v[212:215], a[52:55], v[112:115], v[212:215]
    s_add_u32 m0, s6, 12288
    s_mov_b32 s30, s31
    v_mfma_f32_16x16x32_bf16 v[216:219], a[48:51], v[116:119], v[216:219]
    ds_read_b128 v[180:183], v14 offset:33536
    v_mfma_f32_16x16x32_bf16 v[220:223], a[52:55], v[116:119], v[220:223]
    buffer_load_dwordx4 v22, s[12:15], s29 offen offset:0 lds
    v_mfma_f32_16x16x32_bf16 v[208:211], a[56:59], v[120:123], v[208:211]
    ds_read_b128 v[184:187], v15 offset:768
    v_mfma_f32_16x16x32_bf16 v[212:215], a[60:63], v[120:123], v[212:215]
    s_add_u32 s31, s31, 262144
    v_mfma_f32_16x16x32_bf16 v[216:219], a[56:59], v[124:127], v[216:219]
    ds_read_b128 v[188:191], v15 offset:33536
    v_mfma_f32_16x16x32_bf16 v[220:223], a[60:63], v[124:127], v[220:223]
    buffer_load_dwordx4 v22, s[12:15], s29 offen offset:1024 lds
    s_waitcnt lgkmcnt(12)
    v_mfma_f32_16x16x32_bf16 v[208:211], a[64:67], v[128:131], v[208:211]
    ds_read_b128 v[64:67], v12 offset:1024
    v_mfma_f32_16x16x32_bf16 v[212:215], a[68:71], v[128:131], v[212:215]
    v_mfma_f32_16x16x32_bf16 v[216:219], a[64:67], v[132:135], v[216:219]
    ds_read_b128 v[68:71], v12 offset:33792
    v_mfma_f32_16x16x32_bf16 v[220:223], a[68:71], v[132:135], v[220:223]
    buffer_load_dwordx4 v23, s[12:15], s29 offen offset:2048 lds
    v_mfma_f32_16x16x32_bf16 v[208:211], a[72:75], v[136:139], v[208:211]
    ds_read_b128 v[72:75], v13 offset:1024
    v_mfma_f32_16x16x32_bf16 v[212:215], a[76:79], v[136:139], v[212:215]
    v_mfma_f32_16x16x32_bf16 v[216:219], a[72:75], v[140:143], v[216:219]
    ds_read_b128 v[76:79], v13 offset:33792
    v_mfma_f32_16x16x32_bf16 v[220:223], a[76:79], v[140:143], v[220:223]
    buffer_load_dwordx4 v23, s[12:15], s29 offen offset:3072 lds
    s_waitcnt lgkmcnt(12)
    v_mfma_f32_16x16x32_bf16 v[208:211], a[80:83], v[144:147], v[208:211]
    ds_read_b128 v[80:83], v14 offset:1024
    v_mfma_f32_16x16x32_bf16 v[212:215], a[84:87], v[144:147], v[212:215]
    v_mfma_f32_16x16x32_bf16 v[216:219], a[80:83], v[148:151], v[216:219]
    ds_read_b128 v[84:87], v14 offset:33792
    v_mfma_f32_16x16x32_bf16 v[220:223], a[84:87], v[148:151], v[220:223]
    buffer_load_dword v29, v28, s[12:15], s29 offen
    v_mfma_f32_16x16x32_bf16 v[208:211], a[88:91], v[152:155], v[208:211]
    ds_read_b128 v[88:91], v15 offset:1024
    v_mfma_f32_16x16x32_bf16 v[212:215], a[92:95], v[152:155], v[212:215]
    v_mfma_f32_16x16x32_bf16 v[216:219], a[88:91], v[156:159], v[216:219]
    ds_read_b128 v[92:95], v15 offset:33792
    v_mfma_f32_16x16x32_bf16 v[220:223], a[92:95], v[156:159], v[220:223]
    s_waitcnt lgkmcnt(12)
    v_mfma_f32_16x16x32_bf16 v[208:211], a[96:99], v[160:163], v[208:211]
    ds_read_b128 v[96:99], v12 offset:1280
    v_mfma_f32_16x16x32_bf16 v[212:215], a[100:103], v[160:163], v[212:215]
    v_mfma_f32_16x16x32_bf16 v[216:219], a[96:99], v[164:167], v[216:219]
    ds_read_b128 v[100:103], v12 offset:34048
    v_mfma_f32_16x16x32_bf16 v[220:223], a[100:103], v[164:167], v[220:223]
    v_mfma_f32_16x16x32_bf16 v[208:211], a[104:107], v[168:171], v[208:211]
    ds_read_b128 v[104:107], v13 offset:1280
    v_mfma_f32_16x16x32_bf16 v[212:215], a[108:111], v[168:171], v[212:215]
    v_mfma_f32_16x16x32_bf16 v[216:219], a[104:107], v[172:175], v[216:219]
    ds_read_b128 v[108:111], v13 offset:34048
    v_mfma_f32_16x16x32_bf16 v[220:223], a[108:111], v[172:175], v[220:223]
    s_waitcnt lgkmcnt(12)
    v_mfma_f32_16x16x32_bf16 v[208:211], a[112:115], v[176:179], v[208:211]
    ds_read_b128 v[112:115], v14 offset:1280
    v_mfma_f32_16x16x32_bf16 v[212:215], a[116:119], v[176:179], v[212:215]
    v_mfma_f32_16x16x32_bf16 v[216:219], a[112:115], v[180:183], v[216:219]
    ds_read_b128 v[116:119], v14 offset:34048
    v_mfma_f32_16x16x32_bf16 v[220:223], a[116:119], v[180:183], v[220:223]
    v_mfma_f32_16x16x32_bf16 v[208:211], a[120:123], v[184:187], v[208:211]
    ds_read_b128 v[120:123], v15 offset:1280
    v_mfma_f32_16x16x32_bf16 v[212:215], a[124:127], v[184:187], v[212:215]
    v_mfma_f32_16x16x32_bf16 v[216:219], a[120:123], v[188:191], v[216:219]
    ds_read_b128 v[124:127], v15 offset:34048
    v_mfma_f32_16x16x32_bf16 v[220:223], a[124:127], v[188:191], v[220:223]
    s_waitcnt lgkmcnt(12)
    v_mfma_f32_16x16x32_bf16 v[208:211], a[128:131], v[64:67], v[208:211]
    ds_read_b128 v[128:131], v12 offset:1536
    v_mfma_f32_16x16x32_bf16 v[212:215], a[132:135], v[64:67], v[212:215]
    v_mfma_f32_16x16x32_bf16 v[216:219], a[128:131], v[68:71], v[216:219]
    ds_read_b128 v[132:135], v12 offset:34304
    v_mfma_f32_16x16x32_bf16 v[220:223], a[132:135], v[68:71], v[220:223]
    v_mfma_f32_16x16x32_bf16 v[208:211], a[136:139], v[72:75], v[208:211]
    ds_read_b128 v[136:139], v13 offset:1536
    v_mfma_f32_16x16x32_bf16 v[212:215], a[140:143], v[72:75], v[212:215]
    v_mfma_f32_16x16x32_bf16 v[216:219], a[136:139], v[76:79], v[216:219]
    ds_read_b128 v[140:143], v13 offset:34304
    v_mfma_f32_16x16x32_bf16 v[220:223], a[140:143], v[76:79], v[220:223]
    s_waitcnt lgkmcnt(12)
    v_mfma_f32_16x16x32_bf16 v[208:211], a[144:147], v[80:83], v[208:211]
    ds_read_b128 v[144:147], v14 offset:1536
    v_mfma_f32_16x16x32_bf16 v[212:215], a[148:151], v[80:83], v[212:215]
    v_mfma_f32_16x16x32_bf16 v[216:219], a[144:147], v[84:87], v[216:219]
    ds_read_b128 v[148:151], v14 offset:34304
    v_mfma_f32_16x16x32_bf16 v[220:223], a[148:151], v[84:87], v[220:223]
    v_mfma_f32_16x16x32_bf16 v[208:211], a[152:155], v[88:91], v[208:211]
    ds_read_b128 v[152:155], v15 offset:1536
    v_mfma_f32_16x16x32_bf16 v[212:215], a[156:159], v[88:91], v[212:215]
    v_mfma_f32_16x16x32_bf16 v[216:219], a[152:155], v[92:95], v[216:219]
    ds_read_b128 v[156:159], v15 offset:34304
    v_mfma_f32_16x16x32_bf16 v[220:223], a[156:159], v[92:95], v[220:223]
    s_waitcnt lgkmcnt(12)
    v_mfma_f32_16x16x32_bf16 v[208:211], a[160:163], v[96:99], v[208:211]
    ds_read_b128 v[160:163], v12 offset:1792
    v_mfma_f32_16x16x32_bf16 v[212:215], a[164:167], v[96:99], v[212:215]
    v_mfma_f32_16x16x32_bf16 v[216:219], a[160:163], v[100:103], v[216:219]
    ds_read_b128 v[164:167], v12 offset:34560
    v_mfma_f32_16x16x32_bf16 v[220:223], a[164:167], v[100:103], v[220:223]
    v_mfma_f32_16x16x32_bf16 v[208:211], a[168:171], v[104:107], v[208:211]
    ds_read_b128 v[168:171], v13 offset:1792
    v_mfma_f32_16x16x32_bf16 v[212:215], a[172:175], v[104:107], v[212:215]
    v_mfma_f32_16x16x32_bf16 v[216:219], a[168:171], v[108:111], v[216:219]
    ds_read_b128 v[172:175], v13 offset:34560
    v_mfma_f32_16x16x32_bf16 v[220:223], a[172:175], v[108:111], v[220:223]
    s_waitcnt lgkmcnt(12)
    v_mfma_f32_16x16x32_bf16 v[208:211], a[176:179], v[112:115], v[208:211]
    ds_read_b128 v[176:179], v14 offset:1792
    v_mfma_f32_16x16x32_bf16 v[212:215], a[180:183], v[112:115], v[212:215]
    s_waitcnt vmcnt(6)
    v_mov_b32 v27, s28
    s_mov_b64 exec, 1
    buffer_store_dword v27, v26, s[8:11], s94 offen sc1
    s_mov_b64 exec, -1
    v_mfma_f32_16x16x32_bf16 v[216:219], a[176:179], v[116:119], v[216:219]
    ds_read_b128 v[180:183], v14 offset:34560
    v_mfma_f32_16x16x32_bf16 v[220:223], a[180:183], v[116:119], v[220:223]
    v_mfma_f32_16x16x32_bf16 v[208:211], a[184:187], v[120:123], v[208:211]
    ds_read_b128 v[184:187], v15 offset:1792
    v_mfma_f32_16x16x32_bf16 v[212:215], a[188:191], v[120:123], v[212:215]
    s_add_u32 s28, s28, 1
    v_mfma_f32_16x16x32_bf16 v[216:219], a[184:187], v[124:127], v[216:219]
    ds_read_b128 v[188:191], v15 offset:34560
    v_mfma_f32_16x16x32_bf16 v[220:223], a[188:191], v[124:127], v[220:223]
    s_waitcnt lgkmcnt(12)
    v_mfma_f32_16x16x32_bf16 v[208:211], a[192:195], v[128:131], v[208:211]
    v_mfma_f32_16x16x32_bf16 v[212:215], a[196:199], v[128:131], v[212:215]
    v_mfma_f32_16x16x32_bf16 v[216:219], a[192:195], v[132:135], v[216:219]
    v_mfma_f32_16x16x32_bf16 v[220:223], a[196:199], v[132:135], v[220:223]
    v_mfma_f32_16x16x32_bf16 v[208:211], a[200:203], v[136:139], v[208:211]
    v_mfma_f32_16x16x32_bf16 v[212:215], a[204:207], v[136:139], v[212:215]
    s_add_u32 s29, s29, 0x10000
    s_min_u32 s29, s29, 0x3f0000
    v_mfma_f32_16x16x32_bf16 v[216:219], a[200:203], v[140:143], v[216:219]
    v_mfma_f32_16x16x32_bf16 v[220:223], a[204:207], v[140:143], v[220:223]
    s_waitcnt vmcnt(2) lgkmcnt(0)
    s_barrier
    v_mfma_f32_16x16x32_bf16 v[208:211], a[208:211], v[144:147], v[208:211]
    ds_read_b128 v[64:67], v8 offset:0
    ds_read_b128 v[68:71], v8 offset:32768
    v_mfma_f32_16x16x32_bf16 v[212:215], a[212:215], v[144:147], v[212:215]
    s_add_u32 m0, s6, 65536
    v_mfma_f32_16x16x32_bf16 v[216:219], a[208:211], v[148:151], v[216:219]
    ds_read_b128 v[72:75], v9 offset:0
    ds_read_b128 v[76:79], v9 offset:32768
    v_mfma_f32_16x16x32_bf16 v[220:223], a[212:215], v[148:151], v[220:223]
    buffer_load_dwordx4 v16, s[12:15], s29 offen offset:0 lds
    v_mfma_f32_16x16x32_bf16 v[208:211], a[216:219], v[152:155], v[208:211]
    ds_read_b128 v[80:83], v10 offset:0
    ds_read_b128 v[84:87], v10 offset:32768
    v_mfma_f32_16x16x32_bf16 v[212:215], a[220:223], v[152:155], v[212:215]
    v_mfma_f32_16x16x32_bf16 v[216:219], a[216:219], v[156:159], v[216:219]
    ds_read_b128 v[88:91], v11 offset:0
    ds_read_b128 v[92:95], v11 offset:32768
    v_mfma_f32_16x16x32_bf16 v[220:223], a[220:223], v[156:159], v[220:223]
    buffer_load_dwordx4 v16, s[12:15], s29 offen offset:1024 lds
    v_mfma_f32_16x16x32_bf16 v[208:211], a[224:227], v[160:163], v[208:211]
    ds_read_b128 v[96:99], v8 offset:256
    v_mfma_f32_16x16x32_bf16 v[212:215], a[228:231], v[160:163], v[212:215]
    v_mfma_f32_16x16x32_bf16 v[216:219], a[224:227], v[164:167], v[216:219]
    ds_read_b128 v[100:103], v8 offset:33024
    v_mfma_f32_16x16x32_bf16 v[220:223], a[228:231], v[164:167], v[220:223]
    buffer_load_dwordx4 v17, s[12:15], s29 offen offset:2048 lds
    v_mfma_f32_16x16x32_bf16 v[208:211], a[232:235], v[168:171], v[208:211]
    ds_read_b128 v[104:107], v9 offset:256
    v_mfma_f32_16x16x32_bf16 v[212:215], a[236:239], v[168:171], v[212:215]
    v_mfma_f32_16x16x32_bf16 v[216:219], a[232:235], v[172:175], v[216:219]
    ds_read_b128 v[108:111], v9 offset:33024
    v_mfma_f32_16x16x32_bf16 v[220:223], a[236:239], v[172:175], v[220:223]
    buffer_load_dwordx4 v17, s[12:15], s29 offen offset:3072 lds
    v_mfma_f32_16x16x32_bf16 v[208:211], a[240:243], v[176:179], v[208:211]
    ds_read_b128 v[112:115], v10 offset:256
    v_mfma_f32_16x16x32_bf16 v[212:215], a[244:247], v[176:179], v[212:215]
    s_add_u32 m0, s6, 69632
    v_mfma_f32_16x16x32_bf16 v[216:219], a[240:243], v[180:183], v[216:219]
    ds_read_b128 v[116:119], v10 offset:33024
    v_mfma_f32_16x16x32_bf16 v[220:223], a[244:247], v[180:183], v[220:223]
    buffer_load_dwordx4 v18, s[12:15], s29 offen offset:0 lds
    v_mfma_f32_16x16x32_bf16 v[208:211], a[248:251], v[184:187], v[208:211]
    ds_read_b128 v[120:123], v11 offset:256
    v_mfma_f32_16x16x32_bf16 v[212:215], a[252:255], v[184:187], v[212:215]
    v_mfma_f32_16x16x32_bf16 v[216:219], a[248:251], v[188:191], v[216:219]
    ds_read_b128 v[124:127], v11 offset:33024
    v_mfma_f32_16x16x32_bf16 v[220:223], a[252:255], v[188:191], v[220:223]
    buffer_load_dwordx4 v18, s[12:15], s29 offen offset:1024 lds
    s_cmp_lt_u32 s28, 64
    s_cbranch_scc1 .ql_344
    s_branch .qe_343
.vt_342:
.p2align 6
.ql_345:
    s_waitcnt lgkmcnt(12)
    v_mfma_f32_16x16x32_bf16 v[192:195], v[64:67], a[0:3], 0
    ds_read_b128 v[128:131], v8 offset:512
    v_mfma_f32_16x16x32_bf16 v[200:203], v[64:67], a[4:7], 0
    v_mfma_f32_16x16x32_bf16 v[196:199], v[68:71], a[0:3], 0
    ds_read_b128 v[132:135], v8 offset:33280
    v_mfma_f32_16x16x32_bf16 v[204:207], v[68:71], a[4:7], 0
    buffer_load_dwordx4 v19, s[12:15], s29 offen offset:2048 lds
    v_mfma_f32_16x16x32_bf16 v[192:195], v[72:75], a[8:11], v[192:195]
    ds_read_b128 v[136:139], v9 offset:512
    v_mfma_f32_16x16x32_bf16 v[200:203], v[72:75], a[12:15], v[200:203]
    v_cvt_pk_bf16_f32 v224, v208, v209
    v_cvt_pk_bf16_f32 v225, v210, v211
    v_mfma_f32_16x16x32_bf16 v[196:199], v[76:79], a[8:11], v[196:199]
    ds_read_b128 v[140:143], v9 offset:33280
    v_mfma_f32_16x16x32_bf16 v[204:207], v[76:79], a[12:15], v[204:207]
    buffer_load_dwordx4 v19, s[12:15], s29 offen offset:3072 lds
    s_waitcnt lgkmcnt(12)
    v_mfma_f32_16x16x32_bf16 v[192:195], v[80:83], a[16:19], v[192:195]
    ds_read_b128 v[144:147], v10 offset:512
    v_mfma_f32_16x16x32_bf16 v[200:203], v[80:83], a[20:23], v[200:203]
    s_add_u32 m0, s6, 73728
    v_cvt_pk_bf16_f32 v226, v212, v213
    v_cvt_pk_bf16_f32 v227, v214, v215
    v_mfma_f32_16x16x32_bf16 v[196:199], v[84:87], a[16:19], v[196:199]
    ds_read_b128 v[148:151], v10 offset:33280
    v_mfma_f32_16x16x32_bf16 v[204:207], v[84:87], a[20:23], v[204:207]
    buffer_load_dwordx4 v20, s[12:15], s29 offen offset:0 lds
    v_mfma_f32_16x16x32_bf16 v[192:195], v[88:91], a[24:27], v[192:195]
    ds_read_b128 v[152:155], v11 offset:512
    v_cvt_pk_bf16_f32 v228, v216, v217
    v_mfma_f32_16x16x32_bf16 v[200:203], v[88:91], a[28:31], v[200:203]
    buffer_store_dwordx4 v[224:227], v24, s[8:11], s30 offen sc1
    v_mfma_f32_16x16x32_bf16 v[196:199], v[92:95], a[24:27], v[196:199]
    ds_read_b128 v[156:159], v11 offset:33280
    v_cvt_pk_bf16_f32 v229, v218, v219
    v_mfma_f32_16x16x32_bf16 v[204:207], v[92:95], a[28:31], v[204:207]
    buffer_load_dwordx4 v20, s[12:15], s29 offen offset:1024 lds
    s_waitcnt lgkmcnt(12)
    v_mfma_f32_16x16x32_bf16 v[192:195], v[96:99], a[32:35], v[192:195]
    ds_read_b128 v[160:163], v8 offset:768
    v_mfma_f32_16x16x32_bf16 v[200:203], v[96:99], a[36:39], v[200:203]
    v_cvt_pk_bf16_f32 v230, v220, v221
    v_cvt_pk_bf16_f32 v231, v222, v223
    v_mfma_f32_16x16x32_bf16 v[196:199], v[100:103], a[32:35], v[196:199]
    ds_read_b128 v[164:167], v8 offset:33536
    v_mfma_f32_16x16x32_bf16 v[204:207], v[100:103], a[36:39], v[204:207]
    buffer_load_dwordx4 v21, s[12:15], s29 offen offset:2048 lds
    v_mfma_f32_16x16x32_bf16 v[192:195], v[104:107], a[40:43], v[192:195]
    ds_read_b128 v[168:171], v9 offset:768
    v_mfma_f32_16x16x32_bf16 v[200:203], v[104:107], a[44:47], v[200:203]
    buffer_store_dwordx4 v[228:231], v25, s[8:11], s30 offen sc1
    v_mfma_f32_16x16x32_bf16 v[196:199], v[108:111], a[40:43], v[196:199]
    ds_read_b128 v[172:175], v9 offset:33536
    v_mfma_f32_16x16x32_bf16 v[204:207], v[108:111], a[44:47], v[204:207]
    buffer_load_dwordx4 v21, s[12:15], s29 offen offset:3072 lds
    s_waitcnt lgkmcnt(12)
    v_mfma_f32_16x16x32_bf16 v[192:195], v[112:115], a[48:51], v[192:195]
    ds_read_b128 v[176:179], v10 offset:768
    v_mfma_f32_16x16x32_bf16 v[200:203], v[112:115], a[52:55], v[200:203]
    s_add_u32 m0, s6, 77824
    s_mov_b32 s30, s31
    v_mfma_f32_16x16x32_bf16 v[196:199], v[116:119], a[48:51], v[196:199]
    ds_read_b128 v[180:183], v10 offset:33536
    v_mfma_f32_16x16x32_bf16 v[204:207], v[116:119], a[52:55], v[204:207]
    buffer_load_dwordx4 v22, s[12:15], s29 offen offset:0 lds
    v_mfma_f32_16x16x32_bf16 v[192:195], v[120:123], a[56:59], v[192:195]
    ds_read_b128 v[184:187], v11 offset:768
    v_mfma_f32_16x16x32_bf16 v[200:203], v[120:123], a[60:63], v[200:203]
    s_add_u32 s31, s31, 262144
    v_mfma_f32_16x16x32_bf16 v[196:199], v[124:127], a[56:59], v[196:199]
    ds_read_b128 v[188:191], v11 offset:33536
    v_mfma_f32_16x16x32_bf16 v[204:207], v[124:127], a[60:63], v[204:207]
    buffer_load_dwordx4 v22, s[12:15], s29 offen offset:1024 lds
    s_waitcnt lgkmcnt(12)
    v_mfma_f32_16x16x32_bf16 v[192:195], v[128:131], a[64:67], v[192:195]
    ds_read_b128 v[64:67], v8 offset:1024
    v_mfma_f32_16x16x32_bf16 v[200:203], v[128:131], a[68:71], v[200:203]
    v_mfma_f32_16x16x32_bf16 v[196:199], v[132:135], a[64:67], v[196:199]
    ds_read_b128 v[68:71], v8 offset:33792
    v_mfma_f32_16x16x32_bf16 v[204:207], v[132:135], a[68:71], v[204:207]
    buffer_load_dwordx4 v23, s[12:15], s29 offen offset:2048 lds
    v_mfma_f32_16x16x32_bf16 v[192:195], v[136:139], a[72:75], v[192:195]
    ds_read_b128 v[72:75], v9 offset:1024
    v_mfma_f32_16x16x32_bf16 v[200:203], v[136:139], a[76:79], v[200:203]
    v_mfma_f32_16x16x32_bf16 v[196:199], v[140:143], a[72:75], v[196:199]
    ds_read_b128 v[76:79], v9 offset:33792
    v_mfma_f32_16x16x32_bf16 v[204:207], v[140:143], a[76:79], v[204:207]
    buffer_load_dwordx4 v23, s[12:15], s29 offen offset:3072 lds
    s_waitcnt lgkmcnt(12)
    v_mfma_f32_16x16x32_bf16 v[192:195], v[144:147], a[80:83], v[192:195]
    ds_read_b128 v[80:83], v10 offset:1024
    v_mfma_f32_16x16x32_bf16 v[200:203], v[144:147], a[84:87], v[200:203]
    v_mfma_f32_16x16x32_bf16 v[196:199], v[148:151], a[80:83], v[196:199]
    ds_read_b128 v[84:87], v10 offset:33792
    v_mfma_f32_16x16x32_bf16 v[204:207], v[148:151], a[84:87], v[204:207]
    buffer_load_dword v29, v28, s[12:15], s29 offen
    v_mfma_f32_16x16x32_bf16 v[192:195], v[152:155], a[88:91], v[192:195]
    ds_read_b128 v[88:91], v11 offset:1024
    v_mfma_f32_16x16x32_bf16 v[200:203], v[152:155], a[92:95], v[200:203]
    v_mfma_f32_16x16x32_bf16 v[196:199], v[156:159], a[88:91], v[196:199]
    ds_read_b128 v[92:95], v11 offset:33792
    v_mfma_f32_16x16x32_bf16 v[204:207], v[156:159], a[92:95], v[204:207]
    s_waitcnt lgkmcnt(12)
    v_mfma_f32_16x16x32_bf16 v[192:195], v[160:163], a[96:99], v[192:195]
    ds_read_b128 v[96:99], v8 offset:1280
    v_mfma_f32_16x16x32_bf16 v[200:203], v[160:163], a[100:103], v[200:203]
    v_mfma_f32_16x16x32_bf16 v[196:199], v[164:167], a[96:99], v[196:199]
    ds_read_b128 v[100:103], v8 offset:34048
    v_mfma_f32_16x16x32_bf16 v[204:207], v[164:167], a[100:103], v[204:207]
    v_mfma_f32_16x16x32_bf16 v[192:195], v[168:171], a[104:107], v[192:195]
    ds_read_b128 v[104:107], v9 offset:1280
    v_mfma_f32_16x16x32_bf16 v[200:203], v[168:171], a[108:111], v[200:203]
    v_mfma_f32_16x16x32_bf16 v[196:199], v[172:175], a[104:107], v[196:199]
    ds_read_b128 v[108:111], v9 offset:34048
    v_mfma_f32_16x16x32_bf16 v[204:207], v[172:175], a[108:111], v[204:207]
    s_waitcnt lgkmcnt(12)
    v_mfma_f32_16x16x32_bf16 v[192:195], v[176:179], a[112:115], v[192:195]
    ds_read_b128 v[112:115], v10 offset:1280
    v_mfma_f32_16x16x32_bf16 v[200:203], v[176:179], a[116:119], v[200:203]
    v_mfma_f32_16x16x32_bf16 v[196:199], v[180:183], a[112:115], v[196:199]
    ds_read_b128 v[116:119], v10 offset:34048
    v_mfma_f32_16x16x32_bf16 v[204:207], v[180:183], a[116:119], v[204:207]
    v_mfma_f32_16x16x32_bf16 v[192:195], v[184:187], a[120:123], v[192:195]
    ds_read_b128 v[120:123], v11 offset:1280
    v_mfma_f32_16x16x32_bf16 v[200:203], v[184:187], a[124:127], v[200:203]
    v_mfma_f32_16x16x32_bf16 v[196:199], v[188:191], a[120:123], v[196:199]
    ds_read_b128 v[124:127], v11 offset:34048
    v_mfma_f32_16x16x32_bf16 v[204:207], v[188:191], a[124:127], v[204:207]
    s_waitcnt lgkmcnt(12)
    v_mfma_f32_16x16x32_bf16 v[192:195], v[64:67], a[128:131], v[192:195]
    ds_read_b128 v[128:131], v8 offset:1536
    v_mfma_f32_16x16x32_bf16 v[200:203], v[64:67], a[132:135], v[200:203]
    v_mfma_f32_16x16x32_bf16 v[196:199], v[68:71], a[128:131], v[196:199]
    ds_read_b128 v[132:135], v8 offset:34304
    v_mfma_f32_16x16x32_bf16 v[204:207], v[68:71], a[132:135], v[204:207]
    v_mfma_f32_16x16x32_bf16 v[192:195], v[72:75], a[136:139], v[192:195]
    ds_read_b128 v[136:139], v9 offset:1536
    v_mfma_f32_16x16x32_bf16 v[200:203], v[72:75], a[140:143], v[200:203]
    v_mfma_f32_16x16x32_bf16 v[196:199], v[76:79], a[136:139], v[196:199]
    ds_read_b128 v[140:143], v9 offset:34304
    v_mfma_f32_16x16x32_bf16 v[204:207], v[76:79], a[140:143], v[204:207]
    s_waitcnt lgkmcnt(12)
    v_mfma_f32_16x16x32_bf16 v[192:195], v[80:83], a[144:147], v[192:195]
    ds_read_b128 v[144:147], v10 offset:1536
    v_mfma_f32_16x16x32_bf16 v[200:203], v[80:83], a[148:151], v[200:203]
    v_mfma_f32_16x16x32_bf16 v[196:199], v[84:87], a[144:147], v[196:199]
    ds_read_b128 v[148:151], v10 offset:34304
    v_mfma_f32_16x16x32_bf16 v[204:207], v[84:87], a[148:151], v[204:207]
    v_mfma_f32_16x16x32_bf16 v[192:195], v[88:91], a[152:155], v[192:195]
    ds_read_b128 v[152:155], v11 offset:1536
    v_mfma_f32_16x16x32_bf16 v[200:203], v[88:91], a[156:159], v[200:203]
    v_mfma_f32_16x16x32_bf16 v[196:199], v[92:95], a[152:155], v[196:199]
    ds_read_b128 v[156:159], v11 offset:34304
    v_mfma_f32_16x16x32_bf16 v[204:207], v[92:95], a[156:159], v[204:207]
    s_waitcnt lgkmcnt(12)
    v_mfma_f32_16x16x32_bf16 v[192:195], v[96:99], a[160:163], v[192:195]
    ds_read_b128 v[160:163], v8 offset:1792
    v_mfma_f32_16x16x32_bf16 v[200:203], v[96:99], a[164:167], v[200:203]
    v_mfma_f32_16x16x32_bf16 v[196:199], v[100:103], a[160:163], v[196:199]
    ds_read_b128 v[164:167], v8 offset:34560
    v_mfma_f32_16x16x32_bf16 v[204:207], v[100:103], a[164:167], v[204:207]
    v_mfma_f32_16x16x32_bf16 v[192:195], v[104:107], a[168:171], v[192:195]
    ds_read_b128 v[168:171], v9 offset:1792
    v_mfma_f32_16x16x32_bf16 v[200:203], v[104:107], a[172:175], v[200:203]
    v_mfma_f32_16x16x32_bf16 v[196:199], v[108:111], a[168:171], v[196:199]
    ds_read_b128 v[172:175], v9 offset:34560
    v_mfma_f32_16x16x32_bf16 v[204:207], v[108:111], a[172:175], v[204:207]
    s_waitcnt lgkmcnt(12)
    v_mfma_f32_16x16x32_bf16 v[192:195], v[112:115], a[176:179], v[192:195]
    ds_read_b128 v[176:179], v10 offset:1792
    v_mfma_f32_16x16x32_bf16 v[200:203], v[112:115], a[180:183], v[200:203]
    s_waitcnt vmcnt(6)
    v_mov_b32 v27, s28
    s_mov_b64 exec, 1
    buffer_store_dword v27, v26, s[8:11], s94 offen sc1
    s_mov_b64 exec, -1
    v_mfma_f32_16x16x32_bf16 v[196:199], v[116:119], a[176:179], v[196:199]
    ds_read_b128 v[180:183], v10 offset:34560
    v_mfma_f32_16x16x32_bf16 v[204:207], v[116:119], a[180:183], v[204:207]
    v_mfma_f32_16x16x32_bf16 v[192:195], v[120:123], a[184:187], v[192:195]
    ds_read_b128 v[184:187], v11 offset:1792
    v_mfma_f32_16x16x32_bf16 v[200:203], v[120:123], a[188:191], v[200:203]
    s_add_u32 s28, s28, 1
    v_mfma_f32_16x16x32_bf16 v[196:199], v[124:127], a[184:187], v[196:199]
    ds_read_b128 v[188:191], v11 offset:34560
    v_mfma_f32_16x16x32_bf16 v[204:207], v[124:127], a[188:191], v[204:207]
    s_waitcnt lgkmcnt(12)
    v_mfma_f32_16x16x32_bf16 v[192:195], v[128:131], a[192:195], v[192:195]
    v_mfma_f32_16x16x32_bf16 v[200:203], v[128:131], a[196:199], v[200:203]
    v_mfma_f32_16x16x32_bf16 v[196:199], v[132:135], a[192:195], v[196:199]
    v_mfma_f32_16x16x32_bf16 v[204:207], v[132:135], a[196:199], v[204:207]
    v_mfma_f32_16x16x32_bf16 v[192:195], v[136:139], a[200:203], v[192:195]
    v_mfma_f32_16x16x32_bf16 v[200:203], v[136:139], a[204:207], v[200:203]
    s_add_u32 s29, s29, 0x10000
    s_min_u32 s29, s29, 0x3f0000
    v_mfma_f32_16x16x32_bf16 v[196:199], v[140:143], a[200:203], v[196:199]
    v_mfma_f32_16x16x32_bf16 v[204:207], v[140:143], a[204:207], v[204:207]
    s_waitcnt vmcnt(2) lgkmcnt(0)
    s_barrier
    v_mfma_f32_16x16x32_bf16 v[192:195], v[144:147], a[208:211], v[192:195]
    ds_read_b128 v[64:67], v12 offset:0
    ds_read_b128 v[68:71], v12 offset:32768
    v_mfma_f32_16x16x32_bf16 v[200:203], v[144:147], a[212:215], v[200:203]
    s_add_u32 m0, s6, 0
    v_mfma_f32_16x16x32_bf16 v[196:199], v[148:151], a[208:211], v[196:199]
    ds_read_b128 v[72:75], v13 offset:0
    ds_read_b128 v[76:79], v13 offset:32768
    v_mfma_f32_16x16x32_bf16 v[204:207], v[148:151], a[212:215], v[204:207]
    buffer_load_dwordx4 v16, s[12:15], s29 offen offset:0 lds
    v_mfma_f32_16x16x32_bf16 v[192:195], v[152:155], a[216:219], v[192:195]
    ds_read_b128 v[80:83], v14 offset:0
    ds_read_b128 v[84:87], v14 offset:32768
    v_mfma_f32_16x16x32_bf16 v[200:203], v[152:155], a[220:223], v[200:203]
    v_mfma_f32_16x16x32_bf16 v[196:199], v[156:159], a[216:219], v[196:199]
    ds_read_b128 v[88:91], v15 offset:0
    ds_read_b128 v[92:95], v15 offset:32768
    v_mfma_f32_16x16x32_bf16 v[204:207], v[156:159], a[220:223], v[204:207]
    buffer_load_dwordx4 v16, s[12:15], s29 offen offset:1024 lds
    v_mfma_f32_16x16x32_bf16 v[192:195], v[160:163], a[224:227], v[192:195]
    ds_read_b128 v[96:99], v12 offset:256
    v_mfma_f32_16x16x32_bf16 v[200:203], v[160:163], a[228:231], v[200:203]
    v_mfma_f32_16x16x32_bf16 v[196:199], v[164:167], a[224:227], v[196:199]
    ds_read_b128 v[100:103], v12 offset:33024
    v_mfma_f32_16x16x32_bf16 v[204:207], v[164:167], a[228:231], v[204:207]
    buffer_load_dwordx4 v17, s[12:15], s29 offen offset:2048 lds
    v_mfma_f32_16x16x32_bf16 v[192:195], v[168:171], a[232:235], v[192:195]
    ds_read_b128 v[104:107], v13 offset:256
    v_mfma_f32_16x16x32_bf16 v[200:203], v[168:171], a[236:239], v[200:203]
    v_mfma_f32_16x16x32_bf16 v[196:199], v[172:175], a[232:235], v[196:199]
    ds_read_b128 v[108:111], v13 offset:33024
    v_mfma_f32_16x16x32_bf16 v[204:207], v[172:175], a[236:239], v[204:207]
    buffer_load_dwordx4 v17, s[12:15], s29 offen offset:3072 lds
    v_mfma_f32_16x16x32_bf16 v[192:195], v[176:179], a[240:243], v[192:195]
    ds_read_b128 v[112:115], v14 offset:256
    v_mfma_f32_16x16x32_bf16 v[200:203], v[176:179], a[244:247], v[200:203]
    s_add_u32 m0, s6, 4096
    v_mfma_f32_16x16x32_bf16 v[196:199], v[180:183], a[240:243], v[196:199]
    ds_read_b128 v[116:119], v14 offset:33024
    v_mfma_f32_16x16x32_bf16 v[204:207], v[180:183], a[244:247], v[204:207]
    buffer_load_dwordx4 v18, s[12:15], s29 offen offset:0 lds
    v_mfma_f32_16x16x32_bf16 v[192:195], v[184:187], a[248:251], v[192:195]
    ds_read_b128 v[120:123], v15 offset:256
    v_mfma_f32_16x16x32_bf16 v[200:203], v[184:187], a[252:255], v[200:203]
    v_mfma_f32_16x16x32_bf16 v[196:199], v[188:191], a[248:251], v[196:199]
    ds_read_b128 v[124:127], v15 offset:33024
    v_mfma_f32_16x16x32_bf16 v[204:207], v[188:191], a[252:255], v[204:207]
    buffer_load_dwordx4 v18, s[12:15], s29 offen offset:1024 lds
    s_waitcnt lgkmcnt(12)
    v_mfma_f32_16x16x32_bf16 v[208:211], v[64:67], a[0:3], 0
    ds_read_b128 v[128:131], v12 offset:512
    v_mfma_f32_16x16x32_bf16 v[216:219], v[64:67], a[4:7], 0
    v_mfma_f32_16x16x32_bf16 v[212:215], v[68:71], a[0:3], 0
    ds_read_b128 v[132:135], v12 offset:33280
    v_mfma_f32_16x16x32_bf16 v[220:223], v[68:71], a[4:7], 0
    buffer_load_dwordx4 v19, s[12:15], s29 offen offset:2048 lds
    v_mfma_f32_16x16x32_bf16 v[208:211], v[72:75], a[8:11], v[208:211]
    ds_read_b128 v[136:139], v13 offset:512
    v_mfma_f32_16x16x32_bf16 v[216:219], v[72:75], a[12:15], v[216:219]
    v_cvt_pk_bf16_f32 v224, v192, v193
    v_cvt_pk_bf16_f32 v225, v194, v195
    v_mfma_f32_16x16x32_bf16 v[212:215], v[76:79], a[8:11], v[212:215]
    ds_read_b128 v[140:143], v13 offset:33280
    v_mfma_f32_16x16x32_bf16 v[220:223], v[76:79], a[12:15], v[220:223]
    buffer_load_dwordx4 v19, s[12:15], s29 offen offset:3072 lds
    s_waitcnt lgkmcnt(12)
    v_mfma_f32_16x16x32_bf16 v[208:211], v[80:83], a[16:19], v[208:211]
    ds_read_b128 v[144:147], v14 offset:512
    v_mfma_f32_16x16x32_bf16 v[216:219], v[80:83], a[20:23], v[216:219]
    s_add_u32 m0, s6, 8192
    v_cvt_pk_bf16_f32 v226, v196, v197
    v_cvt_pk_bf16_f32 v227, v198, v199
    v_mfma_f32_16x16x32_bf16 v[212:215], v[84:87], a[16:19], v[212:215]
    ds_read_b128 v[148:151], v14 offset:33280
    v_mfma_f32_16x16x32_bf16 v[220:223], v[84:87], a[20:23], v[220:223]
    buffer_load_dwordx4 v20, s[12:15], s29 offen offset:0 lds
    v_mfma_f32_16x16x32_bf16 v[208:211], v[88:91], a[24:27], v[208:211]
    ds_read_b128 v[152:155], v15 offset:512
    v_cvt_pk_bf16_f32 v228, v200, v201
    v_mfma_f32_16x16x32_bf16 v[216:219], v[88:91], a[28:31], v[216:219]
    buffer_store_dwordx4 v[224:227], v24, s[8:11], s30 offen sc1
    v_mfma_f32_16x16x32_bf16 v[212:215], v[92:95], a[24:27], v[212:215]
    ds_read_b128 v[156:159], v15 offset:33280
    v_cvt_pk_bf16_f32 v229, v202, v203
    v_mfma_f32_16x16x32_bf16 v[220:223], v[92:95], a[28:31], v[220:223]
    buffer_load_dwordx4 v20, s[12:15], s29 offen offset:1024 lds
    s_waitcnt lgkmcnt(12)
    v_mfma_f32_16x16x32_bf16 v[208:211], v[96:99], a[32:35], v[208:211]
    ds_read_b128 v[160:163], v12 offset:768
    v_mfma_f32_16x16x32_bf16 v[216:219], v[96:99], a[36:39], v[216:219]
    v_cvt_pk_bf16_f32 v230, v204, v205
    v_cvt_pk_bf16_f32 v231, v206, v207
    v_mfma_f32_16x16x32_bf16 v[212:215], v[100:103], a[32:35], v[212:215]
    ds_read_b128 v[164:167], v12 offset:33536
    v_mfma_f32_16x16x32_bf16 v[220:223], v[100:103], a[36:39], v[220:223]
    buffer_load_dwordx4 v21, s[12:15], s29 offen offset:2048 lds
    v_mfma_f32_16x16x32_bf16 v[208:211], v[104:107], a[40:43], v[208:211]
    ds_read_b128 v[168:171], v13 offset:768
    v_mfma_f32_16x16x32_bf16 v[216:219], v[104:107], a[44:47], v[216:219]
    buffer_store_dwordx4 v[228:231], v25, s[8:11], s30 offen sc1
    v_mfma_f32_16x16x32_bf16 v[212:215], v[108:111], a[40:43], v[212:215]
    ds_read_b128 v[172:175], v13 offset:33536
    v_mfma_f32_16x16x32_bf16 v[220:223], v[108:111], a[44:47], v[220:223]
    buffer_load_dwordx4 v21, s[12:15], s29 offen offset:3072 lds
    s_waitcnt lgkmcnt(12)
    v_mfma_f32_16x16x32_bf16 v[208:211], v[112:115], a[48:51], v[208:211]
    ds_read_b128 v[176:179], v14 offset:768
    v_mfma_f32_16x16x32_bf16 v[216:219], v[112:115], a[52:55], v[216:219]
    s_add_u32 m0, s6, 12288
    s_mov_b32 s30, s31
    v_mfma_f32_16x16x32_bf16 v[212:215], v[116:119], a[48:51], v[212:215]
    ds_read_b128 v[180:183], v14 offset:33536
    v_mfma_f32_16x16x32_bf16 v[220:223], v[116:119], a[52:55], v[220:223]
    buffer_load_dwordx4 v22, s[12:15], s29 offen offset:0 lds
    v_mfma_f32_16x16x32_bf16 v[208:211], v[120:123], a[56:59], v[208:211]
    ds_read_b128 v[184:187], v15 offset:768
    v_mfma_f32_16x16x32_bf16 v[216:219], v[120:123], a[60:63], v[216:219]
    s_add_u32 s31, s31, 262144
    v_mfma_f32_16x16x32_bf16 v[212:215], v[124:127], a[56:59], v[212:215]
    ds_read_b128 v[188:191], v15 offset:33536
    v_mfma_f32_16x16x32_bf16 v[220:223], v[124:127], a[60:63], v[220:223]
    buffer_load_dwordx4 v22, s[12:15], s29 offen offset:1024 lds
    s_waitcnt lgkmcnt(12)
    v_mfma_f32_16x16x32_bf16 v[208:211], v[128:131], a[64:67], v[208:211]
    ds_read_b128 v[64:67], v12 offset:1024
    v_mfma_f32_16x16x32_bf16 v[216:219], v[128:131], a[68:71], v[216:219]
    v_mfma_f32_16x16x32_bf16 v[212:215], v[132:135], a[64:67], v[212:215]
    ds_read_b128 v[68:71], v12 offset:33792
    v_mfma_f32_16x16x32_bf16 v[220:223], v[132:135], a[68:71], v[220:223]
    buffer_load_dwordx4 v23, s[12:15], s29 offen offset:2048 lds
    v_mfma_f32_16x16x32_bf16 v[208:211], v[136:139], a[72:75], v[208:211]
    ds_read_b128 v[72:75], v13 offset:1024
    v_mfma_f32_16x16x32_bf16 v[216:219], v[136:139], a[76:79], v[216:219]
    v_mfma_f32_16x16x32_bf16 v[212:215], v[140:143], a[72:75], v[212:215]
    ds_read_b128 v[76:79], v13 offset:33792
    v_mfma_f32_16x16x32_bf16 v[220:223], v[140:143], a[76:79], v[220:223]
    buffer_load_dwordx4 v23, s[12:15], s29 offen offset:3072 lds
    s_waitcnt lgkmcnt(12)
    v_mfma_f32_16x16x32_bf16 v[208:211], v[144:147], a[80:83], v[208:211]
    ds_read_b128 v[80:83], v14 offset:1024
    v_mfma_f32_16x16x32_bf16 v[216:219], v[144:147], a[84:87], v[216:219]
    v_mfma_f32_16x16x32_bf16 v[212:215], v[148:151], a[80:83], v[212:215]
    ds_read_b128 v[84:87], v14 offset:33792
    v_mfma_f32_16x16x32_bf16 v[220:223], v[148:151], a[84:87], v[220:223]
    buffer_load_dword v29, v28, s[12:15], s29 offen
    v_mfma_f32_16x16x32_bf16 v[208:211], v[152:155], a[88:91], v[208:211]
    ds_read_b128 v[88:91], v15 offset:1024
    v_mfma_f32_16x16x32_bf16 v[216:219], v[152:155], a[92:95], v[216:219]
    v_mfma_f32_16x16x32_bf16 v[212:215], v[156:159], a[88:91], v[212:215]
    ds_read_b128 v[92:95], v15 offset:33792
    v_mfma_f32_16x16x32_bf16 v[220:223], v[156:159], a[92:95], v[220:223]
    s_waitcnt lgkmcnt(12)
    v_mfma_f32_16x16x32_bf16 v[208:211], v[160:163], a[96:99], v[208:211]
    ds_read_b128 v[96:99], v12 offset:1280
    v_mfma_f32_16x16x32_bf16 v[216:219], v[160:163], a[100:103], v[216:219]
    v_mfma_f32_16x16x32_bf16 v[212:215], v[164:167], a[96:99], v[212:215]
    ds_read_b128 v[100:103], v12 offset:34048
    v_mfma_f32_16x16x32_bf16 v[220:223], v[164:167], a[100:103], v[220:223]
    v_mfma_f32_16x16x32_bf16 v[208:211], v[168:171], a[104:107], v[208:211]
    ds_read_b128 v[104:107], v13 offset:1280
    v_mfma_f32_16x16x32_bf16 v[216:219], v[168:171], a[108:111], v[216:219]
    v_mfma_f32_16x16x32_bf16 v[212:215], v[172:175], a[104:107], v[212:215]
    ds_read_b128 v[108:111], v13 offset:34048
    v_mfma_f32_16x16x32_bf16 v[220:223], v[172:175], a[108:111], v[220:223]
    s_waitcnt lgkmcnt(12)
    v_mfma_f32_16x16x32_bf16 v[208:211], v[176:179], a[112:115], v[208:211]
    ds_read_b128 v[112:115], v14 offset:1280
    v_mfma_f32_16x16x32_bf16 v[216:219], v[176:179], a[116:119], v[216:219]
    v_mfma_f32_16x16x32_bf16 v[212:215], v[180:183], a[112:115], v[212:215]
    ds_read_b128 v[116:119], v14 offset:34048
    v_mfma_f32_16x16x32_bf16 v[220:223], v[180:183], a[116:119], v[220:223]
    v_mfma_f32_16x16x32_bf16 v[208:211], v[184:187], a[120:123], v[208:211]
    ds_read_b128 v[120:123], v15 offset:1280
    v_mfma_f32_16x16x32_bf16 v[216:219], v[184:187], a[124:127], v[216:219]
    v_mfma_f32_16x16x32_bf16 v[212:215], v[188:191], a[120:123], v[212:215]
    ds_read_b128 v[124:127], v15 offset:34048
    v_mfma_f32_16x16x32_bf16 v[220:223], v[188:191], a[124:127], v[220:223]
    s_waitcnt lgkmcnt(12)
    v_mfma_f32_16x16x32_bf16 v[208:211], v[64:67], a[128:131], v[208:211]
    ds_read_b128 v[128:131], v12 offset:1536
    v_mfma_f32_16x16x32_bf16 v[216:219], v[64:67], a[132:135], v[216:219]
    v_mfma_f32_16x16x32_bf16 v[212:215], v[68:71], a[128:131], v[212:215]
    ds_read_b128 v[132:135], v12 offset:34304
    v_mfma_f32_16x16x32_bf16 v[220:223], v[68:71], a[132:135], v[220:223]
    v_mfma_f32_16x16x32_bf16 v[208:211], v[72:75], a[136:139], v[208:211]
    ds_read_b128 v[136:139], v13 offset:1536
    v_mfma_f32_16x16x32_bf16 v[216:219], v[72:75], a[140:143], v[216:219]
    v_mfma_f32_16x16x32_bf16 v[212:215], v[76:79], a[136:139], v[212:215]
    ds_read_b128 v[140:143], v13 offset:34304
    v_mfma_f32_16x16x32_bf16 v[220:223], v[76:79], a[140:143], v[220:223]
    s_waitcnt lgkmcnt(12)
    v_mfma_f32_16x16x32_bf16 v[208:211], v[80:83], a[144:147], v[208:211]
    ds_read_b128 v[144:147], v14 offset:1536
    v_mfma_f32_16x16x32_bf16 v[216:219], v[80:83], a[148:151], v[216:219]
    v_mfma_f32_16x16x32_bf16 v[212:215], v[84:87], a[144:147], v[212:215]
    ds_read_b128 v[148:151], v14 offset:34304
    v_mfma_f32_16x16x32_bf16 v[220:223], v[84:87], a[148:151], v[220:223]
    v_mfma_f32_16x16x32_bf16 v[208:211], v[88:91], a[152:155], v[208:211]
    ds_read_b128 v[152:155], v15 offset:1536
    v_mfma_f32_16x16x32_bf16 v[216:219], v[88:91], a[156:159], v[216:219]
    v_mfma_f32_16x16x32_bf16 v[212:215], v[92:95], a[152:155], v[212:215]
    ds_read_b128 v[156:159], v15 offset:34304
    v_mfma_f32_16x16x32_bf16 v[220:223], v[92:95], a[156:159], v[220:223]
    s_waitcnt lgkmcnt(12)
    v_mfma_f32_16x16x32_bf16 v[208:211], v[96:99], a[160:163], v[208:211]
    ds_read_b128 v[160:163], v12 offset:1792
    v_mfma_f32_16x16x32_bf16 v[216:219], v[96:99], a[164:167], v[216:219]
    v_mfma_f32_16x16x32_bf16 v[212:215], v[100:103], a[160:163], v[212:215]
    ds_read_b128 v[164:167], v12 offset:34560
    v_mfma_f32_16x16x32_bf16 v[220:223], v[100:103], a[164:167], v[220:223]
    v_mfma_f32_16x16x32_bf16 v[208:211], v[104:107], a[168:171], v[208:211]
    ds_read_b128 v[168:171], v13 offset:1792
    v_mfma_f32_16x16x32_bf16 v[216:219], v[104:107], a[172:175], v[216:219]
    v_mfma_f32_16x16x32_bf16 v[212:215], v[108:111], a[168:171], v[212:215]
    ds_read_b128 v[172:175], v13 offset:34560
    v_mfma_f32_16x16x32_bf16 v[220:223], v[108:111], a[172:175], v[220:223]
    s_waitcnt lgkmcnt(12)
    v_mfma_f32_16x16x32_bf16 v[208:211], v[112:115], a[176:179], v[208:211]
    ds_read_b128 v[176:179], v14 offset:1792
    v_mfma_f32_16x16x32_bf16 v[216:219], v[112:115], a[180:183], v[216:219]
    s_waitcnt vmcnt(6)
    v_mov_b32 v27, s28
    s_mov_b64 exec, 1
    buffer_store_dword v27, v26, s[8:11], s94 offen sc1
    s_mov_b64 exec, -1
    v_mfma_f32_16x16x32_bf16 v[212:215], v[116:119], a[176:179], v[212:215]
    ds_read_b128 v[180:183], v14 offset:34560
    v_mfma_f32_16x16x32_bf16 v[220:223], v[116:119], a[180:183], v[220:223]
    v_mfma_f32_16x16x32_bf16 v[208:211], v[120:123], a[184:187], v[208:211]
    ds_read_b128 v[184:187], v15 offset:1792
    v_mfma_f32_16x16x32_bf16 v[216:219], v[120:123], a[188:191], v[216:219]
    s_add_u32 s28, s28, 1
    v_mfma_f32_16x16x32_bf16 v[212:215], v[124:127], a[184:187], v[212:215]
    ds_read_b128 v[188:191], v15 offset:34560
    v_mfma_f32_16x16x32_bf16 v[220:223], v[124:127], a[188:191], v[220:223]
    s_waitcnt lgkmcnt(12)
    v_mfma_f32_16x16x32_bf16 v[208:211], v[128:131], a[192:195], v[208:211]
    v_mfma_f32_16x16x32_bf16 v[216:219], v[128:131], a[196:199], v[216:219]
    v_mfma_f32_16x16x32_bf16 v[212:215], v[132:135], a[192:195], v[212:215]
    v_mfma_f32_16x16x32_bf16 v[220:223], v[132:135], a[196:199], v[220:223]
    v_mfma_f32_16x16x32_bf16 v[208:211], v[136:139], a[200:203], v[208:211]
    v_mfma_f32_16x16x32_bf16 v[216:219], v[136:139], a[204:207], v[216:219]
    s_add_u32 s29, s29, 0x10000
    s_min_u32 s29, s29, 0x3f0000
    v_mfma_f32_16x16x32_bf16 v[212:215], v[140:143], a[200:203], v[212:215]
    v_mfma_f32_16x16x32_bf16 v[220:223], v[140:143], a[204:207], v[220:223]
    s_waitcnt vmcnt(2) lgkmcnt(0)
    s_barrier
    v_mfma_f32_16x16x32_bf16 v[208:211], v[144:147], a[208:211], v[208:211]
    ds_read_b128 v[64:67], v8 offset:0
    ds_read_b128 v[68:71], v8 offset:32768
    v_mfma_f32_16x16x32_bf16 v[216:219], v[144:147], a[212:215], v[216:219]
    s_add_u32 m0, s6, 65536
    v_mfma_f32_16x16x32_bf16 v[212:215], v[148:151], a[208:211], v[212:215]
    ds_read_b128 v[72:75], v9 offset:0
    ds_read_b128 v[76:79], v9 offset:32768
    v_mfma_f32_16x16x32_bf16 v[220:223], v[148:151], a[212:215], v[220:223]
    buffer_load_dwordx4 v16, s[12:15], s29 offen offset:0 lds
    v_mfma_f32_16x16x32_bf16 v[208:211], v[152:155], a[216:219], v[208:211]
    ds_read_b128 v[80:83], v10 offset:0
    ds_read_b128 v[84:87], v10 offset:32768
    v_mfma_f32_16x16x32_bf16 v[216:219], v[152:155], a[220:223], v[216:219]
    v_mfma_f32_16x16x32_bf16 v[212:215], v[156:159], a[216:219], v[212:215]
    ds_read_b128 v[88:91], v11 offset:0
    ds_read_b128 v[92:95], v11 offset:32768
    v_mfma_f32_16x16x32_bf16 v[220:223], v[156:159], a[220:223], v[220:223]
    buffer_load_dwordx4 v16, s[12:15], s29 offen offset:1024 lds
    v_mfma_f32_16x16x32_bf16 v[208:211], v[160:163], a[224:227], v[208:211]
    ds_read_b128 v[96:99], v8 offset:256
    v_mfma_f32_16x16x32_bf16 v[216:219], v[160:163], a[228:231], v[216:219]
    v_mfma_f32_16x16x32_bf16 v[212:215], v[164:167], a[224:227], v[212:215]
    ds_read_b128 v[100:103], v8 offset:33024
    v_mfma_f32_16x16x32_bf16 v[220:223], v[164:167], a[228:231], v[220:223]
    buffer_load_dwordx4 v17, s[12:15], s29 offen offset:2048 lds
    v_mfma_f32_16x16x32_bf16 v[208:211], v[168:171], a[232:235], v[208:211]
    ds_read_b128 v[104:107], v9 offset:256
    v_mfma_f32_16x16x32_bf16 v[216:219], v[168:171], a[236:239], v[216:219]
    v_mfma_f32_16x16x32_bf16 v[212:215], v[172:175], a[232:235], v[212:215]
    ds_read_b128 v[108:111], v9 offset:33024
    v_mfma_f32_16x16x32_bf16 v[220:223], v[172:175], a[236:239], v[220:223]
    buffer_load_dwordx4 v17, s[12:15], s29 offen offset:3072 lds
    v_mfma_f32_16x16x32_bf16 v[208:211], v[176:179], a[240:243], v[208:211]
    ds_read_b128 v[112:115], v10 offset:256
    v_mfma_f32_16x16x32_bf16 v[216:219], v[176:179], a[244:247], v[216:219]
    s_add_u32 m0, s6, 69632
    v_mfma_f32_16x16x32_bf16 v[212:215], v[180:183], a[240:243], v[212:215]
    ds_read_b128 v[116:119], v10 offset:33024
    v_mfma_f32_16x16x32_bf16 v[220:223], v[180:183], a[244:247], v[220:223]
    buffer_load_dwordx4 v18, s[12:15], s29 offen offset:0 lds
    v_mfma_f32_16x16x32_bf16 v[208:211], v[184:187], a[248:251], v[208:211]
    ds_read_b128 v[120:123], v11 offset:256
    v_mfma_f32_16x16x32_bf16 v[216:219], v[184:187], a[252:255], v[216:219]
    v_mfma_f32_16x16x32_bf16 v[212:215], v[188:191], a[248:251], v[212:215]
    ds_read_b128 v[124:127], v11 offset:33024
    v_mfma_f32_16x16x32_bf16 v[220:223], v[188:191], a[252:255], v[220:223]
    buffer_load_dwordx4 v18, s[12:15], s29 offen offset:1024 lds
    s_cmp_lt_u32 s28, 64
    s_cbranch_scc1 .ql_345
.qe_343:
    s_nop 7
    v_cvt_pk_bf16_f32 v224, v208, v209
    v_cvt_pk_bf16_f32 v225, v210, v211
    v_cvt_pk_bf16_f32 v226, v212, v213
    v_cvt_pk_bf16_f32 v227, v214, v215
    v_cvt_pk_bf16_f32 v228, v216, v217
    v_cvt_pk_bf16_f32 v229, v218, v219
    v_cvt_pk_bf16_f32 v230, v220, v221
    v_cvt_pk_bf16_f32 v231, v222, v223
    buffer_store_dwordx4 v[224:227], v24, s[8:11], s30 offen sc1
    buffer_store_dwordx4 v[228:231], v25, s[8:11], s30 offen sc1
    s_waitcnt vmcnt(0) lgkmcnt(0)
    v_mov_b32 v27, s28
    s_mov_b64 exec, 1
    buffer_store_dword v27, v26, s[8:11], s94 offen sc1
    s_mov_b64 exec, -1
    s_barrier
    s_sub_u32 s95, s98, 1
    s_load_dwordx8 s[40:47], s[0:1], 0
    s_load_dwordx4 s[48:51], s[0:1], 32
    s_load_dwordx2 s[52:53], s[0:1], 104
    s_mul_i32 s6, s24, 8320
    s_add_u32 s6, s6, 122880
    s_lshl_b32 s97, s95, 4
    s_and_b32 s4, s99, 16
    s_add_u32 s97, s97, s4
    s_add_u32 s97, s97, s99
    s_lshl_b32 s4, s97, 16
    s_lshl_b32 s5, s24, 14
    s_add_u32 s4, s4, s5
    v_lshlrev_b32 v2, 4, v1
    v_bfe_u32 v254, v1, 0, 3
    v_mul_u32_u24 v3, 2048, v254
    v_bfe_u32 v254, v1, 4, 2
    v_mul_u32_u24 v254, 16, v254
    v_add_u32 v3, v3, v254
    v_add_u32 v3, s4, v3
    v_bfe_u32 v254, v1, 4, 2
    v_mul_u32_u24 v4, 16, v254
    v_add_u32 v4, s6, v4
    s_waitcnt lgkmcnt(0)
    s_mov_b32 s12, s40
    s_and_b32 s13, s41, 0xffff
    s_mov_b32 s14, 0x400000
    s_mov_b32 s15, 0x00020000
    s_mov_b32 s16, s42
    s_and_b32 s17, s43, 0xffff
    s_mov_b32 s18, 0x400000
    s_mov_b32 s19, 0x00020000
    s_mov_b32 s28, s44
    s_and_b32 s29, s45, 0xffff
    s_mov_b32 s30, 0x400000
    s_mov_b32 s31, 0x00020000
    s_mov_b32 s32, s46
    s_and_b32 s33, s47, 0xffff
    s_mov_b32 s34, 0x2000
    s_mov_b32 s35, 0x00020000
    s_mov_b32 s36, s48
    s_and_b32 s37, s49, 0xffff
    s_mov_b32 s38, 0x400000
    s_mov_b32 s39, 0x00020000
    s_mov_b32 s56, s52
    s_and_b32 s57, s53, 0xffff
    s_mov_b32 s58, 0x800
    s_mov_b32 s59, 0x00020000
    s_mov_b32 m0, s6
    s_lshl_b32 s60, s97, 4
    buffer_load_dwordx4 v2, s[56:59], 0 offen lds
    buffer_load_dwordx4 v2, s[56:59], 0 offen offset:1024 lds
    s_add_u32 s61, s60, s24
    v_subrev_u32 v5, 4, v2
    buffer_load_dwordx4 a[0:3], v3, s[12:15], 0 offen offset:0
    buffer_load_dwordx4 a[4:7], v3, s[12:15], 0 offen offset:64
    buffer_load_dwordx4 a[8:11], v3, s[12:15], 0 offen offset:128
    buffer_load_dwordx4 a[12:15], v3, s[12:15], 0 offen offset:192
    buffer_load_dwordx4 a[16:19], v3, s[12:15], 0 offen offset:256
    buffer_load_dwordx4 a[20:23], v3, s[12:15], 0 offen offset:320
    buffer_load_dwordx4 a[24:27], v3, s[12:15], 0 offen offset:384
    buffer_load_dwordx4 a[28:31], v3, s[12:15], 0 offen offset:448
    buffer_load_dwordx4 a[32:35], v3, s[12:15], 0 offen offset:512
    buffer_load_dwordx4 a[36:39], v3, s[12:15], 0 offen offset:576
    buffer_load_dwordx4 a[40:43], v3, s[12:15], 0 offen offset:640
    buffer_load_dwordx4 a[44:47], v3, s[12:15], 0 offen offset:704
    buffer_load_dwordx4 a[48:51], v3, s[12:15], 0 offen offset:768
    buffer_load_dwordx4 a[52:55], v3, s[12:15], 0 offen offset:832
    buffer_load_dwordx4 a[56:59], v3, s[12:15], 0 offen offset:896
    buffer_load_dwordx4 a[60:63], v3, s[12:15], 0 offen offset:960
    buffer_load_dwordx4 a[64:67], v3, s[12:15], 0 offen offset:1024
    buffer_load_dwordx4 a[68:71], v3, s[12:15], 0 offen offset:1088
    buffer_load_dwordx4 a[72:75], v3, s[12:15], 0 offen offset:1152
    buffer_load_dwordx4 a[76:79], v3, s[12:15], 0 offen offset:1216
    buffer_load_dwordx4 a[80:83], v3, s[12:15], 0 offen offset:1280
    buffer_load_dwordx4 a[84:87], v3, s[12:15], 0 offen offset:1344
    buffer_load_dwordx4 a[88:91], v3, s[12:15], 0 offen offset:1408
    buffer_load_dwordx4 a[92:95], v3, s[12:15], 0 offen offset:1472
    buffer_load_dwordx4 a[96:99], v3, s[12:15], 0 offen offset:1536
    buffer_load_dwordx4 a[100:103], v3, s[12:15], 0 offen offset:1600
    buffer_load_dwordx4 a[104:107], v3, s[12:15], 0 offen offset:1664
    buffer_load_dwordx4 a[108:111], v3, s[12:15], 0 offen offset:1728
    buffer_load_dwordx4 a[112:115], v3, s[12:15], 0 offen offset:1792
    buffer_load_dwordx4 a[116:119], v3, s[12:15], 0 offen offset:1856
    buffer_load_dwordx4 a[120:123], v3, s[12:15], 0 offen offset:1920
    buffer_load_dwordx4 a[124:127], v3, s[12:15], 0 offen offset:1984
    s_lshl_b32 s4, s24, 19
    s_lshl_b32 s5, s97, 5
    s_add_u32 s4, s4, s5
    v_bfe_u32 v254, v1, 1, 5
    v_mul_u32_u24 v7, 16384, v254
    v_bfe_u32 v254, v1, 0, 1
    v_mul_u32_u24 v254, 16, v254
    v_add_u32 v7, v7, v254
    v_add_u32 v7, s4, v7
    s_waitcnt vmcnt(32)
    ds_read_b128 a[128:131], v4 offset:0
    ds_read_b128 a[132:135], v4 offset:64
    ds_read_b128 a[136:139], v4 offset:128
    ds_read_b128 a[140:143], v4 offset:192
    ds_read_b128 a[144:147], v4 offset:256
    ds_read_b128 a[148:151], v4 offset:320
    ds_read_b128 a[152:155], v4 offset:384
    ds_read_b128 a[156:159], v4 offset:448
    ds_read_b128 a[160:163], v4 offset:512
    ds_read_b128 a[164:167], v4 offset:576
    ds_read_b128 a[168:171], v4 offset:640
    ds_read_b128 a[172:175], v4 offset:704
    ds_read_b128 a[176:179], v4 offset:768
    ds_read_b128 a[180:183], v4 offset:832
    ds_read_b128 a[184:187], v4 offset:896
    ds_read_b128 a[188:191], v4 offset:960
    ds_read_b128 a[192:195], v4 offset:1024
    ds_read_b128 a[196:199], v4 offset:1088
    ds_read_b128 a[200:203], v4 offset:1152
    ds_read_b128 a[204:207], v4 offset:1216
    ds_read_b128 a[208:211], v4 offset:1280
    ds_read_b128 a[212:215], v4 offset:1344
    ds_read_b128 a[216:219], v4 offset:1408
    ds_read_b128 a[220:223], v4 offset:1472
    ds_read_b128 a[224:227], v4 offset:1536
    ds_read_b128 a[228:231], v4 offset:1600
    ds_read_b128 a[232:235], v4 offset:1664
    ds_read_b128 a[236:239], v4 offset:1728
    ds_read_b128 a[240:243], v4 offset:1792
    ds_read_b128 a[244:247], v4 offset:1856
    ds_read_b128 a[248:251], v4 offset:1920
    ds_read_b128 a[252:255], v4 offset:1984
    v_subrev_u32 v8, 6144, v7
    buffer_load_dwordx4 v[32:35], v8, s[16:19], 0 offen
    v_subrev_u32 v8, 4096, v7
    buffer_load_dwordx4 v[36:39], v8, s[16:19], 0 offen
    v_subrev_u32 v8, 2048, v7
    buffer_load_dwordx4 v[40:43], v8, s[16:19], 0 offen
    s_mov_b32 s4, 0
    buffer_load_dwordx4 v[44:47], v7, s[16:19], s4 offen offset:0
    buffer_load_dwordx4 v[76:79], v7, s[28:31], s4 offen offset:0
    buffer_load_dwordx4 v[48:51], v7, s[16:19], s4 offen offset:2048
    buffer_load_dwordx4 v[80:83], v7, s[28:31], s4 offen offset:2048
    s_mov_b32 s4, 4096
    buffer_load_dwordx4 v[52:55], v7, s[16:19], s4 offen offset:0
    buffer_load_dwordx4 v[84:87], v7, s[28:31], s4 offen offset:0
    buffer_load_dwordx4 v[56:59], v7, s[16:19], s4 offen offset:2048
    buffer_load_dwordx4 v[88:91], v7, s[28:31], s4 offen offset:2048
    s_mov_b32 s4, 8192
    buffer_load_dwordx4 v[60:63], v7, s[16:19], s4 offen offset:0
    buffer_load_dwordx4 v[92:95], v7, s[28:31], s4 offen offset:0
    buffer_load_dwordx4 v[64:67], v7, s[16:19], s4 offen offset:2048
    buffer_load_dwordx4 v[96:99], v7, s[28:31], s4 offen offset:2048
    s_mov_b32 s4, 12288
    buffer_load_dwordx4 v[68:71], v7, s[16:19], s4 offen offset:0
    buffer_load_dwordx4 v[100:103], v7, s[28:31], s4 offen offset:0
    buffer_load_dwordx4 v[72:75], v7, s[16:19], s4 offen offset:2048
    buffer_load_dwordx4 v[104:107], v7, s[28:31], s4 offen offset:2048
    v_add_u32 v9, s6, v2
    v_and_b32 v12, 31, v1
    v_lshrrev_b32 v13, 5, v1
    v_lshlrev_b32 v14, 3, v13
    v_sub_u32 v14, v12, v14
    v_add_u32 v15, 10, v14
    v_and_b32 v10, 1, v15
    v_xor_b32 v10, 1, v10
    v_mul_u32_u24 v10, 4160, v10
    v_lshrrev_b32 v15, 1, v15
    v_lshl_add_u32 v10, v15, 2, v10
    v_add_u32 v10, s6, v10
    v_mul_u32_u24 v11, 80, v12
    v_lshl_add_u32 v11, v13, 4, v11
    s_mul_i32 s4, s24, 7680
    s_sub_u32 s4, s4, 2480
    v_add_u32 v11, s4, v11
    v_cmp_eq_u32 vcc, 7, v14
    v_mov_b32 v15, 0xffff
    s_nop 0
    v_cndmask_b32 v24, 0, v15, vcc
    v_cmp_eq_u32 vcc, 6, v14
    v_mov_b32 v15, 0xffff0000
    s_nop 0
    v_cndmask_b32 v24, v24, v15, vcc
    v_cmp_eq_u32 vcc, 5, v14
    v_mov_b32 v15, 0xffff
    s_nop 0
    v_cndmask_b32 v25, 0, v15, vcc
    v_cmp_eq_u32 vcc, 4, v14
    v_mov_b32 v15, 0xffff0000
    s_nop 0
    v_cndmask_b32 v25, v25, v15, vcc
    v_cmp_eq_u32 vcc, 3, v14
    v_mov_b32 v15, 0xffff
    s_nop 0
    v_cndmask_b32 v26, 0, v15, vcc
    v_cmp_eq_u32 vcc, 2, v14
    v_mov_b32 v15, 0xffff0000
    s_nop 0
    v_cndmask_b32 v26, v26, v15, vcc
    v_cmp_eq_u32 vcc, 1, v14
    v_mov_b32 v15, 0xffff
    s_nop 0
    v_cndmask_b32 v27, 0, v15, vcc
    v_cmp_eq_u32 vcc, 0, v14
    v_mov_b32 v15, 0xffff0000
    s_nop 0
    v_cndmask_b32 v27, v27, v15, vcc
    v_cmp_eq_u32 vcc, 23, v14
    v_mov_b32 v15, 0xffff
    s_nop 0
    v_cndmask_b32 v28, 0, v15, vcc
    v_cmp_eq_u32 vcc, 22, v14
    v_mov_b32 v15, 0xffff0000
    s_nop 0
    v_cndmask_b32 v28, v28, v15, vcc
    v_cmp_eq_u32 vcc, 21, v14
    v_mov_b32 v15, 0xffff
    s_nop 0
    v_cndmask_b32 v29, 0, v15, vcc
    v_cmp_eq_u32 vcc, 20, v14
    v_mov_b32 v15, 0xffff0000
    s_nop 0
    v_cndmask_b32 v29, v29, v15, vcc
    v_cmp_eq_u32 vcc, 19, v14
    v_mov_b32 v15, 0xffff
    s_nop 0
    v_cndmask_b32 v30, 0, v15, vcc
    v_cmp_eq_u32 vcc, 18, v14
    v_mov_b32 v15, 0xffff0000
    s_nop 0
    v_cndmask_b32 v30, v30, v15, vcc
    v_cmp_eq_u32 vcc, 17, v14
    v_mov_b32 v15, 0xffff
    s_nop 0
    v_cndmask_b32 v31, 0, v15, vcc
    v_cmp_eq_u32 vcc, 16, v14
    v_mov_b32 v15, 0xffff0000
    s_nop 0
    v_cndmask_b32 v31, v31, v15, vcc
    s_waitcnt lgkmcnt(0)
    s_waitcnt vmcnt(50)
    v_mfma_f32_16x16x32_bf16 v[216:219], a[128:131], a[0:3], 0
    s_waitcnt vmcnt(49)
    v_mfma_f32_16x16x32_bf16 v[216:219], a[132:135], a[4:7], v[216:219]
    s_waitcnt vmcnt(48)
    v_mfma_f32_16x16x32_bf16 v[216:219], a[136:139], a[8:11], v[216:219]
    s_waitcnt vmcnt(47)
    v_mfma_f32_16x16x32_bf16 v[216:219], a[140:143], a[12:15], v[216:219]
    s_waitcnt vmcnt(46)
    v_mfma_f32_16x16x32_bf16 v[216:219], a[144:147], a[16:19], v[216:219]
    s_waitcnt vmcnt(45)
    v_mfma_f32_16x16x32_bf16 v[216:219], a[148:151], a[20:23], v[216:219]
    s_waitcnt vmcnt(44)
    v_mfma_f32_16x16x32_bf16 v[216:219], a[152:155], a[24:27], v[216:219]
    s_waitcnt vmcnt(43)
    v_mfma_f32_16x16x32_bf16 v[216:219], a[156:159], a[28:31], v[216:219]
    s_waitcnt vmcnt(42)
    v_mfma_f32_16x16x32_bf16 v[216:219], a[160:163], a[32:35], v[216:219]
    s_waitcnt vmcnt(41)
    v_mfma_f32_16x16x32_bf16 v[216:219], a[164:167], a[36:39], v[216:219]
    s_waitcnt vmcnt(40)
    v_mfma_f32_16x16x32_bf16 v[216:219], a[168:171], a[40:43], v[216:219]
    s_waitcnt vmcnt(39)
    v_mfma_f32_16x16x32_bf16 v[216:219], a[172:175], a[44:47], v[216:219]
    s_waitcnt vmcnt(38)
    v_mfma_f32_16x16x32_bf16 v[216:219], a[176:179], a[48:51], v[216:219]
    s_waitcnt vmcnt(37)
    v_mfma_f32_16x16x32_bf16 v[216:219], a[180:183], a[52:55], v[216:219]
    s_waitcnt vmcnt(36)
    v_mfma_f32_16x16x32_bf16 v[216:219], a[184:187], a[56:59], v[216:219]
    s_waitcnt vmcnt(35)
    v_mfma_f32_16x16x32_bf16 v[216:219], a[188:191], a[60:63], v[216:219]
    s_waitcnt vmcnt(34)
    v_mfma_f32_16x16x32_bf16 v[216:219], a[192:195], a[64:67], v[216:219]
    s_waitcnt vmcnt(33)
    v_mfma_f32_16x16x32_bf16 v[216:219], a[196:199], a[68:71], v[216:219]
    s_waitcnt vmcnt(32)
    v_mfma_f32_16x16x32_bf16 v[216:219], a[200:203], a[72:75], v[216:219]
    s_waitcnt vmcnt(31)
    v_mfma_f32_16x16x32_bf16 v[216:219], a[204:207], a[76:79], v[216:219]
    s_waitcnt vmcnt(30)
    v_mfma_f32_16x16x32_bf16 v[216:219], a[208:211], a[80:83], v[216:219]
    s_waitcnt vmcnt(29)
    v_mfma_f32_16x16x32_bf16 v[216:219], a[212:215], a[84:87], v[216:219]
    s_waitcnt vmcnt(28)
    v_mfma_f32_16x16x32_bf16 v[216:219], a[216:219], a[88:91], v[216:219]
    s_waitcnt vmcnt(27)
    v_mfma_f32_16x16x32_bf16 v[216:219], a[220:223], a[92:95], v[216:219]
    s_waitcnt vmcnt(26)
    v_mfma_f32_16x16x32_bf16 v[216:219], a[224:227], a[96:99], v[216:219]
    s_waitcnt vmcnt(25)
    v_mfma_f32_16x16x32_bf16 v[216:219], a[228:231], a[100:103], v[216:219]
    s_waitcnt vmcnt(24)
    v_mfma_f32_16x16x32_bf16 v[216:219], a[232:235], a[104:107], v[216:219]
    s_waitcnt vmcnt(23)
    v_mfma_f32_16x16x32_bf16 v[216:219], a[236:239], a[108:111], v[216:219]
    s_waitcnt vmcnt(22)
    v_mfma_f32_16x16x32_bf16 v[216:219], a[240:243], a[112:115], v[216:219]
    s_waitcnt vmcnt(21)
    v_mfma_f32_16x16x32_bf16 v[216:219], a[244:247], a[116:119], v[216:219]
    s_waitcnt vmcnt(20)
    v_mfma_f32_16x16x32_bf16 v[216:219], a[248:251], a[120:123], v[216:219]
    s_waitcnt vmcnt(19)
    v_mfma_f32_16x16x32_bf16 v[216:219], a[252:255], a[124:127], v[216:219]
    v_add_u32 v7, 2097152, v7
    v_subrev_u32 v8, 6144, v7
    buffer_load_dwordx4 v[108:111], v8, s[16:19], 0 offen
    v_subrev_u32 v8, 4096, v7
    buffer_load_dwordx4 v[112:115], v8, s[16:19], 0 offen
    v_subrev_u32 v8, 2048, v7
    buffer_load_dwordx4 v[116:119], v8, s[16:19], 0 offen
    s_mov_b32 s4, 0
    buffer_load_dwordx4 v[120:123], v7, s[16:19], s4 offen offset:0
    buffer_load_dwordx4 v[152:155], v7, s[28:31], s4 offen offset:0
    buffer_load_dwordx4 v[124:127], v7, s[16:19], s4 offen offset:2048
    buffer_load_dwordx4 v[156:159], v7, s[28:31], s4 offen offset:2048
    s_mov_b32 s4, 4096
    buffer_load_dwordx4 v[128:131], v7, s[16:19], s4 offen offset:0
    buffer_load_dwordx4 v[160:163], v7, s[28:31], s4 offen offset:0
    buffer_load_dwordx4 v[132:135], v7, s[16:19], s4 offen offset:2048
    buffer_load_dwordx4 v[164:167], v7, s[28:31], s4 offen offset:2048
    s_mov_b32 s4, 8192
    buffer_load_dwordx4 v[136:139], v7, s[16:19], s4 offen offset:0
    buffer_load_dwordx4 v[168:171], v7, s[28:31], s4 offen offset:0
    buffer_load_dwordx4 v[140:143], v7, s[16:19], s4 offen offset:2048
    buffer_load_dwordx4 v[172:175], v7, s[28:31], s4 offen offset:2048
    s_mov_b32 s4, 12288
    buffer_load_dwordx4 v[144:147], v7, s[16:19], s4 offen offset:0
    buffer_load_dwordx4 v[176:179], v7, s[28:31], s4 offen offset:0
    buffer_load_dwordx4 v[148:151], v7, s[16:19], s4 offen offset:2048
    buffer_load_dwordx4 v[180:183], v7, s[28:31], s4 offen offset:2048
    v_cvt_pk_bf16_f32 v216, v216, v216
    v_lshlrev_b32 v216, 16, v216
    v_mul_f32 v216, 0xbfb8aa3b, v216
    v_exp_f32 v216, v216
    s_lshl_b32 s4, s97, 7
    v_add_f32 v216, 1.0, v216
    v_rcp_f32 v216, v216
    s_lshl_b32 s5, s24, 5
    v_cvt_pk_bf16_f32 v216, v216, v216
    v_lshlrev_b32 v216, 16, v216
    s_add_u32 s4, s4, s5
    s_add_u32 s4, s4, 121634816
    v_lshlrev_b32 v15, 2, v1
    s_mov_b64 exec, 0xff
    buffer_store_dword v216, v15, s[8:11], s4 offen sc1
    s_mov_b64 exec, -1
    v_mov_b32 v220, 0
    v_mov_b32 v221, 0
    v_mov_b32 v222, 0
    v_mov_b32 v223, 0
    s_mul_i32 s4, s24, 7680
    v_add_u32 v15, s4, v2
    ds_write_b128 v15, v[220:223] offset:0
    ds_write_b128 v15, v[220:223] offset:1024
    ds_write_b128 v15, v[220:223] offset:1536
    v_add_u32 v15, 30720, v15
    ds_write_b128 v15, v[220:223] offset:0
    ds_write_b128 v15, v[220:223] offset:1024
    ds_write_b128 v15, v[220:223] offset:1536
    v_add_u32 v15, 30720, v15
    ds_write_b128 v15, v[220:223] offset:0
    ds_write_b128 v15, v[220:223] offset:1024
    ds_write_b128 v15, v[220:223] offset:1536
    v_add_u32 v15, 30720, v15
    ds_write_b128 v15, v[220:223] offset:0
    ds_write_b128 v15, v[220:223] offset:1024
    ds_write_b128 v15, v[220:223] offset:1536
    v_add_u32 v15, 30720, v15
    s_mov_b64 exec, 0xf
    ds_write_b128 v9, v[220:223]
    ds_write_b128 v9, v[220:223] offset:4160
    s_mov_b64 exec, -1
    s_mul_i32 s4, s24, 640
    s_add_u32 s4, s4, 2560
    v_bfe_u32 v254, v1, 0, 1
    v_mul_u32_u24 v12, 61440, v254
    v_bfe_u32 v254, v1, 3, 3
    v_mul_u32_u24 v254, 80, v254
    v_add_u32 v12, v12, v254
    v_bfe_u32 v254, v1, 1, 2
    v_mul_u32_u24 v254, 16, v254
    v_add_u32 v12, v12, v254
    v_add_u32 v12, s4, v12
    s_lshl_b32 s4, s97, 7
    v_bfe_u32 v254, v1, 0, 1
    v_mul_u32_u24 v13, 64, v254
    v_add_u32 v13, s4, v13
    buffer_load_dwordx4 v[216:219], v13, s[32:35], 0 offen offset:0
    buffer_load_dwordx4 v[220:223], v13, s[32:35], 0 offen offset:16
    buffer_load_dwordx4 v[224:227], v13, s[32:35], 0 offen offset:32
    buffer_load_dwordx4 v[228:231], v13, s[32:35], 0 offen offset:48
    s_waitcnt vmcnt(0)
    v_lshlrev_b32 v184, 16, v216
    v_lshlrev_b32 v185, 16, v218
    v_and_b32 v186, 0xffff0000, v216
    v_and_b32 v187, 0xffff0000, v218
    v_lshlrev_b32 v188, 16, v217
    v_lshlrev_b32 v189, 16, v219
    v_and_b32 v190, 0xffff0000, v217
    v_and_b32 v191, 0xffff0000, v219
    v_lshlrev_b32 v192, 16, v220
    v_lshlrev_b32 v193, 16, v222
    v_and_b32 v194, 0xffff0000, v220
    v_and_b32 v195, 0xffff0000, v222
    v_lshlrev_b32 v196, 16, v221
    v_lshlrev_b32 v197, 16, v223
    v_and_b32 v198, 0xffff0000, v221
    v_and_b32 v199, 0xffff0000, v223
    v_lshlrev_b32 v200, 16, v224
    v_lshlrev_b32 v201, 16, v226
    v_and_b32 v202, 0xffff0000, v224
    v_and_b32 v203, 0xffff0000, v226
    v_lshlrev_b32 v204, 16, v225
    v_lshlrev_b32 v205, 16, v227
    v_and_b32 v206, 0xffff0000, v225
    v_and_b32 v207, 0xffff0000, v227
    v_lshlrev_b32 v208, 16, v228
    v_lshlrev_b32 v209, 16, v230
    v_and_b32 v210, 0xffff0000, v228
    v_and_b32 v211, 0xffff0000, v230
    v_lshlrev_b32 v212, 16, v229
    v_lshlrev_b32 v213, 16, v231
    v_and_b32 v214, 0xffff0000, v229
    v_and_b32 v215, 0xffff0000, v231
    v_lshlrev_b32 v216, 16, v32
    v_and_b32 v217, 0xffff0000, v32
    v_lshlrev_b32 v218, 16, v36
    v_and_b32 v219, 0xffff0000, v36
    v_lshlrev_b32 v220, 16, v40
    v_and_b32 v221, 0xffff0000, v40
    v_lshlrev_b32 v222, 16, v44
    v_and_b32 v223, 0xffff0000, v44
    v_lshlrev_b32 v224, 16, v48
    v_and_b32 v225, 0xffff0000, v48
    v_lshlrev_b32 v226, 16, v52
    v_and_b32 v227, 0xffff0000, v52
    v_lshlrev_b32 v228, 16, v56
    v_and_b32 v229, 0xffff0000, v56
    v_lshlrev_b32 v230, 16, v60
    v_and_b32 v231, 0xffff0000, v60
    v_lshlrev_b32 v232, 16, v64
    v_and_b32 v233, 0xffff0000, v64
    v_lshlrev_b32 v234, 16, v68
    v_and_b32 v235, 0xffff0000, v68
    v_lshlrev_b32 v236, 16, v72
    v_and_b32 v237, 0xffff0000, v72
    v_pk_mul_f32 v[216:217], v[216:217], v[190:191]
    v_lshlrev_b32 v238, 16, v76
    v_pk_fma_f32 v[216:217], v[218:219], v[188:189], v[216:217]
    v_and_b32 v239, 0xffff0000, v76
    v_pk_fma_f32 v[216:217], v[220:221], v[186:187], v[216:217]
    v_pk_fma_f32 v[216:217], v[222:223], v[184:185], v[216:217]
    v_pk_mul_f32 v[216:217], v[216:217], v[238:239]
    v_pk_mul_f32 v[218:219], v[218:219], v[190:191]
    v_lshlrev_b32 v240, 16, v80
    v_pk_fma_f32 v[218:219], v[220:221], v[188:189], v[218:219]
    v_and_b32 v241, 0xffff0000, v80
    v_pk_fma_f32 v[218:219], v[222:223], v[186:187], v[218:219]
    v_pk_fma_f32 v[218:219], v[224:225], v[184:185], v[218:219]
    v_pk_mul_f32 v[218:219], v[218:219], v[240:241]
    v_pk_mul_f32 v[220:221], v[220:221], v[190:191]
    v_lshlrev_b32 v238, 16, v84
    v_pk_fma_f32 v[220:221], v[222:223], v[188:189], v[220:221]
    v_and_b32 v239, 0xffff0000, v84
    v_pk_fma_f32 v[220:221], v[224:225], v[186:187], v[220:221]
    v_pk_fma_f32 v[220:221], v[226:227], v[184:185], v[220:221]
    v_pk_mul_f32 v[220:221], v[220:221], v[238:239]
    v_pk_mul_f32 v[222:223], v[222:223], v[190:191]
    v_lshlrev_b32 v240, 16, v88
    v_pk_fma_f32 v[222:223], v[224:225], v[188:189], v[222:223]
    v_and_b32 v241, 0xffff0000, v88
    v_pk_fma_f32 v[222:223], v[226:227], v[186:187], v[222:223]
    v_pk_fma_f32 v[222:223], v[228:229], v[184:185], v[222:223]
    v_pk_mul_f32 v[222:223], v[222:223], v[240:241]
    v_pk_mul_f32 v[224:225], v[224:225], v[190:191]
    v_lshlrev_b32 v238, 16, v92
    v_pk_fma_f32 v[224:225], v[226:227], v[188:189], v[224:225]
    v_and_b32 v239, 0xffff0000, v92
    v_pk_fma_f32 v[224:225], v[228:229], v[186:187], v[224:225]
    v_pk_fma_f32 v[224:225], v[230:231], v[184:185], v[224:225]
    v_pk_mul_f32 v[224:225], v[224:225], v[238:239]
    v_pk_mul_f32 v[226:227], v[226:227], v[190:191]
    v_lshlrev_b32 v240, 16, v96
    v_pk_fma_f32 v[226:227], v[228:229], v[188:189], v[226:227]
    v_and_b32 v241, 0xffff0000, v96
    v_pk_fma_f32 v[226:227], v[230:231], v[186:187], v[226:227]
    v_pk_fma_f32 v[226:227], v[232:233], v[184:185], v[226:227]
    v_pk_mul_f32 v[226:227], v[226:227], v[240:241]
    v_pk_mul_f32 v[228:229], v[228:229], v[190:191]
    v_lshlrev_b32 v238, 16, v100
    v_pk_fma_f32 v[228:229], v[230:231], v[188:189], v[228:229]
    v_and_b32 v239, 0xffff0000, v100
    v_pk_fma_f32 v[228:229], v[232:233], v[186:187], v[228:229]
    v_pk_fma_f32 v[228:229], v[234:235], v[184:185], v[228:229]
    v_pk_mul_f32 v[228:229], v[228:229], v[238:239]
    v_pk_mul_f32 v[230:231], v[230:231], v[190:191]
    v_lshlrev_b32 v240, 16, v104
    v_pk_fma_f32 v[230:231], v[232:233], v[188:189], v[230:231]
    v_and_b32 v241, 0xffff0000, v104
    v_pk_fma_f32 v[230:231], v[234:235], v[186:187], v[230:231]
    v_pk_fma_f32 v[230:231], v[236:237], v[184:185], v[230:231]
    v_pk_mul_f32 v[230:231], v[230:231], v[240:241]
    v_cvt_pk_bf16_f32 v242, v230, v228
    v_cvt_pk_bf16_f32 v243, v226, v224
    v_cvt_pk_bf16_f32 v244, v222, v220
    v_cvt_pk_bf16_f32 v245, v218, v216
    ds_write_b128 v12, v[242:245] offset:0
    v_cvt_pk_bf16_f32 v246, v231, v229
    v_cvt_pk_bf16_f32 v247, v227, v225
    v_cvt_pk_bf16_f32 v248, v223, v221
    v_cvt_pk_bf16_f32 v249, v219, v217
    ds_write_b128 v12, v[246:249] offset:7680
    v_lshlrev_b32 v216, 16, v33
    v_and_b32 v217, 0xffff0000, v33
    v_lshlrev_b32 v218, 16, v37
    v_and_b32 v219, 0xffff0000, v37
    v_lshlrev_b32 v220, 16, v41
    v_and_b32 v221, 0xffff0000, v41
    v_lshlrev_b32 v222, 16, v45
    v_and_b32 v223, 0xffff0000, v45
    v_lshlrev_b32 v224, 16, v49
    v_and_b32 v225, 0xffff0000, v49
    v_lshlrev_b32 v226, 16, v53
    v_and_b32 v227, 0xffff0000, v53
    v_lshlrev_b32 v228, 16, v57
    v_and_b32 v229, 0xffff0000, v57
    v_lshlrev_b32 v230, 16, v61
    v_and_b32 v231, 0xffff0000, v61
    v_lshlrev_b32 v232, 16, v65
    v_and_b32 v233, 0xffff0000, v65
    v_lshlrev_b32 v234, 16, v69
    v_and_b32 v235, 0xffff0000, v69
    v_lshlrev_b32 v236, 16, v73
    v_and_b32 v237, 0xffff0000, v73
    v_pk_mul_f32 v[216:217], v[216:217], v[198:199]
    v_lshlrev_b32 v238, 16, v77
    v_pk_fma_f32 v[216:217], v[218:219], v[196:197], v[216:217]
    v_and_b32 v239, 0xffff0000, v77
    v_pk_fma_f32 v[216:217], v[220:221], v[194:195], v[216:217]
    v_pk_fma_f32 v[216:217], v[222:223], v[192:193], v[216:217]
    v_pk_mul_f32 v[216:217], v[216:217], v[238:239]
    v_pk_mul_f32 v[218:219], v[218:219], v[198:199]
    v_lshlrev_b32 v240, 16, v81
    v_pk_fma_f32 v[218:219], v[220:221], v[196:197], v[218:219]
    v_and_b32 v241, 0xffff0000, v81
    v_pk_fma_f32 v[218:219], v[222:223], v[194:195], v[218:219]
    v_pk_fma_f32 v[218:219], v[224:225], v[192:193], v[218:219]
    v_pk_mul_f32 v[218:219], v[218:219], v[240:241]
    v_pk_mul_f32 v[220:221], v[220:221], v[198:199]
    v_lshlrev_b32 v238, 16, v85
    v_pk_fma_f32 v[220:221], v[222:223], v[196:197], v[220:221]
    v_and_b32 v239, 0xffff0000, v85
    v_pk_fma_f32 v[220:221], v[224:225], v[194:195], v[220:221]
    v_pk_fma_f32 v[220:221], v[226:227], v[192:193], v[220:221]
    v_pk_mul_f32 v[220:221], v[220:221], v[238:239]
    v_pk_mul_f32 v[222:223], v[222:223], v[198:199]
    v_lshlrev_b32 v240, 16, v89
    v_pk_fma_f32 v[222:223], v[224:225], v[196:197], v[222:223]
    v_and_b32 v241, 0xffff0000, v89
    v_pk_fma_f32 v[222:223], v[226:227], v[194:195], v[222:223]
    v_pk_fma_f32 v[222:223], v[228:229], v[192:193], v[222:223]
    v_pk_mul_f32 v[222:223], v[222:223], v[240:241]
    v_pk_mul_f32 v[224:225], v[224:225], v[198:199]
    v_lshlrev_b32 v238, 16, v93
    v_pk_fma_f32 v[224:225], v[226:227], v[196:197], v[224:225]
    v_and_b32 v239, 0xffff0000, v93
    v_pk_fma_f32 v[224:225], v[228:229], v[194:195], v[224:225]
    v_pk_fma_f32 v[224:225], v[230:231], v[192:193], v[224:225]
    v_pk_mul_f32 v[224:225], v[224:225], v[238:239]
    v_pk_mul_f32 v[226:227], v[226:227], v[198:199]
    v_lshlrev_b32 v240, 16, v97
    v_pk_fma_f32 v[226:227], v[228:229], v[196:197], v[226:227]
    v_and_b32 v241, 0xffff0000, v97
    v_pk_fma_f32 v[226:227], v[230:231], v[194:195], v[226:227]
    v_pk_fma_f32 v[226:227], v[232:233], v[192:193], v[226:227]
    v_pk_mul_f32 v[226:227], v[226:227], v[240:241]
    v_pk_mul_f32 v[228:229], v[228:229], v[198:199]
    v_lshlrev_b32 v238, 16, v101
    v_pk_fma_f32 v[228:229], v[230:231], v[196:197], v[228:229]
    v_and_b32 v239, 0xffff0000, v101
    v_pk_fma_f32 v[228:229], v[232:233], v[194:195], v[228:229]
    v_pk_fma_f32 v[228:229], v[234:235], v[192:193], v[228:229]
    v_pk_mul_f32 v[228:229], v[228:229], v[238:239]
    v_pk_mul_f32 v[230:231], v[230:231], v[198:199]
    v_lshlrev_b32 v240, 16, v105
    v_pk_fma_f32 v[230:231], v[232:233], v[196:197], v[230:231]
    v_and_b32 v241, 0xffff0000, v105
    v_pk_fma_f32 v[230:231], v[234:235], v[194:195], v[230:231]
    v_pk_fma_f32 v[230:231], v[236:237], v[192:193], v[230:231]
    v_pk_mul_f32 v[230:231], v[230:231], v[240:241]
    v_cvt_pk_bf16_f32 v242, v230, v228
    v_cvt_pk_bf16_f32 v243, v226, v224
    v_cvt_pk_bf16_f32 v244, v222, v220
    v_cvt_pk_bf16_f32 v245, v218, v216
    ds_write_b128 v12, v[242:245] offset:15360
    v_cvt_pk_bf16_f32 v246, v231, v229
    v_cvt_pk_bf16_f32 v247, v227, v225
    v_cvt_pk_bf16_f32 v248, v223, v221
    v_cvt_pk_bf16_f32 v249, v219, v217
    ds_write_b128 v12, v[246:249] offset:23040
    v_lshlrev_b32 v216, 16, v34
    v_and_b32 v217, 0xffff0000, v34
    v_lshlrev_b32 v218, 16, v38
    v_and_b32 v219, 0xffff0000, v38
    v_lshlrev_b32 v220, 16, v42
    v_and_b32 v221, 0xffff0000, v42
    v_lshlrev_b32 v222, 16, v46
    v_and_b32 v223, 0xffff0000, v46
    v_lshlrev_b32 v224, 16, v50
    v_and_b32 v225, 0xffff0000, v50
    v_lshlrev_b32 v226, 16, v54
    v_and_b32 v227, 0xffff0000, v54
    v_lshlrev_b32 v228, 16, v58
    v_and_b32 v229, 0xffff0000, v58
    v_lshlrev_b32 v230, 16, v62
    v_and_b32 v231, 0xffff0000, v62
    v_lshlrev_b32 v232, 16, v66
    v_and_b32 v233, 0xffff0000, v66
    v_lshlrev_b32 v234, 16, v70
    v_and_b32 v235, 0xffff0000, v70
    v_lshlrev_b32 v236, 16, v74
    v_and_b32 v237, 0xffff0000, v74
    v_pk_mul_f32 v[216:217], v[216:217], v[206:207]
    v_lshlrev_b32 v238, 16, v78
    v_pk_fma_f32 v[216:217], v[218:219], v[204:205], v[216:217]
    v_and_b32 v239, 0xffff0000, v78
    v_pk_fma_f32 v[216:217], v[220:221], v[202:203], v[216:217]
    v_pk_fma_f32 v[216:217], v[222:223], v[200:201], v[216:217]
    v_pk_mul_f32 v[216:217], v[216:217], v[238:239]
    v_pk_mul_f32 v[218:219], v[218:219], v[206:207]
    v_lshlrev_b32 v240, 16, v82
    v_pk_fma_f32 v[218:219], v[220:221], v[204:205], v[218:219]
    v_and_b32 v241, 0xffff0000, v82
    v_pk_fma_f32 v[218:219], v[222:223], v[202:203], v[218:219]
    v_pk_fma_f32 v[218:219], v[224:225], v[200:201], v[218:219]
    v_pk_mul_f32 v[218:219], v[218:219], v[240:241]
    v_pk_mul_f32 v[220:221], v[220:221], v[206:207]
    v_lshlrev_b32 v238, 16, v86
    v_pk_fma_f32 v[220:221], v[222:223], v[204:205], v[220:221]
    v_and_b32 v239, 0xffff0000, v86
    v_pk_fma_f32 v[220:221], v[224:225], v[202:203], v[220:221]
    v_pk_fma_f32 v[220:221], v[226:227], v[200:201], v[220:221]
    v_pk_mul_f32 v[220:221], v[220:221], v[238:239]
    v_pk_mul_f32 v[222:223], v[222:223], v[206:207]
    v_lshlrev_b32 v240, 16, v90
    v_pk_fma_f32 v[222:223], v[224:225], v[204:205], v[222:223]
    v_and_b32 v241, 0xffff0000, v90
    v_pk_fma_f32 v[222:223], v[226:227], v[202:203], v[222:223]
    v_pk_fma_f32 v[222:223], v[228:229], v[200:201], v[222:223]
    v_pk_mul_f32 v[222:223], v[222:223], v[240:241]
    v_pk_mul_f32 v[224:225], v[224:225], v[206:207]
    v_lshlrev_b32 v238, 16, v94
    v_pk_fma_f32 v[224:225], v[226:227], v[204:205], v[224:225]
    v_and_b32 v239, 0xffff0000, v94
    v_pk_fma_f32 v[224:225], v[228:229], v[202:203], v[224:225]
    v_pk_fma_f32 v[224:225], v[230:231], v[200:201], v[224:225]
    v_pk_mul_f32 v[224:225], v[224:225], v[238:239]
    v_pk_mul_f32 v[226:227], v[226:227], v[206:207]
    v_lshlrev_b32 v240, 16, v98
    v_pk_fma_f32 v[226:227], v[228:229], v[204:205], v[226:227]
    v_and_b32 v241, 0xffff0000, v98
    v_pk_fma_f32 v[226:227], v[230:231], v[202:203], v[226:227]
    v_pk_fma_f32 v[226:227], v[232:233], v[200:201], v[226:227]
    v_pk_mul_f32 v[226:227], v[226:227], v[240:241]
    v_pk_mul_f32 v[228:229], v[228:229], v[206:207]
    v_lshlrev_b32 v238, 16, v102
    v_pk_fma_f32 v[228:229], v[230:231], v[204:205], v[228:229]
    v_and_b32 v239, 0xffff0000, v102
    v_pk_fma_f32 v[228:229], v[232:233], v[202:203], v[228:229]
    v_pk_fma_f32 v[228:229], v[234:235], v[200:201], v[228:229]
    v_pk_mul_f32 v[228:229], v[228:229], v[238:239]
    v_pk_mul_f32 v[230:231], v[230:231], v[206:207]
    v_lshlrev_b32 v240, 16, v106
    v_pk_fma_f32 v[230:231], v[232:233], v[204:205], v[230:231]
    v_and_b32 v241, 0xffff0000, v106
    v_pk_fma_f32 v[230:231], v[234:235], v[202:203], v[230:231]
    v_pk_fma_f32 v[230:231], v[236:237], v[200:201], v[230:231]
    v_pk_mul_f32 v[230:231], v[230:231], v[240:241]
    v_cvt_pk_bf16_f32 v242, v230, v228
    v_cvt_pk_bf16_f32 v243, v226, v224
    v_cvt_pk_bf16_f32 v244, v222, v220
    v_cvt_pk_bf16_f32 v245, v218, v216
    ds_write_b128 v12, v[242:245] offset:30720
    v_cvt_pk_bf16_f32 v246, v231, v229
    v_cvt_pk_bf16_f32 v247, v227, v225
    v_cvt_pk_bf16_f32 v248, v223, v221
    v_cvt_pk_bf16_f32 v249, v219, v217
    ds_write_b128 v12, v[246:249] offset:38400
    v_lshlrev_b32 v216, 16, v35
    v_and_b32 v217, 0xffff0000, v35
    v_lshlrev_b32 v218, 16, v39
    v_and_b32 v219, 0xffff0000, v39
    v_lshlrev_b32 v220, 16, v43
    v_and_b32 v221, 0xffff0000, v43
    v_lshlrev_b32 v222, 16, v47
    v_and_b32 v223, 0xffff0000, v47
    v_lshlrev_b32 v224, 16, v51
    v_and_b32 v225, 0xffff0000, v51
    v_lshlrev_b32 v226, 16, v55
    v_and_b32 v227, 0xffff0000, v55
    v_lshlrev_b32 v228, 16, v59
    v_and_b32 v229, 0xffff0000, v59
    v_lshlrev_b32 v230, 16, v63
    v_and_b32 v231, 0xffff0000, v63
    v_lshlrev_b32 v232, 16, v67
    v_and_b32 v233, 0xffff0000, v67
    v_lshlrev_b32 v234, 16, v71
    v_and_b32 v235, 0xffff0000, v71
    v_lshlrev_b32 v236, 16, v75
    v_and_b32 v237, 0xffff0000, v75
    v_pk_mul_f32 v[216:217], v[216:217], v[214:215]
    v_lshlrev_b32 v238, 16, v79
    v_pk_fma_f32 v[216:217], v[218:219], v[212:213], v[216:217]
    v_and_b32 v239, 0xffff0000, v79
    v_pk_fma_f32 v[216:217], v[220:221], v[210:211], v[216:217]
    v_pk_fma_f32 v[216:217], v[222:223], v[208:209], v[216:217]
    v_pk_mul_f32 v[216:217], v[216:217], v[238:239]
    v_pk_mul_f32 v[218:219], v[218:219], v[214:215]
    v_lshlrev_b32 v240, 16, v83
    v_pk_fma_f32 v[218:219], v[220:221], v[212:213], v[218:219]
    v_and_b32 v241, 0xffff0000, v83
    v_pk_fma_f32 v[218:219], v[222:223], v[210:211], v[218:219]
    v_pk_fma_f32 v[218:219], v[224:225], v[208:209], v[218:219]
    v_pk_mul_f32 v[218:219], v[218:219], v[240:241]
    v_pk_mul_f32 v[220:221], v[220:221], v[214:215]
    v_lshlrev_b32 v238, 16, v87
    v_pk_fma_f32 v[220:221], v[222:223], v[212:213], v[220:221]
    v_and_b32 v239, 0xffff0000, v87
    v_pk_fma_f32 v[220:221], v[224:225], v[210:211], v[220:221]
    v_pk_fma_f32 v[220:221], v[226:227], v[208:209], v[220:221]
    v_pk_mul_f32 v[220:221], v[220:221], v[238:239]
    v_pk_mul_f32 v[222:223], v[222:223], v[214:215]
    v_lshlrev_b32 v240, 16, v91
    v_pk_fma_f32 v[222:223], v[224:225], v[212:213], v[222:223]
    v_and_b32 v241, 0xffff0000, v91
    v_pk_fma_f32 v[222:223], v[226:227], v[210:211], v[222:223]
    v_pk_fma_f32 v[222:223], v[228:229], v[208:209], v[222:223]
    v_pk_mul_f32 v[222:223], v[222:223], v[240:241]
    v_pk_mul_f32 v[224:225], v[224:225], v[214:215]
    v_lshlrev_b32 v238, 16, v95
    v_pk_fma_f32 v[224:225], v[226:227], v[212:213], v[224:225]
    v_and_b32 v239, 0xffff0000, v95
    v_pk_fma_f32 v[224:225], v[228:229], v[210:211], v[224:225]
    v_pk_fma_f32 v[224:225], v[230:231], v[208:209], v[224:225]
    v_pk_mul_f32 v[224:225], v[224:225], v[238:239]
    v_pk_mul_f32 v[226:227], v[226:227], v[214:215]
    v_lshlrev_b32 v240, 16, v99
    v_pk_fma_f32 v[226:227], v[228:229], v[212:213], v[226:227]
    v_and_b32 v241, 0xffff0000, v99
    v_pk_fma_f32 v[226:227], v[230:231], v[210:211], v[226:227]
    v_pk_fma_f32 v[226:227], v[232:233], v[208:209], v[226:227]
    v_pk_mul_f32 v[226:227], v[226:227], v[240:241]
    v_pk_mul_f32 v[228:229], v[228:229], v[214:215]
    v_lshlrev_b32 v238, 16, v103
    v_pk_fma_f32 v[228:229], v[230:231], v[212:213], v[228:229]
    v_and_b32 v239, 0xffff0000, v103
    v_pk_fma_f32 v[228:229], v[232:233], v[210:211], v[228:229]
    v_pk_fma_f32 v[228:229], v[234:235], v[208:209], v[228:229]
    v_pk_mul_f32 v[228:229], v[228:229], v[238:239]
    v_pk_mul_f32 v[230:231], v[230:231], v[214:215]
    v_lshlrev_b32 v240, 16, v107
    v_pk_fma_f32 v[230:231], v[232:233], v[212:213], v[230:231]
    v_and_b32 v241, 0xffff0000, v107
    v_pk_fma_f32 v[230:231], v[234:235], v[210:211], v[230:231]
    v_pk_fma_f32 v[230:231], v[236:237], v[208:209], v[230:231]
    v_pk_mul_f32 v[230:231], v[230:231], v[240:241]
    v_cvt_pk_bf16_f32 v242, v230, v228
    v_cvt_pk_bf16_f32 v243, v226, v224
    v_cvt_pk_bf16_f32 v244, v222, v220
    v_cvt_pk_bf16_f32 v245, v218, v216
    ds_write_b128 v12, v[242:245] offset:46080
    v_cvt_pk_bf16_f32 v246, v231, v229
    v_cvt_pk_bf16_f32 v247, v227, v225
    v_cvt_pk_bf16_f32 v248, v223, v221
    v_cvt_pk_bf16_f32 v249, v219, v217
    ds_write_b128 v12, v[246:249] offset:53760
    v_lshlrev_b32 v216, 16, v108
    v_and_b32 v217, 0xffff0000, v108
    v_lshlrev_b32 v218, 16, v112
    v_and_b32 v219, 0xffff0000, v112
    v_lshlrev_b32 v220, 16, v116
    v_and_b32 v221, 0xffff0000, v116
    v_lshlrev_b32 v222, 16, v120
    v_and_b32 v223, 0xffff0000, v120
    v_lshlrev_b32 v224, 16, v124
    v_and_b32 v225, 0xffff0000, v124
    v_lshlrev_b32 v226, 16, v128
    v_and_b32 v227, 0xffff0000, v128
    v_lshlrev_b32 v228, 16, v132
    v_and_b32 v229, 0xffff0000, v132
    v_lshlrev_b32 v230, 16, v136
    v_and_b32 v231, 0xffff0000, v136
    v_lshlrev_b32 v232, 16, v140
    v_and_b32 v233, 0xffff0000, v140
    v_lshlrev_b32 v234, 16, v144
    v_and_b32 v235, 0xffff0000, v144
    v_lshlrev_b32 v236, 16, v148
    v_and_b32 v237, 0xffff0000, v148
    v_pk_mul_f32 v[216:217], v[216:217], v[190:191]
    v_lshlrev_b32 v238, 16, v152
    v_pk_fma_f32 v[216:217], v[218:219], v[188:189], v[216:217]
    v_and_b32 v239, 0xffff0000, v152
    v_pk_fma_f32 v[216:217], v[220:221], v[186:187], v[216:217]
    v_pk_fma_f32 v[216:217], v[222:223], v[184:185], v[216:217]
    v_pk_mul_f32 v[216:217], v[216:217], v[238:239]
    v_pk_mul_f32 v[218:219], v[218:219], v[190:191]
    v_lshlrev_b32 v240, 16, v156
    v_pk_fma_f32 v[218:219], v[220:221], v[188:189], v[218:219]
    v_and_b32 v241, 0xffff0000, v156
    v_pk_fma_f32 v[218:219], v[222:223], v[186:187], v[218:219]
    v_pk_fma_f32 v[218:219], v[224:225], v[184:185], v[218:219]
    v_pk_mul_f32 v[218:219], v[218:219], v[240:241]
    v_pk_mul_f32 v[220:221], v[220:221], v[190:191]
    v_lshlrev_b32 v238, 16, v160
    v_pk_fma_f32 v[220:221], v[222:223], v[188:189], v[220:221]
    v_and_b32 v239, 0xffff0000, v160
    v_pk_fma_f32 v[220:221], v[224:225], v[186:187], v[220:221]
    v_pk_fma_f32 v[220:221], v[226:227], v[184:185], v[220:221]
    v_pk_mul_f32 v[220:221], v[220:221], v[238:239]
    v_pk_mul_f32 v[222:223], v[222:223], v[190:191]
    v_lshlrev_b32 v240, 16, v164
    v_pk_fma_f32 v[222:223], v[224:225], v[188:189], v[222:223]
    v_and_b32 v241, 0xffff0000, v164
    v_pk_fma_f32 v[222:223], v[226:227], v[186:187], v[222:223]
    v_pk_fma_f32 v[222:223], v[228:229], v[184:185], v[222:223]
    v_pk_mul_f32 v[222:223], v[222:223], v[240:241]
    v_pk_mul_f32 v[224:225], v[224:225], v[190:191]
    v_lshlrev_b32 v238, 16, v168
    v_pk_fma_f32 v[224:225], v[226:227], v[188:189], v[224:225]
    v_and_b32 v239, 0xffff0000, v168
    v_pk_fma_f32 v[224:225], v[228:229], v[186:187], v[224:225]
    v_pk_fma_f32 v[224:225], v[230:231], v[184:185], v[224:225]
    v_pk_mul_f32 v[224:225], v[224:225], v[238:239]
    v_pk_mul_f32 v[226:227], v[226:227], v[190:191]
    v_lshlrev_b32 v240, 16, v172
    v_pk_fma_f32 v[226:227], v[228:229], v[188:189], v[226:227]
    v_and_b32 v241, 0xffff0000, v172
    v_pk_fma_f32 v[226:227], v[230:231], v[186:187], v[226:227]
    v_pk_fma_f32 v[226:227], v[232:233], v[184:185], v[226:227]
    v_pk_mul_f32 v[226:227], v[226:227], v[240:241]
    v_pk_mul_f32 v[228:229], v[228:229], v[190:191]
    v_lshlrev_b32 v238, 16, v176
    v_pk_fma_f32 v[228:229], v[230:231], v[188:189], v[228:229]
    v_and_b32 v239, 0xffff0000, v176
    v_pk_fma_f32 v[228:229], v[232:233], v[186:187], v[228:229]
    v_pk_fma_f32 v[228:229], v[234:235], v[184:185], v[228:229]
    v_pk_mul_f32 v[228:229], v[228:229], v[238:239]
    v_pk_mul_f32 v[230:231], v[230:231], v[190:191]
    v_lshlrev_b32 v240, 16, v180
    v_pk_fma_f32 v[230:231], v[232:233], v[188:189], v[230:231]
    v_and_b32 v241, 0xffff0000, v180
    v_pk_fma_f32 v[230:231], v[234:235], v[186:187], v[230:231]
    v_pk_fma_f32 v[230:231], v[236:237], v[184:185], v[230:231]
    v_pk_mul_f32 v[230:231], v[230:231], v[240:241]
    v_cvt_pk_bf16_f32 v242, v230, v228
    v_cvt_pk_bf16_f32 v243, v226, v224
    v_cvt_pk_bf16_f32 v244, v222, v220
    v_cvt_pk_bf16_f32 v245, v218, v216
    ds_write_b128 v12, v[242:245] offset:2560
    v_cvt_pk_bf16_f32 v246, v231, v229
    v_cvt_pk_bf16_f32 v247, v227, v225
    v_cvt_pk_bf16_f32 v248, v223, v221
    v_cvt_pk_bf16_f32 v249, v219, v217
    ds_write_b128 v12, v[246:249] offset:10240
    v_lshlrev_b32 v216, 16, v109
    v_and_b32 v217, 0xffff0000, v109
    v_lshlrev_b32 v218, 16, v113
    v_and_b32 v219, 0xffff0000, v113
    v_lshlrev_b32 v220, 16, v117
    v_and_b32 v221, 0xffff0000, v117
    v_lshlrev_b32 v222, 16, v121
    v_and_b32 v223, 0xffff0000, v121
    v_lshlrev_b32 v224, 16, v125
    v_and_b32 v225, 0xffff0000, v125
    v_lshlrev_b32 v226, 16, v129
    v_and_b32 v227, 0xffff0000, v129
    v_lshlrev_b32 v228, 16, v133
    v_and_b32 v229, 0xffff0000, v133
    v_lshlrev_b32 v230, 16, v137
    v_and_b32 v231, 0xffff0000, v137
    v_lshlrev_b32 v232, 16, v141
    v_and_b32 v233, 0xffff0000, v141
    v_lshlrev_b32 v234, 16, v145
    v_and_b32 v235, 0xffff0000, v145
    v_lshlrev_b32 v236, 16, v149
    v_and_b32 v237, 0xffff0000, v149
    v_pk_mul_f32 v[216:217], v[216:217], v[198:199]
    v_lshlrev_b32 v238, 16, v153
    v_pk_fma_f32 v[216:217], v[218:219], v[196:197], v[216:217]
    v_and_b32 v239, 0xffff0000, v153
    v_pk_fma_f32 v[216:217], v[220:221], v[194:195], v[216:217]
    v_pk_fma_f32 v[216:217], v[222:223], v[192:193], v[216:217]
    v_pk_mul_f32 v[216:217], v[216:217], v[238:239]
    v_pk_mul_f32 v[218:219], v[218:219], v[198:199]
    v_lshlrev_b32 v240, 16, v157
    v_pk_fma_f32 v[218:219], v[220:221], v[196:197], v[218:219]
    v_and_b32 v241, 0xffff0000, v157
    v_pk_fma_f32 v[218:219], v[222:223], v[194:195], v[218:219]
    v_pk_fma_f32 v[218:219], v[224:225], v[192:193], v[218:219]
    v_pk_mul_f32 v[218:219], v[218:219], v[240:241]
    v_pk_mul_f32 v[220:221], v[220:221], v[198:199]
    v_lshlrev_b32 v238, 16, v161
    v_pk_fma_f32 v[220:221], v[222:223], v[196:197], v[220:221]
    v_and_b32 v239, 0xffff0000, v161
    v_pk_fma_f32 v[220:221], v[224:225], v[194:195], v[220:221]
    v_pk_fma_f32 v[220:221], v[226:227], v[192:193], v[220:221]
    v_pk_mul_f32 v[220:221], v[220:221], v[238:239]
    v_pk_mul_f32 v[222:223], v[222:223], v[198:199]
    v_lshlrev_b32 v240, 16, v165
    v_pk_fma_f32 v[222:223], v[224:225], v[196:197], v[222:223]
    v_and_b32 v241, 0xffff0000, v165
    v_pk_fma_f32 v[222:223], v[226:227], v[194:195], v[222:223]
    v_pk_fma_f32 v[222:223], v[228:229], v[192:193], v[222:223]
    v_pk_mul_f32 v[222:223], v[222:223], v[240:241]
    v_pk_mul_f32 v[224:225], v[224:225], v[198:199]
    v_lshlrev_b32 v238, 16, v169
    v_pk_fma_f32 v[224:225], v[226:227], v[196:197], v[224:225]
    v_and_b32 v239, 0xffff0000, v169
    v_pk_fma_f32 v[224:225], v[228:229], v[194:195], v[224:225]
    v_pk_fma_f32 v[224:225], v[230:231], v[192:193], v[224:225]
    v_pk_mul_f32 v[224:225], v[224:225], v[238:239]
    v_pk_mul_f32 v[226:227], v[226:227], v[198:199]
    v_lshlrev_b32 v240, 16, v173
    v_pk_fma_f32 v[226:227], v[228:229], v[196:197], v[226:227]
    v_and_b32 v241, 0xffff0000, v173
    v_pk_fma_f32 v[226:227], v[230:231], v[194:195], v[226:227]
    v_pk_fma_f32 v[226:227], v[232:233], v[192:193], v[226:227]
    v_pk_mul_f32 v[226:227], v[226:227], v[240:241]
    v_pk_mul_f32 v[228:229], v[228:229], v[198:199]
    v_lshlrev_b32 v238, 16, v177
    v_pk_fma_f32 v[228:229], v[230:231], v[196:197], v[228:229]
    v_and_b32 v239, 0xffff0000, v177
    v_pk_fma_f32 v[228:229], v[232:233], v[194:195], v[228:229]
    v_pk_fma_f32 v[228:229], v[234:235], v[192:193], v[228:229]
    v_pk_mul_f32 v[228:229], v[228:229], v[238:239]
    v_pk_mul_f32 v[230:231], v[230:231], v[198:199]
    v_lshlrev_b32 v240, 16, v181
    v_pk_fma_f32 v[230:231], v[232:233], v[196:197], v[230:231]
    v_and_b32 v241, 0xffff0000, v181
    v_pk_fma_f32 v[230:231], v[234:235], v[194:195], v[230:231]
    v_pk_fma_f32 v[230:231], v[236:237], v[192:193], v[230:231]
    v_pk_mul_f32 v[230:231], v[230:231], v[240:241]
    v_cvt_pk_bf16_f32 v242, v230, v228
    v_cvt_pk_bf16_f32 v243, v226, v224
    v_cvt_pk_bf16_f32 v244, v222, v220
    v_cvt_pk_bf16_f32 v245, v218, v216
    ds_write_b128 v12, v[242:245] offset:17920
    v_cvt_pk_bf16_f32 v246, v231, v229
    v_cvt_pk_bf16_f32 v247, v227, v225
    v_cvt_pk_bf16_f32 v248, v223, v221
    v_cvt_pk_bf16_f32 v249, v219, v217
    ds_write_b128 v12, v[246:249] offset:25600
    v_lshlrev_b32 v216, 16, v110
    v_and_b32 v217, 0xffff0000, v110
    v_lshlrev_b32 v218, 16, v114
    v_and_b32 v219, 0xffff0000, v114
    v_lshlrev_b32 v220, 16, v118
    v_and_b32 v221, 0xffff0000, v118
    v_lshlrev_b32 v222, 16, v122
    v_and_b32 v223, 0xffff0000, v122
    v_lshlrev_b32 v224, 16, v126
    v_and_b32 v225, 0xffff0000, v126
    v_lshlrev_b32 v226, 16, v130
    v_and_b32 v227, 0xffff0000, v130
    v_lshlrev_b32 v228, 16, v134
    v_and_b32 v229, 0xffff0000, v134
    v_lshlrev_b32 v230, 16, v138
    v_and_b32 v231, 0xffff0000, v138
    v_lshlrev_b32 v232, 16, v142
    v_and_b32 v233, 0xffff0000, v142
    v_lshlrev_b32 v234, 16, v146
    v_and_b32 v235, 0xffff0000, v146
    v_lshlrev_b32 v236, 16, v150
    v_and_b32 v237, 0xffff0000, v150
    v_pk_mul_f32 v[216:217], v[216:217], v[206:207]
    v_lshlrev_b32 v238, 16, v154
    v_pk_fma_f32 v[216:217], v[218:219], v[204:205], v[216:217]
    v_and_b32 v239, 0xffff0000, v154
    v_pk_fma_f32 v[216:217], v[220:221], v[202:203], v[216:217]
    v_pk_fma_f32 v[216:217], v[222:223], v[200:201], v[216:217]
    v_pk_mul_f32 v[216:217], v[216:217], v[238:239]
    v_pk_mul_f32 v[218:219], v[218:219], v[206:207]
    v_lshlrev_b32 v240, 16, v158
    v_pk_fma_f32 v[218:219], v[220:221], v[204:205], v[218:219]
    v_and_b32 v241, 0xffff0000, v158
    v_pk_fma_f32 v[218:219], v[222:223], v[202:203], v[218:219]
    v_pk_fma_f32 v[218:219], v[224:225], v[200:201], v[218:219]
    v_pk_mul_f32 v[218:219], v[218:219], v[240:241]
    v_pk_mul_f32 v[220:221], v[220:221], v[206:207]
    v_lshlrev_b32 v238, 16, v162
    v_pk_fma_f32 v[220:221], v[222:223], v[204:205], v[220:221]
    v_and_b32 v239, 0xffff0000, v162
    v_pk_fma_f32 v[220:221], v[224:225], v[202:203], v[220:221]
    v_pk_fma_f32 v[220:221], v[226:227], v[200:201], v[220:221]
    v_pk_mul_f32 v[220:221], v[220:221], v[238:239]
    v_pk_mul_f32 v[222:223], v[222:223], v[206:207]
    v_lshlrev_b32 v240, 16, v166
    v_pk_fma_f32 v[222:223], v[224:225], v[204:205], v[222:223]
    v_and_b32 v241, 0xffff0000, v166
    v_pk_fma_f32 v[222:223], v[226:227], v[202:203], v[222:223]
    v_pk_fma_f32 v[222:223], v[228:229], v[200:201], v[222:223]
    v_pk_mul_f32 v[222:223], v[222:223], v[240:241]
    v_pk_mul_f32 v[224:225], v[224:225], v[206:207]
    v_lshlrev_b32 v238, 16, v170
    v_pk_fma_f32 v[224:225], v[226:227], v[204:205], v[224:225]
    v_and_b32 v239, 0xffff0000, v170
    v_pk_fma_f32 v[224:225], v[228:229], v[202:203], v[224:225]
    v_pk_fma_f32 v[224:225], v[230:231], v[200:201], v[224:225]
    v_pk_mul_f32 v[224:225], v[224:225], v[238:239]
    v_pk_mul_f32 v[226:227], v[226:227], v[206:207]
    v_lshlrev_b32 v240, 16, v174
    v_pk_fma_f32 v[226:227], v[228:229], v[204:205], v[226:227]
    v_and_b32 v241, 0xffff0000, v174
    v_pk_fma_f32 v[226:227], v[230:231], v[202:203], v[226:227]
    v_pk_fma_f32 v[226:227], v[232:233], v[200:201], v[226:227]
    v_pk_mul_f32 v[226:227], v[226:227], v[240:241]
    v_pk_mul_f32 v[228:229], v[228:229], v[206:207]
    v_lshlrev_b32 v238, 16, v178
    v_pk_fma_f32 v[228:229], v[230:231], v[204:205], v[228:229]
    v_and_b32 v239, 0xffff0000, v178
    v_pk_fma_f32 v[228:229], v[232:233], v[202:203], v[228:229]
    v_pk_fma_f32 v[228:229], v[234:235], v[200:201], v[228:229]
    v_pk_mul_f32 v[228:229], v[228:229], v[238:239]
    v_pk_mul_f32 v[230:231], v[230:231], v[206:207]
    v_lshlrev_b32 v240, 16, v182
    v_pk_fma_f32 v[230:231], v[232:233], v[204:205], v[230:231]
    v_and_b32 v241, 0xffff0000, v182
    v_pk_fma_f32 v[230:231], v[234:235], v[202:203], v[230:231]
    v_pk_fma_f32 v[230:231], v[236:237], v[200:201], v[230:231]
    v_pk_mul_f32 v[230:231], v[230:231], v[240:241]
    v_cvt_pk_bf16_f32 v242, v230, v228
    v_cvt_pk_bf16_f32 v243, v226, v224
    v_cvt_pk_bf16_f32 v244, v222, v220
    v_cvt_pk_bf16_f32 v245, v218, v216
    ds_write_b128 v12, v[242:245] offset:33280
    v_cvt_pk_bf16_f32 v246, v231, v229
    v_cvt_pk_bf16_f32 v247, v227, v225
    v_cvt_pk_bf16_f32 v248, v223, v221
    v_cvt_pk_bf16_f32 v249, v219, v217
    ds_write_b128 v12, v[246:249] offset:40960
    v_lshlrev_b32 v216, 16, v111
    v_and_b32 v217, 0xffff0000, v111
    v_lshlrev_b32 v218, 16, v115
    v_and_b32 v219, 0xffff0000, v115
    v_lshlrev_b32 v220, 16, v119
    v_and_b32 v221, 0xffff0000, v119
    v_lshlrev_b32 v222, 16, v123
    v_and_b32 v223, 0xffff0000, v123
    v_lshlrev_b32 v224, 16, v127
    v_and_b32 v225, 0xffff0000, v127
    v_lshlrev_b32 v226, 16, v131
    v_and_b32 v227, 0xffff0000, v131
    v_lshlrev_b32 v228, 16, v135
    v_and_b32 v229, 0xffff0000, v135
    v_lshlrev_b32 v230, 16, v139
    v_and_b32 v231, 0xffff0000, v139
    v_lshlrev_b32 v232, 16, v143
    v_and_b32 v233, 0xffff0000, v143
    v_lshlrev_b32 v234, 16, v147
    v_and_b32 v235, 0xffff0000, v147
    v_lshlrev_b32 v236, 16, v151
    v_and_b32 v237, 0xffff0000, v151
    v_pk_mul_f32 v[216:217], v[216:217], v[214:215]
    v_lshlrev_b32 v238, 16, v155
    v_pk_fma_f32 v[216:217], v[218:219], v[212:213], v[216:217]
    v_and_b32 v239, 0xffff0000, v155
    v_pk_fma_f32 v[216:217], v[220:221], v[210:211], v[216:217]
    v_pk_fma_f32 v[216:217], v[222:223], v[208:209], v[216:217]
    v_pk_mul_f32 v[216:217], v[216:217], v[238:239]
    v_pk_mul_f32 v[218:219], v[218:219], v[214:215]
    v_lshlrev_b32 v240, 16, v159
    v_pk_fma_f32 v[218:219], v[220:221], v[212:213], v[218:219]
    v_and_b32 v241, 0xffff0000, v159
    v_pk_fma_f32 v[218:219], v[222:223], v[210:211], v[218:219]
    v_pk_fma_f32 v[218:219], v[224:225], v[208:209], v[218:219]
    v_pk_mul_f32 v[218:219], v[218:219], v[240:241]
    v_pk_mul_f32 v[220:221], v[220:221], v[214:215]
    v_lshlrev_b32 v238, 16, v163
    v_pk_fma_f32 v[220:221], v[222:223], v[212:213], v[220:221]
    v_and_b32 v239, 0xffff0000, v163
    v_pk_fma_f32 v[220:221], v[224:225], v[210:211], v[220:221]
    v_pk_fma_f32 v[220:221], v[226:227], v[208:209], v[220:221]
    v_pk_mul_f32 v[220:221], v[220:221], v[238:239]
    v_pk_mul_f32 v[222:223], v[222:223], v[214:215]
    v_lshlrev_b32 v240, 16, v167
    v_pk_fma_f32 v[222:223], v[224:225], v[212:213], v[222:223]
    v_and_b32 v241, 0xffff0000, v167
    v_pk_fma_f32 v[222:223], v[226:227], v[210:211], v[222:223]
    v_pk_fma_f32 v[222:223], v[228:229], v[208:209], v[222:223]
    v_pk_mul_f32 v[222:223], v[222:223], v[240:241]
    v_pk_mul_f32 v[224:225], v[224:225], v[214:215]
    v_lshlrev_b32 v238, 16, v171
    v_pk_fma_f32 v[224:225], v[226:227], v[212:213], v[224:225]
    v_and_b32 v239, 0xffff0000, v171
    v_pk_fma_f32 v[224:225], v[228:229], v[210:211], v[224:225]
    v_pk_fma_f32 v[224:225], v[230:231], v[208:209], v[224:225]
    v_pk_mul_f32 v[224:225], v[224:225], v[238:239]
    v_pk_mul_f32 v[226:227], v[226:227], v[214:215]
    v_lshlrev_b32 v240, 16, v175
    v_pk_fma_f32 v[226:227], v[228:229], v[212:213], v[226:227]
    v_and_b32 v241, 0xffff0000, v175
    v_pk_fma_f32 v[226:227], v[230:231], v[210:211], v[226:227]
    v_pk_fma_f32 v[226:227], v[232:233], v[208:209], v[226:227]
    v_pk_mul_f32 v[226:227], v[226:227], v[240:241]
    v_pk_mul_f32 v[228:229], v[228:229], v[214:215]
    v_lshlrev_b32 v238, 16, v179
    v_pk_fma_f32 v[228:229], v[230:231], v[212:213], v[228:229]
    v_and_b32 v239, 0xffff0000, v179
    v_pk_fma_f32 v[228:229], v[232:233], v[210:211], v[228:229]
    v_pk_fma_f32 v[228:229], v[234:235], v[208:209], v[228:229]
    v_pk_mul_f32 v[228:229], v[228:229], v[238:239]
    v_pk_mul_f32 v[230:231], v[230:231], v[214:215]
    v_lshlrev_b32 v240, 16, v183
    v_pk_fma_f32 v[230:231], v[232:233], v[212:213], v[230:231]
    v_and_b32 v241, 0xffff0000, v183
    v_pk_fma_f32 v[230:231], v[234:235], v[210:211], v[230:231]
    v_pk_fma_f32 v[230:231], v[236:237], v[208:209], v[230:231]
    v_pk_mul_f32 v[230:231], v[230:231], v[240:241]
    v_cvt_pk_bf16_f32 v242, v230, v228
    v_cvt_pk_bf16_f32 v243, v226, v224
    v_cvt_pk_bf16_f32 v244, v222, v220
    v_cvt_pk_bf16_f32 v245, v218, v216
    ds_write_b128 v12, v[242:245] offset:48640
    v_cvt_pk_bf16_f32 v246, v231, v229
    v_cvt_pk_bf16_f32 v247, v227, v225
    v_cvt_pk_bf16_f32 v248, v223, v221
    v_cvt_pk_bf16_f32 v249, v219, v217
    ds_write_b128 v12, v[246:249] offset:56320
    s_lshl_b32 s4, s61, 12
    v_add_u32 v6, s4, v5
    buffer_load_dwordx4 v[184:187], v2, s[36:39], s4 offen offset:0
    buffer_load_dwordx4 v[188:191], v2, s[36:39], s4 offen offset:1024
    buffer_load_dwordx4 v[192:195], v2, s[36:39], s4 offen offset:2048
    buffer_load_dwordx4 v[196:199], v2, s[36:39], s4 offen offset:3072
    buffer_load_dword v200, v6, s[36:39], 0 offen
    buffer_load_dword v201, v2, s[36:39], s4 offen offset:1020
    buffer_load_dword v202, v2, s[36:39], s4 offen offset:2044
    buffer_load_dword v203, v2, s[36:39], s4 offen offset:3068
    s_waitcnt vmcnt(0)
    s_waitcnt lgkmcnt(0)
    s_barrier
    s_mov_b32 s64, 0
.chan_347:
    s_lshr_b32 s4, s61, 1
    s_lshl_b32 s4, s4, 2
    s_load_dword s65, s[50:51], s4
    s_lshl_b32 s7, s61, 12
    s_add_u32 s7, s7, 130023424
    v_writelane_b32 v200, 0, 0
    ds_write_b128 v9, v[184:187] offset:64
    v_alignbit_b32 v204, v184, v200, 16
    v_alignbit_b32 v205, v185, v184, 16
    v_alignbit_b32 v206, v186, v185, 16
    v_alignbit_b32 v207, v187, v186, 16
    ds_write_b128 v9, v[204:207] offset:4224
    ds_write_b128 v9, v[188:191] offset:1088
    v_alignbit_b32 v208, v188, v201, 16
    v_alignbit_b32 v209, v189, v188, 16
    v_alignbit_b32 v210, v190, v189, 16
    v_alignbit_b32 v211, v191, v190, 16
    ds_write_b128 v9, v[208:211] offset:5248
    ds_write_b128 v9, v[192:195] offset:2112
    v_alignbit_b32 v212, v192, v202, 16
    v_alignbit_b32 v213, v193, v192, 16
    v_alignbit_b32 v214, v194, v193, 16
    v_alignbit_b32 v215, v195, v194, 16
    ds_write_b128 v9, v[212:215] offset:6272
    ds_write_b128 v9, v[196:199] offset:3136
    v_alignbit_b32 v216, v196, v203, 16
    v_alignbit_b32 v217, v197, v196, 16
    v_alignbit_b32 v218, v198, v197, 16
    v_alignbit_b32 v219, v199, v198, 16
    ds_write_b128 v9, v[216:219] offset:7296
    s_and_b32 s4, s61, 1
    s_lshl_b32 s4, s4, 4
    s_waitcnt lgkmcnt(0)
    s_lshr_b32 s65, s65, s4
    s_pack_ll_b32_b16 s65, s65, s65
    s_add_u32 s61, s61, 4
    s_cmp_eq_u32 s64, 3
    s_cbranch_scc1 .chan_347_ns
    s_lshl_b32 s4, s61, 12
    v_add_u32 v6, s4, v5
    buffer_load_dwordx4 v[184:187], v2, s[36:39], s4 offen offset:0
    buffer_load_dwordx4 v[188:191], v2, s[36:39], s4 offen offset:1024
    buffer_load_dwordx4 v[192:195], v2, s[36:39], s4 offen offset:2048
    buffer_load_dwordx4 v[196:199], v2, s[36:39], s4 offen offset:3072
    buffer_load_dword v200, v6, s[36:39], 0 offen
    buffer_load_dword v201, v2, s[36:39], s4 offen offset:1020
    buffer_load_dword v202, v2, s[36:39], s4 offen offset:2044
    buffer_load_dword v203, v2, s[36:39], s4 offen offset:3068
.chan_347_ns:
    v_and_b32 v16, s65, v24
    v_and_b32 v17, s65, v25
    v_and_b32 v18, s65, v26
    v_and_b32 v19, s65, v27
    v_and_b32 v20, s65, v28
    v_and_b32 v21, s65, v29
    v_and_b32 v22, s65, v30
    v_and_b32 v23, s65, v31
    v_mov_b32 v14, v10
    ds_read2_b32 a[32:33], v14 offset0:0 offset1:1
    ds_read2_b32 a[34:35], v14 offset0:2 offset1:3
    ds_read_b128 a[56:59], v11 offset:7632
    ds_read_b128 a[60:63], v11 offset:5072
    ds_read2_b32 a[36:37], v14 offset0:8 offset1:9
    ds_read2_b32 a[38:39], v14 offset0:10 offset1:11
    ds_read_b128 a[64:67], v11 offset:7600
    ds_read_b128 a[68:71], v11 offset:5040
    ds_read2_b32 a[40:41], v14 offset0:16 offset1:17
    ds_read2_b32 a[42:43], v14 offset0:18 offset1:19
    ds_read_b128 a[72:75], v11 offset:7552
    ds_read_b128 a[76:79], v11 offset:4992
    s_waitcnt lgkmcnt(9)
    v_mfma_f32_32x32x16_bf16 a[16:31], a[32:35], a[56:59], 0
    v_mfma_f32_32x32x16_bf16 a[16:31], v[20:23], a[56:59], a[16:31]
    ds_read2_b32 a[44:45], v14 offset0:24 offset1:25
    ds_read2_b32 a[46:47], v14 offset0:26 offset1:27
    s_waitcnt lgkmcnt(10)
    v_mfma_f32_32x32x16_bf16 a[0:15], a[32:35], a[60:63], 0
    v_mfma_f32_32x32x16_bf16 a[0:15], v[20:23], a[60:63], a[0:15]
    ds_read_b128 a[80:83], v11 offset:7520
    ds_read_b128 a[84:87], v11 offset:4960
    s_waitcnt lgkmcnt(9)
    v_mfma_f32_32x32x16_bf16 a[16:31], a[36:39], a[64:67], a[16:31]
    v_mfma_f32_32x32x16_bf16 a[16:31], v[16:19], a[64:67], a[16:31]
    ds_read2_b32 a[48:49], v14 offset0:32 offset1:33
    ds_read2_b32 a[50:51], v14 offset0:34 offset1:35
    s_waitcnt lgkmcnt(10)
    v_mfma_f32_32x32x16_bf16 a[0:15], a[36:39], a[68:71], a[0:15]
    v_mfma_f32_32x32x16_bf16 a[0:15], v[16:19], a[68:71], a[0:15]
    ds_read_b128 a[56:59], v11 offset:7472
    ds_read_b128 a[60:63], v11 offset:4912
    s_waitcnt lgkmcnt(9)
    v_mfma_f32_32x32x16_bf16 a[16:31], a[40:43], a[72:75], a[16:31]
    ds_read2_b32 a[52:53], v14 offset0:40 offset1:41
    ds_read2_b32 a[54:55], v14 offset0:42 offset1:43
    s_waitcnt lgkmcnt(10)
    v_mfma_f32_32x32x16_bf16 a[0:15], a[40:43], a[76:79], a[0:15]
    ds_read_b128 a[64:67], v11 offset:7440
    ds_read_b128 a[68:71], v11 offset:4880
    s_waitcnt lgkmcnt(9)
    v_mfma_f32_32x32x16_bf16 a[16:31], a[44:47], a[80:83], a[16:31]
    ds_read2_b32 a[32:33], v14 offset0:48 offset1:49
    ds_read2_b32 a[34:35], v14 offset0:50 offset1:51
    s_waitcnt lgkmcnt(10)
    v_mfma_f32_32x32x16_bf16 a[0:15], a[44:47], a[84:87], a[0:15]
    ds_read_b128 a[72:75], v11 offset:7392
    ds_read_b128 a[76:79], v11 offset:4832
    s_waitcnt lgkmcnt(9)
    v_mfma_f32_32x32x16_bf16 a[16:31], a[48:51], a[56:59], a[16:31]
    ds_read2_b32 a[36:37], v14 offset0:56 offset1:57
    ds_read2_b32 a[38:39], v14 offset0:58 offset1:59
    s_waitcnt lgkmcnt(10)
    v_mfma_f32_32x32x16_bf16 a[0:15], a[48:51], a[60:63], a[0:15]
    ds_read_b128 a[80:83], v11 offset:7360
    ds_read_b128 a[84:87], v11 offset:4800
    s_waitcnt lgkmcnt(9)
    v_mfma_f32_32x32x16_bf16 a[16:31], a[52:55], a[64:67], a[16:31]
    ds_read2_b32 a[40:41], v14 offset0:64 offset1:65
    ds_read2_b32 a[42:43], v14 offset0:66 offset1:67
    s_waitcnt lgkmcnt(10)
    v_mfma_f32_32x32x16_bf16 a[0:15], a[52:55], a[68:71], a[0:15]
    ds_read_b128 a[56:59], v11 offset:7312
    ds_read_b128 a[60:63], v11 offset:4752
    s_waitcnt lgkmcnt(9)
    v_mfma_f32_32x32x16_bf16 a[16:31], a[32:35], a[72:75], a[16:31]
    ds_read2_b32 a[44:45], v14 offset0:72 offset1:73
    ds_read2_b32 a[46:47], v14 offset0:74 offset1:75
    s_waitcnt lgkmcnt(10)
    v_mfma_f32_32x32x16_bf16 a[0:15], a[32:35], a[76:79], a[0:15]
    ds_read_b128 a[64:67], v11 offset:7280
    ds_read_b128 a[68:71], v11 offset:4720
    s_waitcnt lgkmcnt(9)
    v_mfma_f32_32x32x16_bf16 a[16:31], a[36:39], a[80:83], a[16:31]
    ds_read2_b32 a[48:49], v14 offset0:80 offset1:81
    ds_read2_b32 a[50:51], v14 offset0:82 offset1:83
    s_waitcnt lgkmcnt(10)
    v_mfma_f32_32x32x16_bf16 a[0:15], a[36:39], a[84:87], a[0:15]
    ds_read_b128 a[72:75], v11 offset:7232
    ds_read_b128 a[76:79], v11 offset:4672
    s_waitcnt lgkmcnt(9)
    v_mfma_f32_32x32x16_bf16 a[16:31], a[40:43], a[56:59], a[16:31]
    ds_read2_b32 a[52:53], v14 offset0:88 offset1:89
    ds_read2_b32 a[54:55], v14 offset0:90 offset1:91
    s_waitcnt lgkmcnt(10)
    v_mfma_f32_32x32x16_bf16 a[0:15], a[40:43], a[60:63], a[0:15]
    ds_read_b128 a[80:83], v11 offset:7200
    ds_read_b128 a[84:87], v11 offset:4640
    s_waitcnt lgkmcnt(9)
    v_mfma_f32_32x32x16_bf16 a[16:31], a[44:47], a[64:67], a[16:31]
    ds_read2_b32 a[32:33], v14 offset0:96 offset1:97
    ds_read2_b32 a[34:35], v14 offset0:98 offset1:99
    s_waitcnt lgkmcnt(10)
    v_mfma_f32_32x32x16_bf16 a[0:15], a[44:47], a[68:71], a[0:15]
    ds_read_b128 a[56:59], v11 offset:7152
    ds_read_b128 a[60:63], v11 offset:4592
    s_waitcnt lgkmcnt(9)
    v_mfma_f32_32x32x16_bf16 a[16:31], a[48:51], a[72:75], a[16:31]
    ds_read2_b32 a[36:37], v14 offset0:104 offset1:105
    ds_read2_b32 a[38:39], v14 offset0:106 offset1:107
    s_waitcnt lgkmcnt(10)
    v_mfma_f32_32x32x16_bf16 a[0:15], a[48:51], a[76:79], a[0:15]
    ds_read_b128 a[64:67], v11 offset:7120
    ds_read_b128 a[68:71], v11 offset:4560
    s_waitcnt lgkmcnt(9)
    v_mfma_f32_32x32x16_bf16 a[16:31], a[52:55], a[80:83], a[16:31]
    ds_read2_b32 a[40:41], v14 offset0:112 offset1:113
    ds_read2_b32 a[42:43], v14 offset0:114 offset1:115
    s_waitcnt lgkmcnt(10)
    v_mfma_f32_32x32x16_bf16 a[0:15], a[52:55], a[84:87], a[0:15]
    ds_read_b128 a[72:75], v11 offset:7072
    ds_read_b128 a[76:79], v11 offset:4512
    s_waitcnt lgkmcnt(9)
    v_mfma_f32_32x32x16_bf16 a[16:31], a[32:35], a[56:59], a[16:31]
    ds_read2_b32 a[44:45], v14 offset0:120 offset1:121
    ds_read2_b32 a[46:47], v14 offset0:122 offset1:123
    s_waitcnt lgkmcnt(10)
    v_mfma_f32_32x32x16_bf16 a[0:15], a[32:35], a[60:63], a[0:15]
    ds_read_b128 a[80:83], v11 offset:7040
    ds_read_b128 a[84:87], v11 offset:4480
    s_waitcnt lgkmcnt(9)
    v_mfma_f32_32x32x16_bf16 a[16:31], a[36:39], a[64:67], a[16:31]
    ds_read2_b32 a[48:49], v14 offset0:128 offset1:129
    ds_read2_b32 a[50:51], v14 offset0:130 offset1:131
    s_waitcnt lgkmcnt(10)
    v_mfma_f32_32x32x16_bf16 a[0:15], a[36:39], a[68:71], a[0:15]
    ds_read_b128 a[56:59], v11 offset:6992
    ds_read_b128 a[60:63], v11 offset:4432
    s_waitcnt lgkmcnt(9)
    v_mfma_f32_32x32x16_bf16 a[16:31], a[40:43], a[72:75], a[16:31]
    ds_read2_b32 a[52:53], v14 offset0:136 offset1:137
    ds_read2_b32 a[54:55], v14 offset0:138 offset1:139
    s_waitcnt lgkmcnt(10)
    v_mfma_f32_32x32x16_bf16 a[0:15], a[40:43], a[76:79], a[0:15]
    ds_read_b128 a[64:67], v11 offset:6960
    ds_read_b128 a[68:71], v11 offset:4400
    s_waitcnt lgkmcnt(9)
    v_mfma_f32_32x32x16_bf16 a[16:31], a[44:47], a[80:83], a[16:31]
    ds_read2_b32 a[32:33], v14 offset0:144 offset1:145
    ds_read2_b32 a[34:35], v14 offset0:146 offset1:147
    s_waitcnt lgkmcnt(10)
    v_mfma_f32_32x32x16_bf16 a[0:15], a[44:47], a[84:87], a[0:15]
    ds_read_b128 a[72:75], v11 offset:6912
    ds_read_b128 a[76:79], v11 offset:4352
    s_waitcnt lgkmcnt(9)
    v_mfma_f32_32x32x16_bf16 a[16:31], a[48:51], a[56:59], a[16:31]
    ds_read2_b32 a[36:37], v14 offset0:152 offset1:153
    ds_read2_b32 a[38:39], v14 offset0:154 offset1:155
    s_waitcnt lgkmcnt(10)
    v_mfma_f32_32x32x16_bf16 a[0:15], a[48:51], a[60:63], a[0:15]
    ds_read_b128 a[80:83], v11 offset:6880
    ds_read_b128 a[84:87], v11 offset:4320
    s_waitcnt lgkmcnt(9)
    v_mfma_f32_32x32x16_bf16 a[16:31], a[52:55], a[64:67], a[16:31]
    ds_read2_b32 a[40:41], v14 offset0:160 offset1:161
    ds_read2_b32 a[42:43], v14 offset0:162 offset1:163
    s_waitcnt lgkmcnt(10)
    v_mfma_f32_32x32x16_bf16 a[0:15], a[52:55], a[68:71], a[0:15]
    ds_read_b128 a[56:59], v11 offset:6832
    ds_read_b128 a[60:63], v11 offset:4272
    s_waitcnt lgkmcnt(9)
    v_mfma_f32_32x32x16_bf16 a[16:31], a[32:35], a[72:75], a[16:31]
    ds_read2_b32 a[44:45], v14 offset0:168 offset1:169
    ds_read2_b32 a[46:47], v14 offset0:170 offset1:171
    s_waitcnt lgkmcnt(10)
    v_mfma_f32_32x32x16_bf16 a[0:15], a[32:35], a[76:79], a[0:15]
    ds_read_b128 a[64:67], v11 offset:6800
    ds_read_b128 a[68:71], v11 offset:4240
    s_waitcnt lgkmcnt(9)
    v_mfma_f32_32x32x16_bf16 a[16:31], a[36:39], a[80:83], a[16:31]
    ds_read2_b32 a[48:49], v14 offset0:176 offset1:177
    ds_read2_b32 a[50:51], v14 offset0:178 offset1:179
    s_waitcnt lgkmcnt(10)
    v_mfma_f32_32x32x16_bf16 a[0:15], a[36:39], a[84:87], a[0:15]
    ds_read_b128 a[72:75], v11 offset:6752
    ds_read_b128 a[76:79], v11 offset:4192
    s_waitcnt lgkmcnt(9)
    v_mfma_f32_32x32x16_bf16 a[16:31], a[40:43], a[56:59], a[16:31]
    ds_read2_b32 a[52:53], v14 offset0:184 offset1:185
    ds_read2_b32 a[54:55], v14 offset0:186 offset1:187
    s_waitcnt lgkmcnt(10)
    v_mfma_f32_32x32x16_bf16 a[0:15], a[40:43], a[60:63], a[0:15]
    ds_read_b128 a[80:83], v11 offset:6720
    ds_read_b128 a[84:87], v11 offset:4160
    s_waitcnt lgkmcnt(9)
    v_mfma_f32_32x32x16_bf16 a[16:31], a[44:47], a[64:67], a[16:31]
    ds_read2_b32 a[32:33], v14 offset0:192 offset1:193
    ds_read2_b32 a[34:35], v14 offset0:194 offset1:195
    s_waitcnt lgkmcnt(10)
    v_mfma_f32_32x32x16_bf16 a[0:15], a[44:47], a[68:71], a[0:15]
    ds_read_b128 a[56:59], v11 offset:6672
    ds_read_b128 a[60:63], v11 offset:4112
    s_waitcnt lgkmcnt(9)
    v_mfma_f32_32x32x16_bf16 a[16:31], a[48:51], a[72:75], a[16:31]
    ds_read2_b32 a[36:37], v14 offset0:200 offset1:201
    ds_read2_b32 a[38:39], v14 offset0:202 offset1:203
    s_waitcnt lgkmcnt(10)
    v_mfma_f32_32x32x16_bf16 a[0:15], a[48:51], a[76:79], a[0:15]
    ds_read_b128 a[64:67], v11 offset:6640
    ds_read_b128 a[68:71], v11 offset:4080
    s_waitcnt lgkmcnt(9)
    v_mfma_f32_32x32x16_bf16 a[16:31], a[52:55], a[80:83], a[16:31]
    ds_read2_b32 a[40:41], v14 offset0:208 offset1:209
    ds_read2_b32 a[42:43], v14 offset0:210 offset1:211
    s_waitcnt lgkmcnt(10)
    v_mfma_f32_32x32x16_bf16 a[0:15], a[52:55], a[84:87], a[0:15]
    ds_read_b128 a[72:75], v11 offset:6592
    ds_read_b128 a[76:79], v11 offset:4032
    s_waitcnt lgkmcnt(9)
    v_mfma_f32_32x32x16_bf16 a[16:31], a[32:35], a[56:59], a[16:31]
    ds_read2_b32 a[44:45], v14 offset0:216 offset1:217
    ds_read2_b32 a[46:47], v14 offset0:218 offset1:219
    s_waitcnt lgkmcnt(10)
    v_mfma_f32_32x32x16_bf16 a[0:15], a[32:35], a[60:63], a[0:15]
    ds_read_b128 a[80:83], v11 offset:6560
    ds_read_b128 a[84:87], v11 offset:4000
    s_waitcnt lgkmcnt(9)
    v_mfma_f32_32x32x16_bf16 a[16:31], a[36:39], a[64:67], a[16:31]
    ds_read2_b32 a[48:49], v14 offset0:224 offset1:225
    ds_read2_b32 a[50:51], v14 offset0:226 offset1:227
    s_waitcnt lgkmcnt(10)
    v_mfma_f32_32x32x16_bf16 a[0:15], a[36:39], a[68:71], a[0:15]
    ds_read_b128 a[56:59], v11 offset:6512
    ds_read_b128 a[60:63], v11 offset:3952
    s_waitcnt lgkmcnt(9)
    v_mfma_f32_32x32x16_bf16 a[16:31], a[40:43], a[72:75], a[16:31]
    ds_read2_b32 a[52:53], v14 offset0:232 offset1:233
    ds_read2_b32 a[54:55], v14 offset0:234 offset1:235
    s_waitcnt lgkmcnt(10)
    v_mfma_f32_32x32x16_bf16 a[0:15], a[40:43], a[76:79], a[0:15]
    ds_read_b128 a[64:67], v11 offset:6480
    ds_read_b128 a[68:71], v11 offset:3920
    s_waitcnt lgkmcnt(9)
    v_mfma_f32_32x32x16_bf16 a[16:31], a[44:47], a[80:83], a[16:31]
    ds_read2_b32 a[32:33], v14 offset0:240 offset1:241
    ds_read2_b32 a[34:35], v14 offset0:242 offset1:243
    s_waitcnt lgkmcnt(10)
    v_mfma_f32_32x32x16_bf16 a[0:15], a[44:47], a[84:87], a[0:15]
    ds_read_b128 a[72:75], v11 offset:6432
    ds_read_b128 a[76:79], v11 offset:3872
    s_waitcnt lgkmcnt(9)
    v_mfma_f32_32x32x16_bf16 a[16:31], a[48:51], a[56:59], a[16:31]
    ds_read2_b32 a[36:37], v14 offset0:248 offset1:249
    ds_read2_b32 a[38:39], v14 offset0:250 offset1:251
    v_add_u32 v14, 1024, v14
    s_waitcnt lgkmcnt(10)
    v_mfma_f32_32x32x16_bf16 a[0:15], a[48:51], a[60:63], a[0:15]
    ds_read_b128 a[80:83], v11 offset:6400
    ds_read_b128 a[84:87], v11 offset:3840
    s_waitcnt lgkmcnt(9)
    v_mfma_f32_32x32x16_bf16 a[16:31], a[52:55], a[64:67], a[16:31]
    ds_read2_b32 a[40:41], v14 offset0:0 offset1:1
    ds_read2_b32 a[42:43], v14 offset0:2 offset1:3
    s_waitcnt lgkmcnt(10)
    v_mfma_f32_32x32x16_bf16 a[0:15], a[52:55], a[68:71], a[0:15]
    ds_read_b128 a[56:59], v11 offset:6352
    ds_read_b128 a[60:63], v11 offset:3792
    s_waitcnt lgkmcnt(9)
    v_mfma_f32_32x32x16_bf16 a[16:31], a[32:35], a[72:75], a[16:31]
    ds_read2_b32 a[44:45], v14 offset0:8 offset1:9
    ds_read2_b32 a[46:47], v14 offset0:10 offset1:11
    s_waitcnt lgkmcnt(10)
    v_mfma_f32_32x32x16_bf16 a[0:15], a[32:35], a[76:79], a[0:15]
    ds_read_b128 a[64:67], v11 offset:6320
    ds_read_b128 a[68:71], v11 offset:3760
    s_waitcnt lgkmcnt(9)
    v_mfma_f32_32x32x16_bf16 a[16:31], a[36:39], a[80:83], a[16:31]
    ds_read2_b32 a[48:49], v14 offset0:16 offset1:17
    ds_read2_b32 a[50:51], v14 offset0:18 offset1:19
    s_waitcnt lgkmcnt(10)
    v_mfma_f32_32x32x16_bf16 a[0:15], a[36:39], a[84:87], a[0:15]
    ds_read_b128 a[72:75], v11 offset:6272
    ds_read_b128 a[76:79], v11 offset:3712
    s_waitcnt lgkmcnt(9)
    v_mfma_f32_32x32x16_bf16 a[16:31], a[40:43], a[56:59], a[16:31]
    ds_read2_b32 a[52:53], v14 offset0:24 offset1:25
    ds_read2_b32 a[54:55], v14 offset0:26 offset1:27
    s_waitcnt lgkmcnt(10)
    v_mfma_f32_32x32x16_bf16 a[0:15], a[40:43], a[60:63], a[0:15]
    ds_read_b128 a[80:83], v11 offset:6240
    ds_read_b128 a[84:87], v11 offset:3680
    s_waitcnt lgkmcnt(9)
    v_mfma_f32_32x32x16_bf16 a[16:31], a[44:47], a[64:67], a[16:31]
    ds_read2_b32 a[32:33], v14 offset0:32 offset1:33
    ds_read2_b32 a[34:35], v14 offset0:34 offset1:35
    s_waitcnt lgkmcnt(10)
    v_mfma_f32_32x32x16_bf16 a[0:15], a[44:47], a[68:71], a[0:15]
    ds_read_b128 a[56:59], v11 offset:6192
    ds_read_b128 a[60:63], v11 offset:3632
    s_waitcnt lgkmcnt(9)
    v_mfma_f32_32x32x16_bf16 a[16:31], a[48:51], a[72:75], a[16:31]
    ds_read2_b32 a[36:37], v14 offset0:40 offset1:41
    ds_read2_b32 a[38:39], v14 offset0:42 offset1:43
    s_waitcnt lgkmcnt(10)
    v_mfma_f32_32x32x16_bf16 a[0:15], a[48:51], a[76:79], a[0:15]
    ds_read_b128 a[64:67], v11 offset:6160
    ds_read_b128 a[68:71], v11 offset:3600
    s_waitcnt lgkmcnt(9)
    v_mfma_f32_32x32x16_bf16 a[16:31], a[52:55], a[80:83], a[16:31]
    ds_read2_b32 a[40:41], v14 offset0:48 offset1:49
    ds_read2_b32 a[42:43], v14 offset0:50 offset1:51
    s_waitcnt lgkmcnt(10)
    v_mfma_f32_32x32x16_bf16 a[0:15], a[52:55], a[84:87], a[0:15]
    ds_read_b128 a[72:75], v11 offset:6112
    ds_read_b128 a[76:79], v11 offset:3552
    s_waitcnt lgkmcnt(9)
    v_mfma_f32_32x32x16_bf16 a[16:31], a[32:35], a[56:59], a[16:31]
    ds_read2_b32 a[44:45], v14 offset0:56 offset1:57
    ds_read2_b32 a[46:47], v14 offset0:58 offset1:59
    s_waitcnt lgkmcnt(10)
    v_mfma_f32_32x32x16_bf16 a[0:15], a[32:35], a[60:63], a[0:15]
    ds_read_b128 a[80:83], v11 offset:6080
    ds_read_b128 a[84:87], v11 offset:3520
    s_waitcnt lgkmcnt(9)
    v_mfma_f32_32x32x16_bf16 a[16:31], a[36:39], a[64:67], a[16:31]
    ds_read2_b32 a[48:49], v14 offset0:64 offset1:65
    ds_read2_b32 a[50:51], v14 offset0:66 offset1:67
    s_waitcnt lgkmcnt(10)
    v_mfma_f32_32x32x16_bf16 a[0:15], a[36:39], a[68:71], a[0:15]
    ds_read_b128 a[56:59], v11 offset:6032
    ds_read_b128 a[60:63], v11 offset:3472
    s_waitcnt lgkmcnt(9)
    v_mfma_f32_32x32x16_bf16 a[16:31], a[40:43], a[72:75], a[16:31]
    ds_read2_b32 a[52:53], v14 offset0:72 offset1:73
    ds_read2_b32 a[54:55], v14 offset0:74 offset1:75
    s_waitcnt lgkmcnt(10)
    v_mfma_f32_32x32x16_bf16 a[0:15], a[40:43], a[76:79], a[0:15]
    ds_read_b128 a[64:67], v11 offset:6000
    ds_read_b128 a[68:71], v11 offset:3440
    s_waitcnt lgkmcnt(9)
    v_mfma_f32_32x32x16_bf16 a[16:31], a[44:47], a[80:83], a[16:31]
    ds_read2_b32 a[32:33], v14 offset0:80 offset1:81
    ds_read2_b32 a[34:35], v14 offset0:82 offset1:83
    s_waitcnt lgkmcnt(10)
    v_mfma_f32_32x32x16_bf16 a[0:15], a[44:47], a[84:87], a[0:15]
    ds_read_b128 a[72:75], v11 offset:5952
    ds_read_b128 a[76:79], v11 offset:3392
    s_waitcnt lgkmcnt(9)
    v_mfma_f32_32x32x16_bf16 a[16:31], a[48:51], a[56:59], a[16:31]
    ds_read2_b32 a[36:37], v14 offset0:88 offset1:89
    ds_read2_b32 a[38:39], v14 offset0:90 offset1:91
    s_waitcnt lgkmcnt(10)
    v_mfma_f32_32x32x16_bf16 a[0:15], a[48:51], a[60:63], a[0:15]
    ds_read_b128 a[80:83], v11 offset:5920
    ds_read_b128 a[84:87], v11 offset:3360
    s_waitcnt lgkmcnt(9)
    v_mfma_f32_32x32x16_bf16 a[16:31], a[52:55], a[64:67], a[16:31]
    ds_read2_b32 a[40:41], v14 offset0:96 offset1:97
    ds_read2_b32 a[42:43], v14 offset0:98 offset1:99
    s_waitcnt lgkmcnt(10)
    v_mfma_f32_32x32x16_bf16 a[0:15], a[52:55], a[68:71], a[0:15]
    ds_read_b128 a[56:59], v11 offset:5872
    ds_read_b128 a[60:63], v11 offset:3312
    s_waitcnt lgkmcnt(9)
    v_mfma_f32_32x32x16_bf16 a[16:31], a[32:35], a[72:75], a[16:31]
    ds_read2_b32 a[44:45], v14 offset0:104 offset1:105
    ds_read2_b32 a[46:47], v14 offset0:106 offset1:107
    s_waitcnt lgkmcnt(10)
    v_mfma_f32_32x32x16_bf16 a[0:15], a[32:35], a[76:79], a[0:15]
    ds_read_b128 a[64:67], v11 offset:5840
    ds_read_b128 a[68:71], v11 offset:3280
    s_waitcnt lgkmcnt(9)
    v_mfma_f32_32x32x16_bf16 a[16:31], a[36:39], a[80:83], a[16:31]
    ds_read2_b32 a[48:49], v14 offset0:112 offset1:113
    ds_read2_b32 a[50:51], v14 offset0:114 offset1:115
    s_waitcnt lgkmcnt(10)
    v_mfma_f32_32x32x16_bf16 a[0:15], a[36:39], a[84:87], a[0:15]
    ds_read_b128 a[72:75], v11 offset:5792
    ds_read_b128 a[76:79], v11 offset:3232
    s_waitcnt lgkmcnt(9)
    v_mfma_f32_32x32x16_bf16 a[16:31], a[40:43], a[56:59], a[16:31]
    ds_read2_b32 a[52:53], v14 offset0:120 offset1:121
    ds_read2_b32 a[54:55], v14 offset0:122 offset1:123
    s_waitcnt lgkmcnt(10)
    v_mfma_f32_32x32x16_bf16 a[0:15], a[40:43], a[60:63], a[0:15]
    ds_read_b128 a[80:83], v11 offset:5760
    ds_read_b128 a[84:87], v11 offset:3200
    s_waitcnt lgkmcnt(9)
    v_mfma_f32_32x32x16_bf16 a[16:31], a[44:47], a[64:67], a[16:31]
    ds_read2_b32 a[32:33], v14 offset0:128 offset1:129
    ds_read2_b32 a[34:35], v14 offset0:130 offset1:131
    s_waitcnt lgkmcnt(10)
    v_mfma_f32_32x32x16_bf16 a[0:15], a[44:47], a[68:71], a[0:15]
    ds_read_b128 a[56:59], v11 offset:5712
    ds_read_b128 a[60:63], v11 offset:3152
    s_waitcnt lgkmcnt(9)
    v_mfma_f32_32x32x16_bf16 a[16:31], a[48:51], a[72:75], a[16:31]
    ds_read2_b32 a[36:37], v14 offset0:136 offset1:137
    ds_read2_b32 a[38:39], v14 offset0:138 offset1:139
    s_waitcnt lgkmcnt(10)
    v_mfma_f32_32x32x16_bf16 a[0:15], a[48:51], a[76:79], a[0:15]
    ds_read_b128 a[64:67], v11 offset:5680
    ds_read_b128 a[68:71], v11 offset:3120
    s_waitcnt lgkmcnt(9)
    v_mfma_f32_32x32x16_bf16 a[16:31], a[52:55], a[80:83], a[16:31]
    ds_read2_b32 a[40:41], v14 offset0:144 offset1:145
    ds_read2_b32 a[42:43], v14 offset0:146 offset1:147
    s_waitcnt lgkmcnt(10)
    v_mfma_f32_32x32x16_bf16 a[0:15], a[52:55], a[84:87], a[0:15]
    ds_read_b128 a[72:75], v11 offset:5632
    ds_read_b128 a[76:79], v11 offset:3072
    s_waitcnt lgkmcnt(9)
    v_mfma_f32_32x32x16_bf16 a[16:31], a[32:35], a[56:59], a[16:31]
    ds_read2_b32 a[44:45], v14 offset0:152 offset1:153
    ds_read2_b32 a[46:47], v14 offset0:154 offset1:155
    s_waitcnt lgkmcnt(10)
    v_mfma_f32_32x32x16_bf16 a[0:15], a[32:35], a[60:63], a[0:15]
    ds_read_b128 a[80:83], v11 offset:5600
    ds_read_b128 a[84:87], v11 offset:3040
    s_waitcnt lgkmcnt(9)
    v_mfma_f32_32x32x16_bf16 a[16:31], a[36:39], a[64:67], a[16:31]
    ds_read2_b32 a[48:49], v14 offset0:160 offset1:161
    ds_read2_b32 a[50:51], v14 offset0:162 offset1:163
    s_waitcnt lgkmcnt(10)
    v_mfma_f32_32x32x16_bf16 a[0:15], a[36:39], a[68:71], a[0:15]
    ds_read_b128 a[56:59], v11 offset:5552
    ds_read_b128 a[60:63], v11 offset:2992
    s_waitcnt lgkmcnt(9)
    v_mfma_f32_32x32x16_bf16 a[16:31], a[40:43], a[72:75], a[16:31]
    ds_read2_b32 a[52:53], v14 offset0:168 offset1:169
    ds_read2_b32 a[54:55], v14 offset0:170 offset1:171
    s_waitcnt lgkmcnt(10)
    v_mfma_f32_32x32x16_bf16 a[0:15], a[40:43], a[76:79], a[0:15]
    ds_read_b128 a[64:67], v11 offset:5520
    ds_read_b128 a[68:71], v11 offset:2960
    s_waitcnt lgkmcnt(9)
    v_mfma_f32_32x32x16_bf16 a[16:31], a[44:47], a[80:83], a[16:31]
    ds_read2_b32 a[32:33], v14 offset0:176 offset1:177
    ds_read2_b32 a[34:35], v14 offset0:178 offset1:179
    s_waitcnt lgkmcnt(10)
    v_mfma_f32_32x32x16_bf16 a[0:15], a[44:47], a[84:87], a[0:15]
    ds_read_b128 a[72:75], v11 offset:5472
    ds_read_b128 a[76:79], v11 offset:2912
    s_waitcnt lgkmcnt(9)
    v_mfma_f32_32x32x16_bf16 a[16:31], a[48:51], a[56:59], a[16:31]
    ds_read2_b32 a[36:37], v14 offset0:184 offset1:185
    ds_read2_b32 a[38:39], v14 offset0:186 offset1:187
    s_waitcnt lgkmcnt(10)
    v_mfma_f32_32x32x16_bf16 a[0:15], a[48:51], a[60:63], a[0:15]
    ds_read_b128 a[80:83], v11 offset:5440
    ds_read_b128 a[84:87], v11 offset:2880
    s_waitcnt lgkmcnt(9)
    v_mfma_f32_32x32x16_bf16 a[16:31], a[52:55], a[64:67], a[16:31]
    ds_read2_b32 a[40:41], v14 offset0:192 offset1:193
    ds_read2_b32 a[42:43], v14 offset0:194 offset1:195
    s_waitcnt lgkmcnt(10)
    v_mfma_f32_32x32x16_bf16 a[0:15], a[52:55], a[68:71], a[0:15]
    ds_read_b128 a[56:59], v11 offset:5392
    ds_read_b128 a[60:63], v11 offset:2832
    s_waitcnt lgkmcnt(9)
    v_mfma_f32_32x32x16_bf16 a[16:31], a[32:35], a[72:75], a[16:31]
    ds_read2_b32 a[44:45], v14 offset0:200 offset1:201
    ds_read2_b32 a[46:47], v14 offset0:202 offset1:203
    s_waitcnt lgkmcnt(10)
    v_mfma_f32_32x32x16_bf16 a[0:15], a[32:35], a[76:79], a[0:15]
    ds_read_b128 a[64:67], v11 offset:5360
    ds_read_b128 a[68:71], v11 offset:2800
    s_waitcnt lgkmcnt(9)
    v_mfma_f32_32x32x16_bf16 a[16:31], a[36:39], a[80:83], a[16:31]
    ds_read2_b32 a[48:49], v14 offset0:208 offset1:209
    ds_read2_b32 a[50:51], v14 offset0:210 offset1:211
    s_waitcnt lgkmcnt(10)
    v_mfma_f32_32x32x16_bf16 a[0:15], a[36:39], a[84:87], a[0:15]
    ds_read_b128 a[72:75], v11 offset:5312
    ds_read_b128 a[76:79], v11 offset:2752
    s_waitcnt lgkmcnt(9)
    v_mfma_f32_32x32x16_bf16 a[16:31], a[40:43], a[56:59], a[16:31]
    ds_read2_b32 a[52:53], v14 offset0:216 offset1:217
    ds_read2_b32 a[54:55], v14 offset0:218 offset1:219
    s_waitcnt lgkmcnt(10)
    v_mfma_f32_32x32x16_bf16 a[0:15], a[40:43], a[60:63], a[0:15]
    ds_read_b128 a[80:83], v11 offset:5280
    ds_read_b128 a[84:87], v11 offset:2720
    s_waitcnt lgkmcnt(9)
    v_mfma_f32_32x32x16_bf16 a[16:31], a[44:47], a[64:67], a[16:31]
    ds_read2_b32 a[32:33], v14 offset0:224 offset1:225
    ds_read2_b32 a[34:35], v14 offset0:226 offset1:227
    s_waitcnt lgkmcnt(10)
    v_mfma_f32_32x32x16_bf16 a[0:15], a[44:47], a[68:71], a[0:15]
    ds_read_b128 a[56:59], v11 offset:5232
    ds_read_b128 a[60:63], v11 offset:2672
    s_waitcnt lgkmcnt(9)
    v_mfma_f32_32x32x16_bf16 a[16:31], a[48:51], a[72:75], a[16:31]
    ds_read2_b32 a[36:37], v14 offset0:232 offset1:233
    ds_read2_b32 a[38:39], v14 offset0:234 offset1:235
    s_waitcnt lgkmcnt(10)
    v_mfma_f32_32x32x16_bf16 a[0:15], a[48:51], a[76:79], a[0:15]
    ds_read_b128 a[64:67], v11 offset:5200
    ds_read_b128 a[68:71], v11 offset:2640
    s_waitcnt lgkmcnt(9)
    v_mfma_f32_32x32x16_bf16 a[16:31], a[52:55], a[80:83], a[16:31]
    ds_read2_b32 a[40:41], v14 offset0:240 offset1:241
    ds_read2_b32 a[42:43], v14 offset0:242 offset1:243
    s_waitcnt lgkmcnt(10)
    v_mfma_f32_32x32x16_bf16 a[0:15], a[52:55], a[84:87], a[0:15]
    ds_read_b128 a[72:75], v11 offset:5152
    ds_read_b128 a[76:79], v11 offset:2592
    s_waitcnt lgkmcnt(9)
    v_mfma_f32_32x32x16_bf16 a[16:31], a[32:35], a[56:59], a[16:31]
    ds_read2_b32 a[44:45], v14 offset0:248 offset1:249
    ds_read2_b32 a[46:47], v14 offset0:250 offset1:251
    v_add_u32 v14, 1024, v14
    s_waitcnt lgkmcnt(10)
    v_mfma_f32_32x32x16_bf16 a[0:15], a[32:35], a[60:63], a[0:15]
    ds_read_b128 a[80:83], v11 offset:5120
    ds_read_b128 a[84:87], v11 offset:2560
    s_waitcnt lgkmcnt(9)
    v_mfma_f32_32x32x16_bf16 a[16:31], a[36:39], a[64:67], a[16:31]
    ds_read2_b32 a[48:49], v14 offset0:0 offset1:1
    ds_read2_b32 a[50:51], v14 offset0:2 offset1:3
    s_waitcnt lgkmcnt(10)
    v_mfma_f32_32x32x16_bf16 a[0:15], a[36:39], a[68:71], a[0:15]
    ds_read_b128 a[56:59], v11 offset:5072
    ds_read2_b32 a[52:53], v14 offset0:8 offset1:9
    ds_read2_b32 a[54:55], v14 offset0:10 offset1:11
    s_waitcnt lgkmcnt(10)
    v_mfma_f32_32x32x16_bf16 a[16:31], a[40:43], a[72:75], a[16:31]
    ds_read_b128 a[60:63], v11 offset:5040
    s_waitcnt lgkmcnt(10)
    v_mfma_f32_32x32x16_bf16 a[0:15], a[40:43], a[76:79], a[0:15]
    ds_read2_b32 a[32:33], v14 offset0:16 offset1:17
    ds_read2_b32 a[34:35], v14 offset0:18 offset1:19
    ds_read_b128 a[64:67], v11 offset:4992
    s_waitcnt lgkmcnt(10)
    v_mfma_f32_32x32x16_bf16 a[16:31], a[44:47], a[80:83], a[16:31]
    ds_read2_b32 a[36:37], v14 offset0:24 offset1:25
    ds_read2_b32 a[38:39], v14 offset0:26 offset1:27
    s_waitcnt lgkmcnt(11)
    v_mfma_f32_32x32x16_bf16 a[0:15], a[44:47], a[84:87], a[0:15]
    ds_read_b128 a[68:71], v11 offset:4960
    ds_read2_b32 a[40:41], v14 offset0:32 offset1:33
    ds_read2_b32 a[42:43], v14 offset0:34 offset1:35
    s_waitcnt lgkmcnt(11)
    v_mfma_f32_32x32x16_bf16 a[16:31], a[48:51], a[56:59], a[16:31]
    ds_read_b128 a[72:75], v11 offset:4912
    ds_read2_b32 a[44:45], v14 offset0:40 offset1:41
    ds_read2_b32 a[46:47], v14 offset0:42 offset1:43
    s_waitcnt lgkmcnt(11)
    v_mfma_f32_32x32x16_bf16 a[16:31], a[52:55], a[60:63], a[16:31]
    ds_read_b128 a[76:79], v11 offset:4880
    ds_read2_b32 a[48:49], v14 offset0:48 offset1:49
    ds_read2_b32 a[50:51], v14 offset0:50 offset1:51
    s_waitcnt lgkmcnt(11)
    v_mfma_f32_32x32x16_bf16 a[16:31], a[32:35], a[64:67], a[16:31]
    ds_read_b128 a[80:83], v11 offset:4832
    ds_read2_b32 a[52:53], v14 offset0:56 offset1:57
    ds_read2_b32 a[54:55], v14 offset0:58 offset1:59
    s_waitcnt lgkmcnt(11)
    v_mfma_f32_32x32x16_bf16 a[16:31], a[36:39], a[68:71], a[16:31]
    ds_read_b128 a[84:87], v11 offset:4800
    ds_read2_b32 a[32:33], v14 offset0:64 offset1:65
    ds_read2_b32 a[34:35], v14 offset0:66 offset1:67
    s_waitcnt lgkmcnt(11)
    v_mfma_f32_32x32x16_bf16 a[16:31], a[40:43], a[72:75], a[16:31]
    ds_read_b128 a[56:59], v11 offset:4752
    ds_read2_b32 a[36:37], v14 offset0:72 offset1:73
    ds_read2_b32 a[38:39], v14 offset0:74 offset1:75
    s_waitcnt lgkmcnt(11)
    v_mfma_f32_32x32x16_bf16 a[16:31], a[44:47], a[76:79], a[16:31]
    ds_read_b128 a[60:63], v11 offset:4720
    ds_read2_b32 a[40:41], v14 offset0:80 offset1:81
    ds_read2_b32 a[42:43], v14 offset0:82 offset1:83
    s_waitcnt lgkmcnt(11)
    v_mfma_f32_32x32x16_bf16 a[16:31], a[48:51], a[80:83], a[16:31]
    ds_read_b128 a[64:67], v11 offset:4672
    ds_read2_b32 a[44:45], v14 offset0:88 offset1:89
    ds_read2_b32 a[46:47], v14 offset0:90 offset1:91
    s_waitcnt lgkmcnt(11)
    v_mfma_f32_32x32x16_bf16 a[16:31], a[52:55], a[84:87], a[16:31]
    ds_read_b128 a[68:71], v11 offset:4640
    ds_read2_b32 a[48:49], v14 offset0:96 offset1:97
    ds_read2_b32 a[50:51], v14 offset0:98 offset1:99
    s_waitcnt lgkmcnt(11)
    v_mfma_f32_32x32x16_bf16 a[16:31], a[32:35], a[56:59], a[16:31]
    ds_read_b128 a[72:75], v11 offset:4592
    ds_read2_b32 a[52:53], v14 offset0:104 offset1:105
    ds_read2_b32 a[54:55], v14 offset0:106 offset1:107
    s_waitcnt lgkmcnt(11)
    v_mfma_f32_32x32x16_bf16 a[16:31], a[36:39], a[60:63], a[16:31]
    ds_read_b128 a[76:79], v11 offset:4560
    ds_read2_b32 a[32:33], v14 offset0:112 offset1:113
    ds_read2_b32 a[34:35], v14 offset0:114 offset1:115
    s_waitcnt lgkmcnt(11)
    v_mfma_f32_32x32x16_bf16 a[16:31], a[40:43], a[64:67], a[16:31]
    ds_read_b128 a[80:83], v11 offset:4512
    ds_read2_b32 a[36:37], v14 offset0:120 offset1:121
    ds_read2_b32 a[38:39], v14 offset0:122 offset1:123
    s_waitcnt lgkmcnt(11)
    v_mfma_f32_32x32x16_bf16 a[16:31], a[44:47], a[68:71], a[16:31]
    ds_read_b128 a[84:87], v11 offset:4480
    ds_read2_b32 a[40:41], v14 offset0:128 offset1:129
    ds_read2_b32 a[42:43], v14 offset0:130 offset1:131
    s_waitcnt lgkmcnt(11)
    v_mfma_f32_32x32x16_bf16 a[16:31], a[48:51], a[72:75], a[16:31]
    ds_read_b128 a[56:59], v11 offset:4432
    ds_read2_b32 a[44:45], v14 offset0:136 offset1:137
    ds_read2_b32 a[46:47], v14 offset0:138 offset1:139
    s_waitcnt lgkmcnt(11)
    v_mfma_f32_32x32x16_bf16 a[16:31], a[52:55], a[76:79], a[16:31]
    ds_read_b128 a[60:63], v11 offset:4400
    ds_read2_b32 a[48:49], v14 offset0:144 offset1:145
    ds_read2_b32 a[50:51], v14 offset0:146 offset1:147
    s_waitcnt lgkmcnt(11)
    v_mfma_f32_32x32x16_bf16 a[16:31], a[32:35], a[80:83], a[16:31]
    ds_read_b128 a[64:67], v11 offset:4352
    ds_read2_b32 a[52:53], v14 offset0:152 offset1:153
    ds_read2_b32 a[54:55], v14 offset0:154 offset1:155
    s_waitcnt lgkmcnt(11)
    v_mfma_f32_32x32x16_bf16 a[16:31], a[36:39], a[84:87], a[16:31]
    ds_read_b128 a[68:71], v11 offset:4320
    ds_read2_b32 a[32:33], v14 offset0:160 offset1:161
    ds_read2_b32 a[34:35], v14 offset0:162 offset1:163
    s_waitcnt lgkmcnt(11)
    v_mfma_f32_32x32x16_bf16 a[16:31], a[40:43], a[56:59], a[16:31]
    ds_read_b128 a[72:75], v11 offset:4272
    ds_read2_b32 a[36:37], v14 offset0:168 offset1:169
    ds_read2_b32 a[38:39], v14 offset0:170 offset1:171
    s_waitcnt lgkmcnt(11)
    v_mfma_f32_32x32x16_bf16 a[16:31], a[44:47], a[60:63], a[16:31]
    ds_read_b128 a[76:79], v11 offset:4240
    ds_read2_b32 a[40:41], v14 offset0:176 offset1:177
    ds_read2_b32 a[42:43], v14 offset0:178 offset1:179
    s_waitcnt lgkmcnt(11)
    v_mfma_f32_32x32x16_bf16 a[16:31], a[48:51], a[64:67], a[16:31]
    ds_read_b128 a[80:83], v11 offset:4192
    ds_read2_b32 a[44:45], v14 offset0:184 offset1:185
    ds_read2_b32 a[46:47], v14 offset0:186 offset1:187
    s_waitcnt lgkmcnt(11)
    v_mfma_f32_32x32x16_bf16 a[16:31], a[52:55], a[68:71], a[16:31]
    ds_read_b128 a[84:87], v11 offset:4160
    ds_read2_b32 a[48:49], v14 offset0:192 offset1:193
    ds_read2_b32 a[50:51], v14 offset0:194 offset1:195
    s_waitcnt lgkmcnt(11)
    v_mfma_f32_32x32x16_bf16 a[16:31], a[32:35], a[72:75], a[16:31]
    ds_read_b128 a[56:59], v11 offset:4112
    ds_read2_b32 a[52:53], v14 offset0:200 offset1:201
    ds_read2_b32 a[54:55], v14 offset0:202 offset1:203
    s_waitcnt lgkmcnt(11)
    v_mfma_f32_32x32x16_bf16 a[16:31], a[36:39], a[76:79], a[16:31]
    ds_read_b128 a[60:63], v11 offset:4080
    ds_read2_b32 a[32:33], v14 offset0:208 offset1:209
    ds_read2_b32 a[34:35], v14 offset0:210 offset1:211
    s_waitcnt lgkmcnt(11)
    v_mfma_f32_32x32x16_bf16 a[16:31], a[40:43], a[80:83], a[16:31]
    ds_read_b128 a[64:67], v11 offset:4032
    ds_read2_b32 a[36:37], v14 offset0:216 offset1:217
    ds_read2_b32 a[38:39], v14 offset0:218 offset1:219
    s_waitcnt lgkmcnt(11)
    v_mfma_f32_32x32x16_bf16 a[16:31], a[44:47], a[84:87], a[16:31]
    ds_read_b128 a[68:71], v11 offset:4000
    ds_read2_b32 a[40:41], v14 offset0:224 offset1:225
    ds_read2_b32 a[42:43], v14 offset0:226 offset1:227
    s_waitcnt lgkmcnt(11)
    v_mfma_f32_32x32x16_bf16 a[16:31], a[48:51], a[56:59], a[16:31]
    ds_read_b128 a[72:75], v11 offset:3952
    ds_read2_b32 a[44:45], v14 offset0:232 offset1:233
    ds_read2_b32 a[46:47], v14 offset0:234 offset1:235
    s_waitcnt lgkmcnt(11)
    v_mfma_f32_32x32x16_bf16 a[16:31], a[52:55], a[60:63], a[16:31]
    ds_read_b128 a[76:79], v11 offset:3920
    ds_read2_b32 a[48:49], v14 offset0:240 offset1:241
    ds_read2_b32 a[50:51], v14 offset0:242 offset1:243
    s_waitcnt lgkmcnt(11)
    v_mfma_f32_32x32x16_bf16 a[16:31], a[32:35], a[64:67], a[16:31]
    ds_read_b128 a[80:83], v11 offset:3872
    ds_read2_b32 a[52:53], v14 offset0:248 offset1:249
    ds_read2_b32 a[54:55], v14 offset0:250 offset1:251
    v_add_u32 v14, 1024, v14
    s_waitcnt lgkmcnt(11)
    v_mfma_f32_32x32x16_bf16 a[16:31], a[36:39], a[68:71], a[16:31]
    ds_read_b128 a[84:87], v11 offset:3840
    ds_read2_b32 a[32:33], v14 offset0:0 offset1:1
    ds_read2_b32 a[34:35], v14 offset0:2 offset1:3
    s_waitcnt lgkmcnt(11)
    v_mfma_f32_32x32x16_bf16 a[16:31], a[40:43], a[72:75], a[16:31]
    ds_read_b128 a[56:59], v11 offset:3792
    ds_read2_b32 a[36:37], v14 offset0:8 offset1:9
    ds_read2_b32 a[38:39], v14 offset0:10 offset1:11
    s_waitcnt lgkmcnt(11)
    v_mfma_f32_32x32x16_bf16 a[16:31], a[44:47], a[76:79], a[16:31]
    ds_read_b128 a[60:63], v11 offset:3760
    ds_read2_b32 a[40:41], v14 offset0:16 offset1:17
    ds_read2_b32 a[42:43], v14 offset0:18 offset1:19
    s_waitcnt lgkmcnt(11)
    v_mfma_f32_32x32x16_bf16 a[16:31], a[48:51], a[80:83], a[16:31]
    ds_read_b128 a[64:67], v11 offset:3712
    ds_read2_b32 a[44:45], v14 offset0:24 offset1:25
    ds_read2_b32 a[46:47], v14 offset0:26 offset1:27
    s_waitcnt lgkmcnt(11)
    v_mfma_f32_32x32x16_bf16 a[16:31], a[52:55], a[84:87], a[16:31]
    ds_read_b128 a[68:71], v11 offset:3680
    ds_read2_b32 a[48:49], v14 offset0:32 offset1:33
    ds_read2_b32 a[50:51], v14 offset0:34 offset1:35
    s_waitcnt lgkmcnt(11)
    v_mfma_f32_32x32x16_bf16 a[16:31], a[32:35], a[56:59], a[16:31]
    ds_read_b128 a[72:75], v11 offset:3632
    ds_read2_b32 a[52:53], v14 offset0:40 offset1:41
    ds_read2_b32 a[54:55], v14 offset0:42 offset1:43
    s_waitcnt lgkmcnt(11)
    v_mfma_f32_32x32x16_bf16 a[16:31], a[36:39], a[60:63], a[16:31]
    ds_read_b128 a[76:79], v11 offset:3600
    ds_read2_b32 a[32:33], v14 offset0:48 offset1:49
    ds_read2_b32 a[34:35], v14 offset0:50 offset1:51
    s_waitcnt lgkmcnt(11)
    v_mfma_f32_32x32x16_bf16 a[16:31], a[40:43], a[64:67], a[16:31]
    ds_read_b128 a[80:83], v11 offset:3552
    ds_read2_b32 a[36:37], v14 offset0:56 offset1:57
    ds_read2_b32 a[38:39], v14 offset0:58 offset1:59
    s_waitcnt lgkmcnt(11)
    v_mfma_f32_32x32x16_bf16 a[16:31], a[44:47], a[68:71], a[16:31]
    ds_read_b128 a[84:87], v11 offset:3520
    ds_read2_b32 a[40:41], v14 offset0:64 offset1:65
    ds_read2_b32 a[42:43], v14 offset0:66 offset1:67
    s_waitcnt lgkmcnt(11)
    v_mfma_f32_32x32x16_bf16 a[16:31], a[48:51], a[72:75], a[16:31]
    ds_read_b128 a[56:59], v11 offset:3472
    ds_read2_b32 a[44:45], v14 offset0:72 offset1:73
    ds_read2_b32 a[46:47], v14 offset0:74 offset1:75
    s_waitcnt lgkmcnt(11)
    v_mfma_f32_32x32x16_bf16 a[16:31], a[52:55], a[76:79], a[16:31]
    ds_read_b128 a[60:63], v11 offset:3440
    ds_read2_b32 a[48:49], v14 offset0:80 offset1:81
    ds_read2_b32 a[50:51], v14 offset0:82 offset1:83
    s_waitcnt lgkmcnt(11)
    v_mfma_f32_32x32x16_bf16 a[16:31], a[32:35], a[80:83], a[16:31]
    ds_read_b128 a[64:67], v11 offset:3392
    ds_read2_b32 a[52:53], v14 offset0:88 offset1:89
    ds_read2_b32 a[54:55], v14 offset0:90 offset1:91
    s_waitcnt lgkmcnt(11)
    v_mfma_f32_32x32x16_bf16 a[16:31], a[36:39], a[84:87], a[16:31]
    ds_read_b128 a[68:71], v11 offset:3360
    ds_read2_b32 a[32:33], v14 offset0:96 offset1:97
    ds_read2_b32 a[34:35], v14 offset0:98 offset1:99
    s_waitcnt lgkmcnt(11)
    v_mfma_f32_32x32x16_bf16 a[16:31], a[40:43], a[56:59], a[16:31]
    ds_read_b128 a[72:75], v11 offset:3312
    ds_read2_b32 a[36:37], v14 offset0:104 offset1:105
    ds_read2_b32 a[38:39], v14 offset0:106 offset1:107
    s_waitcnt lgkmcnt(11)
    v_mfma_f32_32x32x16_bf16 a[16:31], a[44:47], a[60:63], a[16:31]
    ds_read_b128 a[76:79], v11 offset:3280
    ds_read2_b32 a[40:41], v14 offset0:112 offset1:113
    ds_read2_b32 a[42:43], v14 offset0:114 offset1:115
    s_waitcnt lgkmcnt(11)
    v_mfma_f32_32x32x16_bf16 a[16:31], a[48:51], a[64:67], a[16:31]
    ds_read_b128 a[80:83], v11 offset:3232
    ds_read2_b32 a[44:45], v14 offset0:120 offset1:121
    ds_read2_b32 a[46:47], v14 offset0:122 offset1:123
    s_waitcnt lgkmcnt(11)
    v_mfma_f32_32x32x16_bf16 a[16:31], a[52:55], a[68:71], a[16:31]
    ds_read_b128 a[84:87], v11 offset:3200
    ds_read2_b32 a[48:49], v14 offset0:128 offset1:129
    ds_read2_b32 a[50:51], v14 offset0:130 offset1:131
    s_waitcnt lgkmcnt(11)
    v_mfma_f32_32x32x16_bf16 a[16:31], a[32:35], a[72:75], a[16:31]
    ds_read_b128 a[56:59], v11 offset:3152
    ds_read2_b32 a[52:53], v14 offset0:136 offset1:137
    ds_read2_b32 a[54:55], v14 offset0:138 offset1:139
    s_waitcnt lgkmcnt(11)
    v_mfma_f32_32x32x16_bf16 a[16:31], a[36:39], a[76:79], a[16:31]
    ds_read_b128 a[60:63], v11 offset:3120
    ds_read2_b32 a[32:33], v14 offset0:144 offset1:145
    ds_read2_b32 a[34:35], v14 offset0:146 offset1:147
    s_waitcnt lgkmcnt(11)
    v_mfma_f32_32x32x16_bf16 a[16:31], a[40:43], a[80:83], a[16:31]
    ds_read_b128 a[64:67], v11 offset:3072
    ds_read2_b32 a[36:37], v14 offset0:152 offset1:153
    ds_read2_b32 a[38:39], v14 offset0:154 offset1:155
    s_waitcnt lgkmcnt(11)
    v_mfma_f32_32x32x16_bf16 a[16:31], a[44:47], a[84:87], a[16:31]
    ds_read_b128 a[68:71], v11 offset:3040
    ds_read2_b32 a[40:41], v14 offset0:160 offset1:161
    ds_read2_b32 a[42:43], v14 offset0:162 offset1:163
    s_waitcnt lgkmcnt(11)
    v_mfma_f32_32x32x16_bf16 a[16:31], a[48:51], a[56:59], a[16:31]
    ds_read_b128 a[72:75], v11 offset:2992
    ds_read2_b32 a[44:45], v14 offset0:168 offset1:169
    ds_read2_b32 a[46:47], v14 offset0:170 offset1:171
    s_waitcnt lgkmcnt(11)
    v_mfma_f32_32x32x16_bf16 a[16:31], a[52:55], a[60:63], a[16:31]
    ds_read_b128 a[76:79], v11 offset:2960
    ds_read2_b32 a[48:49], v14 offset0:176 offset1:177
    ds_read2_b32 a[50:51], v14 offset0:178 offset1:179
    s_waitcnt lgkmcnt(11)
    v_mfma_f32_32x32x16_bf16 a[16:31], a[32:35], a[64:67], a[16:31]
    ds_read_b128 a[80:83], v11 offset:2912
    ds_read2_b32 a[52:53], v14 offset0:184 offset1:185
    ds_read2_b32 a[54:55], v14 offset0:186 offset1:187
    s_waitcnt lgkmcnt(11)
    v_mfma_f32_32x32x16_bf16 a[16:31], a[36:39], a[68:71], a[16:31]
    ds_read_b128 a[84:87], v11 offset:2880
    ds_read2_b32 a[32:33], v14 offset0:192 offset1:193
    ds_read2_b32 a[34:35], v14 offset0:194 offset1:195
    s_waitcnt lgkmcnt(11)
    v_mfma_f32_32x32x16_bf16 a[16:31], a[40:43], a[72:75], a[16:31]
    ds_read_b128 a[56:59], v11 offset:2832
    ds_read2_b32 a[36:37], v14 offset0:200 offset1:201
    ds_read2_b32 a[38:39], v14 offset0:202 offset1:203
    s_waitcnt lgkmcnt(11)
    v_mfma_f32_32x32x16_bf16 a[16:31], a[44:47], a[76:79], a[16:31]
    ds_read_b128 a[60:63], v11 offset:2800
    ds_read2_b32 a[40:41], v14 offset0:208 offset1:209
    ds_read2_b32 a[42:43], v14 offset0:210 offset1:211
    s_waitcnt lgkmcnt(11)
    v_mfma_f32_32x32x16_bf16 a[16:31], a[48:51], a[80:83], a[16:31]
    ds_read_b128 a[64:67], v11 offset:2752
    ds_read2_b32 a[44:45], v14 offset0:216 offset1:217
    ds_read2_b32 a[46:47], v14 offset0:218 offset1:219
    s_waitcnt lgkmcnt(11)
    v_mfma_f32_32x32x16_bf16 a[16:31], a[52:55], a[84:87], a[16:31]
    ds_read_b128 a[68:71], v11 offset:2720
    ds_read2_b32 a[48:49], v14 offset0:224 offset1:225
    ds_read2_b32 a[50:51], v14 offset0:226 offset1:227
    s_waitcnt lgkmcnt(11)
    v_mfma_f32_32x32x16_bf16 a[16:31], a[32:35], a[56:59], a[16:31]
    ds_read_b128 a[72:75], v11 offset:2672
    ds_read2_b32 a[52:53], v14 offset0:232 offset1:233
    ds_read2_b32 a[54:55], v14 offset0:234 offset1:235
    s_waitcnt lgkmcnt(11)
    v_mfma_f32_32x32x16_bf16 a[16:31], a[36:39], a[60:63], a[16:31]
    ds_read_b128 a[76:79], v11 offset:2640
    ds_read2_b32 a[32:33], v14 offset0:240 offset1:241
    ds_read2_b32 a[34:35], v14 offset0:242 offset1:243
    s_waitcnt lgkmcnt(11)
    v_mfma_f32_32x32x16_bf16 a[16:31], a[40:43], a[64:67], a[16:31]
    ds_read_b128 a[80:83], v11 offset:2592
    ds_read2_b32 a[36:37], v14 offset0:248 offset1:249
    ds_read2_b32 a[38:39], v14 offset0:250 offset1:251
    v_add_u32 v14, 1024, v14
    s_waitcnt lgkmcnt(11)
    v_mfma_f32_32x32x16_bf16 a[16:31], a[44:47], a[68:71], a[16:31]
    ds_read_b128 a[84:87], v11 offset:2560
    s_waitcnt lgkmcnt(9)
    v_mfma_f32_32x32x16_bf16 a[16:31], a[48:51], a[72:75], a[16:31]
    s_waitcnt lgkmcnt(6)
    v_mfma_f32_32x32x16_bf16 a[16:31], a[52:55], a[76:79], a[16:31]
    s_waitcnt lgkmcnt(3)
    v_mfma_f32_32x32x16_bf16 a[16:31], a[32:35], a[80:83], a[16:31]
    s_waitcnt lgkmcnt(0)
    v_mfma_f32_32x32x16_bf16 a[16:31], a[36:39], a[84:87], a[16:31]
    v_accvgpr_read_b32 v220, a0
    v_accvgpr_read_b32 v221, a1
    v_accvgpr_read_b32 v222, a2
    v_accvgpr_read_b32 v223, a3
    v_accvgpr_read_b32 v224, a4
    v_accvgpr_read_b32 v225, a5
    v_accvgpr_read_b32 v226, a6
    v_accvgpr_read_b32 v227, a7
    v_accvgpr_read_b32 v228, a8
    v_accvgpr_read_b32 v229, a9
    v_accvgpr_read_b32 v230, a10
    v_accvgpr_read_b32 v231, a11
    v_accvgpr_read_b32 v232, a12
    v_accvgpr_read_b32 v233, a13
    v_accvgpr_read_b32 v234, a14
    v_accvgpr_read_b32 v235, a15
    v_cvt_pk_bf16_f32 v236, v220, v221
    v_cvt_pk_bf16_f32 v237, v222, v223
    v_cvt_pk_bf16_f32 v238, v224, v225
    v_cvt_pk_bf16_f32 v239, v226, v227
    v_cvt_pk_bf16_f32 v240, v228, v229
    v_cvt_pk_bf16_f32 v241, v230, v231
    v_cvt_pk_bf16_f32 v242, v232, v233
    v_cvt_pk_bf16_f32 v243, v234, v235
    s_nop 0
    v_permlane32_swap_b32 v236, v238
    v_permlane32_swap_b32 v237, v239
    v_permlane32_swap_b32 v240, v242
    v_permlane32_swap_b32 v241, v243
    buffer_store_dwordx4 v[236:239], v2, s[8:11], s7 offen offset:0 sc1
    buffer_store_dwordx4 v[240:243], v2, s[8:11], s7 offen offset:1024 sc1
    v_accvgpr_read_b32 v220, a16
    v_accvgpr_read_b32 v221, a17
    v_accvgpr_read_b32 v222, a18
    v_accvgpr_read_b32 v223, a19
    v_accvgpr_read_b32 v224, a20
    v_accvgpr_read_b32 v225, a21
    v_accvgpr_read_b32 v226, a22
    v_accvgpr_read_b32 v227, a23
    v_accvgpr_read_b32 v228, a24
    v_accvgpr_read_b32 v229, a25
    v_accvgpr_read_b32 v230, a26
    v_accvgpr_read_b32 v231, a27
    v_accvgpr_read_b32 v232, a28
    v_accvgpr_read_b32 v233, a29
    v_accvgpr_read_b32 v234, a30
    v_accvgpr_read_b32 v235, a31
    v_cvt_pk_bf16_f32 v236, v220, v221
    v_cvt_pk_bf16_f32 v237, v222, v223
    v_cvt_pk_bf16_f32 v238, v224, v225
    v_cvt_pk_bf16_f32 v239, v226, v227
    v_cvt_pk_bf16_f32 v240, v228, v229
    v_cvt_pk_bf16_f32 v241, v230, v231
    v_cvt_pk_bf16_f32 v242, v232, v233
    v_cvt_pk_bf16_f32 v243, v234, v235
    s_nop 0
    v_permlane32_swap_b32 v236, v238
    v_permlane32_swap_b32 v237, v239
    v_permlane32_swap_b32 v240, v242
    v_permlane32_swap_b32 v241, v243
    buffer_store_dwordx4 v[236:239], v2, s[8:11], s7 offen offset:2048 sc1
    buffer_store_dwordx4 v[240:243], v2, s[8:11], s7 offen offset:3072 sc1
    v_add_u32 v11, 30720, v11
    s_add_u32 s64, s64, 1
    s_cmp_lt_u32 s64, 4
    s_waitcnt vmcnt(4)
    s_cbranch_scc1 .chan_347
    s_waitcnt vmcnt(0)
    s_barrier
    s_cmp_lg_u32 s24, 0
    s_cbranch_scc1 .sg_349
    s_mov_b64 exec, 1
    v_mov_b32 v4, 1
    v_mov_b32 v5, 0
    buffer_atomic_add v4, v5, s[20:23], 0 offen offset:192 sc1
    s_mov_b64 exec, -1
.sg_349:
    s_branch .fin_350
.qa_341:
    s_and_b32 s34, s24, 1
    s_lshr_b32 s35, s24, 1
    s_lshl_b32 s4, s35, 10
    s_add_u32 s4, s4, 2048
    v_lshlrev_b32 v2, 4, v1
    s_lshl_b32 s5, s24, 10
    s_add_u32 s5, s5, 131072
    v_add_u32 v24, s5, v2
    s_lshl_b32 s5, s34, 12
    s_add_u32 s5, s5, 131072
    v_add_u32 v25, s5, v2
    v_add_u32 v31, 139264, v2
    s_lshl_b32 s5, s35, 12
    v_add_u32 v5, s5, v31
    s_lshl_b32 s43, s24, 11
    v_bfe_u32 v254, v1, 4, 2
    v_mul_u32_u24 v3, 128, v254
    v_bfe_u32 v254, v1, 2, 2
    v_mul_u32_u24 v254, 32, v254
    v_add_u32 v3, v3, v254
    v_bfe_u32 v254, v1, 0, 1
    v_mul_u32_u24 v254, 16, v254
    v_add_u32 v3, v3, v254
    v_add_u32 v3, 155648, v3
    v_bfe_u32 v254, v1, 2, 2
    v_mul_u32_u24 v6, 128, v254
    v_bfe_u32 v254, v1, 0, 2
    v_mul_u32_u24 v254, 16, v254
    v_add_u32 v6, v6, v254
    v_bfe_u32 v254, v1, 4, 2
    v_mul_u32_u24 v254, 4, v254
    v_add_u32 v6, v6, v254
    v_add_u32 v6, 155648, v6
    v_add_u32 v6, s4, v6
    s_lshl_b32 s4, s99, 9
    s_add_u32 s4, s4, 92274688
    v_bfe_u32 v254, v1, 0, 2
    v_mul_u32_u24 v7, 128, v254
    v_add_u32 v7, s4, v7
    v_mov_b32 v232, 0
    v_mov_b32 v233, 0
    v_mov_b32 v234, 0
    v_mov_b32 v235, 0
    v_mov_b32 v236, 0
    v_mov_b32 v237, 0
    v_mov_b32 v238, 0
    v_mov_b32 v239, 0
    v_mov_b32 v240, 0
    v_mov_b32 v241, 0
    v_mov_b32 v40, 0
    v_mov_b32 v44, 0x3f803f80
    v_mov_b32 v41, 0
    v_mov_b32 v45, 0x3f803f80
    v_mov_b32 v42, 0
    v_mov_b32 v46, 0x3f803f80
    v_mov_b32 v43, 0
    v_mov_b32 v47, 0x3f803f80
    s_lshl_b32 s4, s34, 4
    v_and_b32 v48, 15, v1
    v_add_u32 v48, s4, v48
    v_lshrrev_b32 v49, 4, v1
    v_lshlrev_b32 v49, 2, v49
    v_mov_b32 v51, 0xff800000
    v_add_u32 v50, 0, v49
    v_cmp_le_u32 vcc, v50, v48
    s_nop 1
    v_cndmask_b32 v32, v51, v40, vcc
    v_add_u32 v50, 1, v49
    v_cmp_le_u32 vcc, v50, v48
    s_nop 1
    v_cndmask_b32 v33, v51, v40, vcc
    v_add_u32 v50, 2, v49
    v_cmp_le_u32 vcc, v50, v48
    s_nop 1
    v_cndmask_b32 v34, v51, v40, vcc
    v_add_u32 v50, 3, v49
    v_cmp_le_u32 vcc, v50, v48
    s_nop 1
    v_cndmask_b32 v35, v51, v40, vcc
    v_add_u32 v50, 16, v49
    v_cmp_le_u32 vcc, v50, v48
    s_nop 1
    v_cndmask_b32 v36, v51, v40, vcc
    v_add_u32 v50, 17, v49
    v_cmp_le_u32 vcc, v50, v48
    s_nop 1
    v_cndmask_b32 v37, v51, v40, vcc
    v_add_u32 v50, 18, v49
    v_cmp_le_u32 vcc, v50, v48
    s_nop 1
    v_cndmask_b32 v38, v51, v40, vcc
    v_add_u32 v50, 19, v49
    v_cmp_le_u32 vcc, v50, v48
    s_nop 1
    v_cndmask_b32 v39, v51, v40, vcc
    s_lshl_b32 s4, s99, 7
    s_lshl_b32 s5, s24, 2
    s_add_u32 s4, s4, s5
    s_add_u32 s94, s4, 92340224
    s_mov_b32 s46, 16384
    s_mov_b32 s47, 32768
    s_mov_b32 s30, -1
    s_mov_b32 s32, 0
    s_mov_b32 s33, 0
    s_mov_b32 s42, 0
    s_mov_b32 s53, 75497472
    s_mov_b32 s45, 0x3e0293ee
    s_lshl_b32 s36, s99, 13
    s_add_u32 s36, s36, s43
    s_add_u32 s36, s36, 16777216
    s_add_u32 s43, s43, 139264
    s_sub_u32 s37, s36, 0x40000
    v_and_b32 v255, 15, v1
    v_bfe_u32 v254, v1, 4, 1
    v_lshlrev_b32 v255, 7, v255
    v_lshl_add_u32 v255, v254, 24, v255
    s_lshl_b32 s39, s99, 12
    s_lshl_b32 s4, s34, 12
    s_lshl_b32 s40, s99, 13
    s_add_u32 s40, s40, s4
    s_lshl_b32 s4, s35, 11
    s_add_u32 s40, s40, s4
    s_add_u32 s40, s40, 16777216
    s_add_u32 s39, s39, 67108864
    s_lshl_b32 s52, s24, 10
    s_add_u32 s39, s39, s52
    s_add_u32 s52, s52, 155648
    s_mov_b32 s31, 1
    s_sub_u32 s48, s39, 0x20000
    s_mov_b32 s49, s37
    s_mov_b32 vcc_lo, s27
    s_mov_b32 vcc_hi, 0
    s_cmp_gt_u32 s32, 0
    s_cbranch_scc1 .ndd_366
    s_mov_b32 s62, 0
.nd_365:
    buffer_load_dword v29, v7, s[8:11], s46 offen sc1
    buffer_load_dword v30, v7, s[8:11], s47 offen sc1
    s_add_u32 s62, s62, 1
    s_cmp_gt_u32 s62, 0x200000
    s_cbranch_scc1 .mg_end_1
    s_waitcnt vmcnt(0)
    v_min_u32 v29, v29, v30
    s_nop 1
    v_min_u32_dpp v29, v29, v29 quad_perm:[1,0,3,2] row_mask:0xf bank_mask:0xf
    s_nop 1
    v_min_u32_dpp v29, v29, v29 quad_perm:[2,3,0,1] row_mask:0xf bank_mask:0xf
    s_nop 1
    v_readfirstlane_b32 s32, v29
    s_lshl_b32 s55, s32, 18
    s_add_u32 s55, s55, s37
    s_cmp_gt_u32 s32, 0
    s_cbranch_scc1 .ndd_366
    s_sleep 4
    s_branch .nd_365
.ndd_366:
    s_waitcnt lgkmcnt(0)
.p2align 6
.ql_367:
    s_waitcnt lgkmcnt(8)
    v_mfma_f32_16x16x32_bf16 v[192:195], a[0:3], v[64:67], 0
    buffer_load_dwordx4 v19, s[12:15], s29 offen offset:2048 lds
    v_mfma_f32_16x16x32_bf16 v[196:199], a[4:7], v[64:67], 0
    ds_read_b128 v[112:115], v10 offset:256
    ds_read_b128 v[116:119], v10 offset:33024
    v_mfma_f32_16x16x32_bf16 v[200:203], a[0:3], v[68:71], 0
    ds_read_b128 v[120:123], v11 offset:256
    ds_read_b128 v[124:127], v11 offset:33024
    v_mfma_f32_16x16x32_bf16 v[204:207], a[4:7], v[68:71], 0
    ds_read_b128 v[64:67], v8 offset:512
    ds_read_b128 v[68:71], v8 offset:33280
    v_mfma_f32_16x16x32_bf16 v[192:195], a[8:11], v[72:75], v[192:195]
    buffer_load_dwordx4 v19, s[12:15], s29 offen offset:3072 lds
    v_mfma_f32_16x16x32_bf16 v[196:199], a[12:15], v[72:75], v[196:199]
    v_cvt_pk_bf16_f32 v224, v208, v209
    v_cvt_pk_bf16_f32 v225, v210, v211
    v_mfma_f32_16x16x32_bf16 v[200:203], a[8:11], v[76:79], v[200:203]
    v_cvt_pk_bf16_f32 v226, v212, v213
    v_cvt_pk_bf16_f32 v227, v214, v215
    v_mfma_f32_16x16x32_bf16 v[204:207], a[12:15], v[76:79], v[204:207]
    ds_write_b128 v24, v[224:227] offset:0
    s_waitcnt lgkmcnt(11)
    v_mfma_f32_16x16x32_bf16 v[192:195], a[16:19], v[80:83], v[192:195]
    s_add_u32 m0, s6, 73728
    v_cvt_pk_bf16_f32 v228, v216, v217
    v_mfma_f32_16x16x32_bf16 v[196:199], a[20:23], v[80:83], v[196:199]
    buffer_load_dwordx4 v20, s[12:15], s29 offen offset:0 lds
    v_mfma_f32_16x16x32_bf16 v[200:203], a[16:19], v[84:87], v[200:203]
    v_cvt_pk_bf16_f32 v229, v218, v219
    v_cvt_pk_bf16_f32 v230, v220, v221
    v_mfma_f32_16x16x32_bf16 v[204:207], a[20:23], v[84:87], v[204:207]
    v_cvt_pk_bf16_f32 v231, v222, v223
    ds_write_b128 v24, v[228:231] offset:4096
    v_mfma_f32_16x16x32_bf16 v[192:195], a[24:27], v[88:91], v[192:195]
    ds_read_b128 v[72:75], v9 offset:512
    ds_read_b128 v[76:79], v9 offset:33280
    v_mfma_f32_16x16x32_bf16 v[196:199], a[28:31], v[88:91], v[196:199]
    buffer_load_dwordx4 v20, s[12:15], s29 offen offset:1024 lds
    v_mfma_f32_16x16x32_bf16 v[200:203], a[24:27], v[92:95], v[200:203]
    ds_read_b128 v[80:83], v10 offset:512
    ds_read_b128 v[84:87], v10 offset:33280
    v_mfma_f32_16x16x32_bf16 v[204:207], a[28:31], v[92:95], v[204:207]
    ds_read_b128 v[88:91], v11 offset:512
    s_waitcnt lgkmcnt(13)
    v_mfma_f32_16x16x32_bf16 v[192:195], a[32:35], v[96:99], v[192:195]
    s_waitcnt vmcnt(13) lgkmcnt(5)
    s_barrier
    v_mfma_f32_16x16x32_bf16 v[196:199], a[36:39], v[96:99], v[196:199]
    buffer_load_dwordx4 v21, s[12:15], s29 offen offset:2048 lds
    v_mfma_f32_16x16x32_bf16 v[200:203], a[32:35], v[100:103], v[200:203]
    ds_read_b128 v[208:211], v25 offset:0
    ds_read_b128 v[128:131], v31 offset:0
    v_mfma_f32_16x16x32_bf16 v[204:207], a[36:39], v[100:103], v[204:207]
    ds_read_b128 v[144:147], v31 offset:4096
    ds_read_b128 v[212:215], v25 offset:1024
    v_mfma_f32_16x16x32_bf16 v[192:195], a[40:43], v[104:107], v[192:195]
    ds_read_b128 v[132:135], v31 offset:1024
    ds_read_b128 v[148:151], v31 offset:5120
    v_mfma_f32_16x16x32_bf16 v[196:199], a[44:47], v[104:107], v[196:199]
    buffer_load_dwordx4 v21, s[12:15], s29 offen offset:3072 lds
    v_mfma_f32_16x16x32_bf16 v[200:203], a[40:43], v[108:111], v[200:203]
    ds_read_b128 v[92:95], v11 offset:33280
    ds_read_b128 v[216:219], v25 offset:2048
    v_mfma_f32_16x16x32_bf16 v[204:207], a[44:47], v[108:111], v[204:207]
    ds_read_b128 v[136:139], v31 offset:2048
    ds_read_b128 v[152:155], v31 offset:6144
    v_mfma_f32_16x16x32_bf16 v[192:195], a[48:51], v[112:115], v[192:195]
    ds_read_b128 v[220:223], v25 offset:3072
    ds_read_b128 v[140:143], v31 offset:3072
    v_mfma_f32_16x16x32_bf16 v[196:199], a[52:55], v[112:115], v[196:199]
    s_add_u32 m0, s6, 77824
    s_waitcnt lgkmcnt(9)
    v_mfma_f32_16x16x32_bf16 v[48:51], v[128:131], v[208:211], v[32:35]
    buffer_load_dwordx4 v22, s[12:15], s29 offen offset:0 lds
    v_mfma_f32_16x16x32_bf16 v[52:55], v[144:147], v[208:211], v[36:39]
    ds_read_b128 v[156:159], v31 offset:7168
    s_waitcnt lgkmcnt(7)
    v_mfma_f32_16x16x32_bf16 v[48:51], v[132:135], v[212:215], v[48:51]
    ds_read_b128 v[160:163], v5 offset:8192
    ds_read_b128 v[164:167], v5 offset:9216
    v_mfma_f32_16x16x32_bf16 v[52:55], v[148:151], v[212:215], v[52:55]
    ds_read_b128 v[96:99], v8 offset:768
    s_waitcnt lgkmcnt(6)
    v_mfma_f32_16x16x32_bf16 v[48:51], v[136:139], v[216:219], v[48:51]
    buffer_load_dwordx4 v22, s[12:15], s29 offen offset:1024 lds
    v_mfma_f32_16x16x32_bf16 v[52:55], v[152:155], v[216:219], v[52:55]
    ds_read_b128 v[100:103], v8 offset:33536
    ds_read_b128 v[104:107], v9 offset:768
    v_mfma_f32_16x16x32_bf16 v[200:203], a[48:51], v[116:119], v[200:203]
    ds_read_b128 v[108:111], v9 offset:33536
    ds_read_b128 v[168:171], v5 offset:10240
    v_mfma_f32_16x16x32_bf16 v[204:207], a[52:55], v[116:119], v[204:207]
    ds_read_b128 v[172:175], v5 offset:11264
    s_waitcnt lgkmcnt(8)
    v_mfma_f32_16x16x32_bf16 v[48:51], v[140:143], v[220:223], v[48:51]
    buffer_load_dwordx4 v23, s[12:15], s29 offen offset:2048 lds
    v_mfma_f32_16x16x32_bf16 v[52:55], v[156:159], v[220:223], v[52:55]
    v_max_i32 v27, s30, v26
    ds_read_b128 v[112:115], v10 offset:768
    v_mfma_f32_16x16x32_bf16 v[192:195], a[56:59], v[120:123], v[192:195]
    s_waitcnt vmcnt(12)
    s_cbranch_vccnz .cp_373
    buffer_store_dword v27, v26, s[8:11], s94 offen
.cb_374:
    v_mfma_f32_16x16x32_bf16 v[196:199], a[60:63], v[120:123], v[196:199]
    ds_read_b128 v[116:119], v10 offset:33536
    ds_read_b128 v[120:123], v11 offset:768
    v_mfma_f32_16x16x32_bf16 v[200:203], a[56:59], v[124:127], v[200:203]
    buffer_load_dwordx4 v23, s[12:15], s29 offen offset:3072 lds
    v_mfma_f32_16x16x32_bf16 v[204:207], a[60:63], v[124:127], v[204:207]
    s_cmp_eq_u32 s31, 0
    s_cbranch_scc1 .cp_377
.cb_378:
    v_mfma_f32_16x16x32_bf16 v[192:195], a[64:67], v[64:67], v[192:195]
    s_waitcnt lgkmcnt(3)
    s_barrier
    v_mfma_f32_16x16x32_bf16 v[196:199], a[68:71], v[64:67], v[196:199]
    ds_read_b128 v[124:127], v11 offset:33536
    ds_read_b128 v[176:179], v3 offset:0
    v_mfma_f32_16x16x32_bf16 v[200:203], a[64:67], v[68:71], v[200:203]
    ds_read_b128 v[180:183], v3 offset:512
    ds_read_b128 v[184:187], v3 offset:1024
    v_mfma_f32_16x16x32_bf16 v[204:207], a[68:71], v[68:71], v[204:207]
    ds_read_b128 v[188:191], v3 offset:1536
    ds_read_b128 v[64:67], v8 offset:1024
    v_mfma_f32_16x16x32_bf16 v[192:195], a[72:75], v[72:75], v[192:195]
    ds_read_b128 v[68:71], v8 offset:33792
    v_max3_f32 v248, v48, v49, v50
    v_mfma_f32_16x16x32_bf16 v[196:199], a[76:79], v[72:75], v[196:199]
    ds_read_b128 v[72:75], v9 offset:1024
    v_max3_f32 v248, v248, v51, v52
    v_mfma_f32_16x16x32_bf16 v[200:203], a[72:75], v[76:79], v[200:203]
    v_max3_f32 v249, v53, v54, v55
    s_add_u32 m0, s52, 4096
    v_mfma_f32_16x16x32_bf16 v[204:207], a[76:79], v[76:79], v[204:207]
    ds_read_b128 v[76:79], v9 offset:33792
    s_add_u32 s48, s48, 0x20000
    v_mfma_f32_16x16x32_bf16 v[192:195], a[80:83], v[80:83], v[192:195]
    s_mov_b32 s31, 1
    buffer_load_dword v29, v28, s[12:15], s29 offen
    v_mfma_f32_16x16x32_bf16 v[196:199], a[84:87], v[80:83], v[196:199]
    s_cmp_gt_u32 s33, s42
    s_cbranch_scc0 .pp_379
    buffer_load_dwordx4 v2, s[8:11], s48 offen lds
.pb_380:
    s_waitcnt lgkmcnt(4)
    v_mfma_f32_16x16x32_bf16 v[56:59], v[176:179], v[208:211], 0
    ds_read_b128 v[80:83], v10 offset:1024
    s_add_u32 s29, s29, 0x10000
    v_mfma_f32_16x16x32_bf16 v[56:59], v[180:183], v[212:215], v[56:59]
    s_cmp_gt_u32 s32, s42
    s_cbranch_scc0 .cp_375
.cb_376:
    v_mfma_f32_16x16x32_bf16 v[56:59], v[184:187], v[216:219], v[56:59]
    ds_read_b32 v232, v6 offset:0
    ds_read_b32 v234, v6 offset:64
    v_mfma_f32_16x16x32_bf16 v[56:59], v[188:191], v[220:223], v[56:59]
    ds_read_b32 v236, v6 offset:512
    ds_read_b32 v238, v6 offset:576
    v_mfma_f32_16x16x32_bf16 v[200:203], a[80:83], v[84:87], v[200:203]
    s_mov_b32 m0, s43
    s_add_u32 s49, s49, 0x40000
    v_mfma_f32_16x16x32_bf16 v[204:207], a[84:87], v[84:87], v[204:207]
    ds_read_b128 v[84:87], v10 offset:33792
    v_mfma_f32_16x16x32_bf16 v[192:195], a[88:91], v[88:91], v[192:195]
    buffer_load_dwordx4 v2, s[8:11], s49 offen lds
    v_mfma_f32_16x16x32_bf16 v[196:199], a[92:95], v[88:91], v[196:199]
    ds_read_b128 v[88:91], v11 offset:1024
    v_max3_f32 v248, v248, v56, v57
    v_mfma_f32_16x16x32_bf16 v[200:203], a[88:91], v[92:95], v[200:203]
    v_max_f32 v30, v248, v249
    v_max_f32 v249, v248, v249
    v_mfma_f32_16x16x32_bf16 v[204:207], a[92:95], v[92:95], v[204:207]
    ds_read_b128 v[92:95], v11 offset:33792
    s_add_u32 s50, s49, 16777216
    v_mfma_f32_16x16x32_bf16 v[192:195], a[96:99], v[96:99], v[192:195]
    v_permlane16_swap_b32 v249, v30
    v_max_f32 v248, v249, v30
    v_mfma_f32_16x16x32_bf16 v[196:199], a[100:103], v[96:99], v[196:199]
    v_max_f32 v249, v249, v30
    ds_read_b128 v[96:99], v8 offset:1280
    v_mfma_f32_16x16x32_bf16 v[200:203], a[96:99], v[100:103], v[200:203]
    buffer_load_dwordx4 v2, s[8:11], s49 offen offset:1024 lds
    v_mfma_f32_16x16x32_bf16 v[204:207], a[100:103], v[100:103], v[204:207]
    v_permlane32_swap_b32 v248, v249
    v_max_f32 v248, v248, v249
    v_mfma_f32_16x16x32_bf16 v[192:195], a[104:107], v[104:107], v[192:195]
    v_mul_f32 v248, s45, v248
    ds_read_b128 v[100:103], v8 offset:34048
    v_mfma_f32_16x16x32_bf16 v[196:199], a[108:111], v[104:107], v[196:199]
    ds_read_b128 v[104:107], v9 offset:1280
    v_fma_f32 v60, v48, s45, -v248
    v_mfma_f32_16x16x32_bf16 v[200:203], a[104:107], v[108:111], v[200:203]
    v_fma_f32 v61, v49, s45, -v248
    v_fma_f32 v62, v50, s45, -v248
    v_mfma_f32_16x16x32_bf16 v[204:207], a[108:111], v[108:111], v[204:207]
    ds_read_b128 v[108:111], v9 offset:34048
    v_fma_f32 v63, v51, s45, -v248
    v_mfma_f32_16x16x32_bf16 v[192:195], a[112:115], v[112:115], v[192:195]
    v_fma_f32 v242, v52, s45, -v248
    v_fma_f32 v243, v53, s45, -v248
    v_mfma_f32_16x16x32_bf16 v[196:199], a[116:119], v[112:115], v[196:199]
    v_fma_f32 v244, v54, s45, -v248
    v_fma_f32 v245, v55, s45, -v248
    v_mfma_f32_16x16x32_bf16 v[200:203], a[112:115], v[116:119], v[200:203]
    v_fma_f32 v246, v56, s45, -v248
    v_fma_f32 v247, v57, s45, -v248
    v_mfma_f32_16x16x32_bf16 v[204:207], a[116:119], v[116:119], v[204:207]
    ds_read_b128 v[112:115], v10 offset:1280
    ds_read_b128 v[116:119], v10 offset:34048
    v_mfma_f32_16x16x32_bf16 v[192:195], a[120:123], v[120:123], v[192:195]
    s_add_u32 m0, s43, 8192
    s_add_u32 s5, s49, 0x40000
    v_mfma_f32_16x16x32_bf16 v[196:199], a[124:127], v[120:123], v[196:199]
    ds_read_b128 v[120:123], v11 offset:1280
    v_mfma_f32_16x16x32_bf16 v[200:203], a[120:123], v[124:127], v[200:203]
    buffer_load_dwordx4 v2, s[8:11], s50 offen lds
    v_mfma_f32_16x16x32_bf16 v[204:207], a[124:127], v[124:127], v[204:207]
    ds_read_b128 v[124:127], v11 offset:34048
    s_waitcnt lgkmcnt(15)
    v_mfma_f32_16x16x32_bf16 v[192:195], a[128:131], v[64:67], v[192:195]
    s_min_u32 s5, s5, s55
    v_mfma_f32_16x16x32_bf16 v[196:199], a[132:135], v[64:67], v[196:199]
    v_exp_f32 v60, v60
    v_mfma_f32_16x16x32_bf16 v[200:203], a[128:131], v[68:71], v[200:203]
    v_exp_f32 v61, v61
    v_mfma_f32_16x16x32_bf16 v[204:207], a[132:135], v[68:71], v[204:207]
    v_exp_f32 v62, v62
    v_mfma_f32_16x16x32_bf16 v[192:195], a[136:139], v[72:75], v[192:195]
    v_exp_f32 v63, v63
    v_mfma_f32_16x16x32_bf16 v[196:199], a[140:143], v[72:75], v[196:199]
    v_exp_f32 v242, v242
    v_mfma_f32_16x16x32_bf16 v[200:203], a[136:139], v[76:79], v[200:203]
    v_exp_f32 v243, v243
    v_mfma_f32_16x16x32_bf16 v[204:207], a[140:143], v[76:79], v[204:207]
    ds_read_b128 v[64:67], v8 offset:1536
    s_waitcnt lgkmcnt(9)
    v_mfma_f32_16x16x32_bf16 v[192:195], a[144:147], v[80:83], v[192:195]
    v_exp_f32 v244, v244
    v_mfma_f32_16x16x32_bf16 v[196:199], a[148:151], v[80:83], v[196:199]
    v_exp_f32 v245, v245
    v_mfma_f32_16x16x32_bf16 v[200:203], a[144:147], v[84:87], v[200:203]
    v_exp_f32 v246, v246
    v_mfma_f32_16x16x32_bf16 v[204:207], a[148:151], v[84:87], v[204:207]
    v_exp_f32 v247, v247
    v_mfma_f32_16x16x32_bf16 v[192:195], a[152:155], v[88:91], v[192:195]
    ds_read_b128 v[68:71], v8 offset:34304
    ds_read_b128 v[72:75], v9 offset:1536
    v_mfma_f32_16x16x32_bf16 v[196:199], a[156:159], v[88:91], v[196:199]
    ds_read_b128 v[76:79], v9 offset:34304
    v_cvt_pk_bf16_f32 v48, v60, v61
    v_mfma_f32_16x16x32_bf16 v[200:203], a[152:155], v[92:95], v[200:203]
    buffer_load_dwordx4 v2, s[8:11], s50 offen offset:1024 lds
    v_mfma_f32_16x16x32_bf16 v[204:207], a[156:159], v[92:95], v[204:207]
    v_cvt_pk_bf16_f32 v49, v62, v63
    s_waitcnt lgkmcnt(8)
    v_mfma_f32_16x16x32_bf16 v[192:195], a[160:163], v[96:99], v[192:195]
    v_cvt_pk_bf16_f32 v50, v242, v243
    v_cvt_pk_bf16_f32 v51, v244, v245
    v_mfma_f32_16x16x32_bf16 v[196:199], a[164:167], v[96:99], v[196:199]
    v_cvt_pk_bf16_f32 v40, v246, v247
    buffer_load_dword v29, v255, s[8:11], s5 offen
    v_mfma_f32_16x16x32_bf16 v[200:203], a[160:163], v[100:103], v[200:203]
    ds_read_b128 v[80:83], v10 offset:1536
    ds_read_b128 v[84:87], v10 offset:34304
    v_mfma_f32_16x16x32_bf16 v[52:55], v[44:47], v[48:51], 0
    ds_read_b128 v[88:91], v11 offset:1536
    ds_read_b128 v[92:95], v11 offset:34304
    v_mfma_f32_16x16x32_bf16 v[52:55], v[44:47], v[40:43], v[52:55]
    ds_read_b128 v[96:99], v8 offset:1792
    v_mfma_f32_16x16x32_bf16 v[208:211], v[160:163], v[48:51], 0
    v_mfma_f32_16x16x32_bf16 v[208:211], v[232:235], v[40:43], v[208:211]
    v_mfma_f32_16x16x32_bf16 v[212:215], v[164:167], v[48:51], 0
    v_mfma_f32_16x16x32_bf16 v[212:215], v[234:237], v[40:43], v[212:215]
    v_mfma_f32_16x16x32_bf16 v[216:219], v[168:171], v[48:51], 0
    v_mfma_f32_16x16x32_bf16 v[216:219], v[236:239], v[40:43], v[216:219]
    v_mfma_f32_16x16x32_bf16 v[220:223], v[172:175], v[48:51], 0
    v_mfma_f32_16x16x32_bf16 v[220:223], v[238:241], v[40:43], v[220:223]
    v_rcp_f32 v248, v52
    v_mfma_f32_16x16x32_bf16 v[204:207], a[164:167], v[100:103], v[204:207]
    ds_read_b128 v[100:103], v8 offset:34560
    v_mul_f32 v208, v248, v208
    v_mfma_f32_16x16x32_bf16 v[192:195], a[168:171], v[104:107], v[192:195]
    v_mul_f32 v209, v248, v209
    v_mul_f32 v210, v248, v210
    v_mfma_f32_16x16x32_bf16 v[196:199], a[172:175], v[104:107], v[196:199]
    ds_read_b128 v[104:107], v9 offset:1792
    v_mul_f32 v211, v248, v211
    v_mfma_f32_16x16x32_bf16 v[200:203], a[168:171], v[108:111], v[200:203]
    v_cvt_pk_bf16_f32 v224, v208, v209
    v_cvt_pk_bf16_f32 v225, v210, v211
    v_mfma_f32_16x16x32_bf16 v[204:207], a[172:175], v[108:111], v[204:207]
    ds_read_b128 v[108:111], v9 offset:34560
    s_waitcnt lgkmcnt(12)
    v_mfma_f32_16x16x32_bf16 v[192:195], a[176:179], v[112:115], v[192:195]
    v_mul_f32 v212, v248, v212
    v_mul_f32 v213, v248, v213
    v_mfma_f32_16x16x32_bf16 v[196:199], a[180:183], v[112:115], v[196:199]
    ds_read_b128 v[112:115], v10 offset:1792
    v_mul_f32 v214, v248, v214
    v_mfma_f32_16x16x32_bf16 v[200:203], a[176:179], v[116:119], v[200:203]
    v_mul_f32 v215, v248, v215
    v_cvt_pk_bf16_f32 v226, v212, v213
    v_mfma_f32_16x16x32_bf16 v[204:207], a[180:183], v[116:119], v[204:207]
    ds_read_b128 v[116:119], v10 offset:34560
    v_cvt_pk_bf16_f32 v227, v214, v215
    v_mfma_f32_16x16x32_bf16 v[192:195], a[184:187], v[120:123], v[192:195]
    v_mfma_f32_16x16x32_bf16 v[196:199], a[188:191], v[120:123], v[196:199]
    ds_read_b128 v[120:123], v11 offset:1792
    v_mfma_f32_16x16x32_bf16 v[200:203], a[184:187], v[124:127], v[200:203]
    v_mfma_f32_16x16x32_bf16 v[204:207], a[188:191], v[124:127], v[204:207]
    ds_read_b128 v[124:127], v11 offset:34560
    s_waitcnt lgkmcnt(12)
    v_mfma_f32_16x16x32_bf16 v[192:195], a[192:195], v[64:67], v[192:195]
    v_mfma_f32_16x16x32_bf16 v[196:199], a[196:199], v[64:67], v[196:199]
    v_mfma_f32_16x16x32_bf16 v[200:203], a[192:195], v[68:71], v[200:203]
    s_cmp_eq_u32 s31, 0
    s_cbranch_scc1 .cp_381
.cb_382:
    v_mfma_f32_16x16x32_bf16 v[204:207], a[196:199], v[68:71], v[204:207]
    s_cbranch_vccnz .cp_369
    buffer_store_dwordx4 v[224:227], v2, s[8:11], s53 offen offset:0
.cb_370:
    v_mfma_f32_16x16x32_bf16 v[192:195], a[200:203], v[72:75], v[192:195]
    s_waitcnt vmcnt(8) lgkmcnt(0)
    s_barrier
    v_mfma_f32_16x16x32_bf16 v[196:199], a[204:207], v[72:75], v[196:199]
    s_add_u32 m0, s6, 0
    ds_read_b128 v[64:67], v12 offset:0
    v_mfma_f32_16x16x32_bf16 v[200:203], a[200:203], v[76:79], v[200:203]
    buffer_load_dwordx4 v16, s[12:15], s29 offen offset:0 lds
    v_mfma_f32_16x16x32_bf16 v[204:207], a[204:207], v[76:79], v[204:207]
    ds_read_b128 v[68:71], v12 offset:32768
    ds_read_b128 v[72:75], v13 offset:0
    v_mfma_f32_16x16x32_bf16 v[192:195], a[208:211], v[80:83], v[192:195]
    ds_read_b128 v[76:79], v13 offset:32768
    v_mul_f32 v216, v248, v216
    v_mfma_f32_16x16x32_bf16 v[196:199], a[212:215], v[80:83], v[196:199]
    v_mul_f32 v217, v248, v217
    v_mul_f32 v218, v248, v218
    v_mfma_f32_16x16x32_bf16 v[200:203], a[208:211], v[84:87], v[200:203]
    buffer_load_dwordx4 v16, s[12:15], s29 offen offset:1024 lds
    v_mfma_f32_16x16x32_bf16 v[204:207], a[212:215], v[84:87], v[204:207]
    v_mul_f32 v219, v248, v219
    v_cvt_pk_bf16_f32 v228, v216, v217
    v_mfma_f32_16x16x32_bf16 v[192:195], a[216:219], v[88:91], v[192:195]
    v_cvt_pk_bf16_f32 v229, v218, v219
    v_mul_f32 v220, v248, v220
    v_mfma_f32_16x16x32_bf16 v[196:199], a[220:223], v[88:91], v[196:199]
    v_mul_f32 v221, v248, v221
    v_mul_f32 v222, v248, v222
    v_mfma_f32_16x16x32_bf16 v[200:203], a[216:219], v[92:95], v[200:203]
    buffer_load_dwordx4 v17, s[12:15], s29 offen offset:2048 lds
    v_mfma_f32_16x16x32_bf16 v[204:207], a[220:223], v[92:95], v[204:207]
    v_mul_f32 v223, v248, v223
    v_cvt_pk_bf16_f32 v230, v220, v221
    v_mfma_f32_16x16x32_bf16 v[192:195], a[224:227], v[96:99], v[192:195]
    v_cvt_pk_bf16_f32 v231, v222, v223
    ds_read_b128 v[80:83], v14 offset:0
    v_mfma_f32_16x16x32_bf16 v[196:199], a[228:231], v[96:99], v[196:199]
    s_cbranch_vccnz .cp_371
    buffer_store_dwordx4 v[228:231], v2, s[8:11], s53 offen offset:1024
.cb_372:
    v_mfma_f32_16x16x32_bf16 v[200:203], a[224:227], v[100:103], v[200:203]
    buffer_load_dwordx4 v17, s[12:15], s29 offen offset:3072 lds
    v_mfma_f32_16x16x32_bf16 v[204:207], a[228:231], v[100:103], v[204:207]
    ds_read_b128 v[84:87], v14 offset:32768
    ds_read_b128 v[88:91], v15 offset:0
    v_mfma_f32_16x16x32_bf16 v[192:195], a[232:235], v[104:107], v[192:195]
    ds_read_b128 v[92:95], v15 offset:32768
    ds_read_b128 v[96:99], v12 offset:256
    v_mfma_f32_16x16x32_bf16 v[196:199], a[236:239], v[104:107], v[196:199]
    ds_read_b128 v[100:103], v12 offset:33024
    ds_read_b128 v[104:107], v13 offset:256
    v_mfma_f32_16x16x32_bf16 v[200:203], a[232:235], v[108:111], v[200:203]
    s_add_u32 m0, s6, 4096
    s_mov_b32 s53, s40
    v_mfma_f32_16x16x32_bf16 v[204:207], a[236:239], v[108:111], v[204:207]
    buffer_load_dwordx4 v18, s[12:15], s29 offen offset:0 lds
    v_mfma_f32_16x16x32_bf16 v[192:195], a[240:243], v[112:115], v[192:195]
    ds_read_b128 v[108:111], v13 offset:33024
    s_add_u32 s40, s40, 0x40000
    v_mfma_f32_16x16x32_bf16 v[196:199], a[244:247], v[112:115], v[196:199]
    s_mov_b32 s30, s42
    s_add_u32 s42, s42, 1
    v_mfma_f32_16x16x32_bf16 v[200:203], a[240:243], v[116:119], v[200:203]
    v_mfma_f32_16x16x32_bf16 v[204:207], a[244:247], v[116:119], v[204:207]
    buffer_load_dwordx4 v18, s[12:15], s29 offen offset:1024 lds
    v_mfma_f32_16x16x32_bf16 v[192:195], a[248:251], v[120:123], v[192:195]
    v_mfma_f32_16x16x32_bf16 v[196:199], a[252:255], v[120:123], v[196:199]
    v_mfma_f32_16x16x32_bf16 v[200:203], a[248:251], v[124:127], v[200:203]
    v_mfma_f32_16x16x32_bf16 v[204:207], a[252:255], v[124:127], v[204:207]
    s_cmp_eq_u32 s42, 63
    s_cbranch_scc1 .ql_368
    s_waitcnt lgkmcnt(8)
    v_mfma_f32_16x16x32_bf16 v[208:211], a[0:3], v[64:67], 0
    buffer_load_dwordx4 v19, s[12:15], s29 offen offset:2048 lds
    v_mfma_f32_16x16x32_bf16 v[212:215], a[4:7], v[64:67], 0
    ds_read_b128 v[112:115], v14 offset:256
    ds_read_b128 v[116:119], v14 offset:33024
    v_mfma_f32_16x16x32_bf16 v[216:219], a[0:3], v[68:71], 0
    ds_read_b128 v[120:123], v15 offset:256
    ds_read_b128 v[124:127], v15 offset:33024
    v_mfma_f32_16x16x32_bf16 v[220:223], a[4:7], v[68:71], 0
    ds_read_b128 v[64:67], v12 offset:512
    ds_read_b128 v[68:71], v12 offset:33280
    v_mfma_f32_16x16x32_bf16 v[208:211], a[8:11], v[72:75], v[208:211]
    buffer_load_dwordx4 v19, s[12:15], s29 offen offset:3072 lds
    v_mfma_f32_16x16x32_bf16 v[212:215], a[12:15], v[72:75], v[212:215]
    v_cvt_pk_bf16_f32 v224, v192, v193
    v_cvt_pk_bf16_f32 v225, v194, v195
    v_mfma_f32_16x16x32_bf16 v[216:219], a[8:11], v[76:79], v[216:219]
    v_cvt_pk_bf16_f32 v226, v196, v197
    v_cvt_pk_bf16_f32 v227, v198, v199
    v_mfma_f32_16x16x32_bf16 v[220:223], a[12:15], v[76:79], v[220:223]
    ds_write_b128 v24, v[224:227] offset:0
    s_waitcnt lgkmcnt(11)
    v_mfma_f32_16x16x32_bf16 v[208:211], a[16:19], v[80:83], v[208:211]
    s_add_u32 m0, s6, 8192
    v_cvt_pk_bf16_f32 v228, v200, v201
    v_mfma_f32_16x16x32_bf16 v[212:215], a[20:23], v[80:83], v[212:215]
    buffer_load_dwordx4 v20, s[12:15], s29 offen offset:0 lds
    v_mfma_f32_16x16x32_bf16 v[216:219], a[16:19], v[84:87], v[216:219]
    v_cvt_pk_bf16_f32 v229, v202, v203
    v_cvt_pk_bf16_f32 v230, v204, v205
    v_mfma_f32_16x16x32_bf16 v[220:223], a[20:23], v[84:87], v[220:223]
    v_cvt_pk_bf16_f32 v231, v206, v207
    ds_write_b128 v24, v[228:231] offset:4096
    v_mfma_f32_16x16x32_bf16 v[208:211], a[24:27], v[88:91], v[208:211]
    ds_read_b128 v[72:75], v13 offset:512
    ds_read_b128 v[76:79], v13 offset:33280
    v_mfma_f32_16x16x32_bf16 v[212:215], a[28:31], v[88:91], v[212:215]
    buffer_load_dwordx4 v20, s[12:15], s29 offen offset:1024 lds
    v_mfma_f32_16x16x32_bf16 v[216:219], a[24:27], v[92:95], v[216:219]
    ds_read_b128 v[80:83], v14 offset:512
    ds_read_b128 v[84:87], v14 offset:33280
    v_mfma_f32_16x16x32_bf16 v[220:223], a[28:31], v[92:95], v[220:223]
    ds_read_b128 v[88:91], v15 offset:512
    s_waitcnt lgkmcnt(13)
    v_mfma_f32_16x16x32_bf16 v[208:211], a[32:35], v[96:99], v[208:211]
    s_waitcnt vmcnt(13) lgkmcnt(5)
    s_barrier
    v_mfma_f32_16x16x32_bf16 v[212:215], a[36:39], v[96:99], v[212:215]
    buffer_load_dwordx4 v21, s[12:15], s29 offen offset:2048 lds
    v_mfma_f32_16x16x32_bf16 v[216:219], a[32:35], v[100:103], v[216:219]
    ds_read_b128 v[192:195], v25 offset:0
    ds_read_b128 v[128:131], v31 offset:0
    v_mfma_f32_16x16x32_bf16 v[220:223], a[36:39], v[100:103], v[220:223]
    ds_read_b128 v[144:147], v31 offset:4096
    ds_read_b128 v[196:199], v25 offset:1024
    v_mfma_f32_16x16x32_bf16 v[208:211], a[40:43], v[104:107], v[208:211]
    ds_read_b128 v[132:135], v31 offset:1024
    ds_read_b128 v[148:151], v31 offset:5120
    v_mfma_f32_16x16x32_bf16 v[212:215], a[44:47], v[104:107], v[212:215]
    buffer_load_dwordx4 v21, s[12:15], s29 offen offset:3072 lds
    v_mfma_f32_16x16x32_bf16 v[216:219], a[40:43], v[108:111], v[216:219]
    ds_read_b128 v[92:95], v15 offset:33280
    ds_read_b128 v[200:203], v25 offset:2048
    v_mfma_f32_16x16x32_bf16 v[220:223], a[44:47], v[108:111], v[220:223]
    ds_read_b128 v[136:139], v31 offset:2048
    ds_read_b128 v[152:155], v31 offset:6144
    v_mfma_f32_16x16x32_bf16 v[208:211], a[48:51], v[112:115], v[208:211]
    ds_read_b128 v[204:207], v25 offset:3072
    ds_read_b128 v[140:143], v31 offset:3072
    v_mfma_f32_16x16x32_bf16 v[212:215], a[52:55], v[112:115], v[212:215]
    s_add_u32 m0, s6, 12288
    s_waitcnt lgkmcnt(9)
    v_mfma_f32_16x16x32_bf16 v[48:51], v[128:131], v[192:195], v[32:35]
    buffer_load_dwordx4 v22, s[12:15], s29 offen offset:0 lds
    v_mfma_f32_16x16x32_bf16 v[52:55], v[144:147], v[192:195], v[36:39]
    ds_read_b128 v[156:159], v31 offset:7168
    s_waitcnt lgkmcnt(7)
    v_mfma_f32_16x16x32_bf16 v[48:51], v[132:135], v[196:199], v[48:51]
    ds_read_b128 v[160:163], v5 offset:8192
    ds_read_b128 v[164:167], v5 offset:9216
    v_mfma_f32_16x16x32_bf16 v[52:55], v[148:151], v[196:199], v[52:55]
    ds_read_b128 v[96:99], v12 offset:768
    s_waitcnt lgkmcnt(6)
    v_mfma_f32_16x16x32_bf16 v[48:51], v[136:139], v[200:203], v[48:51]
    buffer_load_dwordx4 v22, s[12:15], s29 offen offset:1024 lds
    v_mfma_f32_16x16x32_bf16 v[52:55], v[152:155], v[200:203], v[52:55]
    ds_read_b128 v[100:103], v12 offset:33536
    ds_read_b128 v[104:107], v13 offset:768
    v_mfma_f32_16x16x32_bf16 v[216:219], a[48:51], v[116:119], v[216:219]
    ds_read_b128 v[108:111], v13 offset:33536
    ds_read_b128 v[168:171], v5 offset:10240
    v_mfma_f32_16x16x32_bf16 v[220:223], a[52:55], v[116:119], v[220:223]
    ds_read_b128 v[172:175], v5 offset:11264
    s_waitcnt lgkmcnt(8)
    v_mfma_f32_16x16x32_bf16 v[48:51], v[140:143], v[204:207], v[48:51]
    buffer_load_dwordx4 v23, s[12:15], s29 offen offset:2048 lds
    v_mfma_f32_16x16x32_bf16 v[52:55], v[156:159], v[204:207], v[52:55]
    v_max_i32 v27, s30, v26
    ds_read_b128 v[112:115], v14 offset:768
    v_mfma_f32_16x16x32_bf16 v[208:211], a[56:59], v[120:123], v[208:211]
    s_waitcnt vmcnt(12)
    s_cbranch_vccnz .cp_387
    buffer_store_dword v27, v26, s[8:11], s94 offen
.cb_388:
    v_mfma_f32_16x16x32_bf16 v[212:215], a[60:63], v[120:123], v[212:215]
    ds_read_b128 v[116:119], v14 offset:33536
    ds_read_b128 v[120:123], v15 offset:768
    v_mfma_f32_16x16x32_bf16 v[216:219], a[56:59], v[124:127], v[216:219]
    buffer_load_dwordx4 v23, s[12:15], s29 offen offset:3072 lds
    v_mfma_f32_16x16x32_bf16 v[220:223], a[60:63], v[124:127], v[220:223]
    s_cmp_eq_u32 s31, 0
    s_cbranch_scc1 .cp_391
.cb_392:
    v_mfma_f32_16x16x32_bf16 v[208:211], a[64:67], v[64:67], v[208:211]
    s_waitcnt lgkmcnt(3)
    s_barrier
    v_mfma_f32_16x16x32_bf16 v[212:215], a[68:71], v[64:67], v[212:215]
    ds_read_b128 v[124:127], v15 offset:33536
    ds_read_b128 v[176:179], v3 offset:4096
    v_mfma_f32_16x16x32_bf16 v[216:219], a[64:67], v[68:71], v[216:219]
    ds_read_b128 v[180:183], v3 offset:4608
    ds_read_b128 v[184:187], v3 offset:5120
    v_mfma_f32_16x16x32_bf16 v[220:223], a[68:71], v[68:71], v[220:223]
    ds_read_b128 v[188:191], v3 offset:5632
    ds_read_b128 v[64:67], v12 offset:1024
    v_mfma_f32_16x16x32_bf16 v[208:211], a[72:75], v[72:75], v[208:211]
    ds_read_b128 v[68:71], v12 offset:33792
    v_max3_f32 v248, v48, v49, v50
    v_mfma_f32_16x16x32_bf16 v[212:215], a[76:79], v[72:75], v[212:215]
    ds_read_b128 v[72:75], v13 offset:1024
    v_max3_f32 v248, v248, v51, v52
    v_mfma_f32_16x16x32_bf16 v[216:219], a[72:75], v[76:79], v[216:219]
    v_max3_f32 v249, v53, v54, v55
    s_add_u32 m0, s52, 0
    v_mfma_f32_16x16x32_bf16 v[220:223], a[76:79], v[76:79], v[220:223]
    ds_read_b128 v[76:79], v13 offset:33792
    s_add_u32 s48, s48, 0x20000
    v_mfma_f32_16x16x32_bf16 v[208:211], a[80:83], v[80:83], v[208:211]
    s_mov_b32 s31, 1
    buffer_load_dword v29, v28, s[12:15], s29 offen
    v_mfma_f32_16x16x32_bf16 v[212:215], a[84:87], v[80:83], v[212:215]
    s_cmp_gt_u32 s33, s42
    s_cbranch_scc0 .pp_393
    buffer_load_dwordx4 v2, s[8:11], s48 offen lds
.pb_394:
    s_waitcnt lgkmcnt(4)
    v_mfma_f32_16x16x32_bf16 v[56:59], v[176:179], v[192:195], 0
    ds_read_b128 v[80:83], v14 offset:1024
    s_add_u32 s29, s29, 0x10000
    v_mfma_f32_16x16x32_bf16 v[56:59], v[180:183], v[196:199], v[56:59]
    s_cmp_gt_u32 s32, s42
    s_cbranch_scc0 .cp_389
.cb_390:
    v_mfma_f32_16x16x32_bf16 v[56:59], v[184:187], v[200:203], v[56:59]
    ds_read_b32 v232, v6 offset:4096
    ds_read_b32 v234, v6 offset:4160
    v_mfma_f32_16x16x32_bf16 v[56:59], v[188:191], v[204:207], v[56:59]
    ds_read_b32 v236, v6 offset:4608
    ds_read_b32 v238, v6 offset:4672
    v_mfma_f32_16x16x32_bf16 v[216:219], a[80:83], v[84:87], v[216:219]
    s_mov_b32 m0, s43
    s_add_u32 s49, s49, 0x40000
    v_mfma_f32_16x16x32_bf16 v[220:223], a[84:87], v[84:87], v[220:223]
    ds_read_b128 v[84:87], v14 offset:33792
    v_mfma_f32_16x16x32_bf16 v[208:211], a[88:91], v[88:91], v[208:211]
    buffer_load_dwordx4 v2, s[8:11], s49 offen lds
    v_mfma_f32_16x16x32_bf16 v[212:215], a[92:95], v[88:91], v[212:215]
    ds_read_b128 v[88:91], v15 offset:1024
    v_max3_f32 v248, v248, v56, v57
    v_mfma_f32_16x16x32_bf16 v[216:219], a[88:91], v[92:95], v[216:219]
    v_max_f32 v30, v248, v249
    v_max_f32 v249, v248, v249
    v_mfma_f32_16x16x32_bf16 v[220:223], a[92:95], v[92:95], v[220:223]
    ds_read_b128 v[92:95], v15 offset:33792
    s_add_u32 s50, s49, 16777216
    v_mfma_f32_16x16x32_bf16 v[208:211], a[96:99], v[96:99], v[208:211]
    v_permlane16_swap_b32 v249, v30
    v_max_f32 v248, v249, v30
    v_mfma_f32_16x16x32_bf16 v[212:215], a[100:103], v[96:99], v[212:215]
    v_max_f32 v249, v249, v30
    ds_read_b128 v[96:99], v12 offset:1280
    v_mfma_f32_16x16x32_bf16 v[216:219], a[96:99], v[100:103], v[216:219]
    buffer_load_dwordx4 v2, s[8:11], s49 offen offset:1024 lds
    v_mfma_f32_16x16x32_bf16 v[220:223], a[100:103], v[100:103], v[220:223]
    v_permlane32_swap_b32 v248, v249
    v_max_f32 v248, v248, v249
    v_mfma_f32_16x16x32_bf16 v[208:211], a[104:107], v[104:107], v[208:211]
    v_mul_f32 v248, s45, v248
    ds_read_b128 v[100:103], v12 offset:34048
    v_mfma_f32_16x16x32_bf16 v[212:215], a[108:111], v[104:107], v[212:215]
    ds_read_b128 v[104:107], v13 offset:1280
    v_fma_f32 v60, v48, s45, -v248
    v_mfma_f32_16x16x32_bf16 v[216:219], a[104:107], v[108:111], v[216:219]
    v_fma_f32 v61, v49, s45, -v248
    v_fma_f32 v62, v50, s45, -v248
    v_mfma_f32_16x16x32_bf16 v[220:223], a[108:111], v[108:111], v[220:223]
    ds_read_b128 v[108:111], v13 offset:34048
    v_fma_f32 v63, v51, s45, -v248
    v_mfma_f32_16x16x32_bf16 v[208:211], a[112:115], v[112:115], v[208:211]
    v_fma_f32 v242, v52, s45, -v248
    v_fma_f32 v243, v53, s45, -v248
    v_mfma_f32_16x16x32_bf16 v[212:215], a[116:119], v[112:115], v[212:215]
    v_fma_f32 v244, v54, s45, -v248
    v_fma_f32 v245, v55, s45, -v248
    v_mfma_f32_16x16x32_bf16 v[216:219], a[112:115], v[116:119], v[216:219]
    v_fma_f32 v246, v56, s45, -v248
    v_fma_f32 v247, v57, s45, -v248
    v_mfma_f32_16x16x32_bf16 v[220:223], a[116:119], v[116:119], v[220:223]
    ds_read_b128 v[112:115], v14 offset:1280
    ds_read_b128 v[116:119], v14 offset:34048
    v_mfma_f32_16x16x32_bf16 v[208:211], a[120:123], v[120:123], v[208:211]
    s_add_u32 m0, s43, 8192
    s_add_u32 s5, s49, 0x40000
    v_mfma_f32_16x16x32_bf16 v[212:215], a[124:127], v[120:123], v[212:215]
    ds_read_b128 v[120:123], v15 offset:1280
    v_mfma_f32_16x16x32_bf16 v[216:219], a[120:123], v[124:127], v[216:219]
    buffer_load_dwordx4 v2, s[8:11], s50 offen lds
    v_mfma_f32_16x16x32_bf16 v[220:223], a[124:127], v[124:127], v[220:223]
    ds_read_b128 v[124:127], v15 offset:34048
    s_waitcnt lgkmcnt(15)
    v_mfma_f32_16x16x32_bf16 v[208:211], a[128:131], v[64:67], v[208:211]
    s_min_u32 s5, s5, s55
    v_mfma_f32_16x16x32_bf16 v[212:215], a[132:135], v[64:67], v[212:215]
    v_exp_f32 v60, v60
    v_mfma_f32_16x16x32_bf16 v[216:219], a[128:131], v[68:71], v[216:219]
    v_exp_f32 v61, v61
    v_mfma_f32_16x16x32_bf16 v[220:223], a[132:135], v[68:71], v[220:223]
    v_exp_f32 v62, v62
    v_mfma_f32_16x16x32_bf16 v[208:211], a[136:139], v[72:75], v[208:211]
    v_exp_f32 v63, v63
    v_mfma_f32_16x16x32_bf16 v[212:215], a[140:143], v[72:75], v[212:215]
    v_exp_f32 v242, v242
    v_mfma_f32_16x16x32_bf16 v[216:219], a[136:139], v[76:79], v[216:219]
    v_exp_f32 v243, v243
    v_mfma_f32_16x16x32_bf16 v[220:223], a[140:143], v[76:79], v[220:223]
    ds_read_b128 v[64:67], v12 offset:1536
    s_waitcnt lgkmcnt(9)
    v_mfma_f32_16x16x32_bf16 v[208:211], a[144:147], v[80:83], v[208:211]
    v_exp_f32 v244, v244
    v_mfma_f32_16x16x32_bf16 v[212:215], a[148:151], v[80:83], v[212:215]
    v_exp_f32 v245, v245
    v_mfma_f32_16x16x32_bf16 v[216:219], a[144:147], v[84:87], v[216:219]
    v_exp_f32 v246, v246
    v_mfma_f32_16x16x32_bf16 v[220:223], a[148:151], v[84:87], v[220:223]
    v_exp_f32 v247, v247
    v_mfma_f32_16x16x32_bf16 v[208:211], a[152:155], v[88:91], v[208:211]
    ds_read_b128 v[68:71], v12 offset:34304
    ds_read_b128 v[72:75], v13 offset:1536
    v_mfma_f32_16x16x32_bf16 v[212:215], a[156:159], v[88:91], v[212:215]
    ds_read_b128 v[76:79], v13 offset:34304
    v_cvt_pk_bf16_f32 v48, v60, v61
    v_mfma_f32_16x16x32_bf16 v[216:219], a[152:155], v[92:95], v[216:219]
    buffer_load_dwordx4 v2, s[8:11], s50 offen offset:1024 lds
    v_mfma_f32_16x16x32_bf16 v[220:223], a[156:159], v[92:95], v[220:223]
    v_cvt_pk_bf16_f32 v49, v62, v63
    s_waitcnt lgkmcnt(8)
    v_mfma_f32_16x16x32_bf16 v[208:211], a[160:163], v[96:99], v[208:211]
    v_cvt_pk_bf16_f32 v50, v242, v243
    v_cvt_pk_bf16_f32 v51, v244, v245
    v_mfma_f32_16x16x32_bf16 v[212:215], a[164:167], v[96:99], v[212:215]
    v_cvt_pk_bf16_f32 v40, v246, v247
    buffer_load_dword v29, v255, s[8:11], s5 offen
    v_mfma_f32_16x16x32_bf16 v[216:219], a[160:163], v[100:103], v[216:219]
    ds_read_b128 v[80:83], v14 offset:1536
    ds_read_b128 v[84:87], v14 offset:34304
    v_mfma_f32_16x16x32_bf16 v[52:55], v[44:47], v[48:51], 0
    ds_read_b128 v[88:91], v15 offset:1536
    ds_read_b128 v[92:95], v15 offset:34304
    v_mfma_f32_16x16x32_bf16 v[52:55], v[44:47], v[40:43], v[52:55]
    ds_read_b128 v[96:99], v12 offset:1792
    v_mfma_f32_16x16x32_bf16 v[192:195], v[160:163], v[48:51], 0
    v_mfma_f32_16x16x32_bf16 v[192:195], v[232:235], v[40:43], v[192:195]
    v_mfma_f32_16x16x32_bf16 v[196:199], v[164:167], v[48:51], 0
    v_mfma_f32_16x16x32_bf16 v[196:199], v[234:237], v[40:43], v[196:199]
    v_mfma_f32_16x16x32_bf16 v[200:203], v[168:171], v[48:51], 0
    v_mfma_f32_16x16x32_bf16 v[200:203], v[236:239], v[40:43], v[200:203]
    v_mfma_f32_16x16x32_bf16 v[204:207], v[172:175], v[48:51], 0
    v_mfma_f32_16x16x32_bf16 v[204:207], v[238:241], v[40:43], v[204:207]
    v_rcp_f32 v248, v52
    v_mfma_f32_16x16x32_bf16 v[220:223], a[164:167], v[100:103], v[220:223]
    ds_read_b128 v[100:103], v12 offset:34560
    v_mul_f32 v192, v248, v192
    v_mfma_f32_16x16x32_bf16 v[208:211], a[168:171], v[104:107], v[208:211]
    v_mul_f32 v193, v248, v193
    v_mul_f32 v194, v248, v194
    v_mfma_f32_16x16x32_bf16 v[212:215], a[172:175], v[104:107], v[212:215]
    ds_read_b128 v[104:107], v13 offset:1792
    v_mul_f32 v195, v248, v195
    v_mfma_f32_16x16x32_bf16 v[216:219], a[168:171], v[108:111], v[216:219]
    v_cvt_pk_bf16_f32 v224, v192, v193
    v_cvt_pk_bf16_f32 v225, v194, v195
    v_mfma_f32_16x16x32_bf16 v[220:223], a[172:175], v[108:111], v[220:223]
    ds_read_b128 v[108:111], v13 offset:34560
    s_waitcnt lgkmcnt(12)
    v_mfma_f32_16x16x32_bf16 v[208:211], a[176:179], v[112:115], v[208:211]
    v_mul_f32 v196, v248, v196
    v_mul_f32 v197, v248, v197
    v_mfma_f32_16x16x32_bf16 v[212:215], a[180:183], v[112:115], v[212:215]
    ds_read_b128 v[112:115], v14 offset:1792
    v_mul_f32 v198, v248, v198
    v_mfma_f32_16x16x32_bf16 v[216:219], a[176:179], v[116:119], v[216:219]
    v_mul_f32 v199, v248, v199
    v_cvt_pk_bf16_f32 v226, v196, v197
    v_mfma_f32_16x16x32_bf16 v[220:223], a[180:183], v[116:119], v[220:223]
    ds_read_b128 v[116:119], v14 offset:34560
    v_cvt_pk_bf16_f32 v227, v198, v199
    v_mfma_f32_16x16x32_bf16 v[208:211], a[184:187], v[120:123], v[208:211]
    v_mfma_f32_16x16x32_bf16 v[212:215], a[188:191], v[120:123], v[212:215]
    ds_read_b128 v[120:123], v15 offset:1792
    v_mfma_f32_16x16x32_bf16 v[216:219], a[184:187], v[124:127], v[216:219]
    v_mfma_f32_16x16x32_bf16 v[220:223], a[188:191], v[124:127], v[220:223]
    ds_read_b128 v[124:127], v15 offset:34560
    s_waitcnt lgkmcnt(12)
    v_mfma_f32_16x16x32_bf16 v[208:211], a[192:195], v[64:67], v[208:211]
    v_mfma_f32_16x16x32_bf16 v[212:215], a[196:199], v[64:67], v[212:215]
    v_mfma_f32_16x16x32_bf16 v[216:219], a[192:195], v[68:71], v[216:219]
    s_cmp_eq_u32 s31, 0
    s_cbranch_scc1 .cp_395
.cb_396:
    v_mfma_f32_16x16x32_bf16 v[220:223], a[196:199], v[68:71], v[220:223]
    s_cbranch_vccnz .cp_383
    buffer_store_dwordx4 v[224:227], v2, s[8:11], s53 offen offset:0
.cb_384:
    v_mfma_f32_16x16x32_bf16 v[208:211], a[200:203], v[72:75], v[208:211]
    s_waitcnt vmcnt(8) lgkmcnt(0)
    s_barrier
    v_mfma_f32_16x16x32_bf16 v[212:215], a[204:207], v[72:75], v[212:215]
    s_add_u32 m0, s6, 65536
    ds_read_b128 v[64:67], v8 offset:0
    v_mfma_f32_16x16x32_bf16 v[216:219], a[200:203], v[76:79], v[216:219]
    buffer_load_dwordx4 v16, s[12:15], s29 offen offset:0 lds
    v_mfma_f32_16x16x32_bf16 v[220:223], a[204:207], v[76:79], v[220:223]
    ds_read_b128 v[68:71], v8 offset:32768
    ds_read_b128 v[72:75], v9 offset:0
    v_mfma_f32_16x16x32_bf16 v[208:211], a[208:211], v[80:83], v[208:211]
    ds_read_b128 v[76:79], v9 offset:32768
    v_mul_f32 v200, v248, v200
    v_mfma_f32_16x16x32_bf16 v[212:215], a[212:215], v[80:83], v[212:215]
    v_mul_f32 v201, v248, v201
    v_mul_f32 v202, v248, v202
    v_mfma_f32_16x16x32_bf16 v[216:219], a[208:211], v[84:87], v[216:219]
    buffer_load_dwordx4 v16, s[12:15], s29 offen offset:1024 lds
    v_mfma_f32_16x16x32_bf16 v[220:223], a[212:215], v[84:87], v[220:223]
    v_mul_f32 v203, v248, v203
    v_cvt_pk_bf16_f32 v228, v200, v201
    v_mfma_f32_16x16x32_bf16 v[208:211], a[216:219], v[88:91], v[208:211]
    v_cvt_pk_bf16_f32 v229, v202, v203
    v_mul_f32 v204, v248, v204
    v_mfma_f32_16x16x32_bf16 v[212:215], a[220:223], v[88:91], v[212:215]
    v_mul_f32 v205, v248, v205
    v_mul_f32 v206, v248, v206
    v_mfma_f32_16x16x32_bf16 v[216:219], a[216:219], v[92:95], v[216:219]
    buffer_load_dwordx4 v17, s[12:15], s29 offen offset:2048 lds
    v_mfma_f32_16x16x32_bf16 v[220:223], a[220:223], v[92:95], v[220:223]
    v_mul_f32 v207, v248, v207
    v_cvt_pk_bf16_f32 v230, v204, v205
    v_mfma_f32_16x16x32_bf16 v[208:211], a[224:227], v[96:99], v[208:211]
    v_cvt_pk_bf16_f32 v231, v206, v207
    ds_read_b128 v[80:83], v10 offset:0
    v_mfma_f32_16x16x32_bf16 v[212:215], a[228:231], v[96:99], v[212:215]
    s_cbranch_vccnz .cp_385
    buffer_store_dwordx4 v[228:231], v2, s[8:11], s53 offen offset:1024
.cb_386:
    v_mfma_f32_16x16x32_bf16 v[216:219], a[224:227], v[100:103], v[216:219]
    buffer_load_dwordx4 v17, s[12:15], s29 offen offset:3072 lds
    v_mfma_f32_16x16x32_bf16 v[220:223], a[228:231], v[100:103], v[220:223]
    ds_read_b128 v[84:87], v10 offset:32768
    ds_read_b128 v[88:91], v11 offset:0
    v_mfma_f32_16x16x32_bf16 v[208:211], a[232:235], v[104:107], v[208:211]
    ds_read_b128 v[92:95], v11 offset:32768
    ds_read_b128 v[96:99], v8 offset:256
    v_mfma_f32_16x16x32_bf16 v[212:215], a[236:239], v[104:107], v[212:215]
    ds_read_b128 v[100:103], v8 offset:33024
    ds_read_b128 v[104:107], v9 offset:256
    v_mfma_f32_16x16x32_bf16 v[216:219], a[232:235], v[108:111], v[216:219]
    s_add_u32 m0, s6, 69632
    s_mov_b32 s53, s40
    v_mfma_f32_16x16x32_bf16 v[220:223], a[236:239], v[108:111], v[220:223]
    buffer_load_dwordx4 v18, s[12:15], s29 offen offset:0 lds
    v_mfma_f32_16x16x32_bf16 v[208:211], a[240:243], v[112:115], v[208:211]
    ds_read_b128 v[108:111], v9 offset:33024
    s_add_u32 s40, s40, 0x40000
    v_mfma_f32_16x16x32_bf16 v[212:215], a[244:247], v[112:115], v[212:215]
    s_mov_b32 s30, s42
    s_add_u32 s42, s42, 1
    v_mfma_f32_16x16x32_bf16 v[216:219], a[240:243], v[116:119], v[216:219]
    v_mfma_f32_16x16x32_bf16 v[220:223], a[244:247], v[116:119], v[220:223]
    buffer_load_dwordx4 v18, s[12:15], s29 offen offset:1024 lds
    v_mfma_f32_16x16x32_bf16 v[208:211], a[248:251], v[120:123], v[208:211]
    v_mfma_f32_16x16x32_bf16 v[212:215], a[252:255], v[120:123], v[212:215]
    v_mfma_f32_16x16x32_bf16 v[216:219], a[248:251], v[124:127], v[216:219]
    v_mfma_f32_16x16x32_bf16 v[220:223], a[252:255], v[124:127], v[220:223]
    s_branch .ql_367
.ql_368:
    s_waitcnt lgkmcnt(8)
    v_mfma_f32_16x16x32_bf16 v[208:211], a[0:3], v[64:67], 0
    ds_read_b128 v[112:115], v14 offset:256
    ds_read_b128 v[116:119], v14 offset:33024
    v_mfma_f32_16x16x32_bf16 v[212:215], a[4:7], v[64:67], 0
    ds_read_b128 v[120:123], v15 offset:256
    ds_read_b128 v[124:127], v15 offset:33024
    v_mfma_f32_16x16x32_bf16 v[216:219], a[0:3], v[68:71], 0
    ds_read_b128 v[64:67], v12 offset:512
    v_mfma_f32_16x16x32_bf16 v[220:223], a[4:7], v[68:71], 0
    ds_read_b128 v[68:71], v12 offset:33280
    v_mfma_f32_16x16x32_bf16 v[208:211], a[8:11], v[72:75], v[208:211]
    v_cvt_pk_bf16_f32 v224, v192, v193
    v_cvt_pk_bf16_f32 v225, v194, v195
    v_mfma_f32_16x16x32_bf16 v[212:215], a[12:15], v[72:75], v[212:215]
    v_cvt_pk_bf16_f32 v226, v196, v197
    v_cvt_pk_bf16_f32 v227, v198, v199
    v_mfma_f32_16x16x32_bf16 v[216:219], a[8:11], v[76:79], v[216:219]
    ds_write_b128 v24, v[224:227] offset:0
    v_cvt_pk_bf16_f32 v228, v200, v201
    v_mfma_f32_16x16x32_bf16 v[220:223], a[12:15], v[76:79], v[220:223]
    v_cvt_pk_bf16_f32 v229, v202, v203
    s_waitcnt lgkmcnt(11)
    v_mfma_f32_16x16x32_bf16 v[208:211], a[16:19], v[80:83], v[208:211]
    v_cvt_pk_bf16_f32 v230, v204, v205
    v_cvt_pk_bf16_f32 v231, v206, v207
    v_mfma_f32_16x16x32_bf16 v[212:215], a[20:23], v[80:83], v[212:215]
    ds_write_b128 v24, v[228:231] offset:4096
    ds_read_b128 v[72:75], v13 offset:512
    v_mfma_f32_16x16x32_bf16 v[216:219], a[16:19], v[84:87], v[216:219]
    ds_read_b128 v[76:79], v13 offset:33280
    ds_read_b128 v[80:83], v14 offset:512
    v_mfma_f32_16x16x32_bf16 v[220:223], a[20:23], v[84:87], v[220:223]
    ds_read_b128 v[84:87], v14 offset:33280
    v_mfma_f32_16x16x32_bf16 v[208:211], a[24:27], v[88:91], v[208:211]
    v_mfma_f32_16x16x32_bf16 v[212:215], a[28:31], v[88:91], v[212:215]
    ds_read_b128 v[88:91], v15 offset:512
    v_mfma_f32_16x16x32_bf16 v[216:219], a[24:27], v[92:95], v[216:219]
    s_waitcnt vmcnt(9) lgkmcnt(5)
    s_barrier
    v_mfma_f32_16x16x32_bf16 v[220:223], a[28:31], v[92:95], v[220:223]
    ds_read_b128 v[192:195], v25 offset:0
    ds_read_b128 v[128:131], v31 offset:0
    v_mfma_f32_16x16x32_bf16 v[208:211], a[32:35], v[96:99], v[208:211]
    ds_read_b128 v[144:147], v31 offset:4096
    ds_read_b128 v[196:199], v25 offset:1024
    v_mfma_f32_16x16x32_bf16 v[212:215], a[36:39], v[96:99], v[212:215]
    ds_read_b128 v[132:135], v31 offset:1024
    ds_read_b128 v[148:151], v31 offset:5120
    v_mfma_f32_16x16x32_bf16 v[216:219], a[32:35], v[100:103], v[216:219]
    ds_read_b128 v[92:95], v15 offset:33280
    ds_read_b128 v[200:203], v25 offset:2048
    v_mfma_f32_16x16x32_bf16 v[220:223], a[36:39], v[100:103], v[220:223]
    ds_read_b128 v[136:139], v31 offset:2048
    ds_read_b128 v[152:155], v31 offset:6144
    v_mfma_f32_16x16x32_bf16 v[208:211], a[40:43], v[104:107], v[208:211]
    ds_read_b128 v[204:207], v25 offset:3072
    ds_read_b128 v[140:143], v31 offset:3072
    v_mfma_f32_16x16x32_bf16 v[212:215], a[44:47], v[104:107], v[212:215]
    ds_read_b128 v[156:159], v31 offset:7168
    ds_read_b128 v[160:163], v5 offset:8192
    v_mfma_f32_16x16x32_bf16 v[216:219], a[40:43], v[108:111], v[216:219]
    ds_read_b128 v[164:167], v5 offset:9216
    s_waitcnt lgkmcnt(12)
    v_mfma_f32_16x16x32_bf16 v[48:51], v[128:131], v[192:195], v[32:35]
    ds_read_b128 v[96:99], v12 offset:768
    ds_read_b128 v[100:103], v12 offset:33536
    v_mfma_f32_16x16x32_bf16 v[52:55], v[144:147], v[192:195], v[36:39]
    ds_read_b128 v[104:107], v13 offset:768
    s_waitcnt lgkmcnt(12)
    v_mfma_f32_16x16x32_bf16 v[48:51], v[132:135], v[196:199], v[48:51]
    ds_read_b128 v[168:171], v5 offset:10240
    ds_read_b128 v[172:175], v5 offset:11264
    v_mfma_f32_16x16x32_bf16 v[52:55], v[148:151], v[196:199], v[52:55]
    v_max_i32 v27, s30, v26
    s_waitcnt lgkmcnt(10)
    v_mfma_f32_16x16x32_bf16 v[48:51], v[136:139], v[200:203], v[48:51]
    s_waitcnt vmcnt(3)
    s_cbranch_vccnz .cp_401
    buffer_store_dword v27, v26, s[8:11], s94 offen
.cb_402:
    v_mfma_f32_16x16x32_bf16 v[52:55], v[152:155], v[200:203], v[52:55]
    s_waitcnt lgkmcnt(7)
    v_mfma_f32_16x16x32_bf16 v[48:51], v[140:143], v[204:207], v[48:51]
    s_waitcnt lgkmcnt(0)
    s_barrier
    v_mfma_f32_16x16x32_bf16 v[52:55], v[156:159], v[204:207], v[52:55]
    s_cmp_gt_u32 s32, s42
    s_cbranch_scc0 .cp_403
.cb_404:
    v_mfma_f32_16x16x32_bf16 v[220:223], a[44:47], v[108:111], v[220:223]
    ds_read_b128 v[108:111], v13 offset:33536
    s_mov_b32 m0, s43
    v_mfma_f32_16x16x32_bf16 v[208:211], a[48:51], v[112:115], v[208:211]
    s_add_u32 s49, s49, 0x40000
    v_mfma_f32_16x16x32_bf16 v[212:215], a[52:55], v[112:115], v[212:215]
    ds_read_b128 v[112:115], v14 offset:768
    v_mfma_f32_16x16x32_bf16 v[216:219], a[48:51], v[116:119], v[216:219]
    buffer_load_dwordx4 v2, s[8:11], s49 offen lds
    v_mfma_f32_16x16x32_bf16 v[220:223], a[52:55], v[116:119], v[220:223]
    ds_read_b128 v[116:119], v14 offset:33536
    s_add_u32 s50, s49, 16777216
    v_mfma_f32_16x16x32_bf16 v[208:211], a[56:59], v[120:123], v[208:211]
    v_mfma_f32_16x16x32_bf16 v[212:215], a[60:63], v[120:123], v[212:215]
    ds_read_b128 v[120:123], v15 offset:768
    v_mfma_f32_16x16x32_bf16 v[216:219], a[56:59], v[124:127], v[216:219]
    buffer_load_dwordx4 v2, s[8:11], s49 offen offset:1024 lds
    v_mfma_f32_16x16x32_bf16 v[220:223], a[60:63], v[124:127], v[220:223]
    ds_read_b128 v[124:127], v15 offset:33536
    s_add_u32 m0, s43, 8192
    v_mfma_f32_16x16x32_bf16 v[208:211], a[64:67], v[64:67], v[208:211]
    s_add_u32 s5, s49, 0x40000
    v_mfma_f32_16x16x32_bf16 v[212:215], a[68:71], v[64:67], v[212:215]
    ds_read_b128 v[64:67], v12 offset:1024
    v_mfma_f32_16x16x32_bf16 v[216:219], a[64:67], v[68:71], v[216:219]
    buffer_load_dwordx4 v2, s[8:11], s50 offen lds
    v_mfma_f32_16x16x32_bf16 v[220:223], a[68:71], v[68:71], v[220:223]
    ds_read_b128 v[68:71], v12 offset:33792
    s_min_u32 s5, s5, s55
    v_mfma_f32_16x16x32_bf16 v[208:211], a[72:75], v[72:75], v[208:211]
    v_mfma_f32_16x16x32_bf16 v[212:215], a[76:79], v[72:75], v[212:215]
    ds_read_b128 v[72:75], v13 offset:1024
    v_mfma_f32_16x16x32_bf16 v[216:219], a[72:75], v[76:79], v[216:219]
    buffer_load_dwordx4 v2, s[8:11], s50 offen offset:1024 lds
    v_mfma_f32_16x16x32_bf16 v[220:223], a[76:79], v[76:79], v[220:223]
    ds_read_b128 v[76:79], v13 offset:33792
    v_mfma_f32_16x16x32_bf16 v[208:211], a[80:83], v[80:83], v[208:211]
    v_mfma_f32_16x16x32_bf16 v[212:215], a[84:87], v[80:83], v[212:215]
    ds_read_b128 v[80:83], v14 offset:1024
    v_mfma_f32_16x16x32_bf16 v[216:219], a[80:83], v[84:87], v[216:219]
    v_mfma_f32_16x16x32_bf16 v[220:223], a[84:87], v[84:87], v[220:223]
    ds_read_b128 v[84:87], v14 offset:33792
    v_mfma_f32_16x16x32_bf16 v[208:211], a[88:91], v[88:91], v[208:211]
    v_mfma_f32_16x16x32_bf16 v[212:215], a[92:95], v[88:91], v[212:215]
    ds_read_b128 v[88:91], v15 offset:1024
    v_mfma_f32_16x16x32_bf16 v[216:219], a[88:91], v[92:95], v[216:219]
    v_mfma_f32_16x16x32_bf16 v[220:223], a[92:95], v[92:95], v[220:223]
    ds_read_b128 v[92:95], v15 offset:33792
    s_waitcnt lgkmcnt(12)
    v_mfma_f32_16x16x32_bf16 v[208:211], a[96:99], v[96:99], v[208:211]
    v_mfma_f32_16x16x32_bf16 v[212:215], a[100:103], v[96:99], v[212:215]
    ds_read_b128 v[96:99], v12 offset:1280
    v_mfma_f32_16x16x32_bf16 v[216:219], a[96:99], v[100:103], v[216:219]
    v_mfma_f32_16x16x32_bf16 v[220:223], a[100:103], v[100:103], v[220:223]
    ds_read_b128 v[100:103], v12 offset:34048
    v_mfma_f32_16x16x32_bf16 v[208:211], a[104:107], v[104:107], v[208:211]
    v_mfma_f32_16x16x32_bf16 v[212:215], a[108:111], v[104:107], v[212:215]
    ds_read_b128 v[104:107], v13 offset:1280
    v_mfma_f32_16x16x32_bf16 v[216:219], a[104:107], v[108:111], v[216:219]
    v_mfma_f32_16x16x32_bf16 v[220:223], a[108:111], v[108:111], v[220:223]
    ds_read_b128 v[108:111], v13 offset:34048
    s_waitcnt lgkmcnt(12)
    v_mfma_f32_16x16x32_bf16 v[208:211], a[112:115], v[112:115], v[208:211]
    v_mfma_f32_16x16x32_bf16 v[212:215], a[116:119], v[112:115], v[212:215]
    ds_read_b128 v[112:115], v14 offset:1280
    v_mfma_f32_16x16x32_bf16 v[216:219], a[112:115], v[116:119], v[216:219]
    v_mfma_f32_16x16x32_bf16 v[220:223], a[116:119], v[116:119], v[220:223]
    ds_read_b128 v[116:119], v14 offset:34048
    v_mfma_f32_16x16x32_bf16 v[208:211], a[120:123], v[120:123], v[208:211]
    v_mfma_f32_16x16x32_bf16 v[212:215], a[124:127], v[120:123], v[212:215]
    ds_read_b128 v[120:123], v15 offset:1280
    v_mfma_f32_16x16x32_bf16 v[216:219], a[120:123], v[124:127], v[216:219]
    v_mfma_f32_16x16x32_bf16 v[220:223], a[124:127], v[124:127], v[220:223]
    ds_read_b128 v[124:127], v15 offset:34048
    s_waitcnt lgkmcnt(12)
    v_mfma_f32_16x16x32_bf16 v[208:211], a[128:131], v[64:67], v[208:211]
    v_mfma_f32_16x16x32_bf16 v[212:215], a[132:135], v[64:67], v[212:215]
    ds_read_b128 v[64:67], v12 offset:1536
    v_mfma_f32_16x16x32_bf16 v[216:219], a[128:131], v[68:71], v[216:219]
    v_mfma_f32_16x16x32_bf16 v[220:223], a[132:135], v[68:71], v[220:223]
    ds_read_b128 v[68:71], v12 offset:34304
    v_mfma_f32_16x16x32_bf16 v[208:211], a[136:139], v[72:75], v[208:211]
    v_mfma_f32_16x16x32_bf16 v[212:215], a[140:143], v[72:75], v[212:215]
    ds_read_b128 v[72:75], v13 offset:1536
    v_mfma_f32_16x16x32_bf16 v[216:219], a[136:139], v[76:79], v[216:219]
    v_mfma_f32_16x16x32_bf16 v[220:223], a[140:143], v[76:79], v[220:223]
    ds_read_b128 v[76:79], v13 offset:34304
    s_waitcnt lgkmcnt(12)
    v_mfma_f32_16x16x32_bf16 v[208:211], a[144:147], v[80:83], v[208:211]
    v_mfma_f32_16x16x32_bf16 v[212:215], a[148:151], v[80:83], v[212:215]
    ds_read_b128 v[80:83], v14 offset:1536
    v_mfma_f32_16x16x32_bf16 v[216:219], a[144:147], v[84:87], v[216:219]
    v_mfma_f32_16x16x32_bf16 v[220:223], a[148:151], v[84:87], v[220:223]
    ds_read_b128 v[84:87], v14 offset:34304
    v_mfma_f32_16x16x32_bf16 v[208:211], a[152:155], v[88:91], v[208:211]
    v_mfma_f32_16x16x32_bf16 v[212:215], a[156:159], v[88:91], v[212:215]
    ds_read_b128 v[88:91], v15 offset:1536
    v_mfma_f32_16x16x32_bf16 v[216:219], a[152:155], v[92:95], v[216:219]
    v_mfma_f32_16x16x32_bf16 v[220:223], a[156:159], v[92:95], v[220:223]
    ds_read_b128 v[92:95], v15 offset:34304
    s_waitcnt lgkmcnt(12)
    v_mfma_f32_16x16x32_bf16 v[208:211], a[160:163], v[96:99], v[208:211]
    v_mfma_f32_16x16x32_bf16 v[212:215], a[164:167], v[96:99], v[212:215]
    ds_read_b128 v[96:99], v12 offset:1792
    v_mfma_f32_16x16x32_bf16 v[216:219], a[160:163], v[100:103], v[216:219]
    v_mfma_f32_16x16x32_bf16 v[220:223], a[164:167], v[100:103], v[220:223]
    ds_read_b128 v[100:103], v12 offset:34560
    v_mfma_f32_16x16x32_bf16 v[208:211], a[168:171], v[104:107], v[208:211]
    v_mfma_f32_16x16x32_bf16 v[212:215], a[172:175], v[104:107], v[212:215]
    ds_read_b128 v[104:107], v13 offset:1792
    v_mfma_f32_16x16x32_bf16 v[216:219], a[168:171], v[108:111], v[216:219]
    v_mfma_f32_16x16x32_bf16 v[220:223], a[172:175], v[108:111], v[220:223]
    ds_read_b128 v[108:111], v13 offset:34560
    s_waitcnt lgkmcnt(12)
    v_mfma_f32_16x16x32_bf16 v[208:211], a[176:179], v[112:115], v[208:211]
    v_mfma_f32_16x16x32_bf16 v[212:215], a[180:183], v[112:115], v[212:215]
    ds_read_b128 v[112:115], v14 offset:1792
    v_mfma_f32_16x16x32_bf16 v[216:219], a[176:179], v[116:119], v[216:219]
    v_mfma_f32_16x16x32_bf16 v[220:223], a[180:183], v[116:119], v[220:223]
    ds_read_b128 v[116:119], v14 offset:34560
    v_mfma_f32_16x16x32_bf16 v[208:211], a[184:187], v[120:123], v[208:211]
    v_mfma_f32_16x16x32_bf16 v[212:215], a[188:191], v[120:123], v[212:215]
    ds_read_b128 v[120:123], v15 offset:1792
    v_mfma_f32_16x16x32_bf16 v[216:219], a[184:187], v[124:127], v[216:219]
    v_mfma_f32_16x16x32_bf16 v[220:223], a[188:191], v[124:127], v[220:223]
    ds_read_b128 v[124:127], v15 offset:34560
    s_waitcnt lgkmcnt(12)
    v_mfma_f32_16x16x32_bf16 v[208:211], a[192:195], v[64:67], v[208:211]
    v_mfma_f32_16x16x32_bf16 v[212:215], a[196:199], v[64:67], v[212:215]
    v_mfma_f32_16x16x32_bf16 v[216:219], a[192:195], v[68:71], v[216:219]
    v_mfma_f32_16x16x32_bf16 v[220:223], a[196:199], v[68:71], v[220:223]
    v_mfma_f32_16x16x32_bf16 v[208:211], a[200:203], v[72:75], v[208:211]
    v_mfma_f32_16x16x32_bf16 v[212:215], a[204:207], v[72:75], v[212:215]
    v_mfma_f32_16x16x32_bf16 v[216:219], a[200:203], v[76:79], v[216:219]
    v_mfma_f32_16x16x32_bf16 v[220:223], a[204:207], v[76:79], v[220:223]
    s_waitcnt lgkmcnt(8)
    v_mfma_f32_16x16x32_bf16 v[208:211], a[208:211], v[80:83], v[208:211]
    v_mfma_f32_16x16x32_bf16 v[212:215], a[212:215], v[80:83], v[212:215]
    v_mfma_f32_16x16x32_bf16 v[216:219], a[208:211], v[84:87], v[216:219]
    v_mfma_f32_16x16x32_bf16 v[220:223], a[212:215], v[84:87], v[220:223]
    v_mfma_f32_16x16x32_bf16 v[208:211], a[216:219], v[88:91], v[208:211]
    v_mfma_f32_16x16x32_bf16 v[212:215], a[220:223], v[88:91], v[212:215]
    v_mfma_f32_16x16x32_bf16 v[216:219], a[216:219], v[92:95], v[216:219]
    v_mfma_f32_16x16x32_bf16 v[220:223], a[220:223], v[92:95], v[220:223]
    s_waitcnt lgkmcnt(4)
    v_mfma_f32_16x16x32_bf16 v[208:211], a[224:227], v[96:99], v[208:211]
    v_mfma_f32_16x16x32_bf16 v[212:215], a[228:231], v[96:99], v[212:215]
    v_mfma_f32_16x16x32_bf16 v[216:219], a[224:227], v[100:103], v[216:219]
    v_mfma_f32_16x16x32_bf16 v[220:223], a[228:231], v[100:103], v[220:223]
    v_mfma_f32_16x16x32_bf16 v[208:211], a[232:235], v[104:107], v[208:211]
    v_mfma_f32_16x16x32_bf16 v[212:215], a[236:239], v[104:107], v[212:215]
    v_mfma_f32_16x16x32_bf16 v[216:219], a[232:235], v[108:111], v[216:219]
    v_mfma_f32_16x16x32_bf16 v[220:223], a[236:239], v[108:111], v[220:223]
    s_waitcnt lgkmcnt(0)
    v_mfma_f32_16x16x32_bf16 v[208:211], a[240:243], v[112:115], v[208:211]
    v_mfma_f32_16x16x32_bf16 v[212:215], a[244:247], v[112:115], v[212:215]
    v_mfma_f32_16x16x32_bf16 v[216:219], a[240:243], v[116:119], v[216:219]
    v_mfma_f32_16x16x32_bf16 v[220:223], a[244:247], v[116:119], v[220:223]
    v_mfma_f32_16x16x32_bf16 v[208:211], a[248:251], v[120:123], v[208:211]
    v_mfma_f32_16x16x32_bf16 v[212:215], a[252:255], v[120:123], v[212:215]
    v_mfma_f32_16x16x32_bf16 v[216:219], a[248:251], v[124:127], v[216:219]
    v_mfma_f32_16x16x32_bf16 v[220:223], a[252:255], v[124:127], v[220:223]
    s_cmp_eq_u32 s31, 0
    s_cbranch_scc1 .cp_409
.cb_410:
    s_barrier
    ds_read_b128 v[176:179], v3 offset:4096
    ds_read_b128 v[180:183], v3 offset:4608
    ds_read_b128 v[184:187], v3 offset:5120
    ds_read_b128 v[188:191], v3 offset:5632
    ds_read_b32 v232, v6 offset:4096
    ds_read_b32 v234, v6 offset:4160
    ds_read_b32 v236, v6 offset:4608
    ds_read_b32 v238, v6 offset:4672
    v_max3_f32 v248, v48, v49, v50
    v_max3_f32 v248, v248, v51, v52
    v_max3_f32 v249, v53, v54, v55
    s_waitcnt lgkmcnt(4)
    v_mfma_f32_16x16x32_bf16 v[56:59], v[176:179], v[192:195], 0
    v_mfma_f32_16x16x32_bf16 v[56:59], v[180:183], v[196:199], v[56:59]
    v_mfma_f32_16x16x32_bf16 v[56:59], v[184:187], v[200:203], v[56:59]
    v_mfma_f32_16x16x32_bf16 v[56:59], v[188:191], v[204:207], v[56:59]
    s_nop 7
    v_max3_f32 v248, v248, v56, v57
    v_max_f32 v30, v248, v249
    v_max_f32 v249, v248, v249
    s_nop 1
    v_permlane16_swap_b32 v249, v30
    v_max_f32 v248, v249, v30
    v_max_f32 v249, v249, v30
    s_nop 1
    v_permlane32_swap_b32 v248, v249
    v_max_f32 v248, v248, v249
    v_mul_f32 v248, s45, v248
    v_fma_f32 v60, v48, s45, -v248
    v_fma_f32 v61, v49, s45, -v248
    v_fma_f32 v62, v50, s45, -v248
    v_fma_f32 v63, v51, s45, -v248
    v_fma_f32 v242, v52, s45, -v248
    v_fma_f32 v243, v53, s45, -v248
    v_fma_f32 v244, v54, s45, -v248
    v_fma_f32 v245, v55, s45, -v248
    v_fma_f32 v246, v56, s45, -v248
    v_fma_f32 v247, v57, s45, -v248
    v_exp_f32 v60, v60
    v_exp_f32 v61, v61
    v_exp_f32 v62, v62
    v_exp_f32 v63, v63
    v_exp_f32 v242, v242
    v_exp_f32 v243, v243
    v_exp_f32 v244, v244
    v_exp_f32 v245, v245
    v_exp_f32 v246, v246
    v_exp_f32 v247, v247
    v_cvt_pk_bf16_f32 v48, v60, v61
    v_cvt_pk_bf16_f32 v49, v62, v63
    v_cvt_pk_bf16_f32 v50, v242, v243
    v_cvt_pk_bf16_f32 v51, v244, v245
    v_cvt_pk_bf16_f32 v40, v246, v247
    s_waitcnt lgkmcnt(0)
    v_mfma_f32_16x16x32_bf16 v[52:55], v[44:47], v[48:51], 0
    v_mfma_f32_16x16x32_bf16 v[52:55], v[44:47], v[40:43], v[52:55]
    v_mfma_f32_16x16x32_bf16 v[192:195], v[160:163], v[48:51], 0
    v_mfma_f32_16x16x32_bf16 v[192:195], v[232:235], v[40:43], v[192:195]
    v_mfma_f32_16x16x32_bf16 v[196:199], v[164:167], v[48:51], 0
    v_mfma_f32_16x16x32_bf16 v[196:199], v[234:237], v[40:43], v[196:199]
    v_mfma_f32_16x16x32_bf16 v[200:203], v[168:171], v[48:51], 0
    v_mfma_f32_16x16x32_bf16 v[200:203], v[236:239], v[40:43], v[200:203]
    v_mfma_f32_16x16x32_bf16 v[204:207], v[172:175], v[48:51], 0
    v_mfma_f32_16x16x32_bf16 v[204:207], v[238:241], v[40:43], v[204:207]
    v_rcp_f32 v248, v52
    s_nop 0
    v_mul_f32 v192, v248, v192
    v_mul_f32 v193, v248, v193
    v_mul_f32 v194, v248, v194
    v_mul_f32 v195, v248, v195
    v_cvt_pk_bf16_f32 v224, v192, v193
    v_cvt_pk_bf16_f32 v225, v194, v195
    v_mul_f32 v196, v248, v196
    v_mul_f32 v197, v248, v197
    v_mul_f32 v198, v248, v198
    v_mul_f32 v199, v248, v199
    v_cvt_pk_bf16_f32 v226, v196, v197
    v_cvt_pk_bf16_f32 v227, v198, v199
    s_cbranch_vccnz .cp_405
    buffer_store_dwordx4 v[224:227], v2, s[8:11], s53 offen offset:0
.cb_406:
    v_mul_f32 v200, v248, v200
    v_mul_f32 v201, v248, v201
    v_mul_f32 v202, v248, v202
    v_mul_f32 v203, v248, v203
    v_cvt_pk_bf16_f32 v228, v200, v201
    v_cvt_pk_bf16_f32 v229, v202, v203
    v_mul_f32 v204, v248, v204
    v_mul_f32 v205, v248, v205
    v_mul_f32 v206, v248, v206
    v_mul_f32 v207, v248, v207
    v_cvt_pk_bf16_f32 v230, v204, v205
    v_cvt_pk_bf16_f32 v231, v206, v207
    s_cbranch_vccnz .cp_407
    buffer_store_dwordx4 v[228:231], v2, s[8:11], s53 offen offset:1024
.cb_408:
    s_add_u32 s30, s30, 1
    s_mov_b32 s53, s40
    s_waitcnt vmcnt(0)
    v_max_i32 v27, s30, v26
    s_cbranch_vccnz .cp_411
    buffer_store_dword v27, v26, s[8:11], s94 offen
.cb_412:
    s_add_u32 s48, s48, 0x20000
    s_mov_b32 s31, 0
    v_cvt_pk_bf16_f32 v224, v208, v209
    v_cvt_pk_bf16_f32 v225, v210, v211
    v_cvt_pk_bf16_f32 v226, v212, v213
    v_cvt_pk_bf16_f32 v227, v214, v215
    v_cvt_pk_bf16_f32 v228, v216, v217
    v_cvt_pk_bf16_f32 v229, v218, v219
    v_cvt_pk_bf16_f32 v230, v220, v221
    v_cvt_pk_bf16_f32 v231, v222, v223
    ds_write_b128 v24, v[224:227] offset:0
    ds_write_b128 v24, v[228:231] offset:4096
    s_waitcnt lgkmcnt(0)
    s_barrier
    ds_read_b128 v[208:211], v25 offset:0
    ds_read_b128 v[128:131], v31 offset:0
    ds_read_b128 v[144:147], v31 offset:4096
    ds_read_b128 v[212:215], v25 offset:1024
    ds_read_b128 v[132:135], v31 offset:1024
    ds_read_b128 v[148:151], v31 offset:5120
    ds_read_b128 v[216:219], v25 offset:2048
    ds_read_b128 v[136:139], v31 offset:2048
    ds_read_b128 v[152:155], v31 offset:6144
    ds_read_b128 v[220:223], v25 offset:3072
    ds_read_b128 v[140:143], v31 offset:3072
    ds_read_b128 v[156:159], v31 offset:7168
    ds_read_b128 v[160:163], v5 offset:8192
    ds_read_b128 v[164:167], v5 offset:9216
    ds_read_b128 v[168:171], v5 offset:10240
    ds_read_b128 v[172:175], v5 offset:11264
    s_waitcnt lgkmcnt(4)
    v_mfma_f32_16x16x32_bf16 v[48:51], v[128:131], v[208:211], v[32:35]
    v_mfma_f32_16x16x32_bf16 v[52:55], v[144:147], v[208:211], v[36:39]
    v_mfma_f32_16x16x32_bf16 v[48:51], v[132:135], v[212:215], v[48:51]
    v_mfma_f32_16x16x32_bf16 v[52:55], v[148:151], v[212:215], v[52:55]
    v_mfma_f32_16x16x32_bf16 v[48:51], v[136:139], v[216:219], v[48:51]
    v_mfma_f32_16x16x32_bf16 v[52:55], v[152:155], v[216:219], v[52:55]
    v_mfma_f32_16x16x32_bf16 v[48:51], v[140:143], v[220:223], v[48:51]
    v_mfma_f32_16x16x32_bf16 v[52:55], v[156:159], v[220:223], v[52:55]
    s_cmp_eq_u32 s31, 0
    s_cbranch_scc1 .cp_421
.cb_422:
    s_barrier
    ds_read_b128 v[176:179], v3 offset:0
    ds_read_b128 v[180:183], v3 offset:512
    ds_read_b128 v[184:187], v3 offset:1024
    ds_read_b128 v[188:191], v3 offset:1536
    ds_read_b32 v232, v6 offset:0
    ds_read_b32 v234, v6 offset:64
    ds_read_b32 v236, v6 offset:512
    ds_read_b32 v238, v6 offset:576
    v_max3_f32 v248, v48, v49, v50
    v_max3_f32 v248, v248, v51, v52
    v_max3_f32 v249, v53, v54, v55
    s_waitcnt lgkmcnt(4)
    v_mfma_f32_16x16x32_bf16 v[56:59], v[176:179], v[208:211], 0
    v_mfma_f32_16x16x32_bf16 v[56:59], v[180:183], v[212:215], v[56:59]
    v_mfma_f32_16x16x32_bf16 v[56:59], v[184:187], v[216:219], v[56:59]
    v_mfma_f32_16x16x32_bf16 v[56:59], v[188:191], v[220:223], v[56:59]
    s_nop 7
    v_max3_f32 v248, v248, v56, v57
    v_max_f32 v30, v248, v249
    v_max_f32 v249, v248, v249
    s_nop 1
    v_permlane16_swap_b32 v249, v30
    v_max_f32 v248, v249, v30
    v_max_f32 v249, v249, v30
    s_nop 1
    v_permlane32_swap_b32 v248, v249
    v_max_f32 v248, v248, v249
    v_mul_f32 v248, s45, v248
    v_fma_f32 v60, v48, s45, -v248
    v_fma_f32 v61, v49, s45, -v248
    v_fma_f32 v62, v50, s45, -v248
    v_fma_f32 v63, v51, s45, -v248
    v_fma_f32 v242, v52, s45, -v248
    v_fma_f32 v243, v53, s45, -v248
    v_fma_f32 v244, v54, s45, -v248
    v_fma_f32 v245, v55, s45, -v248
    v_fma_f32 v246, v56, s45, -v248
    v_fma_f32 v247, v57, s45, -v248
    v_exp_f32 v60, v60
    v_exp_f32 v61, v61
    v_exp_f32 v62, v62
    v_exp_f32 v63, v63
    v_exp_f32 v242, v242
    v_exp_f32 v243, v243
    v_exp_f32 v244, v244
    v_exp_f32 v245, v245
    v_exp_f32 v246, v246
    v_exp_f32 v247, v247
    v_cvt_pk_bf16_f32 v48, v60, v61
    v_cvt_pk_bf16_f32 v49, v62, v63
    v_cvt_pk_bf16_f32 v50, v242, v243
    v_cvt_pk_bf16_f32 v51, v244, v245
    v_cvt_pk_bf16_f32 v40, v246, v247
    s_waitcnt lgkmcnt(0)
    v_mfma_f32_16x16x32_bf16 v[52:55], v[44:47], v[48:51], 0
    v_mfma_f32_16x16x32_bf16 v[52:55], v[44:47], v[40:43], v[52:55]
    v_mfma_f32_16x16x32_bf16 v[208:211], v[160:163], v[48:51], 0
    v_mfma_f32_16x16x32_bf16 v[208:211], v[232:235], v[40:43], v[208:211]
    v_mfma_f32_16x16x32_bf16 v[212:215], v[164:167], v[48:51], 0
    v_mfma_f32_16x16x32_bf16 v[212:215], v[234:237], v[40:43], v[212:215]
    v_mfma_f32_16x16x32_bf16 v[216:219], v[168:171], v[48:51], 0
    v_mfma_f32_16x16x32_bf16 v[216:219], v[236:239], v[40:43], v[216:219]
    v_mfma_f32_16x16x32_bf16 v[220:223], v[172:175], v[48:51], 0
    v_mfma_f32_16x16x32_bf16 v[220:223], v[238:241], v[40:43], v[220:223]
    v_rcp_f32 v248, v52
    s_nop 0
    v_mul_f32 v208, v248, v208
    v_mul_f32 v209, v248, v209
    v_mul_f32 v210, v248, v210
    v_mul_f32 v211, v248, v211
    v_cvt_pk_bf16_f32 v224, v208, v209
    v_cvt_pk_bf16_f32 v225, v210, v211
    v_mul_f32 v212, v248, v212
    v_mul_f32 v213, v248, v213
    v_mul_f32 v214, v248, v214
    v_mul_f32 v215, v248, v215
    v_cvt_pk_bf16_f32 v226, v212, v213
    v_cvt_pk_bf16_f32 v227, v214, v215
    s_cbranch_vccnz .cp_417
    buffer_store_dwordx4 v[224:227], v2, s[8:11], s53 offen offset:0
.cb_418:
    v_mul_f32 v216, v248, v216
    v_mul_f32 v217, v248, v217
    v_mul_f32 v218, v248, v218
    v_mul_f32 v219, v248, v219
    v_cvt_pk_bf16_f32 v228, v216, v217
    v_cvt_pk_bf16_f32 v229, v218, v219
    v_mul_f32 v220, v248, v220
    v_mul_f32 v221, v248, v221
    v_mul_f32 v222, v248, v222
    v_mul_f32 v223, v248, v223
    v_cvt_pk_bf16_f32 v230, v220, v221
    v_cvt_pk_bf16_f32 v231, v222, v223
    s_cbranch_vccnz .cp_419
    buffer_store_dwordx4 v[228:231], v2, s[8:11], s53 offen offset:1024
.cb_420:
    s_add_u32 s30, s30, 1
    s_mov_b32 s53, s40
    s_waitcnt vmcnt(0)
    v_max_i32 v27, s30, v26
    s_cbranch_vccnz .cp_423
    buffer_store_dword v27, v26, s[8:11], s94 offen
.cb_424:
    s_endpgm
.cp_369:
    buffer_store_dwordx4 v[224:227], v2, s[8:11], s53 offen offset:0 sc1
    s_branch .cb_370
.cp_371:
    buffer_store_dwordx4 v[228:231], v2, s[8:11], s53 offen offset:1024 sc1
    s_branch .cb_372
.cp_373:
    buffer_store_dword v27, v26, s[8:11], s94 offen sc1
    s_branch .cb_374
.cp_375:
    s_cmp_gt_u32 s32, s42
    s_cbranch_scc1 .ndd_426
    s_mov_b32 s62, 0
.nd_425:
    buffer_load_dword v29, v7, s[8:11], s46 offen sc1
    buffer_load_dword v30, v7, s[8:11], s47 offen sc1
    s_add_u32 s62, s62, 1
    s_cmp_gt_u32 s62, 0x200000
    s_cbranch_scc1 .mg_end_1
    s_waitcnt vmcnt(0)
    v_min_u32 v29, v29, v30
    s_nop 1
    v_min_u32_dpp v29, v29, v29 quad_perm:[1,0,3,2] row_mask:0xf bank_mask:0xf
    s_nop 1
    v_min_u32_dpp v29, v29, v29 quad_perm:[2,3,0,1] row_mask:0xf bank_mask:0xf
    s_nop 1
    v_readfirstlane_b32 s32, v29
    s_lshl_b32 s55, s32, 18
    s_add_u32 s55, s55, s37
    s_cmp_gt_u32 s32, s42
    s_cbranch_scc1 .ndd_426
    s_sleep 4
    s_branch .nd_425
.ndd_426:
    s_branch .cb_376
.cp_377:
    s_cmp_gt_u32 s33, s30
    s_cbranch_scc1 .ndd_428
    s_mov_b32 s62, 0
.nd_427:
    buffer_load_dword v4, v7, s[8:11], 0 offen sc1
    s_add_u32 s62, s62, 1
    s_cmp_gt_u32 s62, 0x200000
    s_cbranch_scc1 .mg_end_1
    s_waitcnt vmcnt(0)
    v_min_u32_dpp v4, v4, v4 quad_perm:[1,0,3,2] row_mask:0xf bank_mask:0xf
    s_nop 1
    v_min_u32_dpp v4, v4, v4 quad_perm:[2,3,0,1] row_mask:0xf bank_mask:0xf
    s_nop 1
    v_readfirstlane_b32 s33, v4
    s_cmp_gt_u32 s33, s30
    s_cbranch_scc1 .ndd_428
    s_sleep 4
    s_branch .nd_427
.ndd_428:
    s_add_u32 m0, s52, 0
    s_nop 0
    buffer_load_dwordx4 v2, s[8:11], s48 offen lds
    s_waitcnt vmcnt(0)
    s_branch .cb_378
.pp_379:
    buffer_load_dword v4, v7, s[8:11], 0 offen sc1
    s_mov_b32 s31, 0
    s_branch .pb_380
.cp_381:
    s_waitcnt vmcnt(1)
    v_min_u32_dpp v4, v4, v4 quad_perm:[1,0,3,2] row_mask:0xf bank_mask:0xf
    s_nop 1
    v_min_u32_dpp v4, v4, v4 quad_perm:[2,3,0,1] row_mask:0xf bank_mask:0xf
    s_nop 1
    v_readfirstlane_b32 s33, v4
    s_cmp_gt_u32 s33, s42
    s_cbranch_scc0 .cb_382
    s_mov_b32 s31, 1
    s_add_u32 m0, s52, 4096
    s_nop 0
    buffer_load_dwordx4 v2, s[8:11], s48 offen lds
    s_branch .cb_382
.cp_383:
    buffer_store_dwordx4 v[224:227], v2, s[8:11], s53 offen offset:0 sc1
    s_branch .cb_384
.cp_385:
    buffer_store_dwordx4 v[228:231], v2, s[8:11], s53 offen offset:1024 sc1
    s_branch .cb_386
.cp_387:
    buffer_store_dword v27, v26, s[8:11], s94 offen sc1
    s_branch .cb_388
.cp_389:
    s_cmp_gt_u32 s32, s42
    s_cbranch_scc1 .ndd_430
    s_mov_b32 s62, 0
.nd_429:
    buffer_load_dword v29, v7, s[8:11], s46 offen sc1
    buffer_load_dword v30, v7, s[8:11], s47 offen sc1
    s_add_u32 s62, s62, 1
    s_cmp_gt_u32 s62, 0x200000
    s_cbranch_scc1 .mg_end_1
    s_waitcnt vmcnt(0)
    v_min_u32 v29, v29, v30
    s_nop 1
    v_min_u32_dpp v29, v29, v29 quad_perm:[1,0,3,2] row_mask:0xf bank_mask:0xf
    s_nop 1
    v_min_u32_dpp v29, v29, v29 quad_perm:[2,3,0,1] row_mask:0xf bank_mask:0xf
    s_nop 1
    v_readfirstlane_b32 s32, v29
    s_lshl_b32 s55, s32, 18
    s_add_u32 s55, s55, s37
    s_cmp_gt_u32 s32, s42
    s_cbranch_scc1 .ndd_430
    s_sleep 4
    s_branch .nd_429
.ndd_430:
    s_branch .cb_390
.cp_391:
    s_cmp_gt_u32 s33, s30
    s_cbranch_scc1 .ndd_432
    s_mov_b32 s62, 0
.nd_431:
    buffer_load_dword v4, v7, s[8:11], 0 offen sc1
    s_add_u32 s62, s62, 1
    s_cmp_gt_u32 s62, 0x200000
    s_cbranch_scc1 .mg_end_1
    s_waitcnt vmcnt(0)
    v_min_u32_dpp v4, v4, v4 quad_perm:[1,0,3,2] row_mask:0xf bank_mask:0xf
    s_nop 1
    v_min_u32_dpp v4, v4, v4 quad_perm:[2,3,0,1] row_mask:0xf bank_mask:0xf
    s_nop 1
    v_readfirstlane_b32 s33, v4
    s_cmp_gt_u32 s33, s30
    s_cbranch_scc1 .ndd_432
    s_sleep 4
    s_branch .nd_431
.ndd_432:
    s_add_u32 m0, s52, 4096
    s_nop 0
    buffer_load_dwordx4 v2, s[8:11], s48 offen lds
    s_waitcnt vmcnt(0)
    s_branch .cb_392
.pp_393:
    buffer_load_dword v4, v7, s[8:11], 0 offen sc1
    s_mov_b32 s31, 0
    s_branch .pb_394
.cp_395:
    s_waitcnt vmcnt(1)
    v_min_u32_dpp v4, v4, v4 quad_perm:[1,0,3,2] row_mask:0xf bank_mask:0xf
    s_nop 1
    v_min_u32_dpp v4, v4, v4 quad_perm:[2,3,0,1] row_mask:0xf bank_mask:0xf
    s_nop 1
    v_readfirstlane_b32 s33, v4
    s_cmp_gt_u32 s33, s42
    s_cbranch_scc0 .cb_396
    s_mov_b32 s31, 1
    s_add_u32 m0, s52, 0
    s_nop 0
    buffer_load_dwordx4 v2, s[8:11], s48 offen lds
    s_branch .cb_396
.cp_401:
    buffer_store_dword v27, v26, s[8:11], s94 offen sc1
    s_branch .cb_402
.cp_403:
    s_cmp_gt_u32 s32, s42
    s_cbranch_scc1 .ndd_434
    s_mov_b32 s62, 0
.nd_433:
    buffer_load_dword v29, v7, s[8:11], s46 offen sc1
    buffer_load_dword v30, v7, s[8:11], s47 offen sc1
    s_add_u32 s62, s62, 1
    s_cmp_gt_u32 s62, 0x200000
    s_cbranch_scc1 .mg_end_1
    s_waitcnt vmcnt(0)
    v_min_u32 v29, v29, v30
    s_nop 1
    v_min_u32_dpp v29, v29, v29 quad_perm:[1,0,3,2] row_mask:0xf bank_mask:0xf
    s_nop 1
    v_min_u32_dpp v29, v29, v29 quad_perm:[2,3,0,1] row_mask:0xf bank_mask:0xf
    s_nop 1
    v_readfirstlane_b32 s32, v29
    s_lshl_b32 s55, s32, 18
    s_add_u32 s55, s55, s37
    s_cmp_gt_u32 s32, s42
    s_cbranch_scc1 .ndd_434
    s_sleep 4
    s_branch .nd_433
.ndd_434:
    s_branch .cb_404
.cp_405:
    buffer_store_dwordx4 v[224:227], v2, s[8:11], s53 offen offset:0 sc1
    s_branch .cb_406
.cp_407:
    buffer_store_dwordx4 v[228:231], v2, s[8:11], s53 offen offset:1024 sc1
    s_branch .cb_408
.cp_409:
    s_cmp_gt_u32 s33, s30
    s_cbranch_scc1 .ndd_436
    s_mov_b32 s62, 0
.nd_435:
    buffer_load_dword v4, v7, s[8:11], 0 offen sc1
    s_add_u32 s62, s62, 1
    s_cmp_gt_u32 s62, 0x200000
    s_cbranch_scc1 .mg_end_1
    s_waitcnt vmcnt(0)
    v_min_u32_dpp v4, v4, v4 quad_perm:[1,0,3,2] row_mask:0xf bank_mask:0xf
    s_nop 1
    v_min_u32_dpp v4, v4, v4 quad_perm:[2,3,0,1] row_mask:0xf bank_mask:0xf
    s_nop 1
    v_readfirstlane_b32 s33, v4
    s_cmp_gt_u32 s33, s30
    s_cbranch_scc1 .ndd_436
    s_sleep 4
    s_branch .nd_435
.ndd_436:
    s_add_u32 m0, s52, 4096
    s_nop 0
    buffer_load_dwordx4 v2, s[8:11], s48 offen lds
    s_waitcnt vmcnt(0)
    s_branch .cb_410
.cp_411:
    buffer_store_dword v27, v26, s[8:11], s94 offen sc1
    s_branch .cb_412
.cp_417:
    buffer_store_dwordx4 v[224:227], v2, s[8:11], s53 offen offset:0 sc1
    s_branch .cb_418
.cp_419:
    buffer_store_dwordx4 v[228:231], v2, s[8:11], s53 offen offset:1024 sc1
    s_branch .cb_420
.cp_421:
    s_cmp_gt_u32 s33, s30
    s_cbranch_scc1 .ndd_438
    s_mov_b32 s62, 0
.nd_437:
    buffer_load_dword v4, v7, s[8:11], 0 offen sc1
    s_add_u32 s62, s62, 1
    s_cmp_gt_u32 s62, 0x200000
    s_cbranch_scc1 .mg_end_1
    s_waitcnt vmcnt(0)
    v_min_u32_dpp v4, v4, v4 quad_perm:[1,0,3,2] row_mask:0xf bank_mask:0xf
    s_nop 1
    v_min_u32_dpp v4, v4, v4 quad_perm:[2,3,0,1] row_mask:0xf bank_mask:0xf
    s_nop 1
    v_readfirstlane_b32 s33, v4
    s_cmp_gt_u32 s33, s30
    s_cbranch_scc1 .ndd_438
    s_sleep 4
    s_branch .nd_437
.ndd_438:
    s_add_u32 m0, s52, 0
    s_nop 0
    buffer_load_dwordx4 v2, s[8:11], s48 offen lds
    s_waitcnt vmcnt(0)
    s_branch .cb_422
.cp_423:
    buffer_store_dword v27, v26, s[8:11], s94 offen sc1
    s_branch .cb_424
.ph2_328:
    s_load_dwordx2 s[42:43], s[0:1], 88
    s_lshr_b32 s34, s99, 3
    s_and_b32 s35, s99, 7
    s_lshl_b32 s4, s34, 21
    s_lshl_b32 s5, s35, 8
    s_add_u32 s4, s4, s5
    s_lshl_b32 s6, s24, 14
    s_mul_i32 s5, s24, 131072
    s_add_u32 s4, s4, s5
    v_bfe_u32 v2, v1, 4, 1
    v_lshlrev_b32 v2, 2, v2
    v_and_b32 v3, 7, v1
    v_xor_b32 v2, v2, v3
    v_lshlrev_b32 v2, 4, v2
    v_bfe_u32 v254, v1, 3, 2
    v_mul_u32_u24 v240, 2048, v254
    v_bfe_u32 v254, v1, 5, 1
    v_mul_u32_u24 v254, 128, v254
    v_add_u32 v240, v240, v254
    v_add_u32 v240, s4, v240
    v_add_u32 v240, v2, v240
    s_lshr_b32 s5, s24, 1
    s_lshl_b32 s5, s5, 9
    v_bfe_u32 v2, v1, 3, 1
    v_xor_b32 v2, s24, v2
    v_and_b32 v2, 1, v2
    v_lshlrev_b32 v2, 6, v2
    v_bfe_u32 v254, v1, 4, 2
    v_mul_u32_u24 v242, 2048, v254
    v_bfe_u32 v254, v1, 2, 2
    v_mul_u32_u24 v254, 128, v254
    v_add_u32 v242, v242, v254
    v_bfe_u32 v254, v1, 0, 2
    v_mul_u32_u24 v254, 16, v254
    v_add_u32 v242, v242, v254
    v_add_u32 v242, s5, v242
    v_add_u32 v242, v2, v242
    v_add_u32 v243, 0x10000, v242
    s_waitcnt lgkmcnt(0)
    s_mov_b32 s16, s42
    s_and_b32 s17, s43, 0xffff
    s_mov_b32 s18, 0x800000
    s_mov_b32 s19, 0x00020000
    s_add_u32 m0, s6, 0
    s_mov_b32 s5, 0
    buffer_load_dwordx4 v240, s[16:19], s5 offen nt lds
    s_add_u32 m0, s6, 1024
    s_mov_b32 s5, 8192
    buffer_load_dwordx4 v240, s[16:19], s5 offen nt lds
    s_add_u32 m0, s6, 2048
    s_mov_b32 s5, 16384
    buffer_load_dwordx4 v240, s[16:19], s5 offen nt lds
    s_add_u32 m0, s6, 3072
    s_mov_b32 s5, 24576
    buffer_load_dwordx4 v240, s[16:19], s5 offen nt lds
    s_add_u32 m0, s6, 4096
    s_mov_b32 s5, 32768
    buffer_load_dwordx4 v240, s[16:19], s5 offen nt lds
    s_add_u32 m0, s6, 5120
    s_mov_b32 s5, 40960
    buffer_load_dwordx4 v240, s[16:19], s5 offen nt lds
    s_add_u32 m0, s6, 6144
    s_mov_b32 s5, 49152
    buffer_load_dwordx4 v240, s[16:19], s5 offen nt lds
    s_add_u32 m0, s6, 7168
    s_mov_b32 s5, 57344
    buffer_load_dwordx4 v240, s[16:19], s5 offen nt lds
    s_add_u32 m0, s6, 8192
    s_mov_b32 s5, 65536
    buffer_load_dwordx4 v240, s[16:19], s5 offen nt lds
    s_add_u32 m0, s6, 9216
    s_mov_b32 s5, 73728
    buffer_load_dwordx4 v240, s[16:19], s5 offen nt lds
    s_add_u32 m0, s6, 10240
    s_mov_b32 s5, 81920
    buffer_load_dwordx4 v240, s[16:19], s5 offen nt lds
    s_add_u32 m0, s6, 11264
    s_mov_b32 s5, 90112
    buffer_load_dwordx4 v240, s[16:19], s5 offen nt lds
    s_add_u32 m0, s6, 12288
    s_mov_b32 s5, 98304
    buffer_load_dwordx4 v240, s[16:19], s5 offen nt lds
    s_add_u32 m0, s6, 13312
    s_mov_b32 s5, 106496
    buffer_load_dwordx4 v240, s[16:19], s5 offen nt lds
    s_add_u32 m0, s6, 14336
    s_mov_b32 s5, 114688
    buffer_load_dwordx4 v240, s[16:19], s5 offen nt lds
    s_add_u32 m0, s6, 15360
    s_mov_b32 s5, 122880
    buffer_load_dwordx4 v240, s[16:19], s5 offen nt lds
    s_add_u32 m0, s6, 65536
    s_mov_b32 s5, 524288
    buffer_load_dwordx4 v240, s[16:19], s5 offen nt lds
    s_add_u32 m0, s6, 66560
    s_mov_b32 s5, 532480
    buffer_load_dwordx4 v240, s[16:19], s5 offen nt lds
    s_add_u32 m0, s6, 67584
    s_mov_b32 s5, 540672
    buffer_load_dwordx4 v240, s[16:19], s5 offen nt lds
    s_add_u32 m0, s6, 68608
    s_mov_b32 s5, 548864
    buffer_load_dwordx4 v240, s[16:19], s5 offen nt lds
    s_add_u32 m0, s6, 69632
    s_mov_b32 s5, 557056
    buffer_load_dwordx4 v240, s[16:19], s5 offen nt lds
    s_add_u32 m0, s6, 70656
    s_mov_b32 s5, 565248
    buffer_load_dwordx4 v240, s[16:19], s5 offen nt lds
    s_add_u32 m0, s6, 71680
    s_mov_b32 s5, 573440
    buffer_load_dwordx4 v240, s[16:19], s5 offen nt lds
    s_add_u32 m0, s6, 72704
    s_mov_b32 s5, 581632
    buffer_load_dwordx4 v240, s[16:19], s5 offen nt lds
    s_add_u32 m0, s6, 73728
    s_mov_b32 s5, 589824
    buffer_load_dwordx4 v240, s[16:19], s5 offen nt lds
    s_add_u32 m0, s6, 74752
    s_mov_b32 s5, 598016
    buffer_load_dwordx4 v240, s[16:19], s5 offen nt lds
    s_add_u32 m0, s6, 75776
    s_mov_b32 s5, 606208
    buffer_load_dwordx4 v240, s[16:19], s5 offen nt lds
    s_add_u32 m0, s6, 76800
    s_mov_b32 s5, 614400
    buffer_load_dwordx4 v240, s[16:19], s5 offen nt lds
    s_add_u32 m0, s6, 77824
    s_mov_b32 s5, 622592
    buffer_load_dwordx4 v240, s[16:19], s5 offen nt lds
    s_add_u32 m0, s6, 78848
    s_mov_b32 s5, 630784
    buffer_load_dwordx4 v240, s[16:19], s5 offen nt lds
    s_add_u32 m0, s6, 79872
    s_mov_b32 s5, 638976
    buffer_load_dwordx4 v240, s[16:19], s5 offen nt lds
    s_add_u32 m0, s6, 80896
    s_mov_b32 s5, 647168
    buffer_load_dwordx4 v240, s[16:19], s5 offen nt lds
    v_lshlrev_b32 v2, 4, v1
    v_mov_b32 v8, v2
    s_lshl_b32 s36, s24, 12
    s_lshl_b32 s4, s34, 16
    s_add_u32 s4, s4, s36
    v_add_u32 v9, s4, v2
    s_lshl_b32 s4, s34, 10
    s_add_u32 s4, s4, 92340224
    v_bfe_u32 v254, v1, 0, 3
    v_mul_u32_u24 v7, 128, v254
    v_add_u32 v7, s4, v7
    s_lshl_b32 s4, s35, 2
    s_add_u32 s4, s4, s24
    s_lshl_b32 s5, s4, 9
    s_lshl_b32 s94, s34, 7
    s_add_u32 s94, s94, s5
    s_add_u32 s94, s94, 92323840
    s_lshl_b32 s38, s4, 1
    s_and_b32 s5, s34, 1
    s_or_b32 s38, s38, s5
    s_lshl_b32 s4, s35, 22
    s_lshl_b32 s37, s34, 20
    s_add_u32 s37, s37, s4
    s_lshl_b32 s4, s24, 18
    s_add_u32 s37, s37, s4
    s_add_u32 s37, s37, 150994944
    s_mov_b32 s29, 16777216
    s_mov_b32 s28, 0
    s_mov_b32 s33, 0
    s_mov_b32 s39, 0
    v_mov_b32 v26, 0
    s_waitcnt vmcnt(16)
    s_barrier
    ds_read_b64_tr_b16 a[0:1], v242 offset:0
    ds_read_b64_tr_b16 a[2:3], v242 offset:1024
    ds_read_b64_tr_b16 a[4:5], v242 offset:8
    ds_read_b64_tr_b16 a[6:7], v242 offset:1032
    ds_read_b64_tr_b16 a[8:9], v242 offset:8192
    ds_read_b64_tr_b16 a[10:11], v242 offset:9216
    ds_read_b64_tr_b16 a[12:13], v242 offset:8200
    ds_read_b64_tr_b16 a[14:15], v242 offset:9224
    ds_read_b64_tr_b16 a[16:17], v242 offset:16384
    ds_read_b64_tr_b16 a[18:19], v242 offset:17408
    ds_read_b64_tr_b16 a[20:21], v242 offset:16392
    ds_read_b64_tr_b16 a[22:23], v242 offset:17416
    ds_read_b64_tr_b16 a[24:25], v242 offset:24576
    ds_read_b64_tr_b16 a[26:27], v242 offset:25600
    ds_read_b64_tr_b16 a[28:29], v242 offset:24584
    ds_read_b64_tr_b16 a[30:31], v242 offset:25608
    ds_read_b64_tr_b16 a[32:33], v242 offset:32768
    ds_read_b64_tr_b16 a[34:35], v242 offset:33792
    ds_read_b64_tr_b16 a[36:37], v242 offset:32776
    ds_read_b64_tr_b16 a[38:39], v242 offset:33800
    ds_read_b64_tr_b16 a[40:41], v242 offset:40960
    ds_read_b64_tr_b16 a[42:43], v242 offset:41984
    ds_read_b64_tr_b16 a[44:45], v242 offset:40968
    ds_read_b64_tr_b16 a[46:47], v242 offset:41992
    ds_read_b64_tr_b16 a[48:49], v242 offset:49152
    ds_read_b64_tr_b16 a[50:51], v242 offset:50176
    ds_read_b64_tr_b16 a[52:53], v242 offset:49160
    ds_read_b64_tr_b16 a[54:55], v242 offset:50184
    ds_read_b64_tr_b16 a[56:57], v242 offset:57344
    ds_read_b64_tr_b16 a[58:59], v242 offset:58368
    ds_read_b64_tr_b16 a[60:61], v242 offset:57352
    ds_read_b64_tr_b16 a[62:63], v242 offset:58376
    s_waitcnt lgkmcnt(0)
    s_barrier
    s_add_u32 m0, s6, 0
    s_mov_b32 s5, 1048576
    buffer_load_dwordx4 v240, s[16:19], s5 offen nt lds
    s_add_u32 m0, s6, 1024
    s_mov_b32 s5, 1056768
    buffer_load_dwordx4 v240, s[16:19], s5 offen nt lds
    s_add_u32 m0, s6, 2048
    s_mov_b32 s5, 1064960
    buffer_load_dwordx4 v240, s[16:19], s5 offen nt lds
    s_add_u32 m0, s6, 3072
    s_mov_b32 s5, 1073152
    buffer_load_dwordx4 v240, s[16:19], s5 offen nt lds
    s_add_u32 m0, s6, 4096
    s_mov_b32 s5, 1081344
    buffer_load_dwordx4 v240, s[16:19], s5 offen nt lds
    s_add_u32 m0, s6, 5120
    s_mov_b32 s5, 1089536
    buffer_load_dwordx4 v240, s[16:19], s5 offen nt lds
    s_add_u32 m0, s6, 6144
    s_mov_b32 s5, 1097728
    buffer_load_dwordx4 v240, s[16:19], s5 offen nt lds
    s_add_u32 m0, s6, 7168
    s_mov_b32 s5, 1105920
    buffer_load_dwordx4 v240, s[16:19], s5 offen nt lds
    s_add_u32 m0, s6, 8192
    s_mov_b32 s5, 1114112
    buffer_load_dwordx4 v240, s[16:19], s5 offen nt lds
    s_add_u32 m0, s6, 9216
    s_mov_b32 s5, 1122304
    buffer_load_dwordx4 v240, s[16:19], s5 offen nt lds
    s_add_u32 m0, s6, 10240
    s_mov_b32 s5, 1130496
    buffer_load_dwordx4 v240, s[16:19], s5 offen nt lds
    s_add_u32 m0, s6, 11264
    s_mov_b32 s5, 1138688
    buffer_load_dwordx4 v240, s[16:19], s5 offen nt lds
    s_add_u32 m0, s6, 12288
    s_mov_b32 s5, 1146880
    buffer_load_dwordx4 v240, s[16:19], s5 offen nt lds
    s_add_u32 m0, s6, 13312
    s_mov_b32 s5, 1155072
    buffer_load_dwordx4 v240, s[16:19], s5 offen nt lds
    s_add_u32 m0, s6, 14336
    s_mov_b32 s5, 1163264
    buffer_load_dwordx4 v240, s[16:19], s5 offen nt lds
    s_add_u32 m0, s6, 15360
    s_mov_b32 s5, 1171456
    buffer_load_dwordx4 v240, s[16:19], s5 offen nt lds
    s_waitcnt vmcnt(16)
    s_barrier
    ds_read_b64_tr_b16 a[64:65], v243 offset:0
    ds_read_b64_tr_b16 a[66:67], v243 offset:1024
    ds_read_b64_tr_b16 a[68:69], v243 offset:8
    ds_read_b64_tr_b16 a[70:71], v243 offset:1032
    ds_read_b64_tr_b16 a[72:73], v243 offset:8192
    ds_read_b64_tr_b16 a[74:75], v243 offset:9216
    ds_read_b64_tr_b16 a[76:77], v243 offset:8200
    ds_read_b64_tr_b16 a[78:79], v243 offset:9224
    ds_read_b64_tr_b16 a[80:81], v243 offset:16384
    ds_read_b64_tr_b16 a[82:83], v243 offset:17408
    ds_read_b64_tr_b16 a[84:85], v243 offset:16392
    ds_read_b64_tr_b16 a[86:87], v243 offset:17416
    ds_read_b64_tr_b16 a[88:89], v243 offset:24576
    ds_read_b64_tr_b16 a[90:91], v243 offset:25600
    ds_read_b64_tr_b16 a[92:93], v243 offset:24584
    ds_read_b64_tr_b16 a[94:95], v243 offset:25608
    ds_read_b64_tr_b16 a[96:97], v243 offset:32768
    ds_read_b64_tr_b16 a[98:99], v243 offset:33792
    ds_read_b64_tr_b16 a[100:101], v243 offset:32776
    ds_read_b64_tr_b16 a[102:103], v243 offset:33800
    ds_read_b64_tr_b16 a[104:105], v243 offset:40960
    ds_read_b64_tr_b16 a[106:107], v243 offset:41984
    ds_read_b64_tr_b16 a[108:109], v243 offset:40968
    ds_read_b64_tr_b16 a[110:111], v243 offset:41992
    ds_read_b64_tr_b16 a[112:113], v243 offset:49152
    ds_read_b64_tr_b16 a[114:115], v243 offset:50176
    ds_read_b64_tr_b16 a[116:117], v243 offset:49160
    ds_read_b64_tr_b16 a[118:119], v243 offset:50184
    ds_read_b64_tr_b16 a[120:121], v243 offset:57344
    ds_read_b64_tr_b16 a[122:123], v243 offset:58368
    ds_read_b64_tr_b16 a[124:125], v243 offset:57352
    ds_read_b64_tr_b16 a[126:127], v243 offset:58376
    s_waitcnt lgkmcnt(0)
    s_barrier
    s_add_u32 m0, s6, 65536
    s_mov_b32 s5, 1572864
    buffer_load_dwordx4 v240, s[16:19], s5 offen nt lds
    s_add_u32 m0, s6, 66560
    s_mov_b32 s5, 1581056
    buffer_load_dwordx4 v240, s[16:19], s5 offen nt lds
    s_add_u32 m0, s6, 67584
    s_mov_b32 s5, 1589248
    buffer_load_dwordx4 v240, s[16:19], s5 offen nt lds
    s_add_u32 m0, s6, 68608
    s_mov_b32 s5, 1597440
    buffer_load_dwordx4 v240, s[16:19], s5 offen nt lds
    s_add_u32 m0, s6, 69632
    s_mov_b32 s5, 1605632
    buffer_load_dwordx4 v240, s[16:19], s5 offen nt lds
    s_add_u32 m0, s6, 70656
    s_mov_b32 s5, 1613824
    buffer_load_dwordx4 v240, s[16:19], s5 offen nt lds
    s_add_u32 m0, s6, 71680
    s_mov_b32 s5, 1622016
    buffer_load_dwordx4 v240, s[16:19], s5 offen nt lds
    s_add_u32 m0, s6, 72704
    s_mov_b32 s5, 1630208
    buffer_load_dwordx4 v240, s[16:19], s5 offen nt lds
    s_add_u32 m0, s6, 73728
    s_mov_b32 s5, 1638400
    buffer_load_dwordx4 v240, s[16:19], s5 offen nt lds
    s_add_u32 m0, s6, 74752
    s_mov_b32 s5, 1646592
    buffer_load_dwordx4 v240, s[16:19], s5 offen nt lds
    s_add_u32 m0, s6, 75776
    s_mov_b32 s5, 1654784
    buffer_load_dwordx4 v240, s[16:19], s5 offen nt lds
    s_add_u32 m0, s6, 76800
    s_mov_b32 s5, 1662976
    buffer_load_dwordx4 v240, s[16:19], s5 offen nt lds
    s_add_u32 m0, s6, 77824
    s_mov_b32 s5, 1671168
    buffer_load_dwordx4 v240, s[16:19], s5 offen nt lds
    s_add_u32 m0, s6, 78848
    s_mov_b32 s5, 1679360
    buffer_load_dwordx4 v240, s[16:19], s5 offen nt lds
    s_add_u32 m0, s6, 79872
    s_mov_b32 s5, 1687552
    buffer_load_dwordx4 v240, s[16:19], s5 offen nt lds
    s_add_u32 m0, s6, 80896
    s_mov_b32 s5, 1695744
    buffer_load_dwordx4 v240, s[16:19], s5 offen nt lds
    s_waitcnt vmcnt(16)
    s_barrier
    ds_read_b64_tr_b16 a[128:129], v242 offset:0
    ds_read_b64_tr_b16 a[130:131], v242 offset:1024
    ds_read_b64_tr_b16 a[132:133], v242 offset:8
    ds_read_b64_tr_b16 a[134:135], v242 offset:1032
    ds_read_b64_tr_b16 a[136:137], v242 offset:8192
    ds_read_b64_tr_b16 a[138:139], v242 offset:9216
    ds_read_b64_tr_b16 a[140:141], v242 offset:8200
    ds_read_b64_tr_b16 a[142:143], v242 offset:9224
    ds_read_b64_tr_b16 a[144:145], v242 offset:16384
    ds_read_b64_tr_b16 a[146:147], v242 offset:17408
    ds_read_b64_tr_b16 a[148:149], v242 offset:16392
    ds_read_b64_tr_b16 a[150:151], v242 offset:17416
    ds_read_b64_tr_b16 a[152:153], v242 offset:24576
    ds_read_b64_tr_b16 a[154:155], v242 offset:25600
    ds_read_b64_tr_b16 a[156:157], v242 offset:24584
    ds_read_b64_tr_b16 a[158:159], v242 offset:25608
    ds_read_b64_tr_b16 a[160:161], v242 offset:32768
    ds_read_b64_tr_b16 a[162:163], v242 offset:33792
    ds_read_b64_tr_b16 a[164:165], v242 offset:32776
    ds_read_b64_tr_b16 a[166:167], v242 offset:33800
    ds_read_b64_tr_b16 a[168:169], v242 offset:40960
    ds_read_b64_tr_b16 a[170:171], v242 offset:41984
    ds_read_b64_tr_b16 a[172:173], v242 offset:40968
    ds_read_b64_tr_b16 a[174:175], v242 offset:41992
    ds_read_b64_tr_b16 a[176:177], v242 offset:49152
    ds_read_b64_tr_b16 a[178:179], v242 offset:50176
    ds_read_b64_tr_b16 a[180:181], v242 offset:49160
    ds_read_b64_tr_b16 a[182:183], v242 offset:50184
    ds_read_b64_tr_b16 a[184:185], v242 offset:57344
    ds_read_b64_tr_b16 a[186:187], v242 offset:58368
    ds_read_b64_tr_b16 a[188:189], v242 offset:57352
    ds_read_b64_tr_b16 a[190:191], v242 offset:58376
    s_waitcnt lgkmcnt(0)
    s_barrier
    s_waitcnt vmcnt(0)
    s_barrier
    ds_read_b64_tr_b16 a[192:193], v243 offset:0
    ds_read_b64_tr_b16 a[194:195], v243 offset:1024
    ds_read_b64_tr_b16 a[196:197], v243 offset:8
    ds_read_b64_tr_b16 a[198:199], v243 offset:1032
    ds_read_b64_tr_b16 a[200:201], v243 offset:8192
    ds_read_b64_tr_b16 a[202:203], v243 offset:9216
    ds_read_b64_tr_b16 a[204:205], v243 offset:8200
    ds_read_b64_tr_b16 a[206:207], v243 offset:9224
    ds_read_b64_tr_b16 a[208:209], v243 offset:16384
    ds_read_b64_tr_b16 a[210:211], v243 offset:17408
    ds_read_b64_tr_b16 a[212:213], v243 offset:16392
    ds_read_b64_tr_b16 a[214:215], v243 offset:17416
    ds_read_b64_tr_b16 a[216:217], v243 offset:24576
    ds_read_b64_tr_b16 a[218:219], v243 offset:25600
    ds_read_b64_tr_b16 a[220:221], v243 offset:24584
    ds_read_b64_tr_b16 a[222:223], v243 offset:25608
    ds_read_b64_tr_b16 a[224:225], v243 offset:32768
    ds_read_b64_tr_b16 a[226:227], v243 offset:33792
    ds_read_b64_tr_b16 a[228:229], v243 offset:32776
    ds_read_b64_tr_b16 a[230:231], v243 offset:33800
    ds_read_b64_tr_b16 a[232:233], v243 offset:40960
    ds_read_b64_tr_b16 a[234:235], v243 offset:41984
    ds_read_b64_tr_b16 a[236:237], v243 offset:40968
    ds_read_b64_tr_b16 a[238:239], v243 offset:41992
    ds_read_b64_tr_b16 a[240:241], v243 offset:49152
    ds_read_b64_tr_b16 a[242:243], v243 offset:50176
    ds_read_b64_tr_b16 a[244:245], v243 offset:49160
    ds_read_b64_tr_b16 a[246:247], v243 offset:50184
    ds_read_b64_tr_b16 a[248:249], v243 offset:57344
    ds_read_b64_tr_b16 a[250:251], v243 offset:58368
    ds_read_b64_tr_b16 a[252:253], v243 offset:57352
    ds_read_b64_tr_b16 a[254:255], v243 offset:58376
    s_waitcnt lgkmcnt(0)
    s_barrier
.cold_439:
    s_mov_b32 s62, 0
.gp_443:
    buffer_load_dwordx4 v[12:15], v7, s[8:11], 0 offen sc1
    s_add_u32 s62, s62, 1
    s_cmp_gt_u32 s62, 0x200000
    s_cbranch_scc1 .mg_end_1
    s_waitcnt vmcnt(0)
    v_min3_u32 v4, v12, v13, v14
    v_min_u32 v4, v4, v15
    s_nop 1
    v_min_u32_dpp v4, v4, v4 quad_perm:[1,0,3,2] row_mask:0xf bank_mask:0xf
    s_nop 1
    v_min_u32_dpp v4, v4, v4 quad_perm:[2,3,0,1] row_mask:0xf bank_mask:0xf
    s_nop 1
    v_min_u32_dpp v4, v4, v4 row_half_mirror row_mask:0xf bank_mask:0xf
    s_nop 1
    v_readfirstlane_b32 s33, v4
    s_cmp_gt_u32 s33, s28
    s_cbranch_scc1 .go_440
    s_sleep 4
    s_branch .gp_443
.go_440:
    s_add_u32 m0, s36, 0
    s_add_u32 s31, s29, 0
    buffer_load_dwordx4 v9, s[8:11], s31 offen offset:0 sc1 lds
    buffer_load_dwordx4 v9, s[8:11], s31 offen offset:1024 sc1 lds
    buffer_load_dwordx4 v9, s[8:11], s31 offen offset:2048 sc1 lds
    buffer_load_dwordx4 v9, s[8:11], s31 offen offset:3072 sc1 lds
    s_add_u32 m0, s36, 16384
    s_add_u32 s31, s29, 16384
    buffer_load_dwordx4 v9, s[8:11], s31 offen offset:0 sc1 lds
    buffer_load_dwordx4 v9, s[8:11], s31 offen offset:1024 sc1 lds
    buffer_load_dwordx4 v9, s[8:11], s31 offen offset:2048 sc1 lds
    buffer_load_dwordx4 v9, s[8:11], s31 offen offset:3072 sc1 lds
.body_441:
    s_waitcnt vmcnt(4)
    s_barrier
    ds_read_b128 v[64:67], v8 offset:0
    ds_read_b128 v[68:71], v8 offset:4096
    ds_read_b128 v[72:75], v8 offset:1024
    ds_read_b128 v[76:79], v8 offset:5120
    ds_read_b128 v[80:83], v8 offset:2048
    ds_read_b128 v[84:87], v8 offset:6144
    ds_read_b128 v[88:91], v8 offset:3072
    ds_read_b128 v[92:95], v8 offset:7168
    s_waitcnt lgkmcnt(6)
    v_mfma_f32_16x16x32_bf16 v[192:195], a[0:3], v[64:67], 0
    s_add_u32 m0, s36, 32768
    s_add_u32 s31, s29, 32768
    v_mfma_f32_16x16x32_bf16 v[196:199], a[4:7], v[64:67], 0
    buffer_load_dwordx4 v9, s[8:11], s31 offen offset:0 sc1 lds
    v_mfma_f32_16x16x32_bf16 v[200:203], a[0:3], v[68:71], 0
    ds_read_b128 v[96:99], v8 offset:8192
    ds_read_b128 v[100:103], v8 offset:12288
    v_mfma_f32_16x16x32_bf16 v[204:207], a[4:7], v[68:71], 0
    ds_read_b128 v[104:107], v8 offset:9216
    s_waitcnt lgkmcnt(7)
    v_mfma_f32_16x16x32_bf16 v[192:195], a[8:11], v[72:75], v[192:195]
    ds_read_b128 v[108:111], v8 offset:13312
    ds_read_b128 v[112:115], v8 offset:10240
    v_mfma_f32_16x16x32_bf16 v[196:199], a[12:15], v[72:75], v[196:199]
    buffer_load_dwordx4 v9, s[8:11], s31 offen offset:1024 sc1 lds
    v_mfma_f32_16x16x32_bf16 v[200:203], a[8:11], v[76:79], v[200:203]
    ds_read_b128 v[116:119], v8 offset:14336
    ds_read_b128 v[120:123], v8 offset:11264
    v_mfma_f32_16x16x32_bf16 v[204:207], a[12:15], v[76:79], v[204:207]
    ds_read_b128 v[124:127], v8 offset:15360
    s_waitcnt lgkmcnt(10)
    v_mfma_f32_16x16x32_bf16 v[192:195], a[16:19], v[80:83], v[192:195]
    buffer_load_dwordx4 v9, s[8:11], s31 offen offset:2048 sc1 lds
    v_mfma_f32_16x16x32_bf16 v[196:199], a[20:23], v[80:83], v[196:199]
    v_mfma_f32_16x16x32_bf16 v[200:203], a[16:19], v[84:87], v[200:203]
    v_mfma_f32_16x16x32_bf16 v[204:207], a[20:23], v[84:87], v[204:207]
    s_waitcnt lgkmcnt(8)
    v_mfma_f32_16x16x32_bf16 v[192:195], a[24:27], v[88:91], v[192:195]
    buffer_load_dwordx4 v9, s[8:11], s31 offen offset:3072 sc1 lds
    v_mfma_f32_16x16x32_bf16 v[196:199], a[28:31], v[88:91], v[196:199]
    v_mfma_f32_16x16x32_bf16 v[200:203], a[24:27], v[92:95], v[200:203]
    s_waitcnt vmcnt(4)
    s_barrier
    v_mfma_f32_16x16x32_bf16 v[204:207], a[28:31], v[92:95], v[204:207]
    ds_read_b128 v[128:131], v8 offset:16384
    s_waitcnt lgkmcnt(5)
    v_mfma_f32_16x16x32_bf16 v[192:195], a[32:35], v[96:99], v[192:195]
    s_add_u32 m0, s36, 49152
    s_add_u32 s31, s29, 49152
    v_mfma_f32_16x16x32_bf16 v[196:199], a[36:39], v[96:99], v[196:199]
    buffer_load_dwordx4 v9, s[8:11], s31 offen offset:0 sc1 lds
    v_mfma_f32_16x16x32_bf16 v[200:203], a[32:35], v[100:103], v[200:203]
    ds_read_b128 v[132:135], v8 offset:20480
    ds_read_b128 v[136:139], v8 offset:17408
    v_mfma_f32_16x16x32_bf16 v[204:207], a[36:39], v[100:103], v[204:207]
    ds_read_b128 v[140:143], v8 offset:21504
    ds_read_b128 v[144:147], v8 offset:18432
    v_mfma_f32_16x16x32_bf16 v[192:195], a[40:43], v[104:107], v[192:195]
    buffer_load_dwordx4 v9, s[8:11], s31 offen offset:1024 sc1 lds
    v_mfma_f32_16x16x32_bf16 v[196:199], a[44:47], v[104:107], v[196:199]
    ds_read_b128 v[148:151], v8 offset:22528
    ds_read_b128 v[152:155], v8 offset:19456
    v_mfma_f32_16x16x32_bf16 v[200:203], a[40:43], v[108:111], v[200:203]
    ds_read_b128 v[156:159], v8 offset:23552
    ds_read_b128 v[160:163], v8 offset:24576
    v_mfma_f32_16x16x32_bf16 v[204:207], a[44:47], v[108:111], v[204:207]
    ds_read_b128 v[164:167], v8 offset:28672
    s_waitcnt lgkmcnt(10)
    v_mfma_f32_16x16x32_bf16 v[192:195], a[48:51], v[112:115], v[192:195]
    buffer_load_dwordx4 v9, s[8:11], s31 offen offset:2048 sc1 lds
    v_mfma_f32_16x16x32_bf16 v[196:199], a[52:55], v[112:115], v[196:199]
    ds_read_b128 v[168:171], v8 offset:25600
    ds_read_b128 v[172:175], v8 offset:29696
    v_mfma_f32_16x16x32_bf16 v[200:203], a[48:51], v[116:119], v[200:203]
    ds_read_b128 v[176:179], v8 offset:26624
    ds_read_b128 v[180:183], v8 offset:30720
    v_mfma_f32_16x16x32_bf16 v[204:207], a[52:55], v[116:119], v[204:207]
    buffer_load_dwordx4 v9, s[8:11], s31 offen offset:3072 sc1 lds
    v_mfma_f32_16x16x32_bf16 v[192:195], a[56:59], v[120:123], v[192:195]
    ds_read_b128 v[184:187], v8 offset:27648
    ds_read_b128 v[188:191], v8 offset:31744
    v_mfma_f32_16x16x32_bf16 v[196:199], a[60:63], v[120:123], v[196:199]
    buffer_load_dwordx4 v[12:15], v7, s[8:11], 0 offen sc1
    s_xor_b32 s36, s36, 0x10000
    v_mfma_f32_16x16x32_bf16 v[200:203], a[56:59], v[124:127], v[200:203]
    s_add_u32 s29, s29, 0x40000
    v_mfma_f32_16x16x32_bf16 v[204:207], a[60:63], v[124:127], v[204:207]
    s_waitcnt lgkmcnt(12)
    v_mfma_f32_16x16x32_bf16 v[192:195], a[64:67], v[128:131], v[192:195]
    v_mfma_f32_16x16x32_bf16 v[196:199], a[68:71], v[128:131], v[196:199]
    v_mfma_f32_16x16x32_bf16 v[200:203], a[64:67], v[132:135], v[200:203]
    v_mfma_f32_16x16x32_bf16 v[204:207], a[68:71], v[132:135], v[204:207]
    v_mfma_f32_16x16x32_bf16 v[192:195], a[72:75], v[136:139], v[192:195]
    v_mfma_f32_16x16x32_bf16 v[196:199], a[76:79], v[136:139], v[196:199]
    v_mfma_f32_16x16x32_bf16 v[200:203], a[72:75], v[140:143], v[200:203]
    v_mfma_f32_16x16x32_bf16 v[204:207], a[76:79], v[140:143], v[204:207]
    s_waitcnt lgkmcnt(8)
    v_mfma_f32_16x16x32_bf16 v[192:195], a[80:83], v[144:147], v[192:195]
    v_mfma_f32_16x16x32_bf16 v[196:199], a[84:87], v[144:147], v[196:199]
    v_mfma_f32_16x16x32_bf16 v[200:203], a[80:83], v[148:151], v[200:203]
    v_mfma_f32_16x16x32_bf16 v[204:207], a[84:87], v[148:151], v[204:207]
    v_mfma_f32_16x16x32_bf16 v[192:195], a[88:91], v[152:155], v[192:195]
    v_mfma_f32_16x16x32_bf16 v[196:199], a[92:95], v[152:155], v[196:199]
    v_mfma_f32_16x16x32_bf16 v[200:203], a[88:91], v[156:159], v[200:203]
    v_mfma_f32_16x16x32_bf16 v[204:207], a[92:95], v[156:159], v[204:207]
    s_waitcnt lgkmcnt(4)
    v_mfma_f32_16x16x32_bf16 v[192:195], a[96:99], v[160:163], v[192:195]
    v_mfma_f32_16x16x32_bf16 v[196:199], a[100:103], v[160:163], v[196:199]
    v_mfma_f32_16x16x32_bf16 v[200:203], a[96:99], v[164:167], v[200:203]
    s_waitcnt vmcnt(0)
    s_barrier
    v_mfma_f32_16x16x32_bf16 v[204:207], a[100:103], v[164:167], v[204:207]
    ds_read_b128 v[64:67], v8 offset:32768
    ds_read_b128 v[68:71], v8 offset:36864
    v_mfma_f32_16x16x32_bf16 v[192:195], a[104:107], v[168:171], v[192:195]
    ds_read_b128 v[72:75], v8 offset:33792
    ds_read_b128 v[76:79], v8 offset:37888
    v_mfma_f32_16x16x32_bf16 v[196:199], a[108:111], v[168:171], v[196:199]
    ds_read_b128 v[80:83], v8 offset:34816
    ds_read_b128 v[84:87], v8 offset:38912
    v_mfma_f32_16x16x32_bf16 v[200:203], a[104:107], v[172:175], v[200:203]
    s_cmp_lg_u32 s39, 0
    s_cbranch_scc1 .pd_445
.pdb_446:
    v_mfma_f32_16x16x32_bf16 v[204:207], a[108:111], v[172:175], v[204:207]
    ds_read_b128 v[88:91], v8 offset:35840
    s_waitcnt lgkmcnt(7)
    v_mfma_f32_16x16x32_bf16 v[192:195], a[112:115], v[176:179], v[192:195]
    ds_read_b128 v[92:95], v8 offset:39936
    s_xor_b32 s30, s28, s38
    v_mfma_f32_16x16x32_bf16 v[196:199], a[116:119], v[176:179], v[196:199]
    s_lshl_b32 s30, s30, 12
    s_add_u32 s30, s30, s37
    v_mfma_f32_16x16x32_bf16 v[200:203], a[112:115], v[180:183], v[200:203]
    s_add_u32 s28, s28, 1
    v_min3_u32 v4, v12, v13, v14
    v_min_u32 v4, v4, v15
    v_mfma_f32_16x16x32_bf16 v[204:207], a[116:119], v[180:183], v[204:207]
    ds_read_b128 v[96:99], v8 offset:40960
    ds_read_b128 v[100:103], v8 offset:45056
    v_mfma_f32_16x16x32_bf16 v[192:195], a[120:123], v[184:187], v[192:195]
    v_min_u32_dpp v4, v4, v4 quad_perm:[1,0,3,2] row_mask:0xf bank_mask:0xf
    ds_read_b128 v[104:107], v8 offset:41984
    v_mfma_f32_16x16x32_bf16 v[196:199], a[124:127], v[184:187], v[196:199]
    ds_read_b128 v[108:111], v8 offset:46080
    ds_read_b128 v[112:115], v8 offset:43008
    v_mfma_f32_16x16x32_bf16 v[200:203], a[120:123], v[188:191], v[200:203]
    v_min_u32_dpp v4, v4, v4 quad_perm:[2,3,0,1] row_mask:0xf bank_mask:0xf
    ds_read_b128 v[116:119], v8 offset:47104
    v_mfma_f32_16x16x32_bf16 v[204:207], a[124:127], v[188:191], v[204:207]
    ds_read_b128 v[120:123], v8 offset:44032
    s_waitcnt lgkmcnt(11)
    v_mfma_f32_16x16x32_bf16 v[192:195], a[128:131], v[64:67], v[192:195]
    v_min_u32_dpp v4, v4, v4 row_half_mirror row_mask:0xf bank_mask:0xf
    ds_read_b128 v[124:127], v8 offset:48128
    v_mfma_f32_16x16x32_bf16 v[196:199], a[132:135], v[64:67], v[196:199]
    ds_read_b128 v[128:131], v8 offset:49152
    ds_read_b128 v[132:135], v8 offset:53248
    v_mfma_f32_16x16x32_bf16 v[200:203], a[128:131], v[68:71], v[200:203]
    v_readfirstlane_b32 s33, v4
    s_cmp_gt_u32 s33, s28
    s_cbranch_scc1 .hot_442
    v_mfma_f32_16x16x32_bf16 v[204:207], a[132:135], v[68:71], v[204:207]
    ds_read_b128 v[136:139], v8 offset:50176
    ds_read_b128 v[140:143], v8 offset:54272
    v_mfma_f32_16x16x32_bf16 v[192:195], a[136:139], v[72:75], v[192:195]
    ds_read_b128 v[144:147], v8 offset:51200
    ds_read_b128 v[148:151], v8 offset:55296
    v_mfma_f32_16x16x32_bf16 v[196:199], a[140:143], v[72:75], v[196:199]
    ds_read_b128 v[152:155], v8 offset:52224
    ds_read_b128 v[156:159], v8 offset:56320
    v_mfma_f32_16x16x32_bf16 v[200:203], a[136:139], v[76:79], v[200:203]
    ds_read_b128 v[160:163], v8 offset:57344
    ds_read_b128 v[164:167], v8 offset:61440
    v_mfma_f32_16x16x32_bf16 v[204:207], a[140:143], v[76:79], v[204:207]
    ds_read_b128 v[168:171], v8 offset:58368
    s_waitcnt lgkmcnt(15)
    v_mfma_f32_16x16x32_bf16 v[192:195], a[144:147], v[80:83], v[192:195]
    ds_read_b128 v[172:175], v8 offset:62464
    ds_read_b128 v[176:179], v8 offset:59392
    v_mfma_f32_16x16x32_bf16 v[196:199], a[148:151], v[80:83], v[196:199]
    ds_read_b128 v[180:183], v8 offset:63488
    ds_read_b128 v[184:187], v8 offset:60416
    v_mfma_f32_16x16x32_bf16 v[200:203], a[144:147], v[84:87], v[200:203]
    ds_read_b128 v[188:191], v8 offset:64512
    v_xor_b32 v8, 0x10000, v8
    v_mfma_f32_16x16x32_bf16 v[204:207], a[148:151], v[84:87], v[204:207]
    v_mfma_f32_16x16x32_bf16 v[192:195], a[152:155], v[88:91], v[192:195]
    v_mfma_f32_16x16x32_bf16 v[196:199], a[156:159], v[88:91], v[196:199]
    v_mfma_f32_16x16x32_bf16 v[200:203], a[152:155], v[92:95], v[200:203]
    v_mfma_f32_16x16x32_bf16 v[204:207], a[156:159], v[92:95], v[204:207]
    v_mfma_f32_16x16x32_bf16 v[192:195], a[160:163], v[96:99], v[192:195]
    v_mfma_f32_16x16x32_bf16 v[196:199], a[164:167], v[96:99], v[196:199]
    v_mfma_f32_16x16x32_bf16 v[200:203], a[160:163], v[100:103], v[200:203]
    v_mfma_f32_16x16x32_bf16 v[204:207], a[164:167], v[100:103], v[204:207]
    v_mfma_f32_16x16x32_bf16 v[192:195], a[168:171], v[104:107], v[192:195]
    v_mfma_f32_16x16x32_bf16 v[196:199], a[172:175], v[104:107], v[196:199]
    v_mfma_f32_16x16x32_bf16 v[200:203], a[168:171], v[108:111], v[200:203]
    v_mfma_f32_16x16x32_bf16 v[204:207], a[172:175], v[108:111], v[204:207]
    s_waitcnt lgkmcnt(15)
    v_mfma_f32_16x16x32_bf16 v[192:195], a[176:179], v[112:115], v[192:195]
    v_mfma_f32_16x16x32_bf16 v[196:199], a[180:183], v[112:115], v[196:199]
    v_mfma_f32_16x16x32_bf16 v[200:203], a[176:179], v[116:119], v[200:203]
    v_mfma_f32_16x16x32_bf16 v[204:207], a[180:183], v[116:119], v[204:207]
    v_mfma_f32_16x16x32_bf16 v[192:195], a[184:187], v[120:123], v[192:195]
    buffer_load_dwordx4 v[12:15], v7, s[8:11], 0 offen sc1
    v_mfma_f32_16x16x32_bf16 v[196:199], a[188:191], v[120:123], v[196:199]
    v_mfma_f32_16x16x32_bf16 v[200:203], a[184:187], v[124:127], v[200:203]
    v_mfma_f32_16x16x32_bf16 v[204:207], a[188:191], v[124:127], v[204:207]
    s_waitcnt lgkmcnt(12)
    v_mfma_f32_16x16x32_bf16 v[192:195], a[192:195], v[128:131], v[192:195]
    v_mfma_f32_16x16x32_bf16 v[196:199], a[196:199], v[128:131], v[196:199]
    v_mfma_f32_16x16x32_bf16 v[200:203], a[192:195], v[132:135], v[200:203]
    v_mfma_f32_16x16x32_bf16 v[204:207], a[196:199], v[132:135], v[204:207]
    v_mfma_f32_16x16x32_bf16 v[192:195], a[200:203], v[136:139], v[192:195]
    v_mfma_f32_16x16x32_bf16 v[196:199], a[204:207], v[136:139], v[196:199]
    v_mfma_f32_16x16x32_bf16 v[200:203], a[200:203], v[140:143], v[200:203]
    v_mfma_f32_16x16x32_bf16 v[204:207], a[204:207], v[140:143], v[204:207]
    s_waitcnt lgkmcnt(8)
    v_mfma_f32_16x16x32_bf16 v[192:195], a[208:211], v[144:147], v[192:195]
    v_mfma_f32_16x16x32_bf16 v[196:199], a[212:215], v[144:147], v[196:199]
    v_mfma_f32_16x16x32_bf16 v[200:203], a[208:211], v[148:151], v[200:203]
    v_mfma_f32_16x16x32_bf16 v[204:207], a[212:215], v[148:151], v[204:207]
    v_mfma_f32_16x16x32_bf16 v[192:195], a[216:219], v[152:155], v[192:195]
    v_mfma_f32_16x16x32_bf16 v[196:199], a[220:223], v[152:155], v[196:199]
    v_mfma_f32_16x16x32_bf16 v[200:203], a[216:219], v[156:159], v[200:203]
    v_mfma_f32_16x16x32_bf16 v[204:207], a[220:223], v[156:159], v[204:207]
    s_waitcnt lgkmcnt(4)
    v_mfma_f32_16x16x32_bf16 v[192:195], a[224:227], v[160:163], v[192:195]
    v_mfma_f32_16x16x32_bf16 v[196:199], a[228:231], v[160:163], v[196:199]
    v_mfma_f32_16x16x32_bf16 v[200:203], a[224:227], v[164:167], v[200:203]
    v_mfma_f32_16x16x32_bf16 v[204:207], a[228:231], v[164:167], v[204:207]
    v_mfma_f32_16x16x32_bf16 v[192:195], a[232:235], v[168:171], v[192:195]
    v_mfma_f32_16x16x32_bf16 v[196:199], a[236:239], v[168:171], v[196:199]
    v_mfma_f32_16x16x32_bf16 v[200:203], a[232:235], v[172:175], v[200:203]
    s_waitcnt vmcnt(0)
    v_min3_u32 v4, v12, v13, v14
    v_min_u32 v4, v4, v15
    v_mfma_f32_16x16x32_bf16 v[204:207], a[236:239], v[172:175], v[204:207]
    s_waitcnt lgkmcnt(0)
    v_mfma_f32_16x16x32_bf16 v[192:195], a[240:243], v[176:179], v[192:195]
    v_min_u32_dpp v4, v4, v4 quad_perm:[1,0,3,2] row_mask:0xf bank_mask:0xf
    v_mfma_f32_16x16x32_bf16 v[196:199], a[244:247], v[176:179], v[196:199]
    v_mfma_f32_16x16x32_bf16 v[200:203], a[240:243], v[180:183], v[200:203]
    v_min_u32_dpp v4, v4, v4 quad_perm:[2,3,0,1] row_mask:0xf bank_mask:0xf
    v_mfma_f32_16x16x32_bf16 v[204:207], a[244:247], v[180:183], v[204:207]
    v_mfma_f32_16x16x32_bf16 v[192:195], a[248:251], v[184:187], v[192:195]
    v_min_u32_dpp v4, v4, v4 row_half_mirror row_mask:0xf bank_mask:0xf
    v_mfma_f32_16x16x32_bf16 v[196:199], a[252:255], v[184:187], v[196:199]
    v_mfma_f32_16x16x32_bf16 v[200:203], a[248:251], v[188:191], v[200:203]
    v_readfirstlane_b32 s33, v4
    v_mfma_f32_16x16x32_bf16 v[204:207], a[252:255], v[188:191], v[204:207]
    s_cmp_gt_u32 s33, s28
    s_cbranch_scc1 .gx_444
    s_nop 5
    buffer_store_dwordx4 v[192:195], v2, s[8:11], s30 offen offset:0 sc1
    buffer_store_dwordx4 v[196:199], v2, s[8:11], s30 offen offset:1024 sc1
    buffer_store_dwordx4 v[200:203], v2, s[8:11], s30 offen offset:2048 sc1
    buffer_store_dwordx4 v[204:207], v2, s[8:11], s30 offen offset:3072 sc1
    s_mov_b32 s39, 0
    s_waitcnt vmcnt(0)
    v_mov_b32 v27, s28
    s_mov_b64 exec, 1
    buffer_store_dword v27, v26, s[8:11], s94 offen sc1
    s_mov_b64 exec, -1
    s_cmp_lt_u32 s28, 64
    s_cbranch_scc1 .cold_439
    s_endpgm
.gx_444:
    s_add_u32 m0, s36, 0
    s_add_u32 s31, s29, 0
    buffer_load_dwordx4 v9, s[8:11], s31 offen offset:0 sc1 lds
    buffer_load_dwordx4 v9, s[8:11], s31 offen offset:1024 sc1 lds
    buffer_load_dwordx4 v9, s[8:11], s31 offen offset:2048 sc1 lds
    buffer_load_dwordx4 v9, s[8:11], s31 offen offset:3072 sc1 lds
    s_add_u32 m0, s36, 16384
    s_add_u32 s31, s29, 16384
    buffer_load_dwordx4 v9, s[8:11], s31 offen offset:0 sc1 lds
    buffer_load_dwordx4 v9, s[8:11], s31 offen offset:1024 sc1 lds
    buffer_load_dwordx4 v9, s[8:11], s31 offen offset:2048 sc1 lds
    buffer_load_dwordx4 v9, s[8:11], s31 offen offset:3072 sc1 lds
    s_branch .cpy_447
.hot_442:
    v_mfma_f32_16x16x32_bf16 v[204:207], a[132:135], v[68:71], v[204:207]
    s_add_u32 m0, s36, 0
    s_add_u32 s31, s29, 0
    v_mfma_f32_16x16x32_bf16 v[192:195], a[136:139], v[72:75], v[192:195]
    buffer_load_dwordx4 v9, s[8:11], s31 offen offset:0 sc1 lds
    v_mfma_f32_16x16x32_bf16 v[196:199], a[140:143], v[72:75], v[196:199]
    ds_read_b128 v[136:139], v8 offset:50176
    ds_read_b128 v[140:143], v8 offset:54272
    v_mfma_f32_16x16x32_bf16 v[200:203], a[136:139], v[76:79], v[200:203]
    ds_read_b128 v[144:147], v8 offset:51200
    ds_read_b128 v[148:151], v8 offset:55296
    v_mfma_f32_16x16x32_bf16 v[204:207], a[140:143], v[76:79], v[204:207]
    ds_read_b128 v[152:155], v8 offset:52224
    s_waitcnt lgkmcnt(15)
    v_mfma_f32_16x16x32_bf16 v[192:195], a[144:147], v[80:83], v[192:195]
    ds_read_b128 v[156:159], v8 offset:56320
    ds_read_b128 v[160:163], v8 offset:57344
    v_mfma_f32_16x16x32_bf16 v[196:199], a[148:151], v[80:83], v[196:199]
    buffer_load_dwordx4 v9, s[8:11], s31 offen offset:1024 sc1 lds
    v_mfma_f32_16x16x32_bf16 v[200:203], a[144:147], v[84:87], v[200:203]
    ds_read_b128 v[164:167], v8 offset:61440
    ds_read_b128 v[168:171], v8 offset:58368
    v_mfma_f32_16x16x32_bf16 v[204:207], a[148:151], v[84:87], v[204:207]
    ds_read_b128 v[172:175], v8 offset:62464
    ds_read_b128 v[176:179], v8 offset:59392
    v_mfma_f32_16x16x32_bf16 v[192:195], a[152:155], v[88:91], v[192:195]
    ds_read_b128 v[180:183], v8 offset:63488
    ds_read_b128 v[184:187], v8 offset:60416
    v_mfma_f32_16x16x32_bf16 v[196:199], a[156:159], v[88:91], v[196:199]
    ds_read_b128 v[188:191], v8 offset:64512
    v_xor_b32 v8, 0x10000, v8
    v_mfma_f32_16x16x32_bf16 v[200:203], a[152:155], v[92:95], v[200:203]
    buffer_load_dwordx4 v9, s[8:11], s31 offen offset:2048 sc1 lds
    v_mfma_f32_16x16x32_bf16 v[204:207], a[156:159], v[92:95], v[204:207]
    s_waitcnt lgkmcnt(15)
    v_mfma_f32_16x16x32_bf16 v[192:195], a[160:163], v[96:99], v[192:195]
    v_mfma_f32_16x16x32_bf16 v[196:199], a[164:167], v[96:99], v[196:199]
    v_mfma_f32_16x16x32_bf16 v[200:203], a[160:163], v[100:103], v[200:203]
    v_mfma_f32_16x16x32_bf16 v[204:207], a[164:167], v[100:103], v[204:207]
    buffer_load_dwordx4 v9, s[8:11], s31 offen offset:3072 sc1 lds
    v_mfma_f32_16x16x32_bf16 v[192:195], a[168:171], v[104:107], v[192:195]
    v_mfma_f32_16x16x32_bf16 v[196:199], a[172:175], v[104:107], v[196:199]
    v_mfma_f32_16x16x32_bf16 v[200:203], a[168:171], v[108:111], v[200:203]
    v_mfma_f32_16x16x32_bf16 v[204:207], a[172:175], v[108:111], v[204:207]
    v_mfma_f32_16x16x32_bf16 v[192:195], a[176:179], v[112:115], v[192:195]
    s_add_u32 m0, s36, 16384
    s_add_u32 s31, s29, 16384
    v_mfma_f32_16x16x32_bf16 v[196:199], a[180:183], v[112:115], v[196:199]
    buffer_load_dwordx4 v9, s[8:11], s31 offen offset:0 sc1 lds
    v_mfma_f32_16x16x32_bf16 v[200:203], a[176:179], v[116:119], v[200:203]
    v_mfma_f32_16x16x32_bf16 v[204:207], a[180:183], v[116:119], v[204:207]
    v_mfma_f32_16x16x32_bf16 v[192:195], a[184:187], v[120:123], v[192:195]
    v_mfma_f32_16x16x32_bf16 v[196:199], a[188:191], v[120:123], v[196:199]
    v_mfma_f32_16x16x32_bf16 v[200:203], a[184:187], v[124:127], v[200:203]
    buffer_load_dwordx4 v9, s[8:11], s31 offen offset:1024 sc1 lds
    v_mfma_f32_16x16x32_bf16 v[204:207], a[188:191], v[124:127], v[204:207]
    s_waitcnt lgkmcnt(12)
    v_mfma_f32_16x16x32_bf16 v[192:195], a[192:195], v[128:131], v[192:195]
    v_mfma_f32_16x16x32_bf16 v[196:199], a[196:199], v[128:131], v[196:199]
    v_mfma_f32_16x16x32_bf16 v[200:203], a[192:195], v[132:135], v[200:203]
    v_mfma_f32_16x16x32_bf16 v[204:207], a[196:199], v[132:135], v[204:207]
    buffer_load_dwordx4 v9, s[8:11], s31 offen offset:2048 sc1 lds
    v_mfma_f32_16x16x32_bf16 v[192:195], a[200:203], v[136:139], v[192:195]
    v_mfma_f32_16x16x32_bf16 v[196:199], a[204:207], v[136:139], v[196:199]
    v_mfma_f32_16x16x32_bf16 v[200:203], a[200:203], v[140:143], v[200:203]
    v_mfma_f32_16x16x32_bf16 v[204:207], a[204:207], v[140:143], v[204:207]
    s_waitcnt lgkmcnt(8)
    v_mfma_f32_16x16x32_bf16 v[192:195], a[208:211], v[144:147], v[192:195]
    buffer_load_dwordx4 v9, s[8:11], s31 offen offset:3072 sc1 lds
    v_mfma_f32_16x16x32_bf16 v[196:199], a[212:215], v[144:147], v[196:199]
    v_mfma_f32_16x16x32_bf16 v[200:203], a[208:211], v[148:151], v[200:203]
    v_mfma_f32_16x16x32_bf16 v[204:207], a[212:215], v[148:151], v[204:207]
    v_mfma_f32_16x16x32_bf16 v[192:195], a[216:219], v[152:155], v[192:195]
    v_mfma_f32_16x16x32_bf16 v[196:199], a[220:223], v[152:155], v[196:199]
    v_mfma_f32_16x16x32_bf16 v[200:203], a[216:219], v[156:159], v[200:203]
    v_mfma_f32_16x16x32_bf16 v[204:207], a[220:223], v[156:159], v[204:207]
    s_waitcnt lgkmcnt(4)
    v_mfma_f32_16x16x32_bf16 v[192:195], a[224:227], v[160:163], v[192:195]
    v_mfma_f32_16x16x32_bf16 v[196:199], a[228:231], v[160:163], v[196:199]
    v_mfma_f32_16x16x32_bf16 v[200:203], a[224:227], v[164:167], v[200:203]
    v_mfma_f32_16x16x32_bf16 v[204:207], a[228:231], v[164:167], v[204:207]
    v_mfma_f32_16x16x32_bf16 v[192:195], a[232:235], v[168:171], v[192:195]
    v_mfma_f32_16x16x32_bf16 v[196:199], a[236:239], v[168:171], v[196:199]
    v_mfma_f32_16x16x32_bf16 v[200:203], a[232:235], v[172:175], v[200:203]
    v_mfma_f32_16x16x32_bf16 v[204:207], a[236:239], v[172:175], v[204:207]
    s_waitcnt lgkmcnt(0)
    v_mfma_f32_16x16x32_bf16 v[192:195], a[240:243], v[176:179], v[192:195]
    v_mfma_f32_16x16x32_bf16 v[196:199], a[244:247], v[176:179], v[196:199]
    v_mfma_f32_16x16x32_bf16 v[200:203], a[240:243], v[180:183], v[200:203]
    v_mfma_f32_16x16x32_bf16 v[204:207], a[244:247], v[180:183], v[204:207]
    v_mfma_f32_16x16x32_bf16 v[192:195], a[248:251], v[184:187], v[192:195]
    v_mfma_f32_16x16x32_bf16 v[196:199], a[252:255], v[184:187], v[196:199]
    v_mfma_f32_16x16x32_bf16 v[200:203], a[248:251], v[188:191], v[200:203]
    v_mfma_f32_16x16x32_bf16 v[204:207], a[252:255], v[188:191], v[204:207]
.cpy_447:
    s_mov_b32 s39, 1
    s_nop 2
    v_pk_mov_b32 v[208:209], v[192:193], v[192:193] op_sel:[0,1]
    v_pk_mov_b32 v[210:211], v[194:195], v[194:195] op_sel:[0,1]
    v_pk_mov_b32 v[212:213], v[196:197], v[196:197] op_sel:[0,1]
    v_pk_mov_b32 v[214:215], v[198:199], v[198:199] op_sel:[0,1]
    v_pk_mov_b32 v[216:217], v[200:201], v[200:201] op_sel:[0,1]
    v_pk_mov_b32 v[218:219], v[202:203], v[202:203] op_sel:[0,1]
    v_pk_mov_b32 v[220:221], v[204:205], v[204:205] op_sel:[0,1]
    v_pk_mov_b32 v[222:223], v[206:207], v[206:207] op_sel:[0,1]
    s_branch .body_441
.pd_445:
    s_sub_u32 s4, s28, 1
    v_mov_b32 v27, s4
    s_mov_b64 exec, 1
    buffer_store_dword v27, v26, s[8:11], s94 offen sc1
    s_mov_b64 exec, -1
    buffer_store_dwordx4 v[208:211], v2, s[8:11], s30 offen offset:0 sc1
    buffer_store_dwordx4 v[212:215], v2, s[8:11], s30 offen offset:1024 sc1
    buffer_store_dwordx4 v[216:219], v2, s[8:11], s30 offen offset:2048 sc1
    buffer_store_dwordx4 v[220:223], v2, s[8:11], s30 offen offset:3072 sc1
    s_branch .pdb_446
.fin_350:
    s_load_dwordx2 s[44:45], s[0:1], 112
    s_sub_u32 s34, s98, 1
    s_lshl_b32 s4, s34, 11
    s_lshr_b32 s5, s99, 2
    s_lshl_b32 s5, s5, 22
    s_add_u32 s4, s4, s5
    s_and_b32 s5, s99, 3
    s_lshl_b32 s5, s5, 18
    s_add_u32 s4, s4, s5
    s_lshl_b32 s38, s99, 1
    v_lshlrev_b32 v2, 4, v1
    v_add_u32 v2, s4, v2
    s_lshl_b32 s4, s34, 15
    s_lshl_b32 s5, s99, 6
    s_add_u32 s4, s4, s5
    v_bfe_u32 v254, v1, 0, 4
    v_mul_u32_u24 v13, 2048, v254
    v_bfe_u32 v254, v1, 4, 2
    v_mul_u32_u24 v254, 16, v254
    v_add_u32 v13, v13, v254
    v_add_u32 v13, s4, v13
    s_lshl_b32 s4, s99, 17
    s_lshl_b32 s5, s34, 10
    s_add_u32 s4, s4, s5
    v_bfe_u32 v254, v1, 4, 2
    v_mul_u32_u24 v14, 32768, v254
    v_bfe_u32 v254, v1, 3, 1
    v_mul_u32_u24 v254, 512, v254
    v_add_u32 v14, v14, v254
    v_bfe_u32 v254, v1, 0, 3
    v_mul_u32_u24 v254, 2, v254
    v_add_u32 v14, v14, v254
    v_add_u32 v14, s4, v14
    v_add_u32 v15, 4096, v14
    v_add_u32 v16, 8192, v14
    v_add_u32 v17, 12288, v14
    v_add_u32 v18, 16384, v14
    v_add_u32 v19, 20480, v14
    v_add_u32 v20, 24576, v14
    v_add_u32 v21, 28672, v14
    s_lshl_b32 s4, s34, 6
    v_bfe_u32 v254, v1, 0, 4
    v_mul_u32_u24 v22, 4, v254
    v_add_u32 v22, s4, v22
    s_lshl_b32 s4, s99, 9
    s_add_u32 s4, s4, 92323840
    v_bfe_u32 v254, v1, 0, 2
    v_mul_u32_u24 v7, 128, v254
    v_add_u32 v7, s4, v7
    s_mov_b32 s28, s24
    s_mov_b32 s33, 0
    s_waitcnt lgkmcnt(0)
    s_mov_b32 s84, s44
    s_and_b32 s85, s45, 0xffff
    s_mov_b32 s86, 0x400000
    s_mov_b32 s87, 0x00020000
    s_mov_b32 s62, 0
    v_mov_b32 v5, 0
.wc_448:
    buffer_load_dword v4, v5, s[20:23], 0 offen offset:192 sc1
    s_add_u32 s62, s62, 1
    s_cmp_gt_u32 s62, 0x200000
    s_cbranch_scc1 .mg_end_1
    s_waitcnt vmcnt(0)
    v_readfirstlane_b32 s4, v4
    s_cmp_ge_u32 s4, 64
    s_cbranch_scc1 .wd_449
    s_sleep 8
    s_branch .wc_448
.wd_449:
.fl_450:
    s_lshl_b32 s57, s28, 16
    s_and_b32 s4, s28, 31
    s_lshl_b32 s4, s4, 4
    s_lshr_b32 s5, s28, 5
    s_lshl_b32 s5, s5, 11
    s_add_u32 s58, s4, s5
    s_add_u32 s58, s58, 130023424
    s_lshl_b32 s59, s28, 7
    s_add_u32 s59, s59, 121634816
    buffer_load_dwordx4 v[32:35], v13, s[12:15], s57 offen
    buffer_load_dword v44, v22, s[8:11], s59 offen
    buffer_load_ushort v36, v14, s[8:11], s58 offen
    buffer_load_ushort v37, v15, s[8:11], s58 offen
    buffer_load_ushort v38, v16, s[8:11], s58 offen
    buffer_load_ushort v39, v17, s[8:11], s58 offen
    buffer_load_ushort v40, v18, s[8:11], s58 offen
    buffer_load_ushort v41, v19, s[8:11], s58 offen
    buffer_load_ushort v42, v20, s[8:11], s58 offen
    buffer_load_ushort v43, v21, s[8:11], s58 offen
    s_xor_b32 s48, s28, s38
    s_lshl_b32 s48, s48, 12
    s_add_u32 s48, s48, 150994944
    s_xor_b32 s49, s48, 0x101000
    s_add_u32 s50, s48, 0x200000
    s_add_u32 s51, s49, 0x200000
    s_cmp_gt_u32 s33, s28
    s_cbranch_scc1 .fd_452
    s_mov_b32 s62, 0
.fp_451:
    buffer_load_dword v4, v7, s[8:11], 0 offen sc1
    s_add_u32 s62, s62, 1
    s_cmp_gt_u32 s62, 0x200000
    s_cbranch_scc1 .mg_end_1
    s_waitcnt vmcnt(0)
    v_min_u32_dpp v4, v4, v4 quad_perm:[1,0,3,2] row_mask:0xf bank_mask:0xf
    s_nop 1
    v_min_u32_dpp v4, v4, v4 quad_perm:[2,3,0,1] row_mask:0xf bank_mask:0xf
    s_nop 1
    v_readfirstlane_b32 s33, v4
    s_cmp_gt_u32 s33, s28
    s_cbranch_scc1 .fd_452
    s_sleep 4
    s_add_u32 s4, s33, 1
    s_cmp_ge_u32 s4, s28
    s_cbranch_scc1 .fp_451
    s_sleep 12
    s_branch .fp_451
.fd_452:
    buffer_load_dwordx4 v[64:67], v2, s[8:11], s48 offen offset:0
    buffer_load_dwordx4 v[68:71], v2, s[8:11], s48 offen offset:1024
    buffer_load_dwordx4 v[72:75], v2, s[8:11], s49 offen offset:0
    buffer_load_dwordx4 v[76:79], v2, s[8:11], s49 offen offset:1024
    buffer_load_dwordx4 v[80:83], v2, s[8:11], s50 offen offset:0
    buffer_load_dwordx4 v[84:87], v2, s[8:11], s50 offen offset:1024
    buffer_load_dwordx4 v[88:91], v2, s[8:11], s51 offen offset:0
    buffer_load_dwordx4 v[92:95], v2, s[8:11], s51 offen offset:1024
    s_waitcnt vmcnt(8)
    v_lshlrev_b32 v48, 16, v32
    v_lshlrev_b32 v36, 16, v36
    v_and_b32 v49, 0xffff0000, v32
    v_lshlrev_b32 v37, 16, v37
    v_lshlrev_b32 v50, 16, v33
    v_lshlrev_b32 v38, 16, v38
    v_and_b32 v51, 0xffff0000, v33
    v_lshlrev_b32 v39, 16, v39
    v_lshlrev_b32 v52, 16, v34
    v_lshlrev_b32 v40, 16, v40
    v_and_b32 v53, 0xffff0000, v34
    v_lshlrev_b32 v41, 16, v41
    v_lshlrev_b32 v54, 16, v35
    v_lshlrev_b32 v42, 16, v42
    v_and_b32 v55, 0xffff0000, v35
    v_lshlrev_b32 v43, 16, v43
    v_mul_f32 v48, v48, v36
    v_mul_f32 v49, v49, v37
    v_mul_f32 v50, v50, v38
    v_mul_f32 v51, v51, v39
    v_mul_f32 v52, v52, v40
    v_mul_f32 v53, v53, v41
    v_mul_f32 v54, v54, v42
    v_mul_f32 v55, v55, v43
    v_mul_f32 v48, v48, v44
    v_mul_f32 v49, v49, v44
    v_mul_f32 v50, v50, v44
    v_mul_f32 v51, v51, v44
    v_mul_f32 v52, v52, v44
    v_mul_f32 v53, v53, v44
    v_mul_f32 v54, v54, v44
    v_mul_f32 v55, v55, v44
    v_sub_f32 v44, 1.0, v44
    s_waitcnt vmcnt(4)
    v_add_f32 v64, v64, v72
    v_add_f32 v65, v65, v73
    v_add_f32 v66, v66, v74
    v_add_f32 v67, v67, v75
    v_add_f32 v68, v68, v76
    v_add_f32 v69, v69, v77
    v_add_f32 v70, v70, v78
    v_add_f32 v71, v71, v79
    s_waitcnt vmcnt(0)
    v_add_f32 v80, v80, v88
    v_add_f32 v81, v81, v89
    v_add_f32 v82, v82, v90
    v_add_f32 v83, v83, v91
    v_add_f32 v84, v84, v92
    v_add_f32 v85, v85, v93
    v_add_f32 v86, v86, v94
    v_add_f32 v87, v87, v95
    v_add_f32 v64, v64, v80
    v_add_f32 v65, v65, v81
    v_add_f32 v66, v66, v82
    v_add_f32 v67, v67, v83
    v_add_f32 v68, v68, v84
    v_add_f32 v69, v69, v85
    v_add_f32 v70, v70, v86
    v_add_f32 v71, v71, v87
    v_fma_f32 v64, v64, v44, v48
    v_fma_f32 v65, v65, v44, v49
    v_fma_f32 v66, v66, v44, v50
    v_fma_f32 v67, v67, v44, v51
    v_fma_f32 v68, v68, v44, v52
    v_fma_f32 v69, v69, v44, v53
    v_fma_f32 v70, v70, v44, v54
    v_fma_f32 v71, v71, v44, v55
    v_cvt_pk_bf16_f32 v56, v64, v65
    v_cvt_pk_bf16_f32 v57, v66, v67
    v_cvt_pk_bf16_f32 v58, v68, v69
    v_cvt_pk_bf16_f32 v59, v70, v71
    buffer_store_dwordx4 v[56:59], v13, s[84:87], s57 offen
    s_add_u32 s28, s28, 4
    s_cmp_lt_u32 s28, 64
    s_cbranch_scc1 .fl_450
    s_endpgm
.mg_end_1:
    s_endpgm
.section .rodata,"a"
.p2align 6
.amdhsa_kernel mega_kernel
  .amdhsa_next_free_vgpr 512
  .amdhsa_next_free_sgpr 102
  .amdhsa_accum_offset 256
  .amdhsa_group_segment_fixed_size 0
  .amdhsa_kernarg_size 136
  .amdhsa_user_sgpr_count 2
  .amdhsa_user_sgpr_kernarg_segment_ptr 1
  .amdhsa_system_sgpr_workgroup_id_x 1
.end_amdhsa_kernel
```

```asm
; @launch kernel=mega_kernel grid=(256,1,1) block=(256,1,1) lds=163840
.amdgcn_target "amdgcn-amd-amdhsa--gfx950"
.text
.globl mega_kernel
.p2align 8
.type mega_kernel,@function
mega_kernel:
    s_cmp_ge_u32 s2, 256
    s_cbranch_scc1 .mg_end_1
    s_load_dwordx4 s[52:55], s[0:1], 120
    s_getreg_b32 s3, hwreg(HW_REG_XCC_ID)
    v_and_b32 v1, 63, v0
    v_lshrrev_b32 v4, 6, v0
    s_and_b32 s3, s3, 7
    v_readfirstlane_b32 s24, v4
    s_waitcnt lgkmcnt(0)
    s_mov_b32 s8, s54
    s_and_b32 s9, s55, 0xffff
    s_mov_b32 s10, 0x10000000
    s_mov_b32 s11, 0x00020000
    s_mov_b32 s20, s52
    s_and_b32 s21, s53, 0xffff
    s_mov_b32 s22, 0x100
    s_mov_b32 s23, 0x00020000
    s_mov_b32 s100, s54
    v_mov_b32 v7, 163832
    s_cmp_lg_u32 s24, 0
    s_cbranch_scc1 .noat_4
    s_mov_b64 exec, 1
    v_mov_b32 v5, 1
    s_lshl_b32 s4, s3, 3
    s_mov_b32 s6, 0x60402000
    s_mov_b32 s7, 0xe4e08480
    s_lshr_b64 s[6:7], s[6:7], s4
    s_and_b32 s4, s6, 0xff
    v_mov_b32 v6, s4
    buffer_atomic_add v5, v6, s[20:23], 0 offen sc0 sc1
    s_mov_b64 exec, -1
.noat_4:
    s_sub_u32 s101, 0, s100
    s_and_b32 s101, s101, 0x1fffff
    s_add_u32 s101, s101, 100663296
    s_lshl_b32 s4, s2, 2
    s_add_u32 s4, s4, s24
    s_lshl_b32 s5, s4, 11
    s_add_u32 s5, s5, s101
    v_lshlrev_b32 v8, 4, v1
    v_mov_b32 v20, -1
    v_mov_b32 v21, -1
    v_mov_b32 v22, -1
    v_mov_b32 v23, -1
    s_lshl_b32 s4, s4, 10
    s_add_u32 s4, s4, 83886080
    buffer_store_dwordx4 v[20:23], v8, s[8:11], s5 offen sc1
    buffer_store_dwordx4 v[20:23], v8, s[8:11], s5 offen offset:1024 sc1
    buffer_store_dwordx4 v[20:23], v8, s[8:11], s4 offen sc1
    s_cmp_eq_u32 s24, 2
    s_cselect_b32 s6, s2, -1
    s_cmp_ge_u32 s6, 128
    s_cbranch_scc1 .nr_7
    s_lshl_b32 s6, s6, 10
    s_add_u32 s6, s6, 84934656
    buffer_store_dwordx4 v[20:23], v8, s[8:11], s6 offen sc1
.nr_7:
    s_cmp_eq_u32 s24, 3
    s_cselect_b32 s6, s2, -1
    s_cmp_ge_u32 s6, 68
    s_cbranch_scc1 .nf_5
    v_mov_b32 v24, 0
    v_mov_b32 v25, 0
    v_mov_b32 v26, 0
    v_mov_b32 v27, 0
    s_lshl_b32 s6, s6, 10
    s_add_u32 s6, s6, 92274688
    buffer_store_dwordx4 v[24:27], v8, s[8:11], s6 offen sc1
.nf_5:
    s_cmp_lg_u32 s24, 0
    s_cbranch_scc1 .nw_6
    s_mov_b64 exec, 1
    s_waitcnt vmcnt(3)
    ds_write_b32 v7, v5
    s_waitcnt lgkmcnt(0)
    s_mov_b64 exec, -1
.nw_6:
    s_barrier
    ds_read_b32 v5, v7
    s_mov_b32 s25, s3
    s_mov_b32 s27, 0
    s_waitcnt lgkmcnt(0)
    v_readfirstlane_b32 s26, v5
    s_cmp_ge_u32 s26, 32
    s_cselect_b32 s3, 0x10001, 1
    s_and_b32 s26, s26, 31
.mg_role_3:
    s_cmp_ge_u32 s25, 4
    s_cbranch_scc1 .mg_bg_2
    s_load_dwordx8 s[84:91], s[0:1], 64
    s_load_dwordx2 s[40:41], s[0:1], 56
    v_and_b32 v1, 63, v0
    s_lshl_b32 s4, s25, 4
    s_andn2_b32 s5, 8, s26
    s_or_b32 s4, s4, s5
    s_cbranch_scc1 .nocal_8
    s_cmp_lg_u32 s24, 3
    s_cbranch_scc1 .calb_9
    s_lshr_b32 s4, s26, 1
    s_and_b32 s4, s4, 8
    s_and_b32 s5, s26, 7
    s_or_b32 s4, s4, s5
    s_lshl_b32 s5, s4, 11
    s_add_u32 s5, s5, s101
    s_mov_b64 exec, 1
    v_mov_b32 v4, -1
    v_mov_b32 v5, 0
    s_mov_b32 s7, 0xffff
    s_memtime s[72:73]
    s_waitcnt lgkmcnt(0)
    buffer_store_dword v4, v5, s[8:11], s5 offen sc1
    s_waitcnt vmcnt(0)
    s_memtime s[74:75]
    s_waitcnt lgkmcnt(0)
    s_sub_u32 s74, s74, s72
    s_min_u32 s7, s7, s74
    s_memtime s[72:73]
    s_waitcnt lgkmcnt(0)
    buffer_store_dword v4, v5, s[8:11], s5 offen sc1
    s_waitcnt vmcnt(0)
    s_memtime s[74:75]
    s_waitcnt lgkmcnt(0)
    s_sub_u32 s74, s74, s72
    s_min_u32 s7, s7, s74
    s_memtime s[72:73]
    s_waitcnt lgkmcnt(0)
    buffer_store_dword v4, v5, s[8:11], s5 offen sc1
    s_waitcnt vmcnt(0)
    s_memtime s[74:75]
    s_waitcnt lgkmcnt(0)
    s_sub_u32 s74, s74, s72
    s_min_u32 s7, s7, s74
    s_lshl_b32 s5, s4, 1
    s_add_u32 s5, s5, 160
    v_mov_b32 v4, s7
    buffer_store_short v4, v5, s[20:23], s5 offen sc1
    s_mov_b64 exec, -1
.calb_9:
    s_barrier
.nocal_8:
    s_lshl_b32 s4, s25, 11
    s_lshl_b32 s5, s26, 6
    s_add_u32 s4, s4, s5
    s_lshl_b32 s6, s24, 21
    s_add_u32 s4, s4, s6
    s_lshl_b32 s7, s25, 21
    s_lshl_b32 s6, s24, 19
    s_add_u32 s7, s7, s6
    s_add_u32 s7, s7, s5
    s_lshl_b32 s6, s24, 15
    v_bfe_u32 v4, v1, 4, 1
    v_lshlrev_b32 v4, 1, v4
    v_and_b32 v5, 3, v1
    v_xor_b32 v4, v4, v5
    v_lshlrev_b32 v4, 4, v4
    v_bfe_u32 v254, v1, 2, 1
    v_mul_u32_u24 v5, 1, v254
    v_bfe_u32 v254, v1, 3, 1
    v_mul_u32_u24 v254, 8, v254
    v_add_u32 v5, v5, v254
    v_bfe_u32 v254, v1, 4, 1
    v_mul_u32_u24 v254, 4, v254
    v_add_u32 v5, v5, v254
    v_bfe_u32 v254, v1, 5, 1
    v_mul_u32_u24 v254, 2, v254
    v_add_u32 v5, v5, v254
    v_lshlrev_b32 v6, 13, v5
    v_add_u32 v6, v6, v4
    v_add_u32 v240, s4, v6
    v_lshlrev_b32 v6, 11, v5
    v_add_u32 v6, v6, v4
    v_add_u32 v241, s7, v6
    v_xor_b32 v241, 256, v241
    v_bfe_u32 v254, v1, 2, 2
    v_mul_u32_u24 v242, 64, v254
    v_bfe_u32 v254, v1, 4, 1
    v_mul_u32_u24 v254, 288, v254
    v_add_u32 v242, v242, v254
    v_bfe_u32 v254, v1, 5, 1
    v_mul_u32_u24 v254, 1024, v254
    v_add_u32 v242, v242, v254
    v_bfe_u32 v254, v1, 0, 2
    v_mul_u32_u24 v254, 8, v254
    v_add_u32 v242, v242, v254
    v_add_u32 v242, s6, v242
    v_xor_b32 v243, 32, v242
    s_waitcnt lgkmcnt(0)
    s_mov_b32 s16, s84
    s_and_b32 s17, s85, 0xffff
    s_mov_b32 s18, 0x800000
    s_mov_b32 s19, 0x00020000
    v_xor_b32 v240, 128, v240
    s_and_b32 s4, s26, 1
    s_lshl_b32 s98, s4, 11
    s_lshl_b32 s99, s4, 18
    s_add_u32 s98, s98, s6
    s_xor_b32 m0, s98, 0
    s_xor_b32 s5, s99, 0
    buffer_load_dwordx4 v240, s[16:19], s5 offen nt lds
    s_xor_b32 m0, s98, 1024
    s_xor_b32 s5, s99, 131072
    buffer_load_dwordx4 v240, s[16:19], s5 offen nt lds
    s_xor_b32 m0, s98, 2048
    s_xor_b32 s5, s99, 262144
    buffer_load_dwordx4 v240, s[16:19], s5 offen nt lds
    s_xor_b32 m0, s98, 3072
    s_xor_b32 s5, s99, 393216
    buffer_load_dwordx4 v240, s[16:19], s5 offen nt lds
    s_xor_b32 m0, s98, 4096
    s_xor_b32 s5, s99, 524288
    buffer_load_dwordx4 v240, s[16:19], s5 offen nt lds
    s_xor_b32 m0, s98, 5120
    s_xor_b32 s5, s99, 655360
    buffer_load_dwordx4 v240, s[16:19], s5 offen nt lds
    s_xor_b32 m0, s98, 6144
    s_xor_b32 s5, s99, 786432
    buffer_load_dwordx4 v240, s[16:19], s5 offen nt lds
    s_xor_b32 m0, s98, 7168
    s_xor_b32 s5, s99, 917504
    buffer_load_dwordx4 v240, s[16:19], s5 offen nt lds
    s_xor_b32 m0, s98, 8192
    s_xor_b32 s5, s99, 1048576
    buffer_load_dwordx4 v240, s[16:19], s5 offen nt lds
    s_xor_b32 m0, s98, 9216
    s_xor_b32 s5, s99, 1179648
    buffer_load_dwordx4 v240, s[16:19], s5 offen nt lds
    s_xor_b32 m0, s98, 10240
    s_xor_b32 s5, s99, 1310720
    buffer_load_dwordx4 v240, s[16:19], s5 offen nt lds
    s_xor_b32 m0, s98, 11264
    s_xor_b32 s5, s99, 1441792
    buffer_load_dwordx4 v240, s[16:19], s5 offen nt lds
    s_xor_b32 m0, s98, 12288
    s_xor_b32 s5, s99, 1572864
    buffer_load_dwordx4 v240, s[16:19], s5 offen nt lds
    s_xor_b32 m0, s98, 13312
    s_xor_b32 s5, s99, 1703936
    buffer_load_dwordx4 v240, s[16:19], s5 offen nt lds
    s_xor_b32 m0, s98, 14336
    s_xor_b32 s5, s99, 1835008
    buffer_load_dwordx4 v240, s[16:19], s5 offen nt lds
    s_xor_b32 m0, s98, 15360
    s_xor_b32 s5, s99, 1966080
    buffer_load_dwordx4 v240, s[16:19], s5 offen nt lds
    s_waitcnt vmcnt(16)
    s_barrier
    s_cmp_lg_u32 s24, 1
    s_cbranch_scc1 .ns_10
    s_mov_b64 exec, 1
    v_mov_b32 v238, s3
    v_mov_b32 v239, 0
    buffer_atomic_add v238, v239, s[20:23], 0 offen offset:196 sc1
    s_mov_b64 exec, -1
.ns_10:
    s_mov_b32 s16, s86
    s_and_b32 s17, s87, 0xffff
    s_mov_b32 s18, 0x800000
    s_mov_b32 s19, 0x00020000
    v_xor_b32 v240, 0, v240
    s_and_b32 s4, s26, 1
    s_lshl_b32 s98, s4, 11
    s_lshl_b32 s99, s4, 18
    s_add_u32 s98, s98, s6
    s_xor_b32 m0, s98, 16384
    s_xor_b32 s5, s99, 0
    buffer_load_dwordx4 v240, s[16:19], s5 offen nt lds
    s_xor_b32 m0, s98, 17408
    s_xor_b32 s5, s99, 131072
    buffer_load_dwordx4 v240, s[16:19], s5 offen nt lds
    s_xor_b32 m0, s98, 18432
    s_xor_b32 s5, s99, 262144
    buffer_load_dwordx4 v240, s[16:19], s5 offen nt lds
    s_xor_b32 m0, s98, 19456
    s_xor_b32 s5, s99, 393216
    buffer_load_dwordx4 v240, s[16:19], s5 offen nt lds
    s_xor_b32 m0, s98, 20480
    s_xor_b32 s5, s99, 524288
    buffer_load_dwordx4 v240, s[16:19], s5 offen nt lds
    s_xor_b32 m0, s98, 21504
    s_xor_b32 s5, s99, 655360
    buffer_load_dwordx4 v240, s[16:19], s5 offen nt lds
    s_xor_b32 m0, s98, 22528
    s_xor_b32 s5, s99, 786432
    buffer_load_dwordx4 v240, s[16:19], s5 offen nt lds
    s_xor_b32 m0, s98, 23552
    s_xor_b32 s5, s99, 917504
    buffer_load_dwordx4 v240, s[16:19], s5 offen nt lds
    s_xor_b32 m0, s98, 24576
    s_xor_b32 s5, s99, 1048576
    buffer_load_dwordx4 v240, s[16:19], s5 offen nt lds
    s_xor_b32 m0, s98, 25600
    s_xor_b32 s5, s99, 1179648
    buffer_load_dwordx4 v240, s[16:19], s5 offen nt lds
    s_xor_b32 m0, s98, 26624
    s_xor_b32 s5, s99, 1310720
    buffer_load_dwordx4 v240, s[16:19], s5 offen nt lds
    s_xor_b32 m0, s98, 27648
    s_xor_b32 s5, s99, 1441792
    buffer_load_dwordx4 v240, s[16:19], s5 offen nt lds
    s_xor_b32 m0, s98, 28672
    s_xor_b32 s5, s99, 1572864
    buffer_load_dwordx4 v240, s[16:19], s5 offen nt lds
    s_xor_b32 m0, s98, 29696
    s_xor_b32 s5, s99, 1703936
    buffer_load_dwordx4 v240, s[16:19], s5 offen nt lds
    s_xor_b32 m0, s98, 30720
    s_xor_b32 s5, s99, 1835008
    buffer_load_dwordx4 v240, s[16:19], s5 offen nt lds
    s_xor_b32 m0, s98, 31744
    s_xor_b32 s5, s99, 1966080
    buffer_load_dwordx4 v240, s[16:19], s5 offen nt lds
    s_lshr_b32 s52, s26, 2
    s_and_b32 s53, s26, 3
    s_lshl_b32 s54, s25, 14
    s_lshl_b32 s55, s26, 9
    s_add_u32 s55, s55, s54
    s_lshl_b32 s56, s25, 3
    s_add_u32 s56, s56, s52
    s_lshl_b32 s57, s56, 12
    s_lshl_b32 s58, s53, 9
    s_add_u32 s58, s58, s57
    s_mov_b32 s48, 0x00ff00ff
    s_mov_b32 s49, 0x00ff00ff
    s_mov_b32 s50, 0xff00ff00
    s_mov_b32 s51, 0xff00ff00
    v_mov_b32 v2, 0x4444
    v_mov_b32 v4, 0xeeee
    s_lshl_b32 s4, s24, 12
    s_add_u32 s4, s4, s54
    v_cndmask_b32 v2, v4, v2, s[48:49]
    v_bfe_u32 v254, v1, 0, 6
    v_mul_u32_u24 v3, 16, v254
    v_add_u32 v3, s4, v3
    v_add_u32 v4, 0x10000, v3
    s_mul_i32 s4, s24, 1152
    v_bfe_u32 v254, v1, 4, 1
    v_mul_u32_u24 v5, 576, v254
    v_bfe_u32 v254, v1, 5, 1
    v_mul_u32_u24 v254, 64, v254
    v_add_u32 v5, v5, v254
    v_bfe_u32 v254, v1, 0, 4
    v_mul_u32_u24 v254, 4, v254
    v_add_u32 v5, v5, v254
    v_add_u32 v5, s4, v5
    v_add_u32 v6, 4736, v5
    v_add_u32 v7, 9472, v5
    s_lshl_b32 s4, s24, 10
    v_bfe_u32 v254, v1, 0, 6
    v_mul_u32_u24 v8, 16, v254
    v_add_u32 v8, 14080, v8
    v_add_u32 v8, s4, v8
    s_and_b32 s4, s24, 1
    s_lshr_b32 s5, s24, 1
    s_lshl_b32 s59, s4, 6
    s_mul_i32 s60, s5, 4736
    s_add_u32 s59, s59, s60
    s_lshl_b32 s4, s4, 8
    s_add_u32 s60, s58, s4
    s_lshl_b32 s5, s5, 11
    s_add_u32 s61, s60, s5
    s_cmp_lt_u32 s24, 2
    s_cselect_b32 s5, 8, 1
    s_lshl_b32 s5, s5, 10
    s_xor_b32 s61, s61, s5
    v_bfe_u32 v254, v1, 2, 3
    v_mul_u32_u24 v9, 144, v254
    v_bfe_u32 v254, v1, 5, 1
    v_mul_u32_u24 v254, 32, v254
    v_add_u32 v9, v9, v254
    v_bfe_u32 v254, v1, 0, 2
    v_mul_u32_u24 v254, 8, v254
    v_add_u32 v9, v9, v254
    v_add_u32 v9, s59, v9
    v_bfe_u32 v254, v1, 0, 6
    v_mul_u32_u24 v10, 4, v254
    v_add_u32 v10, 131072, v10
    v_add_u32 v10, s61, v10
    v_bfe_u32 v254, v1, 0, 6
    v_mul_u32_u24 v11, 4, v254
    v_add_u32 v11, 18176, v11
    v_add_u32 v11, s4, v11
    s_lshl_b32 s4, s24, 2
    v_bfe_u32 v254, v1, 2, 1
    v_mul_u32_u24 v255, 1024, v254
    v_bfe_u32 v254, v1, 4, 1
    v_mul_u32_u24 v254, 512, v254
    v_add_u32 v255, v255, v254
    v_bfe_u32 v254, v1, 5, 1
    v_mul_u32_u24 v254, 128, v254
    v_add_u32 v255, v255, v254
    v_bfe_u32 v254, v1, 3, 1
    v_mul_u32_u24 v254, 64, v254
    v_add_u32 v255, v255, v254
    v_bfe_u32 v254, v1, 0, 2
    v_mul_u32_u24 v254, 16, v254
    v_add_u32 v255, v255, v254
    v_add_u32 v255, 20224, v255
    v_add_u32 v255, s4, v255
    v_mov_b32 v20, -1
    v_mov_b32 v21, -1
    v_mov_b32 v22, -1
    v_mov_b32 v23, -1
    v_mov_b32 v40, 0
    v_mov_b32 v41, 0
    v_mov_b32 v42, 0
    v_mov_b32 v43, 0
    v_mov_b32 v44, 0
    v_mov_b32 v45, 0
    v_mov_b32 v46, 0
    v_mov_b32 v47, 0
    v_mov_b32 v48, 0
    v_mov_b32 v49, 0
    v_mov_b32 v50, 0
    v_mov_b32 v51, 0
    v_mov_b32 v52, 0
    v_mov_b32 v53, 0
    v_mov_b32 v54, 0
    v_mov_b32 v55, 0
    v_mov_b32 v56, 0
    v_mov_b32 v57, 0
    v_mov_b32 v58, 0
    v_mov_b32 v59, 0
    v_mov_b32 v60, 0
    v_mov_b32 v61, 0
    v_mov_b32 v62, 0
    v_mov_b32 v63, 0
    v_mov_b32 v64, 0
    v_mov_b32 v65, 0
    v_mov_b32 v66, 0
    v_mov_b32 v67, 0
    v_mov_b32 v68, 0
    v_mov_b32 v69, 0
    v_mov_b32 v70, 0
    v_mov_b32 v71, 0
    v_bfe_u32 v254, v1, 0, 5
    v_mul_u32_u24 v244, 16, v254
    v_bfe_u32 v254, v1, 5, 1
    v_mul_u32_u24 v254, 2048, v254
    v_add_u32 v244, v244, v254
    v_add_u32 v244, 131072, v244
    v_add_u32 v244, s58, v244
    v_bfe_u32 v254, v1, 0, 5
    v_mul_u32_u24 v245, 16, v254
    v_bfe_u32 v254, v1, 5, 1
    v_mul_u32_u24 v254, 65536, v254
    v_add_u32 v245, v245, v254
    v_add_u32 v245, s55, v245
    s_lshl_b32 s4, s53, 10
    s_add_u32 s4, s4, s57
    v_bfe_u32 v254, v1, 0, 6
    v_mul_u32_u24 v246, 16, v254
    v_add_u32 v246, 131072, v246
    v_add_u32 v246, s4, v246
    v_subrev_u32 v237, 0x20000, v246
    v_lshrrev_b32 v237, 2, v237
    v_add_u32 v237, 262144, v237
    s_waitcnt vmcnt(16)
    ds_read_b64_tr_b16 a[0:1], v242 offset:0
    ds_read_b64_tr_b16 a[2:3], v242 offset:512
    ds_read_b64_tr_b16 a[4:5], v242 offset:2048
    ds_read_b64_tr_b16 a[6:7], v242 offset:2560
    ds_read_b64_tr_b16 a[8:9], v242 offset:4096
    ds_read_b64_tr_b16 a[10:11], v242 offset:4608
    ds_read_b64_tr_b16 a[12:13], v242 offset:6144
    ds_read_b64_tr_b16 a[14:15], v242 offset:6656
    ds_read_b64_tr_b16 a[16:17], v242 offset:8192
    ds_read_b64_tr_b16 a[18:19], v242 offset:8704
    ds_read_b64_tr_b16 a[20:21], v242 offset:10240
    ds_read_b64_tr_b16 a[22:23], v242 offset:10752
    ds_read_b64_tr_b16 a[24:25], v242 offset:12288
    ds_read_b64_tr_b16 a[26:27], v242 offset:12800
    ds_read_b64_tr_b16 a[28:29], v242 offset:14336
    ds_read_b64_tr_b16 a[30:31], v242 offset:14848
    ds_read_b64_tr_b16 a[32:33], v243 offset:0
    ds_read_b64_tr_b16 a[34:35], v243 offset:512
    ds_read_b64_tr_b16 a[36:37], v243 offset:2048
    ds_read_b64_tr_b16 a[38:39], v243 offset:2560
    ds_read_b64_tr_b16 a[40:41], v243 offset:4096
    ds_read_b64_tr_b16 a[42:43], v243 offset:4608
    ds_read_b64_tr_b16 a[44:45], v243 offset:6144
    ds_read_b64_tr_b16 a[46:47], v243 offset:6656
    ds_read_b64_tr_b16 a[48:49], v243 offset:8192
    ds_read_b64_tr_b16 a[50:51], v243 offset:8704
    ds_read_b64_tr_b16 a[52:53], v243 offset:10240
    ds_read_b64_tr_b16 a[54:55], v243 offset:10752
    ds_read_b64_tr_b16 a[56:57], v243 offset:12288
    ds_read_b64_tr_b16 a[58:59], v243 offset:12800
    ds_read_b64_tr_b16 a[60:61], v243 offset:14336
    ds_read_b64_tr_b16 a[62:63], v243 offset:14848
    s_waitcnt lgkmcnt(0)
    s_mov_b32 s16, s88
    s_and_b32 s17, s89, 0xffff
    s_mov_b32 s18, 0x800000
    s_mov_b32 s19, 0x00020000
    v_xor_b32 v240, 128, v240
    s_and_b32 s4, s26, 1
    s_lshl_b32 s98, s4, 11
    s_lshl_b32 s99, s4, 18
    s_add_u32 s98, s98, s6
    s_xor_b32 m0, s98, 0
    s_xor_b32 s5, s99, 0
    buffer_load_dwordx4 v240, s[16:19], s5 offen nt lds
    s_xor_b32 m0, s98, 1024
    s_xor_b32 s5, s99, 131072
    buffer_load_dwordx4 v240, s[16:19], s5 offen nt lds
    s_xor_b32 m0, s98, 2048
    s_xor_b32 s5, s99, 262144
    buffer_load_dwordx4 v240, s[16:19], s5 offen nt lds
    s_xor_b32 m0, s98, 3072
    s_xor_b32 s5, s99, 393216
    buffer_load_dwordx4 v240, s[16:19], s5 offen nt lds
    s_xor_b32 m0, s98, 4096
    s_xor_b32 s5, s99, 524288
    buffer_load_dwordx4 v240, s[16:19], s5 offen nt lds
    s_xor_b32 m0, s98, 5120
    s_xor_b32 s5, s99, 655360
    buffer_load_dwordx4 v240, s[16:19], s5 offen nt lds
    s_xor_b32 m0, s98, 6144
    s_xor_b32 s5, s99, 786432
    buffer_load_dwordx4 v240, s[16:19], s5 offen nt lds
    s_xor_b32 m0, s98, 7168
    s_xor_b32 s5, s99, 917504
    buffer_load_dwordx4 v240, s[16:19], s5 offen nt lds
    s_xor_b32 m0, s98, 8192
    s_xor_b32 s5, s99, 1048576
    buffer_load_dwordx4 v240, s[16:19], s5 offen nt lds
    s_xor_b32 m0, s98, 9216
    s_xor_b32 s5, s99, 1179648
    buffer_load_dwordx4 v240, s[16:19], s5 offen nt lds
    s_xor_b32 m0, s98, 10240
    s_xor_b32 s5, s99, 1310720
    buffer_load_dwordx4 v240, s[16:19], s5 offen nt lds
    s_xor_b32 m0, s98, 11264
    s_xor_b32 s5, s99, 1441792
    buffer_load_dwordx4 v240, s[16:19], s5 offen nt lds
    s_xor_b32 m0, s98, 12288
    s_xor_b32 s5, s99, 1572864
    buffer_load_dwordx4 v240, s[16:19], s5 offen nt lds
    s_xor_b32 m0, s98, 13312
    s_xor_b32 s5, s99, 1703936
    buffer_load_dwordx4 v240, s[16:19], s5 offen nt lds
    s_xor_b32 m0, s98, 14336
    s_xor_b32 s5, s99, 1835008
    buffer_load_dwordx4 v240, s[16:19], s5 offen nt lds
    s_xor_b32 m0, s98, 15360
    s_xor_b32 s5, s99, 1966080
    buffer_load_dwordx4 v240, s[16:19], s5 offen nt lds
    s_waitcnt vmcnt(16)
    ds_read_b64_tr_b16 a[64:65], v242 offset:16384
    ds_read_b64_tr_b16 a[66:67], v242 offset:16896
    ds_read_b64_tr_b16 a[68:69], v242 offset:18432
    ds_read_b64_tr_b16 a[70:71], v242 offset:18944
    ds_read_b64_tr_b16 a[72:73], v242 offset:20480
    ds_read_b64_tr_b16 a[74:75], v242 offset:20992
    ds_read_b64_tr_b16 a[76:77], v242 offset:22528
    ds_read_b64_tr_b16 a[78:79], v242 offset:23040
    ds_read_b64_tr_b16 a[80:81], v242 offset:24576
    ds_read_b64_tr_b16 a[82:83], v242 offset:25088
    ds_read_b64_tr_b16 a[84:85], v242 offset:26624
    ds_read_b64_tr_b16 a[86:87], v242 offset:27136
    ds_read_b64_tr_b16 a[88:89], v242 offset:28672
    ds_read_b64_tr_b16 a[90:91], v242 offset:29184
    ds_read_b64_tr_b16 a[92:93], v242 offset:30720
    ds_read_b64_tr_b16 a[94:95], v242 offset:31232
    ds_read_b64_tr_b16 a[96:97], v243 offset:16384
    ds_read_b64_tr_b16 a[98:99], v243 offset:16896
    ds_read_b64_tr_b16 a[100:101], v243 offset:18432
    ds_read_b64_tr_b16 a[102:103], v243 offset:18944
    ds_read_b64_tr_b16 a[104:105], v243 offset:20480
    ds_read_b64_tr_b16 a[106:107], v243 offset:20992
    ds_read_b64_tr_b16 a[108:109], v243 offset:22528
    ds_read_b64_tr_b16 a[110:111], v243 offset:23040
    ds_read_b64_tr_b16 a[112:113], v243 offset:24576
    ds_read_b64_tr_b16 a[114:115], v243 offset:25088
    ds_read_b64_tr_b16 a[116:117], v243 offset:26624
    ds_read_b64_tr_b16 a[118:119], v243 offset:27136
    ds_read_b64_tr_b16 a[120:121], v243 offset:28672
    ds_read_b64_tr_b16 a[122:123], v243 offset:29184
    ds_read_b64_tr_b16 a[124:125], v243 offset:30720
    ds_read_b64_tr_b16 a[126:127], v243 offset:31232
    s_waitcnt lgkmcnt(0)
    v_or_b32 v239, 32, v1
    v_lshlrev_b32 v239, 2, v239
    buffer_load_dword v238, v239, s[20:23], 0 offen sc1
    s_mov_b32 s12, s40
    s_and_b32 s13, s41, 0xffff
    s_mov_b32 s14, 0x4000
    s_mov_b32 s15, 0x00020000
    s_xor_b32 s4, s26, 4
    s_lshl_b32 s4, s4, 6
    v_bfe_u32 v254, v1, 1, 3
    v_mul_u32_u24 v247, 2048, v254
    v_bfe_u32 v254, v1, 4, 2
    v_mul_u32_u24 v254, 16, v254
    v_add_u32 v247, v247, v254
    v_bfe_u32 v254, v1, 0, 1
    v_mul_u32_u24 v254, 8, v254
    v_add_u32 v247, v247, v254
    buffer_load_dwordx2 v[248:249], v247, s[12:15], s4 offen
    s_mov_b32 s16, s90
    s_and_b32 s17, s91, 0xffff
    s_mov_b32 s18, 0x800000
    s_mov_b32 s19, 0x00020000
    s_and_b32 s4, s26, 1
    s_lshl_b32 s98, s4, 11
    s_lshl_b32 s99, s4, 16
    s_add_u32 s98, s98, s6
    s_xor_b32 m0, s98, 16384
    s_xor_b32 s5, s99, 0
    buffer_load_dwordx4 v241, s[16:19], s5 offen nt lds
    s_xor_b32 m0, s98, 17408
    s_xor_b32 s5, s99, 32768
    buffer_load_dwordx4 v241, s[16:19], s5 offen nt lds
    s_xor_b32 m0, s98, 18432
    s_xor_b32 s5, s99, 65536
    buffer_load_dwordx4 v241, s[16:19], s5 offen nt lds
    s_xor_b32 m0, s98, 19456
    s_xor_b32 s5, s99, 98304
    buffer_load_dwordx4 v241, s[16:19], s5 offen nt lds
    s_xor_b32 m0, s98, 20480
    s_xor_b32 s5, s99, 131072
    buffer_load_dwordx4 v241, s[16:19], s5 offen nt lds
    s_xor_b32 m0, s98, 21504
    s_xor_b32 s5, s99, 163840
    buffer_load_dwordx4 v241, s[16:19], s5 offen nt lds
    s_xor_b32 m0, s98, 22528
    s_xor_b32 s5, s99, 196608
    buffer_load_dwordx4 v241, s[16:19], s5 offen nt lds
    s_xor_b32 m0, s98, 23552
    s_xor_b32 s5, s99, 229376
    buffer_load_dwordx4 v241, s[16:19], s5 offen nt lds
    s_xor_b32 m0, s98, 24576
    s_xor_b32 s5, s99, 262144
    buffer_load_dwordx4 v241, s[16:19], s5 offen nt lds
    s_xor_b32 m0, s98, 25600
    s_xor_b32 s5, s99, 294912
    buffer_load_dwordx4 v241, s[16:19], s5 offen nt lds
    s_xor_b32 m0, s98, 26624
    s_xor_b32 s5, s99, 327680
    buffer_load_dwordx4 v241, s[16:19], s5 offen nt lds
    s_xor_b32 m0, s98, 27648
    s_xor_b32 s5, s99, 360448
    buffer_load_dwordx4 v241, s[16:19], s5 offen nt lds
    s_xor_b32 m0, s98, 28672
    s_xor_b32 s5, s99, 393216
    buffer_load_dwordx4 v241, s[16:19], s5 offen nt lds
    s_xor_b32 m0, s98, 29696
    s_xor_b32 s5, s99, 425984
    buffer_load_dwordx4 v241, s[16:19], s5 offen nt lds
    s_xor_b32 m0, s98, 30720
    s_xor_b32 s5, s99, 458752
    buffer_load_dwordx4 v241, s[16:19], s5 offen nt lds
    s_xor_b32 m0, s98, 31744
    s_xor_b32 s5, s99, 491520
    buffer_load_dwordx4 v241, s[16:19], s5 offen nt lds
    s_waitcnt vmcnt(16)
    s_cmp_lg_u32 s27, 0
    s_cbranch_scc1 .vd_12
    s_mov_b32 s62, 0
.vp_11:
    v_readlane_b32 s4, v238, 49
    s_and_b32 s5, s4, 0xffff
    s_cmp_ge_u32 s5, 256
    s_cbranch_scc1 .va_13
    s_add_u32 s62, s62, 1
    s_cmp_gt_u32 s62, 0x100000
    s_cbranch_scc1 .mg_end_1
    s_sleep 16
    buffer_load_dword v238, v239, s[20:23], 0 offen sc1
    s_waitcnt vmcnt(0)
    s_branch .vp_11
.va_13:
    s_lshr_b32 s4, s4, 16
    s_cbranch_scc0 .vd_12
    s_lshr_b32 s25, s2, 5
    s_and_b32 s26, s2, 31
    s_mov_b32 s27, 1
    s_waitcnt vmcnt(0) lgkmcnt(0)
    s_barrier
    s_branch .mg_role_3
.vd_12:
    ds_read_b64_tr_b16 a[128:129], v242 offset:0
    ds_read_b64_tr_b16 a[130:131], v242 offset:512
    ds_read_b64_tr_b16 a[132:133], v242 offset:2048
    ds_read_b64_tr_b16 a[134:135], v242 offset:2560
    ds_read_b64_tr_b16 a[136:137], v242 offset:4096
    ds_read_b64_tr_b16 a[138:139], v242 offset:4608
    ds_read_b64_tr_b16 a[140:141], v242 offset:6144
    ds_read_b64_tr_b16 a[142:143], v242 offset:6656
    ds_read_b64_tr_b16 a[144:145], v242 offset:8192
    ds_read_b64_tr_b16 a[146:147], v242 offset:8704
    ds_read_b64_tr_b16 a[148:149], v242 offset:10240
    ds_read_b64_tr_b16 a[150:151], v242 offset:10752
    ds_read_b64_tr_b16 a[152:153], v242 offset:12288
    ds_read_b64_tr_b16 a[154:155], v242 offset:12800
    ds_read_b64_tr_b16 a[156:157], v242 offset:14336
    ds_read_b64_tr_b16 a[158:159], v242 offset:14848
    ds_read_b64_tr_b16 a[160:161], v243 offset:0
    ds_read_b64_tr_b16 a[162:163], v243 offset:512
    ds_read_b64_tr_b16 a[164:165], v243 offset:2048
    ds_read_b64_tr_b16 a[166:167], v243 offset:2560
    ds_read_b64_tr_b16 a[168:169], v243 offset:4096
    ds_read_b64_tr_b16 a[170:171], v243 offset:4608
    ds_read_b64_tr_b16 a[172:173], v243 offset:6144
    ds_read_b64_tr_b16 a[174:175], v243 offset:6656
    ds_read_b64_tr_b16 a[176:177], v243 offset:8192
    ds_read_b64_tr_b16 a[178:179], v243 offset:8704
    ds_read_b64_tr_b16 a[180:181], v243 offset:10240
    ds_read_b64_tr_b16 a[182:183], v243 offset:10752
    ds_read_b64_tr_b16 a[184:185], v243 offset:12288
    ds_read_b64_tr_b16 a[186:187], v243 offset:12800
    ds_read_b64_tr_b16 a[188:189], v243 offset:14336
    ds_read_b64_tr_b16 a[190:191], v243 offset:14848
    s_waitcnt lgkmcnt(0)
    s_mov_b32 s47, 0
    s_cmp_lg_u32 s27, 0
    s_cbranch_scc1 .cd_15
    s_mov_b32 s62, 0
.cp_14:
    v_and_b32 v18, 0xffff, v238
    v_lshrrev_b32 v19, 16, v238
    v_min_u32 v17, v18, v19
    v_cmp_eq_u32 vcc, 0, v17
    s_and_b32 s4, vcc_hi, 65280
    s_cbranch_scc0 .cg_16
    s_add_u32 s62, s62, 1
    s_cmp_gt_u32 s62, 0x100000
    s_cbranch_scc1 .mg_end_1
    s_sleep 16
    buffer_load_dword v238, v239, s[20:23], 0 offen sc1
    s_waitcnt vmcnt(0)
    s_branch .cp_14
.cg_16:
    v_readlane_b32 s66, v18, 40
    v_readlane_b32 s67, v19, 40
    v_readlane_b32 s68, v18, 41
    v_readlane_b32 s69, v19, 41
    v_readlane_b32 s70, v18, 42
    v_readlane_b32 s71, v19, 42
    v_readlane_b32 s72, v18, 43
    v_readlane_b32 s73, v19, 43
    v_readlane_b32 s74, v18, 44
    v_readlane_b32 s75, v19, 44
    v_readlane_b32 s76, v18, 45
    v_readlane_b32 s77, v19, 45
    v_readlane_b32 s78, v18, 46
    v_readlane_b32 s79, v19, 46
    v_readlane_b32 s80, v18, 47
    v_readlane_b32 s81, v19, 47
    s_nop 3
    s_add_u32 s4, s66, s67
    s_add_u32 s4, s4, s68
    s_add_u32 s4, s4, s69
    s_add_u32 s4, s4, s74
    s_add_u32 s4, s4, s75
    s_add_u32 s4, s4, s76
    s_add_u32 s4, s4, s77
    s_add_u32 s5, s70, s71
    s_add_u32 s5, s5, s72
    s_add_u32 s5, s5, s73
    s_add_u32 s5, s5, s78
    s_add_u32 s5, s5, s79
    s_add_u32 s5, s5, s80
    s_add_u32 s5, s5, s81
    s_cmp_lt_u32 s5, s4
    s_cselect_b32 s47, 0x2000, 0
    s_cselect_b32 s66, s70, s66
    s_cselect_b32 s67, s71, s67
    s_cselect_b32 s68, s72, s68
    s_cselect_b32 s69, s73, s69
    s_cselect_b32 s74, s78, s74
    s_cselect_b32 s75, s79, s75
    s_cselect_b32 s76, s80, s76
    s_cselect_b32 s77, s81, s77
    s_add_u32 s4, s66, s68
    s_add_u32 s4, s4, s74
    s_add_u32 s4, s4, s76
    s_add_u32 s5, s67, s69
    s_add_u32 s5, s5, s75
    s_add_u32 s5, s5, s77
    s_cmp_lt_u32 s5, s4
    s_cselect_b32 s4, 2048, 0
    s_or_b32 s47, s47, s4
    s_add_u32 s4, s66, s67
    s_add_u32 s4, s4, s74
    s_add_u32 s4, s4, s75
    s_add_u32 s5, s68, s69
    s_add_u32 s5, s5, s76
    s_add_u32 s5, s5, s77
    s_cmp_lt_u32 s5, s4
    s_cselect_b32 s4, 4096, 0
    s_or_b32 s47, s47, s4
    s_add_u32 s4, s66, s67
    s_add_u32 s4, s4, s68
    s_add_u32 s4, s4, s69
    s_add_u32 s5, s74, s75
    s_add_u32 s5, s5, s76
    s_add_u32 s5, s5, s77
    s_cmp_lt_u32 s5, s4
    s_cselect_b32 s4, 16384, 0
    s_or_b32 s47, s47, s4
.cd_15:
    s_cmp_lg_u32 s27, 0
    s_cbranch_scc1 .slowv_17
    s_mov_b32 s28, 0
    s_mov_b32 s30, 83886080
    s_mov_b32 s31, 84180992
    s_mov_b32 s32, 84475904
    s_mov_b32 s33, 84770816
    s_mov_b32 s41, 66977792
    s_lshl_b32 s42, s56, 13
    s_lshl_b32 s4, s53, 11
    s_add_u32 s44, s42, s4
    s_add_u32 s44, s44, 33554432
    s_add_u32 s42, s42, 16777216
    s_xor_b32 s4, s53, 2
    s_lshl_b32 s4, s4, 10
    s_add_u32 s42, s42, s4
    s_add_u32 s43, s42, 4096
    s_add_u32 s96, s44, 524288
    s_sub_u32 s95, s96, 16777216
    s_mov_b32 s62, 0
    s_mov_b32 s45, 0x3e0293ee
    s_mov_b32 s46, 0
    s_and_b32 s4, s25, 1
    s_lshl_b32 s4, s4, 14
    s_lshr_b32 s5, s25, 1
    s_lshl_b32 s5, s5, 12
    s_or_b32 s4, s4, s5
    s_xor_b32 s47, s47, s4
    s_and_b32 s5, s26, 1
    s_lshl_b32 s5, s5, 10
    s_lshr_b32 s4, s26, 1
    s_lshl_b32 s4, s4, 15
    s_or_b32 s5, s5, s4
    s_bfe_u32 s4, s26, 0x10004
    s_lshl_b32 s4, s4, 11
    s_xor_b32 s5, s5, s4
    s_xor_b32 s34, s5, s47
    s_xor_b32 s35, s34, 0x84000
    s_xor_b32 s36, s34, 0x101000
    s_xor_b32 s37, s34, 0x185000
    s_cmp_eq_u32 s24, 1
    s_cbranch_scc1 .w1_19
    s_cmp_eq_u32 s24, 2
    s_cbranch_scc1 .w2_20
    s_cmp_eq_u32 s24, 3
    s_cbranch_scc1 .w3_21
.w0_18:
    v_bfe_u32 v254, v1, 0, 3
    v_mul_u32_u24 v9, 144, v254
    v_bfe_u32 v254, v1, 3, 1
    v_mul_u32_u24 v254, 1152, v254
    v_add_u32 v9, v9, v254
    v_bfe_u32 v254, v1, 4, 2
    v_mul_u32_u24 v254, 32, v254
    v_add_u32 v9, v9, v254
    s_lshl_b32 s4, s56, 10
    v_bfe_u32 v254, v1, 0, 6
    v_mul_u32_u24 v13, 16, v254
    v_add_u32 v13, 262144, v13
    v_add_u32 v13, s4, v13
    v_xor_b32 v156, 1024, v246
    v_xor_b32 v157, 2048, v246
    v_xor_b32 v158, 3072, v246
    v_bfe_u32 v254, v1, 4, 2
    v_mul_u32_u24 v14, 128, v254
    v_bfe_u32 v254, v1, 0, 4
    v_mul_u32_u24 v254, 16, v254
    v_add_u32 v14, v14, v254
    v_add_u32 v14, 65536, v14
    v_add_u32 v14, s55, v14
    v_bfe_u32 v254, v1, 0, 6
    v_mul_u32_u24 v15, 16, v254
    v_bfe_u32 v254, v1, 2, 2
    v_mul_u32_u24 v16, 128, v254
    v_bfe_u32 v254, v1, 0, 2
    v_mul_u32_u24 v254, 16, v254
    v_add_u32 v16, v16, v254
    v_bfe_u32 v254, v1, 4, 2
    v_mul_u32_u24 v254, 4, v254
    v_add_u32 v16, v16, v254
    v_add_u32 v16, 18688, v16
    v_mov_b32 v208, 0
    v_mov_b32 v209, 0
    v_mov_b32 v210, 0
    v_mov_b32 v211, 0
    v_mov_b32 v212, 0
    v_mov_b32 v213, 0
    v_mov_b32 v214, 0
    v_mov_b32 v215, 0
    v_mov_b32 v216, 0
    v_mov_b32 v217, 0
    v_mov_b32 v218, 0
    v_mov_b32 v219, 0
    s_mov_b64 s[50:51], s[48:49]
    v_mov_b32 v164, 0
    v_mov_b32 v165, 0
    v_mov_b32 v166, 0
    v_mov_b32 v167, 0
    v_mov_b32 v164, 0x3f803f80
    v_mov_b32 v200, s45
    v_mov_b32 v220, 0x3f803f80
    v_mov_b32 v201, s45
    v_mov_b32 v221, 0x3f803f80
    v_mov_b32 v202, s45
    v_mov_b32 v222, 0x3f803f80
    v_mov_b32 v203, s45
    v_mov_b32 v223, 0x3f803f80
    buffer_load_dwordx4 v[24:27], v246, s[8:11], s30 offen sc1
    buffer_load_dwordx4 v[28:31], v245, s[8:11], s30 offen sc1
    buffer_load_dword v32, v237, s[8:11], s30 offen sc1
    s_waitcnt vmcnt(0)
    ds_read_b64_tr_b16 a[192:193], v242 offset:16384
    ds_read_b64_tr_b16 a[194:195], v242 offset:16896
    ds_read_b64_tr_b16 a[196:197], v242 offset:18432
    ds_read_b64_tr_b16 a[198:199], v242 offset:18944
    ds_read_b64_tr_b16 a[200:201], v242 offset:20480
    ds_read_b64_tr_b16 a[202:203], v242 offset:20992
    ds_read_b64_tr_b16 a[204:205], v242 offset:22528
    ds_read_b64_tr_b16 a[206:207], v242 offset:23040
    ds_read_b64_tr_b16 a[208:209], v242 offset:24576
    ds_read_b64_tr_b16 a[210:211], v242 offset:25088
    ds_read_b64_tr_b16 a[212:213], v242 offset:26624
    ds_read_b64_tr_b16 a[214:215], v242 offset:27136
    ds_read_b64_tr_b16 a[216:217], v242 offset:28672
    ds_read_b64_tr_b16 a[218:219], v242 offset:29184
    ds_read_b64_tr_b16 a[220:221], v242 offset:30720
    ds_read_b64_tr_b16 a[222:223], v242 offset:31232
    ds_read_b64_tr_b16 a[224:225], v243 offset:16384
    ds_read_b64_tr_b16 a[226:227], v243 offset:16896
    ds_read_b64_tr_b16 a[228:229], v243 offset:18432
    ds_read_b64_tr_b16 a[230:231], v243 offset:18944
    ds_read_b64_tr_b16 a[232:233], v243 offset:20480
    ds_read_b64_tr_b16 a[234:235], v243 offset:20992
    ds_read_b64_tr_b16 a[236:237], v243 offset:22528
    ds_read_b64_tr_b16 a[238:239], v243 offset:23040
    ds_read_b64_tr_b16 a[240:241], v243 offset:24576
    ds_read_b64_tr_b16 a[242:243], v243 offset:25088
    ds_read_b64_tr_b16 a[244:245], v243 offset:26624
    ds_read_b64_tr_b16 a[246:247], v243 offset:27136
    ds_read_b64_tr_b16 a[248:249], v243 offset:28672
    ds_read_b64_tr_b16 a[250:251], v243 offset:29184
    ds_read_b64_tr_b16 a[252:253], v243 offset:30720
    ds_read_b64_tr_b16 a[254:255], v243 offset:31232
    s_waitcnt lgkmcnt(0)
    s_barrier
    buffer_load_dwordx4 v[104:107], v15, s[8:11], s42 offen offset:0
    buffer_load_dwordx4 v[120:123], v15, s[8:11], s43 offen offset:0
    buffer_load_dwordx4 v[136:139], v15, s[8:11], s44 offen offset:0
    buffer_load_dwordx4 v[140:143], v15, s[8:11], s44 offen offset:1024
    s_add_u32 s42, s42, 262144
    s_add_u32 s43, s43, 262144
    s_add_u32 s44, s44, 262144
.p2align 6
.step_24:
    s_barrier
    s_setprio 3
    buffer_load_dwordx4 v[24:27], v3, s[8:11], s30 offen offset:0 sc1
    s_setprio 2
    buffer_load_dwordx4 v[28:31], v3, s[8:11], s30 offen offset:1024 sc1
    s_setprio 1
    buffer_load_dwordx4 v[32:35], v3, s[8:11], s30 offen offset:2048 sc1
    s_setprio 0
    buffer_load_dwordx4 v[36:39], v3, s[8:11], s30 offen offset:3072 sc1
    s_call_b64 s[98:99], .gm_22
    v_permlane32_swap_b32 v40, v44
    v_permlane32_swap_b32 v41, v45
    v_permlane32_swap_b32 v42, v46
    v_permlane32_swap_b32 v43, v47
    v_add_f32 v40, v40, v44
    v_add_f32 v41, v41, v45
    v_add_f32 v42, v42, v46
    v_add_f32 v43, v43, v47
    ds_write2_b32 v5, v40, v41 offset0:0 offset1:36
    ds_write2_b32 v5, v42, v43 offset0:72 offset1:108
    v_permlane32_swap_b32 v48, v52
    v_permlane32_swap_b32 v49, v53
    v_permlane32_swap_b32 v50, v54
    v_permlane32_swap_b32 v51, v55
    v_pk_add_f32 v[48:49], v[48:49], v[52:53]
    v_pk_add_f32 v[50:51], v[50:51], v[54:55]
    ds_write2_b32 v6, v48, v49 offset0:0 offset1:36
    ds_write2_b32 v6, v50, v51 offset0:72 offset1:108
    s_waitcnt lgkmcnt(2)
    s_barrier
    ds_read_b128 v[72:75], v9 offset:0
    ds_read_b128 v[76:79], v9 offset:2304
    ds_read_b128 v[80:83], v9 offset:16
    ds_read_b128 v[84:87], v9 offset:2320
    v_smfmac_f32_16x16x64_bf16 v[56:59], v[24:27], a[128:135], v2
    v_smfmac_f32_16x16x64_bf16 v[60:63], v[24:27], a[160:167], v2
    s_waitcnt lgkmcnt(4)
    s_barrier
    v_smfmac_f32_16x16x64_bf16 v[56:59], v[28:31], a[136:143], v2
    s_waitcnt lgkmcnt(2)
    v_pk_add_f32 v[72:73], v[72:73], v[76:77]
    v_pk_add_f32 v[74:75], v[74:75], v[78:79]
    v_cvt_pk_bf16_f32 v144, v72, v73
    v_cvt_pk_bf16_f32 v145, v74, v75
    s_waitcnt lgkmcnt(0)
    v_pk_add_f32 v[80:81], v[80:81], v[84:85]
    v_pk_add_f32 v[82:83], v[82:83], v[86:87]
    v_cvt_pk_bf16_f32 v146, v80, v81
    v_cvt_pk_bf16_f32 v147, v82, v83
    s_nop 1
    v_mfma_f32_16x16x32_bf16 v[192:195], v[104:107], v[144:147], 0
    v_mfma_f32_16x16x32_bf16 v[160:163], v[120:123], v[144:147], 0
    v_smfmac_f32_16x16x64_bf16 v[60:63], v[28:31], a[168:175], v2
    v_add_f32_dpp v151, v195, v195 row_ror:8 row_mask:0xf bank_mask:0x3
    v_add_f32_dpp v148, v192, v192 row_ror:8 row_mask:0xf bank_mask:0x3
    v_add_f32_dpp v149, v193, v193 row_ror:8 row_mask:0xf bank_mask:0x3
    v_add_f32_dpp v150, v194, v194 row_ror:8 row_mask:0xf bank_mask:0x3
    v_add_f32_dpp v151, v163, v163 row_ror:8 row_mask:0xf bank_mask:0xc
    v_add_f32_dpp v148, v160, v160 row_ror:8 row_mask:0xf bank_mask:0xc
    v_add_f32_dpp v149, v161, v161 row_ror:8 row_mask:0xf bank_mask:0xc
    v_add_f32_dpp v150, v162, v162 row_ror:8 row_mask:0xf bank_mask:0xc
    v_min_u32 v151, 0xfffffffe, v151
    buffer_store_dwordx4 v[148:151], v246, s[8:11], s30 offen
    v_smfmac_f32_16x16x64_bf16 v[56:59], v[32:35], a[144:151], v2
    v_smfmac_f32_16x16x64_bf16 v[60:63], v[32:35], a[176:183], v2
    v_smfmac_f32_16x16x64_bf16 v[56:59], v[36:39], a[152:159], v2
    v_smfmac_f32_16x16x64_bf16 v[60:63], v[36:39], a[184:191], v2
    v_mov_b32 v40, 0
    v_mov_b32 v41, 0
    v_mov_b32 v42, 0
    v_mov_b32 v43, 0
    v_mov_b32 v44, 0
    v_mov_b32 v45, 0
    v_mov_b32 v46, 0
    v_mov_b32 v47, 0
    v_permlane32_swap_b32 v56, v60
    v_permlane32_swap_b32 v57, v61
    v_permlane32_swap_b32 v58, v62
    v_permlane32_swap_b32 v59, v63
    v_pk_add_f32 v[56:57], v[56:57], v[60:61]
    v_pk_add_f32 v[58:59], v[58:59], v[62:63]
    v_cvt_pk_bf16_f32 v60, v56, v57
    v_cvt_pk_bf16_f32 v61, v58, v59
    ds_write2_b32 v255, v60, v61 offset0:0 offset1:64
    ds_write_b128 v8, v[56:59]
    s_cmp_eq_u32 s28, 63
    s_cbranch_scc1 .fin_25
    buffer_load_dwordx4 v[176:179], v13, s[8:11], s30 offen sc1
    buffer_load_dwordx4 v[180:183], v156, s[8:11], s30 offen sc1
    buffer_load_dwordx4 v[184:187], v157, s[8:11], s30 offen sc1
    buffer_load_dwordx4 v[188:191], v158, s[8:11], s30 offen sc1
    s_waitcnt lgkmcnt(0)
    s_barrier
    ds_read_b128 v[212:215], v15 offset:20224
    ds_read_b128 v[216:219], v15 offset:21248
    buffer_load_dwordx4 v[72:75], v13, s[8:11], s30 offen sc1
    buffer_load_dwordx4 v[76:79], v156, s[8:11], s30 offen sc1
    buffer_load_dwordx4 v[80:83], v157, s[8:11], s30 offen sc1
    buffer_load_dwordx4 v[84:87], v158, s[8:11], s30 offen sc1
.mf_26:
    s_waitcnt vmcnt(7)
    v_max3_u32 v18, v176, v177, v178
    v_pk_add_f32 v[196:197], v[176:177], v[178:179]
    s_waitcnt vmcnt(6)
    v_max3_u32 v18, v18, v179, v183
    v_pk_add_f32 v[192:193], v[148:149], v[180:181]
    v_pk_add_f32 v[194:195], v[150:151], v[182:183]
    v_add_f32 v196, v196, v197
    s_waitcnt vmcnt(5)
    v_pk_add_f32 v[192:193], v[192:193], v[184:185]
    v_pk_add_f32 v[194:195], v[194:195], v[186:187]
    s_waitcnt vmcnt(4)
    v_max3_u32 v18, v18, v187, v191
    v_pk_add_f32 v[192:193], v[192:193], v[188:189]
    v_pk_add_f32 v[194:195], v[194:195], v[190:191]
    v_cmp_eq_u32 vcc, -1, v18
    v_max3_f32 v19, v192, v193, v196
    v_max3_f32 v19, v19, v194, v195
    s_cbranch_vccnz .re_27
.sj_28:
    s_nop 0
    v_max_f32_dpp v18, v19, v19 row_ror:8 row_mask:0xf bank_mask:0xf
    v_max_f32_dpp v17, v19, v19 row_ror:8 row_mask:0xf bank_mask:0xf
    s_nop 1
    v_permlane16_swap_b32 v18, v17
    v_max_f32 v19, v18, v17
    v_max_f32 v18, v18, v17
    s_nop 1
    v_permlane32_swap_b32 v18, v19
    v_max_f32 v18, v18, v19
    v_mul_f32 v18, s45, v18
    v_fma_f32 v244, v196, s45, -v18
    v_pk_fma_f32 v[240:241], v[192:193], v[200:201], v[18:19] op_sel_hi:[1,1,0] neg_lo:[0,0,1] neg_hi:[0,0,1]
    v_exp_f32 v244, v244
    v_pk_fma_f32 v[242:243], v[194:195], v[200:201], v[18:19] op_sel_hi:[1,1,0] neg_lo:[0,0,1] neg_hi:[0,0,1]
    v_exp_f32 v240, v240
    v_mov_b32_dpp v245, v244 row_ror:8 row_mask:0xf bank_mask:0xf
    v_cvt_pk_bf16_f32 v208, v244, v245
    v_cvt_pk_bf16_f32 v209, v244, v245
    v_pk_mov_b32 v[210:211], v[208:209], v[208:209] op_sel:[0,1]
    v_exp_f32 v241, v241
    s_waitcnt lgkmcnt(0)
    v_mfma_f32_16x16x32_bf16 v[228:231], v[212:215], v[208:211], 0
    v_exp_f32 v242, v242
    v_mfma_f32_16x16x32_bf16 v[224:227], v[164:167], v[208:211], 0
    v_exp_f32 v243, v243
    v_cvt_pk_bf16_f32 v204, v240, v241
    v_cvt_pk_bf16_f32 v205, v242, v243
    v_mfma_f32_16x16x32_bf16 v[232:235], v[216:219], v[208:211], 0
    v_mov_b32_dpp v206, v204 row_ror:8 row_mask:0xf bank_mask:0xf
    v_mov_b32_dpp v207, v205 row_ror:8 row_mask:0xf bank_mask:0xf
    s_nop 1
    v_mfma_f32_16x16x32_bf16 v[224:227], v[220:223], v[204:207], v[224:227]
    v_mfma_f32_16x16x32_bf16 v[228:231], v[136:139], v[204:207], v[228:231]
    v_mfma_f32_16x16x32_bf16 v[232:235], v[140:143], v[204:207], v[232:235]
    s_mov_b64 exec, s[50:51]
    v_rcp_f32 v18, v224
    s_nop 1
    v_mul_f32 v228, v18, v228
    v_mul_f32 v229, v18, v229
    v_mul_f32 v230, v18, v230
    v_mul_f32 v231, v18, v231
    v_pk_mul_f32 v[232:233], v[18:19], v[232:233] op_sel_hi:[0,1]
    v_pk_mul_f32 v[234:235], v[18:19], v[234:235] op_sel_hi:[0,1]
    v_cvt_pk_bf16_f32 v236, v228, v229
    v_cvt_pk_bf16_f32 v239, v234, v235
    v_cvt_pk_bf16_f32 v237, v230, v231
    v_cvt_pk_bf16_f32 v238, v232, v233
    v_min_u32 v239, 0xfffffffe, v239
    buffer_store_dwordx4 v[236:239], v14, s[8:11], s30 offen
    s_mov_b64 exec, -1
    v_mov_b32 v48, 0
    v_mov_b32 v49, 0
    v_mov_b32 v50, 0
    v_mov_b32 v51, 0
    v_mov_b32 v52, 0
    v_mov_b32 v53, 0
    v_mov_b32 v54, 0
    v_mov_b32 v55, 0
    v_mov_b32 v56, 0
    v_mov_b32 v57, 0
    v_mov_b32 v58, 0
    v_mov_b32 v59, 0
    v_mov_b32 v60, 0
    v_mov_b32 v61, 0
    v_mov_b32 v62, 0
    v_mov_b32 v63, 0
    s_waitcnt vmcnt(0)
    s_barrier
    s_setprio 3
    buffer_load_dwordx4 v[24:27], v4, s[8:11], s30 offen offset:0 sc1
    s_setprio 2
    buffer_load_dwordx4 v[28:31], v4, s[8:11], s30 offen offset:1024 sc1
    s_setprio 1
    buffer_load_dwordx4 v[32:35], v4, s[8:11], s30 offen offset:2048 sc1
    s_setprio 0
    buffer_load_dwordx4 v[36:39], v4, s[8:11], s30 offen offset:3072 sc1
    s_call_b64 s[98:99], .gm_23
    s_nop 6
    v_permlane32_swap_b32 v64, v68
    v_permlane32_swap_b32 v65, v69
    v_permlane32_swap_b32 v66, v70
    v_permlane32_swap_b32 v67, v71
    v_pk_add_f32 v[64:65], v[64:65], v[68:69]
    v_pk_add_f32 v[66:67], v[66:67], v[70:71]
    ds_write2_b32 v7, v64, v65 offset0:0 offset1:36
    ds_write2_b32 v7, v66, v67 offset0:72 offset1:108
    s_waitcnt lgkmcnt(0)
    s_barrier
    buffer_load_dwordx4 v[104:107], v15, s[8:11], s42 offen offset:0
    buffer_load_dwordx4 v[120:123], v15, s[8:11], s43 offen offset:0
    buffer_load_dwordx4 v[136:139], v15, s[8:11], s44 offen offset:0
    buffer_load_dwordx4 v[140:143], v15, s[8:11], s44 offen offset:1024
    s_add_u32 s42, s42, 262144
    s_add_u32 s43, s43, 262144
    s_add_u32 s44, s44, 262144
    v_mov_b32 v64, 0
    v_mov_b32 v65, 0
    v_mov_b32 v66, 0
    v_mov_b32 v67, 0
    v_mov_b32 v68, 0
    v_mov_b32 v69, 0
    v_mov_b32 v70, 0
    v_mov_b32 v71, 0
    s_mov_b32 s4, s30
    s_mov_b32 s30, s31
    s_mov_b32 s31, s32
    s_mov_b32 s32, s33
    s_mov_b32 s33, s4
    s_add_u32 s28, s28, 1
    s_mov_b32 s62, 0
    s_branch .step_24
.fin_25:
    s_waitcnt lgkmcnt(0)
    s_barrier
    s_barrier
    s_endpgm
.re_27:
    buffer_load_dwordx4 v[176:179], v13, s[8:11], s30 offen sc1
    buffer_load_dwordx4 v[180:183], v156, s[8:11], s30 offen sc1
    buffer_load_dwordx4 v[184:187], v157, s[8:11], s30 offen sc1
    buffer_load_dwordx4 v[188:191], v158, s[8:11], s30 offen sc1
    s_waitcnt vmcnt(7)
    v_max3_u32 v18, v72, v73, v74
    v_pk_add_f32 v[196:197], v[72:73], v[74:75]
    s_waitcnt vmcnt(6)
    v_max3_u32 v18, v18, v75, v79
    v_pk_add_f32 v[192:193], v[148:149], v[76:77]
    v_pk_add_f32 v[194:195], v[150:151], v[78:79]
    v_add_f32 v196, v196, v197
    s_waitcnt vmcnt(5)
    v_pk_add_f32 v[192:193], v[192:193], v[80:81]
    v_pk_add_f32 v[194:195], v[194:195], v[82:83]
    s_waitcnt vmcnt(4)
    v_max3_u32 v18, v18, v83, v87
    v_pk_add_f32 v[192:193], v[192:193], v[84:85]
    v_pk_add_f32 v[194:195], v[194:195], v[86:87]
    v_cmp_eq_u32 vcc, -1, v18
    v_max3_f32 v19, v192, v193, v196
    v_max3_f32 v19, v19, v194, v195
    s_cbranch_vccnz .re_29
    s_branch .sj_28
.re_29:
    buffer_load_dwordx4 v[72:75], v13, s[8:11], s30 offen sc1
    buffer_load_dwordx4 v[76:79], v156, s[8:11], s30 offen sc1
    buffer_load_dwordx4 v[80:83], v157, s[8:11], s30 offen sc1
    buffer_load_dwordx4 v[84:87], v158, s[8:11], s30 offen sc1
    s_add_u32 s62, s62, 1
    s_cmp_gt_u32 s62, 0x100000
    s_cbranch_scc1 .mg_end_1
    s_branch .mf_26
.w1_19:
    v_bfe_u32 v254, v1, 0, 3
    v_mul_u32_u24 v9, 144, v254
    v_bfe_u32 v254, v1, 3, 1
    v_mul_u32_u24 v254, 1152, v254
    v_add_u32 v9, v9, v254
    v_bfe_u32 v254, v1, 4, 2
    v_mul_u32_u24 v254, 32, v254
    v_add_u32 v9, v9, v254
    v_bfe_u32 v254, v1, 0, 1
    v_mul_u32_u24 v11, 144, v254
    v_bfe_u32 v254, v1, 2, 2
    v_mul_u32_u24 v254, 288, v254
    v_add_u32 v11, v11, v254
    v_bfe_u32 v254, v1, 1, 1
    v_mul_u32_u24 v254, 1152, v254
    v_add_u32 v11, v11, v254
    v_bfe_u32 v254, v1, 4, 2
    v_mul_u32_u24 v254, 32, v254
    v_add_u32 v11, v11, v254
    v_add_u32 v11, 4736, v11
    s_lshl_b32 s4, s56, 10
    s_lshl_b32 s5, s53, 2
    v_bfe_u32 v254, v1, 0, 6
    v_mul_u32_u24 v10, 16, v254
    v_add_u32 v10, 262144, v10
    v_add_u32 v10, s4, v10
    v_add_u32 v10, s5, v10
    v_bfe_u32 v254, v1, 1, 3
    v_mul_u32_u24 v12, 144, v254
    v_bfe_u32 v254, v1, 4, 2
    v_mul_u32_u24 v254, 32, v254
    v_add_u32 v12, v12, v254
    v_bfe_u32 v254, v1, 0, 1
    v_mul_u32_u24 v254, 16, v254
    v_add_u32 v12, v12, v254
    v_add_u32 v12, 9472, v12
    v_bfe_u32 v254, v1, 0, 6
    v_mul_u32_u24 v13, 16, v254
    v_add_u32 v13, s101, v13
    v_bfe_u32 v254, v1, 0, 6
    v_mul_u32_u24 v14, 8, v254
    v_add_u32 v14, s55, v14
    v_xor_b32 v14, 2048, v14
    v_min_u32 v249, 0xfffffffe, v249
    buffer_store_dwordx2 v[248:249], v14, s[8:11], s30 offen
    v_bfe_u32 v254, v1, 0, 6
    v_mul_u32_u24 v15, 16, v254
    s_add_u32 s42, s42, 262144
    s_add_u32 s43, s43, 262144
    s_add_u32 s44, s44, 262144
    buffer_load_dwordx4 v[24:27], v246, s[8:11], s31 offen sc1
    buffer_load_dwordx4 v[28:31], v245, s[8:11], s31 offen sc1
    buffer_load_dword v32, v237, s[8:11], s31 offen sc1
    s_waitcnt vmcnt(0)
    ds_read_b64_tr_b16 a[192:193], v242 offset:16384
    ds_read_b64_tr_b16 a[194:195], v242 offset:16896
    ds_read_b64_tr_b16 a[196:197], v242 offset:18432
    ds_read_b64_tr_b16 a[198:199], v242 offset:18944
    ds_read_b64_tr_b16 a[200:201], v242 offset:20480
    ds_read_b64_tr_b16 a[202:203], v242 offset:20992
    ds_read_b64_tr_b16 a[204:205], v242 offset:22528
    ds_read_b64_tr_b16 a[206:207], v242 offset:23040
    ds_read_b64_tr_b16 a[208:209], v242 offset:24576
    ds_read_b64_tr_b16 a[210:211], v242 offset:25088
    ds_read_b64_tr_b16 a[212:213], v242 offset:26624
    ds_read_b64_tr_b16 a[214:215], v242 offset:27136
    ds_read_b64_tr_b16 a[216:217], v242 offset:28672
    ds_read_b64_tr_b16 a[218:219], v242 offset:29184
    ds_read_b64_tr_b16 a[220:221], v242 offset:30720
    ds_read_b64_tr_b16 a[222:223], v242 offset:31232
    ds_read_b64_tr_b16 a[224:225], v243 offset:16384
    ds_read_b64_tr_b16 a[226:227], v243 offset:16896
    ds_read_b64_tr_b16 a[228:229], v243 offset:18432
    ds_read_b64_tr_b16 a[230:231], v243 offset:18944
    ds_read_b64_tr_b16 a[232:233], v243 offset:20480
    ds_read_b64_tr_b16 a[234:235], v243 offset:20992
    ds_read_b64_tr_b16 a[236:237], v243 offset:22528
    ds_read_b64_tr_b16 a[238:239], v243 offset:23040
    ds_read_b64_tr_b16 a[240:241], v243 offset:24576
    ds_read_b64_tr_b16 a[242:243], v243 offset:25088
    ds_read_b64_tr_b16 a[244:245], v243 offset:26624
    ds_read_b64_tr_b16 a[246:247], v243 offset:27136
    ds_read_b64_tr_b16 a[248:249], v243 offset:28672
    ds_read_b64_tr_b16 a[250:251], v243 offset:29184
    ds_read_b64_tr_b16 a[252:253], v243 offset:30720
    ds_read_b64_tr_b16 a[254:255], v243 offset:31232
    s_waitcnt lgkmcnt(0)
    s_barrier
.p2align 6
.step_30:
    s_barrier
    s_setprio 3
    buffer_load_dwordx4 v[24:27], v3, s[8:11], s30 offen offset:0 sc1
    s_setprio 2
    buffer_load_dwordx4 v[28:31], v3, s[8:11], s30 offen offset:1024 sc1
    s_setprio 1
    buffer_load_dwordx4 v[32:35], v3, s[8:11], s30 offen offset:2048 sc1
    s_setprio 0
    buffer_load_dwordx4 v[36:39], v3, s[8:11], s30 offen offset:3072 sc1
    s_call_b64 s[98:99], .gm_22
    v_permlane32_swap_b32 v40, v44
    v_permlane32_swap_b32 v41, v45
    v_permlane32_swap_b32 v42, v46
    v_permlane32_swap_b32 v43, v47
    v_add_f32 v40, v40, v44
    v_add_f32 v41, v41, v45
    v_add_f32 v42, v42, v46
    v_add_f32 v43, v43, v47
    ds_write2_b32 v5, v40, v41 offset0:0 offset1:36
    ds_write2_b32 v5, v42, v43 offset0:72 offset1:108
    v_permlane32_swap_b32 v48, v52
    v_permlane32_swap_b32 v49, v53
    v_permlane32_swap_b32 v50, v54
    v_permlane32_swap_b32 v51, v55
    v_pk_add_f32 v[48:49], v[48:49], v[52:53]
    v_pk_add_f32 v[50:51], v[50:51], v[54:55]
    ds_write2_b32 v6, v48, v49 offset0:0 offset1:36
    ds_write2_b32 v6, v50, v51 offset0:72 offset1:108
    s_waitcnt lgkmcnt(2)
    s_barrier
    ds_read_b128 v[72:75], v9 offset:0
    ds_read_b128 v[76:79], v9 offset:2304
    ds_read_b128 v[80:83], v9 offset:16
    ds_read_b128 v[84:87], v9 offset:2320
    v_smfmac_f32_16x16x64_bf16 v[56:59], v[24:27], a[128:135], v2
    v_smfmac_f32_16x16x64_bf16 v[60:63], v[24:27], a[160:167], v2
    s_waitcnt lgkmcnt(4)
    s_barrier
    ds_read_b128 v[88:91], v11 offset:0
    ds_read_b128 v[92:95], v11 offset:2304
    ds_read_b128 v[96:99], v11 offset:16
    ds_read_b128 v[100:103], v11 offset:2320
    v_smfmac_f32_16x16x64_bf16 v[56:59], v[28:31], a[136:143], v2
    s_waitcnt lgkmcnt(6)
    v_pk_add_f32 v[72:73], v[72:73], v[76:77]
    v_pk_add_f32 v[74:75], v[74:75], v[78:79]
    v_cvt_pk_bf16_f32 v144, v72, v73
    v_cvt_pk_bf16_f32 v145, v74, v75
    s_waitcnt lgkmcnt(4)
    v_pk_add_f32 v[80:81], v[80:81], v[84:85]
    v_pk_add_f32 v[82:83], v[82:83], v[86:87]
    v_cvt_pk_bf16_f32 v146, v80, v81
    v_cvt_pk_bf16_f32 v147, v82, v83
    s_waitcnt lgkmcnt(2)
    v_pk_add_f32 v[88:89], v[88:89], v[92:93]
    v_pk_add_f32 v[90:91], v[90:91], v[94:95]
    v_cvt_pk_bf16_f32 v148, v88, v89
    v_cvt_pk_bf16_f32 v149, v90, v91
    s_waitcnt lgkmcnt(0)
    v_pk_add_f32 v[96:97], v[96:97], v[100:101]
    v_pk_add_f32 v[98:99], v[98:99], v[102:103]
    v_cvt_pk_bf16_f32 v150, v96, v97
    v_cvt_pk_bf16_f32 v151, v98, v99
    s_nop 1
    v_mfma_f32_16x16x32_bf16 v[196:199], v[148:151], v[144:147], 0
    v_smfmac_f32_16x16x64_bf16 v[60:63], v[28:31], a[168:175], v2
    v_smfmac_f32_16x16x64_bf16 v[56:59], v[32:35], a[144:151], v2
    v_pk_add_f32 v[196:197], v[196:197], v[198:199]
    s_nop 1
    v_add_f32_dpp v198, v196, v196 row_ror:8 row_mask:0xf bank_mask:0xf
    v_add_f32_dpp v199, v197, v197 row_ror:8 row_mask:0xf bank_mask:0xf
    v_cndmask_b32 v198, v199, v198, s[48:49]
    v_min_u32 v198, 0xfffffffe, v198
    buffer_store_dword v198, v10, s[8:11], s30 offen
    v_smfmac_f32_16x16x64_bf16 v[60:63], v[32:35], a[176:183], v2
    v_smfmac_f32_16x16x64_bf16 v[56:59], v[36:39], a[152:159], v2
    v_smfmac_f32_16x16x64_bf16 v[60:63], v[36:39], a[184:191], v2
    v_mov_b32 v40, 0
    v_mov_b32 v41, 0
    v_mov_b32 v42, 0
    v_mov_b32 v43, 0
    v_mov_b32 v44, 0
    v_mov_b32 v45, 0
    v_mov_b32 v46, 0
    v_mov_b32 v47, 0
    v_permlane32_swap_b32 v56, v60
    v_permlane32_swap_b32 v57, v61
    v_permlane32_swap_b32 v58, v62
    v_permlane32_swap_b32 v59, v63
    v_pk_add_f32 v[56:57], v[56:57], v[60:61]
    v_pk_add_f32 v[58:59], v[58:59], v[62:63]
    v_cvt_pk_bf16_f32 v60, v56, v57
    v_cvt_pk_bf16_f32 v61, v58, v59
    ds_write2_b32 v255, v60, v61 offset0:0 offset1:64
    ds_write_b128 v8, v[56:59]
    s_waitcnt lgkmcnt(0)
    s_barrier
    s_cmp_eq_u32 s28, 63
    s_cbranch_scc1 .fin_31
    s_xor_b32 s38, s34, 0x4000
    s_xor_b32 s39, s34, 0x1000
    s_xor_b32 s40, s34, 0x5000
    v_mov_b32 v48, 0
    v_mov_b32 v49, 0
    v_mov_b32 v50, 0
    v_mov_b32 v51, 0
    v_mov_b32 v52, 0
    v_mov_b32 v53, 0
    v_mov_b32 v54, 0
    v_mov_b32 v55, 0
    v_mov_b32 v56, 0
    v_mov_b32 v57, 0
    v_mov_b32 v58, 0
    v_mov_b32 v59, 0
    v_mov_b32 v60, 0
    v_mov_b32 v61, 0
    v_mov_b32 v62, 0
    v_mov_b32 v63, 0
    s_barrier
    s_setprio 3
    buffer_load_dwordx4 v[24:27], v4, s[8:11], s30 offen offset:0 sc1
    s_setprio 2
    buffer_load_dwordx4 v[28:31], v4, s[8:11], s30 offen offset:1024 sc1
    s_setprio 1
    buffer_load_dwordx4 v[32:35], v4, s[8:11], s30 offen offset:2048 sc1
    s_setprio 0
    buffer_load_dwordx4 v[36:39], v4, s[8:11], s30 offen offset:3072 sc1
    s_call_b64 s[98:99], .gm_23
    s_nop 6
    v_permlane32_swap_b32 v64, v68
    v_permlane32_swap_b32 v65, v69
    v_permlane32_swap_b32 v66, v70
    v_permlane32_swap_b32 v67, v71
    v_pk_add_f32 v[64:65], v[64:65], v[68:69]
    v_pk_add_f32 v[66:67], v[66:67], v[70:71]
    ds_write2_b32 v7, v64, v65 offset0:0 offset1:36
    ds_write2_b32 v7, v66, v67 offset0:72 offset1:108
    s_waitcnt lgkmcnt(0)
    s_barrier
    ds_read_b128 v[72:75], v12 offset:0
    ds_read_b128 v[76:79], v12 offset:1152
    ds_read_b128 v[80:83], v12 offset:2304
    ds_read_b128 v[84:87], v12 offset:3456
    s_waitcnt lgkmcnt(2)
    v_pk_add_f32 v[72:73], v[72:73], v[76:77]
    v_pk_add_f32 v[74:75], v[74:75], v[78:79]
    s_waitcnt lgkmcnt(0)
    v_pk_add_f32 v[80:81], v[80:81], v[84:85]
    v_pk_add_f32 v[82:83], v[82:83], v[86:87]
    v_pk_add_f32 v[72:73], v[72:73], v[80:81]
    v_pk_add_f32 v[74:75], v[74:75], v[82:83]
    v_min_u32 v75, 0xfffffffe, v75
    buffer_store_dwordx4 v[72:75], v13, s[8:11], s34 offen sc1
    v_mov_b32 v64, 0
    v_mov_b32 v65, 0
    v_mov_b32 v66, 0
    v_mov_b32 v67, 0
    v_mov_b32 v68, 0
    v_mov_b32 v69, 0
    v_mov_b32 v70, 0
    v_mov_b32 v71, 0
    s_waitcnt vmcnt(0)
.pl_32:
    buffer_load_dwordx4 v[76:79], v13, s[8:11], s38 offen sc1
    buffer_load_dwordx4 v[80:83], v13, s[8:11], s39 offen sc1
    buffer_load_dwordx4 v[84:87], v13, s[8:11], s40 offen sc1
    s_waitcnt vmcnt(2)
    v_pk_add_f32 v[88:89], v[72:73], v[76:77]
    v_pk_add_f32 v[90:91], v[74:75], v[78:79]
    s_waitcnt vmcnt(0)
    v_max3_u32 v18, v79, v83, v87
    v_cmp_eq_u32 vcc, -1, v18
    v_pk_add_f32 v[80:81], v[80:81], v[84:85]
    v_pk_add_f32 v[82:83], v[82:83], v[86:87]
    v_pk_add_f32 v[88:89], v[88:89], v[80:81]
    v_pk_add_f32 v[90:91], v[90:91], v[82:83]
    v_cvt_pk_bf16_f32 v92, v88, v89
    v_cvt_pk_bf16_f32 v93, v90, v91
    v_min_u32 v93, 0xfffffffe, v93
    s_cbranch_vccnz .pr_33
    buffer_store_dwordx2 v[92:93], v14, s[8:11], s31 offen
    s_mov_b32 s4, s30
    s_mov_b32 s30, s31
    s_mov_b32 s31, s32
    s_mov_b32 s32, s33
    s_mov_b32 s33, s4
    s_add_u32 s28, s28, 1
    s_mov_b32 s62, 0
    s_mov_b32 s4, s34
    s_mov_b32 s34, s35
    s_mov_b32 s35, s36
    s_mov_b32 s36, s37
    s_mov_b32 s37, s4
    s_branch .step_30
.fin_31:
    s_barrier
    s_waitcnt vmcnt(0)
    s_endpgm
.pr_33:
    s_add_u32 s62, s62, 1
    s_cmp_gt_u32 s62, 0x100000
    s_cbranch_scc1 .mg_end_1
    s_branch .pl_32
.w2_20:
    s_lshl_b32 s4, s56, 9
    s_lshl_b32 s5, s53, 7
    s_add_u32 s4, s4, s5
    s_add_u32 s4, s4, 92274688
    v_mov_b32 v14, s4
    v_bfe_u32 v254, v1, 0, 6
    v_mul_u32_u24 v12, 16, v254
    v_add_u32 v12, 18176, v12
    v_bfe_u32 v254, v1, 0, 6
    v_mul_u32_u24 v15, 16, v254
    s_add_u32 s42, s42, 262144
    s_add_u32 s43, s43, 262144
    s_add_u32 s44, s44, 262144
    s_mov_b32 exec_hi, 0
    v_xor_b32 v244, 1024, v244
    s_mov_b32 exec_hi, -1
    buffer_load_dwordx4 v[24:27], v246, s[8:11], s32 offen sc1
    buffer_load_dwordx4 v[28:31], v245, s[8:11], s32 offen sc1
    buffer_load_dword v32, v237, s[8:11], s32 offen sc1
    s_waitcnt vmcnt(0)
    ds_read_b64_tr_b16 a[192:193], v242 offset:16384
    ds_read_b64_tr_b16 a[194:195], v242 offset:16896
    ds_read_b64_tr_b16 a[196:197], v242 offset:18432
    ds_read_b64_tr_b16 a[198:199], v242 offset:18944
    ds_read_b64_tr_b16 a[200:201], v242 offset:20480
    ds_read_b64_tr_b16 a[202:203], v242 offset:20992
    ds_read_b64_tr_b16 a[204:205], v242 offset:22528
    ds_read_b64_tr_b16 a[206:207], v242 offset:23040
    ds_read_b64_tr_b16 a[208:209], v242 offset:24576
    ds_read_b64_tr_b16 a[210:211], v242 offset:25088
    ds_read_b64_tr_b16 a[212:213], v242 offset:26624
    ds_read_b64_tr_b16 a[214:215], v242 offset:27136
    ds_read_b64_tr_b16 a[216:217], v242 offset:28672
    ds_read_b64_tr_b16 a[218:219], v242 offset:29184
    ds_read_b64_tr_b16 a[220:221], v242 offset:30720
    ds_read_b64_tr_b16 a[222:223], v242 offset:31232
    ds_read_b64_tr_b16 a[224:225], v243 offset:16384
    ds_read_b64_tr_b16 a[226:227], v243 offset:16896
    ds_read_b64_tr_b16 a[228:229], v243 offset:18432
    ds_read_b64_tr_b16 a[230:231], v243 offset:18944
    ds_read_b64_tr_b16 a[232:233], v243 offset:20480
    ds_read_b64_tr_b16 a[234:235], v243 offset:20992
    ds_read_b64_tr_b16 a[236:237], v243 offset:22528
    ds_read_b64_tr_b16 a[238:239], v243 offset:23040
    ds_read_b64_tr_b16 a[240:241], v243 offset:24576
    ds_read_b64_tr_b16 a[242:243], v243 offset:25088
    ds_read_b64_tr_b16 a[244:245], v243 offset:26624
    ds_read_b64_tr_b16 a[246:247], v243 offset:27136
    ds_read_b64_tr_b16 a[248:249], v243 offset:28672
    ds_read_b64_tr_b16 a[250:251], v243 offset:29184
    ds_read_b64_tr_b16 a[252:253], v243 offset:30720
    ds_read_b64_tr_b16 a[254:255], v243 offset:31232
    s_waitcnt lgkmcnt(0)
    s_barrier
.p2align 6
.step_34:
    s_barrier
    s_setprio 3
    buffer_load_dwordx4 v[24:27], v3, s[8:11], s30 offen offset:0 sc1
    s_setprio 2
    buffer_load_dwordx4 v[28:31], v3, s[8:11], s30 offen offset:1024 sc1
    s_setprio 1
    buffer_load_dwordx4 v[32:35], v3, s[8:11], s30 offen offset:2048 sc1
    s_setprio 0
    buffer_load_dwordx4 v[36:39], v3, s[8:11], s30 offen offset:3072 sc1
    s_call_b64 s[98:99], .gm_22
    v_permlane32_swap_b32 v40, v44
    v_permlane32_swap_b32 v41, v45
    v_permlane32_swap_b32 v42, v46
    v_permlane32_swap_b32 v43, v47
    v_add_f32 v40, v40, v44
    v_add_f32 v41, v41, v45
    v_add_f32 v42, v42, v46
    v_add_f32 v43, v43, v47
    ds_write2_b32 v5, v40, v41 offset0:0 offset1:36
    ds_write2_b32 v5, v42, v43 offset0:72 offset1:108
    v_permlane32_swap_b32 v48, v52
    v_permlane32_swap_b32 v49, v53
    v_permlane32_swap_b32 v50, v54
    v_permlane32_swap_b32 v51, v55
    v_pk_add_f32 v[48:49], v[48:49], v[52:53]
    v_pk_add_f32 v[50:51], v[50:51], v[54:55]
    ds_write2_b32 v6, v48, v49 offset0:0 offset1:36
    ds_write2_b32 v6, v50, v51 offset0:72 offset1:108
    s_waitcnt lgkmcnt(2)
    s_barrier
    s_waitcnt lgkmcnt(0)
    s_barrier
    v_smfmac_f32_16x16x64_bf16 v[56:59], v[24:27], a[128:135], v2
    v_smfmac_f32_16x16x64_bf16 v[60:63], v[24:27], a[160:167], v2
    v_smfmac_f32_16x16x64_bf16 v[56:59], v[28:31], a[136:143], v2
    v_smfmac_f32_16x16x64_bf16 v[60:63], v[28:31], a[168:175], v2
    v_smfmac_f32_16x16x64_bf16 v[56:59], v[32:35], a[144:151], v2
    v_smfmac_f32_16x16x64_bf16 v[60:63], v[32:35], a[176:183], v2
    v_smfmac_f32_16x16x64_bf16 v[56:59], v[36:39], a[152:159], v2
    v_smfmac_f32_16x16x64_bf16 v[60:63], v[36:39], a[184:191], v2
    ds_read_b64 v[72:73], v9 offset:0
    ds_read_b64 v[74:75], v9 offset:1152
    ds_read_b64 v[76:77], v9 offset:2304
    ds_read_b64 v[78:79], v9 offset:3456
    s_waitcnt lgkmcnt(0)
    v_pk_add_f32 v[72:73], v[72:73], v[74:75]
    v_pk_add_f32 v[76:77], v[76:77], v[78:79]
    v_pk_add_f32 v[72:73], v[72:73], v[76:77]
    v_cvt_pk_bf16_f32 v72, v72, v73
    ds_write_b32 v11, v72
    v_mov_b32 v40, 0
    v_mov_b32 v41, 0
    v_mov_b32 v42, 0
    v_mov_b32 v43, 0
    v_mov_b32 v44, 0
    v_mov_b32 v45, 0
    v_mov_b32 v46, 0
    v_mov_b32 v47, 0
    v_permlane32_swap_b32 v56, v60
    v_permlane32_swap_b32 v57, v61
    v_permlane32_swap_b32 v58, v62
    v_permlane32_swap_b32 v59, v63
    v_pk_add_f32 v[56:57], v[56:57], v[60:61]
    v_pk_add_f32 v[58:59], v[58:59], v[62:63]
    v_cvt_pk_bf16_f32 v60, v56, v57
    v_cvt_pk_bf16_f32 v61, v58, v59
    ds_write2_b32 v255, v60, v61 offset0:0 offset1:64
    ds_write_b128 v8, v[56:59]
    s_waitcnt lgkmcnt(0)
    s_barrier
    s_cmp_eq_u32 s28, 63
    s_cbranch_scc1 .fin_35
    s_waitcnt lgkmcnt(0)
    v_mov_b32 v48, 0
    v_mov_b32 v49, 0
    v_mov_b32 v50, 0
    v_mov_b32 v51, 0
    v_mov_b32 v52, 0
    v_mov_b32 v53, 0
    v_mov_b32 v54, 0
    v_mov_b32 v55, 0
    v_mov_b32 v56, 0
    v_mov_b32 v57, 0
    v_mov_b32 v58, 0
    v_mov_b32 v59, 0
    v_mov_b32 v60, 0
    v_mov_b32 v61, 0
    v_mov_b32 v62, 0
    v_mov_b32 v63, 0
    s_barrier
    ds_read_b128 v[72:75], v12
    s_setprio 3
    buffer_load_dwordx4 v[24:27], v4, s[8:11], s30 offen offset:0 sc1
    s_setprio 2
    buffer_load_dwordx4 v[28:31], v4, s[8:11], s30 offen offset:1024 sc1
    s_setprio 1
    buffer_load_dwordx4 v[32:35], v4, s[8:11], s30 offen offset:2048 sc1
    s_setprio 0
    buffer_load_dwordx4 v[36:39], v4, s[8:11], s30 offen offset:3072 sc1
    s_call_b64 s[98:99], .gm_23
    s_waitcnt lgkmcnt(0)
    buffer_store_dwordx4 v[72:75], v244, s[8:11], s41 offen sc1
    s_nop 5
    v_permlane32_swap_b32 v64, v68
    v_permlane32_swap_b32 v65, v69
    v_permlane32_swap_b32 v66, v70
    v_permlane32_swap_b32 v67, v71
    v_pk_add_f32 v[64:65], v[64:65], v[68:69]
    v_pk_add_f32 v[66:67], v[66:67], v[70:71]
    ds_write2_b32 v7, v64, v65 offset0:0 offset1:36
    ds_write2_b32 v7, v66, v67 offset0:72 offset1:108
    s_waitcnt lgkmcnt(0)
    s_barrier
    s_cmp_lt_u32 s28, 52
    s_cselect_b32 s4, 1, 0
    s_andn2_b32 s4, s4, s28
    s_cbranch_scc1 .nl_36
    v_mov_b32 v18, s28
    v_add_u32 v18, 1, v18
    s_mov_b64 exec, 1
    s_waitcnt vmcnt(0)
    buffer_store_dword v18, v14, s[8:11], 0 offen sc1
    s_mov_b64 exec, -1
.nl_36:
    v_mov_b32 v64, 0
    v_mov_b32 v65, 0
    v_mov_b32 v66, 0
    v_mov_b32 v67, 0
    v_mov_b32 v68, 0
    v_mov_b32 v69, 0
    v_mov_b32 v70, 0
    v_mov_b32 v71, 0
    s_mov_b32 s4, s30
    s_mov_b32 s30, s31
    s_mov_b32 s31, s32
    s_mov_b32 s32, s33
    s_mov_b32 s33, s4
    s_add_u32 s28, s28, 1
    s_mov_b32 s62, 0
    s_add_u32 s41, s41, 0x20000
    s_branch .step_34
.fin_35:
    s_barrier
    ds_read_b128 v[72:75], v12
    s_waitcnt lgkmcnt(0)
    buffer_store_dwordx4 v[72:75], v244, s[8:11], s41 offen sc1
    s_waitcnt vmcnt(0)
    v_mov_b32 v18, 64
    s_mov_b64 exec, 1
    buffer_store_dword v18, v14, s[8:11], 0 offen sc1
    s_mov_b64 exec, -1
    s_endpgm
.w3_21:
    v_bfe_u32 v254, v1, 3, 1
    v_mul_u32_u24 v12, 512, v254
    v_bfe_u32 v254, v1, 5, 1
    v_mul_u32_u24 v254, 256, v254
    v_add_u32 v12, v12, v254
    v_bfe_u32 v254, v1, 2, 1
    v_mul_u32_u24 v254, 128, v254
    v_add_u32 v12, v12, v254
    v_bfe_u32 v254, v1, 0, 2
    v_mul_u32_u24 v254, 16, v254
    v_add_u32 v12, v12, v254
    v_bfe_u32 v254, v1, 4, 1
    v_mul_u32_u24 v254, 8, v254
    v_add_u32 v12, v12, v254
    v_add_u32 v12, 14080, v12
    v_bfe_u32 v254, v1, 2, 2
    v_mul_u32_u24 v14, 128, v254
    v_bfe_u32 v254, v1, 0, 2
    v_mul_u32_u24 v254, 16, v254
    v_add_u32 v14, v14, v254
    v_bfe_u32 v254, v1, 4, 2
    v_mul_u32_u24 v254, 4, v254
    v_add_u32 v14, v14, v254
    v_add_u32 v14, 18688, v14
    v_bfe_u32 v254, v1, 0, 6
    v_mul_u32_u24 v15, 16, v254
    v_add_u32 v15, s101, v15
    v_bfe_u32 v254, v1, 2, 2
    v_mul_u32_u24 v16, 128, v254
    v_bfe_u32 v254, v1, 0, 2
    v_mul_u32_u24 v254, 16, v254
    v_add_u32 v16, v16, v254
    v_bfe_u32 v254, v1, 4, 2
    v_mul_u32_u24 v254, 4, v254
    v_add_u32 v16, v16, v254
    v_add_u32 v16, 135168, v16
    v_add_u32 v16, s58, v16
    s_lshl_b32 s4, s56, 9
    s_add_u32 s4, s4, 92291072
    v_bfe_u32 v254, v1, 0, 2
    v_mul_u32_u24 v13, 128, v254
    v_bfe_u32 v254, v1, 2, 1
    v_mul_u32_u24 v254, 16384, v254
    v_add_u32 v13, v13, v254
    v_add_u32 v13, s4, v13
    buffer_load_dwordx4 v[24:27], v246, s[8:11], s33 offen sc1
    buffer_load_dwordx4 v[28:31], v245, s[8:11], s33 offen sc1
    buffer_load_dword v32, v237, s[8:11], s33 offen sc1
    s_waitcnt vmcnt(0)
    ds_read_b64_tr_b16 a[192:193], v242 offset:16384
    ds_read_b64_tr_b16 a[194:195], v242 offset:16896
    ds_read_b64_tr_b16 a[196:197], v242 offset:18432
    ds_read_b64_tr_b16 a[198:199], v242 offset:18944
    ds_read_b64_tr_b16 a[200:201], v242 offset:20480
    ds_read_b64_tr_b16 a[202:203], v242 offset:20992
    ds_read_b64_tr_b16 a[204:205], v242 offset:22528
    ds_read_b64_tr_b16 a[206:207], v242 offset:23040
    ds_read_b64_tr_b16 a[208:209], v242 offset:24576
    ds_read_b64_tr_b16 a[210:211], v242 offset:25088
    ds_read_b64_tr_b16 a[212:213], v242 offset:26624
    ds_read_b64_tr_b16 a[214:215], v242 offset:27136
    ds_read_b64_tr_b16 a[216:217], v242 offset:28672
    ds_read_b64_tr_b16 a[218:219], v242 offset:29184
    ds_read_b64_tr_b16 a[220:221], v242 offset:30720
    ds_read_b64_tr_b16 a[222:223], v242 offset:31232
    ds_read_b64_tr_b16 a[224:225], v243 offset:16384
    ds_read_b64_tr_b16 a[226:227], v243 offset:16896
    ds_read_b64_tr_b16 a[228:229], v243 offset:18432
    ds_read_b64_tr_b16 a[230:231], v243 offset:18944
    ds_read_b64_tr_b16 a[232:233], v243 offset:20480
    ds_read_b64_tr_b16 a[234:235], v243 offset:20992
    ds_read_b64_tr_b16 a[236:237], v243 offset:22528
    ds_read_b64_tr_b16 a[238:239], v243 offset:23040
    ds_read_b64_tr_b16 a[240:241], v243 offset:24576
    ds_read_b64_tr_b16 a[242:243], v243 offset:25088
    ds_read_b64_tr_b16 a[244:245], v243 offset:26624
    ds_read_b64_tr_b16 a[246:247], v243 offset:27136
    ds_read_b64_tr_b16 a[248:249], v243 offset:28672
    ds_read_b64_tr_b16 a[250:251], v243 offset:29184
    ds_read_b64_tr_b16 a[252:253], v243 offset:30720
    ds_read_b64_tr_b16 a[254:255], v243 offset:31232
    s_waitcnt lgkmcnt(0)
    s_cmp_ge_u32 s46, 1
    s_cbranch_scc1 .kvd_38
    s_mov_b32 s62, 0
.kv_37:
    buffer_load_dword v18, v13, s[8:11], 0 offen sc1
    s_add_u32 s62, s62, 1
    s_cmp_gt_u32 s62, 0x100000
    s_cbranch_scc1 .mg_end_1
    s_waitcnt vmcnt(0)
    v_min_u32_dpp v18, v18, v18 quad_perm:[1,0,3,2] row_mask:0xf bank_mask:0xf
    s_nop 1
    v_min_u32_dpp v18, v18, v18 quad_perm:[2,3,0,1] row_mask:0xf bank_mask:0xf
    s_nop 1
    v_min_u32_dpp v18, v18, v18 row_half_mirror row_mask:0xf bank_mask:0xf
    s_nop 0
    v_readfirstlane_b32 s46, v18
    s_cmp_lt_u32 s46, 1
    s_cbranch_scc1 .kv_37
.kvd_38:
    s_barrier
.p2align 6
.step_39:
    s_barrier
    s_setprio 3
    buffer_load_dwordx4 v[24:27], v3, s[8:11], s30 offen offset:0 sc1
    s_setprio 2
    buffer_load_dwordx4 v[28:31], v3, s[8:11], s30 offen offset:1024 sc1
    s_setprio 1
    buffer_load_dwordx4 v[32:35], v3, s[8:11], s30 offen offset:2048 sc1
    s_setprio 0
    buffer_load_dwordx4 v[36:39], v3, s[8:11], s30 offen offset:3072 sc1
    s_call_b64 s[98:99], .gm_22
    v_permlane32_swap_b32 v40, v44
    v_permlane32_swap_b32 v41, v45
    v_permlane32_swap_b32 v42, v46
    v_permlane32_swap_b32 v43, v47
    v_add_f32 v40, v40, v44
    v_add_f32 v41, v41, v45
    v_add_f32 v42, v42, v46
    v_add_f32 v43, v43, v47
    ds_write2_b32 v5, v40, v41 offset0:0 offset1:36
    ds_write2_b32 v5, v42, v43 offset0:72 offset1:108
    v_permlane32_swap_b32 v48, v52
    v_permlane32_swap_b32 v49, v53
    v_permlane32_swap_b32 v50, v54
    v_permlane32_swap_b32 v51, v55
    v_pk_add_f32 v[48:49], v[48:49], v[52:53]
    v_pk_add_f32 v[50:51], v[50:51], v[54:55]
    ds_write2_b32 v6, v48, v49 offset0:0 offset1:36
    ds_write2_b32 v6, v50, v51 offset0:72 offset1:108
    s_waitcnt lgkmcnt(2)
    s_barrier
    s_waitcnt lgkmcnt(0)
    s_barrier
    v_smfmac_f32_16x16x64_bf16 v[56:59], v[24:27], a[128:135], v2
    v_smfmac_f32_16x16x64_bf16 v[60:63], v[24:27], a[160:167], v2
    v_smfmac_f32_16x16x64_bf16 v[56:59], v[28:31], a[136:143], v2
    v_smfmac_f32_16x16x64_bf16 v[60:63], v[28:31], a[168:175], v2
    v_smfmac_f32_16x16x64_bf16 v[56:59], v[32:35], a[144:151], v2
    v_smfmac_f32_16x16x64_bf16 v[60:63], v[32:35], a[176:183], v2
    v_smfmac_f32_16x16x64_bf16 v[56:59], v[36:39], a[152:159], v2
    v_smfmac_f32_16x16x64_bf16 v[60:63], v[36:39], a[184:191], v2
    ds_read_b64 v[72:73], v9 offset:0
    ds_read_b64 v[74:75], v9 offset:1152
    ds_read_b64 v[76:77], v9 offset:2304
    ds_read_b64 v[78:79], v9 offset:3456
    s_waitcnt lgkmcnt(0)
    v_pk_add_f32 v[72:73], v[72:73], v[74:75]
    v_pk_add_f32 v[76:77], v[76:77], v[78:79]
    v_pk_add_f32 v[72:73], v[72:73], v[76:77]
    v_cvt_pk_bf16_f32 v72, v72, v73
    ds_write_b32 v11, v72
    v_mov_b32 v40, 0
    v_mov_b32 v41, 0
    v_mov_b32 v42, 0
    v_mov_b32 v43, 0
    v_mov_b32 v44, 0
    v_mov_b32 v45, 0
    v_mov_b32 v46, 0
    v_mov_b32 v47, 0
    v_permlane32_swap_b32 v56, v60
    v_permlane32_swap_b32 v57, v61
    v_permlane32_swap_b32 v58, v62
    v_permlane32_swap_b32 v59, v63
    v_pk_add_f32 v[56:57], v[56:57], v[60:61]
    v_pk_add_f32 v[58:59], v[58:59], v[62:63]
    v_cvt_pk_bf16_f32 v60, v56, v57
    v_cvt_pk_bf16_f32 v61, v58, v59
    ds_write2_b32 v255, v60, v61 offset0:0 offset1:64
    ds_write_b128 v8, v[56:59]
    s_waitcnt lgkmcnt(0)
    s_barrier
    ds_read_b64 v[72:73], v12 offset:0
    ds_read_b64 v[74:75], v12 offset:1024
    ds_read_b64 v[76:77], v12 offset:2048
    ds_read_b64 v[78:79], v12 offset:3072
    ds_read_b64 v[80:81], v12 offset:64
    ds_read_b64 v[82:83], v12 offset:1088
    ds_read_b64 v[84:85], v12 offset:2112
    ds_read_b64 v[86:87], v12 offset:3136
    s_waitcnt lgkmcnt(4)
    v_add_f32 v72, v72, v74
    v_add_f32 v73, v73, v75
    v_add_f32 v76, v76, v78
    v_add_f32 v77, v77, v79
    v_add_f32 v72, v72, v76
    v_add_f32 v73, v73, v77
    v_cvt_pk_bf16_f32 v72, v72, v73
    s_waitcnt lgkmcnt(0)
    v_add_f32 v80, v80, v82
    v_add_f32 v81, v81, v83
    v_add_f32 v84, v84, v86
    v_add_f32 v85, v85, v87
    v_add_f32 v80, v80, v84
    v_add_f32 v81, v81, v85
    v_cvt_pk_bf16_f32 v80, v80, v81
    ds_write_b32 v14, v72
    ds_write_b32 v14, v80 offset:64
    s_waitcnt lgkmcnt(0)
    s_cmp_eq_u32 s28, 63
    s_cbranch_scc1 .fin_40
    buffer_store_dwordx4 v[20:23], v246, s[8:11], s32 offen
    buffer_store_dwordx4 v[20:23], v245, s[8:11], s32 offen
    buffer_store_dword v20, v237, s[8:11], s32 offen
    s_add_u32 s5, s28, 2
    s_cmp_ge_u32 s46, s5
    s_cbranch_scc1 .kvd_42
    s_mov_b32 s62, 0
.kv_41:
    buffer_load_dword v18, v13, s[8:11], 0 offen sc1
    s_add_u32 s62, s62, 1
    s_cmp_gt_u32 s62, 0x100000
    s_cbranch_scc1 .mg_end_1
    s_waitcnt vmcnt(0)
    v_min_u32_dpp v18, v18, v18 quad_perm:[1,0,3,2] row_mask:0xf bank_mask:0xf
    s_nop 1
    v_min_u32_dpp v18, v18, v18 quad_perm:[2,3,0,1] row_mask:0xf bank_mask:0xf
    s_nop 1
    v_min_u32_dpp v18, v18, v18 row_half_mirror row_mask:0xf bank_mask:0xf
    s_nop 0
    v_readfirstlane_b32 s46, v18
    s_cmp_lt_u32 s46, s5
    s_cbranch_scc1 .kv_41
.kvd_42:
    v_mov_b32 v48, 0
    v_mov_b32 v49, 0
    v_mov_b32 v50, 0
    v_mov_b32 v51, 0
    v_mov_b32 v52, 0
    v_mov_b32 v53, 0
    v_mov_b32 v54, 0
    v_mov_b32 v55, 0
    v_mov_b32 v56, 0
    v_mov_b32 v57, 0
    v_mov_b32 v58, 0
    v_mov_b32 v59, 0
    v_mov_b32 v60, 0
    v_mov_b32 v61, 0
    v_mov_b32 v62, 0
    v_mov_b32 v63, 0
    s_barrier
    s_setprio 3
    buffer_load_dwordx4 v[24:27], v4, s[8:11], s30 offen offset:0 sc1
    s_setprio 2
    buffer_load_dwordx4 v[28:31], v4, s[8:11], s30 offen offset:1024 sc1
    s_setprio 1
    buffer_load_dwordx4 v[32:35], v4, s[8:11], s30 offen offset:2048 sc1
    s_setprio 0
    buffer_load_dwordx4 v[36:39], v4, s[8:11], s30 offen offset:3072 sc1
    s_call_b64 s[98:99], .gm_23
    buffer_store_dwordx4 v[20:23], v15, s[8:11], s36 offen sc1
    s_nop 5
    v_permlane32_swap_b32 v64, v68
    v_permlane32_swap_b32 v65, v69
    v_permlane32_swap_b32 v66, v70
    v_permlane32_swap_b32 v67, v71
    v_pk_add_f32 v[64:65], v[64:65], v[68:69]
    v_pk_add_f32 v[66:67], v[66:67], v[70:71]
    ds_write2_b32 v7, v64, v65 offset0:0 offset1:36
    ds_write2_b32 v7, v66, v67 offset0:72 offset1:108
    s_waitcnt lgkmcnt(0)
    s_barrier
    s_add_u32 s5, s28, 3
    s_min_u32 s5, s5, 64
    s_cmp_ge_u32 s46, s5
    s_cbranch_scc1 .kvd_44
    s_mov_b32 s62, 0
.kv_43:
    buffer_load_dword v18, v13, s[8:11], 0 offen sc1
    s_add_u32 s62, s62, 1
    s_cmp_gt_u32 s62, 0x100000
    s_cbranch_scc1 .mg_end_1
    s_waitcnt vmcnt(0)
    v_min_u32_dpp v18, v18, v18 quad_perm:[1,0,3,2] row_mask:0xf bank_mask:0xf
    s_nop 1
    v_min_u32_dpp v18, v18, v18 quad_perm:[2,3,0,1] row_mask:0xf bank_mask:0xf
    s_nop 1
    v_min_u32_dpp v18, v18, v18 row_half_mirror row_mask:0xf bank_mask:0xf
    s_nop 0
    v_readfirstlane_b32 s46, v18
.kvd_44:
    v_mov_b32 v64, 0
    v_mov_b32 v65, 0
    v_mov_b32 v66, 0
    v_mov_b32 v67, 0
    v_mov_b32 v68, 0
    v_mov_b32 v69, 0
    v_mov_b32 v70, 0
    v_mov_b32 v71, 0
    s_mov_b32 s4, s30
    s_mov_b32 s30, s31
    s_mov_b32 s31, s32
    s_mov_b32 s32, s33
    s_mov_b32 s33, s4
    s_add_u32 s28, s28, 1
    s_mov_b32 s62, 0
    s_mov_b32 s4, s34
    s_mov_b32 s34, s35
    s_mov_b32 s35, s36
    s_mov_b32 s36, s37
    s_mov_b32 s37, s4
    s_add_u32 s41, s41, 0x20000
    s_branch .step_39
.fin_40:
    s_barrier
    s_endpgm
.p2align 6
.gm_22:
    s_waitcnt vmcnt(3)
    v_max_u32 v18, v25, v27
    v_cmp_eq_u32 vcc, -1, v18
    s_cbranch_vccnz .nk_45
.ok_46:
    v_smfmac_f32_16x16x64_bf16 v[40:43], v[24:27], a[0:7], v2
    v_smfmac_f32_16x16x64_bf16 v[44:47], v[24:27], a[32:39], v2
    s_waitcnt vmcnt(2)
    v_max_u32 v18, v29, v31
    v_cmp_eq_u32 vcc, -1, v18
    v_smfmac_f32_16x16x64_bf16 v[48:51], v[24:27], a[64:71], v2
    v_smfmac_f32_16x16x64_bf16 v[52:55], v[24:27], a[96:103], v2
    s_cbranch_vccnz .nk_47
.ok_48:
    v_smfmac_f32_16x16x64_bf16 v[40:43], v[28:31], a[8:15], v2
    v_smfmac_f32_16x16x64_bf16 v[44:47], v[28:31], a[40:47], v2
    s_waitcnt vmcnt(1)
    v_max_u32 v18, v33, v35
    v_cmp_eq_u32 vcc, -1, v18
    v_smfmac_f32_16x16x64_bf16 v[48:51], v[28:31], a[72:79], v2
    v_smfmac_f32_16x16x64_bf16 v[52:55], v[28:31], a[104:111], v2
    s_cbranch_vccnz .nk_49
.ok_50:
    v_smfmac_f32_16x16x64_bf16 v[40:43], v[32:35], a[16:23], v2
    v_smfmac_f32_16x16x64_bf16 v[44:47], v[32:35], a[48:55], v2
    s_waitcnt vmcnt(0)
    v_max_u32 v18, v37, v39
    v_cmp_eq_u32 vcc, -1, v18
    v_smfmac_f32_16x16x64_bf16 v[48:51], v[32:35], a[80:87], v2
    v_smfmac_f32_16x16x64_bf16 v[52:55], v[32:35], a[112:119], v2
    s_cbranch_vccnz .nk_51
.ok_52:
    v_smfmac_f32_16x16x64_bf16 v[40:43], v[36:39], a[24:31], v2
    v_smfmac_f32_16x16x64_bf16 v[44:47], v[36:39], a[56:63], v2
    v_smfmac_f32_16x16x64_bf16 v[48:51], v[36:39], a[88:95], v2
    v_smfmac_f32_16x16x64_bf16 v[52:55], v[36:39], a[120:127], v2
    s_setpc_b64 s[98:99]
.nk_45:
    buffer_load_dwordx4 v[24:27], v3, s[8:11], s30 offen offset:0 sc1
    s_add_u32 s62, s62, 1
    s_cmp_gt_u32 s62, 0x100000
    s_cbranch_scc1 .mg_end_1
    s_waitcnt vmcnt(3)
    v_max_u32 v18, v29, v31
    v_cmp_eq_u32 vcc, -1, v18
    s_cbranch_vccnz .nk_53
.ok_54:
    v_smfmac_f32_16x16x64_bf16 v[40:43], v[28:31], a[8:15], v2
    v_smfmac_f32_16x16x64_bf16 v[44:47], v[28:31], a[40:47], v2
    s_waitcnt vmcnt(2)
    v_max_u32 v18, v33, v35
    v_cmp_eq_u32 vcc, -1, v18
    v_smfmac_f32_16x16x64_bf16 v[48:51], v[28:31], a[72:79], v2
    v_smfmac_f32_16x16x64_bf16 v[52:55], v[28:31], a[104:111], v2
    s_cbranch_vccnz .nk_55
.ok_56:
    v_smfmac_f32_16x16x64_bf16 v[40:43], v[32:35], a[16:23], v2
    v_smfmac_f32_16x16x64_bf16 v[44:47], v[32:35], a[48:55], v2
    s_waitcnt vmcnt(1)
    v_max_u32 v18, v37, v39
    v_cmp_eq_u32 vcc, -1, v18
    v_smfmac_f32_16x16x64_bf16 v[48:51], v[32:35], a[80:87], v2
    v_smfmac_f32_16x16x64_bf16 v[52:55], v[32:35], a[112:119], v2
    s_cbranch_vccnz .nk_57
.ok_58:
    v_smfmac_f32_16x16x64_bf16 v[40:43], v[36:39], a[24:31], v2
    v_smfmac_f32_16x16x64_bf16 v[44:47], v[36:39], a[56:63], v2
    s_waitcnt vmcnt(0)
    v_max_u32 v18, v25, v27
    v_cmp_eq_u32 vcc, -1, v18
    v_smfmac_f32_16x16x64_bf16 v[48:51], v[36:39], a[88:95], v2
    v_smfmac_f32_16x16x64_bf16 v[52:55], v[36:39], a[120:127], v2
    s_cbranch_vccnz .nk_59
.ok_60:
    v_smfmac_f32_16x16x64_bf16 v[40:43], v[24:27], a[0:7], v2
    v_smfmac_f32_16x16x64_bf16 v[44:47], v[24:27], a[32:39], v2
    v_smfmac_f32_16x16x64_bf16 v[48:51], v[24:27], a[64:71], v2
    v_smfmac_f32_16x16x64_bf16 v[52:55], v[24:27], a[96:103], v2
    s_setpc_b64 s[98:99]
.nk_47:
    buffer_load_dwordx4 v[28:31], v3, s[8:11], s30 offen offset:1024 sc1
    s_add_u32 s62, s62, 1
    s_cmp_gt_u32 s62, 0x100000
    s_cbranch_scc1 .mg_end_1
    s_waitcnt vmcnt(2)
    v_max_u32 v18, v33, v35
    v_cmp_eq_u32 vcc, -1, v18
    s_cbranch_vccnz .nk_61
.ok_62:
    v_smfmac_f32_16x16x64_bf16 v[40:43], v[32:35], a[16:23], v2
    v_smfmac_f32_16x16x64_bf16 v[44:47], v[32:35], a[48:55], v2
    s_waitcnt vmcnt(1)
    v_max_u32 v18, v37, v39
    v_cmp_eq_u32 vcc, -1, v18
    v_smfmac_f32_16x16x64_bf16 v[48:51], v[32:35], a[80:87], v2
    v_smfmac_f32_16x16x64_bf16 v[52:55], v[32:35], a[112:119], v2
    s_cbranch_vccnz .nk_63
.ok_64:
    v_smfmac_f32_16x16x64_bf16 v[40:43], v[36:39], a[24:31], v2
    v_smfmac_f32_16x16x64_bf16 v[44:47], v[36:39], a[56:63], v2
    s_waitcnt vmcnt(0)
    v_max_u32 v18, v29, v31
    v_cmp_eq_u32 vcc, -1, v18
    v_smfmac_f32_16x16x64_bf16 v[48:51], v[36:39], a[88:95], v2
    v_smfmac_f32_16x16x64_bf16 v[52:55], v[36:39], a[120:127], v2
    s_cbranch_vccnz .nk_65
.ok_66:
    v_smfmac_f32_16x16x64_bf16 v[40:43], v[28:31], a[8:15], v2
    v_smfmac_f32_16x16x64_bf16 v[44:47], v[28:31], a[40:47], v2
    v_smfmac_f32_16x16x64_bf16 v[48:51], v[28:31], a[72:79], v2
    v_smfmac_f32_16x16x64_bf16 v[52:55], v[28:31], a[104:111], v2
    s_setpc_b64 s[98:99]
.nk_49:
    buffer_load_dwordx4 v[32:35], v3, s[8:11], s30 offen offset:2048 sc1
    s_add_u32 s62, s62, 1
    s_cmp_gt_u32 s62, 0x100000
    s_cbranch_scc1 .mg_end_1
    s_waitcnt vmcnt(1)
    v_max_u32 v18, v37, v39
    v_cmp_eq_u32 vcc, -1, v18
    s_cbranch_vccnz .nk_67
.ok_68:
    v_smfmac_f32_16x16x64_bf16 v[40:43], v[36:39], a[24:31], v2
    v_smfmac_f32_16x16x64_bf16 v[44:47], v[36:39], a[56:63], v2
    s_waitcnt vmcnt(0)
    v_max_u32 v18, v33, v35
    v_cmp_eq_u32 vcc, -1, v18
    v_smfmac_f32_16x16x64_bf16 v[48:51], v[36:39], a[88:95], v2
    v_smfmac_f32_16x16x64_bf16 v[52:55], v[36:39], a[120:127], v2
    s_cbranch_vccnz .nk_69
.ok_70:
    v_smfmac_f32_16x16x64_bf16 v[40:43], v[32:35], a[16:23], v2
    v_smfmac_f32_16x16x64_bf16 v[44:47], v[32:35], a[48:55], v2
    v_smfmac_f32_16x16x64_bf16 v[48:51], v[32:35], a[80:87], v2
    v_smfmac_f32_16x16x64_bf16 v[52:55], v[32:35], a[112:119], v2
    s_setpc_b64 s[98:99]
.nk_51:
    buffer_load_dwordx4 v[36:39], v3, s[8:11], s30 offen offset:3072 sc1
    s_add_u32 s62, s62, 1
    s_cmp_gt_u32 s62, 0x100000
    s_cbranch_scc1 .mg_end_1
    s_waitcnt vmcnt(0)
    v_max_u32 v18, v37, v39
    v_cmp_eq_u32 vcc, -1, v18
    s_cbranch_vccnz .nk_51
    s_branch .ok_52
.nk_53:
    buffer_load_dwordx4 v[28:31], v3, s[8:11], s30 offen offset:1024 sc1
    s_add_u32 s62, s62, 1
    s_cmp_gt_u32 s62, 0x100000
    s_cbranch_scc1 .mg_end_1
    s_waitcnt vmcnt(3)
    v_max_u32 v18, v33, v35
    v_cmp_eq_u32 vcc, -1, v18
    s_cbranch_vccnz .nk_71
.ok_72:
    v_smfmac_f32_16x16x64_bf16 v[40:43], v[32:35], a[16:23], v2
    v_smfmac_f32_16x16x64_bf16 v[44:47], v[32:35], a[48:55], v2
    s_waitcnt vmcnt(2)
    v_max_u32 v18, v37, v39
    v_cmp_eq_u32 vcc, -1, v18
    v_smfmac_f32_16x16x64_bf16 v[48:51], v[32:35], a[80:87], v2
    v_smfmac_f32_16x16x64_bf16 v[52:55], v[32:35], a[112:119], v2
    s_cbranch_vccnz .nk_73
.ok_74:
    v_smfmac_f32_16x16x64_bf16 v[40:43], v[36:39], a[24:31], v2
    v_smfmac_f32_16x16x64_bf16 v[44:47], v[36:39], a[56:63], v2
    s_waitcnt vmcnt(1)
    v_max_u32 v18, v25, v27
    v_cmp_eq_u32 vcc, -1, v18
    v_smfmac_f32_16x16x64_bf16 v[48:51], v[36:39], a[88:95], v2
    v_smfmac_f32_16x16x64_bf16 v[52:55], v[36:39], a[120:127], v2
    s_cbranch_vccnz .nk_75
.ok_76:
    v_smfmac_f32_16x16x64_bf16 v[40:43], v[24:27], a[0:7], v2
    v_smfmac_f32_16x16x64_bf16 v[44:47], v[24:27], a[32:39], v2
    s_waitcnt vmcnt(0)
    v_max_u32 v18, v29, v31
    v_cmp_eq_u32 vcc, -1, v18
    v_smfmac_f32_16x16x64_bf16 v[48:51], v[24:27], a[64:71], v2
    v_smfmac_f32_16x16x64_bf16 v[52:55], v[24:27], a[96:103], v2
    s_cbranch_vccnz .nk_65
    s_branch .ok_66
.nk_55:
    buffer_load_dwordx4 v[32:35], v3, s[8:11], s30 offen offset:2048 sc1
    s_add_u32 s62, s62, 1
    s_cmp_gt_u32 s62, 0x100000
    s_cbranch_scc1 .mg_end_1
    s_waitcnt vmcnt(2)
    v_max_u32 v18, v37, v39
    v_cmp_eq_u32 vcc, -1, v18
    s_cbranch_vccnz .nk_77
.ok_78:
    v_smfmac_f32_16x16x64_bf16 v[40:43], v[36:39], a[24:31], v2
    v_smfmac_f32_16x16x64_bf16 v[44:47], v[36:39], a[56:63], v2
    s_waitcnt vmcnt(1)
    v_max_u32 v18, v25, v27
    v_cmp_eq_u32 vcc, -1, v18
    v_smfmac_f32_16x16x64_bf16 v[48:51], v[36:39], a[88:95], v2
    v_smfmac_f32_16x16x64_bf16 v[52:55], v[36:39], a[120:127], v2
    s_cbranch_vccnz .nk_79
.ok_80:
    v_smfmac_f32_16x16x64_bf16 v[40:43], v[24:27], a[0:7], v2
    v_smfmac_f32_16x16x64_bf16 v[44:47], v[24:27], a[32:39], v2
    s_waitcnt vmcnt(0)
    v_max_u32 v18, v33, v35
    v_cmp_eq_u32 vcc, -1, v18
    v_smfmac_f32_16x16x64_bf16 v[48:51], v[24:27], a[64:71], v2
    v_smfmac_f32_16x16x64_bf16 v[52:55], v[24:27], a[96:103], v2
    s_cbranch_vccnz .nk_69
    s_branch .ok_70
.nk_57:
    buffer_load_dwordx4 v[36:39], v3, s[8:11], s30 offen offset:3072 sc1
    s_add_u32 s62, s62, 1
    s_cmp_gt_u32 s62, 0x100000
    s_cbranch_scc1 .mg_end_1
    s_waitcnt vmcnt(1)
    v_max_u32 v18, v25, v27
    v_cmp_eq_u32 vcc, -1, v18
    s_cbranch_vccnz .nk_81
.ok_82:
    v_smfmac_f32_16x16x64_bf16 v[40:43], v[24:27], a[0:7], v2
    v_smfmac_f32_16x16x64_bf16 v[44:47], v[24:27], a[32:39], v2
    s_waitcnt vmcnt(0)
    v_max_u32 v18, v37, v39
    v_cmp_eq_u32 vcc, -1, v18
    v_smfmac_f32_16x16x64_bf16 v[48:51], v[24:27], a[64:71], v2
    v_smfmac_f32_16x16x64_bf16 v[52:55], v[24:27], a[96:103], v2
    s_cbranch_vccnz .nk_51
    s_branch .ok_52
.nk_59:
    buffer_load_dwordx4 v[24:27], v3, s[8:11], s30 offen offset:0 sc1
    s_add_u32 s62, s62, 1
    s_cmp_gt_u32 s62, 0x100000
    s_cbranch_scc1 .mg_end_1
    s_waitcnt vmcnt(0)
    v_max_u32 v18, v25, v27
    v_cmp_eq_u32 vcc, -1, v18
    s_cbranch_vccnz .nk_59
    s_branch .ok_60
.nk_61:
    buffer_load_dwordx4 v[32:35], v3, s[8:11], s30 offen offset:2048 sc1
    s_add_u32 s62, s62, 1
    s_cmp_gt_u32 s62, 0x100000
    s_cbranch_scc1 .mg_end_1
    s_waitcnt vmcnt(2)
    v_max_u32 v18, v37, v39
    v_cmp_eq_u32 vcc, -1, v18
    s_cbranch_vccnz .nk_83
.ok_84:
    v_smfmac_f32_16x16x64_bf16 v[40:43], v[36:39], a[24:31], v2
    v_smfmac_f32_16x16x64_bf16 v[44:47], v[36:39], a[56:63], v2
    s_waitcnt vmcnt(1)
    v_max_u32 v18, v29, v31
    v_cmp_eq_u32 vcc, -1, v18
    v_smfmac_f32_16x16x64_bf16 v[48:51], v[36:39], a[88:95], v2
    v_smfmac_f32_16x16x64_bf16 v[52:55], v[36:39], a[120:127], v2
    s_cbranch_vccnz .nk_85
.ok_86:
    v_smfmac_f32_16x16x64_bf16 v[40:43], v[28:31], a[8:15], v2
    v_smfmac_f32_16x16x64_bf16 v[44:47], v[28:31], a[40:47], v2
    s_waitcnt vmcnt(0)
    v_max_u32 v18, v33, v35
    v_cmp_eq_u32 vcc, -1, v18
    v_smfmac_f32_16x16x64_bf16 v[48:51], v[28:31], a[72:79], v2
    v_smfmac_f32_16x16x64_bf16 v[52:55], v[28:31], a[104:111], v2
    s_cbranch_vccnz .nk_69
    s_branch .ok_70
.nk_63:
    buffer_load_dwordx4 v[36:39], v3, s[8:11], s30 offen offset:3072 sc1
    s_add_u32 s62, s62, 1
    s_cmp_gt_u32 s62, 0x100000
    s_cbranch_scc1 .mg_end_1
    s_waitcnt vmcnt(1)
    v_max_u32 v18, v29, v31
    v_cmp_eq_u32 vcc, -1, v18
    s_cbranch_vccnz .nk_87
.ok_88:
    v_smfmac_f32_16x16x64_bf16 v[40:43], v[28:31], a[8:15], v2
    v_smfmac_f32_16x16x64_bf16 v[44:47], v[28:31], a[40:47], v2
    s_waitcnt vmcnt(0)
    v_max_u32 v18, v37, v39
    v_cmp_eq_u32 vcc, -1, v18
    v_smfmac_f32_16x16x64_bf16 v[48:51], v[28:31], a[72:79], v2
    v_smfmac_f32_16x16x64_bf16 v[52:55], v[28:31], a[104:111], v2
    s_cbranch_vccnz .nk_51
    s_branch .ok_52
.nk_65:
    buffer_load_dwordx4 v[28:31], v3, s[8:11], s30 offen offset:1024 sc1
    s_add_u32 s62, s62, 1
    s_cmp_gt_u32 s62, 0x100000
    s_cbranch_scc1 .mg_end_1
    s_waitcnt vmcnt(0)
    v_max_u32 v18, v29, v31
    v_cmp_eq_u32 vcc, -1, v18
    s_cbranch_vccnz .nk_65
    s_branch .ok_66
.nk_67:
    buffer_load_dwordx4 v[36:39], v3, s[8:11], s30 offen offset:3072 sc1
    s_add_u32 s62, s62, 1
    s_cmp_gt_u32 s62, 0x100000
    s_cbranch_scc1 .mg_end_1
    s_waitcnt vmcnt(1)
    v_max_u32 v18, v33, v35
    v_cmp_eq_u32 vcc, -1, v18
    s_cbranch_vccnz .nk_49
    s_branch .ok_50
.nk_69:
    buffer_load_dwordx4 v[32:35], v3, s[8:11], s30 offen offset:2048 sc1
    s_add_u32 s62, s62, 1
    s_cmp_gt_u32 s62, 0x100000
    s_cbranch_scc1 .mg_end_1
    s_waitcnt vmcnt(0)
    v_max_u32 v18, v33, v35
    v_cmp_eq_u32 vcc, -1, v18
    s_cbranch_vccnz .nk_69
    s_branch .ok_70
.nk_71:
    buffer_load_dwordx4 v[32:35], v3, s[8:11], s30 offen offset:2048 sc1
    s_add_u32 s62, s62, 1
    s_cmp_gt_u32 s62, 0x100000
    s_cbranch_scc1 .mg_end_1
    s_waitcnt vmcnt(3)
    v_max_u32 v18, v37, v39
    v_cmp_eq_u32 vcc, -1, v18
    s_cbranch_vccnz .nk_89
.ok_90:
    v_smfmac_f32_16x16x64_bf16 v[40:43], v[36:39], a[24:31], v2
    v_smfmac_f32_16x16x64_bf16 v[44:47], v[36:39], a[56:63], v2
    s_waitcnt vmcnt(2)
    v_max_u32 v18, v25, v27
    v_cmp_eq_u32 vcc, -1, v18
    v_smfmac_f32_16x16x64_bf16 v[48:51], v[36:39], a[88:95], v2
    v_smfmac_f32_16x16x64_bf16 v[52:55], v[36:39], a[120:127], v2
    s_cbranch_vccnz .nk_91
.ok_92:
    v_smfmac_f32_16x16x64_bf16 v[40:43], v[24:27], a[0:7], v2
    v_smfmac_f32_16x16x64_bf16 v[44:47], v[24:27], a[32:39], v2
    s_waitcnt vmcnt(1)
    v_max_u32 v18, v29, v31
    v_cmp_eq_u32 vcc, -1, v18
    v_smfmac_f32_16x16x64_bf16 v[48:51], v[24:27], a[64:71], v2
    v_smfmac_f32_16x16x64_bf16 v[52:55], v[24:27], a[96:103], v2
    s_cbranch_vccnz .nk_85
    s_branch .ok_86
.nk_73:
    buffer_load_dwordx4 v[36:39], v3, s[8:11], s30 offen offset:3072 sc1
    s_add_u32 s62, s62, 1
    s_cmp_gt_u32 s62, 0x100000
    s_cbranch_scc1 .mg_end_1
    s_waitcnt vmcnt(2)
    v_max_u32 v18, v25, v27
    v_cmp_eq_u32 vcc, -1, v18
    s_cbranch_vccnz .nk_93
.ok_94:
    v_smfmac_f32_16x16x64_bf16 v[40:43], v[24:27], a[0:7], v2
    v_smfmac_f32_16x16x64_bf16 v[44:47], v[24:27], a[32:39], v2
    s_waitcnt vmcnt(1)
    v_max_u32 v18, v29, v31
    v_cmp_eq_u32 vcc, -1, v18
    v_smfmac_f32_16x16x64_bf16 v[48:51], v[24:27], a[64:71], v2
    v_smfmac_f32_16x16x64_bf16 v[52:55], v[24:27], a[96:103], v2
    s_cbranch_vccnz .nk_87
    s_branch .ok_88
.nk_75:
    buffer_load_dwordx4 v[24:27], v3, s[8:11], s30 offen offset:0 sc1
    s_add_u32 s62, s62, 1
    s_cmp_gt_u32 s62, 0x100000
    s_cbranch_scc1 .mg_end_1
    s_waitcnt vmcnt(1)
    v_max_u32 v18, v29, v31
    v_cmp_eq_u32 vcc, -1, v18
    s_cbranch_vccnz .nk_95
.ok_96:
    v_smfmac_f32_16x16x64_bf16 v[40:43], v[28:31], a[8:15], v2
    v_smfmac_f32_16x16x64_bf16 v[44:47], v[28:31], a[40:47], v2
    s_waitcnt vmcnt(0)
    v_max_u32 v18, v25, v27
    v_cmp_eq_u32 vcc, -1, v18
    v_smfmac_f32_16x16x64_bf16 v[48:51], v[28:31], a[72:79], v2
    v_smfmac_f32_16x16x64_bf16 v[52:55], v[28:31], a[104:111], v2
    s_cbranch_vccnz .nk_59
    s_branch .ok_60
.nk_77:
    buffer_load_dwordx4 v[36:39], v3, s[8:11], s30 offen offset:3072 sc1
    s_add_u32 s62, s62, 1
    s_cmp_gt_u32 s62, 0x100000
    s_cbranch_scc1 .mg_end_1
    s_waitcnt vmcnt(2)
    v_max_u32 v18, v25, v27
    v_cmp_eq_u32 vcc, -1, v18
    s_cbranch_vccnz .nk_97
.ok_98:
    v_smfmac_f32_16x16x64_bf16 v[40:43], v[24:27], a[0:7], v2
    v_smfmac_f32_16x16x64_bf16 v[44:47], v[24:27], a[32:39], v2
    s_waitcnt vmcnt(1)
    v_max_u32 v18, v33, v35
    v_cmp_eq_u32 vcc, -1, v18
    v_smfmac_f32_16x16x64_bf16 v[48:51], v[24:27], a[64:71], v2
    v_smfmac_f32_16x16x64_bf16 v[52:55], v[24:27], a[96:103], v2
    s_cbranch_vccnz .nk_49
    s_branch .ok_50
.nk_79:
    buffer_load_dwordx4 v[24:27], v3, s[8:11], s30 offen offset:0 sc1
    s_add_u32 s62, s62, 1
    s_cmp_gt_u32 s62, 0x100000
    s_cbranch_scc1 .mg_end_1
    s_waitcnt vmcnt(1)
    v_max_u32 v18, v33, v35
    v_cmp_eq_u32 vcc, -1, v18
    s_cbranch_vccnz .nk_99
.ok_100:
    v_smfmac_f32_16x16x64_bf16 v[40:43], v[32:35], a[16:23], v2
    v_smfmac_f32_16x16x64_bf16 v[44:47], v[32:35], a[48:55], v2
    s_waitcnt vmcnt(0)
    v_max_u32 v18, v25, v27
    v_cmp_eq_u32 vcc, -1, v18
    v_smfmac_f32_16x16x64_bf16 v[48:51], v[32:35], a[80:87], v2
    v_smfmac_f32_16x16x64_bf16 v[52:55], v[32:35], a[112:119], v2
    s_cbranch_vccnz .nk_59
    s_branch .ok_60
.nk_81:
    buffer_load_dwordx4 v[24:27], v3, s[8:11], s30 offen offset:0 sc1
    s_add_u32 s62, s62, 1
    s_cmp_gt_u32 s62, 0x100000
    s_cbranch_scc1 .mg_end_1
    s_waitcnt vmcnt(1)
    v_max_u32 v18, v37, v39
    v_cmp_eq_u32 vcc, -1, v18
    s_cbranch_vccnz .nk_57
    s_branch .ok_58
.nk_83:
    buffer_load_dwordx4 v[36:39], v3, s[8:11], s30 offen offset:3072 sc1
    s_add_u32 s62, s62, 1
    s_cmp_gt_u32 s62, 0x100000
    s_cbranch_scc1 .mg_end_1
    s_waitcnt vmcnt(2)
    v_max_u32 v18, v29, v31
    v_cmp_eq_u32 vcc, -1, v18
    s_cbranch_vccnz .nk_47
    s_branch .ok_48
.nk_85:
    buffer_load_dwordx4 v[28:31], v3, s[8:11], s30 offen offset:1024 sc1
    s_add_u32 s62, s62, 1
    s_cmp_gt_u32 s62, 0x100000
    s_cbranch_scc1 .mg_end_1
    s_waitcnt vmcnt(1)
    v_max_u32 v18, v33, v35
    v_cmp_eq_u32 vcc, -1, v18
    s_cbranch_vccnz .nk_101
.ok_102:
    v_smfmac_f32_16x16x64_bf16 v[40:43], v[32:35], a[16:23], v2
    v_smfmac_f32_16x16x64_bf16 v[44:47], v[32:35], a[48:55], v2
    s_waitcnt vmcnt(0)
    v_max_u32 v18, v29, v31
    v_cmp_eq_u32 vcc, -1, v18
    v_smfmac_f32_16x16x64_bf16 v[48:51], v[32:35], a[80:87], v2
    v_smfmac_f32_16x16x64_bf16 v[52:55], v[32:35], a[112:119], v2
    s_cbranch_vccnz .nk_65
    s_branch .ok_66
.nk_87:
    buffer_load_dwordx4 v[28:31], v3, s[8:11], s30 offen offset:1024 sc1
    s_add_u32 s62, s62, 1
    s_cmp_gt_u32 s62, 0x100000
    s_cbranch_scc1 .mg_end_1
    s_waitcnt vmcnt(1)
    v_max_u32 v18, v37, v39
    v_cmp_eq_u32 vcc, -1, v18
    s_cbranch_vccnz .nk_63
    s_branch .ok_64
.nk_89:
    buffer_load_dwordx4 v[36:39], v3, s[8:11], s30 offen offset:3072 sc1
    s_add_u32 s62, s62, 1
    s_cmp_gt_u32 s62, 0x100000
    s_cbranch_scc1 .mg_end_1
    s_waitcnt vmcnt(3)
    v_max_u32 v18, v25, v27
    v_cmp_eq_u32 vcc, -1, v18
    s_cbranch_vccnz .nk_45
    s_branch .ok_46
.nk_91:
    buffer_load_dwordx4 v[24:27], v3, s[8:11], s30 offen offset:0 sc1
    s_add_u32 s62, s62, 1
    s_cmp_gt_u32 s62, 0x100000
    s_cbranch_scc1 .mg_end_1
    s_waitcnt vmcnt(2)
    v_max_u32 v18, v29, v31
    v_cmp_eq_u32 vcc, -1, v18
    s_cbranch_vccnz .nk_103
.ok_104:
    v_smfmac_f32_16x16x64_bf16 v[40:43], v[28:31], a[8:15], v2
    v_smfmac_f32_16x16x64_bf16 v[44:47], v[28:31], a[40:47], v2
    s_waitcnt vmcnt(1)
    v_max_u32 v18, v33, v35
    v_cmp_eq_u32 vcc, -1, v18
    v_smfmac_f32_16x16x64_bf16 v[48:51], v[28:31], a[72:79], v2
    v_smfmac_f32_16x16x64_bf16 v[52:55], v[28:31], a[104:111], v2
    s_cbranch_vccnz .nk_99
    s_branch .ok_100
.nk_93:
    buffer_load_dwordx4 v[24:27], v3, s[8:11], s30 offen offset:0 sc1
    s_add_u32 s62, s62, 1
    s_cmp_gt_u32 s62, 0x100000
    s_cbranch_scc1 .mg_end_1
    s_waitcnt vmcnt(2)
    v_max_u32 v18, v29, v31
    v_cmp_eq_u32 vcc, -1, v18
    s_cbranch_vccnz .nk_105
.ok_106:
    v_smfmac_f32_16x16x64_bf16 v[40:43], v[28:31], a[8:15], v2
    v_smfmac_f32_16x16x64_bf16 v[44:47], v[28:31], a[40:47], v2
    s_waitcnt vmcnt(1)
    v_max_u32 v18, v37, v39
    v_cmp_eq_u32 vcc, -1, v18
    v_smfmac_f32_16x16x64_bf16 v[48:51], v[28:31], a[72:79], v2
    v_smfmac_f32_16x16x64_bf16 v[52:55], v[28:31], a[104:111], v2
    s_cbranch_vccnz .nk_57
    s_branch .ok_58
.nk_95:
    buffer_load_dwordx4 v[28:31], v3, s[8:11], s30 offen offset:1024 sc1
    s_add_u32 s62, s62, 1
    s_cmp_gt_u32 s62, 0x100000
    s_cbranch_scc1 .mg_end_1
    s_waitcnt vmcnt(1)
    v_max_u32 v18, v25, v27
    v_cmp_eq_u32 vcc, -1, v18
    s_cbranch_vccnz .nk_75
    s_branch .ok_76
.nk_97:
    buffer_load_dwordx4 v[24:27], v3, s[8:11], s30 offen offset:0 sc1
    s_add_u32 s62, s62, 1
    s_cmp_gt_u32 s62, 0x100000
    s_cbranch_scc1 .mg_end_1
    s_waitcnt vmcnt(2)
    v_max_u32 v18, v33, v35
    v_cmp_eq_u32 vcc, -1, v18
    s_cbranch_vccnz .nk_55
    s_branch .ok_56
.nk_99:
    buffer_load_dwordx4 v[32:35], v3, s[8:11], s30 offen offset:2048 sc1
    s_add_u32 s62, s62, 1
    s_cmp_gt_u32 s62, 0x100000
    s_cbranch_scc1 .mg_end_1
    s_waitcnt vmcnt(1)
    v_max_u32 v18, v25, v27
    v_cmp_eq_u32 vcc, -1, v18
    s_cbranch_vccnz .nk_79
    s_branch .ok_80
.nk_101:
    buffer_load_dwordx4 v[32:35], v3, s[8:11], s30 offen offset:2048 sc1
    s_add_u32 s62, s62, 1
    s_cmp_gt_u32 s62, 0x100000
    s_cbranch_scc1 .mg_end_1
    s_waitcnt vmcnt(1)
    v_max_u32 v18, v29, v31
    v_cmp_eq_u32 vcc, -1, v18
    s_cbranch_vccnz .nk_85
    s_branch .ok_86
.nk_103:
    buffer_load_dwordx4 v[28:31], v3, s[8:11], s30 offen offset:1024 sc1
    s_add_u32 s62, s62, 1
    s_cmp_gt_u32 s62, 0x100000
    s_cbranch_scc1 .mg_end_1
    s_waitcnt vmcnt(2)
    v_max_u32 v18, v33, v35
    v_cmp_eq_u32 vcc, -1, v18
    s_cbranch_vccnz .nk_107
.ok_108:
    v_smfmac_f32_16x16x64_bf16 v[40:43], v[32:35], a[16:23], v2
    v_smfmac_f32_16x16x64_bf16 v[44:47], v[32:35], a[48:55], v2
    s_waitcnt vmcnt(1)
    v_max_u32 v18, v25, v27
    v_cmp_eq_u32 vcc, -1, v18
    v_smfmac_f32_16x16x64_bf16 v[48:51], v[32:35], a[80:87], v2
    v_smfmac_f32_16x16x64_bf16 v[52:55], v[32:35], a[112:119], v2
    s_cbranch_vccnz .nk_75
    s_branch .ok_76
.nk_105:
    buffer_load_dwordx4 v[28:31], v3, s[8:11], s30 offen offset:1024 sc1
    s_add_u32 s62, s62, 1
    s_cmp_gt_u32 s62, 0x100000
    s_cbranch_scc1 .mg_end_1
    s_waitcnt vmcnt(2)
    v_max_u32 v18, v37, v39
    v_cmp_eq_u32 vcc, -1, v18
    s_cbranch_vccnz .nk_73
    s_branch .ok_74
.nk_107:
    buffer_load_dwordx4 v[32:35], v3, s[8:11], s30 offen offset:2048 sc1
    s_add_u32 s62, s62, 1
    s_cmp_gt_u32 s62, 0x100000
    s_cbranch_scc1 .mg_end_1
    s_waitcnt vmcnt(2)
    v_max_u32 v18, v25, v27
    v_cmp_eq_u32 vcc, -1, v18
    s_cbranch_vccnz .nk_91
    s_branch .ok_92
.p2align 6
.gm_23:
    s_waitcnt vmcnt(3)
    v_cmp_eq_u32 vcc, -1, v27
    s_cbranch_vccnz .nk_109
.ok_110:
    v_smfmac_f32_16x16x64_bf16 v[64:67], v[24:27], a[192:199], v2
    s_waitcnt vmcnt(2)
    v_cmp_eq_u32 vcc, -1, v31
    v_smfmac_f32_16x16x64_bf16 v[68:71], v[24:27], a[224:231], v2
    s_cbranch_vccnz .nk_111
.ok_112:
    v_smfmac_f32_16x16x64_bf16 v[64:67], v[28:31], a[200:207], v2
    s_waitcnt vmcnt(1)
    v_cmp_eq_u32 vcc, -1, v35
    v_smfmac_f32_16x16x64_bf16 v[68:71], v[28:31], a[232:239], v2
    s_cbranch_vccnz .nk_113
.ok_114:
    v_smfmac_f32_16x16x64_bf16 v[64:67], v[32:35], a[208:215], v2
    s_waitcnt vmcnt(0)
    v_cmp_eq_u32 vcc, -1, v39
    v_smfmac_f32_16x16x64_bf16 v[68:71], v[32:35], a[240:247], v2
    s_cbranch_vccnz .nk_115
.ok_116:
    v_smfmac_f32_16x16x64_bf16 v[64:67], v[36:39], a[216:223], v2
    v_smfmac_f32_16x16x64_bf16 v[68:71], v[36:39], a[248:255], v2
    s_setpc_b64 s[98:99]
.nk_109:
    buffer_load_dwordx4 v[24:27], v4, s[8:11], s30 offen offset:0 sc1
    s_add_u32 s62, s62, 1
    s_cmp_gt_u32 s62, 0x100000
    s_cbranch_scc1 .mg_end_1
    s_waitcnt vmcnt(3)
    v_cmp_eq_u32 vcc, -1, v31
    s_cbranch_vccnz .nk_117
.ok_118:
    v_smfmac_f32_16x16x64_bf16 v[64:67], v[28:31], a[200:207], v2
    s_waitcnt vmcnt(2)
    v_cmp_eq_u32 vcc, -1, v35
    v_smfmac_f32_16x16x64_bf16 v[68:71], v[28:31], a[232:239], v2
    s_cbranch_vccnz .nk_119
.ok_120:
    v_smfmac_f32_16x16x64_bf16 v[64:67], v[32:35], a[208:215], v2
    s_waitcnt vmcnt(1)
    v_cmp_eq_u32 vcc, -1, v39
    v_smfmac_f32_16x16x64_bf16 v[68:71], v[32:35], a[240:247], v2
    s_cbranch_vccnz .nk_121
.ok_122:
    v_smfmac_f32_16x16x64_bf16 v[64:67], v[36:39], a[216:223], v2
    s_waitcnt vmcnt(0)
    v_cmp_eq_u32 vcc, -1, v27
    v_smfmac_f32_16x16x64_bf16 v[68:71], v[36:39], a[248:255], v2
    s_cbranch_vccnz .nk_123
.ok_124:
    v_smfmac_f32_16x16x64_bf16 v[64:67], v[24:27], a[192:199], v2
    v_smfmac_f32_16x16x64_bf16 v[68:71], v[24:27], a[224:231], v2
    s_setpc_b64 s[98:99]
.nk_111:
    buffer_load_dwordx4 v[28:31], v4, s[8:11], s30 offen offset:1024 sc1
    s_add_u32 s62, s62, 1
    s_cmp_gt_u32 s62, 0x100000
    s_cbranch_scc1 .mg_end_1
    s_waitcnt vmcnt(2)
    v_cmp_eq_u32 vcc, -1, v35
    s_cbranch_vccnz .nk_125
.ok_126:
    v_smfmac_f32_16x16x64_bf16 v[64:67], v[32:35], a[208:215], v2
    s_waitcnt vmcnt(1)
    v_cmp_eq_u32 vcc, -1, v39
    v_smfmac_f32_16x16x64_bf16 v[68:71], v[32:35], a[240:247], v2
    s_cbranch_vccnz .nk_127
.ok_128:
    v_smfmac_f32_16x16x64_bf16 v[64:67], v[36:39], a[216:223], v2
    s_waitcnt vmcnt(0)
    v_cmp_eq_u32 vcc, -1, v31
    v_smfmac_f32_16x16x64_bf16 v[68:71], v[36:39], a[248:255], v2
    s_cbranch_vccnz .nk_129
.ok_130:
    v_smfmac_f32_16x16x64_bf16 v[64:67], v[28:31], a[200:207], v2
    v_smfmac_f32_16x16x64_bf16 v[68:71], v[28:31], a[232:239], v2
    s_setpc_b64 s[98:99]
.nk_113:
    buffer_load_dwordx4 v[32:35], v4, s[8:11], s30 offen offset:2048 sc1
    s_add_u32 s62, s62, 1
    s_cmp_gt_u32 s62, 0x100000
    s_cbranch_scc1 .mg_end_1
    s_waitcnt vmcnt(1)
    v_cmp_eq_u32 vcc, -1, v39
    s_cbranch_vccnz .nk_131
.ok_132:
    v_smfmac_f32_16x16x64_bf16 v[64:67], v[36:39], a[216:223], v2
    s_waitcnt vmcnt(0)
    v_cmp_eq_u32 vcc, -1, v35
    v_smfmac_f32_16x16x64_bf16 v[68:71], v[36:39], a[248:255], v2
    s_cbranch_vccnz .nk_133
.ok_134:
    v_smfmac_f32_16x16x64_bf16 v[64:67], v[32:35], a[208:215], v2
    v_smfmac_f32_16x16x64_bf16 v[68:71], v[32:35], a[240:247], v2
    s_setpc_b64 s[98:99]
.nk_115:
    buffer_load_dwordx4 v[36:39], v4, s[8:11], s30 offen offset:3072 sc1
    s_add_u32 s62, s62, 1
    s_cmp_gt_u32 s62, 0x100000
    s_cbranch_scc1 .mg_end_1
    s_waitcnt vmcnt(0)
    v_cmp_eq_u32 vcc, -1, v39
    s_cbranch_vccnz .nk_115
    s_branch .ok_116
.nk_117:
    buffer_load_dwordx4 v[28:31], v4, s[8:11], s30 offen offset:1024 sc1
    s_add_u32 s62, s62, 1
    s_cmp_gt_u32 s62, 0x100000
    s_cbranch_scc1 .mg_end_1
    s_waitcnt vmcnt(3)
    v_cmp_eq_u32 vcc, -1, v35
    s_cbranch_vccnz .nk_135
.ok_136:
    v_smfmac_f32_16x16x64_bf16 v[64:67], v[32:35], a[208:215], v2
    s_waitcnt vmcnt(2)
    v_cmp_eq_u32 vcc, -1, v39
    v_smfmac_f32_16x16x64_bf16 v[68:71], v[32:35], a[240:247], v2
    s_cbranch_vccnz .nk_137
.ok_138:
    v_smfmac_f32_16x16x64_bf16 v[64:67], v[36:39], a[216:223], v2
    s_waitcnt vmcnt(1)
    v_cmp_eq_u32 vcc, -1, v27
    v_smfmac_f32_16x16x64_bf16 v[68:71], v[36:39], a[248:255], v2
    s_cbranch_vccnz .nk_139
.ok_140:
    v_smfmac_f32_16x16x64_bf16 v[64:67], v[24:27], a[192:199], v2
    s_waitcnt vmcnt(0)
    v_cmp_eq_u32 vcc, -1, v31
    v_smfmac_f32_16x16x64_bf16 v[68:71], v[24:27], a[224:231], v2
    s_cbranch_vccnz .nk_129
    s_branch .ok_130
.nk_119:
    buffer_load_dwordx4 v[32:35], v4, s[8:11], s30 offen offset:2048 sc1
    s_add_u32 s62, s62, 1
    s_cmp_gt_u32 s62, 0x100000
    s_cbranch_scc1 .mg_end_1
    s_waitcnt vmcnt(2)
    v_cmp_eq_u32 vcc, -1, v39
    s_cbranch_vccnz .nk_141
.ok_142:
    v_smfmac_f32_16x16x64_bf16 v[64:67], v[36:39], a[216:223], v2
    s_waitcnt vmcnt(1)
    v_cmp_eq_u32 vcc, -1, v27
    v_smfmac_f32_16x16x64_bf16 v[68:71], v[36:39], a[248:255], v2
    s_cbranch_vccnz .nk_143
.ok_144:
    v_smfmac_f32_16x16x64_bf16 v[64:67], v[24:27], a[192:199], v2
    s_waitcnt vmcnt(0)
    v_cmp_eq_u32 vcc, -1, v35
    v_smfmac_f32_16x16x64_bf16 v[68:71], v[24:27], a[224:231], v2
    s_cbranch_vccnz .nk_133
    s_branch .ok_134
.nk_121:
    buffer_load_dwordx4 v[36:39], v4, s[8:11], s30 offen offset:3072 sc1
    s_add_u32 s62, s62, 1
    s_cmp_gt_u32 s62, 0x100000
    s_cbranch_scc1 .mg_end_1
    s_waitcnt vmcnt(1)
    v_cmp_eq_u32 vcc, -1, v27
    s_cbranch_vccnz .nk_145
.ok_146:
    v_smfmac_f32_16x16x64_bf16 v[64:67], v[24:27], a[192:199], v2
    s_waitcnt vmcnt(0)
    v_cmp_eq_u32 vcc, -1, v39
    v_smfmac_f32_16x16x64_bf16 v[68:71], v[24:27], a[224:231], v2
    s_cbranch_vccnz .nk_115
    s_branch .ok_116
.nk_123:
    buffer_load_dwordx4 v[24:27], v4, s[8:11], s30 offen offset:0 sc1
    s_add_u32 s62, s62, 1
    s_cmp_gt_u32 s62, 0x100000
    s_cbranch_scc1 .mg_end_1
    s_waitcnt vmcnt(0)
    v_cmp_eq_u32 vcc, -1, v27
    s_cbranch_vccnz .nk_123
    s_branch .ok_124
.nk_125:
    buffer_load_dwordx4 v[32:35], v4, s[8:11], s30 offen offset:2048 sc1
    s_add_u32 s62, s62, 1
    s_cmp_gt_u32 s62, 0x100000
    s_cbranch_scc1 .mg_end_1
    s_waitcnt vmcnt(2)
    v_cmp_eq_u32 vcc, -1, v39
    s_cbranch_vccnz .nk_147
.ok_148:
    v_smfmac_f32_16x16x64_bf16 v[64:67], v[36:39], a[216:223], v2
    s_waitcnt vmcnt(1)
    v_cmp_eq_u32 vcc, -1, v31
    v_smfmac_f32_16x16x64_bf16 v[68:71], v[36:39], a[248:255], v2
    s_cbranch_vccnz .nk_149
.ok_150:
    v_smfmac_f32_16x16x64_bf16 v[64:67], v[28:31], a[200:207], v2
    s_waitcnt vmcnt(0)
    v_cmp_eq_u32 vcc, -1, v35
    v_smfmac_f32_16x16x64_bf16 v[68:71], v[28:31], a[232:239], v2
    s_cbranch_vccnz .nk_133
    s_branch .ok_134
.nk_127:
    buffer_load_dwordx4 v[36:39], v4, s[8:11], s30 offen offset:3072 sc1
    s_add_u32 s62, s62, 1
    s_cmp_gt_u32 s62, 0x100000
    s_cbranch_scc1 .mg_end_1
    s_waitcnt vmcnt(1)
    v_cmp_eq_u32 vcc, -1, v31
    s_cbranch_vccnz .nk_151
.ok_152:
    v_smfmac_f32_16x16x64_bf16 v[64:67], v[28:31], a[200:207], v2
    s_waitcnt vmcnt(0)
    v_cmp_eq_u32 vcc, -1, v39
    v_smfmac_f32_16x16x64_bf16 v[68:71], v[28:31], a[232:239], v2
    s_cbranch_vccnz .nk_115
    s_branch .ok_116
.nk_129:
    buffer_load_dwordx4 v[28:31], v4, s[8:11], s30 offen offset:1024 sc1
    s_add_u32 s62, s62, 1
    s_cmp_gt_u32 s62, 0x100000
    s_cbranch_scc1 .mg_end_1
    s_waitcnt vmcnt(0)
    v_cmp_eq_u32 vcc, -1, v31
    s_cbranch_vccnz .nk_129
    s_branch .ok_130
.nk_131:
    buffer_load_dwordx4 v[36:39], v4, s[8:11], s30 offen offset:3072 sc1
    s_add_u32 s62, s62, 1
    s_cmp_gt_u32 s62, 0x100000
    s_cbranch_scc1 .mg_end_1
    s_waitcnt vmcnt(1)
    v_cmp_eq_u32 vcc, -1, v35
    s_cbranch_vccnz .nk_113
    s_branch .ok_114
.nk_133:
    buffer_load_dwordx4 v[32:35], v4, s[8:11], s30 offen offset:2048 sc1
    s_add_u32 s62, s62, 1
    s_cmp_gt_u32 s62, 0x100000
    s_cbranch_scc1 .mg_end_1
    s_waitcnt vmcnt(0)
    v_cmp_eq_u32 vcc, -1, v35
    s_cbranch_vccnz .nk_133
    s_branch .ok_134
.nk_135:
    buffer_load_dwordx4 v[32:35], v4, s[8:11], s30 offen offset:2048 sc1
    s_add_u32 s62, s62, 1
    s_cmp_gt_u32 s62, 0x100000
    s_cbranch_scc1 .mg_end_1
    s_waitcnt vmcnt(3)
    v_cmp_eq_u32 vcc, -1, v39
    s_cbranch_vccnz .nk_153
.ok_154:
    v_smfmac_f32_16x16x64_bf16 v[64:67], v[36:39], a[216:223], v2
    s_waitcnt vmcnt(2)
    v_cmp_eq_u32 vcc, -1, v27
    v_smfmac_f32_16x16x64_bf16 v[68:71], v[36:39], a[248:255], v2
    s_cbranch_vccnz .nk_155
.ok_156:
    v_smfmac_f32_16x16x64_bf16 v[64:67], v[24:27], a[192:199], v2
    s_waitcnt vmcnt(1)
    v_cmp_eq_u32 vcc, -1, v31
    v_smfmac_f32_16x16x64_bf16 v[68:71], v[24:27], a[224:231], v2
    s_cbranch_vccnz .nk_149
    s_branch .ok_150
.nk_137:
    buffer_load_dwordx4 v[36:39], v4, s[8:11], s30 offen offset:3072 sc1
    s_add_u32 s62, s62, 1
    s_cmp_gt_u32 s62, 0x100000
    s_cbranch_scc1 .mg_end_1
    s_waitcnt vmcnt(2)
    v_cmp_eq_u32 vcc, -1, v27
    s_cbranch_vccnz .nk_157
.ok_158:
    v_smfmac_f32_16x16x64_bf16 v[64:67], v[24:27], a[192:199], v2
    s_waitcnt vmcnt(1)
    v_cmp_eq_u32 vcc, -1, v31
    v_smfmac_f32_16x16x64_bf16 v[68:71], v[24:27], a[224:231], v2
    s_cbranch_vccnz .nk_151
    s_branch .ok_152
.nk_139:
    buffer_load_dwordx4 v[24:27], v4, s[8:11], s30 offen offset:0 sc1
    s_add_u32 s62, s62, 1
    s_cmp_gt_u32 s62, 0x100000
    s_cbranch_scc1 .mg_end_1
    s_waitcnt vmcnt(1)
    v_cmp_eq_u32 vcc, -1, v31
    s_cbranch_vccnz .nk_159
.ok_160:
    v_smfmac_f32_16x16x64_bf16 v[64:67], v[28:31], a[200:207], v2
    s_waitcnt vmcnt(0)
    v_cmp_eq_u32 vcc, -1, v27
    v_smfmac_f32_16x16x64_bf16 v[68:71], v[28:31], a[232:239], v2
    s_cbranch_vccnz .nk_123
    s_branch .ok_124
.nk_141:
    buffer_load_dwordx4 v[36:39], v4, s[8:11], s30 offen offset:3072 sc1
    s_add_u32 s62, s62, 1
    s_cmp_gt_u32 s62, 0x100000
    s_cbranch_scc1 .mg_end_1
    s_waitcnt vmcnt(2)
    v_cmp_eq_u32 vcc, -1, v27
    s_cbranch_vccnz .nk_161
.ok_162:
    v_smfmac_f32_16x16x64_bf16 v[64:67], v[24:27], a[192:199], v2
    s_waitcnt vmcnt(1)
    v_cmp_eq_u32 vcc, -1, v35
    v_smfmac_f32_16x16x64_bf16 v[68:71], v[24:27], a[224:231], v2
    s_cbranch_vccnz .nk_113
    s_branch .ok_114
.nk_143:
    buffer_load_dwordx4 v[24:27], v4, s[8:11], s30 offen offset:0 sc1
    s_add_u32 s62, s62, 1
    s_cmp_gt_u32 s62, 0x100000
    s_cbranch_scc1 .mg_end_1
    s_waitcnt vmcnt(1)
    v_cmp_eq_u32 vcc, -1, v35
    s_cbranch_vccnz .nk_163
.ok_164:
    v_smfmac_f32_16x16x64_bf16 v[64:67], v[32:35], a[208:215], v2
    s_waitcnt vmcnt(0)
    v_cmp_eq_u32 vcc, -1, v27
    v_smfmac_f32_16x16x64_bf16 v[68:71], v[32:35], a[240:247], v2
    s_cbranch_vccnz .nk_123
    s_branch .ok_124
.nk_145:
    buffer_load_dwordx4 v[24:27], v4, s[8:11], s30 offen offset:0 sc1
    s_add_u32 s62, s62, 1
    s_cmp_gt_u32 s62, 0x100000
    s_cbranch_scc1 .mg_end_1
    s_waitcnt vmcnt(1)
    v_cmp_eq_u32 vcc, -1, v39
    s_cbranch_vccnz .nk_121
    s_branch .ok_122
.nk_147:
    buffer_load_dwordx4 v[36:39], v4, s[8:11], s30 offen offset:3072 sc1
    s_add_u32 s62, s62, 1
    s_cmp_gt_u32 s62, 0x100000
    s_cbranch_scc1 .mg_end_1
    s_waitcnt vmcnt(2)
    v_cmp_eq_u32 vcc, -1, v31
    s_cbranch_vccnz .nk_111
    s_branch .ok_112
.nk_149:
    buffer_load_dwordx4 v[28:31], v4, s[8:11], s30 offen offset:1024 sc1
    s_add_u32 s62, s62, 1
    s_cmp_gt_u32 s62, 0x100000
    s_cbranch_scc1 .mg_end_1
    s_waitcnt vmcnt(1)
    v_cmp_eq_u32 vcc, -1, v35
    s_cbranch_vccnz .nk_165
.ok_166:
    v_smfmac_f32_16x16x64_bf16 v[64:67], v[32:35], a[208:215], v2
    s_waitcnt vmcnt(0)
    v_cmp_eq_u32 vcc, -1, v31
    v_smfmac_f32_16x16x64_bf16 v[68:71], v[32:35], a[240:247], v2
    s_cbranch_vccnz .nk_129
    s_branch .ok_130
.nk_151:
    buffer_load_dwordx4 v[28:31], v4, s[8:11], s30 offen offset:1024 sc1
    s_add_u32 s62, s62, 1
    s_cmp_gt_u32 s62, 0x100000
    s_cbranch_scc1 .mg_end_1
    s_waitcnt vmcnt(1)
    v_cmp_eq_u32 vcc, -1, v39
    s_cbranch_vccnz .nk_127
    s_branch .ok_128
.nk_153:
    buffer_load_dwordx4 v[36:39], v4, s[8:11], s30 offen offset:3072 sc1
    s_add_u32 s62, s62, 1
    s_cmp_gt_u32 s62, 0x100000
    s_cbranch_scc1 .mg_end_1
    s_waitcnt vmcnt(3)
    v_cmp_eq_u32 vcc, -1, v27
    s_cbranch_vccnz .nk_109
    s_branch .ok_110
.nk_155:
    buffer_load_dwordx4 v[24:27], v4, s[8:11], s30 offen offset:0 sc1
    s_add_u32 s62, s62, 1
    s_cmp_gt_u32 s62, 0x100000
    s_cbranch_scc1 .mg_end_1
    s_waitcnt vmcnt(2)
    v_cmp_eq_u32 vcc, -1, v31
    s_cbranch_vccnz .nk_167
.ok_168:
    v_smfmac_f32_16x16x64_bf16 v[64:67], v[28:31], a[200:207], v2
    s_waitcnt vmcnt(1)
    v_cmp_eq_u32 vcc, -1, v35
    v_smfmac_f32_16x16x64_bf16 v[68:71], v[28:31], a[232:239], v2
    s_cbranch_vccnz .nk_163
    s_branch .ok_164
.nk_157:
    buffer_load_dwordx4 v[24:27], v4, s[8:11], s30 offen offset:0 sc1
    s_add_u32 s62, s62, 1
    s_cmp_gt_u32 s62, 0x100000
    s_cbranch_scc1 .mg_end_1
    s_waitcnt vmcnt(2)
    v_cmp_eq_u32 vcc, -1, v31
    s_cbranch_vccnz .nk_169
.ok_170:
    v_smfmac_f32_16x16x64_bf16 v[64:67], v[28:31], a[200:207], v2
    s_waitcnt vmcnt(1)
    v_cmp_eq_u32 vcc, -1, v39
    v_smfmac_f32_16x16x64_bf16 v[68:71], v[28:31], a[232:239], v2
    s_cbranch_vccnz .nk_121
    s_branch .ok_122
.nk_159:
    buffer_load_dwordx4 v[28:31], v4, s[8:11], s30 offen offset:1024 sc1
    s_add_u32 s62, s62, 1
    s_cmp_gt_u32 s62, 0x100000
    s_cbranch_scc1 .mg_end_1
    s_waitcnt vmcnt(1)
    v_cmp_eq_u32 vcc, -1, v27
    s_cbranch_vccnz .nk_139
    s_branch .ok_140
.nk_161:
    buffer_load_dwordx4 v[24:27], v4, s[8:11], s30 offen offset:0 sc1
    s_add_u32 s62, s62, 1
    s_cmp_gt_u32 s62, 0x100000
    s_cbranch_scc1 .mg_end_1
    s_waitcnt vmcnt(2)
    v_cmp_eq_u32 vcc, -1, v35
    s_cbranch_vccnz .nk_119
    s_branch .ok_120
.nk_163:
    buffer_load_dwordx4 v[32:35], v4, s[8:11], s30 offen offset:2048 sc1
    s_add_u32 s62, s62, 1
    s_cmp_gt_u32 s62, 0x100000
    s_cbranch_scc1 .mg_end_1
    s_waitcnt vmcnt(1)
    v_cmp_eq_u32 vcc, -1, v27
    s_cbranch_vccnz .nk_143
    s_branch .ok_144
.nk_165:
    buffer_load_dwordx4 v[32:35], v4, s[8:11], s30 offen offset:2048 sc1
    s_add_u32 s62, s62, 1
    s_cmp_gt_u32 s62, 0x100000
    s_cbranch_scc1 .mg_end_1
    s_waitcnt vmcnt(1)
    v_cmp_eq_u32 vcc, -1, v31
    s_cbranch_vccnz .nk_149
    s_branch .ok_150
.nk_167:
    buffer_load_dwordx4 v[28:31], v4, s[8:11], s30 offen offset:1024 sc1
    s_add_u32 s62, s62, 1
    s_cmp_gt_u32 s62, 0x100000
    s_cbranch_scc1 .mg_end_1
    s_waitcnt vmcnt(2)
    v_cmp_eq_u32 vcc, -1, v35
    s_cbranch_vccnz .nk_171
.ok_172:
    v_smfmac_f32_16x16x64_bf16 v[64:67], v[32:35], a[208:215], v2
    s_waitcnt vmcnt(1)
    v_cmp_eq_u32 vcc, -1, v27
    v_smfmac_f32_16x16x64_bf16 v[68:71], v[32:35], a[240:247], v2
    s_cbranch_vccnz .nk_139
    s_branch .ok_140
.nk_169:
    buffer_load_dwordx4 v[28:31], v4, s[8:11], s30 offen offset:1024 sc1
    s_add_u32 s62, s62, 1
    s_cmp_gt_u32 s62, 0x100000
    s_cbranch_scc1 .mg_end_1
    s_waitcnt vmcnt(2)
    v_cmp_eq_u32 vcc, -1, v39
    s_cbranch_vccnz .nk_137
    s_branch .ok_138
.nk_171:
    buffer_load_dwordx4 v[32:35], v4, s[8:11], s30 offen offset:2048 sc1
    s_add_u32 s62, s62, 1
    s_cmp_gt_u32 s62, 0x100000
    s_cbranch_scc1 .mg_end_1
    s_waitcnt vmcnt(2)
    v_cmp_eq_u32 vcc, -1, v27
    s_cbranch_vccnz .nk_155
    s_branch .ok_156
.slowv_17:
    s_mov_b32 s28, 0
    s_mov_b32 s30, 83886080
    s_mov_b32 s31, 84180992
    s_mov_b32 s32, 84475904
    s_mov_b32 s33, 84770816
    s_mov_b32 s41, 66977792
    s_lshl_b32 s42, s56, 13
    s_lshl_b32 s4, s53, 11
    s_add_u32 s44, s42, s4
    s_add_u32 s44, s44, 33554432
    s_add_u32 s42, s42, 16777216
    s_xor_b32 s4, s53, 2
    s_lshl_b32 s4, s4, 10
    s_add_u32 s42, s42, s4
    s_add_u32 s43, s42, 4096
    s_add_u32 s96, s44, 524288
    s_sub_u32 s95, s96, 16777216
    s_mov_b32 s62, 0
    s_mov_b32 s45, 0x3e0293ee
    s_mov_b32 s46, 0
    s_and_b32 s4, s25, 1
    s_lshl_b32 s4, s4, 14
    s_lshr_b32 s5, s25, 1
    s_lshl_b32 s5, s5, 12
    s_or_b32 s4, s4, s5
    s_xor_b32 s47, s47, s4
    s_and_b32 s5, s26, 1
    s_lshl_b32 s5, s5, 10
    s_lshr_b32 s4, s26, 1
    s_lshl_b32 s4, s4, 15
    s_or_b32 s5, s5, s4
    s_bfe_u32 s4, s26, 0x10004
    s_lshl_b32 s4, s4, 11
    s_xor_b32 s5, s5, s4
    s_xor_b32 s34, s5, s47
    s_xor_b32 s35, s34, 0x84000
    s_xor_b32 s36, s34, 0x101000
    s_xor_b32 s37, s34, 0x185000
    s_cmp_eq_u32 s24, 1
    s_cbranch_scc1 .w1_174
    s_cmp_eq_u32 s24, 2
    s_cbranch_scc1 .w2_175
    s_cmp_eq_u32 s24, 3
    s_cbranch_scc1 .w3_176
.w0_173:
    v_bfe_u32 v254, v1, 0, 3
    v_mul_u32_u24 v9, 144, v254
    v_bfe_u32 v254, v1, 3, 1
    v_mul_u32_u24 v254, 1152, v254
    v_add_u32 v9, v9, v254
    v_bfe_u32 v254, v1, 4, 2
    v_mul_u32_u24 v254, 32, v254
    v_add_u32 v9, v9, v254
    s_lshl_b32 s4, s56, 10
    v_bfe_u32 v254, v1, 0, 6
    v_mul_u32_u24 v13, 16, v254
    v_add_u32 v13, 262144, v13
    v_add_u32 v13, s4, v13
    v_xor_b32 v156, 1024, v246
    v_xor_b32 v157, 2048, v246
    v_xor_b32 v158, 3072, v246
    v_bfe_u32 v254, v1, 4, 2
    v_mul_u32_u24 v14, 128, v254
    v_bfe_u32 v254, v1, 0, 4
    v_mul_u32_u24 v254, 16, v254
    v_add_u32 v14, v14, v254
    v_add_u32 v14, 65536, v14
    v_add_u32 v14, s55, v14
    v_bfe_u32 v254, v1, 0, 6
    v_mul_u32_u24 v15, 16, v254
    v_bfe_u32 v254, v1, 2, 2
    v_mul_u32_u24 v16, 128, v254
    v_bfe_u32 v254, v1, 0, 2
    v_mul_u32_u24 v254, 16, v254
    v_add_u32 v16, v16, v254
    v_bfe_u32 v254, v1, 4, 2
    v_mul_u32_u24 v254, 4, v254
    v_add_u32 v16, v16, v254
    v_add_u32 v16, 18688, v16
    v_mov_b32 v208, 0
    v_mov_b32 v209, 0
    v_mov_b32 v210, 0
    v_mov_b32 v211, 0
    v_mov_b32 v212, 0
    v_mov_b32 v213, 0
    v_mov_b32 v214, 0
    v_mov_b32 v215, 0
    v_mov_b32 v216, 0
    v_mov_b32 v217, 0
    v_mov_b32 v218, 0
    v_mov_b32 v219, 0
    s_mov_b64 s[50:51], s[48:49]
    v_mov_b32 v164, 0
    v_mov_b32 v165, 0
    v_mov_b32 v166, 0
    v_mov_b32 v167, 0
    v_mov_b32 v164, 0x3f803f80
    v_mov_b32 v200, s45
    v_mov_b32 v220, 0x3f803f80
    v_mov_b32 v201, s45
    v_mov_b32 v221, 0x3f803f80
    v_mov_b32 v202, s45
    v_mov_b32 v222, 0x3f803f80
    v_mov_b32 v203, s45
    v_mov_b32 v223, 0x3f803f80
    s_waitcnt vmcnt(0)
    ds_read_b64_tr_b16 a[192:193], v242 offset:16384
    ds_read_b64_tr_b16 a[194:195], v242 offset:16896
    ds_read_b64_tr_b16 a[196:197], v242 offset:18432
    ds_read_b64_tr_b16 a[198:199], v242 offset:18944
    ds_read_b64_tr_b16 a[200:201], v242 offset:20480
    ds_read_b64_tr_b16 a[202:203], v242 offset:20992
    ds_read_b64_tr_b16 a[204:205], v242 offset:22528
    ds_read_b64_tr_b16 a[206:207], v242 offset:23040
    ds_read_b64_tr_b16 a[208:209], v242 offset:24576
    ds_read_b64_tr_b16 a[210:211], v242 offset:25088
    ds_read_b64_tr_b16 a[212:213], v242 offset:26624
    ds_read_b64_tr_b16 a[214:215], v242 offset:27136
    ds_read_b64_tr_b16 a[216:217], v242 offset:28672
    ds_read_b64_tr_b16 a[218:219], v242 offset:29184
    ds_read_b64_tr_b16 a[220:221], v242 offset:30720
    ds_read_b64_tr_b16 a[222:223], v242 offset:31232
    ds_read_b64_tr_b16 a[224:225], v243 offset:16384
    ds_read_b64_tr_b16 a[226:227], v243 offset:16896
    ds_read_b64_tr_b16 a[228:229], v243 offset:18432
    ds_read_b64_tr_b16 a[230:231], v243 offset:18944
    ds_read_b64_tr_b16 a[232:233], v243 offset:20480
    ds_read_b64_tr_b16 a[234:235], v243 offset:20992
    ds_read_b64_tr_b16 a[236:237], v243 offset:22528
    ds_read_b64_tr_b16 a[238:239], v243 offset:23040
    ds_read_b64_tr_b16 a[240:241], v243 offset:24576
    ds_read_b64_tr_b16 a[242:243], v243 offset:25088
    ds_read_b64_tr_b16 a[244:245], v243 offset:26624
    ds_read_b64_tr_b16 a[246:247], v243 offset:27136
    ds_read_b64_tr_b16 a[248:249], v243 offset:28672
    ds_read_b64_tr_b16 a[250:251], v243 offset:29184
    ds_read_b64_tr_b16 a[252:253], v243 offset:30720
    ds_read_b64_tr_b16 a[254:255], v243 offset:31232
    s_waitcnt lgkmcnt(0)
    s_barrier
    buffer_load_dwordx4 v[104:107], v15, s[8:11], s42 offen offset:0
    buffer_load_dwordx4 v[120:123], v15, s[8:11], s43 offen offset:0
    buffer_load_dwordx4 v[136:139], v15, s[8:11], s44 offen offset:0
    buffer_load_dwordx4 v[140:143], v15, s[8:11], s44 offen offset:1024
    s_add_u32 s42, s42, 262144
    s_add_u32 s43, s43, 262144
    s_add_u32 s44, s44, 262144
.p2align 6
.step_179:
    s_barrier
    s_setprio 3
    buffer_load_dwordx4 v[24:27], v3, s[8:11], s30 offen offset:0 sc1
    s_setprio 2
    buffer_load_dwordx4 v[28:31], v3, s[8:11], s30 offen offset:1024 sc1
    s_setprio 1
    buffer_load_dwordx4 v[32:35], v3, s[8:11], s30 offen offset:2048 sc1
    s_setprio 0
    buffer_load_dwordx4 v[36:39], v3, s[8:11], s30 offen offset:3072 sc1
    s_call_b64 s[98:99], .gm_177
    v_permlane32_swap_b32 v40, v44
    v_permlane32_swap_b32 v41, v45
    v_permlane32_swap_b32 v42, v46
    v_permlane32_swap_b32 v43, v47
    v_add_f32 v40, v40, v44
    v_add_f32 v41, v41, v45
    v_add_f32 v42, v42, v46
    v_add_f32 v43, v43, v47
    ds_write2_b32 v5, v40, v41 offset0:0 offset1:36
    ds_write2_b32 v5, v42, v43 offset0:72 offset1:108
    v_permlane32_swap_b32 v48, v52
    v_permlane32_swap_b32 v49, v53
    v_permlane32_swap_b32 v50, v54
    v_permlane32_swap_b32 v51, v55
    v_pk_add_f32 v[48:49], v[48:49], v[52:53]
    v_pk_add_f32 v[50:51], v[50:51], v[54:55]
    ds_write2_b32 v6, v48, v49 offset0:0 offset1:36
    ds_write2_b32 v6, v50, v51 offset0:72 offset1:108
    s_waitcnt lgkmcnt(2)
    s_barrier
    ds_read_b128 v[72:75], v9 offset:0
    ds_read_b128 v[76:79], v9 offset:2304
    ds_read_b128 v[80:83], v9 offset:16
    ds_read_b128 v[84:87], v9 offset:2320
    v_smfmac_f32_16x16x64_bf16 v[56:59], v[24:27], a[128:135], v2
    v_smfmac_f32_16x16x64_bf16 v[60:63], v[24:27], a[160:167], v2
    s_waitcnt lgkmcnt(4)
    s_barrier
    v_smfmac_f32_16x16x64_bf16 v[56:59], v[28:31], a[136:143], v2
    s_waitcnt lgkmcnt(2)
    v_pk_add_f32 v[72:73], v[72:73], v[76:77]
    v_pk_add_f32 v[74:75], v[74:75], v[78:79]
    v_cvt_pk_bf16_f32 v144, v72, v73
    v_cvt_pk_bf16_f32 v145, v74, v75
    s_waitcnt lgkmcnt(0)
    v_pk_add_f32 v[80:81], v[80:81], v[84:85]
    v_pk_add_f32 v[82:83], v[82:83], v[86:87]
    v_cvt_pk_bf16_f32 v146, v80, v81
    v_cvt_pk_bf16_f32 v147, v82, v83
    s_nop 1
    v_mfma_f32_16x16x32_bf16 v[192:195], v[104:107], v[144:147], 0
    v_mfma_f32_16x16x32_bf16 v[160:163], v[120:123], v[144:147], 0
    v_smfmac_f32_16x16x64_bf16 v[60:63], v[28:31], a[168:175], v2
    v_add_f32_dpp v151, v195, v195 row_ror:8 row_mask:0xf bank_mask:0x3
    v_add_f32_dpp v148, v192, v192 row_ror:8 row_mask:0xf bank_mask:0x3
    v_add_f32_dpp v149, v193, v193 row_ror:8 row_mask:0xf bank_mask:0x3
    v_add_f32_dpp v150, v194, v194 row_ror:8 row_mask:0xf bank_mask:0x3
    v_add_f32_dpp v151, v163, v163 row_ror:8 row_mask:0xf bank_mask:0xc
    v_add_f32_dpp v148, v160, v160 row_ror:8 row_mask:0xf bank_mask:0xc
    v_add_f32_dpp v149, v161, v161 row_ror:8 row_mask:0xf bank_mask:0xc
    v_add_f32_dpp v150, v162, v162 row_ror:8 row_mask:0xf bank_mask:0xc
    v_min_u32 v151, 0xfffffffe, v151
    buffer_store_dwordx4 v[148:151], v246, s[8:11], s30 offen sc1
    v_smfmac_f32_16x16x64_bf16 v[56:59], v[32:35], a[144:151], v2
    v_smfmac_f32_16x16x64_bf16 v[60:63], v[32:35], a[176:183], v2
    v_smfmac_f32_16x16x64_bf16 v[56:59], v[36:39], a[152:159], v2
    v_smfmac_f32_16x16x64_bf16 v[60:63], v[36:39], a[184:191], v2
    v_mov_b32 v40, 0
    v_mov_b32 v41, 0
    v_mov_b32 v42, 0
    v_mov_b32 v43, 0
    v_mov_b32 v44, 0
    v_mov_b32 v45, 0
    v_mov_b32 v46, 0
    v_mov_b32 v47, 0
    v_permlane32_swap_b32 v56, v60
    v_permlane32_swap_b32 v57, v61
    v_permlane32_swap_b32 v58, v62
    v_permlane32_swap_b32 v59, v63
    v_pk_add_f32 v[56:57], v[56:57], v[60:61]
    v_pk_add_f32 v[58:59], v[58:59], v[62:63]
    v_cvt_pk_bf16_f32 v60, v56, v57
    v_cvt_pk_bf16_f32 v61, v58, v59
    ds_write2_b32 v255, v60, v61 offset0:0 offset1:64
    ds_write_b128 v8, v[56:59]
    s_cmp_eq_u32 s28, 63
    s_cbranch_scc1 .fin_180
    buffer_load_dwordx4 v[176:179], v13, s[8:11], s30 offen sc1
    buffer_load_dwordx4 v[180:183], v156, s[8:11], s30 offen sc1
    buffer_load_dwordx4 v[184:187], v157, s[8:11], s30 offen sc1
    buffer_load_dwordx4 v[188:191], v158, s[8:11], s30 offen sc1
    s_waitcnt lgkmcnt(0)
    s_barrier
    ds_read_b128 v[212:215], v15 offset:20224
    ds_read_b128 v[216:219], v15 offset:21248
    buffer_load_dwordx4 v[72:75], v13, s[8:11], s30 offen sc1
    buffer_load_dwordx4 v[76:79], v156, s[8:11], s30 offen sc1
    buffer_load_dwordx4 v[80:83], v157, s[8:11], s30 offen sc1
    buffer_load_dwordx4 v[84:87], v158, s[8:11], s30 offen sc1
.mf_181:
    s_waitcnt vmcnt(7)
    v_max3_u32 v18, v176, v177, v178
    v_pk_add_f32 v[196:197], v[176:177], v[178:179]
    s_waitcnt vmcnt(6)
    v_max3_u32 v18, v18, v179, v183
    v_pk_add_f32 v[192:193], v[148:149], v[180:181]
    v_pk_add_f32 v[194:195], v[150:151], v[182:183]
    v_add_f32 v196, v196, v197
    s_waitcnt vmcnt(5)
    v_pk_add_f32 v[192:193], v[192:193], v[184:185]
    v_pk_add_f32 v[194:195], v[194:195], v[186:187]
    s_waitcnt vmcnt(4)
    v_max3_u32 v18, v18, v187, v191
    v_pk_add_f32 v[192:193], v[192:193], v[188:189]
    v_pk_add_f32 v[194:195], v[194:195], v[190:191]
    v_cmp_eq_u32 vcc, -1, v18
    v_max3_f32 v19, v192, v193, v196
    v_max3_f32 v19, v19, v194, v195
    s_cbranch_vccnz .re_182
.sj_183:
    s_nop 0
    v_max_f32_dpp v18, v19, v19 row_ror:8 row_mask:0xf bank_mask:0xf
    v_max_f32_dpp v17, v19, v19 row_ror:8 row_mask:0xf bank_mask:0xf
    s_nop 1
    v_permlane16_swap_b32 v18, v17
    v_max_f32 v19, v18, v17
    v_max_f32 v18, v18, v17
    s_nop 1
    v_permlane32_swap_b32 v18, v19
    v_max_f32 v18, v18, v19
    v_mul_f32 v18, s45, v18
    v_fma_f32 v244, v196, s45, -v18
    v_pk_fma_f32 v[240:241], v[192:193], v[200:201], v[18:19] op_sel_hi:[1,1,0] neg_lo:[0,0,1] neg_hi:[0,0,1]
    v_exp_f32 v244, v244
    v_pk_fma_f32 v[242:243], v[194:195], v[200:201], v[18:19] op_sel_hi:[1,1,0] neg_lo:[0,0,1] neg_hi:[0,0,1]
    v_exp_f32 v240, v240
    v_mov_b32_dpp v245, v244 row_ror:8 row_mask:0xf bank_mask:0xf
    v_cvt_pk_bf16_f32 v208, v244, v245
    v_cvt_pk_bf16_f32 v209, v244, v245
    v_pk_mov_b32 v[210:211], v[208:209], v[208:209] op_sel:[0,1]
    v_exp_f32 v241, v241
    s_waitcnt lgkmcnt(0)
    v_mfma_f32_16x16x32_bf16 v[228:231], v[212:215], v[208:211], 0
    v_exp_f32 v242, v242
    v_mfma_f32_16x16x32_bf16 v[224:227], v[164:167], v[208:211], 0
    v_exp_f32 v243, v243
    v_cvt_pk_bf16_f32 v204, v240, v241
    v_cvt_pk_bf16_f32 v205, v242, v243
    v_mfma_f32_16x16x32_bf16 v[232:235], v[216:219], v[208:211], 0
    v_mov_b32_dpp v206, v204 row_ror:8 row_mask:0xf bank_mask:0xf
    v_mov_b32_dpp v207, v205 row_ror:8 row_mask:0xf bank_mask:0xf
    s_nop 1
    v_mfma_f32_16x16x32_bf16 v[224:227], v[220:223], v[204:207], v[224:227]
    v_mfma_f32_16x16x32_bf16 v[228:231], v[136:139], v[204:207], v[228:231]
    v_mfma_f32_16x16x32_bf16 v[232:235], v[140:143], v[204:207], v[232:235]
    s_mov_b64 exec, s[50:51]
    v_rcp_f32 v18, v224
    s_nop 1
    v_mul_f32 v228, v18, v228
    v_mul_f32 v229, v18, v229
    v_mul_f32 v230, v18, v230
    v_mul_f32 v231, v18, v231
    v_pk_mul_f32 v[232:233], v[18:19], v[232:233] op_sel_hi:[0,1]
    v_pk_mul_f32 v[234:235], v[18:19], v[234:235] op_sel_hi:[0,1]
    v_cvt_pk_bf16_f32 v236, v228, v229
    v_cvt_pk_bf16_f32 v239, v234, v235
    v_cvt_pk_bf16_f32 v237, v230, v231
    v_cvt_pk_bf16_f32 v238, v232, v233
    v_min_u32 v239, 0xfffffffe, v239
    buffer_store_dwordx4 v[236:239], v14, s[8:11], s30 offen sc1
    s_mov_b64 exec, -1
    v_mov_b32 v48, 0
    v_mov_b32 v49, 0
    v_mov_b32 v50, 0
    v_mov_b32 v51, 0
    v_mov_b32 v52, 0
    v_mov_b32 v53, 0
    v_mov_b32 v54, 0
    v_mov_b32 v55, 0
    v_mov_b32 v56, 0
    v_mov_b32 v57, 0
    v_mov_b32 v58, 0
    v_mov_b32 v59, 0
    v_mov_b32 v60, 0
    v_mov_b32 v61, 0
    v_mov_b32 v62, 0
    v_mov_b32 v63, 0
    s_waitcnt vmcnt(0)
    s_barrier
    s_setprio 3
    buffer_load_dwordx4 v[24:27], v4, s[8:11], s30 offen offset:0 sc1
    s_setprio 2
    buffer_load_dwordx4 v[28:31], v4, s[8:11], s30 offen offset:1024 sc1
    s_setprio 1
    buffer_load_dwordx4 v[32:35], v4, s[8:11], s30 offen offset:2048 sc1
    s_setprio 0
    buffer_load_dwordx4 v[36:39], v4, s[8:11], s30 offen offset:3072 sc1
    s_call_b64 s[98:99], .gm_178
    s_nop 6
    v_permlane32_swap_b32 v64, v68
    v_permlane32_swap_b32 v65, v69
    v_permlane32_swap_b32 v66, v70
    v_permlane32_swap_b32 v67, v71
    v_pk_add_f32 v[64:65], v[64:65], v[68:69]
    v_pk_add_f32 v[66:67], v[66:67], v[70:71]
    ds_write2_b32 v7, v64, v65 offset0:0 offset1:36
    ds_write2_b32 v7, v66, v67 offset0:72 offset1:108
    s_waitcnt lgkmcnt(0)
    s_barrier
    buffer_load_dwordx4 v[104:107], v15, s[8:11], s42 offen offset:0
    buffer_load_dwordx4 v[120:123], v15, s[8:11], s43 offen offset:0
    buffer_load_dwordx4 v[136:139], v15, s[8:11], s44 offen offset:0
    buffer_load_dwordx4 v[140:143], v15, s[8:11], s44 offen offset:1024
    s_add_u32 s42, s42, 262144
    s_add_u32 s43, s43, 262144
    s_add_u32 s44, s44, 262144
    v_mov_b32 v64, 0
    v_mov_b32 v65, 0
    v_mov_b32 v66, 0
    v_mov_b32 v67, 0
    v_mov_b32 v68, 0
    v_mov_b32 v69, 0
    v_mov_b32 v70, 0
    v_mov_b32 v71, 0
    s_mov_b32 s4, s30
    s_mov_b32 s30, s31
    s_mov_b32 s31, s32
    s_mov_b32 s32, s33
    s_mov_b32 s33, s4
    s_add_u32 s28, s28, 1
    s_mov_b32 s62, 0
    s_branch .step_179
.fin_180:
    s_waitcnt lgkmcnt(0)
    s_barrier
    s_barrier
    s_endpgm
.re_182:
    buffer_load_dwordx4 v[176:179], v13, s[8:11], s30 offen sc1
    buffer_load_dwordx4 v[180:183], v156, s[8:11], s30 offen sc1
    buffer_load_dwordx4 v[184:187], v157, s[8:11], s30 offen sc1
    buffer_load_dwordx4 v[188:191], v158, s[8:11], s30 offen sc1
    s_waitcnt vmcnt(7)
    v_max3_u32 v18, v72, v73, v74
    v_pk_add_f32 v[196:197], v[72:73], v[74:75]
    s_waitcnt vmcnt(6)
    v_max3_u32 v18, v18, v75, v79
    v_pk_add_f32 v[192:193], v[148:149], v[76:77]
    v_pk_add_f32 v[194:195], v[150:151], v[78:79]
    v_add_f32 v196, v196, v197
    s_waitcnt vmcnt(5)
    v_pk_add_f32 v[192:193], v[192:193], v[80:81]
    v_pk_add_f32 v[194:195], v[194:195], v[82:83]
    s_waitcnt vmcnt(4)
    v_max3_u32 v18, v18, v83, v87
    v_pk_add_f32 v[192:193], v[192:193], v[84:85]
    v_pk_add_f32 v[194:195], v[194:195], v[86:87]
    v_cmp_eq_u32 vcc, -1, v18
    v_max3_f32 v19, v192, v193, v196
    v_max3_f32 v19, v19, v194, v195
    s_cbranch_vccnz .re_184
    s_branch .sj_183
.re_184:
    buffer_load_dwordx4 v[72:75], v13, s[8:11], s30 offen sc1
    buffer_load_dwordx4 v[76:79], v156, s[8:11], s30 offen sc1
    buffer_load_dwordx4 v[80:83], v157, s[8:11], s30 offen sc1
    buffer_load_dwordx4 v[84:87], v158, s[8:11], s30 offen sc1
    s_add_u32 s62, s62, 1
    s_cmp_gt_u32 s62, 0x100000
    s_cbranch_scc1 .mg_end_1
    s_branch .mf_181
.w1_174:
    v_bfe_u32 v254, v1, 0, 3
    v_mul_u32_u24 v9, 144, v254
    v_bfe_u32 v254, v1, 3, 1
    v_mul_u32_u24 v254, 1152, v254
    v_add_u32 v9, v9, v254
    v_bfe_u32 v254, v1, 4, 2
    v_mul_u32_u24 v254, 32, v254
    v_add_u32 v9, v9, v254
    v_bfe_u32 v254, v1, 0, 1
    v_mul_u32_u24 v11, 144, v254
    v_bfe_u32 v254, v1, 2, 2
    v_mul_u32_u24 v254, 288, v254
    v_add_u32 v11, v11, v254
    v_bfe_u32 v254, v1, 1, 1
    v_mul_u32_u24 v254, 1152, v254
    v_add_u32 v11, v11, v254
    v_bfe_u32 v254, v1, 4, 2
    v_mul_u32_u24 v254, 32, v254
    v_add_u32 v11, v11, v254
    v_add_u32 v11, 4736, v11
    s_lshl_b32 s4, s56, 10
    s_lshl_b32 s5, s53, 2
    v_bfe_u32 v254, v1, 0, 6
    v_mul_u32_u24 v10, 16, v254
    v_add_u32 v10, 262144, v10
    v_add_u32 v10, s4, v10
    v_add_u32 v10, s5, v10
    v_bfe_u32 v254, v1, 1, 3
    v_mul_u32_u24 v12, 144, v254
    v_bfe_u32 v254, v1, 4, 2
    v_mul_u32_u24 v254, 32, v254
    v_add_u32 v12, v12, v254
    v_bfe_u32 v254, v1, 0, 1
    v_mul_u32_u24 v254, 16, v254
    v_add_u32 v12, v12, v254
    v_add_u32 v12, 9472, v12
    v_bfe_u32 v254, v1, 0, 6
    v_mul_u32_u24 v13, 16, v254
    v_add_u32 v13, s101, v13
    v_bfe_u32 v254, v1, 0, 6
    v_mul_u32_u24 v14, 8, v254
    v_add_u32 v14, s55, v14
    v_xor_b32 v14, 2048, v14
    v_min_u32 v249, 0xfffffffe, v249
    buffer_store_dwordx2 v[248:249], v14, s[8:11], s30 offen sc1
    v_bfe_u32 v254, v1, 0, 6
    v_mul_u32_u24 v15, 16, v254
    s_add_u32 s42, s42, 262144
    s_add_u32 s43, s43, 262144
    s_add_u32 s44, s44, 262144
    s_waitcnt vmcnt(0)
    ds_read_b64_tr_b16 a[192:193], v242 offset:16384
    ds_read_b64_tr_b16 a[194:195], v242 offset:16896
    ds_read_b64_tr_b16 a[196:197], v242 offset:18432
    ds_read_b64_tr_b16 a[198:199], v242 offset:18944
    ds_read_b64_tr_b16 a[200:201], v242 offset:20480
    ds_read_b64_tr_b16 a[202:203], v242 offset:20992
    ds_read_b64_tr_b16 a[204:205], v242 offset:22528
    ds_read_b64_tr_b16 a[206:207], v242 offset:23040
    ds_read_b64_tr_b16 a[208:209], v242 offset:24576
    ds_read_b64_tr_b16 a[210:211], v242 offset:25088
    ds_read_b64_tr_b16 a[212:213], v242 offset:26624
    ds_read_b64_tr_b16 a[214:215], v242 offset:27136
    ds_read_b64_tr_b16 a[216:217], v242 offset:28672
    ds_read_b64_tr_b16 a[218:219], v242 offset:29184
    ds_read_b64_tr_b16 a[220:221], v242 offset:30720
    ds_read_b64_tr_b16 a[222:223], v242 offset:31232
    ds_read_b64_tr_b16 a[224:225], v243 offset:16384
    ds_read_b64_tr_b16 a[226:227], v243 offset:16896
    ds_read_b64_tr_b16 a[228:229], v243 offset:18432
    ds_read_b64_tr_b16 a[230:231], v243 offset:18944
    ds_read_b64_tr_b16 a[232:233], v243 offset:20480
    ds_read_b64_tr_b16 a[234:235], v243 offset:20992
    ds_read_b64_tr_b16 a[236:237], v243 offset:22528
    ds_read_b64_tr_b16 a[238:239], v243 offset:23040
    ds_read_b64_tr_b16 a[240:241], v243 offset:24576
    ds_read_b64_tr_b16 a[242:243], v243 offset:25088
    ds_read_b64_tr_b16 a[244:245], v243 offset:26624
    ds_read_b64_tr_b16 a[246:247], v243 offset:27136
    ds_read_b64_tr_b16 a[248:249], v243 offset:28672
    ds_read_b64_tr_b16 a[250:251], v243 offset:29184
    ds_read_b64_tr_b16 a[252:253], v243 offset:30720
    ds_read_b64_tr_b16 a[254:255], v243 offset:31232
    s_waitcnt lgkmcnt(0)
    s_barrier
.p2align 6
.step_185:
    s_barrier
    s_setprio 3
    buffer_load_dwordx4 v[24:27], v3, s[8:11], s30 offen offset:0 sc1
    s_setprio 2
    buffer_load_dwordx4 v[28:31], v3, s[8:11], s30 offen offset:1024 sc1
    s_setprio 1
    buffer_load_dwordx4 v[32:35], v3, s[8:11], s30 offen offset:2048 sc1
    s_setprio 0
    buffer_load_dwordx4 v[36:39], v3, s[8:11], s30 offen offset:3072 sc1
    s_call_b64 s[98:99], .gm_177
    v_permlane32_swap_b32 v40, v44
    v_permlane32_swap_b32 v41, v45
    v_permlane32_swap_b32 v42, v46
    v_permlane32_swap_b32 v43, v47
    v_add_f32 v40, v40, v44
    v_add_f32 v41, v41, v45
    v_add_f32 v42, v42, v46
    v_add_f32 v43, v43, v47
    ds_write2_b32 v5, v40, v41 offset0:0 offset1:36
    ds_write2_b32 v5, v42, v43 offset0:72 offset1:108
    v_permlane32_swap_b32 v48, v52
    v_permlane32_swap_b32 v49, v53
    v_permlane32_swap_b32 v50, v54
    v_permlane32_swap_b32 v51, v55
    v_pk_add_f32 v[48:49], v[48:49], v[52:53]
    v_pk_add_f32 v[50:51], v[50:51], v[54:55]
    ds_write2_b32 v6, v48, v49 offset0:0 offset1:36
    ds_write2_b32 v6, v50, v51 offset0:72 offset1:108
    s_waitcnt lgkmcnt(2)
    s_barrier
    ds_read_b128 v[72:75], v9 offset:0
    ds_read_b128 v[76:79], v9 offset:2304
    ds_read_b128 v[80:83], v9 offset:16
    ds_read_b128 v[84:87], v9 offset:2320
    v_smfmac_f32_16x16x64_bf16 v[56:59], v[24:27], a[128:135], v2
    v_smfmac_f32_16x16x64_bf16 v[60:63], v[24:27], a[160:167], v2
    s_waitcnt lgkmcnt(4)
    s_barrier
    ds_read_b128 v[88:91], v11 offset:0
    ds_read_b128 v[92:95], v11 offset:2304
    ds_read_b128 v[96:99], v11 offset:16
    ds_read_b128 v[100:103], v11 offset:2320
    v_smfmac_f32_16x16x64_bf16 v[56:59], v[28:31], a[136:143], v2
    s_waitcnt lgkmcnt(6)
    v_pk_add_f32 v[72:73], v[72:73], v[76:77]
    v_pk_add_f32 v[74:75], v[74:75], v[78:79]
    v_cvt_pk_bf16_f32 v144, v72, v73
    v_cvt_pk_bf16_f32 v145, v74, v75
    s_waitcnt lgkmcnt(4)
    v_pk_add_f32 v[80:81], v[80:81], v[84:85]
    v_pk_add_f32 v[82:83], v[82:83], v[86:87]
    v_cvt_pk_bf16_f32 v146, v80, v81
    v_cvt_pk_bf16_f32 v147, v82, v83
    s_waitcnt lgkmcnt(2)
    v_pk_add_f32 v[88:89], v[88:89], v[92:93]
    v_pk_add_f32 v[90:91], v[90:91], v[94:95]
    v_cvt_pk_bf16_f32 v148, v88, v89
    v_cvt_pk_bf16_f32 v149, v90, v91
    s_waitcnt lgkmcnt(0)
    v_pk_add_f32 v[96:97], v[96:97], v[100:101]
    v_pk_add_f32 v[98:99], v[98:99], v[102:103]
    v_cvt_pk_bf16_f32 v150, v96, v97
    v_cvt_pk_bf16_f32 v151, v98, v99
    s_nop 1
    v_mfma_f32_16x16x32_bf16 v[196:199], v[148:151], v[144:147], 0
    v_smfmac_f32_16x16x64_bf16 v[60:63], v[28:31], a[168:175], v2
    v_smfmac_f32_16x16x64_bf16 v[56:59], v[32:35], a[144:151], v2
    v_pk_add_f32 v[196:197], v[196:197], v[198:199]
    s_nop 1
    v_add_f32_dpp v198, v196, v196 row_ror:8 row_mask:0xf bank_mask:0xf
    v_add_f32_dpp v199, v197, v197 row_ror:8 row_mask:0xf bank_mask:0xf
    v_cndmask_b32 v198, v199, v198, s[48:49]
    v_min_u32 v198, 0xfffffffe, v198
    buffer_store_dword v198, v10, s[8:11], s30 offen sc1
    v_smfmac_f32_16x16x64_bf16 v[60:63], v[32:35], a[176:183], v2
    v_smfmac_f32_16x16x64_bf16 v[56:59], v[36:39], a[152:159], v2
    v_smfmac_f32_16x16x64_bf16 v[60:63], v[36:39], a[184:191], v2
    v_mov_b32 v40, 0
    v_mov_b32 v41, 0
    v_mov_b32 v42, 0
    v_mov_b32 v43, 0
    v_mov_b32 v44, 0
    v_mov_b32 v45, 0
    v_mov_b32 v46, 0
    v_mov_b32 v47, 0
    v_permlane32_swap_b32 v56, v60
    v_permlane32_swap_b32 v57, v61
    v_permlane32_swap_b32 v58, v62
    v_permlane32_swap_b32 v59, v63
    v_pk_add_f32 v[56:57], v[56:57], v[60:61]
    v_pk_add_f32 v[58:59], v[58:59], v[62:63]
    v_cvt_pk_bf16_f32 v60, v56, v57
    v_cvt_pk_bf16_f32 v61, v58, v59
    ds_write2_b32 v255, v60, v61 offset0:0 offset1:64
    ds_write_b128 v8, v[56:59]
    s_waitcnt lgkmcnt(0)
    s_barrier
    s_cmp_eq_u32 s28, 63
    s_cbranch_scc1 .fin_186
    s_xor_b32 s38, s34, 0x4000
    s_xor_b32 s39, s34, 0x1000
    s_xor_b32 s40, s34, 0x5000
    v_mov_b32 v48, 0
    v_mov_b32 v49, 0
    v_mov_b32 v50, 0
    v_mov_b32 v51, 0
    v_mov_b32 v52, 0
    v_mov_b32 v53, 0
    v_mov_b32 v54, 0
    v_mov_b32 v55, 0
    v_mov_b32 v56, 0
    v_mov_b32 v57, 0
    v_mov_b32 v58, 0
    v_mov_b32 v59, 0
    v_mov_b32 v60, 0
    v_mov_b32 v61, 0
    v_mov_b32 v62, 0
    v_mov_b32 v63, 0
    s_barrier
    s_setprio 3
    buffer_load_dwordx4 v[24:27], v4, s[8:11], s30 offen offset:0 sc1
    s_setprio 2
    buffer_load_dwordx4 v[28:31], v4, s[8:11], s30 offen offset:1024 sc1
    s_setprio 1
    buffer_load_dwordx4 v[32:35], v4, s[8:11], s30 offen offset:2048 sc1
    s_setprio 0
    buffer_load_dwordx4 v[36:39], v4, s[8:11], s30 offen offset:3072 sc1
    s_call_b64 s[98:99], .gm_178
    s_nop 6
    v_permlane32_swap_b32 v64, v68
    v_permlane32_swap_b32 v65, v69
    v_permlane32_swap_b32 v66, v70
    v_permlane32_swap_b32 v67, v71
    v_pk_add_f32 v[64:65], v[64:65], v[68:69]
    v_pk_add_f32 v[66:67], v[66:67], v[70:71]
    ds_write2_b32 v7, v64, v65 offset0:0 offset1:36
    ds_write2_b32 v7, v66, v67 offset0:72 offset1:108
    s_waitcnt lgkmcnt(0)
    s_barrier
    ds_read_b128 v[72:75], v12 offset:0
    ds_read_b128 v[76:79], v12 offset:1152
    ds_read_b128 v[80:83], v12 offset:2304
    ds_read_b128 v[84:87], v12 offset:3456
    s_waitcnt lgkmcnt(2)
    v_pk_add_f32 v[72:73], v[72:73], v[76:77]
    v_pk_add_f32 v[74:75], v[74:75], v[78:79]
    s_waitcnt lgkmcnt(0)
    v_pk_add_f32 v[80:81], v[80:81], v[84:85]
    v_pk_add_f32 v[82:83], v[82:83], v[86:87]
    v_pk_add_f32 v[72:73], v[72:73], v[80:81]
    v_pk_add_f32 v[74:75], v[74:75], v[82:83]
    v_min_u32 v75, 0xfffffffe, v75
    buffer_store_dwordx4 v[72:75], v13, s[8:11], s34 offen sc1
    v_mov_b32 v64, 0
    v_mov_b32 v65, 0
    v_mov_b32 v66, 0
    v_mov_b32 v67, 0
    v_mov_b32 v68, 0
    v_mov_b32 v69, 0
    v_mov_b32 v70, 0
    v_mov_b32 v71, 0
    s_waitcnt vmcnt(0)
.pl_187:
    buffer_load_dwordx4 v[76:79], v13, s[8:11], s38 offen sc1
    buffer_load_dwordx4 v[80:83], v13, s[8:11], s39 offen sc1
    buffer_load_dwordx4 v[84:87], v13, s[8:11], s40 offen sc1
    s_waitcnt vmcnt(2)
    v_pk_add_f32 v[88:89], v[72:73], v[76:77]
    v_pk_add_f32 v[90:91], v[74:75], v[78:79]
    s_waitcnt vmcnt(0)
    v_max3_u32 v18, v79, v83, v87
    v_cmp_eq_u32 vcc, -1, v18
    v_pk_add_f32 v[80:81], v[80:81], v[84:85]
    v_pk_add_f32 v[82:83], v[82:83], v[86:87]
    v_pk_add_f32 v[88:89], v[88:89], v[80:81]
    v_pk_add_f32 v[90:91], v[90:91], v[82:83]
    v_cvt_pk_bf16_f32 v92, v88, v89
    v_cvt_pk_bf16_f32 v93, v90, v91
    v_min_u32 v93, 0xfffffffe, v93
    s_cbranch_vccnz .pr_188
    buffer_store_dwordx2 v[92:93], v14, s[8:11], s31 offen sc1
    s_mov_b32 s4, s30
    s_mov_b32 s30, s31
    s_mov_b32 s31, s32
    s_mov_b32 s32, s33
    s_mov_b32 s33, s4
    s_add_u32 s28, s28, 1
    s_mov_b32 s62, 0
    s_mov_b32 s4, s34
    s_mov_b32 s34, s35
    s_mov_b32 s35, s36
    s_mov_b32 s36, s37
    s_mov_b32 s37, s4
    s_branch .step_185
.fin_186:
    s_barrier
    s_waitcnt vmcnt(0)
    s_endpgm
.pr_188:
    s_add_u32 s62, s62, 1
    s_cmp_gt_u32 s62, 0x100000
    s_cbranch_scc1 .mg_end_1
    s_branch .pl_187
.w2_175:
    s_lshl_b32 s4, s56, 9
    s_lshl_b32 s5, s53, 7
    s_add_u32 s4, s4, s5
    s_add_u32 s4, s4, 92274688
    v_mov_b32 v14, s4
    v_bfe_u32 v254, v1, 0, 6
    v_mul_u32_u24 v12, 16, v254
    v_add_u32 v12, 18176, v12
    v_bfe_u32 v254, v1, 0, 6
    v_mul_u32_u24 v15, 16, v254
    s_add_u32 s42, s42, 262144
    s_add_u32 s43, s43, 262144
    s_add_u32 s44, s44, 262144
    s_mov_b32 exec_hi, 0
    v_xor_b32 v244, 1024, v244
    s_mov_b32 exec_hi, -1
    s_waitcnt vmcnt(0)
    ds_read_b64_tr_b16 a[192:193], v242 offset:16384
    ds_read_b64_tr_b16 a[194:195], v242 offset:16896
    ds_read_b64_tr_b16 a[196:197], v242 offset:18432
    ds_read_b64_tr_b16 a[198:199], v242 offset:18944
    ds_read_b64_tr_b16 a[200:201], v242 offset:20480
    ds_read_b64_tr_b16 a[202:203], v242 offset:20992
    ds_read_b64_tr_b16 a[204:205], v242 offset:22528
    ds_read_b64_tr_b16 a[206:207], v242 offset:23040
    ds_read_b64_tr_b16 a[208:209], v242 offset:24576
    ds_read_b64_tr_b16 a[210:211], v242 offset:25088
    ds_read_b64_tr_b16 a[212:213], v242 offset:26624
    ds_read_b64_tr_b16 a[214:215], v242 offset:27136
    ds_read_b64_tr_b16 a[216:217], v242 offset:28672
    ds_read_b64_tr_b16 a[218:219], v242 offset:29184
    ds_read_b64_tr_b16 a[220:221], v242 offset:30720
    ds_read_b64_tr_b16 a[222:223], v242 offset:31232
    ds_read_b64_tr_b16 a[224:225], v243 offset:16384
    ds_read_b64_tr_b16 a[226:227], v243 offset:16896
    ds_read_b64_tr_b16 a[228:229], v243 offset:18432
    ds_read_b64_tr_b16 a[230:231], v243 offset:18944
    ds_read_b64_tr_b16 a[232:233], v243 offset:20480
    ds_read_b64_tr_b16 a[234:235], v243 offset:20992
    ds_read_b64_tr_b16 a[236:237], v243 offset:22528
    ds_read_b64_tr_b16 a[238:239], v243 offset:23040
    ds_read_b64_tr_b16 a[240:241], v243 offset:24576
    ds_read_b64_tr_b16 a[242:243], v243 offset:25088
    ds_read_b64_tr_b16 a[244:245], v243 offset:26624
    ds_read_b64_tr_b16 a[246:247], v243 offset:27136
    ds_read_b64_tr_b16 a[248:249], v243 offset:28672
    ds_read_b64_tr_b16 a[250:251], v243 offset:29184
    ds_read_b64_tr_b16 a[252:253], v243 offset:30720
    ds_read_b64_tr_b16 a[254:255], v243 offset:31232
    s_waitcnt lgkmcnt(0)
    s_barrier
.p2align 6
.step_189:
    s_barrier
    s_setprio 3
    buffer_load_dwordx4 v[24:27], v3, s[8:11], s30 offen offset:0 sc1
    s_setprio 2
    buffer_load_dwordx4 v[28:31], v3, s[8:11], s30 offen offset:1024 sc1
    s_setprio 1
    buffer_load_dwordx4 v[32:35], v3, s[8:11], s30 offen offset:2048 sc1
    s_setprio 0
    buffer_load_dwordx4 v[36:39], v3, s[8:11], s30 offen offset:3072 sc1
    s_call_b64 s[98:99], .gm_177
    v_permlane32_swap_b32 v40, v44
    v_permlane32_swap_b32 v41, v45
    v_permlane32_swap_b32 v42, v46
    v_permlane32_swap_b32 v43, v47
    v_add_f32 v40, v40, v44
    v_add_f32 v41, v41, v45
    v_add_f32 v42, v42, v46
    v_add_f32 v43, v43, v47
    ds_write2_b32 v5, v40, v41 offset0:0 offset1:36
    ds_write2_b32 v5, v42, v43 offset0:72 offset1:108
    v_permlane32_swap_b32 v48, v52
    v_permlane32_swap_b32 v49, v53
    v_permlane32_swap_b32 v50, v54
    v_permlane32_swap_b32 v51, v55
    v_pk_add_f32 v[48:49], v[48:49], v[52:53]
    v_pk_add_f32 v[50:51], v[50:51], v[54:55]
    ds_write2_b32 v6, v48, v49 offset0:0 offset1:36
    ds_write2_b32 v6, v50, v51 offset0:72 offset1:108
    s_waitcnt lgkmcnt(2)
    s_barrier
    s_waitcnt lgkmcnt(0)
    s_barrier
    v_smfmac_f32_16x16x64_bf16 v[56:59], v[24:27], a[128:135], v2
    v_smfmac_f32_16x16x64_bf16 v[60:63], v[24:27], a[160:167], v2
    v_smfmac_f32_16x16x64_bf16 v[56:59], v[28:31], a[136:143], v2
    v_smfmac_f32_16x16x64_bf16 v[60:63], v[28:31], a[168:175], v2
    v_smfmac_f32_16x16x64_bf16 v[56:59], v[32:35], a[144:151], v2
    v_smfmac_f32_16x16x64_bf16 v[60:63], v[32:35], a[176:183], v2
    v_smfmac_f32_16x16x64_bf16 v[56:59], v[36:39], a[152:159], v2
    v_smfmac_f32_16x16x64_bf16 v[60:63], v[36:39], a[184:191], v2
    ds_read_b64 v[72:73], v9 offset:0
    ds_read_b64 v[74:75], v9 offset:1152
    ds_read_b64 v[76:77], v9 offset:2304
    ds_read_b64 v[78:79], v9 offset:3456
    s_waitcnt lgkmcnt(0)
    v_pk_add_f32 v[72:73], v[72:73], v[74:75]
    v_pk_add_f32 v[76:77], v[76:77], v[78:79]
    v_pk_add_f32 v[72:73], v[72:73], v[76:77]
    v_cvt_pk_bf16_f32 v72, v72, v73
    ds_write_b32 v11, v72
    v_mov_b32 v40, 0
    v_mov_b32 v41, 0
    v_mov_b32 v42, 0
    v_mov_b32 v43, 0
    v_mov_b32 v44, 0
    v_mov_b32 v45, 0
    v_mov_b32 v46, 0
    v_mov_b32 v47, 0
    v_permlane32_swap_b32 v56, v60
    v_permlane32_swap_b32 v57, v61
    v_permlane32_swap_b32 v58, v62
    v_permlane32_swap_b32 v59, v63
    v_pk_add_f32 v[56:57], v[56:57], v[60:61]
    v_pk_add_f32 v[58:59], v[58:59], v[62:63]
    v_cvt_pk_bf16_f32 v60, v56, v57
    v_cvt_pk_bf16_f32 v61, v58, v59
    ds_write2_b32 v255, v60, v61 offset0:0 offset1:64
    ds_write_b128 v8, v[56:59]
    s_waitcnt lgkmcnt(0)
    s_barrier
    s_cmp_eq_u32 s28, 63
    s_cbranch_scc1 .fin_190
    s_waitcnt lgkmcnt(0)
    v_mov_b32 v48, 0
    v_mov_b32 v49, 0
    v_mov_b32 v50, 0
    v_mov_b32 v51, 0
    v_mov_b32 v52, 0
    v_mov_b32 v53, 0
    v_mov_b32 v54, 0
    v_mov_b32 v55, 0
    v_mov_b32 v56, 0
    v_mov_b32 v57, 0
    v_mov_b32 v58, 0
    v_mov_b32 v59, 0
    v_mov_b32 v60, 0
    v_mov_b32 v61, 0
    v_mov_b32 v62, 0
    v_mov_b32 v63, 0
    s_barrier
    ds_read_b128 v[72:75], v12
    s_setprio 3
    buffer_load_dwordx4 v[24:27], v4, s[8:11], s30 offen offset:0 sc1
    s_setprio 2
    buffer_load_dwordx4 v[28:31], v4, s[8:11], s30 offen offset:1024 sc1
    s_setprio 1
    buffer_load_dwordx4 v[32:35], v4, s[8:11], s30 offen offset:2048 sc1
    s_setprio 0
    buffer_load_dwordx4 v[36:39], v4, s[8:11], s30 offen offset:3072 sc1
    s_call_b64 s[98:99], .gm_178
    s_waitcnt lgkmcnt(0)
    buffer_store_dwordx4 v[72:75], v244, s[8:11], s41 offen sc1
    s_nop 5
    v_permlane32_swap_b32 v64, v68
    v_permlane32_swap_b32 v65, v69
    v_permlane32_swap_b32 v66, v70
    v_permlane32_swap_b32 v67, v71
    v_pk_add_f32 v[64:65], v[64:65], v[68:69]
    v_pk_add_f32 v[66:67], v[66:67], v[70:71]
    ds_write2_b32 v7, v64, v65 offset0:0 offset1:36
    ds_write2_b32 v7, v66, v67 offset0:72 offset1:108
    s_waitcnt lgkmcnt(0)
    s_barrier
    s_cmp_lt_u32 s28, 52
    s_cselect_b32 s4, 1, 0
    s_andn2_b32 s4, s4, s28
    s_cbranch_scc1 .nl_191
    v_mov_b32 v18, s28
    v_add_u32 v18, 1, v18
    s_mov_b64 exec, 1
    s_waitcnt vmcnt(0)
    buffer_store_dword v18, v14, s[8:11], 0 offen sc1
    s_mov_b64 exec, -1
.nl_191:
    v_mov_b32 v64, 0
    v_mov_b32 v65, 0
    v_mov_b32 v66, 0
    v_mov_b32 v67, 0
    v_mov_b32 v68, 0
    v_mov_b32 v69, 0
    v_mov_b32 v70, 0
    v_mov_b32 v71, 0
    s_mov_b32 s4, s30
    s_mov_b32 s30, s31
    s_mov_b32 s31, s32
    s_mov_b32 s32, s33
    s_mov_b32 s33, s4
    s_add_u32 s28, s28, 1
    s_mov_b32 s62, 0
    s_add_u32 s41, s41, 0x20000
    s_branch .step_189
.fin_190:
    s_barrier
    ds_read_b128 v[72:75], v12
    s_waitcnt lgkmcnt(0)
    buffer_store_dwordx4 v[72:75], v244, s[8:11], s41 offen sc1
    s_waitcnt vmcnt(0)
    v_mov_b32 v18, 64
    s_mov_b64 exec, 1
    buffer_store_dword v18, v14, s[8:11], 0 offen sc1
    s_mov_b64 exec, -1
    s_endpgm
.w3_176:
    v_bfe_u32 v254, v1, 3, 1
    v_mul_u32_u24 v12, 512, v254
    v_bfe_u32 v254, v1, 5, 1
    v_mul_u32_u24 v254, 256, v254
    v_add_u32 v12, v12, v254
    v_bfe_u32 v254, v1, 2, 1
    v_mul_u32_u24 v254, 128, v254
    v_add_u32 v12, v12, v254
    v_bfe_u32 v254, v1, 0, 2
    v_mul_u32_u24 v254, 16, v254
    v_add_u32 v12, v12, v254
    v_bfe_u32 v254, v1, 4, 1
    v_mul_u32_u24 v254, 8, v254
    v_add_u32 v12, v12, v254
    v_add_u32 v12, 14080, v12
    v_bfe_u32 v254, v1, 2, 2
    v_mul_u32_u24 v14, 128, v254
    v_bfe_u32 v254, v1, 0, 2
    v_mul_u32_u24 v254, 16, v254
    v_add_u32 v14, v14, v254
    v_bfe_u32 v254, v1, 4, 2
    v_mul_u32_u24 v254, 4, v254
    v_add_u32 v14, v14, v254
    v_add_u32 v14, 18688, v14
    v_bfe_u32 v254, v1, 0, 6
    v_mul_u32_u24 v15, 16, v254
    v_add_u32 v15, s101, v15
    v_bfe_u32 v254, v1, 2, 2
    v_mul_u32_u24 v16, 128, v254
    v_bfe_u32 v254, v1, 0, 2
    v_mul_u32_u24 v254, 16, v254
    v_add_u32 v16, v16, v254
    v_bfe_u32 v254, v1, 4, 2
    v_mul_u32_u24 v254, 4, v254
    v_add_u32 v16, v16, v254
    v_add_u32 v16, 135168, v16
    v_add_u32 v16, s58, v16
    s_lshl_b32 s4, s56, 9
    s_add_u32 s4, s4, 92291072
    v_bfe_u32 v254, v1, 0, 2
    v_mul_u32_u24 v13, 128, v254
    v_bfe_u32 v254, v1, 2, 1
    v_mul_u32_u24 v254, 16384, v254
    v_add_u32 v13, v13, v254
    v_add_u32 v13, s4, v13
    s_waitcnt vmcnt(0)
    ds_read_b64_tr_b16 a[192:193], v242 offset:16384
    ds_read_b64_tr_b16 a[194:195], v242 offset:16896
    ds_read_b64_tr_b16 a[196:197], v242 offset:18432
    ds_read_b64_tr_b16 a[198:199], v242 offset:18944
    ds_read_b64_tr_b16 a[200:201], v242 offset:20480
    ds_read_b64_tr_b16 a[202:203], v242 offset:20992
    ds_read_b64_tr_b16 a[204:205], v242 offset:22528
    ds_read_b64_tr_b16 a[206:207], v242 offset:23040
    ds_read_b64_tr_b16 a[208:209], v242 offset:24576
    ds_read_b64_tr_b16 a[210:211], v242 offset:25088
    ds_read_b64_tr_b16 a[212:213], v242 offset:26624
    ds_read_b64_tr_b16 a[214:215], v242 offset:27136
    ds_read_b64_tr_b16 a[216:217], v242 offset:28672
    ds_read_b64_tr_b16 a[218:219], v242 offset:29184
    ds_read_b64_tr_b16 a[220:221], v242 offset:30720
    ds_read_b64_tr_b16 a[222:223], v242 offset:31232
    ds_read_b64_tr_b16 a[224:225], v243 offset:16384
    ds_read_b64_tr_b16 a[226:227], v243 offset:16896
    ds_read_b64_tr_b16 a[228:229], v243 offset:18432
    ds_read_b64_tr_b16 a[230:231], v243 offset:18944
    ds_read_b64_tr_b16 a[232:233], v243 offset:20480
    ds_read_b64_tr_b16 a[234:235], v243 offset:20992
    ds_read_b64_tr_b16 a[236:237], v243 offset:22528
    ds_read_b64_tr_b16 a[238:239], v243 offset:23040
    ds_read_b64_tr_b16 a[240:241], v243 offset:24576
    ds_read_b64_tr_b16 a[242:243], v243 offset:25088
    ds_read_b64_tr_b16 a[244:245], v243 offset:26624
    ds_read_b64_tr_b16 a[246:247], v243 offset:27136
    ds_read_b64_tr_b16 a[248:249], v243 offset:28672
    ds_read_b64_tr_b16 a[250:251], v243 offset:29184
    ds_read_b64_tr_b16 a[252:253], v243 offset:30720
    ds_read_b64_tr_b16 a[254:255], v243 offset:31232
    s_waitcnt lgkmcnt(0)
    s_cmp_ge_u32 s46, 1
    s_cbranch_scc1 .kvd_193
    s_mov_b32 s62, 0
.kv_192:
    buffer_load_dword v18, v13, s[8:11], 0 offen sc1
    s_add_u32 s62, s62, 1
    s_cmp_gt_u32 s62, 0x100000
    s_cbranch_scc1 .mg_end_1
    s_waitcnt vmcnt(0)
    v_min_u32_dpp v18, v18, v18 quad_perm:[1,0,3,2] row_mask:0xf bank_mask:0xf
    s_nop 1
    v_min_u32_dpp v18, v18, v18 quad_perm:[2,3,0,1] row_mask:0xf bank_mask:0xf
    s_nop 1
    v_min_u32_dpp v18, v18, v18 row_half_mirror row_mask:0xf bank_mask:0xf
    s_nop 0
    v_readfirstlane_b32 s46, v18
    s_cmp_lt_u32 s46, 1
    s_cbranch_scc1 .kv_192
.kvd_193:
    s_barrier
.p2align 6
.step_194:
    s_barrier
    s_setprio 3
    buffer_load_dwordx4 v[24:27], v3, s[8:11], s30 offen offset:0 sc1
    s_setprio 2
    buffer_load_dwordx4 v[28:31], v3, s[8:11], s30 offen offset:1024 sc1
    s_setprio 1
    buffer_load_dwordx4 v[32:35], v3, s[8:11], s30 offen offset:2048 sc1
    s_setprio 0
    buffer_load_dwordx4 v[36:39], v3, s[8:11], s30 offen offset:3072 sc1
    s_call_b64 s[98:99], .gm_177
    v_permlane32_swap_b32 v40, v44
    v_permlane32_swap_b32 v41, v45
    v_permlane32_swap_b32 v42, v46
    v_permlane32_swap_b32 v43, v47
    v_add_f32 v40, v40, v44
    v_add_f32 v41, v41, v45
    v_add_f32 v42, v42, v46
    v_add_f32 v43, v43, v47
    ds_write2_b32 v5, v40, v41 offset0:0 offset1:36
    ds_write2_b32 v5, v42, v43 offset0:72 offset1:108
    v_permlane32_swap_b32 v48, v52
    v_permlane32_swap_b32 v49, v53
    v_permlane32_swap_b32 v50, v54
    v_permlane32_swap_b32 v51, v55
    v_pk_add_f32 v[48:49], v[48:49], v[52:53]
    v_pk_add_f32 v[50:51], v[50:51], v[54:55]
    ds_write2_b32 v6, v48, v49 offset0:0 offset1:36
    ds_write2_b32 v6, v50, v51 offset0:72 offset1:108
    s_waitcnt lgkmcnt(2)
    s_barrier
    s_waitcnt lgkmcnt(0)
    s_barrier
    v_smfmac_f32_16x16x64_bf16 v[56:59], v[24:27], a[128:135], v2
    v_smfmac_f32_16x16x64_bf16 v[60:63], v[24:27], a[160:167], v2
    v_smfmac_f32_16x16x64_bf16 v[56:59], v[28:31], a[136:143], v2
    v_smfmac_f32_16x16x64_bf16 v[60:63], v[28:31], a[168:175], v2
    v_smfmac_f32_16x16x64_bf16 v[56:59], v[32:35], a[144:151], v2
    v_smfmac_f32_16x16x64_bf16 v[60:63], v[32:35], a[176:183], v2
    v_smfmac_f32_16x16x64_bf16 v[56:59], v[36:39], a[152:159], v2
    v_smfmac_f32_16x16x64_bf16 v[60:63], v[36:39], a[184:191], v2
    ds_read_b64 v[72:73], v9 offset:0
    ds_read_b64 v[74:75], v9 offset:1152
    ds_read_b64 v[76:77], v9 offset:2304
    ds_read_b64 v[78:79], v9 offset:3456
    s_waitcnt lgkmcnt(0)
    v_pk_add_f32 v[72:73], v[72:73], v[74:75]
    v_pk_add_f32 v[76:77], v[76:77], v[78:79]
    v_pk_add_f32 v[72:73], v[72:73], v[76:77]
    v_cvt_pk_bf16_f32 v72, v72, v73
    ds_write_b32 v11, v72
    v_mov_b32 v40, 0
    v_mov_b32 v41, 0
    v_mov_b32 v42, 0
    v_mov_b32 v43, 0
    v_mov_b32 v44, 0
    v_mov_b32 v45, 0
    v_mov_b32 v46, 0
    v_mov_b32 v47, 0
    v_permlane32_swap_b32 v56, v60
    v_permlane32_swap_b32 v57, v61
    v_permlane32_swap_b32 v58, v62
    v_permlane32_swap_b32 v59, v63
    v_pk_add_f32 v[56:57], v[56:57], v[60:61]
    v_pk_add_f32 v[58:59], v[58:59], v[62:63]
    v_cvt_pk_bf16_f32 v60, v56, v57
    v_cvt_pk_bf16_f32 v61, v58, v59
    ds_write2_b32 v255, v60, v61 offset0:0 offset1:64
    ds_write_b128 v8, v[56:59]
    s_waitcnt lgkmcnt(0)
    s_barrier
    ds_read_b64 v[72:73], v12 offset:0
    ds_read_b64 v[74:75], v12 offset:1024
    ds_read_b64 v[76:77], v12 offset:2048
    ds_read_b64 v[78:79], v12 offset:3072
    ds_read_b64 v[80:81], v12 offset:64
    ds_read_b64 v[82:83], v12 offset:1088
    ds_read_b64 v[84:85], v12 offset:2112
    ds_read_b64 v[86:87], v12 offset:3136
    s_waitcnt lgkmcnt(4)
    v_add_f32 v72, v72, v74
    v_add_f32 v73, v73, v75
    v_add_f32 v76, v76, v78
    v_add_f32 v77, v77, v79
    v_add_f32 v72, v72, v76
    v_add_f32 v73, v73, v77
    v_cvt_pk_bf16_f32 v72, v72, v73
    s_waitcnt lgkmcnt(0)
    v_add_f32 v80, v80, v82
    v_add_f32 v81, v81, v83
    v_add_f32 v84, v84, v86
    v_add_f32 v85, v85, v87
    v_add_f32 v80, v80, v84
    v_add_f32 v81, v81, v85
    v_cvt_pk_bf16_f32 v80, v80, v81
    ds_write_b32 v14, v72
    ds_write_b32 v14, v80 offset:64
    s_waitcnt lgkmcnt(0)
    s_cmp_eq_u32 s28, 63
    s_cbranch_scc1 .fin_195
    buffer_store_dwordx4 v[20:23], v246, s[8:11], s32 offen sc1
    buffer_store_dwordx4 v[20:23], v245, s[8:11], s32 offen sc1
    buffer_store_dword v20, v237, s[8:11], s32 offen sc1
    s_add_u32 s5, s28, 2
    s_cmp_ge_u32 s46, s5
    s_cbranch_scc1 .kvd_197
    s_mov_b32 s62, 0
.kv_196:
    buffer_load_dword v18, v13, s[8:11], 0 offen sc1
    s_add_u32 s62, s62, 1
    s_cmp_gt_u32 s62, 0x100000
    s_cbranch_scc1 .mg_end_1
    s_waitcnt vmcnt(0)
    v_min_u32_dpp v18, v18, v18 quad_perm:[1,0,3,2] row_mask:0xf bank_mask:0xf
    s_nop 1
    v_min_u32_dpp v18, v18, v18 quad_perm:[2,3,0,1] row_mask:0xf bank_mask:0xf
    s_nop 1
    v_min_u32_dpp v18, v18, v18 row_half_mirror row_mask:0xf bank_mask:0xf
    s_nop 0
    v_readfirstlane_b32 s46, v18
    s_cmp_lt_u32 s46, s5
    s_cbranch_scc1 .kv_196
.kvd_197:
    v_mov_b32 v48, 0
    v_mov_b32 v49, 0
    v_mov_b32 v50, 0
    v_mov_b32 v51, 0
    v_mov_b32 v52, 0
    v_mov_b32 v53, 0
    v_mov_b32 v54, 0
    v_mov_b32 v55, 0
    v_mov_b32 v56, 0
    v_mov_b32 v57, 0
    v_mov_b32 v58, 0
    v_mov_b32 v59, 0
    v_mov_b32 v60, 0
    v_mov_b32 v61, 0
    v_mov_b32 v62, 0
    v_mov_b32 v63, 0
    s_barrier
    s_setprio 3
    buffer_load_dwordx4 v[24:27], v4, s[8:11], s30 offen offset:0 sc1
    s_setprio 2
    buffer_load_dwordx4 v[28:31], v4, s[8:11], s30 offen offset:1024 sc1
    s_setprio 1
    buffer_load_dwordx4 v[32:35], v4, s[8:11], s30 offen offset:2048 sc1
    s_setprio 0
    buffer_load_dwordx4 v[36:39], v4, s[8:11], s30 offen offset:3072 sc1
    s_call_b64 s[98:99], .gm_178
    buffer_store_dwordx4 v[20:23], v15, s[8:11], s36 offen sc1
    s_nop 5
    v_permlane32_swap_b32 v64, v68
    v_permlane32_swap_b32 v65, v69
    v_permlane32_swap_b32 v66, v70
    v_permlane32_swap_b32 v67, v71
    v_pk_add_f32 v[64:65], v[64:65], v[68:69]
    v_pk_add_f32 v[66:67], v[66:67], v[70:71]
    ds_write2_b32 v7, v64, v65 offset0:0 offset1:36
    ds_write2_b32 v7, v66, v67 offset0:72 offset1:108
    s_waitcnt lgkmcnt(0)
    s_barrier
    s_add_u32 s5, s28, 3
    s_min_u32 s5, s5, 64
    s_cmp_ge_u32 s46, s5
    s_cbranch_scc1 .kvd_199
    s_mov_b32 s62, 0
.kv_198:
    buffer_load_dword v18, v13, s[8:11], 0 offen sc1
    s_add_u32 s62, s62, 1
    s_cmp_gt_u32 s62, 0x100000
    s_cbranch_scc1 .mg_end_1
    s_waitcnt vmcnt(0)
    v_min_u32_dpp v18, v18, v18 quad_perm:[1,0,3,2] row_mask:0xf bank_mask:0xf
    s_nop 1
    v_min_u32_dpp v18, v18, v18 quad_perm:[2,3,0,1] row_mask:0xf bank_mask:0xf
    s_nop 1
    v_min_u32_dpp v18, v18, v18 row_half_mirror row_mask:0xf bank_mask:0xf
    s_nop 0
    v_readfirstlane_b32 s46, v18
.kvd_199:
    v_mov_b32 v64, 0
    v_mov_b32 v65, 0
    v_mov_b32 v66, 0
    v_mov_b32 v67, 0
    v_mov_b32 v68, 0
    v_mov_b32 v69, 0
    v_mov_b32 v70, 0
    v_mov_b32 v71, 0
    s_mov_b32 s4, s30
    s_mov_b32 s30, s31
    s_mov_b32 s31, s32
    s_mov_b32 s32, s33
    s_mov_b32 s33, s4
    s_add_u32 s28, s28, 1
    s_mov_b32 s62, 0
    s_mov_b32 s4, s34
    s_mov_b32 s34, s35
    s_mov_b32 s35, s36
    s_mov_b32 s36, s37
    s_mov_b32 s37, s4
    s_add_u32 s41, s41, 0x20000
    s_branch .step_194
.fin_195:
    s_barrier
    s_endpgm
.p2align 6
.gm_177:
    s_waitcnt vmcnt(3)
    v_max_u32 v18, v25, v27
    v_cmp_eq_u32 vcc, -1, v18
    s_cbranch_vccnz .nk_200
.ok_201:
    v_smfmac_f32_16x16x64_bf16 v[40:43], v[24:27], a[0:7], v2
    v_smfmac_f32_16x16x64_bf16 v[44:47], v[24:27], a[32:39], v2
    s_waitcnt vmcnt(2)
    v_max_u32 v18, v29, v31
    v_cmp_eq_u32 vcc, -1, v18
    v_smfmac_f32_16x16x64_bf16 v[48:51], v[24:27], a[64:71], v2
    v_smfmac_f32_16x16x64_bf16 v[52:55], v[24:27], a[96:103], v2
    s_cbranch_vccnz .nk_202
.ok_203:
    v_smfmac_f32_16x16x64_bf16 v[40:43], v[28:31], a[8:15], v2
    v_smfmac_f32_16x16x64_bf16 v[44:47], v[28:31], a[40:47], v2
    s_waitcnt vmcnt(1)
    v_max_u32 v18, v33, v35
    v_cmp_eq_u32 vcc, -1, v18
    v_smfmac_f32_16x16x64_bf16 v[48:51], v[28:31], a[72:79], v2
    v_smfmac_f32_16x16x64_bf16 v[52:55], v[28:31], a[104:111], v2
    s_cbranch_vccnz .nk_204
.ok_205:
    v_smfmac_f32_16x16x64_bf16 v[40:43], v[32:35], a[16:23], v2
    v_smfmac_f32_16x16x64_bf16 v[44:47], v[32:35], a[48:55], v2
    s_waitcnt vmcnt(0)
    v_max_u32 v18, v37, v39
    v_cmp_eq_u32 vcc, -1, v18
    v_smfmac_f32_16x16x64_bf16 v[48:51], v[32:35], a[80:87], v2
    v_smfmac_f32_16x16x64_bf16 v[52:55], v[32:35], a[112:119], v2
    s_cbranch_vccnz .nk_206
.ok_207:
    v_smfmac_f32_16x16x64_bf16 v[40:43], v[36:39], a[24:31], v2
    v_smfmac_f32_16x16x64_bf16 v[44:47], v[36:39], a[56:63], v2
    v_smfmac_f32_16x16x64_bf16 v[48:51], v[36:39], a[88:95], v2
    v_smfmac_f32_16x16x64_bf16 v[52:55], v[36:39], a[120:127], v2
    s_setpc_b64 s[98:99]
.nk_200:
    buffer_load_dwordx4 v[24:27], v3, s[8:11], s30 offen offset:0 sc1
    s_add_u32 s62, s62, 1
    s_cmp_gt_u32 s62, 0x100000
    s_cbranch_scc1 .mg_end_1
    s_waitcnt vmcnt(3)
    v_max_u32 v18, v29, v31
    v_cmp_eq_u32 vcc, -1, v18
    s_cbranch_vccnz .nk_208
.ok_209:
    v_smfmac_f32_16x16x64_bf16 v[40:43], v[28:31], a[8:15], v2
    v_smfmac_f32_16x16x64_bf16 v[44:47], v[28:31], a[40:47], v2
    s_waitcnt vmcnt(2)
    v_max_u32 v18, v33, v35
    v_cmp_eq_u32 vcc, -1, v18
    v_smfmac_f32_16x16x64_bf16 v[48:51], v[28:31], a[72:79], v2
    v_smfmac_f32_16x16x64_bf16 v[52:55], v[28:31], a[104:111], v2
    s_cbranch_vccnz .nk_210
.ok_211:
    v_smfmac_f32_16x16x64_bf16 v[40:43], v[32:35], a[16:23], v2
    v_smfmac_f32_16x16x64_bf16 v[44:47], v[32:35], a[48:55], v2
    s_waitcnt vmcnt(1)
    v_max_u32 v18, v37, v39
    v_cmp_eq_u32 vcc, -1, v18
    v_smfmac_f32_16x16x64_bf16 v[48:51], v[32:35], a[80:87], v2
    v_smfmac_f32_16x16x64_bf16 v[52:55], v[32:35], a[112:119], v2
    s_cbranch_vccnz .nk_212
.ok_213:
    v_smfmac_f32_16x16x64_bf16 v[40:43], v[36:39], a[24:31], v2
    v_smfmac_f32_16x16x64_bf16 v[44:47], v[36:39], a[56:63], v2
    s_waitcnt vmcnt(0)
    v_max_u32 v18, v25, v27
    v_cmp_eq_u32 vcc, -1, v18
    v_smfmac_f32_16x16x64_bf16 v[48:51], v[36:39], a[88:95], v2
    v_smfmac_f32_16x16x64_bf16 v[52:55], v[36:39], a[120:127], v2
    s_cbranch_vccnz .nk_214
.ok_215:
    v_smfmac_f32_16x16x64_bf16 v[40:43], v[24:27], a[0:7], v2
    v_smfmac_f32_16x16x64_bf16 v[44:47], v[24:27], a[32:39], v2
    v_smfmac_f32_16x16x64_bf16 v[48:51], v[24:27], a[64:71], v2
    v_smfmac_f32_16x16x64_bf16 v[52:55], v[24:27], a[96:103], v2
    s_setpc_b64 s[98:99]
.nk_202:
    buffer_load_dwordx4 v[28:31], v3, s[8:11], s30 offen offset:1024 sc1
    s_add_u32 s62, s62, 1
    s_cmp_gt_u32 s62, 0x100000
    s_cbranch_scc1 .mg_end_1
    s_waitcnt vmcnt(2)
    v_max_u32 v18, v33, v35
    v_cmp_eq_u32 vcc, -1, v18
    s_cbranch_vccnz .nk_216
.ok_217:
    v_smfmac_f32_16x16x64_bf16 v[40:43], v[32:35], a[16:23], v2
    v_smfmac_f32_16x16x64_bf16 v[44:47], v[32:35], a[48:55], v2
    s_waitcnt vmcnt(1)
    v_max_u32 v18, v37, v39
    v_cmp_eq_u32 vcc, -1, v18
    v_smfmac_f32_16x16x64_bf16 v[48:51], v[32:35], a[80:87], v2
    v_smfmac_f32_16x16x64_bf16 v[52:55], v[32:35], a[112:119], v2
    s_cbranch_vccnz .nk_218
.ok_219:
    v_smfmac_f32_16x16x64_bf16 v[40:43], v[36:39], a[24:31], v2
    v_smfmac_f32_16x16x64_bf16 v[44:47], v[36:39], a[56:63], v2
    s_waitcnt vmcnt(0)
    v_max_u32 v18, v29, v31
    v_cmp_eq_u32 vcc, -1, v18
    v_smfmac_f32_16x16x64_bf16 v[48:51], v[36:39], a[88:95], v2
    v_smfmac_f32_16x16x64_bf16 v[52:55], v[36:39], a[120:127], v2
    s_cbranch_vccnz .nk_220
.ok_221:
    v_smfmac_f32_16x16x64_bf16 v[40:43], v[28:31], a[8:15], v2
    v_smfmac_f32_16x16x64_bf16 v[44:47], v[28:31], a[40:47], v2
    v_smfmac_f32_16x16x64_bf16 v[48:51], v[28:31], a[72:79], v2
    v_smfmac_f32_16x16x64_bf16 v[52:55], v[28:31], a[104:111], v2
    s_setpc_b64 s[98:99]
.nk_204:
    buffer_load_dwordx4 v[32:35], v3, s[8:11], s30 offen offset:2048 sc1
    s_add_u32 s62, s62, 1
    s_cmp_gt_u32 s62, 0x100000
    s_cbranch_scc1 .mg_end_1
    s_waitcnt vmcnt(1)
    v_max_u32 v18, v37, v39
    v_cmp_eq_u32 vcc, -1, v18
    s_cbranch_vccnz .nk_222
.ok_223:
    v_smfmac_f32_16x16x64_bf16 v[40:43], v[36:39], a[24:31], v2
    v_smfmac_f32_16x16x64_bf16 v[44:47], v[36:39], a[56:63], v2
    s_waitcnt vmcnt(0)
    v_max_u32 v18, v33, v35
    v_cmp_eq_u32 vcc, -1, v18
    v_smfmac_f32_16x16x64_bf16 v[48:51], v[36:39], a[88:95], v2
    v_smfmac_f32_16x16x64_bf16 v[52:55], v[36:39], a[120:127], v2
    s_cbranch_vccnz .nk_224
.ok_225:
    v_smfmac_f32_16x16x64_bf16 v[40:43], v[32:35], a[16:23], v2
    v_smfmac_f32_16x16x64_bf16 v[44:47], v[32:35], a[48:55], v2
    v_smfmac_f32_16x16x64_bf16 v[48:51], v[32:35], a[80:87], v2
    v_smfmac_f32_16x16x64_bf16 v[52:55], v[32:35], a[112:119], v2
    s_setpc_b64 s[98:99]
.nk_206:
    buffer_load_dwordx4 v[36:39], v3, s[8:11], s30 offen offset:3072 sc1
    s_add_u32 s62, s62, 1
    s_cmp_gt_u32 s62, 0x100000
    s_cbranch_scc1 .mg_end_1
    s_waitcnt vmcnt(0)
    v_max_u32 v18, v37, v39
    v_cmp_eq_u32 vcc, -1, v18
    s_cbranch_vccnz .nk_206
    s_branch .ok_207
.nk_208:
    buffer_load_dwordx4 v[28:31], v3, s[8:11], s30 offen offset:1024 sc1
    s_add_u32 s62, s62, 1
    s_cmp_gt_u32 s62, 0x100000
    s_cbranch_scc1 .mg_end_1
    s_waitcnt vmcnt(3)
    v_max_u32 v18, v33, v35
    v_cmp_eq_u32 vcc, -1, v18
    s_cbranch_vccnz .nk_226
.ok_227:
    v_smfmac_f32_16x16x64_bf16 v[40:43], v[32:35], a[16:23], v2
    v_smfmac_f32_16x16x64_bf16 v[44:47], v[32:35], a[48:55], v2
    s_waitcnt vmcnt(2)
    v_max_u32 v18, v37, v39
    v_cmp_eq_u32 vcc, -1, v18
    v_smfmac_f32_16x16x64_bf16 v[48:51], v[32:35], a[80:87], v2
    v_smfmac_f32_16x16x64_bf16 v[52:55], v[32:35], a[112:119], v2
    s_cbranch_vccnz .nk_228
.ok_229:
    v_smfmac_f32_16x16x64_bf16 v[40:43], v[36:39], a[24:31], v2
    v_smfmac_f32_16x16x64_bf16 v[44:47], v[36:39], a[56:63], v2
    s_waitcnt vmcnt(1)
    v_max_u32 v18, v25, v27
    v_cmp_eq_u32 vcc, -1, v18
    v_smfmac_f32_16x16x64_bf16 v[48:51], v[36:39], a[88:95], v2
    v_smfmac_f32_16x16x64_bf16 v[52:55], v[36:39], a[120:127], v2
    s_cbranch_vccnz .nk_230
.ok_231:
    v_smfmac_f32_16x16x64_bf16 v[40:43], v[24:27], a[0:7], v2
    v_smfmac_f32_16x16x64_bf16 v[44:47], v[24:27], a[32:39], v2
    s_waitcnt vmcnt(0)
    v_max_u32 v18, v29, v31
    v_cmp_eq_u32 vcc, -1, v18
    v_smfmac_f32_16x16x64_bf16 v[48:51], v[24:27], a[64:71], v2
    v_smfmac_f32_16x16x64_bf16 v[52:55], v[24:27], a[96:103], v2
    s_cbranch_vccnz .nk_220
    s_branch .ok_221
.nk_210:
    buffer_load_dwordx4 v[32:35], v3, s[8:11], s30 offen offset:2048 sc1
    s_add_u32 s62, s62, 1
    s_cmp_gt_u32 s62, 0x100000
    s_cbranch_scc1 .mg_end_1
    s_waitcnt vmcnt(2)
    v_max_u32 v18, v37, v39
    v_cmp_eq_u32 vcc, -1, v18
    s_cbranch_vccnz .nk_232
.ok_233:
    v_smfmac_f32_16x16x64_bf16 v[40:43], v[36:39], a[24:31], v2
    v_smfmac_f32_16x16x64_bf16 v[44:47], v[36:39], a[56:63], v2
    s_waitcnt vmcnt(1)
    v_max_u32 v18, v25, v27
    v_cmp_eq_u32 vcc, -1, v18
    v_smfmac_f32_16x16x64_bf16 v[48:51], v[36:39], a[88:95], v2
    v_smfmac_f32_16x16x64_bf16 v[52:55], v[36:39], a[120:127], v2
    s_cbranch_vccnz .nk_234
.ok_235:
    v_smfmac_f32_16x16x64_bf16 v[40:43], v[24:27], a[0:7], v2
    v_smfmac_f32_16x16x64_bf16 v[44:47], v[24:27], a[32:39], v2
    s_waitcnt vmcnt(0)
    v_max_u32 v18, v33, v35
    v_cmp_eq_u32 vcc, -1, v18
    v_smfmac_f32_16x16x64_bf16 v[48:51], v[24:27], a[64:71], v2
    v_smfmac_f32_16x16x64_bf16 v[52:55], v[24:27], a[96:103], v2
    s_cbranch_vccnz .nk_224
    s_branch .ok_225
.nk_212:
    buffer_load_dwordx4 v[36:39], v3, s[8:11], s30 offen offset:3072 sc1
    s_add_u32 s62, s62, 1
    s_cmp_gt_u32 s62, 0x100000
    s_cbranch_scc1 .mg_end_1
    s_waitcnt vmcnt(1)
    v_max_u32 v18, v25, v27
    v_cmp_eq_u32 vcc, -1, v18
    s_cbranch_vccnz .nk_236
.ok_237:
    v_smfmac_f32_16x16x64_bf16 v[40:43], v[24:27], a[0:7], v2
    v_smfmac_f32_16x16x64_bf16 v[44:47], v[24:27], a[32:39], v2
    s_waitcnt vmcnt(0)
    v_max_u32 v18, v37, v39
    v_cmp_eq_u32 vcc, -1, v18
    v_smfmac_f32_16x16x64_bf16 v[48:51], v[24:27], a[64:71], v2
    v_smfmac_f32_16x16x64_bf16 v[52:55], v[24:27], a[96:103], v2
    s_cbranch_vccnz .nk_206
    s_branch .ok_207
.nk_214:
    buffer_load_dwordx4 v[24:27], v3, s[8:11], s30 offen offset:0 sc1
    s_add_u32 s62, s62, 1
    s_cmp_gt_u32 s62, 0x100000
    s_cbranch_scc1 .mg_end_1
    s_waitcnt vmcnt(0)
    v_max_u32 v18, v25, v27
    v_cmp_eq_u32 vcc, -1, v18
    s_cbranch_vccnz .nk_214
    s_branch .ok_215
.nk_216:
    buffer_load_dwordx4 v[32:35], v3, s[8:11], s30 offen offset:2048 sc1
    s_add_u32 s62, s62, 1
    s_cmp_gt_u32 s62, 0x100000
    s_cbranch_scc1 .mg_end_1
    s_waitcnt vmcnt(2)
    v_max_u32 v18, v37, v39
    v_cmp_eq_u32 vcc, -1, v18
    s_cbranch_vccnz .nk_238
.ok_239:
    v_smfmac_f32_16x16x64_bf16 v[40:43], v[36:39], a[24:31], v2
    v_smfmac_f32_16x16x64_bf16 v[44:47], v[36:39], a[56:63], v2
    s_waitcnt vmcnt(1)
    v_max_u32 v18, v29, v31
    v_cmp_eq_u32 vcc, -1, v18
    v_smfmac_f32_16x16x64_bf16 v[48:51], v[36:39], a[88:95], v2
    v_smfmac_f32_16x16x64_bf16 v[52:55], v[36:39], a[120:127], v2
    s_cbranch_vccnz .nk_240
.ok_241:
    v_smfmac_f32_16x16x64_bf16 v[40:43], v[28:31], a[8:15], v2
    v_smfmac_f32_16x16x64_bf16 v[44:47], v[28:31], a[40:47], v2
    s_waitcnt vmcnt(0)
    v_max_u32 v18, v33, v35
    v_cmp_eq_u32 vcc, -1, v18
    v_smfmac_f32_16x16x64_bf16 v[48:51], v[28:31], a[72:79], v2
    v_smfmac_f32_16x16x64_bf16 v[52:55], v[28:31], a[104:111], v2
    s_cbranch_vccnz .nk_224
    s_branch .ok_225
.nk_218:
    buffer_load_dwordx4 v[36:39], v3, s[8:11], s30 offen offset:3072 sc1
    s_add_u32 s62, s62, 1
    s_cmp_gt_u32 s62, 0x100000
    s_cbranch_scc1 .mg_end_1
    s_waitcnt vmcnt(1)
    v_max_u32 v18, v29, v31
    v_cmp_eq_u32 vcc, -1, v18
    s_cbranch_vccnz .nk_242
.ok_243:
    v_smfmac_f32_16x16x64_bf16 v[40:43], v[28:31], a[8:15], v2
    v_smfmac_f32_16x16x64_bf16 v[44:47], v[28:31], a[40:47], v2
    s_waitcnt vmcnt(0)
    v_max_u32 v18, v37, v39
    v_cmp_eq_u32 vcc, -1, v18
    v_smfmac_f32_16x16x64_bf16 v[48:51], v[28:31], a[72:79], v2
    v_smfmac_f32_16x16x64_bf16 v[52:55], v[28:31], a[104:111], v2
    s_cbranch_vccnz .nk_206
    s_branch .ok_207
.nk_220:
    buffer_load_dwordx4 v[28:31], v3, s[8:11], s30 offen offset:1024 sc1
    s_add_u32 s62, s62, 1
    s_cmp_gt_u32 s62, 0x100000
    s_cbranch_scc1 .mg_end_1
    s_waitcnt vmcnt(0)
    v_max_u32 v18, v29, v31
    v_cmp_eq_u32 vcc, -1, v18
    s_cbranch_vccnz .nk_220
    s_branch .ok_221
.nk_222:
    buffer_load_dwordx4 v[36:39], v3, s[8:11], s30 offen offset:3072 sc1
    s_add_u32 s62, s62, 1
    s_cmp_gt_u32 s62, 0x100000
    s_cbranch_scc1 .mg_end_1
    s_waitcnt vmcnt(1)
    v_max_u32 v18, v33, v35
    v_cmp_eq_u32 vcc, -1, v18
    s_cbranch_vccnz .nk_204
    s_branch .ok_205
.nk_224:
    buffer_load_dwordx4 v[32:35], v3, s[8:11], s30 offen offset:2048 sc1
    s_add_u32 s62, s62, 1
    s_cmp_gt_u32 s62, 0x100000
    s_cbranch_scc1 .mg_end_1
    s_waitcnt vmcnt(0)
    v_max_u32 v18, v33, v35
    v_cmp_eq_u32 vcc, -1, v18
    s_cbranch_vccnz .nk_224
    s_branch .ok_225
.nk_226:
    buffer_load_dwordx4 v[32:35], v3, s[8:11], s30 offen offset:2048 sc1
    s_add_u32 s62, s62, 1
    s_cmp_gt_u32 s62, 0x100000
    s_cbranch_scc1 .mg_end_1
    s_waitcnt vmcnt(3)
    v_max_u32 v18, v37, v39
    v_cmp_eq_u32 vcc, -1, v18
    s_cbranch_vccnz .nk_244
.ok_245:
    v_smfmac_f32_16x16x64_bf16 v[40:43], v[36:39], a[24:31], v2
    v_smfmac_f32_16x16x64_bf16 v[44:47], v[36:39], a[56:63], v2
    s_waitcnt vmcnt(2)
    v_max_u32 v18, v25, v27
    v_cmp_eq_u32 vcc, -1, v18
    v_smfmac_f32_16x16x64_bf16 v[48:51], v[36:39], a[88:95], v2
    v_smfmac_f32_16x16x64_bf16 v[52:55], v[36:39], a[120:127], v2
    s_cbranch_vccnz .nk_246
.ok_247:
    v_smfmac_f32_16x16x64_bf16 v[40:43], v[24:27], a[0:7], v2
    v_smfmac_f32_16x16x64_bf16 v[44:47], v[24:27], a[32:39], v2
    s_waitcnt vmcnt(1)
    v_max_u32 v18, v29, v31
    v_cmp_eq_u32 vcc, -1, v18
    v_smfmac_f32_16x16x64_bf16 v[48:51], v[24:27], a[64:71], v2
    v_smfmac_f32_16x16x64_bf16 v[52:55], v[24:27], a[96:103], v2
    s_cbranch_vccnz .nk_240
    s_branch .ok_241
.nk_228:
    buffer_load_dwordx4 v[36:39], v3, s[8:11], s30 offen offset:3072 sc1
    s_add_u32 s62, s62, 1
    s_cmp_gt_u32 s62, 0x100000
    s_cbranch_scc1 .mg_end_1
    s_waitcnt vmcnt(2)
    v_max_u32 v18, v25, v27
    v_cmp_eq_u32 vcc, -1, v18
    s_cbranch_vccnz .nk_248
.ok_249:
    v_smfmac_f32_16x16x64_bf16 v[40:43], v[24:27], a[0:7], v2
    v_smfmac_f32_16x16x64_bf16 v[44:47], v[24:27], a[32:39], v2
    s_waitcnt vmcnt(1)
    v_max_u32 v18, v29, v31
    v_cmp_eq_u32 vcc, -1, v18
    v_smfmac_f32_16x16x64_bf16 v[48:51], v[24:27], a[64:71], v2
    v_smfmac_f32_16x16x64_bf16 v[52:55], v[24:27], a[96:103], v2
    s_cbranch_vccnz .nk_242
    s_branch .ok_243
.nk_230:
    buffer_load_dwordx4 v[24:27], v3, s[8:11], s30 offen offset:0 sc1
    s_add_u32 s62, s62, 1
    s_cmp_gt_u32 s62, 0x100000
    s_cbranch_scc1 .mg_end_1
    s_waitcnt vmcnt(1)
    v_max_u32 v18, v29, v31
    v_cmp_eq_u32 vcc, -1, v18
    s_cbranch_vccnz .nk_250
.ok_251:
    v_smfmac_f32_16x16x64_bf16 v[40:43], v[28:31], a[8:15], v2
    v_smfmac_f32_16x16x64_bf16 v[44:47], v[28:31], a[40:47], v2
    s_waitcnt vmcnt(0)
    v_max_u32 v18, v25, v27
    v_cmp_eq_u32 vcc, -1, v18
    v_smfmac_f32_16x16x64_bf16 v[48:51], v[28:31], a[72:79], v2
    v_smfmac_f32_16x16x64_bf16 v[52:55], v[28:31], a[104:111], v2
    s_cbranch_vccnz .nk_214
    s_branch .ok_215
.nk_232:
    buffer_load_dwordx4 v[36:39], v3, s[8:11], s30 offen offset:3072 sc1
    s_add_u32 s62, s62, 1
    s_cmp_gt_u32 s62, 0x100000
    s_cbranch_scc1 .mg_end_1
    s_waitcnt vmcnt(2)
    v_max_u32 v18, v25, v27
    v_cmp_eq_u32 vcc, -1, v18
    s_cbranch_vccnz .nk_252
.ok_253:
    v_smfmac_f32_16x16x64_bf16 v[40:43], v[24:27], a[0:7], v2
    v_smfmac_f32_16x16x64_bf16 v[44:47], v[24:27], a[32:39], v2
    s_waitcnt vmcnt(1)
    v_max_u32 v18, v33, v35
    v_cmp_eq_u32 vcc, -1, v18
    v_smfmac_f32_16x16x64_bf16 v[48:51], v[24:27], a[64:71], v2
    v_smfmac_f32_16x16x64_bf16 v[52:55], v[24:27], a[96:103], v2
    s_cbranch_vccnz .nk_204
    s_branch .ok_205
.nk_234:
    buffer_load_dwordx4 v[24:27], v3, s[8:11], s30 offen offset:0 sc1
    s_add_u32 s62, s62, 1
    s_cmp_gt_u32 s62, 0x100000
    s_cbranch_scc1 .mg_end_1
    s_waitcnt vmcnt(1)
    v_max_u32 v18, v33, v35
    v_cmp_eq_u32 vcc, -1, v18
    s_cbranch_vccnz .nk_254
.ok_255:
    v_smfmac_f32_16x16x64_bf16 v[40:43], v[32:35], a[16:23], v2
    v_smfmac_f32_16x16x64_bf16 v[44:47], v[32:35], a[48:55], v2
    s_waitcnt vmcnt(0)
    v_max_u32 v18, v25, v27
    v_cmp_eq_u32 vcc, -1, v18
    v_smfmac_f32_16x16x64_bf16 v[48:51], v[32:35], a[80:87], v2
    v_smfmac_f32_16x16x64_bf16 v[52:55], v[32:35], a[112:119], v2
    s_cbranch_vccnz .nk_214
    s_branch .ok_215
.nk_236:
    buffer_load_dwordx4 v[24:27], v3, s[8:11], s30 offen offset:0 sc1
    s_add_u32 s62, s62, 1
    s_cmp_gt_u32 s62, 0x100000
    s_cbranch_scc1 .mg_end_1
    s_waitcnt vmcnt(1)
    v_max_u32 v18, v37, v39
    v_cmp_eq_u32 vcc, -1, v18
    s_cbranch_vccnz .nk_212
    s_branch .ok_213
.nk_238:
    buffer_load_dwordx4 v[36:39], v3, s[8:11], s30 offen offset:3072 sc1
    s_add_u32 s62, s62, 1
    s_cmp_gt_u32 s62, 0x100000
    s_cbranch_scc1 .mg_end_1
    s_waitcnt vmcnt(2)
    v_max_u32 v18, v29, v31
    v_cmp_eq_u32 vcc, -1, v18
    s_cbranch_vccnz .nk_202
    s_branch .ok_203
.nk_240:
    buffer_load_dwordx4 v[28:31], v3, s[8:11], s30 offen offset:1024 sc1
    s_add_u32 s62, s62, 1
    s_cmp_gt_u32 s62, 0x100000
    s_cbranch_scc1 .mg_end_1
    s_waitcnt vmcnt(1)
    v_max_u32 v18, v33, v35
    v_cmp_eq_u32 vcc, -1, v18
    s_cbranch_vccnz .nk_256
.ok_257:
    v_smfmac_f32_16x16x64_bf16 v[40:43], v[32:35], a[16:23], v2
    v_smfmac_f32_16x16x64_bf16 v[44:47], v[32:35], a[48:55], v2
    s_waitcnt vmcnt(0)
    v_max_u32 v18, v29, v31
    v_cmp_eq_u32 vcc, -1, v18
    v_smfmac_f32_16x16x64_bf16 v[48:51], v[32:35], a[80:87], v2
    v_smfmac_f32_16x16x64_bf16 v[52:55], v[32:35], a[112:119], v2
    s_cbranch_vccnz .nk_220
    s_branch .ok_221
.nk_242:
    buffer_load_dwordx4 v[28:31], v3, s[8:11], s30 offen offset:1024 sc1
    s_add_u32 s62, s62, 1
    s_cmp_gt_u32 s62, 0x100000
    s_cbranch_scc1 .mg_end_1
    s_waitcnt vmcnt(1)
    v_max_u32 v18, v37, v39
    v_cmp_eq_u32 vcc, -1, v18
    s_cbranch_vccnz .nk_218
    s_branch .ok_219
.nk_244:
    buffer_load_dwordx4 v[36:39], v3, s[8:11], s30 offen offset:3072 sc1
    s_add_u32 s62, s62, 1
    s_cmp_gt_u32 s62, 0x100000
    s_cbranch_scc1 .mg_end_1
    s_waitcnt vmcnt(3)
    v_max_u32 v18, v25, v27
    v_cmp_eq_u32 vcc, -1, v18
    s_cbranch_vccnz .nk_200
    s_branch .ok_201
.nk_246:
    buffer_load_dwordx4 v[24:27], v3, s[8:11], s30 offen offset:0 sc1
    s_add_u32 s62, s62, 1
    s_cmp_gt_u32 s62, 0x100000
    s_cbranch_scc1 .mg_end_1
    s_waitcnt vmcnt(2)
    v_max_u32 v18, v29, v31
    v_cmp_eq_u32 vcc, -1, v18
    s_cbranch_vccnz .nk_258
.ok_259:
    v_smfmac_f32_16x16x64_bf16 v[40:43], v[28:31], a[8:15], v2
    v_smfmac_f32_16x16x64_bf16 v[44:47], v[28:31], a[40:47], v2
    s_waitcnt vmcnt(1)
    v_max_u32 v18, v33, v35
    v_cmp_eq_u32 vcc, -1, v18
    v_smfmac_f32_16x16x64_bf16 v[48:51], v[28:31], a[72:79], v2
    v_smfmac_f32_16x16x64_bf16 v[52:55], v[28:31], a[104:111], v2
    s_cbranch_vccnz .nk_254
    s_branch .ok_255
.nk_248:
    buffer_load_dwordx4 v[24:27], v3, s[8:11], s30 offen offset:0 sc1
    s_add_u32 s62, s62, 1
    s_cmp_gt_u32 s62, 0x100000
    s_cbranch_scc1 .mg_end_1
    s_waitcnt vmcnt(2)
    v_max_u32 v18, v29, v31
    v_cmp_eq_u32 vcc, -1, v18
    s_cbranch_vccnz .nk_260
.ok_261:
    v_smfmac_f32_16x16x64_bf16 v[40:43], v[28:31], a[8:15], v2
    v_smfmac_f32_16x16x64_bf16 v[44:47], v[28:31], a[40:47], v2
    s_waitcnt vmcnt(1)
    v_max_u32 v18, v37, v39
    v_cmp_eq_u32 vcc, -1, v18
    v_smfmac_f32_16x16x64_bf16 v[48:51], v[28:31], a[72:79], v2
    v_smfmac_f32_16x16x64_bf16 v[52:55], v[28:31], a[104:111], v2
    s_cbranch_vccnz .nk_212
    s_branch .ok_213
.nk_250:
    buffer_load_dwordx4 v[28:31], v3, s[8:11], s30 offen offset:1024 sc1
    s_add_u32 s62, s62, 1
    s_cmp_gt_u32 s62, 0x100000
    s_cbranch_scc1 .mg_end_1
    s_waitcnt vmcnt(1)
    v_max_u32 v18, v25, v27
    v_cmp_eq_u32 vcc, -1, v18
    s_cbranch_vccnz .nk_230
    s_branch .ok_231
.nk_252:
    buffer_load_dwordx4 v[24:27], v3, s[8:11], s30 offen offset:0 sc1
    s_add_u32 s62, s62, 1
    s_cmp_gt_u32 s62, 0x100000
    s_cbranch_scc1 .mg_end_1
    s_waitcnt vmcnt(2)
    v_max_u32 v18, v33, v35
    v_cmp_eq_u32 vcc, -1, v18
    s_cbranch_vccnz .nk_210
    s_branch .ok_211
.nk_254:
    buffer_load_dwordx4 v[32:35], v3, s[8:11], s30 offen offset:2048 sc1
    s_add_u32 s62, s62, 1
    s_cmp_gt_u32 s62, 0x100000
    s_cbranch_scc1 .mg_end_1
    s_waitcnt vmcnt(1)
    v_max_u32 v18, v25, v27
    v_cmp_eq_u32 vcc, -1, v18
    s_cbranch_vccnz .nk_234
    s_branch .ok_235
.nk_256:
    buffer_load_dwordx4 v[32:35], v3, s[8:11], s30 offen offset:2048 sc1
    s_add_u32 s62, s62, 1
    s_cmp_gt_u32 s62, 0x100000
    s_cbranch_scc1 .mg_end_1
    s_waitcnt vmcnt(1)
    v_max_u32 v18, v29, v31
    v_cmp_eq_u32 vcc, -1, v18
    s_cbranch_vccnz .nk_240
    s_branch .ok_241
.nk_258:
    buffer_load_dwordx4 v[28:31], v3, s[8:11], s30 offen offset:1024 sc1
    s_add_u32 s62, s62, 1
    s_cmp_gt_u32 s62, 0x100000
    s_cbranch_scc1 .mg_end_1
    s_waitcnt vmcnt(2)
    v_max_u32 v18, v33, v35
    v_cmp_eq_u32 vcc, -1, v18
    s_cbranch_vccnz .nk_262
.ok_263:
    v_smfmac_f32_16x16x64_bf16 v[40:43], v[32:35], a[16:23], v2
    v_smfmac_f32_16x16x64_bf16 v[44:47], v[32:35], a[48:55], v2
    s_waitcnt vmcnt(1)
    v_max_u32 v18, v25, v27
    v_cmp_eq_u32 vcc, -1, v18
    v_smfmac_f32_16x16x64_bf16 v[48:51], v[32:35], a[80:87], v2
    v_smfmac_f32_16x16x64_bf16 v[52:55], v[32:35], a[112:119], v2
    s_cbranch_vccnz .nk_230
    s_branch .ok_231
.nk_260:
    buffer_load_dwordx4 v[28:31], v3, s[8:11], s30 offen offset:1024 sc1
    s_add_u32 s62, s62, 1
    s_cmp_gt_u32 s62, 0x100000
    s_cbranch_scc1 .mg_end_1
    s_waitcnt vmcnt(2)
    v_max_u32 v18, v37, v39
    v_cmp_eq_u32 vcc, -1, v18
    s_cbranch_vccnz .nk_228
    s_branch .ok_229
.nk_262:
    buffer_load_dwordx4 v[32:35], v3, s[8:11], s30 offen offset:2048 sc1
    s_add_u32 s62, s62, 1
    s_cmp_gt_u32 s62, 0x100000
    s_cbranch_scc1 .mg_end_1
    s_waitcnt vmcnt(2)
    v_max_u32 v18, v25, v27
    v_cmp_eq_u32 vcc, -1, v18
    s_cbranch_vccnz .nk_246
    s_branch .ok_247
.p2align 6
.gm_178:
    s_waitcnt vmcnt(3)
    v_cmp_eq_u32 vcc, -1, v27
    s_cbranch_vccnz .nk_264
.ok_265:
    v_smfmac_f32_16x16x64_bf16 v[64:67], v[24:27], a[192:199], v2
    s_waitcnt vmcnt(2)
    v_cmp_eq_u32 vcc, -1, v31
    v_smfmac_f32_16x16x64_bf16 v[68:71], v[24:27], a[224:231], v2
    s_cbranch_vccnz .nk_266
.ok_267:
    v_smfmac_f32_16x16x64_bf16 v[64:67], v[28:31], a[200:207], v2
    s_waitcnt vmcnt(1)
    v_cmp_eq_u32 vcc, -1, v35
    v_smfmac_f32_16x16x64_bf16 v[68:71], v[28:31], a[232:239], v2
    s_cbranch_vccnz .nk_268
.ok_269:
    v_smfmac_f32_16x16x64_bf16 v[64:67], v[32:35], a[208:215], v2
    s_waitcnt vmcnt(0)
    v_cmp_eq_u32 vcc, -1, v39
    v_smfmac_f32_16x16x64_bf16 v[68:71], v[32:35], a[240:247], v2
    s_cbranch_vccnz .nk_270
.ok_271:
    v_smfmac_f32_16x16x64_bf16 v[64:67], v[36:39], a[216:223], v2
    v_smfmac_f32_16x16x64_bf16 v[68:71], v[36:39], a[248:255], v2
    s_setpc_b64 s[98:99]
.nk_264:
    buffer_load_dwordx4 v[24:27], v4, s[8:11], s30 offen offset:0 sc1
    s_add_u32 s62, s62, 1
    s_cmp_gt_u32 s62, 0x100000
    s_cbranch_scc1 .mg_end_1
    s_waitcnt vmcnt(3)
    v_cmp_eq_u32 vcc, -1, v31
    s_cbranch_vccnz .nk_272
.ok_273:
    v_smfmac_f32_16x16x64_bf16 v[64:67], v[28:31], a[200:207], v2
    s_waitcnt vmcnt(2)
    v_cmp_eq_u32 vcc, -1, v35
    v_smfmac_f32_16x16x64_bf16 v[68:71], v[28:31], a[232:239], v2
    s_cbranch_vccnz .nk_274
.ok_275:
    v_smfmac_f32_16x16x64_bf16 v[64:67], v[32:35], a[208:215], v2
    s_waitcnt vmcnt(1)
    v_cmp_eq_u32 vcc, -1, v39
    v_smfmac_f32_16x16x64_bf16 v[68:71], v[32:35], a[240:247], v2
    s_cbranch_vccnz .nk_276
.ok_277:
    v_smfmac_f32_16x16x64_bf16 v[64:67], v[36:39], a[216:223], v2
    s_waitcnt vmcnt(0)
    v_cmp_eq_u32 vcc, -1, v27
    v_smfmac_f32_16x16x64_bf16 v[68:71], v[36:39], a[248:255], v2
    s_cbranch_vccnz .nk_278
.ok_279:
    v_smfmac_f32_16x16x64_bf16 v[64:67], v[24:27], a[192:199], v2
    v_smfmac_f32_16x16x64_bf16 v[68:71], v[24:27], a[224:231], v2
    s_setpc_b64 s[98:99]
.nk_266:
    buffer_load_dwordx4 v[28:31], v4, s[8:11], s30 offen offset:1024 sc1
    s_add_u32 s62, s62, 1
    s_cmp_gt_u32 s62, 0x100000
    s_cbranch_scc1 .mg_end_1
    s_waitcnt vmcnt(2)
    v_cmp_eq_u32 vcc, -1, v35
    s_cbranch_vccnz .nk_280
.ok_281:
    v_smfmac_f32_16x16x64_bf16 v[64:67], v[32:35], a[208:215], v2
    s_waitcnt vmcnt(1)
    v_cmp_eq_u32 vcc, -1, v39
    v_smfmac_f32_16x16x64_bf16 v[68:71], v[32:35], a[240:247], v2
    s_cbranch_vccnz .nk_282
.ok_283:
    v_smfmac_f32_16x16x64_bf16 v[64:67], v[36:39], a[216:223], v2
    s_waitcnt vmcnt(0)
    v_cmp_eq_u32 vcc, -1, v31
    v_smfmac_f32_16x16x64_bf16 v[68:71], v[36:39], a[248:255], v2
    s_cbranch_vccnz .nk_284
.ok_285:
    v_smfmac_f32_16x16x64_bf16 v[64:67], v[28:31], a[200:207], v2
    v_smfmac_f32_16x16x64_bf16 v[68:71], v[28:31], a[232:239], v2
    s_setpc_b64 s[98:99]
.nk_268:
    buffer_load_dwordx4 v[32:35], v4, s[8:11], s30 offen offset:2048 sc1
    s_add_u32 s62, s62, 1
    s_cmp_gt_u32 s62, 0x100000
    s_cbranch_scc1 .mg_end_1
    s_waitcnt vmcnt(1)
    v_cmp_eq_u32 vcc, -1, v39
    s_cbranch_vccnz .nk_286
.ok_287:
    v_smfmac_f32_16x16x64_bf16 v[64:67], v[36:39], a[216:223], v2
    s_waitcnt vmcnt(0)
    v_cmp_eq_u32 vcc, -1, v35
    v_smfmac_f32_16x16x64_bf16 v[68:71], v[36:39], a[248:255], v2
    s_cbranch_vccnz .nk_288
.ok_289:
    v_smfmac_f32_16x16x64_bf16 v[64:67], v[32:35], a[208:215], v2
    v_smfmac_f32_16x16x64_bf16 v[68:71], v[32:35], a[240:247], v2
    s_setpc_b64 s[98:99]
.nk_270:
    buffer_load_dwordx4 v[36:39], v4, s[8:11], s30 offen offset:3072 sc1
    s_add_u32 s62, s62, 1
    s_cmp_gt_u32 s62, 0x100000
    s_cbranch_scc1 .mg_end_1
    s_waitcnt vmcnt(0)
    v_cmp_eq_u32 vcc, -1, v39
    s_cbranch_vccnz .nk_270
    s_branch .ok_271
.nk_272:
    buffer_load_dwordx4 v[28:31], v4, s[8:11], s30 offen offset:1024 sc1
    s_add_u32 s62, s62, 1
    s_cmp_gt_u32 s62, 0x100000
    s_cbranch_scc1 .mg_end_1
    s_waitcnt vmcnt(3)
    v_cmp_eq_u32 vcc, -1, v35
    s_cbranch_vccnz .nk_290
.ok_291:
    v_smfmac_f32_16x16x64_bf16 v[64:67], v[32:35], a[208:215], v2
    s_waitcnt vmcnt(2)
    v_cmp_eq_u32 vcc, -1, v39
    v_smfmac_f32_16x16x64_bf16 v[68:71], v[32:35], a[240:247], v2
    s_cbranch_vccnz .nk_292
.ok_293:
    v_smfmac_f32_16x16x64_bf16 v[64:67], v[36:39], a[216:223], v2
    s_waitcnt vmcnt(1)
    v_cmp_eq_u32 vcc, -1, v27
    v_smfmac_f32_16x16x64_bf16 v[68:71], v[36:39], a[248:255], v2
    s_cbranch_vccnz .nk_294
.ok_295:
    v_smfmac_f32_16x16x64_bf16 v[64:67], v[24:27], a[192:199], v2
    s_waitcnt vmcnt(0)
    v_cmp_eq_u32 vcc, -1, v31
    v_smfmac_f32_16x16x64_bf16 v[68:71], v[24:27], a[224:231], v2
    s_cbranch_vccnz .nk_284
    s_branch .ok_285
.nk_274:
    buffer_load_dwordx4 v[32:35], v4, s[8:11], s30 offen offset:2048 sc1
    s_add_u32 s62, s62, 1
    s_cmp_gt_u32 s62, 0x100000
    s_cbranch_scc1 .mg_end_1
    s_waitcnt vmcnt(2)
    v_cmp_eq_u32 vcc, -1, v39
    s_cbranch_vccnz .nk_296
.ok_297:
    v_smfmac_f32_16x16x64_bf16 v[64:67], v[36:39], a[216:223], v2
    s_waitcnt vmcnt(1)
    v_cmp_eq_u32 vcc, -1, v27
    v_smfmac_f32_16x16x64_bf16 v[68:71], v[36:39], a[248:255], v2
    s_cbranch_vccnz .nk_298
.ok_299:
    v_smfmac_f32_16x16x64_bf16 v[64:67], v[24:27], a[192:199], v2
    s_waitcnt vmcnt(0)
    v_cmp_eq_u32 vcc, -1, v35
    v_smfmac_f32_16x16x64_bf16 v[68:71], v[24:27], a[224:231], v2
    s_cbranch_vccnz .nk_288
    s_branch .ok_289
.nk_276:
    buffer_load_dwordx4 v[36:39], v4, s[8:11], s30 offen offset:3072 sc1
    s_add_u32 s62, s62, 1
    s_cmp_gt_u32 s62, 0x100000
    s_cbranch_scc1 .mg_end_1
    s_waitcnt vmcnt(1)
    v_cmp_eq_u32 vcc, -1, v27
    s_cbranch_vccnz .nk_300
.ok_301:
    v_smfmac_f32_16x16x64_bf16 v[64:67], v[24:27], a[192:199], v2
    s_waitcnt vmcnt(0)
    v_cmp_eq_u32 vcc, -1, v39
    v_smfmac_f32_16x16x64_bf16 v[68:71], v[24:27], a[224:231], v2
    s_cbranch_vccnz .nk_270
    s_branch .ok_271
.nk_278:
    buffer_load_dwordx4 v[24:27], v4, s[8:11], s30 offen offset:0 sc1
    s_add_u32 s62, s62, 1
    s_cmp_gt_u32 s62, 0x100000
    s_cbranch_scc1 .mg_end_1
    s_waitcnt vmcnt(0)
    v_cmp_eq_u32 vcc, -1, v27
    s_cbranch_vccnz .nk_278
    s_branch .ok_279
.nk_280:
    buffer_load_dwordx4 v[32:35], v4, s[8:11], s30 offen offset:2048 sc1
    s_add_u32 s62, s62, 1
    s_cmp_gt_u32 s62, 0x100000
    s_cbranch_scc1 .mg_end_1
    s_waitcnt vmcnt(2)
    v_cmp_eq_u32 vcc, -1, v39
    s_cbranch_vccnz .nk_302
.ok_303:
    v_smfmac_f32_16x16x64_bf16 v[64:67], v[36:39], a[216:223], v2
    s_waitcnt vmcnt(1)
    v_cmp_eq_u32 vcc, -1, v31
    v_smfmac_f32_16x16x64_bf16 v[68:71], v[36:39], a[248:255], v2
    s_cbranch_vccnz .nk_304
.ok_305:
    v_smfmac_f32_16x16x64_bf16 v[64:67], v[28:31], a[200:207], v2
    s_waitcnt vmcnt(0)
    v_cmp_eq_u32 vcc, -1, v35
    v_smfmac_f32_16x16x64_bf16 v[68:71], v[28:31], a[232:239], v2
    s_cbranch_vccnz .nk_288
    s_branch .ok_289
.nk_282:
    buffer_load_dwordx4 v[36:39], v4, s[8:11], s30 offen offset:3072 sc1
    s_add_u32 s62, s62, 1
    s_cmp_gt_u32 s62, 0x100000
    s_cbranch_scc1 .mg_end_1
    s_waitcnt vmcnt(1)
    v_cmp_eq_u32 vcc, -1, v31
    s_cbranch_vccnz .nk_306
.ok_307:
    v_smfmac_f32_16x16x64_bf16 v[64:67], v[28:31], a[200:207], v2
    s_waitcnt vmcnt(0)
    v_cmp_eq_u32 vcc, -1, v39
    v_smfmac_f32_16x16x64_bf16 v[68:71], v[28:31], a[232:239], v2
    s_cbranch_vccnz .nk_270
    s_branch .ok_271
.nk_284:
    buffer_load_dwordx4 v[28:31], v4, s[8:11], s30 offen offset:1024 sc1
    s_add_u32 s62, s62, 1
    s_cmp_gt_u32 s62, 0x100000
    s_cbranch_scc1 .mg_end_1
    s_waitcnt vmcnt(0)
    v_cmp_eq_u32 vcc, -1, v31
    s_cbranch_vccnz .nk_284
    s_branch .ok_285
.nk_286:
    buffer_load_dwordx4 v[36:39], v4, s[8:11], s30 offen offset:3072 sc1
    s_add_u32 s62, s62, 1
    s_cmp_gt_u32 s62, 0x100000
    s_cbranch_scc1 .mg_end_1
    s_waitcnt vmcnt(1)
    v_cmp_eq_u32 vcc, -1, v35
    s_cbranch_vccnz .nk_268
    s_branch .ok_269
.nk_288:
    buffer_load_dwordx4 v[32:35], v4, s[8:11], s30 offen offset:2048 sc1
    s_add_u32 s62, s62, 1
    s_cmp_gt_u32 s62, 0x100000
    s_cbranch_scc1 .mg_end_1
    s_waitcnt vmcnt(0)
    v_cmp_eq_u32 vcc, -1, v35
    s_cbranch_vccnz .nk_288
    s_branch .ok_289
.nk_290:
    buffer_load_dwordx4 v[32:35], v4, s[8:11], s30 offen offset:2048 sc1
    s_add_u32 s62, s62, 1
    s_cmp_gt_u32 s62, 0x100000
    s_cbranch_scc1 .mg_end_1
    s_waitcnt vmcnt(3)
    v_cmp_eq_u32 vcc, -1, v39
    s_cbranch_vccnz .nk_308
.ok_309:
    v_smfmac_f32_16x16x64_bf16 v[64:67], v[36:39], a[216:223], v2
    s_waitcnt vmcnt(2)
    v_cmp_eq_u32 vcc, -1, v27
    v_smfmac_f32_16x16x64_bf16 v[68:71], v[36:39], a[248:255], v2
    s_cbranch_vccnz .nk_310
.ok_311:
    v_smfmac_f32_16x16x64_bf16 v[64:67], v[24:27], a[192:199], v2
    s_waitcnt vmcnt(1)
    v_cmp_eq_u32 vcc, -1, v31
    v_smfmac_f32_16x16x64_bf16 v[68:71], v[24:27], a[224:231], v2
    s_cbranch_vccnz .nk_304
    s_branch .ok_305
.nk_292:
    buffer_load_dwordx4 v[36:39], v4, s[8:11], s30 offen offset:3072 sc1
    s_add_u32 s62, s62, 1
    s_cmp_gt_u32 s62, 0x100000
    s_cbranch_scc1 .mg_end_1
    s_waitcnt vmcnt(2)
    v_cmp_eq_u32 vcc, -1, v27
    s_cbranch_vccnz .nk_312
.ok_313:
    v_smfmac_f32_16x16x64_bf16 v[64:67], v[24:27], a[192:199], v2
    s_waitcnt vmcnt(1)
    v_cmp_eq_u32 vcc, -1, v31
    v_smfmac_f32_16x16x64_bf16 v[68:71], v[24:27], a[224:231], v2
    s_cbranch_vccnz .nk_306
    s_branch .ok_307
.nk_294:
    buffer_load_dwordx4 v[24:27], v4, s[8:11], s30 offen offset:0 sc1
    s_add_u32 s62, s62, 1
    s_cmp_gt_u32 s62, 0x100000
    s_cbranch_scc1 .mg_end_1
    s_waitcnt vmcnt(1)
    v_cmp_eq_u32 vcc, -1, v31
    s_cbranch_vccnz .nk_314
.ok_315:
    v_smfmac_f32_16x16x64_bf16 v[64:67], v[28:31], a[200:207], v2
    s_waitcnt vmcnt(0)
    v_cmp_eq_u32 vcc, -1, v27
    v_smfmac_f32_16x16x64_bf16 v[68:71], v[28:31], a[232:239], v2
    s_cbranch_vccnz .nk_278
    s_branch .ok_279
.nk_296:
    buffer_load_dwordx4 v[36:39], v4, s[8:11], s30 offen offset:3072 sc1
    s_add_u32 s62, s62, 1
    s_cmp_gt_u32 s62, 0x100000
    s_cbranch_scc1 .mg_end_1
    s_waitcnt vmcnt(2)
    v_cmp_eq_u32 vcc, -1, v27
    s_cbranch_vccnz .nk_316
.ok_317:
    v_smfmac_f32_16x16x64_bf16 v[64:67], v[24:27], a[192:199], v2
    s_waitcnt vmcnt(1)
    v_cmp_eq_u32 vcc, -1, v35
    v_smfmac_f32_16x16x64_bf16 v[68:71], v[24:27], a[224:231], v2
    s_cbranch_vccnz .nk_268
    s_branch .ok_269
.nk_298:
    buffer_load_dwordx4 v[24:27], v4, s[8:11], s30 offen offset:0 sc1
    s_add_u32 s62, s62, 1
    s_cmp_gt_u32 s62, 0x100000
    s_cbranch_scc1 .mg_end_1
    s_waitcnt vmcnt(1)
    v_cmp_eq_u32 vcc, -1, v35
    s_cbranch_vccnz .nk_318
.ok_319:
    v_smfmac_f32_16x16x64_bf16 v[64:67], v[32:35], a[208:215], v2
    s_waitcnt vmcnt(0)
    v_cmp_eq_u32 vcc, -1, v27
    v_smfmac_f32_16x16x64_bf16 v[68:71], v[32:35], a[240:247], v2
    s_cbranch_vccnz .nk_278
    s_branch .ok_279
.nk_300:
    buffer_load_dwordx4 v[24:27], v4, s[8:11], s30 offen offset:0 sc1
    s_add_u32 s62, s62, 1
    s_cmp_gt_u32 s62, 0x100000
    s_cbranch_scc1 .mg_end_1
    s_waitcnt vmcnt(1)
    v_cmp_eq_u32 vcc, -1, v39
    s_cbranch_vccnz .nk_276
    s_branch .ok_277
.nk_302:
    buffer_load_dwordx4 v[36:39], v4, s[8:11], s30 offen offset:3072 sc1
    s_add_u32 s62, s62, 1
    s_cmp_gt_u32 s62, 0x100000
    s_cbranch_scc1 .mg_end_1
    s_waitcnt vmcnt(2)
    v_cmp_eq_u32 vcc, -1, v31
    s_cbranch_vccnz .nk_266
    s_branch .ok_267
.nk_304:
    buffer_load_dwordx4 v[28:31], v4, s[8:11], s30 offen offset:1024 sc1
    s_add_u32 s62, s62, 1
    s_cmp_gt_u32 s62, 0x100000
    s_cbranch_scc1 .mg_end_1
    s_waitcnt vmcnt(1)
    v_cmp_eq_u32 vcc, -1, v35
    s_cbranch_vccnz .nk_320
.ok_321:
    v_smfmac_f32_16x16x64_bf16 v[64:67], v[32:35], a[208:215], v2
    s_waitcnt vmcnt(0)
    v_cmp_eq_u32 vcc, -1, v31
    v_smfmac_f32_16x16x64_bf16 v[68:71], v[32:35], a[240:247], v2
    s_cbranch_vccnz .nk_284
    s_branch .ok_285
.nk_306:
    buffer_load_dwordx4 v[28:31], v4, s[8:11], s30 offen offset:1024 sc1
    s_add_u32 s62, s62, 1
    s_cmp_gt_u32 s62, 0x100000
    s_cbranch_scc1 .mg_end_1
    s_waitcnt vmcnt(1)
    v_cmp_eq_u32 vcc, -1, v39
    s_cbranch_vccnz .nk_282
    s_branch .ok_283
.nk_308:
    buffer_load_dwordx4 v[36:39], v4, s[8:11], s30 offen offset:3072 sc1
    s_add_u32 s62, s62, 1
    s_cmp_gt_u32 s62, 0x100000
    s_cbranch_scc1 .mg_end_1
    s_waitcnt vmcnt(3)
    v_cmp_eq_u32 vcc, -1, v27
    s_cbranch_vccnz .nk_264
    s_branch .ok_265
.nk_310:
    buffer_load_dwordx4 v[24:27], v4, s[8:11], s30 offen offset:0 sc1
    s_add_u32 s62, s62, 1
    s_cmp_gt_u32 s62, 0x100000
    s_cbranch_scc1 .mg_end_1
    s_waitcnt vmcnt(2)
    v_cmp_eq_u32 vcc, -1, v31
    s_cbranch_vccnz .nk_322
.ok_323:
    v_smfmac_f32_16x16x64_bf16 v[64:67], v[28:31], a[200:207], v2
    s_waitcnt vmcnt(1)
    v_cmp_eq_u32 vcc, -1, v35
    v_smfmac_f32_16x16x64_bf16 v[68:71], v[28:31], a[232:239], v2
    s_cbranch_vccnz .nk_318
    s_branch .ok_319
.nk_312:
    buffer_load_dwordx4 v[24:27], v4, s[8:11], s30 offen offset:0 sc1
    s_add_u32 s62, s62, 1
    s_cmp_gt_u32 s62, 0x100000
    s_cbranch_scc1 .mg_end_1
    s_waitcnt vmcnt(2)
    v_cmp_eq_u32 vcc, -1, v31
    s_cbranch_vccnz .nk_324
.ok_325:
    v_smfmac_f32_16x16x64_bf16 v[64:67], v[28:31], a[200:207], v2
    s_waitcnt vmcnt(1)
    v_cmp_eq_u32 vcc, -1, v39
    v_smfmac_f32_16x16x64_bf16 v[68:71], v[28:31], a[232:239], v2
    s_cbranch_vccnz .nk_276
    s_branch .ok_277
.nk_314:
    buffer_load_dwordx4 v[28:31], v4, s[8:11], s30 offen offset:1024 sc1
    s_add_u32 s62, s62, 1
    s_cmp_gt_u32 s62, 0x100000
    s_cbranch_scc1 .mg_end_1
    s_waitcnt vmcnt(1)
    v_cmp_eq_u32 vcc, -1, v27
    s_cbranch_vccnz .nk_294
    s_branch .ok_295
.nk_316:
    buffer_load_dwordx4 v[24:27], v4, s[8:11], s30 offen offset:0 sc1
    s_add_u32 s62, s62, 1
    s_cmp_gt_u32 s62, 0x100000
    s_cbranch_scc1 .mg_end_1
    s_waitcnt vmcnt(2)
    v_cmp_eq_u32 vcc, -1, v35
    s_cbranch_vccnz .nk_274
    s_branch .ok_275
.nk_318:
    buffer_load_dwordx4 v[32:35], v4, s[8:11], s30 offen offset:2048 sc1
    s_add_u32 s62, s62, 1
    s_cmp_gt_u32 s62, 0x100000
    s_cbranch_scc1 .mg_end_1
    s_waitcnt vmcnt(1)
    v_cmp_eq_u32 vcc, -1, v27
    s_cbranch_vccnz .nk_298
    s_branch .ok_299
.nk_320:
    buffer_load_dwordx4 v[32:35], v4, s[8:11], s30 offen offset:2048 sc1
    s_add_u32 s62, s62, 1
    s_cmp_gt_u32 s62, 0x100000
    s_cbranch_scc1 .mg_end_1
    s_waitcnt vmcnt(1)
    v_cmp_eq_u32 vcc, -1, v31
    s_cbranch_vccnz .nk_304
    s_branch .ok_305
.nk_322:
    buffer_load_dwordx4 v[28:31], v4, s[8:11], s30 offen offset:1024 sc1
    s_add_u32 s62, s62, 1
    s_cmp_gt_u32 s62, 0x100000
    s_cbranch_scc1 .mg_end_1
    s_waitcnt vmcnt(2)
    v_cmp_eq_u32 vcc, -1, v35
    s_cbranch_vccnz .nk_326
.ok_327:
    v_smfmac_f32_16x16x64_bf16 v[64:67], v[32:35], a[208:215], v2
    s_waitcnt vmcnt(1)
    v_cmp_eq_u32 vcc, -1, v27
    v_smfmac_f32_16x16x64_bf16 v[68:71], v[32:35], a[240:247], v2
    s_cbranch_vccnz .nk_294
    s_branch .ok_295
.nk_324:
    buffer_load_dwordx4 v[28:31], v4, s[8:11], s30 offen offset:1024 sc1
    s_add_u32 s62, s62, 1
    s_cmp_gt_u32 s62, 0x100000
    s_cbranch_scc1 .mg_end_1
    s_waitcnt vmcnt(2)
    v_cmp_eq_u32 vcc, -1, v39
    s_cbranch_vccnz .nk_292
    s_branch .ok_293
.nk_326:
    buffer_load_dwordx4 v[32:35], v4, s[8:11], s30 offen offset:2048 sc1
    s_add_u32 s62, s62, 1
    s_cmp_gt_u32 s62, 0x100000
    s_cbranch_scc1 .mg_end_1
    s_waitcnt vmcnt(2)
    v_cmp_eq_u32 vcc, -1, v27
    s_cbranch_vccnz .nk_310
    s_branch .ok_311
.mg_bg_2:
    s_lshr_b32 s98, s26, 3
    s_add_u32 s98, s98, 1
    s_and_b32 s98, s98, 3
    s_and_b32 s99, s25, 3
    s_lshl_b32 s99, s99, 3
    s_and_b32 s4, s26, 7
    s_add_u32 s99, s99, s4
    s_mov_b32 s96, 0
    v_and_b32 v1, 63, v0
    v_mov_b32 v250, 0
    v_mov_b32 v251, 0
    s_bitcmp0_b32 s26, 4
    s_cbranch_scc1 .qkv_329
    s_bfe_u32 s95, s26, 0x10003
    s_load_dwordx2 s[40:41], s[0:1], 0
    s_lshl_b32 s4, s95, 3
    s_add_u32 s4, s4, 72
    s_load_dwordx2 s[42:43], s[0:1], s4
    s_lshl_b32 s4, s99, 8
    s_lshl_b32 s6, s24, 14
    s_mul_i32 s5, s24, 524288
    s_add_u32 s4, s4, s5
    v_bfe_u32 v2, v1, 4, 1
    v_lshlrev_b32 v2, 2, v2
    v_and_b32 v3, 7, v1
    v_xor_b32 v2, v2, v3
    v_lshlrev_b32 v2, 4, v2
    v_bfe_u32 v254, v1, 3, 2
    v_mul_u32_u24 v240, 8192, v254
    v_bfe_u32 v254, v1, 5, 1
    v_mul_u32_u24 v254, 128, v254
    v_add_u32 v240, v240, v254
    v_add_u32 v240, s4, v240
    v_add_u32 v240, v2, v240
    s_lshr_b32 s5, s24, 1
    s_lshl_b32 s5, s5, 9
    v_bfe_u32 v2, v1, 3, 1
    v_xor_b32 v2, s24, v2
    v_and_b32 v2, 1, v2
    v_lshlrev_b32 v2, 6, v2
    v_bfe_u32 v254, v1, 4, 2
    v_mul_u32_u24 v242, 2048, v254
    v_bfe_u32 v254, v1, 2, 2
    v_mul_u32_u24 v254, 128, v254
    v_add_u32 v242, v242, v254
    v_bfe_u32 v254, v1, 0, 2
    v_mul_u32_u24 v254, 16, v254
    v_add_u32 v242, v242, v254
    v_add_u32 v242, s5, v242
    v_add_u32 v242, v2, v242
    v_add_u32 v243, 0x10000, v242
    s_waitcnt lgkmcnt(0)
    s_mov_b32 s16, s42
    s_and_b32 s17, s43, 0xffff
    s_mov_b32 s18, 0x800000
    s_mov_b32 s19, 0x00020000
    s_add_u32 m0, s6, 0
    s_mov_b32 s5, 4194304
    buffer_load_dwordx4 v240, s[16:19], s5 offen  lds
    s_add_u32 m0, s6, 1024
    s_mov_b32 s5, 4227072
    buffer_load_dwordx4 v240, s[16:19], s5 offen  lds
    s_add_u32 m0, s6, 2048
    s_mov_b32 s5, 4259840
    buffer_load_dwordx4 v240, s[16:19], s5 offen  lds
    s_add_u32 m0, s6, 3072
    s_mov_b32 s5, 4292608
    buffer_load_dwordx4 v240, s[16:19], s5 offen  lds
    s_add_u32 m0, s6, 4096
    s_mov_b32 s5, 4325376
    buffer_load_dwordx4 v240, s[16:19], s5 offen  lds
    s_add_u32 m0, s6, 5120
    s_mov_b32 s5, 4358144
    buffer_load_dwordx4 v240, s[16:19], s5 offen  lds
    s_add_u32 m0, s6, 6144
    s_mov_b32 s5, 4390912
    buffer_load_dwordx4 v240, s[16:19], s5 offen  lds
    s_add_u32 m0, s6, 7168
    s_mov_b32 s5, 4423680
    buffer_load_dwordx4 v240, s[16:19], s5 offen  lds
    s_add_u32 m0, s6, 8192
    s_mov_b32 s5, 4456448
    buffer_load_dwordx4 v240, s[16:19], s5 offen  lds
    s_add_u32 m0, s6, 9216
    s_mov_b32 s5, 4489216
    buffer_load_dwordx4 v240, s[16:19], s5 offen  lds
    s_add_u32 m0, s6, 10240
    s_mov_b32 s5, 4521984
    buffer_load_dwordx4 v240, s[16:19], s5 offen  lds
    s_add_u32 m0, s6, 11264
    s_mov_b32 s5, 4554752
    buffer_load_dwordx4 v240, s[16:19], s5 offen  lds
    s_add_u32 m0, s6, 12288
    s_mov_b32 s5, 4587520
    buffer_load_dwordx4 v240, s[16:19], s5 offen  lds
    s_add_u32 m0, s6, 13312
    s_mov_b32 s5, 4620288
    buffer_load_dwordx4 v240, s[16:19], s5 offen  lds
    s_add_u32 m0, s6, 14336
    s_mov_b32 s5, 4653056
    buffer_load_dwordx4 v240, s[16:19], s5 offen  lds
    s_add_u32 m0, s6, 15360
    s_mov_b32 s5, 4685824
    buffer_load_dwordx4 v240, s[16:19], s5 offen  lds
    s_waitcnt vmcnt(16)
    s_barrier
    s_cmp_lg_u32 s24, 1
    s_cbranch_scc1 .ns_330
    s_mov_b64 exec, 1
    v_mov_b32 v238, s3
    v_mov_b32 v239, 0
    buffer_atomic_add v238, v239, s[20:23], 0 offen offset:196 sc1
    s_mov_b64 exec, -1
.ns_330:
    s_and_b32 s4, s26, 15
    s_lshl_b32 s4, s4, 2
    s_add_u32 s4, s4, s24
    s_lshl_b32 s5, s4, 13
    v_lshlrev_b32 v6, 7, v1
    s_waitcnt lgkmcnt(0)
    s_mov_b32 s12, s40
    s_and_b32 s13, s41, 0xffff
    s_mov_b32 s14, 0x400000
    s_mov_b32 s15, 0x00020000
    buffer_load_dword v7, v6, s[12:15], s5 offen
    s_and_b32 s5, s25, 3
    s_lshl_b32 s5, s5, 6
    s_add_u32 s4, s4, s5
    s_lshl_b32 s4, s4, 14
    s_add_u32 s4, s4, 0x80000
    v_add_u32 v6, s4, v6
    v_add_u32 v8, 0x2000, v6
    s_add_u32 m0, s6, 65536
    s_mov_b32 s5, 6291456
    buffer_load_dwordx4 v240, s[16:19], s5 offen  lds
    s_add_u32 m0, s6, 66560
    s_mov_b32 s5, 6324224
    buffer_load_dwordx4 v240, s[16:19], s5 offen  lds
    s_add_u32 m0, s6, 67584
    s_mov_b32 s5, 6356992
    buffer_load_dwordx4 v240, s[16:19], s5 offen  lds
    s_add_u32 m0, s6, 68608
    s_mov_b32 s5, 6389760
    buffer_load_dwordx4 v240, s[16:19], s5 offen  lds
    s_add_u32 m0, s6, 69632
    s_mov_b32 s5, 6422528
    buffer_load_dwordx4 v240, s[16:19], s5 offen  lds
    s_add_u32 m0, s6, 70656
    s_mov_b32 s5, 6455296
    buffer_load_dwordx4 v240, s[16:19], s5 offen  lds
    s_add_u32 m0, s6, 71680
    s_mov_b32 s5, 6488064
    buffer_load_dwordx4 v240, s[16:19], s5 offen  lds
    s_add_u32 m0, s6, 72704
    s_mov_b32 s5, 6520832
    buffer_load_dwordx4 v240, s[16:19], s5 offen  lds
    s_add_u32 m0, s6, 73728
    s_mov_b32 s5, 6553600
    buffer_load_dwordx4 v240, s[16:19], s5 offen  lds
    s_add_u32 m0, s6, 74752
    s_mov_b32 s5, 6586368
    buffer_load_dwordx4 v240, s[16:19], s5 offen  lds
    s_add_u32 m0, s6, 75776
    s_mov_b32 s5, 6619136
    buffer_load_dwordx4 v240, s[16:19], s5 offen  lds
    s_add_u32 m0, s6, 76800
    s_mov_b32 s5, 6651904
    buffer_load_dwordx4 v240, s[16:19], s5 offen  lds
    s_add_u32 m0, s6, 77824
    s_mov_b32 s5, 6684672
    buffer_load_dwordx4 v240, s[16:19], s5 offen  lds
    s_add_u32 m0, s6, 78848
    s_mov_b32 s5, 6717440
    buffer_load_dwordx4 v240, s[16:19], s5 offen  lds
    s_add_u32 m0, s6, 79872
    s_mov_b32 s5, 6750208
    buffer_load_dwordx4 v240, s[16:19], s5 offen  lds
    s_add_u32 m0, s6, 80896
    s_mov_b32 s5, 6782976
    buffer_load_dwordx4 v240, s[16:19], s5 offen  lds
    s_cmp_lg_u32 s24, 0
    s_cbranch_scc1 .aw_331
    s_mov_b32 s62, 0
.aw_332:
    s_sleep 64
    s_add_u32 s62, s62, 1
    s_cmp_gt_u32 s62, 0x200000
    s_cbranch_scc1 .mg_end_1
    v_or_b32 v239, 32, v1
    v_lshlrev_b32 v239, 2, v239
    buffer_load_dword v238, v239, s[20:23], 0 offen sc1
    s_waitcnt vmcnt(0)
    v_readlane_b32 s4, v238, 49
    s_and_b32 s5, s4, 0xffff
    s_cmp_lt_u32 s5, 256
    s_cbranch_scc1 .aw_332
    s_lshr_b32 s4, s4, 16
    s_cbranch_scc1 .aw_331
    s_and_b32 s4, s99, 30
    s_lshl_b32 s4, s4, 9
    s_lshl_b32 s5, s95, 14
    s_add_u32 s4, s4, s5
    s_and_b32 s5, s99, 1
    s_lshl_b32 s5, s5, 7
    s_add_u32 s4, s4, s5
    s_lshl_b32 s4, s99, 9
    s_add_u32 s4, s4, 92291072
    v_mov_b32 v5, 0
    s_mov_b32 s62, 0
.aw_333:
    buffer_load_dword v4, v5, s[8:11], s4 offen sc1
    s_add_u32 s62, s62, 1
    s_cmp_gt_u32 s62, 0x200000
    s_cbranch_scc1 .mg_end_1
    s_waitcnt vmcnt(0)
    v_readfirstlane_b32 s5, v4
    s_cmp_ge_u32 s5, 3
    s_cbranch_scc1 .aw_331
    s_sleep 16
    s_branch .aw_333
.aw_331:
    s_barrier
    v_or_b32 v239, 32, v1
    v_lshlrev_b32 v239, 2, v239
    buffer_load_dword v238, v239, s[20:23], 0 offen sc1
    s_waitcnt vmcnt(0)
    s_cmp_lg_u32 s27, 0
    s_cbranch_scc1 .vd_335
    s_mov_b32 s62, 0
.vp_334:
    v_readlane_b32 s4, v238, 49
    s_and_b32 s5, s4, 0xffff
    s_cmp_ge_u32 s5, 256
    s_cbranch_scc1 .va_336
    s_add_u32 s62, s62, 1
    s_cmp_gt_u32 s62, 0x100000
    s_cbranch_scc1 .mg_end_1
    s_sleep 16
    buffer_load_dword v238, v239, s[20:23], 0 offen sc1
    s_waitcnt vmcnt(0)
    s_branch .vp_334
.va_336:
    s_lshr_b32 s4, s4, 16
    s_cbranch_scc0 .vd_335
    s_lshr_b32 s25, s2, 5
    s_and_b32 s26, s2, 31
    s_mov_b32 s27, 1
    s_waitcnt vmcnt(0) lgkmcnt(0)
    s_barrier
    s_branch .mg_role_3
.vd_335:
    s_cmp_eq_u32 s98, 3
    s_cbranch_scc1 .ph2_328
.qkv_329:
    s_lshl_b32 s4, s98, 3
    s_add_u32 s4, s4, 64
    s_load_dwordx2 s[40:41], s[0:1], 0
    s_load_dwordx2 s[42:43], s[0:1], s4
    s_lshl_b32 s4, s99, 8
    s_lshl_b32 s6, s24, 14
    s_mul_i32 s5, s24, 524288
    s_add_u32 s4, s4, s5
    v_bfe_u32 v2, v1, 4, 1
    v_lshlrev_b32 v2, 2, v2
    v_and_b32 v3, 7, v1
    v_xor_b32 v2, v2, v3
    v_lshlrev_b32 v2, 4, v2
    v_bfe_u32 v254, v1, 3, 2
    v_mul_u32_u24 v240, 8192, v254
    v_bfe_u32 v254, v1, 5, 1
    v_mul_u32_u24 v254, 128, v254
    v_add_u32 v240, v240, v254
    v_add_u32 v240, s4, v240
    v_add_u32 v240, v2, v240
    s_lshr_b32 s5, s24, 1
    s_lshl_b32 s5, s5, 9
    v_bfe_u32 v2, v1, 3, 1
    v_xor_b32 v2, s24, v2
    v_and_b32 v2, 1, v2
    v_lshlrev_b32 v2, 6, v2
    v_bfe_u32 v254, v1, 4, 2
    v_mul_u32_u24 v242, 2048, v254
    v_bfe_u32 v254, v1, 2, 2
    v_mul_u32_u24 v254, 128, v254
    v_add_u32 v242, v242, v254
    v_bfe_u32 v254, v1, 0, 2
    v_mul_u32_u24 v254, 16, v254
    v_add_u32 v242, v242, v254
    v_add_u32 v242, s5, v242
    v_add_u32 v242, v2, v242
    v_add_u32 v243, 0x10000, v242
    s_waitcnt lgkmcnt(0)
    s_mov_b32 s12, s40
    s_and_b32 s13, s41, 0xffff
    s_mov_b32 s14, 0x400000
    s_mov_b32 s15, 0x00020000
    s_mov_b32 s16, s42
    s_and_b32 s17, s43, 0xffff
    s_mov_b32 s18, 0x800000
    s_mov_b32 s19, 0x00020000
    s_add_u32 m0, s6, 0
    s_mov_b32 s5, 0
    buffer_load_dwordx4 v240, s[16:19], s5 offen nt lds
    s_add_u32 m0, s6, 1024
    s_mov_b32 s5, 32768
    buffer_load_dwordx4 v240, s[16:19], s5 offen nt lds
    s_add_u32 m0, s6, 2048
    s_mov_b32 s5, 65536
    buffer_load_dwordx4 v240, s[16:19], s5 offen nt lds
    s_add_u32 m0, s6, 3072
    s_mov_b32 s5, 98304
    buffer_load_dwordx4 v240, s[16:19], s5 offen nt lds
    s_add_u32 m0, s6, 4096
    s_mov_b32 s5, 131072
    buffer_load_dwordx4 v240, s[16:19], s5 offen nt lds
    s_add_u32 m0, s6, 5120
    s_mov_b32 s5, 163840
    buffer_load_dwordx4 v240, s[16:19], s5 offen nt lds
    s_add_u32 m0, s6, 6144
    s_mov_b32 s5, 196608
    buffer_load_dwordx4 v240, s[16:19], s5 offen nt lds
    s_add_u32 m0, s6, 7168
    s_mov_b32 s5, 229376
    buffer_load_dwordx4 v240, s[16:19], s5 offen nt lds
    s_add_u32 m0, s6, 8192
    s_mov_b32 s5, 262144
    buffer_load_dwordx4 v240, s[16:19], s5 offen nt lds
    s_add_u32 m0, s6, 9216
    s_mov_b32 s5, 294912
    buffer_load_dwordx4 v240, s[16:19], s5 offen nt lds
    s_add_u32 m0, s6, 10240
    s_mov_b32 s5, 327680
    buffer_load_dwordx4 v240, s[16:19], s5 offen nt lds
    s_add_u32 m0, s6, 11264
    s_mov_b32 s5, 360448
    buffer_load_dwordx4 v240, s[16:19], s5 offen nt lds
    s_add_u32 m0, s6, 12288
    s_mov_b32 s5, 393216
    buffer_load_dwordx4 v240, s[16:19], s5 offen nt lds
    s_add_u32 m0, s6, 13312
    s_mov_b32 s5, 425984
    buffer_load_dwordx4 v240, s[16:19], s5 offen nt lds
    s_add_u32 m0, s6, 14336
    s_mov_b32 s5, 458752
    buffer_load_dwordx4 v240, s[16:19], s5 offen nt lds
    s_add_u32 m0, s6, 15360
    s_mov_b32 s5, 491520
    buffer_load_dwordx4 v240, s[16:19], s5 offen nt lds
    s_waitcnt vmcnt(16)
    s_barrier
    s_cmp_lg_u32 s24, 1
    s_cbranch_scc1 .ns_337
    s_mov_b64 exec, 1
    v_mov_b32 v238, s3
    v_mov_b32 v239, 0
    buffer_atomic_add v238, v239, s[20:23], 0 offen offset:196 sc1
    s_mov_b64 exec, -1
.ns_337:
    s_add_u32 m0, s6, 65536
    s_mov_b32 s5, 2097152
    buffer_load_dwordx4 v240, s[16:19], s5 offen nt lds
    s_add_u32 m0, s6, 66560
    s_mov_b32 s5, 2129920
    buffer_load_dwordx4 v240, s[16:19], s5 offen nt lds
    s_add_u32 m0, s6, 67584
    s_mov_b32 s5, 2162688
    buffer_load_dwordx4 v240, s[16:19], s5 offen nt lds
    s_add_u32 m0, s6, 68608
    s_mov_b32 s5, 2195456
    buffer_load_dwordx4 v240, s[16:19], s5 offen nt lds
    s_add_u32 m0, s6, 69632
    s_mov_b32 s5, 2228224
    buffer_load_dwordx4 v240, s[16:19], s5 offen nt lds
    s_add_u32 m0, s6, 70656
    s_mov_b32 s5, 2260992
    buffer_load_dwordx4 v240, s[16:19], s5 offen nt lds
    s_add_u32 m0, s6, 71680
    s_mov_b32 s5, 2293760
    buffer_load_dwordx4 v240, s[16:19], s5 offen nt lds
    s_add_u32 m0, s6, 72704
    s_mov_b32 s5, 2326528
    buffer_load_dwordx4 v240, s[16:19], s5 offen nt lds
    s_add_u32 m0, s6, 73728
    s_mov_b32 s5, 2359296
    buffer_load_dwordx4 v240, s[16:19], s5 offen nt lds
    s_add_u32 m0, s6, 74752
    s_mov_b32 s5, 2392064
    buffer_load_dwordx4 v240, s[16:19], s5 offen nt lds
    s_add_u32 m0, s6, 75776
    s_mov_b32 s5, 2424832
    buffer_load_dwordx4 v240, s[16:19], s5 offen nt lds
    s_add_u32 m0, s6, 76800
    s_mov_b32 s5, 2457600
    buffer_load_dwordx4 v240, s[16:19], s5 offen nt lds
    s_add_u32 m0, s6, 77824
    s_mov_b32 s5, 2490368
    buffer_load_dwordx4 v240, s[16:19], s5 offen nt lds
    s_add_u32 m0, s6, 78848
    s_mov_b32 s5, 2523136
    buffer_load_dwordx4 v240, s[16:19], s5 offen nt lds
    s_add_u32 m0, s6, 79872
    s_mov_b32 s5, 2555904
    buffer_load_dwordx4 v240, s[16:19], s5 offen nt lds
    s_add_u32 m0, s6, 80896
    s_mov_b32 s5, 2588672
    buffer_load_dwordx4 v240, s[16:19], s5 offen nt lds
    v_and_b32 v2, 15, v1
    v_lshrrev_b32 v3, 4, v1
    v_lshlrev_b32 v4, 11, v2
    v_add_u32 v5, 0, v3
    v_xor_b32 v5, v5, v2
    v_lshl_add_u32 v8, v5, 4, v4
    v_add_u32 v12, 0x10000, v8
    v_add_u32 v5, 4, v3
    v_xor_b32 v5, v5, v2
    v_lshl_add_u32 v9, v5, 4, v4
    v_add_u32 v13, 0x10000, v9
    v_add_u32 v5, 8, v3
    v_xor_b32 v5, v5, v2
    v_lshl_add_u32 v10, v5, 4, v4
    v_add_u32 v14, 0x10000, v10
    v_add_u32 v5, 12, v3
    v_xor_b32 v5, v5, v2
    v_lshl_add_u32 v11, v5, 4, v4
    v_add_u32 v15, 0x10000, v11
    s_lshl_b32 s4, s24, 3
    s_and_b32 s4, s4, 8
    s_add_u32 s5, s4, 0
    v_xor_b32 v5, s5, v1
    s_add_u32 s5, s6, 0
    v_lshlrev_b32 v5, 4, v5
    v_add_u32 v16, s5, v5
    s_add_u32 s5, s4, 1
    v_xor_b32 v5, s5, v1
    s_add_u32 s5, s6, 0
    v_lshlrev_b32 v5, 4, v5
    v_add_u32 v17, s5, v5
    s_add_u32 s5, s4, 2
    v_xor_b32 v5, s5, v1
    s_add_u32 s5, s6, 4096
    v_lshlrev_b32 v5, 4, v5
    v_add_u32 v18, s5, v5
    s_add_u32 s5, s4, 3
    v_xor_b32 v5, s5, v1
    s_add_u32 s5, s6, 4096
    v_lshlrev_b32 v5, 4, v5
    v_add_u32 v19, s5, v5
    s_add_u32 s5, s4, 4
    v_xor_b32 v5, s5, v1
    s_add_u32 s5, s6, 8192
    v_lshlrev_b32 v5, 4, v5
    v_add_u32 v20, s5, v5
    s_add_u32 s5, s4, 5
    v_xor_b32 v5, s5, v1
    s_add_u32 s5, s6, 8192
    v_lshlrev_b32 v5, 4, v5
    v_add_u32 v21, s5, v5
    s_add_u32 s5, s4, 6
    v_xor_b32 v5, s5, v1
    s_add_u32 s5, s6, 12288
    v_lshlrev_b32 v5, 4, v5
    v_add_u32 v22, s5, v5
    s_add_u32 s5, s4, 7
    v_xor_b32 v5, s5, v1
    s_add_u32 s5, s6, 12288
    v_lshlrev_b32 v5, 4, v5
    v_add_u32 v23, s5, v5
    s_cmp_eq_u32 s98, 2
    s_cselect_b32 s4, 11, 10
    s_cselect_b32 s5, 1, 4
    s_lshl_b32 s5, s5, 10
    s_lshl_b32 s4, s24, s4
    v_lshlrev_b32 v24, 4, v1
    v_add_u32 v24, s4, v24
    v_add_u32 v25, s5, v24
    v_mov_b32 v26, 0
    s_and_b32 s4, s99, 7
    s_lshl_b32 s4, s4, 13
    s_lshl_b32 s5, s24, 11
    s_add_u32 s4, s4, s5
    s_add_u32 s4, s4, 196608
    v_lshlrev_b32 v28, 5, v1
    v_add_u32 v28, s4, v28
    s_lshl_b32 s31, s98, 24
    s_lshl_b32 s4, s99, 13
    s_add_u32 s31, s31, s4
    s_mov_b32 s30, 75497472
    s_cmp_eq_u32 s98, 0
    s_cselect_b32 s28, 60, 0
    s_lshl_b32 s29, s28, 16
    s_waitcnt vmcnt(16)
    s_barrier
    ds_read_b64_tr_b16 a[0:1], v242 offset:0
    ds_read_b64_tr_b16 a[2:3], v242 offset:1024
    ds_read_b64_tr_b16 a[4:5], v242 offset:8
    ds_read_b64_tr_b16 a[6:7], v242 offset:1032
    ds_read_b64_tr_b16 a[8:9], v242 offset:8192
    ds_read_b64_tr_b16 a[10:11], v242 offset:9216
    ds_read_b64_tr_b16 a[12:13], v242 offset:8200
    ds_read_b64_tr_b16 a[14:15], v242 offset:9224
    ds_read_b64_tr_b16 a[16:17], v242 offset:16384
    ds_read_b64_tr_b16 a[18:19], v242 offset:17408
    ds_read_b64_tr_b16 a[20:21], v242 offset:16392
    ds_read_b64_tr_b16 a[22:23], v242 offset:17416
    ds_read_b64_tr_b16 a[24:25], v242 offset:24576
    ds_read_b64_tr_b16 a[26:27], v242 offset:25600
    ds_read_b64_tr_b16 a[28:29], v242 offset:24584
    ds_read_b64_tr_b16 a[30:31], v242 offset:25608
    ds_read_b64_tr_b16 a[32:33], v242 offset:32768
    ds_read_b64_tr_b16 a[34:35], v242 offset:33792
    ds_read_b64_tr_b16 a[36:37], v242 offset:32776
    ds_read_b64_tr_b16 a[38:39], v242 offset:33800
    ds_read_b64_tr_b16 a[40:41], v242 offset:40960
    ds_read_b64_tr_b16 a[42:43], v242 offset:41984
    ds_read_b64_tr_b16 a[44:45], v242 offset:40968
    ds_read_b64_tr_b16 a[46:47], v242 offset:41992
    ds_read_b64_tr_b16 a[48:49], v242 offset:49152
    ds_read_b64_tr_b16 a[50:51], v242 offset:50176
    ds_read_b64_tr_b16 a[52:53], v242 offset:49160
    ds_read_b64_tr_b16 a[54:55], v242 offset:50184
    ds_read_b64_tr_b16 a[56:57], v242 offset:57344
    ds_read_b64_tr_b16 a[58:59], v242 offset:58368
    ds_read_b64_tr_b16 a[60:61], v242 offset:57352
    ds_read_b64_tr_b16 a[62:63], v242 offset:58376
    s_waitcnt lgkmcnt(0)
    s_barrier
    s_add_u32 m0, s6, 0
    s_mov_b32 s5, 4194304
    buffer_load_dwordx4 v240, s[16:19], s5 offen nt lds
    s_add_u32 m0, s6, 1024
    s_mov_b32 s5, 4227072
    buffer_load_dwordx4 v240, s[16:19], s5 offen nt lds
    s_add_u32 m0, s6, 2048
    s_mov_b32 s5, 4259840
    buffer_load_dwordx4 v240, s[16:19], s5 offen nt lds
    s_add_u32 m0, s6, 3072
    s_mov_b32 s5, 4292608
    buffer_load_dwordx4 v240, s[16:19], s5 offen nt lds
    s_add_u32 m0, s6, 4096
    s_mov_b32 s5, 4325376
    buffer_load_dwordx4 v240, s[16:19], s5 offen nt lds
    s_add_u32 m0, s6, 5120
    s_mov_b32 s5, 4358144
    buffer_load_dwordx4 v240, s[16:19], s5 offen nt lds
    s_add_u32 m0, s6, 6144
    s_mov_b32 s5, 4390912
    buffer_load_dwordx4 v240, s[16:19], s5 offen nt lds
    s_add_u32 m0, s6, 7168
    s_mov_b32 s5, 4423680
    buffer_load_dwordx4 v240, s[16:19], s5 offen nt lds
    s_add_u32 m0, s6, 8192
    s_mov_b32 s5, 4456448
    buffer_load_dwordx4 v240, s[16:19], s5 offen nt lds
    s_add_u32 m0, s6, 9216
    s_mov_b32 s5, 4489216
    buffer_load_dwordx4 v240, s[16:19], s5 offen nt lds
    s_add_u32 m0, s6, 10240
    s_mov_b32 s5, 4521984
    buffer_load_dwordx4 v240, s[16:19], s5 offen nt lds
    s_add_u32 m0, s6, 11264
    s_mov_b32 s5, 4554752
    buffer_load_dwordx4 v240, s[16:19], s5 offen nt lds
    s_add_u32 m0, s6, 12288
    s_mov_b32 s5, 4587520
    buffer_load_dwordx4 v240, s[16:19], s5 offen nt lds
    s_add_u32 m0, s6, 13312
    s_mov_b32 s5, 4620288
    buffer_load_dwordx4 v240, s[16:19], s5 offen nt lds
    s_add_u32 m0, s6, 14336
    s_mov_b32 s5, 4653056
    buffer_load_dwordx4 v240, s[16:19], s5 offen nt lds
    s_add_u32 m0, s6, 15360
    s_mov_b32 s5, 4685824
    buffer_load_dwordx4 v240, s[16:19], s5 offen nt lds
    s_waitcnt vmcnt(16)
    s_lshl_b32 s4, s99, 9
    s_lshl_b32 s5, s24, 7
    s_add_u32 s4, s4, s5
    s_lshl_b32 s5, s98, 14
    s_add_u32 s4, s4, s5
    s_add_u32 s94, s4, 92274688
    s_add_u32 s4, s4, 76546048
    s_cmp_eq_u32 s98, 0
    s_cselect_b32 s94, s4, s94
    s_barrier
    ds_read_b64_tr_b16 a[64:65], v243 offset:0
    ds_read_b64_tr_b16 a[66:67], v243 offset:1024
    ds_read_b64_tr_b16 a[68:69], v243 offset:8
    ds_read_b64_tr_b16 a[70:71], v243 offset:1032
    ds_read_b64_tr_b16 a[72:73], v243 offset:8192
    ds_read_b64_tr_b16 a[74:75], v243 offset:9216
    ds_read_b64_tr_b16 a[76:77], v243 offset:8200
    ds_read_b64_tr_b16 a[78:79], v243 offset:9224
    ds_read_b64_tr_b16 a[80:81], v243 offset:16384
    ds_read_b64_tr_b16 a[82:83], v243 offset:17408
    ds_read_b64_tr_b16 a[84:85], v243 offset:16392
    ds_read_b64_tr_b16 a[86:87], v243 offset:17416
    ds_read_b64_tr_b16 a[88:89], v243 offset:24576
    ds_read_b64_tr_b16 a[90:91], v243 offset:25600
    ds_read_b64_tr_b16 a[92:93], v243 offset:24584
    ds_read_b64_tr_b16 a[94:95], v243 offset:25608
    ds_read_b64_tr_b16 a[96:97], v243 offset:32768
    ds_read_b64_tr_b16 a[98:99], v243 offset:33792
    ds_read_b64_tr_b16 a[100:101], v243 offset:32776
    ds_read_b64_tr_b16 a[102:103], v243 offset:33800
    ds_read_b64_tr_b16 a[104:105], v243 offset:40960
    ds_read_b64_tr_b16 a[106:107], v243 offset:41984
    ds_read_b64_tr_b16 a[108:109], v243 offset:40968
    ds_read_b64_tr_b16 a[110:111], v243 offset:41992
    ds_read_b64_tr_b16 a[112:113], v243 offset:49152
    ds_read_b64_tr_b16 a[114:115], v243 offset:50176
    ds_read_b64_tr_b16 a[116:117], v243 offset:49160
    ds_read_b64_tr_b16 a[118:119], v243 offset:50184
    ds_read_b64_tr_b16 a[120:121], v243 offset:57344
    ds_read_b64_tr_b16 a[122:123], v243 offset:58368
    ds_read_b64_tr_b16 a[124:125], v243 offset:57352
    ds_read_b64_tr_b16 a[126:127], v243 offset:58376
    s_waitcnt lgkmcnt(0)
    s_barrier
    v_or_b32 v239, 32, v1
    v_lshlrev_b32 v239, 2, v239
    buffer_load_dword v238, v239, s[20:23], 0 offen sc1
    s_add_u32 m0, s6, 65536
    s_mov_b32 s5, 6291456
    buffer_load_dwordx4 v240, s[16:19], s5 offen nt lds
    s_add_u32 m0, s6, 66560
    s_mov_b32 s5, 6324224
    buffer_load_dwordx4 v240, s[16:19], s5 offen nt lds
    s_add_u32 m0, s6, 67584
    s_mov_b32 s5, 6356992
    buffer_load_dwordx4 v240, s[16:19], s5 offen nt lds
    s_add_u32 m0, s6, 68608
    s_mov_b32 s5, 6389760
    buffer_load_dwordx4 v240, s[16:19], s5 offen nt lds
    s_add_u32 m0, s6, 69632
    s_mov_b32 s5, 6422528
    buffer_load_dwordx4 v240, s[16:19], s5 offen nt lds
    s_add_u32 m0, s6, 70656
    s_mov_b32 s5, 6455296
    buffer_load_dwordx4 v240, s[16:19], s5 offen nt lds
    s_add_u32 m0, s6, 71680
    s_mov_b32 s5, 6488064
    buffer_load_dwordx4 v240, s[16:19], s5 offen nt lds
    s_add_u32 m0, s6, 72704
    s_mov_b32 s5, 6520832
    buffer_load_dwordx4 v240, s[16:19], s5 offen nt lds
    s_add_u32 m0, s6, 73728
    s_mov_b32 s5, 6553600
    buffer_load_dwordx4 v240, s[16:19], s5 offen nt lds
    s_add_u32 m0, s6, 74752
    s_mov_b32 s5, 6586368
    buffer_load_dwordx4 v240, s[16:19], s5 offen nt lds
    s_add_u32 m0, s6, 75776
    s_mov_b32 s5, 6619136
    buffer_load_dwordx4 v240, s[16:19], s5 offen nt lds
    s_add_u32 m0, s6, 76800
    s_mov_b32 s5, 6651904
    buffer_load_dwordx4 v240, s[16:19], s5 offen nt lds
    s_add_u32 m0, s6, 77824
    s_mov_b32 s5, 6684672
    buffer_load_dwordx4 v240, s[16:19], s5 offen nt lds
    s_add_u32 m0, s6, 78848
    s_mov_b32 s5, 6717440
    buffer_load_dwordx4 v240, s[16:19], s5 offen nt lds
    s_add_u32 m0, s6, 79872
    s_mov_b32 s5, 6750208
    buffer_load_dwordx4 v240, s[16:19], s5 offen nt lds
    s_add_u32 m0, s6, 80896
    s_mov_b32 s5, 6782976
    buffer_load_dwordx4 v240, s[16:19], s5 offen nt lds
    s_waitcnt vmcnt(16)
    s_cmp_lg_u32 s27, 0
    s_cbranch_scc1 .vd_339
    s_mov_b32 s62, 0
.vp_338:
    v_readlane_b32 s4, v238, 49
    s_and_b32 s5, s4, 0xffff
    s_cmp_ge_u32 s5, 256
    s_cbranch_scc1 .va_340
    s_add_u32 s62, s62, 1
    s_cmp_gt_u32 s62, 0x100000
    s_cbranch_scc1 .mg_end_1
    s_sleep 16
    buffer_load_dword v238, v239, s[20:23], 0 offen sc1
    s_waitcnt vmcnt(0)
    s_branch .vp_338
.va_340:
    s_lshr_b32 s4, s4, 16
    s_cbranch_scc0 .vd_339
    s_lshr_b32 s25, s2, 5
    s_and_b32 s26, s2, 31
    s_mov_b32 s27, 1
    s_waitcnt vmcnt(0) lgkmcnt(0)
    s_barrier
    s_branch .mg_role_3
.vd_339:
    s_barrier
    ds_read_b64_tr_b16 a[128:129], v242 offset:0
    ds_read_b64_tr_b16 a[130:131], v242 offset:1024
    ds_read_b64_tr_b16 a[132:133], v242 offset:8
    ds_read_b64_tr_b16 a[134:135], v242 offset:1032
    ds_read_b64_tr_b16 a[136:137], v242 offset:8192
    ds_read_b64_tr_b16 a[138:139], v242 offset:9216
    ds_read_b64_tr_b16 a[140:141], v242 offset:8200
    ds_read_b64_tr_b16 a[142:143], v242 offset:9224
    ds_read_b64_tr_b16 a[144:145], v242 offset:16384
    ds_read_b64_tr_b16 a[146:147], v242 offset:17408
    ds_read_b64_tr_b16 a[148:149], v242 offset:16392
    ds_read_b64_tr_b16 a[150:151], v242 offset:17416
    ds_read_b64_tr_b16 a[152:153], v242 offset:24576
    ds_read_b64_tr_b16 a[154:155], v242 offset:25600
    ds_read_b64_tr_b16 a[156:157], v242 offset:24584
    ds_read_b64_tr_b16 a[158:159], v242 offset:25608
    ds_read_b64_tr_b16 a[160:161], v242 offset:32768
    ds_read_b64_tr_b16 a[162:163], v242 offset:33792
    ds_read_b64_tr_b16 a[164:165], v242 offset:32776
    ds_read_b64_tr_b16 a[166:167], v242 offset:33800
    ds_read_b64_tr_b16 a[168:169], v242 offset:40960
    ds_read_b64_tr_b16 a[170:171], v242 offset:41984
    ds_read_b64_tr_b16 a[172:173], v242 offset:40968
    ds_read_b64_tr_b16 a[174:175], v242 offset:41992
    ds_read_b64_tr_b16 a[176:177], v242 offset:49152
    ds_read_b64_tr_b16 a[178:179], v242 offset:50176
    ds_read_b64_tr_b16 a[180:181], v242 offset:49160
    ds_read_b64_tr_b16 a[182:183], v242 offset:50184
    ds_read_b64_tr_b16 a[184:185], v242 offset:57344
    ds_read_b64_tr_b16 a[186:187], v242 offset:58368
    ds_read_b64_tr_b16 a[188:189], v242 offset:57352
    ds_read_b64_tr_b16 a[190:191], v242 offset:58376
    s_waitcnt lgkmcnt(0)
    s_barrier
    s_add_u32 m0, s6, 0
    s_nop 0
    buffer_load_dwordx4 v16, s[12:15], s29 offen offset:0 lds
    buffer_load_dwordx4 v16, s[12:15], s29 offen offset:1024 lds
    buffer_load_dwordx4 v17, s[12:15], s29 offen offset:2048 lds
    buffer_load_dwordx4 v17, s[12:15], s29 offen offset:3072 lds
    s_add_u32 m0, s6, 4096
    s_nop 0
    buffer_load_dwordx4 v18, s[12:15], s29 offen offset:0 lds
    buffer_load_dwordx4 v18, s[12:15], s29 offen offset:1024 lds
    buffer_load_dwordx4 v19, s[12:15], s29 offen offset:2048 lds
    buffer_load_dwordx4 v19, s[12:15], s29 offen offset:3072 lds
    s_add_u32 m0, s6, 8192
    s_nop 0
    buffer_load_dwordx4 v20, s[12:15], s29 offen offset:0 lds
    buffer_load_dwordx4 v20, s[12:15], s29 offen offset:1024 lds
    buffer_load_dwordx4 v21, s[12:15], s29 offen offset:2048 lds
    buffer_load_dwordx4 v21, s[12:15], s29 offen offset:3072 lds
    s_add_u32 m0, s6, 12288
    s_nop 0
    buffer_load_dwordx4 v22, s[12:15], s29 offen offset:0 lds
    buffer_load_dwordx4 v22, s[12:15], s29 offen offset:1024 lds
    buffer_load_dwordx4 v23, s[12:15], s29 offen offset:2048 lds
    buffer_load_dwordx4 v23, s[12:15], s29 offen offset:3072 lds
    s_waitcnt vmcnt(16)
    s_barrier
    ds_read_b64_tr_b16 a[192:193], v243 offset:0
    ds_read_b64_tr_b16 a[194:195], v243 offset:1024
    ds_read_b64_tr_b16 a[196:197], v243 offset:8
    ds_read_b64_tr_b16 a[198:199], v243 offset:1032
    ds_read_b64_tr_b16 a[200:201], v243 offset:8192
    ds_read_b64_tr_b16 a[202:203], v243 offset:9216
    ds_read_b64_tr_b16 a[204:205], v243 offset:8200
    ds_read_b64_tr_b16 a[206:207], v243 offset:9224
    ds_read_b64_tr_b16 a[208:209], v243 offset:16384
    ds_read_b64_tr_b16 a[210:211], v243 offset:17408
    ds_read_b64_tr_b16 a[212:213], v243 offset:16392
    ds_read_b64_tr_b16 a[214:215], v243 offset:17416
    ds_read_b64_tr_b16 a[216:217], v243 offset:24576
    ds_read_b64_tr_b16 a[218:219], v243 offset:25600
    ds_read_b64_tr_b16 a[220:221], v243 offset:24584
    ds_read_b64_tr_b16 a[222:223], v243 offset:25608
    ds_read_b64_tr_b16 a[224:225], v243 offset:32768
    ds_read_b64_tr_b16 a[226:227], v243 offset:33792
    ds_read_b64_tr_b16 a[228:229], v243 offset:32776
    ds_read_b64_tr_b16 a[230:231], v243 offset:33800
    ds_read_b64_tr_b16 a[232:233], v243 offset:40960
    ds_read_b64_tr_b16 a[234:235], v243 offset:41984
    ds_read_b64_tr_b16 a[236:237], v243 offset:40968
    ds_read_b64_tr_b16 a[238:239], v243 offset:41992
    ds_read_b64_tr_b16 a[240:241], v243 offset:49152
    ds_read_b64_tr_b16 a[242:243], v243 offset:50176
    ds_read_b64_tr_b16 a[244:245], v243 offset:49160
    ds_read_b64_tr_b16 a[246:247], v243 offset:50184
    ds_read_b64_tr_b16 a[248:249], v243 offset:57344
    ds_read_b64_tr_b16 a[250:251], v243 offset:58368
    ds_read_b64_tr_b16 a[252:253], v243 offset:57352
    ds_read_b64_tr_b16 a[254:255], v243 offset:58376
    s_waitcnt lgkmcnt(0)
    s_barrier
    s_waitcnt vmcnt(0)
    s_barrier
    s_add_u32 s29, s29, 0x10000
    ds_read_b128 v[64:67], v8 offset:0
    ds_read_b128 v[68:71], v8 offset:32768
    ds_read_b128 v[72:75], v9 offset:0
    ds_read_b128 v[76:79], v9 offset:32768
    ds_read_b128 v[80:83], v10 offset:0
    ds_read_b128 v[84:87], v10 offset:32768
    ds_read_b128 v[88:91], v11 offset:0
    ds_read_b128 v[92:95], v11 offset:32768
    ds_read_b128 v[96:99], v8 offset:256
    ds_read_b128 v[100:103], v8 offset:33024
    ds_read_b128 v[104:107], v9 offset:256
    ds_read_b128 v[108:111], v9 offset:33024
    ds_read_b128 v[112:115], v10 offset:256
    ds_read_b128 v[116:119], v10 offset:33024
    ds_read_b128 v[120:123], v11 offset:256
    ds_read_b128 v[124:127], v11 offset:33024
    s_add_u32 m0, s6, 65536
    s_nop 0
    buffer_load_dwordx4 v16, s[12:15], s29 offen offset:0 lds
    buffer_load_dwordx4 v16, s[12:15], s29 offen offset:1024 lds
    buffer_load_dwordx4 v17, s[12:15], s29 offen offset:2048 lds
    buffer_load_dwordx4 v17, s[12:15], s29 offen offset:3072 lds
    s_add_u32 m0, s6, 69632
    s_nop 0
    buffer_load_dwordx4 v18, s[12:15], s29 offen offset:0 lds
    buffer_load_dwordx4 v18, s[12:15], s29 offen offset:1024 lds
    s_cmp_eq_u32 s98, 2
    s_cbranch_scc1 .vt_342
.p2align 6
.ql_344:
    s_waitcnt lgkmcnt(12)
    v_mfma_f32_16x16x32_bf16 v[192:195], a[0:3], v[64:67], 0
    ds_read_b128 v[128:131], v8 offset:512
    v_mfma_f32_16x16x32_bf16 v[196:199], a[4:7], v[64:67], 0
    v_mfma_f32_16x16x32_bf16 v[200:203], a[0:3], v[68:71], 0
    ds_read_b128 v[132:135], v8 offset:33280
    v_mfma_f32_16x16x32_bf16 v[204:207], a[4:7], v[68:71], 0
    buffer_load_dwordx4 v19, s[12:15], s29 offen offset:2048 lds
    v_mfma_f32_16x16x32_bf16 v[192:195], a[8:11], v[72:75], v[192:195]
    ds_read_b128 v[136:139], v9 offset:512
    v_mfma_f32_16x16x32_bf16 v[196:199], a[12:15], v[72:75], v[196:199]
    v_cvt_pk_bf16_f32 v224, v208, v209
    v_cvt_pk_bf16_f32 v225, v210, v211
    v_mfma_f32_16x16x32_bf16 v[200:203], a[8:11], v[76:79], v[200:203]
    ds_read_b128 v[140:143], v9 offset:33280
    v_mfma_f32_16x16x32_bf16 v[204:207], a[12:15], v[76:79], v[204:207]
    buffer_load_dwordx4 v19, s[12:15], s29 offen offset:3072 lds
    s_waitcnt lgkmcnt(12)
    v_mfma_f32_16x16x32_bf16 v[192:195], a[16:19], v[80:83], v[192:195]
    ds_read_b128 v[144:147], v10 offset:512
    v_mfma_f32_16x16x32_bf16 v[196:199], a[20:23], v[80:83], v[196:199]
    s_add_u32 m0, s6, 73728
    v_cvt_pk_bf16_f32 v226, v212, v213
    v_cvt_pk_bf16_f32 v227, v214, v215
    v_mfma_f32_16x16x32_bf16 v[200:203], a[16:19], v[84:87], v[200:203]
    ds_read_b128 v[148:151], v10 offset:33280
    v_mfma_f32_16x16x32_bf16 v[204:207], a[20:23], v[84:87], v[204:207]
    buffer_load_dwordx4 v20, s[12:15], s29 offen offset:0 lds
    v_mfma_f32_16x16x32_bf16 v[192:195], a[24:27], v[88:91], v[192:195]
    ds_read_b128 v[152:155], v11 offset:512
    v_cvt_pk_bf16_f32 v228, v216, v217
    v_mfma_f32_16x16x32_bf16 v[196:199], a[28:31], v[88:91], v[196:199]
    buffer_store_dwordx4 v[224:227], v24, s[8:11], s30 offen sc1
    v_mfma_f32_16x16x32_bf16 v[200:203], a[24:27], v[92:95], v[200:203]
    ds_read_b128 v[156:159], v11 offset:33280
    v_cvt_pk_bf16_f32 v229, v218, v219
    v_mfma_f32_16x16x32_bf16 v[204:207], a[28:31], v[92:95], v[204:207]
    buffer_load_dwordx4 v20, s[12:15], s29 offen offset:1024 lds
    s_waitcnt lgkmcnt(12)
    v_mfma_f32_16x16x32_bf16 v[192:195], a[32:35], v[96:99], v[192:195]
    ds_read_b128 v[160:163], v8 offset:768
    v_mfma_f32_16x16x32_bf16 v[196:199], a[36:39], v[96:99], v[196:199]
    v_cvt_pk_bf16_f32 v230, v220, v221
    v_cvt_pk_bf16_f32 v231, v222, v223
    v_mfma_f32_16x16x32_bf16 v[200:203], a[32:35], v[100:103], v[200:203]
    ds_read_b128 v[164:167], v8 offset:33536
    v_mfma_f32_16x16x32_bf16 v[204:207], a[36:39], v[100:103], v[204:207]
    buffer_load_dwordx4 v21, s[12:15], s29 offen offset:2048 lds
    v_mfma_f32_16x16x32_bf16 v[192:195], a[40:43], v[104:107], v[192:195]
    ds_read_b128 v[168:171], v9 offset:768
    v_mfma_f32_16x16x32_bf16 v[196:199], a[44:47], v[104:107], v[196:199]
    buffer_store_dwordx4 v[228:231], v25, s[8:11], s30 offen sc1
    v_mfma_f32_16x16x32_bf16 v[200:203], a[40:43], v[108:111], v[200:203]
    ds_read_b128 v[172:175], v9 offset:33536
    v_mfma_f32_16x16x32_bf16 v[204:207], a[44:47], v[108:111], v[204:207]
    buffer_load_dwordx4 v21, s[12:15], s29 offen offset:3072 lds
    s_waitcnt lgkmcnt(12)
    v_mfma_f32_16x16x32_bf16 v[192:195], a[48:51], v[112:115], v[192:195]
    ds_read_b128 v[176:179], v10 offset:768
    v_mfma_f32_16x16x32_bf16 v[196:199], a[52:55], v[112:115], v[196:199]
    s_add_u32 m0, s6, 77824
    s_mov_b32 s30, s31
    v_mfma_f32_16x16x32_bf16 v[200:203], a[48:51], v[116:119], v[200:203]
    ds_read_b128 v[180:183], v10 offset:33536
    v_mfma_f32_16x16x32_bf16 v[204:207], a[52:55], v[116:119], v[204:207]
    buffer_load_dwordx4 v22, s[12:15], s29 offen offset:0 lds
    v_mfma_f32_16x16x32_bf16 v[192:195], a[56:59], v[120:123], v[192:195]
    ds_read_b128 v[184:187], v11 offset:768
    v_mfma_f32_16x16x32_bf16 v[196:199], a[60:63], v[120:123], v[196:199]
    s_add_u32 s31, s31, 262144
    v_mfma_f32_16x16x32_bf16 v[200:203], a[56:59], v[124:127], v[200:203]
    ds_read_b128 v[188:191], v11 offset:33536
    v_mfma_f32_16x16x32_bf16 v[204:207], a[60:63], v[124:127], v[204:207]
    buffer_load_dwordx4 v22, s[12:15], s29 offen offset:1024 lds
    s_waitcnt lgkmcnt(12)
    v_mfma_f32_16x16x32_bf16 v[192:195], a[64:67], v[128:131], v[192:195]
    ds_read_b128 v[64:67], v8 offset:1024
    v_mfma_f32_16x16x32_bf16 v[196:199], a[68:71], v[128:131], v[196:199]
    v_mfma_f32_16x16x32_bf16 v[200:203], a[64:67], v[132:135], v[200:203]
    ds_read_b128 v[68:71], v8 offset:33792
    v_mfma_f32_16x16x32_bf16 v[204:207], a[68:71], v[132:135], v[204:207]
    buffer_load_dwordx4 v23, s[12:15], s29 offen offset:2048 lds
    v_mfma_f32_16x16x32_bf16 v[192:195], a[72:75], v[136:139], v[192:195]
    ds_read_b128 v[72:75], v9 offset:1024
    v_mfma_f32_16x16x32_bf16 v[196:199], a[76:79], v[136:139], v[196:199]
    v_mfma_f32_16x16x32_bf16 v[200:203], a[72:75], v[140:143], v[200:203]
    ds_read_b128 v[76:79], v9 offset:33792
    v_mfma_f32_16x16x32_bf16 v[204:207], a[76:79], v[140:143], v[204:207]
    buffer_load_dwordx4 v23, s[12:15], s29 offen offset:3072 lds
    s_waitcnt lgkmcnt(12)
    v_mfma_f32_16x16x32_bf16 v[192:195], a[80:83], v[144:147], v[192:195]
    ds_read_b128 v[80:83], v10 offset:1024
    v_mfma_f32_16x16x32_bf16 v[196:199], a[84:87], v[144:147], v[196:199]
    v_mfma_f32_16x16x32_bf16 v[200:203], a[80:83], v[148:151], v[200:203]
    ds_read_b128 v[84:87], v10 offset:33792
    v_mfma_f32_16x16x32_bf16 v[204:207], a[84:87], v[148:151], v[204:207]
    buffer_load_dword v29, v28, s[12:15], s29 offen
    v_mfma_f32_16x16x32_bf16 v[192:195], a[88:91], v[152:155], v[192:195]
    ds_read_b128 v[88:91], v11 offset:1024
    v_mfma_f32_16x16x32_bf16 v[196:199], a[92:95], v[152:155], v[196:199]
    v_mfma_f32_16x16x32_bf16 v[200:203], a[88:91], v[156:159], v[200:203]
    ds_read_b128 v[92:95], v11 offset:33792
    v_mfma_f32_16x16x32_bf16 v[204:207], a[92:95], v[156:159], v[204:207]
    s_waitcnt lgkmcnt(12)
    v_mfma_f32_16x16x32_bf16 v[192:195], a[96:99], v[160:163], v[192:195]
    ds_read_b128 v[96:99], v8 offset:1280
    v_mfma_f32_16x16x32_bf16 v[196:199], a[100:103], v[160:163], v[196:199]
    v_mfma_f32_16x16x32_bf16 v[200:203], a[96:99], v[164:167], v[200:203]
    ds_read_b128 v[100:103], v8 offset:34048
    v_mfma_f32_16x16x32_bf16 v[204:207], a[100:103], v[164:167], v[204:207]
    v_mfma_f32_16x16x32_bf16 v[192:195], a[104:107], v[168:171], v[192:195]
    ds_read_b128 v[104:107], v9 offset:1280
    v_mfma_f32_16x16x32_bf16 v[196:199], a[108:111], v[168:171], v[196:199]
    v_mfma_f32_16x16x32_bf16 v[200:203], a[104:107], v[172:175], v[200:203]
    ds_read_b128 v[108:111], v9 offset:34048
    v_mfma_f32_16x16x32_bf16 v[204:207], a[108:111], v[172:175], v[204:207]
    s_waitcnt lgkmcnt(12)
    v_mfma_f32_16x16x32_bf16 v[192:195], a[112:115], v[176:179], v[192:195]
    ds_read_b128 v[112:115], v10 offset:1280
    v_mfma_f32_16x16x32_bf16 v[196:199], a[116:119], v[176:179], v[196:199]
    v_mfma_f32_16x16x32_bf16 v[200:203], a[112:115], v[180:183], v[200:203]
    ds_read_b128 v[116:119], v10 offset:34048
    v_mfma_f32_16x16x32_bf16 v[204:207], a[116:119], v[180:183], v[204:207]
    v_mfma_f32_16x16x32_bf16 v[192:195], a[120:123], v[184:187], v[192:195]
    ds_read_b128 v[120:123], v11 offset:1280
    v_mfma_f32_16x16x32_bf16 v[196:199], a[124:127], v[184:187], v[196:199]
    v_mfma_f32_16x16x32_bf16 v[200:203], a[120:123], v[188:191], v[200:203]
    ds_read_b128 v[124:127], v11 offset:34048
    v_mfma_f32_16x16x32_bf16 v[204:207], a[124:127], v[188:191], v[204:207]
    s_waitcnt lgkmcnt(12)
    v_mfma_f32_16x16x32_bf16 v[192:195], a[128:131], v[64:67], v[192:195]
    ds_read_b128 v[128:131], v8 offset:1536
    v_mfma_f32_16x16x32_bf16 v[196:199], a[132:135], v[64:67], v[196:199]
    v_mfma_f32_16x16x32_bf16 v[200:203], a[128:131], v[68:71], v[200:203]
    ds_read_b128 v[132:135], v8 offset:34304
    v_mfma_f32_16x16x32_bf16 v[204:207], a[132:135], v[68:71], v[204:207]
    v_mfma_f32_16x16x32_bf16 v[192:195], a[136:139], v[72:75], v[192:195]
    ds_read_b128 v[136:139], v9 offset:1536
    v_mfma_f32_16x16x32_bf16 v[196:199], a[140:143], v[72:75], v[196:199]
    v_mfma_f32_16x16x32_bf16 v[200:203], a[136:139], v[76:79], v[200:203]
    ds_read_b128 v[140:143], v9 offset:34304
    v_mfma_f32_16x16x32_bf16 v[204:207], a[140:143], v[76:79], v[204:207]
    s_waitcnt lgkmcnt(12)
    v_mfma_f32_16x16x32_bf16 v[192:195], a[144:147], v[80:83], v[192:195]
    ds_read_b128 v[144:147], v10 offset:1536
    v_mfma_f32_16x16x32_bf16 v[196:199], a[148:151], v[80:83], v[196:199]
    v_mfma_f32_16x16x32_bf16 v[200:203], a[144:147], v[84:87], v[200:203]
    ds_read_b128 v[148:151], v10 offset:34304
    v_mfma_f32_16x16x32_bf16 v[204:207], a[148:151], v[84:87], v[204:207]
    v_mfma_f32_16x16x32_bf16 v[192:195], a[152:155], v[88:91], v[192:195]
    ds_read_b128 v[152:155], v11 offset:1536
    v_mfma_f32_16x16x32_bf16 v[196:199], a[156:159], v[88:91], v[196:199]
    v_mfma_f32_16x16x32_bf16 v[200:203], a[152:155], v[92:95], v[200:203]
    ds_read_b128 v[156:159], v11 offset:34304
    v_mfma_f32_16x16x32_bf16 v[204:207], a[156:159], v[92:95], v[204:207]
    s_waitcnt lgkmcnt(12)
    v_mfma_f32_16x16x32_bf16 v[192:195], a[160:163], v[96:99], v[192:195]
    ds_read_b128 v[160:163], v8 offset:1792
    v_mfma_f32_16x16x32_bf16 v[196:199], a[164:167], v[96:99], v[196:199]
    v_mfma_f32_16x16x32_bf16 v[200:203], a[160:163], v[100:103], v[200:203]
    ds_read_b128 v[164:167], v8 offset:34560
    v_mfma_f32_16x16x32_bf16 v[204:207], a[164:167], v[100:103], v[204:207]
    v_mfma_f32_16x16x32_bf16 v[192:195], a[168:171], v[104:107], v[192:195]
    ds_read_b128 v[168:171], v9 offset:1792
    v_mfma_f32_16x16x32_bf16 v[196:199], a[172:175], v[104:107], v[196:199]
    v_mfma_f32_16x16x32_bf16 v[200:203], a[168:171], v[108:111], v[200:203]
    ds_read_b128 v[172:175], v9 offset:34560
    v_mfma_f32_16x16x32_bf16 v[204:207], a[172:175], v[108:111], v[204:207]
    s_waitcnt lgkmcnt(12)
    v_mfma_f32_16x16x32_bf16 v[192:195], a[176:179], v[112:115], v[192:195]
    ds_read_b128 v[176:179], v10 offset:1792
    v_mfma_f32_16x16x32_bf16 v[196:199], a[180:183], v[112:115], v[196:199]
    s_waitcnt vmcnt(6)
    v_mov_b32 v27, s28
    s_mov_b64 exec, 1
    buffer_store_dword v27, v26, s[8:11], s94 offen sc1
    s_mov_b64 exec, -1
    v_mfma_f32_16x16x32_bf16 v[200:203], a[176:179], v[116:119], v[200:203]
    ds_read_b128 v[180:183], v10 offset:34560
    v_mfma_f32_16x16x32_bf16 v[204:207], a[180:183], v[116:119], v[204:207]
    v_mfma_f32_16x16x32_bf16 v[192:195], a[184:187], v[120:123], v[192:195]
    ds_read_b128 v[184:187], v11 offset:1792
    v_mfma_f32_16x16x32_bf16 v[196:199], a[188:191], v[120:123], v[196:199]
    s_add_u32 s28, s28, 1
    v_mfma_f32_16x16x32_bf16 v[200:203], a[184:187], v[124:127], v[200:203]
    ds_read_b128 v[188:191], v11 offset:34560
    v_mfma_f32_16x16x32_bf16 v[204:207], a[188:191], v[124:127], v[204:207]
    s_waitcnt lgkmcnt(12)
    v_mfma_f32_16x16x32_bf16 v[192:195], a[192:195], v[128:131], v[192:195]
    v_mfma_f32_16x16x32_bf16 v[196:199], a[196:199], v[128:131], v[196:199]
    v_mfma_f32_16x16x32_bf16 v[200:203], a[192:195], v[132:135], v[200:203]
    v_mfma_f32_16x16x32_bf16 v[204:207], a[196:199], v[132:135], v[204:207]
    v_mfma_f32_16x16x32_bf16 v[192:195], a[200:203], v[136:139], v[192:195]
    v_mfma_f32_16x16x32_bf16 v[196:199], a[204:207], v[136:139], v[196:199]
    s_add_u32 s29, s29, 0x10000
    s_and_b32 s29, s29, 0x3fffff
    v_mfma_f32_16x16x32_bf16 v[200:203], a[200:203], v[140:143], v[200:203]
    v_mfma_f32_16x16x32_bf16 v[204:207], a[204:207], v[140:143], v[204:207]
    s_waitcnt vmcnt(2) lgkmcnt(0)
    s_barrier
    v_mfma_f32_16x16x32_bf16 v[192:195], a[208:211], v[144:147], v[192:195]
    ds_read_b128 v[64:67], v12 offset:0
    ds_read_b128 v[68:71], v12 offset:32768
    v_mfma_f32_16x16x32_bf16 v[196:199], a[212:215], v[144:147], v[196:199]
    s_add_u32 m0, s6, 0
    v_mfma_f32_16x16x32_bf16 v[200:203], a[208:211], v[148:151], v[200:203]
    ds_read_b128 v[72:75], v13 offset:0
    ds_read_b128 v[76:79], v13 offset:32768
    v_mfma_f32_16x16x32_bf16 v[204:207], a[212:215], v[148:151], v[204:207]
    buffer_load_dwordx4 v16, s[12:15], s29 offen offset:0 lds
    v_mfma_f32_16x16x32_bf16 v[192:195], a[216:219], v[152:155], v[192:195]
    ds_read_b128 v[80:83], v14 offset:0
    ds_read_b128 v[84:87], v14 offset:32768
    v_mfma_f32_16x16x32_bf16 v[196:199], a[220:223], v[152:155], v[196:199]
    v_mfma_f32_16x16x32_bf16 v[200:203], a[216:219], v[156:159], v[200:203]
    ds_read_b128 v[88:91], v15 offset:0
    ds_read_b128 v[92:95], v15 offset:32768
    v_mfma_f32_16x16x32_bf16 v[204:207], a[220:223], v[156:159], v[204:207]
    buffer_load_dwordx4 v16, s[12:15], s29 offen offset:1024 lds
    v_mfma_f32_16x16x32_bf16 v[192:195], a[224:227], v[160:163], v[192:195]
    ds_read_b128 v[96:99], v12 offset:256
    v_mfma_f32_16x16x32_bf16 v[196:199], a[228:231], v[160:163], v[196:199]
    v_mfma_f32_16x16x32_bf16 v[200:203], a[224:227], v[164:167], v[200:203]
    ds_read_b128 v[100:103], v12 offset:33024
    v_mfma_f32_16x16x32_bf16 v[204:207], a[228:231], v[164:167], v[204:207]
    buffer_load_dwordx4 v17, s[12:15], s29 offen offset:2048 lds
    v_mfma_f32_16x16x32_bf16 v[192:195], a[232:235], v[168:171], v[192:195]
    ds_read_b128 v[104:107], v13 offset:256
    v_mfma_f32_16x16x32_bf16 v[196:199], a[236:239], v[168:171], v[196:199]
    v_mfma_f32_16x16x32_bf16 v[200:203], a[232:235], v[172:175], v[200:203]
    ds_read_b128 v[108:111], v13 offset:33024
    v_mfma_f32_16x16x32_bf16 v[204:207], a[236:239], v[172:175], v[204:207]
    buffer_load_dwordx4 v17, s[12:15], s29 offen offset:3072 lds
    v_mfma_f32_16x16x32_bf16 v[192:195], a[240:243], v[176:179], v[192:195]
    ds_read_b128 v[112:115], v14 offset:256
    v_mfma_f32_16x16x32_bf16 v[196:199], a[244:247], v[176:179], v[196:199]
    s_add_u32 m0, s6, 4096
    v_mfma_f32_16x16x32_bf16 v[200:203], a[240:243], v[180:183], v[200:203]
    ds_read_b128 v[116:119], v14 offset:33024
    v_mfma_f32_16x16x32_bf16 v[204:207], a[244:247], v[180:183], v[204:207]
    buffer_load_dwordx4 v18, s[12:15], s29 offen offset:0 lds
    v_mfma_f32_16x16x32_bf16 v[192:195], a[248:251], v[184:187], v[192:195]
    ds_read_b128 v[120:123], v15 offset:256
    v_mfma_f32_16x16x32_bf16 v[196:199], a[252:255], v[184:187], v[196:199]
    v_mfma_f32_16x16x32_bf16 v[200:203], a[248:251], v[188:191], v[200:203]
    ds_read_b128 v[124:127], v15 offset:33024
    v_mfma_f32_16x16x32_bf16 v[204:207], a[252:255], v[188:191], v[204:207]
    buffer_load_dwordx4 v18, s[12:15], s29 offen offset:1024 lds
    s_waitcnt lgkmcnt(12)
    v_mfma_f32_16x16x32_bf16 v[208:211], a[0:3], v[64:67], 0
    ds_read_b128 v[128:131], v12 offset:512
    v_mfma_f32_16x16x32_bf16 v[212:215], a[4:7], v[64:67], 0
    v_mfma_f32_16x16x32_bf16 v[216:219], a[0:3], v[68:71], 0
    ds_read_b128 v[132:135], v12 offset:33280
    v_mfma_f32_16x16x32_bf16 v[220:223], a[4:7], v[68:71], 0
    buffer_load_dwordx4 v19, s[12:15], s29 offen offset:2048 lds
    v_mfma_f32_16x16x32_bf16 v[208:211], a[8:11], v[72:75], v[208:211]
    ds_read_b128 v[136:139], v13 offset:512
    v_mfma_f32_16x16x32_bf16 v[212:215], a[12:15], v[72:75], v[212:215]
    v_cvt_pk_bf16_f32 v224, v192, v193
    v_cvt_pk_bf16_f32 v225, v194, v195
    v_mfma_f32_16x16x32_bf16 v[216:219], a[8:11], v[76:79], v[216:219]
    ds_read_b128 v[140:143], v13 offset:33280
    v_mfma_f32_16x16x32_bf16 v[220:223], a[12:15], v[76:79], v[220:223]
    buffer_load_dwordx4 v19, s[12:15], s29 offen offset:3072 lds
    s_waitcnt lgkmcnt(12)
    v_mfma_f32_16x16x32_bf16 v[208:211], a[16:19], v[80:83], v[208:211]
    ds_read_b128 v[144:147], v14 offset:512
    v_mfma_f32_16x16x32_bf16 v[212:215], a[20:23], v[80:83], v[212:215]
    s_add_u32 m0, s6, 8192
    v_cvt_pk_bf16_f32 v226, v196, v197
    v_cvt_pk_bf16_f32 v227, v198, v199
    v_mfma_f32_16x16x32_bf16 v[216:219], a[16:19], v[84:87], v[216:219]
    ds_read_b128 v[148:151], v14 offset:33280
    v_mfma_f32_16x16x32_bf16 v[220:223], a[20:23], v[84:87], v[220:223]
    buffer_load_dwordx4 v20, s[12:15], s29 offen offset:0 lds
    v_mfma_f32_16x16x32_bf16 v[208:211], a[24:27], v[88:91], v[208:211]
    ds_read_b128 v[152:155], v15 offset:512
    v_cvt_pk_bf16_f32 v228, v200, v201
    v_mfma_f32_16x16x32_bf16 v[212:215], a[28:31], v[88:91], v[212:215]
    buffer_store_dwordx4 v[224:227], v24, s[8:11], s30 offen sc1
    v_mfma_f32_16x16x32_bf16 v[216:219], a[24:27], v[92:95], v[216:219]
    ds_read_b128 v[156:159], v15 offset:33280
    v_cvt_pk_bf16_f32 v229, v202, v203
    v_mfma_f32_16x16x32_bf16 v[220:223], a[28:31], v[92:95], v[220:223]
    buffer_load_dwordx4 v20, s[12:15], s29 offen offset:1024 lds
    s_waitcnt lgkmcnt(12)
    v_mfma_f32_16x16x32_bf16 v[208:211], a[32:35], v[96:99], v[208:211]
    ds_read_b128 v[160:163], v12 offset:768
    v_mfma_f32_16x16x32_bf16 v[212:215], a[36:39], v[96:99], v[212:215]
    v_cvt_pk_bf16_f32 v230, v204, v205
    v_cvt_pk_bf16_f32 v231, v206, v207
    v_mfma_f32_16x16x32_bf16 v[216:219], a[32:35], v[100:103], v[216:219]
    ds_read_b128 v[164:167], v12 offset:33536
    v_mfma_f32_16x16x32_bf16 v[220:223], a[36:39], v[100:103], v[220:223]
    buffer_load_dwordx4 v21, s[12:15], s29 offen offset:2048 lds
    v_mfma_f32_16x16x32_bf16 v[208:211], a[40:43], v[104:107], v[208:211]
    ds_read_b128 v[168:171], v13 offset:768
    v_mfma_f32_16x16x32_bf16 v[212:215], a[44:47], v[104:107], v[212:215]
    buffer_store_dwordx4 v[228:231], v25, s[8:11], s30 offen sc1
    v_mfma_f32_16x16x32_bf16 v[216:219], a[40:43], v[108:111], v[216:219]
    ds_read_b128 v[172:175], v13 offset:33536
    v_mfma_f32_16x16x32_bf16 v[220:223], a[44:47], v[108:111], v[220:223]
    buffer_load_dwordx4 v21, s[12:15], s29 offen offset:3072 lds
    s_waitcnt lgkmcnt(12)
    v_mfma_f32_16x16x32_bf16 v[208:211], a[48:51], v[112:115], v[208:211]
    ds_read_b128 v[176:179], v14 offset:768
    v_mfma_f32_16x16x32_bf16 v[212:215], a[52:55], v[112:115], v[212:215]
    s_add_u32 m0, s6, 12288
    s_mov_b32 s30, s31
    v_mfma_f32_16x16x32_bf16 v[216:219], a[48:51], v[116:119], v[216:219]
    ds_read_b128 v[180:183], v14 offset:33536
    v_mfma_f32_16x16x32_bf16 v[220:223], a[52:55], v[116:119], v[220:223]
    buffer_load_dwordx4 v22, s[12:15], s29 offen offset:0 lds
    v_mfma_f32_16x16x32_bf16 v[208:211], a[56:59], v[120:123], v[208:211]
    ds_read_b128 v[184:187], v15 offset:768
    v_mfma_f32_16x16x32_bf16 v[212:215], a[60:63], v[120:123], v[212:215]
    s_add_u32 s31, s31, 262144
    v_mfma_f32_16x16x32_bf16 v[216:219], a[56:59], v[124:127], v[216:219]
    ds_read_b128 v[188:191], v15 offset:33536
    v_mfma_f32_16x16x32_bf16 v[220:223], a[60:63], v[124:127], v[220:223]
    buffer_load_dwordx4 v22, s[12:15], s29 offen offset:1024 lds
    s_waitcnt lgkmcnt(12)
    v_mfma_f32_16x16x32_bf16 v[208:211], a[64:67], v[128:131], v[208:211]
    ds_read_b128 v[64:67], v12 offset:1024
    v_mfma_f32_16x16x32_bf16 v[212:215], a[68:71], v[128:131], v[212:215]
    v_mfma_f32_16x16x32_bf16 v[216:219], a[64:67], v[132:135], v[216:219]
    ds_read_b128 v[68:71], v12 offset:33792
    v_mfma_f32_16x16x32_bf16 v[220:223], a[68:71], v[132:135], v[220:223]
    buffer_load_dwordx4 v23, s[12:15], s29 offen offset:2048 lds
    v_mfma_f32_16x16x32_bf16 v[208:211], a[72:75], v[136:139], v[208:211]
    ds_read_b128 v[72:75], v13 offset:1024
    v_mfma_f32_16x16x32_bf16 v[212:215], a[76:79], v[136:139], v[212:215]
    v_mfma_f32_16x16x32_bf16 v[216:219], a[72:75], v[140:143], v[216:219]
    ds_read_b128 v[76:79], v13 offset:33792
    v_mfma_f32_16x16x32_bf16 v[220:223], a[76:79], v[140:143], v[220:223]
    buffer_load_dwordx4 v23, s[12:15], s29 offen offset:3072 lds
    s_waitcnt lgkmcnt(12)
    v_mfma_f32_16x16x32_bf16 v[208:211], a[80:83], v[144:147], v[208:211]
    ds_read_b128 v[80:83], v14 offset:1024
    v_mfma_f32_16x16x32_bf16 v[212:215], a[84:87], v[144:147], v[212:215]
    v_mfma_f32_16x16x32_bf16 v[216:219], a[80:83], v[148:151], v[216:219]
    ds_read_b128 v[84:87], v14 offset:33792
    v_mfma_f32_16x16x32_bf16 v[220:223], a[84:87], v[148:151], v[220:223]
    buffer_load_dword v29, v28, s[12:15], s29 offen
    v_mfma_f32_16x16x32_bf16 v[208:211], a[88:91], v[152:155], v[208:211]
    ds_read_b128 v[88:91], v15 offset:1024
    v_mfma_f32_16x16x32_bf16 v[212:215], a[92:95], v[152:155], v[212:215]
    v_mfma_f32_16x16x32_bf16 v[216:219], a[88:91], v[156:159], v[216:219]
    ds_read_b128 v[92:95], v15 offset:33792
    v_mfma_f32_16x16x32_bf16 v[220:223], a[92:95], v[156:159], v[220:223]
    s_waitcnt lgkmcnt(12)
    v_mfma_f32_16x16x32_bf16 v[208:211], a[96:99], v[160:163], v[208:211]
    ds_read_b128 v[96:99], v12 offset:1280
    v_mfma_f32_16x16x32_bf16 v[212:215], a[100:103], v[160:163], v[212:215]
    v_mfma_f32_16x16x32_bf16 v[216:219], a[96:99], v[164:167], v[216:219]
    ds_read_b128 v[100:103], v12 offset:34048
    v_mfma_f32_16x16x32_bf16 v[220:223], a[100:103], v[164:167], v[220:223]
    v_mfma_f32_16x16x32_bf16 v[208:211], a[104:107], v[168:171], v[208:211]
    ds_read_b128 v[104:107], v13 offset:1280
    v_mfma_f32_16x16x32_bf16 v[212:215], a[108:111], v[168:171], v[212:215]
    v_mfma_f32_16x16x32_bf16 v[216:219], a[104:107], v[172:175], v[216:219]
    ds_read_b128 v[108:111], v13 offset:34048
    v_mfma_f32_16x16x32_bf16 v[220:223], a[108:111], v[172:175], v[220:223]
    s_waitcnt lgkmcnt(12)
    v_mfma_f32_16x16x32_bf16 v[208:211], a[112:115], v[176:179], v[208:211]
    ds_read_b128 v[112:115], v14 offset:1280
    v_mfma_f32_16x16x32_bf16 v[212:215], a[116:119], v[176:179], v[212:215]
    v_mfma_f32_16x16x32_bf16 v[216:219], a[112:115], v[180:183], v[216:219]
    ds_read_b128 v[116:119], v14 offset:34048
    v_mfma_f32_16x16x32_bf16 v[220:223], a[116:119], v[180:183], v[220:223]
    v_mfma_f32_16x16x32_bf16 v[208:211], a[120:123], v[184:187], v[208:211]
    ds_read_b128 v[120:123], v15 offset:1280
    v_mfma_f32_16x16x32_bf16 v[212:215], a[124:127], v[184:187], v[212:215]
    v_mfma_f32_16x16x32_bf16 v[216:219], a[120:123], v[188:191], v[216:219]
    ds_read_b128 v[124:127], v15 offset:34048
    v_mfma_f32_16x16x32_bf16 v[220:223], a[124:127], v[188:191], v[220:223]
    s_waitcnt lgkmcnt(12)
    v_mfma_f32_16x16x32_bf16 v[208:211], a[128:131], v[64:67], v[208:211]
    ds_read_b128 v[128:131], v12 offset:1536
    v_mfma_f32_16x16x32_bf16 v[212:215], a[132:135], v[64:67], v[212:215]
    v_mfma_f32_16x16x32_bf16 v[216:219], a[128:131], v[68:71], v[216:219]
    ds_read_b128 v[132:135], v12 offset:34304
    v_mfma_f32_16x16x32_bf16 v[220:223], a[132:135], v[68:71], v[220:223]
    v_mfma_f32_16x16x32_bf16 v[208:211], a[136:139], v[72:75], v[208:211]
    ds_read_b128 v[136:139], v13 offset:1536
    v_mfma_f32_16x16x32_bf16 v[212:215], a[140:143], v[72:75], v[212:215]
    v_mfma_f32_16x16x32_bf16 v[216:219], a[136:139], v[76:79], v[216:219]
    ds_read_b128 v[140:143], v13 offset:34304
    v_mfma_f32_16x16x32_bf16 v[220:223], a[140:143], v[76:79], v[220:223]
    s_waitcnt lgkmcnt(12)
    v_mfma_f32_16x16x32_bf16 v[208:211], a[144:147], v[80:83], v[208:211]
    ds_read_b128 v[144:147], v14 offset:1536
    v_mfma_f32_16x16x32_bf16 v[212:215], a[148:151], v[80:83], v[212:215]
    v_mfma_f32_16x16x32_bf16 v[216:219], a[144:147], v[84:87], v[216:219]
    ds_read_b128 v[148:151], v14 offset:34304
    v_mfma_f32_16x16x32_bf16 v[220:223], a[148:151], v[84:87], v[220:223]
    v_mfma_f32_16x16x32_bf16 v[208:211], a[152:155], v[88:91], v[208:211]
    ds_read_b128 v[152:155], v15 offset:1536
    v_mfma_f32_16x16x32_bf16 v[212:215], a[156:159], v[88:91], v[212:215]
    v_mfma_f32_16x16x32_bf16 v[216:219], a[152:155], v[92:95], v[216:219]
    ds_read_b128 v[156:159], v15 offset:34304
    v_mfma_f32_16x16x32_bf16 v[220:223], a[156:159], v[92:95], v[220:223]
    s_waitcnt lgkmcnt(12)
    v_mfma_f32_16x16x32_bf16 v[208:211], a[160:163], v[96:99], v[208:211]
    ds_read_b128 v[160:163], v12 offset:1792
    v_mfma_f32_16x16x32_bf16 v[212:215], a[164:167], v[96:99], v[212:215]
    v_mfma_f32_16x16x32_bf16 v[216:219], a[160:163], v[100:103], v[216:219]
    ds_read_b128 v[164:167], v12 offset:34560
    v_mfma_f32_16x16x32_bf16 v[220:223], a[164:167], v[100:103], v[220:223]
    v_mfma_f32_16x16x32_bf16 v[208:211], a[168:171], v[104:107], v[208:211]
    ds_read_b128 v[168:171], v13 offset:1792
    v_mfma_f32_16x16x32_bf16 v[212:215], a[172:175], v[104:107], v[212:215]
    v_mfma_f32_16x16x32_bf16 v[216:219], a[168:171], v[108:111], v[216:219]
    ds_read_b128 v[172:175], v13 offset:34560
    v_mfma_f32_16x16x32_bf16 v[220:223], a[172:175], v[108:111], v[220:223]
    s_waitcnt lgkmcnt(12)
    v_mfma_f32_16x16x32_bf16 v[208:211], a[176:179], v[112:115], v[208:211]
    ds_read_b128 v[176:179], v14 offset:1792
    v_mfma_f32_16x16x32_bf16 v[212:215], a[180:183], v[112:115], v[212:215]
    s_waitcnt vmcnt(6)
    v_mov_b32 v27, s28
    s_mov_b64 exec, 1
    buffer_store_dword v27, v26, s[8:11], s94 offen sc1
    s_mov_b64 exec, -1
    v_mfma_f32_16x16x32_bf16 v[216:219], a[176:179], v[116:119], v[216:219]
    ds_read_b128 v[180:183], v14 offset:34560
    v_mfma_f32_16x16x32_bf16 v[220:223], a[180:183], v[116:119], v[220:223]
    v_mfma_f32_16x16x32_bf16 v[208:211], a[184:187], v[120:123], v[208:211]
    ds_read_b128 v[184:187], v15 offset:1792
    v_mfma_f32_16x16x32_bf16 v[212:215], a[188:191], v[120:123], v[212:215]
    s_add_u32 s28, s28, 1
    v_mfma_f32_16x16x32_bf16 v[216:219], a[184:187], v[124:127], v[216:219]
    ds_read_b128 v[188:191], v15 offset:34560
    v_mfma_f32_16x16x32_bf16 v[220:223], a[188:191], v[124:127], v[220:223]
    s_waitcnt lgkmcnt(12)
    v_mfma_f32_16x16x32_bf16 v[208:211], a[192:195], v[128:131], v[208:211]
    v_mfma_f32_16x16x32_bf16 v[212:215], a[196:199], v[128:131], v[212:215]
    v_mfma_f32_16x16x32_bf16 v[216:219], a[192:195], v[132:135], v[216:219]
    v_mfma_f32_16x16x32_bf16 v[220:223], a[196:199], v[132:135], v[220:223]
    v_mfma_f32_16x16x32_bf16 v[208:211], a[200:203], v[136:139], v[208:211]
    v_mfma_f32_16x16x32_bf16 v[212:215], a[204:207], v[136:139], v[212:215]
    s_add_u32 s29, s29, 0x10000
    s_and_b32 s29, s29, 0x3fffff
    v_mfma_f32_16x16x32_bf16 v[216:219], a[200:203], v[140:143], v[216:219]
    v_mfma_f32_16x16x32_bf16 v[220:223], a[204:207], v[140:143], v[220:223]
    s_waitcnt vmcnt(2) lgkmcnt(0)
    s_barrier
    v_mfma_f32_16x16x32_bf16 v[208:211], a[208:211], v[144:147], v[208:211]
    ds_read_b128 v[64:67], v8 offset:0
    ds_read_b128 v[68:71], v8 offset:32768
    v_mfma_f32_16x16x32_bf16 v[212:215], a[212:215], v[144:147], v[212:215]
    s_add_u32 m0, s6, 65536
    v_mfma_f32_16x16x32_bf16 v[216:219], a[208:211], v[148:151], v[216:219]
    ds_read_b128 v[72:75], v9 offset:0
    ds_read_b128 v[76:79], v9 offset:32768
    v_mfma_f32_16x16x32_bf16 v[220:223], a[212:215], v[148:151], v[220:223]
    buffer_load_dwordx4 v16, s[12:15], s29 offen offset:0 lds
    v_mfma_f32_16x16x32_bf16 v[208:211], a[216:219], v[152:155], v[208:211]
    ds_read_b128 v[80:83], v10 offset:0
    ds_read_b128 v[84:87], v10 offset:32768
    v_mfma_f32_16x16x32_bf16 v[212:215], a[220:223], v[152:155], v[212:215]
    v_mfma_f32_16x16x32_bf16 v[216:219], a[216:219], v[156:159], v[216:219]
    ds_read_b128 v[88:91], v11 offset:0
    ds_read_b128 v[92:95], v11 offset:32768
    v_mfma_f32_16x16x32_bf16 v[220:223], a[220:223], v[156:159], v[220:223]
    buffer_load_dwordx4 v16, s[12:15], s29 offen offset:1024 lds
    v_mfma_f32_16x16x32_bf16 v[208:211], a[224:227], v[160:163], v[208:211]
    ds_read_b128 v[96:99], v8 offset:256
    v_mfma_f32_16x16x32_bf16 v[212:215], a[228:231], v[160:163], v[212:215]
    v_mfma_f32_16x16x32_bf16 v[216:219], a[224:227], v[164:167], v[216:219]
    ds_read_b128 v[100:103], v8 offset:33024
    v_mfma_f32_16x16x32_bf16 v[220:223], a[228:231], v[164:167], v[220:223]
    buffer_load_dwordx4 v17, s[12:15], s29 offen offset:2048 lds
    v_mfma_f32_16x16x32_bf16 v[208:211], a[232:235], v[168:171], v[208:211]
    ds_read_b128 v[104:107], v9 offset:256
    v_mfma_f32_16x16x32_bf16 v[212:215], a[236:239], v[168:171], v[212:215]
    v_mfma_f32_16x16x32_bf16 v[216:219], a[232:235], v[172:175], v[216:219]
    ds_read_b128 v[108:111], v9 offset:33024
    v_mfma_f32_16x16x32_bf16 v[220:223], a[236:239], v[172:175], v[220:223]
    buffer_load_dwordx4 v17, s[12:15], s29 offen offset:3072 lds
    v_mfma_f32_16x16x32_bf16 v[208:211], a[240:243], v[176:179], v[208:211]
    ds_read_b128 v[112:115], v10 offset:256
    v_mfma_f32_16x16x32_bf16 v[212:215], a[244:247], v[176:179], v[212:215]
    s_add_u32 m0, s6, 69632
    v_mfma_f32_16x16x32_bf16 v[216:219], a[240:243], v[180:183], v[216:219]
    ds_read_b128 v[116:119], v10 offset:33024
    v_mfma_f32_16x16x32_bf16 v[220:223], a[244:247], v[180:183], v[220:223]
    buffer_load_dwordx4 v18, s[12:15], s29 offen offset:0 lds
    v_mfma_f32_16x16x32_bf16 v[208:211], a[248:251], v[184:187], v[208:211]
    ds_read_b128 v[120:123], v11 offset:256
    v_mfma_f32_16x16x32_bf16 v[212:215], a[252:255], v[184:187], v[212:215]
    v_mfma_f32_16x16x32_bf16 v[216:219], a[248:251], v[188:191], v[216:219]
    ds_read_b128 v[124:127], v11 offset:33024
    v_mfma_f32_16x16x32_bf16 v[220:223], a[252:255], v[188:191], v[220:223]
    buffer_load_dwordx4 v18, s[12:15], s29 offen offset:1024 lds
    s_cmp_lt_u32 s28, 64
    s_cbranch_scc1 .ql_344
    s_branch .qe_343
.vt_342:
.p2align 6
.ql_345:
    s_waitcnt lgkmcnt(12)
    v_mfma_f32_16x16x32_bf16 v[192:195], v[64:67], a[0:3], 0
    ds_read_b128 v[128:131], v8 offset:512
    v_mfma_f32_16x16x32_bf16 v[200:203], v[64:67], a[4:7], 0
    v_mfma_f32_16x16x32_bf16 v[196:199], v[68:71], a[0:3], 0
    ds_read_b128 v[132:135], v8 offset:33280
    v_mfma_f32_16x16x32_bf16 v[204:207], v[68:71], a[4:7], 0
    buffer_load_dwordx4 v19, s[12:15], s29 offen offset:2048 lds
    v_mfma_f32_16x16x32_bf16 v[192:195], v[72:75], a[8:11], v[192:195]
    ds_read_b128 v[136:139], v9 offset:512
    v_mfma_f32_16x16x32_bf16 v[200:203], v[72:75], a[12:15], v[200:203]
    v_cvt_pk_bf16_f32 v224, v208, v209
    v_cvt_pk_bf16_f32 v225, v210, v211
    v_mfma_f32_16x16x32_bf16 v[196:199], v[76:79], a[8:11], v[196:199]
    ds_read_b128 v[140:143], v9 offset:33280
    v_mfma_f32_16x16x32_bf16 v[204:207], v[76:79], a[12:15], v[204:207]
    buffer_load_dwordx4 v19, s[12:15], s29 offen offset:3072 lds
    s_waitcnt lgkmcnt(12)
    v_mfma_f32_16x16x32_bf16 v[192:195], v[80:83], a[16:19], v[192:195]
    ds_read_b128 v[144:147], v10 offset:512
    v_mfma_f32_16x16x32_bf16 v[200:203], v[80:83], a[20:23], v[200:203]
    s_add_u32 m0, s6, 73728
    v_cvt_pk_bf16_f32 v226, v212, v213
    v_cvt_pk_bf16_f32 v227, v214, v215
    v_mfma_f32_16x16x32_bf16 v[196:199], v[84:87], a[16:19], v[196:199]
    ds_read_b128 v[148:151], v10 offset:33280
    v_mfma_f32_16x16x32_bf16 v[204:207], v[84:87], a[20:23], v[204:207]
    buffer_load_dwordx4 v20, s[12:15], s29 offen offset:0 lds
    v_mfma_f32_16x16x32_bf16 v[192:195], v[88:91], a[24:27], v[192:195]
    ds_read_b128 v[152:155], v11 offset:512
    v_cvt_pk_bf16_f32 v228, v216, v217
    v_mfma_f32_16x16x32_bf16 v[200:203], v[88:91], a[28:31], v[200:203]
    buffer_store_dwordx4 v[224:227], v24, s[8:11], s30 offen sc1
    v_mfma_f32_16x16x32_bf16 v[196:199], v[92:95], a[24:27], v[196:199]
    ds_read_b128 v[156:159], v11 offset:33280
    v_cvt_pk_bf16_f32 v229, v218, v219
    v_mfma_f32_16x16x32_bf16 v[204:207], v[92:95], a[28:31], v[204:207]
    buffer_load_dwordx4 v20, s[12:15], s29 offen offset:1024 lds
    s_waitcnt lgkmcnt(12)
    v_mfma_f32_16x16x32_bf16 v[192:195], v[96:99], a[32:35], v[192:195]
    ds_read_b128 v[160:163], v8 offset:768
    v_mfma_f32_16x16x32_bf16 v[200:203], v[96:99], a[36:39], v[200:203]
    v_cvt_pk_bf16_f32 v230, v220, v221
    v_cvt_pk_bf16_f32 v231, v222, v223
    v_mfma_f32_16x16x32_bf16 v[196:199], v[100:103], a[32:35], v[196:199]
    ds_read_b128 v[164:167], v8 offset:33536
    v_mfma_f32_16x16x32_bf16 v[204:207], v[100:103], a[36:39], v[204:207]
    buffer_load_dwordx4 v21, s[12:15], s29 offen offset:2048 lds
    v_mfma_f32_16x16x32_bf16 v[192:195], v[104:107], a[40:43], v[192:195]
    ds_read_b128 v[168:171], v9 offset:768
    v_mfma_f32_16x16x32_bf16 v[200:203], v[104:107], a[44:47], v[200:203]
    buffer_store_dwordx4 v[228:231], v25, s[8:11], s30 offen sc1
    v_mfma_f32_16x16x32_bf16 v[196:199], v[108:111], a[40:43], v[196:199]
    ds_read_b128 v[172:175], v9 offset:33536
    v_mfma_f32_16x16x32_bf16 v[204:207], v[108:111], a[44:47], v[204:207]
    buffer_load_dwordx4 v21, s[12:15], s29 offen offset:3072 lds
    s_waitcnt lgkmcnt(12)
    v_mfma_f32_16x16x32_bf16 v[192:195], v[112:115], a[48:51], v[192:195]
    ds_read_b128 v[176:179], v10 offset:768
    v_mfma_f32_16x16x32_bf16 v[200:203], v[112:115], a[52:55], v[200:203]
    s_add_u32 m0, s6, 77824
    s_mov_b32 s30, s31
    v_mfma_f32_16x16x32_bf16 v[196:199], v[116:119], a[48:51], v[196:199]
    ds_read_b128 v[180:183], v10 offset:33536
    v_mfma_f32_16x16x32_bf16 v[204:207], v[116:119], a[52:55], v[204:207]
    buffer_load_dwordx4 v22, s[12:15], s29 offen offset:0 lds
    v_mfma_f32_16x16x32_bf16 v[192:195], v[120:123], a[56:59], v[192:195]
    ds_read_b128 v[184:187], v11 offset:768
    v_mfma_f32_16x16x32_bf16 v[200:203], v[120:123], a[60:63], v[200:203]
    s_add_u32 s31, s31, 262144
    v_mfma_f32_16x16x32_bf16 v[196:199], v[124:127], a[56:59], v[196:199]
    ds_read_b128 v[188:191], v11 offset:33536
    v_mfma_f32_16x16x32_bf16 v[204:207], v[124:127], a[60:63], v[204:207]
    buffer_load_dwordx4 v22, s[12:15], s29 offen offset:1024 lds
    s_waitcnt lgkmcnt(12)
    v_mfma_f32_16x16x32_bf16 v[192:195], v[128:131], a[64:67], v[192:195]
    ds_read_b128 v[64:67], v8 offset:1024
    v_mfma_f32_16x16x32_bf16 v[200:203], v[128:131], a[68:71], v[200:203]
    v_mfma_f32_16x16x32_bf16 v[196:199], v[132:135], a[64:67], v[196:199]
    ds_read_b128 v[68:71], v8 offset:33792
    v_mfma_f32_16x16x32_bf16 v[204:207], v[132:135], a[68:71], v[204:207]
    buffer_load_dwordx4 v23, s[12:15], s29 offen offset:2048 lds
    v_mfma_f32_16x16x32_bf16 v[192:195], v[136:139], a[72:75], v[192:195]
    ds_read_b128 v[72:75], v9 offset:1024
    v_mfma_f32_16x16x32_bf16 v[200:203], v[136:139], a[76:79], v[200:203]
    v_mfma_f32_16x16x32_bf16 v[196:199], v[140:143], a[72:75], v[196:199]
    ds_read_b128 v[76:79], v9 offset:33792
    v_mfma_f32_16x16x32_bf16 v[204:207], v[140:143], a[76:79], v[204:207]
    buffer_load_dwordx4 v23, s[12:15], s29 offen offset:3072 lds
    s_waitcnt lgkmcnt(12)
    v_mfma_f32_16x16x32_bf16 v[192:195], v[144:147], a[80:83], v[192:195]
    ds_read_b128 v[80:83], v10 offset:1024
    v_mfma_f32_16x16x32_bf16 v[200:203], v[144:147], a[84:87], v[200:203]
    v_mfma_f32_16x16x32_bf16 v[196:199], v[148:151], a[80:83], v[196:199]
    ds_read_b128 v[84:87], v10 offset:33792
    v_mfma_f32_16x16x32_bf16 v[204:207], v[148:151], a[84:87], v[204:207]
    buffer_load_dword v29, v28, s[12:15], s29 offen
    v_mfma_f32_16x16x32_bf16 v[192:195], v[152:155], a[88:91], v[192:195]
    ds_read_b128 v[88:91], v11 offset:1024
    v_mfma_f32_16x16x32_bf16 v[200:203], v[152:155], a[92:95], v[200:203]
    v_mfma_f32_16x16x32_bf16 v[196:199], v[156:159], a[88:91], v[196:199]
    ds_read_b128 v[92:95], v11 offset:33792
    v_mfma_f32_16x16x32_bf16 v[204:207], v[156:159], a[92:95], v[204:207]
    s_waitcnt lgkmcnt(12)
    v_mfma_f32_16x16x32_bf16 v[192:195], v[160:163], a[96:99], v[192:195]
    ds_read_b128 v[96:99], v8 offset:1280
    v_mfma_f32_16x16x32_bf16 v[200:203], v[160:163], a[100:103], v[200:203]
    v_mfma_f32_16x16x32_bf16 v[196:199], v[164:167], a[96:99], v[196:199]
    ds_read_b128 v[100:103], v8 offset:34048
    v_mfma_f32_16x16x32_bf16 v[204:207], v[164:167], a[100:103], v[204:207]
    v_mfma_f32_16x16x32_bf16 v[192:195], v[168:171], a[104:107], v[192:195]
    ds_read_b128 v[104:107], v9 offset:1280
    v_mfma_f32_16x16x32_bf16 v[200:203], v[168:171], a[108:111], v[200:203]
    v_mfma_f32_16x16x32_bf16 v[196:199], v[172:175], a[104:107], v[196:199]
    ds_read_b128 v[108:111], v9 offset:34048
    v_mfma_f32_16x16x32_bf16 v[204:207], v[172:175], a[108:111], v[204:207]
    s_waitcnt lgkmcnt(12)
    v_mfma_f32_16x16x32_bf16 v[192:195], v[176:179], a[112:115], v[192:195]
    ds_read_b128 v[112:115], v10 offset:1280
    v_mfma_f32_16x16x32_bf16 v[200:203], v[176:179], a[116:119], v[200:203]
    v_mfma_f32_16x16x32_bf16 v[196:199], v[180:183], a[112:115], v[196:199]
    ds_read_b128 v[116:119], v10 offset:34048
    v_mfma_f32_16x16x32_bf16 v[204:207], v[180:183], a[116:119], v[204:207]
    v_mfma_f32_16x16x32_bf16 v[192:195], v[184:187], a[120:123], v[192:195]
    ds_read_b128 v[120:123], v11 offset:1280
    v_mfma_f32_16x16x32_bf16 v[200:203], v[184:187], a[124:127], v[200:203]
    v_mfma_f32_16x16x32_bf16 v[196:199], v[188:191], a[120:123], v[196:199]
    ds_read_b128 v[124:127], v11 offset:34048
    v_mfma_f32_16x16x32_bf16 v[204:207], v[188:191], a[124:127], v[204:207]
    s_waitcnt lgkmcnt(12)
    v_mfma_f32_16x16x32_bf16 v[192:195], v[64:67], a[128:131], v[192:195]
    ds_read_b128 v[128:131], v8 offset:1536
    v_mfma_f32_16x16x32_bf16 v[200:203], v[64:67], a[132:135], v[200:203]
    v_mfma_f32_16x16x32_bf16 v[196:199], v[68:71], a[128:131], v[196:199]
    ds_read_b128 v[132:135], v8 offset:34304
    v_mfma_f32_16x16x32_bf16 v[204:207], v[68:71], a[132:135], v[204:207]
    v_mfma_f32_16x16x32_bf16 v[192:195], v[72:75], a[136:139], v[192:195]
    ds_read_b128 v[136:139], v9 offset:1536
    v_mfma_f32_16x16x32_bf16 v[200:203], v[72:75], a[140:143], v[200:203]
    v_mfma_f32_16x16x32_bf16 v[196:199], v[76:79], a[136:139], v[196:199]
    ds_read_b128 v[140:143], v9 offset:34304
    v_mfma_f32_16x16x32_bf16 v[204:207], v[76:79], a[140:143], v[204:207]
    s_waitcnt lgkmcnt(12)
    v_mfma_f32_16x16x32_bf16 v[192:195], v[80:83], a[144:147], v[192:195]
    ds_read_b128 v[144:147], v10 offset:1536
    v_mfma_f32_16x16x32_bf16 v[200:203], v[80:83], a[148:151], v[200:203]
    v_mfma_f32_16x16x32_bf16 v[196:199], v[84:87], a[144:147], v[196:199]
    ds_read_b128 v[148:151], v10 offset:34304
    v_mfma_f32_16x16x32_bf16 v[204:207], v[84:87], a[148:151], v[204:207]
    v_mfma_f32_16x16x32_bf16 v[192:195], v[88:91], a[152:155], v[192:195]
    ds_read_b128 v[152:155], v11 offset:1536
    v_mfma_f32_16x16x32_bf16 v[200:203], v[88:91], a[156:159], v[200:203]
    v_mfma_f32_16x16x32_bf16 v[196:199], v[92:95], a[152:155], v[196:199]
    ds_read_b128 v[156:159], v11 offset:34304
    v_mfma_f32_16x16x32_bf16 v[204:207], v[92:95], a[156:159], v[204:207]
    s_waitcnt lgkmcnt(12)
    v_mfma_f32_16x16x32_bf16 v[192:195], v[96:99], a[160:163], v[192:195]
    ds_read_b128 v[160:163], v8 offset:1792
    v_mfma_f32_16x16x32_bf16 v[200:203], v[96:99], a[164:167], v[200:203]
    v_mfma_f32_16x16x32_bf16 v[196:199], v[100:103], a[160:163], v[196:199]
    ds_read_b128 v[164:167], v8 offset:34560
    v_mfma_f32_16x16x32_bf16 v[204:207], v[100:103], a[164:167], v[204:207]
    v_mfma_f32_16x16x32_bf16 v[192:195], v[104:107], a[168:171], v[192:195]
    ds_read_b128 v[168:171], v9 offset:1792
    v_mfma_f32_16x16x32_bf16 v[200:203], v[104:107], a[172:175], v[200:203]
    v_mfma_f32_16x16x32_bf16 v[196:199], v[108:111], a[168:171], v[196:199]
    ds_read_b128 v[172:175], v9 offset:34560
    v_mfma_f32_16x16x32_bf16 v[204:207], v[108:111], a[172:175], v[204:207]
    s_waitcnt lgkmcnt(12)
    v_mfma_f32_16x16x32_bf16 v[192:195], v[112:115], a[176:179], v[192:195]
    ds_read_b128 v[176:179], v10 offset:1792
    v_mfma_f32_16x16x32_bf16 v[200:203], v[112:115], a[180:183], v[200:203]
    s_waitcnt vmcnt(6)
    v_mov_b32 v27, s28
    s_mov_b64 exec, 1
    buffer_store_dword v27, v26, s[8:11], s94 offen sc1
    s_mov_b64 exec, -1
    v_mfma_f32_16x16x32_bf16 v[196:199], v[116:119], a[176:179], v[196:199]
    ds_read_b128 v[180:183], v10 offset:34560
    v_mfma_f32_16x16x32_bf16 v[204:207], v[116:119], a[180:183], v[204:207]
    v_mfma_f32_16x16x32_bf16 v[192:195], v[120:123], a[184:187], v[192:195]
    ds_read_b128 v[184:187], v11 offset:1792
    v_mfma_f32_16x16x32_bf16 v[200:203], v[120:123], a[188:191], v[200:203]
    s_add_u32 s28, s28, 1
    v_mfma_f32_16x16x32_bf16 v[196:199], v[124:127], a[184:187], v[196:199]
    ds_read_b128 v[188:191], v11 offset:34560
    v_mfma_f32_16x16x32_bf16 v[204:207], v[124:127], a[188:191], v[204:207]
    s_waitcnt lgkmcnt(12)
    v_mfma_f32_16x16x32_bf16 v[192:195], v[128:131], a[192:195], v[192:195]
    v_mfma_f32_16x16x32_bf16 v[200:203], v[128:131], a[196:199], v[200:203]
    v_mfma_f32_16x16x32_bf16 v[196:199], v[132:135], a[192:195], v[196:199]
    v_mfma_f32_16x16x32_bf16 v[204:207], v[132:135], a[196:199], v[204:207]
    v_mfma_f32_16x16x32_bf16 v[192:195], v[136:139], a[200:203], v[192:195]
    v_mfma_f32_16x16x32_bf16 v[200:203], v[136:139], a[204:207], v[200:203]
    s_add_u32 s29, s29, 0x10000
    s_and_b32 s29, s29, 0x3fffff
    v_mfma_f32_16x16x32_bf16 v[196:199], v[140:143], a[200:203], v[196:199]
    v_mfma_f32_16x16x32_bf16 v[204:207], v[140:143], a[204:207], v[204:207]
    s_waitcnt vmcnt(2) lgkmcnt(0)
    s_barrier
    v_mfma_f32_16x16x32_bf16 v[192:195], v[144:147], a[208:211], v[192:195]
    ds_read_b128 v[64:67], v12 offset:0
    ds_read_b128 v[68:71], v12 offset:32768
    v_mfma_f32_16x16x32_bf16 v[200:203], v[144:147], a[212:215], v[200:203]
    s_add_u32 m0, s6, 0
    v_mfma_f32_16x16x32_bf16 v[196:199], v[148:151], a[208:211], v[196:199]
    ds_read_b128 v[72:75], v13 offset:0
    ds_read_b128 v[76:79], v13 offset:32768
    v_mfma_f32_16x16x32_bf16 v[204:207], v[148:151], a[212:215], v[204:207]
    buffer_load_dwordx4 v16, s[12:15], s29 offen offset:0 lds
    v_mfma_f32_16x16x32_bf16 v[192:195], v[152:155], a[216:219], v[192:195]
    ds_read_b128 v[80:83], v14 offset:0
    ds_read_b128 v[84:87], v14 offset:32768
    v_mfma_f32_16x16x32_bf16 v[200:203], v[152:155], a[220:223], v[200:203]
    v_mfma_f32_16x16x32_bf16 v[196:199], v[156:159], a[216:219], v[196:199]
    ds_read_b128 v[88:91], v15 offset:0
    ds_read_b128 v[92:95], v15 offset:32768
    v_mfma_f32_16x16x32_bf16 v[204:207], v[156:159], a[220:223], v[204:207]
    buffer_load_dwordx4 v16, s[12:15], s29 offen offset:1024 lds
    v_mfma_f32_16x16x32_bf16 v[192:195], v[160:163], a[224:227], v[192:195]
    ds_read_b128 v[96:99], v12 offset:256
    v_mfma_f32_16x16x32_bf16 v[200:203], v[160:163], a[228:231], v[200:203]
    v_mfma_f32_16x16x32_bf16 v[196:199], v[164:167], a[224:227], v[196:199]
    ds_read_b128 v[100:103], v12 offset:33024
    v_mfma_f32_16x16x32_bf16 v[204:207], v[164:167], a[228:231], v[204:207]
    buffer_load_dwordx4 v17, s[12:15], s29 offen offset:2048 lds
    v_mfma_f32_16x16x32_bf16 v[192:195], v[168:171], a[232:235], v[192:195]
    ds_read_b128 v[104:107], v13 offset:256
    v_mfma_f32_16x16x32_bf16 v[200:203], v[168:171], a[236:239], v[200:203]
    v_mfma_f32_16x16x32_bf16 v[196:199], v[172:175], a[232:235], v[196:199]
    ds_read_b128 v[108:111], v13 offset:33024
    v_mfma_f32_16x16x32_bf16 v[204:207], v[172:175], a[236:239], v[204:207]
    buffer_load_dwordx4 v17, s[12:15], s29 offen offset:3072 lds
    v_mfma_f32_16x16x32_bf16 v[192:195], v[176:179], a[240:243], v[192:195]
    ds_read_b128 v[112:115], v14 offset:256
    v_mfma_f32_16x16x32_bf16 v[200:203], v[176:179], a[244:247], v[200:203]
    s_add_u32 m0, s6, 4096
    v_mfma_f32_16x16x32_bf16 v[196:199], v[180:183], a[240:243], v[196:199]
    ds_read_b128 v[116:119], v14 offset:33024
    v_mfma_f32_16x16x32_bf16 v[204:207], v[180:183], a[244:247], v[204:207]
    buffer_load_dwordx4 v18, s[12:15], s29 offen offset:0 lds
    v_mfma_f32_16x16x32_bf16 v[192:195], v[184:187], a[248:251], v[192:195]
    ds_read_b128 v[120:123], v15 offset:256
    v_mfma_f32_16x16x32_bf16 v[200:203], v[184:187], a[252:255], v[200:203]
    v_mfma_f32_16x16x32_bf16 v[196:199], v[188:191], a[248:251], v[196:199]
    ds_read_b128 v[124:127], v15 offset:33024
    v_mfma_f32_16x16x32_bf16 v[204:207], v[188:191], a[252:255], v[204:207]
    buffer_load_dwordx4 v18, s[12:15], s29 offen offset:1024 lds
    s_waitcnt lgkmcnt(12)
    v_mfma_f32_16x16x32_bf16 v[208:211], v[64:67], a[0:3], 0
    ds_read_b128 v[128:131], v12 offset:512
    v_mfma_f32_16x16x32_bf16 v[216:219], v[64:67], a[4:7], 0
    v_mfma_f32_16x16x32_bf16 v[212:215], v[68:71], a[0:3], 0
    ds_read_b128 v[132:135], v12 offset:33280
    v_mfma_f32_16x16x32_bf16 v[220:223], v[68:71], a[4:7], 0
    buffer_load_dwordx4 v19, s[12:15], s29 offen offset:2048 lds
    v_mfma_f32_16x16x32_bf16 v[208:211], v[72:75], a[8:11], v[208:211]
    ds_read_b128 v[136:139], v13 offset:512
    v_mfma_f32_16x16x32_bf16 v[216:219], v[72:75], a[12:15], v[216:219]
    v_cvt_pk_bf16_f32 v224, v192, v193
    v_cvt_pk_bf16_f32 v225, v194, v195
    v_mfma_f32_16x16x32_bf16 v[212:215], v[76:79], a[8:11], v[212:215]
    ds_read_b128 v[140:143], v13 offset:33280
    v_mfma_f32_16x16x32_bf16 v[220:223], v[76:79], a[12:15], v[220:223]
    buffer_load_dwordx4 v19, s[12:15], s29 offen offset:3072 lds
    s_waitcnt lgkmcnt(12)
    v_mfma_f32_16x16x32_bf16 v[208:211], v[80:83], a[16:19], v[208:211]
    ds_read_b128 v[144:147], v14 offset:512
    v_mfma_f32_16x16x32_bf16 v[216:219], v[80:83], a[20:23], v[216:219]
    s_add_u32 m0, s6, 8192
    v_cvt_pk_bf16_f32 v226, v196, v197
    v_cvt_pk_bf16_f32 v227, v198, v199
    v_mfma_f32_16x16x32_bf16 v[212:215], v[84:87], a[16:19], v[212:215]
    ds_read_b128 v[148:151], v14 offset:33280
    v_mfma_f32_16x16x32_bf16 v[220:223], v[84:87], a[20:23], v[220:223]
    buffer_load_dwordx4 v20, s[12:15], s29 offen offset:0 lds
    v_mfma_f32_16x16x32_bf16 v[208:211], v[88:91], a[24:27], v[208:211]
    ds_read_b128 v[152:155], v15 offset:512
    v_cvt_pk_bf16_f32 v228, v200, v201
    v_mfma_f32_16x16x32_bf16 v[216:219], v[88:91], a[28:31], v[216:219]
    buffer_store_dwordx4 v[224:227], v24, s[8:11], s30 offen sc1
    v_mfma_f32_16x16x32_bf16 v[212:215], v[92:95], a[24:27], v[212:215]
    ds_read_b128 v[156:159], v15 offset:33280
    v_cvt_pk_bf16_f32 v229, v202, v203
    v_mfma_f32_16x16x32_bf16 v[220:223], v[92:95], a[28:31], v[220:223]
    buffer_load_dwordx4 v20, s[12:15], s29 offen offset:1024 lds
    s_waitcnt lgkmcnt(12)
    v_mfma_f32_16x16x32_bf16 v[208:211], v[96:99], a[32:35], v[208:211]
    ds_read_b128 v[160:163], v12 offset:768
    v_mfma_f32_16x16x32_bf16 v[216:219], v[96:99], a[36:39], v[216:219]
    v_cvt_pk_bf16_f32 v230, v204, v205
    v_cvt_pk_bf16_f32 v231, v206, v207
    v_mfma_f32_16x16x32_bf16 v[212:215], v[100:103], a[32:35], v[212:215]
    ds_read_b128 v[164:167], v12 offset:33536
    v_mfma_f32_16x16x32_bf16 v[220:223], v[100:103], a[36:39], v[220:223]
    buffer_load_dwordx4 v21, s[12:15], s29 offen offset:2048 lds
    v_mfma_f32_16x16x32_bf16 v[208:211], v[104:107], a[40:43], v[208:211]
    ds_read_b128 v[168:171], v13 offset:768
    v_mfma_f32_16x16x32_bf16 v[216:219], v[104:107], a[44:47], v[216:219]
    buffer_store_dwordx4 v[228:231], v25, s[8:11], s30 offen sc1
    v_mfma_f32_16x16x32_bf16 v[212:215], v[108:111], a[40:43], v[212:215]
    ds_read_b128 v[172:175], v13 offset:33536
    v_mfma_f32_16x16x32_bf16 v[220:223], v[108:111], a[44:47], v[220:223]
    buffer_load_dwordx4 v21, s[12:15], s29 offen offset:3072 lds
    s_waitcnt lgkmcnt(12)
    v_mfma_f32_16x16x32_bf16 v[208:211], v[112:115], a[48:51], v[208:211]
    ds_read_b128 v[176:179], v14 offset:768
    v_mfma_f32_16x16x32_bf16 v[216:219], v[112:115], a[52:55], v[216:219]
    s_add_u32 m0, s6, 12288
    s_mov_b32 s30, s31
    v_mfma_f32_16x16x32_bf16 v[212:215], v[116:119], a[48:51], v[212:215]
    ds_read_b128 v[180:183], v14 offset:33536
    v_mfma_f32_16x16x32_bf16 v[220:223], v[116:119], a[52:55], v[220:223]
    buffer_load_dwordx4 v22, s[12:15], s29 offen offset:0 lds
    v_mfma_f32_16x16x32_bf16 v[208:211], v[120:123], a[56:59], v[208:211]
    ds_read_b128 v[184:187], v15 offset:768
    v_mfma_f32_16x16x32_bf16 v[216:219], v[120:123], a[60:63], v[216:219]
    s_add_u32 s31, s31, 262144
    v_mfma_f32_16x16x32_bf16 v[212:215], v[124:127], a[56:59], v[212:215]
    ds_read_b128 v[188:191], v15 offset:33536
    v_mfma_f32_16x16x32_bf16 v[220:223], v[124:127], a[60:63], v[220:223]
    buffer_load_dwordx4 v22, s[12:15], s29 offen offset:1024 lds
    s_waitcnt lgkmcnt(12)
    v_mfma_f32_16x16x32_bf16 v[208:211], v[128:131], a[64:67], v[208:211]
    ds_read_b128 v[64:67], v12 offset:1024
    v_mfma_f32_16x16x32_bf16 v[216:219], v[128:131], a[68:71], v[216:219]
    v_mfma_f32_16x16x32_bf16 v[212:215], v[132:135], a[64:67], v[212:215]
    ds_read_b128 v[68:71], v12 offset:33792
    v_mfma_f32_16x16x32_bf16 v[220:223], v[132:135], a[68:71], v[220:223]
    buffer_load_dwordx4 v23, s[12:15], s29 offen offset:2048 lds
    v_mfma_f32_16x16x32_bf16 v[208:211], v[136:139], a[72:75], v[208:211]
    ds_read_b128 v[72:75], v13 offset:1024
    v_mfma_f32_16x16x32_bf16 v[216:219], v[136:139], a[76:79], v[216:219]
    v_mfma_f32_16x16x32_bf16 v[212:215], v[140:143], a[72:75], v[212:215]
    ds_read_b128 v[76:79], v13 offset:33792
    v_mfma_f32_16x16x32_bf16 v[220:223], v[140:143], a[76:79], v[220:223]
    buffer_load_dwordx4 v23, s[12:15], s29 offen offset:3072 lds
    s_waitcnt lgkmcnt(12)
    v_mfma_f32_16x16x32_bf16 v[208:211], v[144:147], a[80:83], v[208:211]
    ds_read_b128 v[80:83], v14 offset:1024
    v_mfma_f32_16x16x32_bf16 v[216:219], v[144:147], a[84:87], v[216:219]
    v_mfma_f32_16x16x32_bf16 v[212:215], v[148:151], a[80:83], v[212:215]
    ds_read_b128 v[84:87], v14 offset:33792
    v_mfma_f32_16x16x32_bf16 v[220:223], v[148:151], a[84:87], v[220:223]
    buffer_load_dword v29, v28, s[12:15], s29 offen
    v_mfma_f32_16x16x32_bf16 v[208:211], v[152:155], a[88:91], v[208:211]
    ds_read_b128 v[88:91], v15 offset:1024
    v_mfma_f32_16x16x32_bf16 v[216:219], v[152:155], a[92:95], v[216:219]
    v_mfma_f32_16x16x32_bf16 v[212:215], v[156:159], a[88:91], v[212:215]
    ds_read_b128 v[92:95], v15 offset:33792
    v_mfma_f32_16x16x32_bf16 v[220:223], v[156:159], a[92:95], v[220:223]
    s_waitcnt lgkmcnt(12)
    v_mfma_f32_16x16x32_bf16 v[208:211], v[160:163], a[96:99], v[208:211]
    ds_read_b128 v[96:99], v12 offset:1280
    v_mfma_f32_16x16x32_bf16 v[216:219], v[160:163], a[100:103], v[216:219]
    v_mfma_f32_16x16x32_bf16 v[212:215], v[164:167], a[96:99], v[212:215]
    ds_read_b128 v[100:103], v12 offset:34048
    v_mfma_f32_16x16x32_bf16 v[220:223], v[164:167], a[100:103], v[220:223]
    v_mfma_f32_16x16x32_bf16 v[208:211], v[168:171], a[104:107], v[208:211]
    ds_read_b128 v[104:107], v13 offset:1280
    v_mfma_f32_16x16x32_bf16 v[216:219], v[168:171], a[108:111], v[216:219]
    v_mfma_f32_16x16x32_bf16 v[212:215], v[172:175], a[104:107], v[212:215]
    ds_read_b128 v[108:111], v13 offset:34048
    v_mfma_f32_16x16x32_bf16 v[220:223], v[172:175], a[108:111], v[220:223]
    s_waitcnt lgkmcnt(12)
    v_mfma_f32_16x16x32_bf16 v[208:211], v[176:179], a[112:115], v[208:211]
    ds_read_b128 v[112:115], v14 offset:1280
    v_mfma_f32_16x16x32_bf16 v[216:219], v[176:179], a[116:119], v[216:219]
    v_mfma_f32_16x16x32_bf16 v[212:215], v[180:183], a[112:115], v[212:215]
    ds_read_b128 v[116:119], v14 offset:34048
    v_mfma_f32_16x16x32_bf16 v[220:223], v[180:183], a[116:119], v[220:223]
    v_mfma_f32_16x16x32_bf16 v[208:211], v[184:187], a[120:123], v[208:211]
    ds_read_b128 v[120:123], v15 offset:1280
    v_mfma_f32_16x16x32_bf16 v[216:219], v[184:187], a[124:127], v[216:219]
    v_mfma_f32_16x16x32_bf16 v[212:215], v[188:191], a[120:123], v[212:215]
    ds_read_b128 v[124:127], v15 offset:34048
    v_mfma_f32_16x16x32_bf16 v[220:223], v[188:191], a[124:127], v[220:223]
    s_waitcnt lgkmcnt(12)
    v_mfma_f32_16x16x32_bf16 v[208:211], v[64:67], a[128:131], v[208:211]
    ds_read_b128 v[128:131], v12 offset:1536
    v_mfma_f32_16x16x32_bf16 v[216:219], v[64:67], a[132:135], v[216:219]
    v_mfma_f32_16x16x32_bf16 v[212:215], v[68:71], a[128:131], v[212:215]
    ds_read_b128 v[132:135], v12 offset:34304
    v_mfma_f32_16x16x32_bf16 v[220:223], v[68:71], a[132:135], v[220:223]
    v_mfma_f32_16x16x32_bf16 v[208:211], v[72:75], a[136:139], v[208:211]
    ds_read_b128 v[136:139], v13 offset:1536
    v_mfma_f32_16x16x32_bf16 v[216:219], v[72:75], a[140:143], v[216:219]
    v_mfma_f32_16x16x32_bf16 v[212:215], v[76:79], a[136:139], v[212:215]
    ds_read_b128 v[140:143], v13 offset:34304
    v_mfma_f32_16x16x32_bf16 v[220:223], v[76:79], a[140:143], v[220:223]
    s_waitcnt lgkmcnt(12)
    v_mfma_f32_16x16x32_bf16 v[208:211], v[80:83], a[144:147], v[208:211]
    ds_read_b128 v[144:147], v14 offset:1536
    v_mfma_f32_16x16x32_bf16 v[216:219], v[80:83], a[148:151], v[216:219]
    v_mfma_f32_16x16x32_bf16 v[212:215], v[84:87], a[144:147], v[212:215]
    ds_read_b128 v[148:151], v14 offset:34304
    v_mfma_f32_16x16x32_bf16 v[220:223], v[84:87], a[148:151], v[220:223]
    v_mfma_f32_16x16x32_bf16 v[208:211], v[88:91], a[152:155], v[208:211]
    ds_read_b128 v[152:155], v15 offset:1536
    v_mfma_f32_16x16x32_bf16 v[216:219], v[88:91], a[156:159], v[216:219]
    v_mfma_f32_16x16x32_bf16 v[212:215], v[92:95], a[152:155], v[212:215]
    ds_read_b128 v[156:159], v15 offset:34304
    v_mfma_f32_16x16x32_bf16 v[220:223], v[92:95], a[156:159], v[220:223]
    s_waitcnt lgkmcnt(12)
    v_mfma_f32_16x16x32_bf16 v[208:211], v[96:99], a[160:163], v[208:211]
    ds_read_b128 v[160:163], v12 offset:1792
    v_mfma_f32_16x16x32_bf16 v[216:219], v[96:99], a[164:167], v[216:219]
    v_mfma_f32_16x16x32_bf16 v[212:215], v[100:103], a[160:163], v[212:215]
    ds_read_b128 v[164:167], v12 offset:34560
    v_mfma_f32_16x16x32_bf16 v[220:223], v[100:103], a[164:167], v[220:223]
    v_mfma_f32_16x16x32_bf16 v[208:211], v[104:107], a[168:171], v[208:211]
    ds_read_b128 v[168:171], v13 offset:1792
    v_mfma_f32_16x16x32_bf16 v[216:219], v[104:107], a[172:175], v[216:219]
    v_mfma_f32_16x16x32_bf16 v[212:215], v[108:111], a[168:171], v[212:215]
    ds_read_b128 v[172:175], v13 offset:34560
    v_mfma_f32_16x16x32_bf16 v[220:223], v[108:111], a[172:175], v[220:223]
    s_waitcnt lgkmcnt(12)
    v_mfma_f32_16x16x32_bf16 v[208:211], v[112:115], a[176:179], v[208:211]
    ds_read_b128 v[176:179], v14 offset:1792
    v_mfma_f32_16x16x32_bf16 v[216:219], v[112:115], a[180:183], v[216:219]
    s_waitcnt vmcnt(6)
    v_mov_b32 v27, s28
    s_mov_b64 exec, 1
    buffer_store_dword v27, v26, s[8:11], s94 offen sc1
    s_mov_b64 exec, -1
    v_mfma_f32_16x16x32_bf16 v[212:215], v[116:119], a[176:179], v[212:215]
    ds_read_b128 v[180:183], v14 offset:34560
    v_mfma_f32_16x16x32_bf16 v[220:223], v[116:119], a[180:183], v[220:223]
    v_mfma_f32_16x16x32_bf16 v[208:211], v[120:123], a[184:187], v[208:211]
    ds_read_b128 v[184:187], v15 offset:1792
    v_mfma_f32_16x16x32_bf16 v[216:219], v[120:123], a[188:191], v[216:219]
    s_add_u32 s28, s28, 1
    v_mfma_f32_16x16x32_bf16 v[212:215], v[124:127], a[184:187], v[212:215]
    ds_read_b128 v[188:191], v15 offset:34560
    v_mfma_f32_16x16x32_bf16 v[220:223], v[124:127], a[188:191], v[220:223]
    s_waitcnt lgkmcnt(12)
    v_mfma_f32_16x16x32_bf16 v[208:211], v[128:131], a[192:195], v[208:211]
    v_mfma_f32_16x16x32_bf16 v[216:219], v[128:131], a[196:199], v[216:219]
    v_mfma_f32_16x16x32_bf16 v[212:215], v[132:135], a[192:195], v[212:215]
    v_mfma_f32_16x16x32_bf16 v[220:223], v[132:135], a[196:199], v[220:223]
    v_mfma_f32_16x16x32_bf16 v[208:211], v[136:139], a[200:203], v[208:211]
    v_mfma_f32_16x16x32_bf16 v[216:219], v[136:139], a[204:207], v[216:219]
    s_add_u32 s29, s29, 0x10000
    s_and_b32 s29, s29, 0x3fffff
    v_mfma_f32_16x16x32_bf16 v[212:215], v[140:143], a[200:203], v[212:215]
    v_mfma_f32_16x16x32_bf16 v[220:223], v[140:143], a[204:207], v[220:223]
    s_waitcnt vmcnt(2) lgkmcnt(0)
    s_barrier
    v_mfma_f32_16x16x32_bf16 v[208:211], v[144:147], a[208:211], v[208:211]
    ds_read_b128 v[64:67], v8 offset:0
    ds_read_b128 v[68:71], v8 offset:32768
    v_mfma_f32_16x16x32_bf16 v[216:219], v[144:147], a[212:215], v[216:219]
    s_add_u32 m0, s6, 65536
    v_mfma_f32_16x16x32_bf16 v[212:215], v[148:151], a[208:211], v[212:215]
    ds_read_b128 v[72:75], v9 offset:0
    ds_read_b128 v[76:79], v9 offset:32768
    v_mfma_f32_16x16x32_bf16 v[220:223], v[148:151], a[212:215], v[220:223]
    buffer_load_dwordx4 v16, s[12:15], s29 offen offset:0 lds
    v_mfma_f32_16x16x32_bf16 v[208:211], v[152:155], a[216:219], v[208:211]
    ds_read_b128 v[80:83], v10 offset:0
    ds_read_b128 v[84:87], v10 offset:32768
    v_mfma_f32_16x16x32_bf16 v[216:219], v[152:155], a[220:223], v[216:219]
    v_mfma_f32_16x16x32_bf16 v[212:215], v[156:159], a[216:219], v[212:215]
    ds_read_b128 v[88:91], v11 offset:0
    ds_read_b128 v[92:95], v11 offset:32768
    v_mfma_f32_16x16x32_bf16 v[220:223], v[156:159], a[220:223], v[220:223]
    buffer_load_dwordx4 v16, s[12:15], s29 offen offset:1024 lds
    v_mfma_f32_16x16x32_bf16 v[208:211], v[160:163], a[224:227], v[208:211]
    ds_read_b128 v[96:99], v8 offset:256
    v_mfma_f32_16x16x32_bf16 v[216:219], v[160:163], a[228:231], v[216:219]
    v_mfma_f32_16x16x32_bf16 v[212:215], v[164:167], a[224:227], v[212:215]
    ds_read_b128 v[100:103], v8 offset:33024
    v_mfma_f32_16x16x32_bf16 v[220:223], v[164:167], a[228:231], v[220:223]
    buffer_load_dwordx4 v17, s[12:15], s29 offen offset:2048 lds
    v_mfma_f32_16x16x32_bf16 v[208:211], v[168:171], a[232:235], v[208:211]
    ds_read_b128 v[104:107], v9 offset:256
    v_mfma_f32_16x16x32_bf16 v[216:219], v[168:171], a[236:239], v[216:219]
    v_mfma_f32_16x16x32_bf16 v[212:215], v[172:175], a[232:235], v[212:215]
    ds_read_b128 v[108:111], v9 offset:33024
    v_mfma_f32_16x16x32_bf16 v[220:223], v[172:175], a[236:239], v[220:223]
    buffer_load_dwordx4 v17, s[12:15], s29 offen offset:3072 lds
    v_mfma_f32_16x16x32_bf16 v[208:211], v[176:179], a[240:243], v[208:211]
    ds_read_b128 v[112:115], v10 offset:256
    v_mfma_f32_16x16x32_bf16 v[216:219], v[176:179], a[244:247], v[216:219]
    s_add_u32 m0, s6, 69632
    v_mfma_f32_16x16x32_bf16 v[212:215], v[180:183], a[240:243], v[212:215]
    ds_read_b128 v[116:119], v10 offset:33024
    v_mfma_f32_16x16x32_bf16 v[220:223], v[180:183], a[244:247], v[220:223]
    buffer_load_dwordx4 v18, s[12:15], s29 offen offset:0 lds
    v_mfma_f32_16x16x32_bf16 v[208:211], v[184:187], a[248:251], v[208:211]
    ds_read_b128 v[120:123], v11 offset:256
    v_mfma_f32_16x16x32_bf16 v[216:219], v[184:187], a[252:255], v[216:219]
    v_mfma_f32_16x16x32_bf16 v[212:215], v[188:191], a[248:251], v[212:215]
    ds_read_b128 v[124:127], v11 offset:33024
    v_mfma_f32_16x16x32_bf16 v[220:223], v[188:191], a[252:255], v[220:223]
    buffer_load_dwordx4 v18, s[12:15], s29 offen offset:1024 lds
    s_cmp_lt_u32 s28, 64
    s_cbranch_scc1 .ql_345
.qe_343:
    s_nop 7
    v_cvt_pk_bf16_f32 v224, v208, v209
    v_cvt_pk_bf16_f32 v225, v210, v211
    v_cvt_pk_bf16_f32 v226, v212, v213
    v_cvt_pk_bf16_f32 v227, v214, v215
    v_cvt_pk_bf16_f32 v228, v216, v217
    v_cvt_pk_bf16_f32 v229, v218, v219
    v_cvt_pk_bf16_f32 v230, v220, v221
    v_cvt_pk_bf16_f32 v231, v222, v223
    buffer_store_dwordx4 v[224:227], v24, s[8:11], s30 offen sc1
    buffer_store_dwordx4 v[228:231], v25, s[8:11], s30 offen sc1
    s_cmp_eq_u32 s98, 0
    s_cbranch_scc1 .qa_341
    s_waitcnt vmcnt(0) lgkmcnt(0)
    v_mov_b32 v27, s28
    s_mov_b64 exec, 1
    buffer_store_dword v27, v26, s[8:11], s94 offen sc1
    s_mov_b64 exec, -1
    s_barrier
    s_sub_u32 s95, s98, 1
    s_load_dwordx8 s[40:47], s[0:1], 0
    s_load_dwordx4 s[48:51], s[0:1], 32
    s_load_dwordx2 s[52:53], s[0:1], 104
    s_mul_i32 s6, s24, 8320
    s_add_u32 s6, s6, 122880
    s_lshl_b32 s97, s95, 4
    s_and_b32 s4, s99, 16
    s_add_u32 s97, s97, s4
    s_add_u32 s97, s97, s99
    s_lshl_b32 s4, s97, 16
    s_lshl_b32 s5, s24, 14
    s_add_u32 s4, s4, s5
    v_lshlrev_b32 v2, 4, v1
    v_bfe_u32 v254, v1, 0, 3
    v_mul_u32_u24 v3, 2048, v254
    v_bfe_u32 v254, v1, 4, 2
    v_mul_u32_u24 v254, 16, v254
    v_add_u32 v3, v3, v254
    v_add_u32 v3, s4, v3
    v_bfe_u32 v254, v1, 4, 2
    v_mul_u32_u24 v4, 16, v254
    v_add_u32 v4, s6, v4
    s_waitcnt lgkmcnt(0)
    s_mov_b32 s12, s40
    s_and_b32 s13, s41, 0xffff
    s_mov_b32 s14, 0x400000
    s_mov_b32 s15, 0x00020000
    s_mov_b32 s16, s42
    s_and_b32 s17, s43, 0xffff
    s_mov_b32 s18, 0x400000
    s_mov_b32 s19, 0x00020000
    s_mov_b32 s28, s44
    s_and_b32 s29, s45, 0xffff
    s_mov_b32 s30, 0x400000
    s_mov_b32 s31, 0x00020000
    s_mov_b32 s32, s46
    s_and_b32 s33, s47, 0xffff
    s_mov_b32 s34, 0x2000
    s_mov_b32 s35, 0x00020000
    s_mov_b32 s36, s48
    s_and_b32 s37, s49, 0xffff
    s_mov_b32 s38, 0x400000
    s_mov_b32 s39, 0x00020000
    s_mov_b32 s56, s52
    s_and_b32 s57, s53, 0xffff
    s_mov_b32 s58, 0x800
    s_mov_b32 s59, 0x00020000
    s_mov_b32 m0, s6
    s_lshl_b32 s60, s97, 4
    buffer_load_dwordx4 v2, s[56:59], 0 offen lds
    buffer_load_dwordx4 v2, s[56:59], 0 offen offset:1024 lds
    s_add_u32 s61, s60, s24
    v_subrev_u32 v5, 4, v2
    buffer_load_dwordx4 a[0:3], v3, s[12:15], 0 offen offset:0
    buffer_load_dwordx4 a[4:7], v3, s[12:15], 0 offen offset:64
    buffer_load_dwordx4 a[8:11], v3, s[12:15], 0 offen offset:128
    buffer_load_dwordx4 a[12:15], v3, s[12:15], 0 offen offset:192
    buffer_load_dwordx4 a[16:19], v3, s[12:15], 0 offen offset:256
    buffer_load_dwordx4 a[20:23], v3, s[12:15], 0 offen offset:320
    buffer_load_dwordx4 a[24:27], v3, s[12:15], 0 offen offset:384
    buffer_load_dwordx4 a[28:31], v3, s[12:15], 0 offen offset:448
    buffer_load_dwordx4 a[32:35], v3, s[12:15], 0 offen offset:512
    buffer_load_dwordx4 a[36:39], v3, s[12:15], 0 offen offset:576
    buffer_load_dwordx4 a[40:43], v3, s[12:15], 0 offen offset:640
    buffer_load_dwordx4 a[44:47], v3, s[12:15], 0 offen offset:704
    buffer_load_dwordx4 a[48:51], v3, s[12:15], 0 offen offset:768
    buffer_load_dwordx4 a[52:55], v3, s[12:15], 0 offen offset:832
    buffer_load_dwordx4 a[56:59], v3, s[12:15], 0 offen offset:896
    buffer_load_dwordx4 a[60:63], v3, s[12:15], 0 offen offset:960
    buffer_load_dwordx4 a[64:67], v3, s[12:15], 0 offen offset:1024
    buffer_load_dwordx4 a[68:71], v3, s[12:15], 0 offen offset:1088
    buffer_load_dwordx4 a[72:75], v3, s[12:15], 0 offen offset:1152
    buffer_load_dwordx4 a[76:79], v3, s[12:15], 0 offen offset:1216
    buffer_load_dwordx4 a[80:83], v3, s[12:15], 0 offen offset:1280
    buffer_load_dwordx4 a[84:87], v3, s[12:15], 0 offen offset:1344
    buffer_load_dwordx4 a[88:91], v3, s[12:15], 0 offen offset:1408
    buffer_load_dwordx4 a[92:95], v3, s[12:15], 0 offen offset:1472
    buffer_load_dwordx4 a[96:99], v3, s[12:15], 0 offen offset:1536
    buffer_load_dwordx4 a[100:103], v3, s[12:15], 0 offen offset:1600
    buffer_load_dwordx4 a[104:107], v3, s[12:15], 0 offen offset:1664
    buffer_load_dwordx4 a[108:111], v3, s[12:15], 0 offen offset:1728
    buffer_load_dwordx4 a[112:115], v3, s[12:15], 0 offen offset:1792
    buffer_load_dwordx4 a[116:119], v3, s[12:15], 0 offen offset:1856
    buffer_load_dwordx4 a[120:123], v3, s[12:15], 0 offen offset:1920
    buffer_load_dwordx4 a[124:127], v3, s[12:15], 0 offen offset:1984
    s_lshl_b32 s4, s24, 19
    s_lshl_b32 s5, s97, 5
    s_add_u32 s4, s4, s5
    v_bfe_u32 v254, v1, 1, 5
    v_mul_u32_u24 v7, 16384, v254
    v_bfe_u32 v254, v1, 0, 1
    v_mul_u32_u24 v254, 16, v254
    v_add_u32 v7, v7, v254
    v_add_u32 v7, s4, v7
    s_waitcnt vmcnt(32)
    ds_read_b128 a[128:131], v4 offset:0
    ds_read_b128 a[132:135], v4 offset:64
    ds_read_b128 a[136:139], v4 offset:128
    ds_read_b128 a[140:143], v4 offset:192
    ds_read_b128 a[144:147], v4 offset:256
    ds_read_b128 a[148:151], v4 offset:320
    ds_read_b128 a[152:155], v4 offset:384
    ds_read_b128 a[156:159], v4 offset:448
    ds_read_b128 a[160:163], v4 offset:512
    ds_read_b128 a[164:167], v4 offset:576
    ds_read_b128 a[168:171], v4 offset:640
    ds_read_b128 a[172:175], v4 offset:704
    ds_read_b128 a[176:179], v4 offset:768
    ds_read_b128 a[180:183], v4 offset:832
    ds_read_b128 a[184:187], v4 offset:896
    ds_read_b128 a[188:191], v4 offset:960
    ds_read_b128 a[192:195], v4 offset:1024
    ds_read_b128 a[196:199], v4 offset:1088
    ds_read_b128 a[200:203], v4 offset:1152
    ds_read_b128 a[204:207], v4 offset:1216
    ds_read_b128 a[208:211], v4 offset:1280
    ds_read_b128 a[212:215], v4 offset:1344
    ds_read_b128 a[216:219], v4 offset:1408
    ds_read_b128 a[220:223], v4 offset:1472
    ds_read_b128 a[224:227], v4 offset:1536
    ds_read_b128 a[228:231], v4 offset:1600
    ds_read_b128 a[232:235], v4 offset:1664
    ds_read_b128 a[236:239], v4 offset:1728
    ds_read_b128 a[240:243], v4 offset:1792
    ds_read_b128 a[244:247], v4 offset:1856
    ds_read_b128 a[248:251], v4 offset:1920
    ds_read_b128 a[252:255], v4 offset:1984
    v_subrev_u32 v8, 6144, v7
    buffer_load_dwordx4 v[32:35], v8, s[16:19], 0 offen
    v_subrev_u32 v8, 4096, v7
    buffer_load_dwordx4 v[36:39], v8, s[16:19], 0 offen
    v_subrev_u32 v8, 2048, v7
    buffer_load_dwordx4 v[40:43], v8, s[16:19], 0 offen
    s_mov_b32 s4, 0
    buffer_load_dwordx4 v[44:47], v7, s[16:19], s4 offen offset:0
    buffer_load_dwordx4 v[76:79], v7, s[28:31], s4 offen offset:0
    buffer_load_dwordx4 v[48:51], v7, s[16:19], s4 offen offset:2048
    buffer_load_dwordx4 v[80:83], v7, s[28:31], s4 offen offset:2048
    s_mov_b32 s4, 4096
    buffer_load_dwordx4 v[52:55], v7, s[16:19], s4 offen offset:0
    buffer_load_dwordx4 v[84:87], v7, s[28:31], s4 offen offset:0
    buffer_load_dwordx4 v[56:59], v7, s[16:19], s4 offen offset:2048
    buffer_load_dwordx4 v[88:91], v7, s[28:31], s4 offen offset:2048
    s_mov_b32 s4, 8192
    buffer_load_dwordx4 v[60:63], v7, s[16:19], s4 offen offset:0
    buffer_load_dwordx4 v[92:95], v7, s[28:31], s4 offen offset:0
    buffer_load_dwordx4 v[64:67], v7, s[16:19], s4 offen offset:2048
    buffer_load_dwordx4 v[96:99], v7, s[28:31], s4 offen offset:2048
    s_mov_b32 s4, 12288
    buffer_load_dwordx4 v[68:71], v7, s[16:19], s4 offen offset:0
    buffer_load_dwordx4 v[100:103], v7, s[28:31], s4 offen offset:0
    buffer_load_dwordx4 v[72:75], v7, s[16:19], s4 offen offset:2048
    buffer_load_dwordx4 v[104:107], v7, s[28:31], s4 offen offset:2048
    v_add_u32 v9, s6, v2
    v_and_b32 v12, 31, v1
    v_lshrrev_b32 v13, 5, v1
    v_lshlrev_b32 v14, 3, v13
    v_sub_u32 v14, v12, v14
    v_add_u32 v15, 10, v14
    v_and_b32 v10, 1, v15
    v_xor_b32 v10, 1, v10
    v_mul_u32_u24 v10, 4160, v10
    v_lshrrev_b32 v15, 1, v15
    v_lshl_add_u32 v10, v15, 2, v10
    v_add_u32 v10, s6, v10
    v_mul_u32_u24 v11, 80, v12
    v_lshl_add_u32 v11, v13, 4, v11
    s_mul_i32 s4, s24, 7680
    s_sub_u32 s4, s4, 2480
    v_add_u32 v11, s4, v11
    v_cmp_eq_u32 vcc, 7, v14
    v_mov_b32 v15, 0xffff
    s_nop 0
    v_cndmask_b32 v24, 0, v15, vcc
    v_cmp_eq_u32 vcc, 6, v14
    v_mov_b32 v15, 0xffff0000
    s_nop 0
    v_cndmask_b32 v24, v24, v15, vcc
    v_cmp_eq_u32 vcc, 5, v14
    v_mov_b32 v15, 0xffff
    s_nop 0
    v_cndmask_b32 v25, 0, v15, vcc
    v_cmp_eq_u32 vcc, 4, v14
    v_mov_b32 v15, 0xffff0000
    s_nop 0
    v_cndmask_b32 v25, v25, v15, vcc
    v_cmp_eq_u32 vcc, 3, v14
    v_mov_b32 v15, 0xffff
    s_nop 0
    v_cndmask_b32 v26, 0, v15, vcc
    v_cmp_eq_u32 vcc, 2, v14
    v_mov_b32 v15, 0xffff0000
    s_nop 0
    v_cndmask_b32 v26, v26, v15, vcc
    v_cmp_eq_u32 vcc, 1, v14
    v_mov_b32 v15, 0xffff
    s_nop 0
    v_cndmask_b32 v27, 0, v15, vcc
    v_cmp_eq_u32 vcc, 0, v14
    v_mov_b32 v15, 0xffff0000
    s_nop 0
    v_cndmask_b32 v27, v27, v15, vcc
    v_cmp_eq_u32 vcc, 23, v14
    v_mov_b32 v15, 0xffff
    s_nop 0
    v_cndmask_b32 v28, 0, v15, vcc
    v_cmp_eq_u32 vcc, 22, v14
    v_mov_b32 v15, 0xffff0000
    s_nop 0
    v_cndmask_b32 v28, v28, v15, vcc
    v_cmp_eq_u32 vcc, 21, v14
    v_mov_b32 v15, 0xffff
    s_nop 0
    v_cndmask_b32 v29, 0, v15, vcc
    v_cmp_eq_u32 vcc, 20, v14
    v_mov_b32 v15, 0xffff0000
    s_nop 0
    v_cndmask_b32 v29, v29, v15, vcc
    v_cmp_eq_u32 vcc, 19, v14
    v_mov_b32 v15, 0xffff
    s_nop 0
    v_cndmask_b32 v30, 0, v15, vcc
    v_cmp_eq_u32 vcc, 18, v14
    v_mov_b32 v15, 0xffff0000
    s_nop 0
    v_cndmask_b32 v30, v30, v15, vcc
    v_cmp_eq_u32 vcc, 17, v14
    v_mov_b32 v15, 0xffff
    s_nop 0
    v_cndmask_b32 v31, 0, v15, vcc
    v_cmp_eq_u32 vcc, 16, v14
    v_mov_b32 v15, 0xffff0000
    s_nop 0
    v_cndmask_b32 v31, v31, v15, vcc
    s_waitcnt lgkmcnt(0)
    s_waitcnt vmcnt(50)
    v_mfma_f32_16x16x32_bf16 v[216:219], a[128:131], a[0:3], 0
    s_waitcnt vmcnt(49)
    v_mfma_f32_16x16x32_bf16 v[216:219], a[132:135], a[4:7], v[216:219]
    s_waitcnt vmcnt(48)
    v_mfma_f32_16x16x32_bf16 v[216:219], a[136:139], a[8:11], v[216:219]
    s_waitcnt vmcnt(47)
    v_mfma_f32_16x16x32_bf16 v[216:219], a[140:143], a[12:15], v[216:219]
    s_waitcnt vmcnt(46)
    v_mfma_f32_16x16x32_bf16 v[216:219], a[144:147], a[16:19], v[216:219]
    s_waitcnt vmcnt(45)
    v_mfma_f32_16x16x32_bf16 v[216:219], a[148:151], a[20:23], v[216:219]
    s_waitcnt vmcnt(44)
    v_mfma_f32_16x16x32_bf16 v[216:219], a[152:155], a[24:27], v[216:219]
    s_waitcnt vmcnt(43)
    v_mfma_f32_16x16x32_bf16 v[216:219], a[156:159], a[28:31], v[216:219]
    s_waitcnt vmcnt(42)
    v_mfma_f32_16x16x32_bf16 v[216:219], a[160:163], a[32:35], v[216:219]
    s_waitcnt vmcnt(41)
    v_mfma_f32_16x16x32_bf16 v[216:219], a[164:167], a[36:39], v[216:219]
    s_waitcnt vmcnt(40)
    v_mfma_f32_16x16x32_bf16 v[216:219], a[168:171], a[40:43], v[216:219]
    s_waitcnt vmcnt(39)
    v_mfma_f32_16x16x32_bf16 v[216:219], a[172:175], a[44:47], v[216:219]
    s_waitcnt vmcnt(38)
    v_mfma_f32_16x16x32_bf16 v[216:219], a[176:179], a[48:51], v[216:219]
    s_waitcnt vmcnt(37)
    v_mfma_f32_16x16x32_bf16 v[216:219], a[180:183], a[52:55], v[216:219]
    s_waitcnt vmcnt(36)
    v_mfma_f32_16x16x32_bf16 v[216:219], a[184:187], a[56:59], v[216:219]
    s_waitcnt vmcnt(35)
    v_mfma_f32_16x16x32_bf16 v[216:219], a[188:191], a[60:63], v[216:219]
    s_waitcnt vmcnt(34)
    v_mfma_f32_16x16x32_bf16 v[216:219], a[192:195], a[64:67], v[216:219]
    s_waitcnt vmcnt(33)
    v_mfma_f32_16x16x32_bf16 v[216:219], a[196:199], a[68:71], v[216:219]
    s_waitcnt vmcnt(32)
    v_mfma_f32_16x16x32_bf16 v[216:219], a[200:203], a[72:75], v[216:219]
    s_waitcnt vmcnt(31)
    v_mfma_f32_16x16x32_bf16 v[216:219], a[204:207], a[76:79], v[216:219]
    s_waitcnt vmcnt(30)
    v_mfma_f32_16x16x32_bf16 v[216:219], a[208:211], a[80:83], v[216:219]
    s_waitcnt vmcnt(29)
    v_mfma_f32_16x16x32_bf16 v[216:219], a[212:215], a[84:87], v[216:219]
    s_waitcnt vmcnt(28)
    v_mfma_f32_16x16x32_bf16 v[216:219], a[216:219], a[88:91], v[216:219]
    s_waitcnt vmcnt(27)
    v_mfma_f32_16x16x32_bf16 v[216:219], a[220:223], a[92:95], v[216:219]
    s_waitcnt vmcnt(26)
    v_mfma_f32_16x16x32_bf16 v[216:219], a[224:227], a[96:99], v[216:219]
    s_waitcnt vmcnt(25)
    v_mfma_f32_16x16x32_bf16 v[216:219], a[228:231], a[100:103], v[216:219]
    s_waitcnt vmcnt(24)
    v_mfma_f32_16x16x32_bf16 v[216:219], a[232:235], a[104:107], v[216:219]
    s_waitcnt vmcnt(23)
    v_mfma_f32_16x16x32_bf16 v[216:219], a[236:239], a[108:111], v[216:219]
    s_waitcnt vmcnt(22)
    v_mfma_f32_16x16x32_bf16 v[216:219], a[240:243], a[112:115], v[216:219]
    s_waitcnt vmcnt(21)
    v_mfma_f32_16x16x32_bf16 v[216:219], a[244:247], a[116:119], v[216:219]
    s_waitcnt vmcnt(20)
    v_mfma_f32_16x16x32_bf16 v[216:219], a[248:251], a[120:123], v[216:219]
    s_waitcnt vmcnt(19)
    v_mfma_f32_16x16x32_bf16 v[216:219], a[252:255], a[124:127], v[216:219]
    v_add_u32 v7, 2097152, v7
    v_subrev_u32 v8, 6144, v7
    buffer_load_dwordx4 v[108:111], v8, s[16:19], 0 offen
    v_subrev_u32 v8, 4096, v7
    buffer_load_dwordx4 v[112:115], v8, s[16:19], 0 offen
    v_subrev_u32 v8, 2048, v7
    buffer_load_dwordx4 v[116:119], v8, s[16:19], 0 offen
    s_mov_b32 s4, 0
    buffer_load_dwordx4 v[120:123], v7, s[16:19], s4 offen offset:0
    buffer_load_dwordx4 v[152:155], v7, s[28:31], s4 offen offset:0
    buffer_load_dwordx4 v[124:127], v7, s[16:19], s4 offen offset:2048
    buffer_load_dwordx4 v[156:159], v7, s[28:31], s4 offen offset:2048
    s_mov_b32 s4, 4096
    buffer_load_dwordx4 v[128:131], v7, s[16:19], s4 offen offset:0
    buffer_load_dwordx4 v[160:163], v7, s[28:31], s4 offen offset:0
    buffer_load_dwordx4 v[132:135], v7, s[16:19], s4 offen offset:2048
    buffer_load_dwordx4 v[164:167], v7, s[28:31], s4 offen offset:2048
    s_mov_b32 s4, 8192
    buffer_load_dwordx4 v[136:139], v7, s[16:19], s4 offen offset:0
    buffer_load_dwordx4 v[168:171], v7, s[28:31], s4 offen offset:0
    buffer_load_dwordx4 v[140:143], v7, s[16:19], s4 offen offset:2048
    buffer_load_dwordx4 v[172:175], v7, s[28:31], s4 offen offset:2048
    s_mov_b32 s4, 12288
    buffer_load_dwordx4 v[144:147], v7, s[16:19], s4 offen offset:0
    buffer_load_dwordx4 v[176:179], v7, s[28:31], s4 offen offset:0
    buffer_load_dwordx4 v[148:151], v7, s[16:19], s4 offen offset:2048
    buffer_load_dwordx4 v[180:183], v7, s[28:31], s4 offen offset:2048
    v_cvt_pk_bf16_f32 v216, v216, v216
    v_lshlrev_b32 v216, 16, v216
    v_mul_f32 v216, 0xbfb8aa3b, v216
    v_exp_f32 v216, v216
    s_lshl_b32 s4, s97, 7
    v_add_f32 v216, 1.0, v216
    v_rcp_f32 v216, v216
    s_lshl_b32 s5, s24, 5
    v_cvt_pk_bf16_f32 v216, v216, v216
    v_lshlrev_b32 v216, 16, v216
    s_add_u32 s4, s4, s5
    s_add_u32 s4, s4, 121634816
    v_lshlrev_b32 v15, 2, v1
    s_mov_b64 exec, 0xff
    buffer_store_dword v216, v15, s[8:11], s4 offen sc1
    s_mov_b64 exec, -1
    v_mov_b32 v220, 0
    v_mov_b32 v221, 0
    v_mov_b32 v222, 0
    v_mov_b32 v223, 0
    s_mul_i32 s4, s24, 7680
    v_add_u32 v15, s4, v2
    ds_write_b128 v15, v[220:223] offset:0
    ds_write_b128 v15, v[220:223] offset:1024
    ds_write_b128 v15, v[220:223] offset:1536
    v_add_u32 v15, 30720, v15
    ds_write_b128 v15, v[220:223] offset:0
    ds_write_b128 v15, v[220:223] offset:1024
    ds_write_b128 v15, v[220:223] offset:1536
    v_add_u32 v15, 30720, v15
    ds_write_b128 v15, v[220:223] offset:0
    ds_write_b128 v15, v[220:223] offset:1024
    ds_write_b128 v15, v[220:223] offset:1536
    v_add_u32 v15, 30720, v15
    ds_write_b128 v15, v[220:223] offset:0
    ds_write_b128 v15, v[220:223] offset:1024
    ds_write_b128 v15, v[220:223] offset:1536
    v_add_u32 v15, 30720, v15
    s_mov_b64 exec, 0xf
    ds_write_b128 v9, v[220:223]
    ds_write_b128 v9, v[220:223] offset:4160
    s_mov_b64 exec, -1
    s_mul_i32 s4, s24, 640
    s_add_u32 s4, s4, 2560
    v_bfe_u32 v254, v1, 0, 1
    v_mul_u32_u24 v12, 61440, v254
    v_bfe_u32 v254, v1, 3, 3
    v_mul_u32_u24 v254, 80, v254
    v_add_u32 v12, v12, v254
    v_bfe_u32 v254, v1, 1, 2
    v_mul_u32_u24 v254, 16, v254
    v_add_u32 v12, v12, v254
    v_add_u32 v12, s4, v12
    s_lshl_b32 s4, s97, 7
    v_bfe_u32 v254, v1, 0, 1
    v_mul_u32_u24 v13, 64, v254
    v_add_u32 v13, s4, v13
    buffer_load_dwordx4 v[216:219], v13, s[32:35], 0 offen offset:0
    buffer_load_dwordx4 v[220:223], v13, s[32:35], 0 offen offset:16
    buffer_load_dwordx4 v[224:227], v13, s[32:35], 0 offen offset:32
    buffer_load_dwordx4 v[228:231], v13, s[32:35], 0 offen offset:48
    s_waitcnt vmcnt(0)
    v_lshlrev_b32 v184, 16, v216
    v_lshlrev_b32 v185, 16, v218
    v_and_b32 v186, 0xffff0000, v216
    v_and_b32 v187, 0xffff0000, v218
    v_lshlrev_b32 v188, 16, v217
    v_lshlrev_b32 v189, 16, v219
    v_and_b32 v190, 0xffff0000, v217
    v_and_b32 v191, 0xffff0000, v219
    v_lshlrev_b32 v192, 16, v220
    v_lshlrev_b32 v193, 16, v222
    v_and_b32 v194, 0xffff0000, v220
    v_and_b32 v195, 0xffff0000, v222
    v_lshlrev_b32 v196, 16, v221
    v_lshlrev_b32 v197, 16, v223
    v_and_b32 v198, 0xffff0000, v221
    v_and_b32 v199, 0xffff0000, v223
    v_lshlrev_b32 v200, 16, v224
    v_lshlrev_b32 v201, 16, v226
    v_and_b32 v202, 0xffff0000, v224
    v_and_b32 v203, 0xffff0000, v226
    v_lshlrev_b32 v204, 16, v225
    v_lshlrev_b32 v205, 16, v227
    v_and_b32 v206, 0xffff0000, v225
    v_and_b32 v207, 0xffff0000, v227
    v_lshlrev_b32 v208, 16, v228
    v_lshlrev_b32 v209, 16, v230
    v_and_b32 v210, 0xffff0000, v228
    v_and_b32 v211, 0xffff0000, v230
    v_lshlrev_b32 v212, 16, v229
    v_lshlrev_b32 v213, 16, v231
    v_and_b32 v214, 0xffff0000, v229
    v_and_b32 v215, 0xffff0000, v231
    v_lshlrev_b32 v216, 16, v32
    v_and_b32 v217, 0xffff0000, v32
    v_lshlrev_b32 v218, 16, v36
    v_and_b32 v219, 0xffff0000, v36
    v_lshlrev_b32 v220, 16, v40
    v_and_b32 v221, 0xffff0000, v40
    v_lshlrev_b32 v222, 16, v44
    v_and_b32 v223, 0xffff0000, v44
    v_lshlrev_b32 v224, 16, v48
    v_and_b32 v225, 0xffff0000, v48
    v_lshlrev_b32 v226, 16, v52
    v_and_b32 v227, 0xffff0000, v52
    v_lshlrev_b32 v228, 16, v56
    v_and_b32 v229, 0xffff0000, v56
    v_lshlrev_b32 v230, 16, v60
    v_and_b32 v231, 0xffff0000, v60
    v_lshlrev_b32 v232, 16, v64
    v_and_b32 v233, 0xffff0000, v64
    v_lshlrev_b32 v234, 16, v68
    v_and_b32 v235, 0xffff0000, v68
    v_lshlrev_b32 v236, 16, v72
    v_and_b32 v237, 0xffff0000, v72
    v_pk_mul_f32 v[216:217], v[216:217], v[190:191]
    v_lshlrev_b32 v238, 16, v76
    v_pk_fma_f32 v[216:217], v[218:219], v[188:189], v[216:217]
    v_and_b32 v239, 0xffff0000, v76
    v_pk_fma_f32 v[216:217], v[220:221], v[186:187], v[216:217]
    v_pk_fma_f32 v[216:217], v[222:223], v[184:185], v[216:217]
    v_pk_mul_f32 v[216:217], v[216:217], v[238:239]
    v_pk_mul_f32 v[218:219], v[218:219], v[190:191]
    v_lshlrev_b32 v240, 16, v80
    v_pk_fma_f32 v[218:219], v[220:221], v[188:189], v[218:219]
    v_and_b32 v241, 0xffff0000, v80
    v_pk_fma_f32 v[218:219], v[222:223], v[186:187], v[218:219]
    v_pk_fma_f32 v[218:219], v[224:225], v[184:185], v[218:219]
    v_pk_mul_f32 v[218:219], v[218:219], v[240:241]
    v_pk_mul_f32 v[220:221], v[220:221], v[190:191]
    v_lshlrev_b32 v238, 16, v84
    v_pk_fma_f32 v[220:221], v[222:223], v[188:189], v[220:221]
    v_and_b32 v239, 0xffff0000, v84
    v_pk_fma_f32 v[220:221], v[224:225], v[186:187], v[220:221]
    v_pk_fma_f32 v[220:221], v[226:227], v[184:185], v[220:221]
    v_pk_mul_f32 v[220:221], v[220:221], v[238:239]
    v_pk_mul_f32 v[222:223], v[222:223], v[190:191]
    v_lshlrev_b32 v240, 16, v88
    v_pk_fma_f32 v[222:223], v[224:225], v[188:189], v[222:223]
    v_and_b32 v241, 0xffff0000, v88
    v_pk_fma_f32 v[222:223], v[226:227], v[186:187], v[222:223]
    v_pk_fma_f32 v[222:223], v[228:229], v[184:185], v[222:223]
    v_pk_mul_f32 v[222:223], v[222:223], v[240:241]
    v_pk_mul_f32 v[224:225], v[224:225], v[190:191]
    v_lshlrev_b32 v238, 16, v92
    v_pk_fma_f32 v[224:225], v[226:227], v[188:189], v[224:225]
    v_and_b32 v239, 0xffff0000, v92
    v_pk_fma_f32 v[224:225], v[228:229], v[186:187], v[224:225]
    v_pk_fma_f32 v[224:225], v[230:231], v[184:185], v[224:225]
    v_pk_mul_f32 v[224:225], v[224:225], v[238:239]
    v_pk_mul_f32 v[226:227], v[226:227], v[190:191]
    v_lshlrev_b32 v240, 16, v96
    v_pk_fma_f32 v[226:227], v[228:229], v[188:189], v[226:227]
    v_and_b32 v241, 0xffff0000, v96
    v_pk_fma_f32 v[226:227], v[230:231], v[186:187], v[226:227]
    v_pk_fma_f32 v[226:227], v[232:233], v[184:185], v[226:227]
    v_pk_mul_f32 v[226:227], v[226:227], v[240:241]
    v_pk_mul_f32 v[228:229], v[228:229], v[190:191]
    v_lshlrev_b32 v238, 16, v100
    v_pk_fma_f32 v[228:229], v[230:231], v[188:189], v[228:229]
    v_and_b32 v239, 0xffff0000, v100
    v_pk_fma_f32 v[228:229], v[232:233], v[186:187], v[228:229]
    v_pk_fma_f32 v[228:229], v[234:235], v[184:185], v[228:229]
    v_pk_mul_f32 v[228:229], v[228:229], v[238:239]
    v_pk_mul_f32 v[230:231], v[230:231], v[190:191]
    v_lshlrev_b32 v240, 16, v104
    v_pk_fma_f32 v[230:231], v[232:233], v[188:189], v[230:231]
    v_and_b32 v241, 0xffff0000, v104
    v_pk_fma_f32 v[230:231], v[234:235], v[186:187], v[230:231]
    v_pk_fma_f32 v[230:231], v[236:237], v[184:185], v[230:231]
    v_pk_mul_f32 v[230:231], v[230:231], v[240:241]
    v_cvt_pk_bf16_f32 v242, v230, v228
    v_cvt_pk_bf16_f32 v243, v226, v224
    v_cvt_pk_bf16_f32 v244, v222, v220
    v_cvt_pk_bf16_f32 v245, v218, v216
    ds_write_b128 v12, v[242:245] offset:0
    v_cvt_pk_bf16_f32 v246, v231, v229
    v_cvt_pk_bf16_f32 v247, v227, v225
    v_cvt_pk_bf16_f32 v248, v223, v221
    v_cvt_pk_bf16_f32 v249, v219, v217
    ds_write_b128 v12, v[246:249] offset:7680
    v_lshlrev_b32 v216, 16, v33
    v_and_b32 v217, 0xffff0000, v33
    v_lshlrev_b32 v218, 16, v37
    v_and_b32 v219, 0xffff0000, v37
    v_lshlrev_b32 v220, 16, v41
    v_and_b32 v221, 0xffff0000, v41
    v_lshlrev_b32 v222, 16, v45
    v_and_b32 v223, 0xffff0000, v45
    v_lshlrev_b32 v224, 16, v49
    v_and_b32 v225, 0xffff0000, v49
    v_lshlrev_b32 v226, 16, v53
    v_and_b32 v227, 0xffff0000, v53
    v_lshlrev_b32 v228, 16, v57
    v_and_b32 v229, 0xffff0000, v57
    v_lshlrev_b32 v230, 16, v61
    v_and_b32 v231, 0xffff0000, v61
    v_lshlrev_b32 v232, 16, v65
    v_and_b32 v233, 0xffff0000, v65
    v_lshlrev_b32 v234, 16, v69
    v_and_b32 v235, 0xffff0000, v69
    v_lshlrev_b32 v236, 16, v73
    v_and_b32 v237, 0xffff0000, v73
    v_pk_mul_f32 v[216:217], v[216:217], v[198:199]
    v_lshlrev_b32 v238, 16, v77
    v_pk_fma_f32 v[216:217], v[218:219], v[196:197], v[216:217]
    v_and_b32 v239, 0xffff0000, v77
    v_pk_fma_f32 v[216:217], v[220:221], v[194:195], v[216:217]
    v_pk_fma_f32 v[216:217], v[222:223], v[192:193], v[216:217]
    v_pk_mul_f32 v[216:217], v[216:217], v[238:239]
    v_pk_mul_f32 v[218:219], v[218:219], v[198:199]
    v_lshlrev_b32 v240, 16, v81
    v_pk_fma_f32 v[218:219], v[220:221], v[196:197], v[218:219]
    v_and_b32 v241, 0xffff0000, v81
    v_pk_fma_f32 v[218:219], v[222:223], v[194:195], v[218:219]
    v_pk_fma_f32 v[218:219], v[224:225], v[192:193], v[218:219]
    v_pk_mul_f32 v[218:219], v[218:219], v[240:241]
    v_pk_mul_f32 v[220:221], v[220:221], v[198:199]
    v_lshlrev_b32 v238, 16, v85
    v_pk_fma_f32 v[220:221], v[222:223], v[196:197], v[220:221]
    v_and_b32 v239, 0xffff0000, v85
    v_pk_fma_f32 v[220:221], v[224:225], v[194:195], v[220:221]
    v_pk_fma_f32 v[220:221], v[226:227], v[192:193], v[220:221]
    v_pk_mul_f32 v[220:221], v[220:221], v[238:239]
    v_pk_mul_f32 v[222:223], v[222:223], v[198:199]
    v_lshlrev_b32 v240, 16, v89
    v_pk_fma_f32 v[222:223], v[224:225], v[196:197], v[222:223]
    v_and_b32 v241, 0xffff0000, v89
    v_pk_fma_f32 v[222:223], v[226:227], v[194:195], v[222:223]
    v_pk_fma_f32 v[222:223], v[228:229], v[192:193], v[222:223]
    v_pk_mul_f32 v[222:223], v[222:223], v[240:241]
    v_pk_mul_f32 v[224:225], v[224:225], v[198:199]
    v_lshlrev_b32 v238, 16, v93
    v_pk_fma_f32 v[224:225], v[226:227], v[196:197], v[224:225]
    v_and_b32 v239, 0xffff0000, v93
    v_pk_fma_f32 v[224:225], v[228:229], v[194:195], v[224:225]
    v_pk_fma_f32 v[224:225], v[230:231], v[192:193], v[224:225]
    v_pk_mul_f32 v[224:225], v[224:225], v[238:239]
    v_pk_mul_f32 v[226:227], v[226:227], v[198:199]
    v_lshlrev_b32 v240, 16, v97
    v_pk_fma_f32 v[226:227], v[228:229], v[196:197], v[226:227]
    v_and_b32 v241, 0xffff0000, v97
    v_pk_fma_f32 v[226:227], v[230:231], v[194:195], v[226:227]
    v_pk_fma_f32 v[226:227], v[232:233], v[192:193], v[226:227]
    v_pk_mul_f32 v[226:227], v[226:227], v[240:241]
    v_pk_mul_f32 v[228:229], v[228:229], v[198:199]
    v_lshlrev_b32 v238, 16, v101
    v_pk_fma_f32 v[228:229], v[230:231], v[196:197], v[228:229]
    v_and_b32 v239, 0xffff0000, v101
    v_pk_fma_f32 v[228:229], v[232:233], v[194:195], v[228:229]
    v_pk_fma_f32 v[228:229], v[234:235], v[192:193], v[228:229]
    v_pk_mul_f32 v[228:229], v[228:229], v[238:239]
    v_pk_mul_f32 v[230:231], v[230:231], v[198:199]
    v_lshlrev_b32 v240, 16, v105
    v_pk_fma_f32 v[230:231], v[232:233], v[196:197], v[230:231]
    v_and_b32 v241, 0xffff0000, v105
    v_pk_fma_f32 v[230:231], v[234:235], v[194:195], v[230:231]
    v_pk_fma_f32 v[230:231], v[236:237], v[192:193], v[230:231]
    v_pk_mul_f32 v[230:231], v[230:231], v[240:241]
    v_cvt_pk_bf16_f32 v242, v230, v228
    v_cvt_pk_bf16_f32 v243, v226, v224
    v_cvt_pk_bf16_f32 v244, v222, v220
    v_cvt_pk_bf16_f32 v245, v218, v216
    ds_write_b128 v12, v[242:245] offset:15360
    v_cvt_pk_bf16_f32 v246, v231, v229
    v_cvt_pk_bf16_f32 v247, v227, v225
    v_cvt_pk_bf16_f32 v248, v223, v221
    v_cvt_pk_bf16_f32 v249, v219, v217
    ds_write_b128 v12, v[246:249] offset:23040
    v_lshlrev_b32 v216, 16, v34
    v_and_b32 v217, 0xffff0000, v34
    v_lshlrev_b32 v218, 16, v38
    v_and_b32 v219, 0xffff0000, v38
    v_lshlrev_b32 v220, 16, v42
    v_and_b32 v221, 0xffff0000, v42
    v_lshlrev_b32 v222, 16, v46
    v_and_b32 v223, 0xffff0000, v46
    v_lshlrev_b32 v224, 16, v50
    v_and_b32 v225, 0xffff0000, v50
    v_lshlrev_b32 v226, 16, v54
    v_and_b32 v227, 0xffff0000, v54
    v_lshlrev_b32 v228, 16, v58
    v_and_b32 v229, 0xffff0000, v58
    v_lshlrev_b32 v230, 16, v62
    v_and_b32 v231, 0xffff0000, v62
    v_lshlrev_b32 v232, 16, v66
    v_and_b32 v233, 0xffff0000, v66
    v_lshlrev_b32 v234, 16, v70
    v_and_b32 v235, 0xffff0000, v70
    v_lshlrev_b32 v236, 16, v74
    v_and_b32 v237, 0xffff0000, v74
    v_pk_mul_f32 v[216:217], v[216:217], v[206:207]
    v_lshlrev_b32 v238, 16, v78
    v_pk_fma_f32 v[216:217], v[218:219], v[204:205], v[216:217]
    v_and_b32 v239, 0xffff0000, v78
    v_pk_fma_f32 v[216:217], v[220:221], v[202:203], v[216:217]
    v_pk_fma_f32 v[216:217], v[222:223], v[200:201], v[216:217]
    v_pk_mul_f32 v[216:217], v[216:217], v[238:239]
    v_pk_mul_f32 v[218:219], v[218:219], v[206:207]
    v_lshlrev_b32 v240, 16, v82
    v_pk_fma_f32 v[218:219], v[220:221], v[204:205], v[218:219]
    v_and_b32 v241, 0xffff0000, v82
    v_pk_fma_f32 v[218:219], v[222:223], v[202:203], v[218:219]
    v_pk_fma_f32 v[218:219], v[224:225], v[200:201], v[218:219]
    v_pk_mul_f32 v[218:219], v[218:219], v[240:241]
    v_pk_mul_f32 v[220:221], v[220:221], v[206:207]
    v_lshlrev_b32 v238, 16, v86
    v_pk_fma_f32 v[220:221], v[222:223], v[204:205], v[220:221]
    v_and_b32 v239, 0xffff0000, v86
    v_pk_fma_f32 v[220:221], v[224:225], v[202:203], v[220:221]
    v_pk_fma_f32 v[220:221], v[226:227], v[200:201], v[220:221]
    v_pk_mul_f32 v[220:221], v[220:221], v[238:239]
    v_pk_mul_f32 v[222:223], v[222:223], v[206:207]
    v_lshlrev_b32 v240, 16, v90
    v_pk_fma_f32 v[222:223], v[224:225], v[204:205], v[222:223]
    v_and_b32 v241, 0xffff0000, v90
    v_pk_fma_f32 v[222:223], v[226:227], v[202:203], v[222:223]
    v_pk_fma_f32 v[222:223], v[228:229], v[200:201], v[222:223]
    v_pk_mul_f32 v[222:223], v[222:223], v[240:241]
    v_pk_mul_f32 v[224:225], v[224:225], v[206:207]
    v_lshlrev_b32 v238, 16, v94
    v_pk_fma_f32 v[224:225], v[226:227], v[204:205], v[224:225]
    v_and_b32 v239, 0xffff0000, v94
    v_pk_fma_f32 v[224:225], v[228:229], v[202:203], v[224:225]
    v_pk_fma_f32 v[224:225], v[230:231], v[200:201], v[224:225]
    v_pk_mul_f32 v[224:225], v[224:225], v[238:239]
    v_pk_mul_f32 v[226:227], v[226:227], v[206:207]
    v_lshlrev_b32 v240, 16, v98
    v_pk_fma_f32 v[226:227], v[228:229], v[204:205], v[226:227]
    v_and_b32 v241, 0xffff0000, v98
    v_pk_fma_f32 v[226:227], v[230:231], v[202:203], v[226:227]
    v_pk_fma_f32 v[226:227], v[232:233], v[200:201], v[226:227]
    v_pk_mul_f32 v[226:227], v[226:227], v[240:241]
    v_pk_mul_f32 v[228:229], v[228:229], v[206:207]
    v_lshlrev_b32 v238, 16, v102
    v_pk_fma_f32 v[228:229], v[230:231], v[204:205], v[228:229]
    v_and_b32 v239, 0xffff0000, v102
    v_pk_fma_f32 v[228:229], v[232:233], v[202:203], v[228:229]
    v_pk_fma_f32 v[228:229], v[234:235], v[200:201], v[228:229]
    v_pk_mul_f32 v[228:229], v[228:229], v[238:239]
    v_pk_mul_f32 v[230:231], v[230:231], v[206:207]
    v_lshlrev_b32 v240, 16, v106
    v_pk_fma_f32 v[230:231], v[232:233], v[204:205], v[230:231]
    v_and_b32 v241, 0xffff0000, v106
    v_pk_fma_f32 v[230:231], v[234:235], v[202:203], v[230:231]
    v_pk_fma_f32 v[230:231], v[236:237], v[200:201], v[230:231]
    v_pk_mul_f32 v[230:231], v[230:231], v[240:241]
    v_cvt_pk_bf16_f32 v242, v230, v228
    v_cvt_pk_bf16_f32 v243, v226, v224
    v_cvt_pk_bf16_f32 v244, v222, v220
    v_cvt_pk_bf16_f32 v245, v218, v216
    ds_write_b128 v12, v[242:245] offset:30720
    v_cvt_pk_bf16_f32 v246, v231, v229
    v_cvt_pk_bf16_f32 v247, v227, v225
    v_cvt_pk_bf16_f32 v248, v223, v221
    v_cvt_pk_bf16_f32 v249, v219, v217
    ds_write_b128 v12, v[246:249] offset:38400
    v_lshlrev_b32 v216, 16, v35
    v_and_b32 v217, 0xffff0000, v35
    v_lshlrev_b32 v218, 16, v39
    v_and_b32 v219, 0xffff0000, v39
    v_lshlrev_b32 v220, 16, v43
    v_and_b32 v221, 0xffff0000, v43
    v_lshlrev_b32 v222, 16, v47
    v_and_b32 v223, 0xffff0000, v47
    v_lshlrev_b32 v224, 16, v51
    v_and_b32 v225, 0xffff0000, v51
    v_lshlrev_b32 v226, 16, v55
    v_and_b32 v227, 0xffff0000, v55
    v_lshlrev_b32 v228, 16, v59
    v_and_b32 v229, 0xffff0000, v59
    v_lshlrev_b32 v230, 16, v63
    v_and_b32 v231, 0xffff0000, v63
    v_lshlrev_b32 v232, 16, v67
    v_and_b32 v233, 0xffff0000, v67
    v_lshlrev_b32 v234, 16, v71
    v_and_b32 v235, 0xffff0000, v71
    v_lshlrev_b32 v236, 16, v75
    v_and_b32 v237, 0xffff0000, v75
    v_pk_mul_f32 v[216:217], v[216:217], v[214:215]
    v_lshlrev_b32 v238, 16, v79
    v_pk_fma_f32 v[216:217], v[218:219], v[212:213], v[216:217]
    v_and_b32 v239, 0xffff0000, v79
    v_pk_fma_f32 v[216:217], v[220:221], v[210:211], v[216:217]
    v_pk_fma_f32 v[216:217], v[222:223], v[208:209], v[216:217]
    v_pk_mul_f32 v[216:217], v[216:217], v[238:239]
    v_pk_mul_f32 v[218:219], v[218:219], v[214:215]
    v_lshlrev_b32 v240, 16, v83
    v_pk_fma_f32 v[218:219], v[220:221], v[212:213], v[218:219]
    v_and_b32 v241, 0xffff0000, v83
    v_pk_fma_f32 v[218:219], v[222:223], v[210:211], v[218:219]
    v_pk_fma_f32 v[218:219], v[224:225], v[208:209], v[218:219]
    v_pk_mul_f32 v[218:219], v[218:219], v[240:241]
    v_pk_mul_f32 v[220:221], v[220:221], v[214:215]
    v_lshlrev_b32 v238, 16, v87
    v_pk_fma_f32 v[220:221], v[222:223], v[212:213], v[220:221]
    v_and_b32 v239, 0xffff0000, v87
    v_pk_fma_f32 v[220:221], v[224:225], v[210:211], v[220:221]
    v_pk_fma_f32 v[220:221], v[226:227], v[208:209], v[220:221]
    v_pk_mul_f32 v[220:221], v[220:221], v[238:239]
    v_pk_mul_f32 v[222:223], v[222:223], v[214:215]
    v_lshlrev_b32 v240, 16, v91
    v_pk_fma_f32 v[222:223], v[224:225], v[212:213], v[222:223]
    v_and_b32 v241, 0xffff0000, v91
    v_pk_fma_f32 v[222:223], v[226:227], v[210:211], v[222:223]
    v_pk_fma_f32 v[222:223], v[228:229], v[208:209], v[222:223]
    v_pk_mul_f32 v[222:223], v[222:223], v[240:241]
    v_pk_mul_f32 v[224:225], v[224:225], v[214:215]
    v_lshlrev_b32 v238, 16, v95
    v_pk_fma_f32 v[224:225], v[226:227], v[212:213], v[224:225]
    v_and_b32 v239, 0xffff0000, v95
    v_pk_fma_f32 v[224:225], v[228:229], v[210:211], v[224:225]
    v_pk_fma_f32 v[224:225], v[230:231], v[208:209], v[224:225]
    v_pk_mul_f32 v[224:225], v[224:225], v[238:239]
    v_pk_mul_f32 v[226:227], v[226:227], v[214:215]
    v_lshlrev_b32 v240, 16, v99
    v_pk_fma_f32 v[226:227], v[228:229], v[212:213], v[226:227]
    v_and_b32 v241, 0xffff0000, v99
    v_pk_fma_f32 v[226:227], v[230:231], v[210:211], v[226:227]
    v_pk_fma_f32 v[226:227], v[232:233], v[208:209], v[226:227]
    v_pk_mul_f32 v[226:227], v[226:227], v[240:241]
    v_pk_mul_f32 v[228:229], v[228:229], v[214:215]
    v_lshlrev_b32 v238, 16, v103
    v_pk_fma_f32 v[228:229], v[230:231], v[212:213], v[228:229]
    v_and_b32 v239, 0xffff0000, v103
    v_pk_fma_f32 v[228:229], v[232:233], v[210:211], v[228:229]
    v_pk_fma_f32 v[228:229], v[234:235], v[208:209], v[228:229]
    v_pk_mul_f32 v[228:229], v[228:229], v[238:239]
    v_pk_mul_f32 v[230:231], v[230:231], v[214:215]
    v_lshlrev_b32 v240, 16, v107
    v_pk_fma_f32 v[230:231], v[232:233], v[212:213], v[230:231]
    v_and_b32 v241, 0xffff0000, v107
    v_pk_fma_f32 v[230:231], v[234:235], v[210:211], v[230:231]
    v_pk_fma_f32 v[230:231], v[236:237], v[208:209], v[230:231]
    v_pk_mul_f32 v[230:231], v[230:231], v[240:241]
    v_cvt_pk_bf16_f32 v242, v230, v228
    v_cvt_pk_bf16_f32 v243, v226, v224
    v_cvt_pk_bf16_f32 v244, v222, v220
    v_cvt_pk_bf16_f32 v245, v218, v216
    ds_write_b128 v12, v[242:245] offset:46080
    v_cvt_pk_bf16_f32 v246, v231, v229
    v_cvt_pk_bf16_f32 v247, v227, v225
    v_cvt_pk_bf16_f32 v248, v223, v221
    v_cvt_pk_bf16_f32 v249, v219, v217
    ds_write_b128 v12, v[246:249] offset:53760
    v_lshlrev_b32 v216, 16, v108
    v_and_b32 v217, 0xffff0000, v108
    v_lshlrev_b32 v218, 16, v112
    v_and_b32 v219, 0xffff0000, v112
    v_lshlrev_b32 v220, 16, v116
    v_and_b32 v221, 0xffff0000, v116
    v_lshlrev_b32 v222, 16, v120
    v_and_b32 v223, 0xffff0000, v120
    v_lshlrev_b32 v224, 16, v124
    v_and_b32 v225, 0xffff0000, v124
    v_lshlrev_b32 v226, 16, v128
    v_and_b32 v227, 0xffff0000, v128
    v_lshlrev_b32 v228, 16, v132
    v_and_b32 v229, 0xffff0000, v132
    v_lshlrev_b32 v230, 16, v136
    v_and_b32 v231, 0xffff0000, v136
    v_lshlrev_b32 v232, 16, v140
    v_and_b32 v233, 0xffff0000, v140
    v_lshlrev_b32 v234, 16, v144
    v_and_b32 v235, 0xffff0000, v144
    v_lshlrev_b32 v236, 16, v148
    v_and_b32 v237, 0xffff0000, v148
    v_pk_mul_f32 v[216:217], v[216:217], v[190:191]
    v_lshlrev_b32 v238, 16, v152
    v_pk_fma_f32 v[216:217], v[218:219], v[188:189], v[216:217]
    v_and_b32 v239, 0xffff0000, v152
    v_pk_fma_f32 v[216:217], v[220:221], v[186:187], v[216:217]
    v_pk_fma_f32 v[216:217], v[222:223], v[184:185], v[216:217]
    v_pk_mul_f32 v[216:217], v[216:217], v[238:239]
    v_pk_mul_f32 v[218:219], v[218:219], v[190:191]
    v_lshlrev_b32 v240, 16, v156
    v_pk_fma_f32 v[218:219], v[220:221], v[188:189], v[218:219]
    v_and_b32 v241, 0xffff0000, v156
    v_pk_fma_f32 v[218:219], v[222:223], v[186:187], v[218:219]
    v_pk_fma_f32 v[218:219], v[224:225], v[184:185], v[218:219]
    v_pk_mul_f32 v[218:219], v[218:219], v[240:241]
    v_pk_mul_f32 v[220:221], v[220:221], v[190:191]
    v_lshlrev_b32 v238, 16, v160
    v_pk_fma_f32 v[220:221], v[222:223], v[188:189], v[220:221]
    v_and_b32 v239, 0xffff0000, v160
    v_pk_fma_f32 v[220:221], v[224:225], v[186:187], v[220:221]
    v_pk_fma_f32 v[220:221], v[226:227], v[184:185], v[220:221]
    v_pk_mul_f32 v[220:221], v[220:221], v[238:239]
    v_pk_mul_f32 v[222:223], v[222:223], v[190:191]
    v_lshlrev_b32 v240, 16, v164
    v_pk_fma_f32 v[222:223], v[224:225], v[188:189], v[222:223]
    v_and_b32 v241, 0xffff0000, v164
    v_pk_fma_f32 v[222:223], v[226:227], v[186:187], v[222:223]
    v_pk_fma_f32 v[222:223], v[228:229], v[184:185], v[222:223]
    v_pk_mul_f32 v[222:223], v[222:223], v[240:241]
    v_pk_mul_f32 v[224:225], v[224:225], v[190:191]
    v_lshlrev_b32 v238, 16, v168
    v_pk_fma_f32 v[224:225], v[226:227], v[188:189], v[224:225]
    v_and_b32 v239, 0xffff0000, v168
    v_pk_fma_f32 v[224:225], v[228:229], v[186:187], v[224:225]
    v_pk_fma_f32 v[224:225], v[230:231], v[184:185], v[224:225]
    v_pk_mul_f32 v[224:225], v[224:225], v[238:239]
    v_pk_mul_f32 v[226:227], v[226:227], v[190:191]
    v_lshlrev_b32 v240, 16, v172
    v_pk_fma_f32 v[226:227], v[228:229], v[188:189], v[226:227]
    v_and_b32 v241, 0xffff0000, v172
    v_pk_fma_f32 v[226:227], v[230:231], v[186:187], v[226:227]
    v_pk_fma_f32 v[226:227], v[232:233], v[184:185], v[226:227]
    v_pk_mul_f32 v[226:227], v[226:227], v[240:241]
    v_pk_mul_f32 v[228:229], v[228:229], v[190:191]
    v_lshlrev_b32 v238, 16, v176
    v_pk_fma_f32 v[228:229], v[230:231], v[188:189], v[228:229]
    v_and_b32 v239, 0xffff0000, v176
    v_pk_fma_f32 v[228:229], v[232:233], v[186:187], v[228:229]
    v_pk_fma_f32 v[228:229], v[234:235], v[184:185], v[228:229]
    v_pk_mul_f32 v[228:229], v[228:229], v[238:239]
    v_pk_mul_f32 v[230:231], v[230:231], v[190:191]
    v_lshlrev_b32 v240, 16, v180
    v_pk_fma_f32 v[230:231], v[232:233], v[188:189], v[230:231]
    v_and_b32 v241, 0xffff0000, v180
    v_pk_fma_f32 v[230:231], v[234:235], v[186:187], v[230:231]
    v_pk_fma_f32 v[230:231], v[236:237], v[184:185], v[230:231]
    v_pk_mul_f32 v[230:231], v[230:231], v[240:241]
    v_cvt_pk_bf16_f32 v242, v230, v228
    v_cvt_pk_bf16_f32 v243, v226, v224
    v_cvt_pk_bf16_f32 v244, v222, v220
    v_cvt_pk_bf16_f32 v245, v218, v216
    ds_write_b128 v12, v[242:245] offset:2560
    v_cvt_pk_bf16_f32 v246, v231, v229
    v_cvt_pk_bf16_f32 v247, v227, v225
    v_cvt_pk_bf16_f32 v248, v223, v221
    v_cvt_pk_bf16_f32 v249, v219, v217
    ds_write_b128 v12, v[246:249] offset:10240
    v_lshlrev_b32 v216, 16, v109
    v_and_b32 v217, 0xffff0000, v109
    v_lshlrev_b32 v218, 16, v113
    v_and_b32 v219, 0xffff0000, v113
    v_lshlrev_b32 v220, 16, v117
    v_and_b32 v221, 0xffff0000, v117
    v_lshlrev_b32 v222, 16, v121
    v_and_b32 v223, 0xffff0000, v121
    v_lshlrev_b32 v224, 16, v125
    v_and_b32 v225, 0xffff0000, v125
    v_lshlrev_b32 v226, 16, v129
    v_and_b32 v227, 0xffff0000, v129
    v_lshlrev_b32 v228, 16, v133
    v_and_b32 v229, 0xffff0000, v133
    v_lshlrev_b32 v230, 16, v137
    v_and_b32 v231, 0xffff0000, v137
    v_lshlrev_b32 v232, 16, v141
    v_and_b32 v233, 0xffff0000, v141
    v_lshlrev_b32 v234, 16, v145
    v_and_b32 v235, 0xffff0000, v145
    v_lshlrev_b32 v236, 16, v149
    v_and_b32 v237, 0xffff0000, v149
    v_pk_mul_f32 v[216:217], v[216:217], v[198:199]
    v_lshlrev_b32 v238, 16, v153
    v_pk_fma_f32 v[216:217], v[218:219], v[196:197], v[216:217]
    v_and_b32 v239, 0xffff0000, v153
    v_pk_fma_f32 v[216:217], v[220:221], v[194:195], v[216:217]
    v_pk_fma_f32 v[216:217], v[222:223], v[192:193], v[216:217]
    v_pk_mul_f32 v[216:217], v[216:217], v[238:239]
    v_pk_mul_f32 v[218:219], v[218:219], v[198:199]
    v_lshlrev_b32 v240, 16, v157
    v_pk_fma_f32 v[218:219], v[220:221], v[196:197], v[218:219]
    v_and_b32 v241, 0xffff0000, v157
    v_pk_fma_f32 v[218:219], v[222:223], v[194:195], v[218:219]
    v_pk_fma_f32 v[218:219], v[224:225], v[192:193], v[218:219]
    v_pk_mul_f32 v[218:219], v[218:219], v[240:241]
    v_pk_mul_f32 v[220:221], v[220:221], v[198:199]
    v_lshlrev_b32 v238, 16, v161
    v_pk_fma_f32 v[220:221], v[222:223], v[196:197], v[220:221]
    v_and_b32 v239, 0xffff0000, v161
    v_pk_fma_f32 v[220:221], v[224:225], v[194:195], v[220:221]
    v_pk_fma_f32 v[220:221], v[226:227], v[192:193], v[220:221]
    v_pk_mul_f32 v[220:221], v[220:221], v[238:239]
    v_pk_mul_f32 v[222:223], v[222:223], v[198:199]
    v_lshlrev_b32 v240, 16, v165
    v_pk_fma_f32 v[222:223], v[224:225], v[196:197], v[222:223]
    v_and_b32 v241, 0xffff0000, v165
    v_pk_fma_f32 v[222:223], v[226:227], v[194:195], v[222:223]
    v_pk_fma_f32 v[222:223], v[228:229], v[192:193], v[222:223]
    v_pk_mul_f32 v[222:223], v[222:223], v[240:241]
    v_pk_mul_f32 v[224:225], v[224:225], v[198:199]
    v_lshlrev_b32 v238, 16, v169
    v_pk_fma_f32 v[224:225], v[226:227], v[196:197], v[224:225]
    v_and_b32 v239, 0xffff0000, v169
    v_pk_fma_f32 v[224:225], v[228:229], v[194:195], v[224:225]
    v_pk_fma_f32 v[224:225], v[230:231], v[192:193], v[224:225]
    v_pk_mul_f32 v[224:225], v[224:225], v[238:239]
    v_pk_mul_f32 v[226:227], v[226:227], v[198:199]
    v_lshlrev_b32 v240, 16, v173
    v_pk_fma_f32 v[226:227], v[228:229], v[196:197], v[226:227]
    v_and_b32 v241, 0xffff0000, v173
    v_pk_fma_f32 v[226:227], v[230:231], v[194:195], v[226:227]
    v_pk_fma_f32 v[226:227], v[232:233], v[192:193], v[226:227]
    v_pk_mul_f32 v[226:227], v[226:227], v[240:241]
    v_pk_mul_f32 v[228:229], v[228:229], v[198:199]
    v_lshlrev_b32 v238, 16, v177
    v_pk_fma_f32 v[228:229], v[230:231], v[196:197], v[228:229]
    v_and_b32 v239, 0xffff0000, v177
    v_pk_fma_f32 v[228:229], v[232:233], v[194:195], v[228:229]
    v_pk_fma_f32 v[228:229], v[234:235], v[192:193], v[228:229]
    v_pk_mul_f32 v[228:229], v[228:229], v[238:239]
    v_pk_mul_f32 v[230:231], v[230:231], v[198:199]
    v_lshlrev_b32 v240, 16, v181
    v_pk_fma_f32 v[230:231], v[232:233], v[196:197], v[230:231]
    v_and_b32 v241, 0xffff0000, v181
    v_pk_fma_f32 v[230:231], v[234:235], v[194:195], v[230:231]
    v_pk_fma_f32 v[230:231], v[236:237], v[192:193], v[230:231]
    v_pk_mul_f32 v[230:231], v[230:231], v[240:241]
    v_cvt_pk_bf16_f32 v242, v230, v228
    v_cvt_pk_bf16_f32 v243, v226, v224
    v_cvt_pk_bf16_f32 v244, v222, v220
    v_cvt_pk_bf16_f32 v245, v218, v216
    ds_write_b128 v12, v[242:245] offset:17920
    v_cvt_pk_bf16_f32 v246, v231, v229
    v_cvt_pk_bf16_f32 v247, v227, v225
    v_cvt_pk_bf16_f32 v248, v223, v221
    v_cvt_pk_bf16_f32 v249, v219, v217
    ds_write_b128 v12, v[246:249] offset:25600
    v_lshlrev_b32 v216, 16, v110
    v_and_b32 v217, 0xffff0000, v110
    v_lshlrev_b32 v218, 16, v114
    v_and_b32 v219, 0xffff0000, v114
    v_lshlrev_b32 v220, 16, v118
    v_and_b32 v221, 0xffff0000, v118
    v_lshlrev_b32 v222, 16, v122
    v_and_b32 v223, 0xffff0000, v122
    v_lshlrev_b32 v224, 16, v126
    v_and_b32 v225, 0xffff0000, v126
    v_lshlrev_b32 v226, 16, v130
    v_and_b32 v227, 0xffff0000, v130
    v_lshlrev_b32 v228, 16, v134
    v_and_b32 v229, 0xffff0000, v134
    v_lshlrev_b32 v230, 16, v138
    v_and_b32 v231, 0xffff0000, v138
    v_lshlrev_b32 v232, 16, v142
    v_and_b32 v233, 0xffff0000, v142
    v_lshlrev_b32 v234, 16, v146
    v_and_b32 v235, 0xffff0000, v146
    v_lshlrev_b32 v236, 16, v150
    v_and_b32 v237, 0xffff0000, v150
    v_pk_mul_f32 v[216:217], v[216:217], v[206:207]
    v_lshlrev_b32 v238, 16, v154
    v_pk_fma_f32 v[216:217], v[218:219], v[204:205], v[216:217]
    v_and_b32 v239, 0xffff0000, v154
    v_pk_fma_f32 v[216:217], v[220:221], v[202:203], v[216:217]
    v_pk_fma_f32 v[216:217], v[222:223], v[200:201], v[216:217]
    v_pk_mul_f32 v[216:217], v[216:217], v[238:239]
    v_pk_mul_f32 v[218:219], v[218:219], v[206:207]
    v_lshlrev_b32 v240, 16, v158
    v_pk_fma_f32 v[218:219], v[220:221], v[204:205], v[218:219]
    v_and_b32 v241, 0xffff0000, v158
    v_pk_fma_f32 v[218:219], v[222:223], v[202:203], v[218:219]
    v_pk_fma_f32 v[218:219], v[224:225], v[200:201], v[218:219]
    v_pk_mul_f32 v[218:219], v[218:219], v[240:241]
    v_pk_mul_f32 v[220:221], v[220:221], v[206:207]
    v_lshlrev_b32 v238, 16, v162
    v_pk_fma_f32 v[220:221], v[222:223], v[204:205], v[220:221]
    v_and_b32 v239, 0xffff0000, v162
    v_pk_fma_f32 v[220:221], v[224:225], v[202:203], v[220:221]
    v_pk_fma_f32 v[220:221], v[226:227], v[200:201], v[220:221]
    v_pk_mul_f32 v[220:221], v[220:221], v[238:239]
    v_pk_mul_f32 v[222:223], v[222:223], v[206:207]
    v_lshlrev_b32 v240, 16, v166
    v_pk_fma_f32 v[222:223], v[224:225], v[204:205], v[222:223]
    v_and_b32 v241, 0xffff0000, v166
    v_pk_fma_f32 v[222:223], v[226:227], v[202:203], v[222:223]
    v_pk_fma_f32 v[222:223], v[228:229], v[200:201], v[222:223]
    v_pk_mul_f32 v[222:223], v[222:223], v[240:241]
    v_pk_mul_f32 v[224:225], v[224:225], v[206:207]
    v_lshlrev_b32 v238, 16, v170
    v_pk_fma_f32 v[224:225], v[226:227], v[204:205], v[224:225]
    v_and_b32 v239, 0xffff0000, v170
    v_pk_fma_f32 v[224:225], v[228:229], v[202:203], v[224:225]
    v_pk_fma_f32 v[224:225], v[230:231], v[200:201], v[224:225]
    v_pk_mul_f32 v[224:225], v[224:225], v[238:239]
    v_pk_mul_f32 v[226:227], v[226:227], v[206:207]
    v_lshlrev_b32 v240, 16, v174
    v_pk_fma_f32 v[226:227], v[228:229], v[204:205], v[226:227]
    v_and_b32 v241, 0xffff0000, v174
    v_pk_fma_f32 v[226:227], v[230:231], v[202:203], v[226:227]
    v_pk_fma_f32 v[226:227], v[232:233], v[200:201], v[226:227]
    v_pk_mul_f32 v[226:227], v[226:227], v[240:241]
    v_pk_mul_f32 v[228:229], v[228:229], v[206:207]
    v_lshlrev_b32 v238, 16, v178
    v_pk_fma_f32 v[228:229], v[230:231], v[204:205], v[228:229]
    v_and_b32 v239, 0xffff0000, v178
    v_pk_fma_f32 v[228:229], v[232:233], v[202:203], v[228:229]
    v_pk_fma_f32 v[228:229], v[234:235], v[200:201], v[228:229]
    v_pk_mul_f32 v[228:229], v[228:229], v[238:239]
    v_pk_mul_f32 v[230:231], v[230:231], v[206:207]
    v_lshlrev_b32 v240, 16, v182
    v_pk_fma_f32 v[230:231], v[232:233], v[204:205], v[230:231]
    v_and_b32 v241, 0xffff0000, v182
    v_pk_fma_f32 v[230:231], v[234:235], v[202:203], v[230:231]
    v_pk_fma_f32 v[230:231], v[236:237], v[200:201], v[230:231]
    v_pk_mul_f32 v[230:231], v[230:231], v[240:241]
    v_cvt_pk_bf16_f32 v242, v230, v228
    v_cvt_pk_bf16_f32 v243, v226, v224
    v_cvt_pk_bf16_f32 v244, v222, v220
    v_cvt_pk_bf16_f32 v245, v218, v216
    ds_write_b128 v12, v[242:245] offset:33280
    v_cvt_pk_bf16_f32 v246, v231, v229
    v_cvt_pk_bf16_f32 v247, v227, v225
    v_cvt_pk_bf16_f32 v248, v223, v221
    v_cvt_pk_bf16_f32 v249, v219, v217
    ds_write_b128 v12, v[246:249] offset:40960
    v_lshlrev_b32 v216, 16, v111
    v_and_b32 v217, 0xffff0000, v111
    v_lshlrev_b32 v218, 16, v115
    v_and_b32 v219, 0xffff0000, v115
    v_lshlrev_b32 v220, 16, v119
    v_and_b32 v221, 0xffff0000, v119
    v_lshlrev_b32 v222, 16, v123
    v_and_b32 v223, 0xffff0000, v123
    v_lshlrev_b32 v224, 16, v127
    v_and_b32 v225, 0xffff0000, v127
    v_lshlrev_b32 v226, 16, v131
    v_and_b32 v227, 0xffff0000, v131
    v_lshlrev_b32 v228, 16, v135
    v_and_b32 v229, 0xffff0000, v135
    v_lshlrev_b32 v230, 16, v139
    v_and_b32 v231, 0xffff0000, v139
    v_lshlrev_b32 v232, 16, v143
    v_and_b32 v233, 0xffff0000, v143
    v_lshlrev_b32 v234, 16, v147
    v_and_b32 v235, 0xffff0000, v147
    v_lshlrev_b32 v236, 16, v151
    v_and_b32 v237, 0xffff0000, v151
    v_pk_mul_f32 v[216:217], v[216:217], v[214:215]
    v_lshlrev_b32 v238, 16, v155
    v_pk_fma_f32 v[216:217], v[218:219], v[212:213], v[216:217]
    v_and_b32 v239, 0xffff0000, v155
    v_pk_fma_f32 v[216:217], v[220:221], v[210:211], v[216:217]
    v_pk_fma_f32 v[216:217], v[222:223], v[208:209], v[216:217]
    v_pk_mul_f32 v[216:217], v[216:217], v[238:239]
    v_pk_mul_f32 v[218:219], v[218:219], v[214:215]
    v_lshlrev_b32 v240, 16, v159
    v_pk_fma_f32 v[218:219], v[220:221], v[212:213], v[218:219]
    v_and_b32 v241, 0xffff0000, v159
    v_pk_fma_f32 v[218:219], v[222:223], v[210:211], v[218:219]
    v_pk_fma_f32 v[218:219], v[224:225], v[208:209], v[218:219]
    v_pk_mul_f32 v[218:219], v[218:219], v[240:241]
    v_pk_mul_f32 v[220:221], v[220:221], v[214:215]
    v_lshlrev_b32 v238, 16, v163
    v_pk_fma_f32 v[220:221], v[222:223], v[212:213], v[220:221]
    v_and_b32 v239, 0xffff0000, v163
    v_pk_fma_f32 v[220:221], v[224:225], v[210:211], v[220:221]
    v_pk_fma_f32 v[220:221], v[226:227], v[208:209], v[220:221]
    v_pk_mul_f32 v[220:221], v[220:221], v[238:239]
    v_pk_mul_f32 v[222:223], v[222:223], v[214:215]
    v_lshlrev_b32 v240, 16, v167
    v_pk_fma_f32 v[222:223], v[224:225], v[212:213], v[222:223]
    v_and_b32 v241, 0xffff0000, v167
    v_pk_fma_f32 v[222:223], v[226:227], v[210:211], v[222:223]
    v_pk_fma_f32 v[222:223], v[228:229], v[208:209], v[222:223]
    v_pk_mul_f32 v[222:223], v[222:223], v[240:241]
    v_pk_mul_f32 v[224:225], v[224:225], v[214:215]
    v_lshlrev_b32 v238, 16, v171
    v_pk_fma_f32 v[224:225], v[226:227], v[212:213], v[224:225]
    v_and_b32 v239, 0xffff0000, v171
    v_pk_fma_f32 v[224:225], v[228:229], v[210:211], v[224:225]
    v_pk_fma_f32 v[224:225], v[230:231], v[208:209], v[224:225]
    v_pk_mul_f32 v[224:225], v[224:225], v[238:239]
    v_pk_mul_f32 v[226:227], v[226:227], v[214:215]
    v_lshlrev_b32 v240, 16, v175
    v_pk_fma_f32 v[226:227], v[228:229], v[212:213], v[226:227]
    v_and_b32 v241, 0xffff0000, v175
    v_pk_fma_f32 v[226:227], v[230:231], v[210:211], v[226:227]
    v_pk_fma_f32 v[226:227], v[232:233], v[208:209], v[226:227]
    v_pk_mul_f32 v[226:227], v[226:227], v[240:241]
    v_pk_mul_f32 v[228:229], v[228:229], v[214:215]
    v_lshlrev_b32 v238, 16, v179
    v_pk_fma_f32 v[228:229], v[230:231], v[212:213], v[228:229]
    v_and_b32 v239, 0xffff0000, v179
    v_pk_fma_f32 v[228:229], v[232:233], v[210:211], v[228:229]
    v_pk_fma_f32 v[228:229], v[234:235], v[208:209], v[228:229]
    v_pk_mul_f32 v[228:229], v[228:229], v[238:239]
    v_pk_mul_f32 v[230:231], v[230:231], v[214:215]
    v_lshlrev_b32 v240, 16, v183
    v_pk_fma_f32 v[230:231], v[232:233], v[212:213], v[230:231]
    v_and_b32 v241, 0xffff0000, v183
    v_pk_fma_f32 v[230:231], v[234:235], v[210:211], v[230:231]
    v_pk_fma_f32 v[230:231], v[236:237], v[208:209], v[230:231]
    v_pk_mul_f32 v[230:231], v[230:231], v[240:241]
    v_cvt_pk_bf16_f32 v242, v230, v228
    v_cvt_pk_bf16_f32 v243, v226, v224
    v_cvt_pk_bf16_f32 v244, v222, v220
    v_cvt_pk_bf16_f32 v245, v218, v216
    ds_write_b128 v12, v[242:245] offset:48640
    v_cvt_pk_bf16_f32 v246, v231, v229
    v_cvt_pk_bf16_f32 v247, v227, v225
    v_cvt_pk_bf16_f32 v248, v223, v221
    v_cvt_pk_bf16_f32 v249, v219, v217
    ds_write_b128 v12, v[246:249] offset:56320
    s_lshl_b32 s4, s61, 12
    v_add_u32 v6, s4, v5
    buffer_load_dwordx4 v[184:187], v2, s[36:39], s4 offen offset:0
    buffer_load_dwordx4 v[188:191], v2, s[36:39], s4 offen offset:1024
    buffer_load_dwordx4 v[192:195], v2, s[36:39], s4 offen offset:2048
    buffer_load_dwordx4 v[196:199], v2, s[36:39], s4 offen offset:3072
    buffer_load_dword v200, v6, s[36:39], 0 offen
    buffer_load_dword v201, v2, s[36:39], s4 offen offset:1020
    buffer_load_dword v202, v2, s[36:39], s4 offen offset:2044
    buffer_load_dword v203, v2, s[36:39], s4 offen offset:3068
    s_waitcnt vmcnt(0)
    s_waitcnt lgkmcnt(0)
    s_barrier
    s_mov_b32 s64, 0
.chan_347:
    s_lshr_b32 s4, s61, 1
    s_lshl_b32 s4, s4, 2
    s_load_dword s65, s[50:51], s4
    s_lshl_b32 s7, s61, 12
    s_add_u32 s7, s7, 130023424
    v_writelane_b32 v200, 0, 0
    ds_write_b128 v9, v[184:187] offset:64
    v_alignbit_b32 v204, v184, v200, 16
    v_alignbit_b32 v205, v185, v184, 16
    v_alignbit_b32 v206, v186, v185, 16
    v_alignbit_b32 v207, v187, v186, 16
    ds_write_b128 v9, v[204:207] offset:4224
    ds_write_b128 v9, v[188:191] offset:1088
    v_alignbit_b32 v208, v188, v201, 16
    v_alignbit_b32 v209, v189, v188, 16
    v_alignbit_b32 v210, v190, v189, 16
    v_alignbit_b32 v211, v191, v190, 16
    ds_write_b128 v9, v[208:211] offset:5248
    ds_write_b128 v9, v[192:195] offset:2112
    v_alignbit_b32 v212, v192, v202, 16
    v_alignbit_b32 v213, v193, v192, 16
    v_alignbit_b32 v214, v194, v193, 16
    v_alignbit_b32 v215, v195, v194, 16
    ds_write_b128 v9, v[212:215] offset:6272
    ds_write_b128 v9, v[196:199] offset:3136
    v_alignbit_b32 v216, v196, v203, 16
    v_alignbit_b32 v217, v197, v196, 16
    v_alignbit_b32 v218, v198, v197, 16
    v_alignbit_b32 v219, v199, v198, 16
    ds_write_b128 v9, v[216:219] offset:7296
    s_and_b32 s4, s61, 1
    s_lshl_b32 s4, s4, 4
    s_waitcnt lgkmcnt(0)
    s_lshr_b32 s65, s65, s4
    s_pack_ll_b32_b16 s65, s65, s65
    s_add_u32 s61, s61, 4
    s_cmp_eq_u32 s64, 3
    s_cbranch_scc1 .chan_347_ns
    s_lshl_b32 s4, s61, 12
    v_add_u32 v6, s4, v5
    buffer_load_dwordx4 v[184:187], v2, s[36:39], s4 offen offset:0
    buffer_load_dwordx4 v[188:191], v2, s[36:39], s4 offen offset:1024
    buffer_load_dwordx4 v[192:195], v2, s[36:39], s4 offen offset:2048
    buffer_load_dwordx4 v[196:199], v2, s[36:39], s4 offen offset:3072
    buffer_load_dword v200, v6, s[36:39], 0 offen
    buffer_load_dword v201, v2, s[36:39], s4 offen offset:1020
    buffer_load_dword v202, v2, s[36:39], s4 offen offset:2044
    buffer_load_dword v203, v2, s[36:39], s4 offen offset:3068
.chan_347_ns:
    v_and_b32 v16, s65, v24
    v_and_b32 v17, s65, v25
    v_and_b32 v18, s65, v26
    v_and_b32 v19, s65, v27
    v_and_b32 v20, s65, v28
    v_and_b32 v21, s65, v29
    v_and_b32 v22, s65, v30
    v_and_b32 v23, s65, v31
    v_mov_b32 v14, v10
    ds_read2_b32 a[32:33], v14 offset0:0 offset1:1
    ds_read2_b32 a[34:35], v14 offset0:2 offset1:3
    ds_read_b128 a[56:59], v11 offset:7632
    ds_read_b128 a[60:63], v11 offset:5072
    ds_read2_b32 a[36:37], v14 offset0:8 offset1:9
    ds_read2_b32 a[38:39], v14 offset0:10 offset1:11
    ds_read_b128 a[64:67], v11 offset:7600
    ds_read_b128 a[68:71], v11 offset:5040
    ds_read2_b32 a[40:41], v14 offset0:16 offset1:17
    ds_read2_b32 a[42:43], v14 offset0:18 offset1:19
    ds_read_b128 a[72:75], v11 offset:7552
    ds_read_b128 a[76:79], v11 offset:4992
    s_waitcnt lgkmcnt(9)
    v_mfma_f32_32x32x16_bf16 a[16:31], a[32:35], a[56:59], 0
    v_mfma_f32_32x32x16_bf16 a[16:31], v[20:23], a[56:59], a[16:31]
    ds_read2_b32 a[44:45], v14 offset0:24 offset1:25
    ds_read2_b32 a[46:47], v14 offset0:26 offset1:27
    s_waitcnt lgkmcnt(10)
    v_mfma_f32_32x32x16_bf16 a[0:15], a[32:35], a[60:63], 0
    v_mfma_f32_32x32x16_bf16 a[0:15], v[20:23], a[60:63], a[0:15]
    ds_read_b128 a[80:83], v11 offset:7520
    ds_read_b128 a[84:87], v11 offset:4960
    s_waitcnt lgkmcnt(9)
    v_mfma_f32_32x32x16_bf16 a[16:31], a[36:39], a[64:67], a[16:31]
    v_mfma_f32_32x32x16_bf16 a[16:31], v[16:19], a[64:67], a[16:31]
    ds_read2_b32 a[48:49], v14 offset0:32 offset1:33
    ds_read2_b32 a[50:51], v14 offset0:34 offset1:35
    s_waitcnt lgkmcnt(10)
    v_mfma_f32_32x32x16_bf16 a[0:15], a[36:39], a[68:71], a[0:15]
    v_mfma_f32_32x32x16_bf16 a[0:15], v[16:19], a[68:71], a[0:15]
    ds_read_b128 a[56:59], v11 offset:7472
    ds_read_b128 a[60:63], v11 offset:4912
    s_waitcnt lgkmcnt(9)
    v_mfma_f32_32x32x16_bf16 a[16:31], a[40:43], a[72:75], a[16:31]
    ds_read2_b32 a[52:53], v14 offset0:40 offset1:41
    ds_read2_b32 a[54:55], v14 offset0:42 offset1:43
    s_waitcnt lgkmcnt(10)
    v_mfma_f32_32x32x16_bf16 a[0:15], a[40:43], a[76:79], a[0:15]
    ds_read_b128 a[64:67], v11 offset:7440
    ds_read_b128 a[68:71], v11 offset:4880
    s_waitcnt lgkmcnt(9)
    v_mfma_f32_32x32x16_bf16 a[16:31], a[44:47], a[80:83], a[16:31]
    ds_read2_b32 a[32:33], v14 offset0:48 offset1:49
    ds_read2_b32 a[34:35], v14 offset0:50 offset1:51
    s_waitcnt lgkmcnt(10)
    v_mfma_f32_32x32x16_bf16 a[0:15], a[44:47], a[84:87], a[0:15]
    ds_read_b128 a[72:75], v11 offset:7392
    ds_read_b128 a[76:79], v11 offset:4832
    s_waitcnt lgkmcnt(9)
    v_mfma_f32_32x32x16_bf16 a[16:31], a[48:51], a[56:59], a[16:31]
    ds_read2_b32 a[36:37], v14 offset0:56 offset1:57
    ds_read2_b32 a[38:39], v14 offset0:58 offset1:59
    s_waitcnt lgkmcnt(10)
    v_mfma_f32_32x32x16_bf16 a[0:15], a[48:51], a[60:63], a[0:15]
    ds_read_b128 a[80:83], v11 offset:7360
    ds_read_b128 a[84:87], v11 offset:4800
    s_waitcnt lgkmcnt(9)
    v_mfma_f32_32x32x16_bf16 a[16:31], a[52:55], a[64:67], a[16:31]
    ds_read2_b32 a[40:41], v14 offset0:64 offset1:65
    ds_read2_b32 a[42:43], v14 offset0:66 offset1:67
    s_waitcnt lgkmcnt(10)
    v_mfma_f32_32x32x16_bf16 a[0:15], a[52:55], a[68:71], a[0:15]
    ds_read_b128 a[56:59], v11 offset:7312
    ds_read_b128 a[60:63], v11 offset:4752
    s_waitcnt lgkmcnt(9)
    v_mfma_f32_32x32x16_bf16 a[16:31], a[32:35], a[72:75], a[16:31]
    ds_read2_b32 a[44:45], v14 offset0:72 offset1:73
    ds_read2_b32 a[46:47], v14 offset0:74 offset1:75
    s_waitcnt lgkmcnt(10)
    v_mfma_f32_32x32x16_bf16 a[0:15], a[32:35], a[76:79], a[0:15]
    ds_read_b128 a[64:67], v11 offset:7280
    ds_read_b128 a[68:71], v11 offset:4720
    s_waitcnt lgkmcnt(9)
    v_mfma_f32_32x32x16_bf16 a[16:31], a[36:39], a[80:83], a[16:31]
    ds_read2_b32 a[48:49], v14 offset0:80 offset1:81
    ds_read2_b32 a[50:51], v14 offset0:82 offset1:83
    s_waitcnt lgkmcnt(10)
    v_mfma_f32_32x32x16_bf16 a[0:15], a[36:39], a[84:87], a[0:15]
    ds_read_b128 a[72:75], v11 offset:7232
    ds_read_b128 a[76:79], v11 offset:4672
    s_waitcnt lgkmcnt(9)
    v_mfma_f32_32x32x16_bf16 a[16:31], a[40:43], a[56:59], a[16:31]
    ds_read2_b32 a[52:53], v14 offset0:88 offset1:89
    ds_read2_b32 a[54:55], v14 offset0:90 offset1:91
    s_waitcnt lgkmcnt(10)
    v_mfma_f32_32x32x16_bf16 a[0:15], a[40:43], a[60:63], a[0:15]
    ds_read_b128 a[80:83], v11 offset:7200
    ds_read_b128 a[84:87], v11 offset:4640
    s_waitcnt lgkmcnt(9)
    v_mfma_f32_32x32x16_bf16 a[16:31], a[44:47], a[64:67], a[16:31]
    ds_read2_b32 a[32:33], v14 offset0:96 offset1:97
    ds_read2_b32 a[34:35], v14 offset0:98 offset1:99
    s_waitcnt lgkmcnt(10)
    v_mfma_f32_32x32x16_bf16 a[0:15], a[44:47], a[68:71], a[0:15]
    ds_read_b128 a[56:59], v11 offset:7152
    ds_read_b128 a[60:63], v11 offset:4592
    s_waitcnt lgkmcnt(9)
    v_mfma_f32_32x32x16_bf16 a[16:31], a[48:51], a[72:75], a[16:31]
    ds_read2_b32 a[36:37], v14 offset0:104 offset1:105
    ds_read2_b32 a[38:39], v14 offset0:106 offset1:107
    s_waitcnt lgkmcnt(10)
    v_mfma_f32_32x32x16_bf16 a[0:15], a[48:51], a[76:79], a[0:15]
    ds_read_b128 a[64:67], v11 offset:7120
    ds_read_b128 a[68:71], v11 offset:4560
    s_waitcnt lgkmcnt(9)
    v_mfma_f32_32x32x16_bf16 a[16:31], a[52:55], a[80:83], a[16:31]
    ds_read2_b32 a[40:41], v14 offset0:112 offset1:113
    ds_read2_b32 a[42:43], v14 offset0:114 offset1:115
    s_waitcnt lgkmcnt(10)
    v_mfma_f32_32x32x16_bf16 a[0:15], a[52:55], a[84:87], a[0:15]
    ds_read_b128 a[72:75], v11 offset:7072
    ds_read_b128 a[76:79], v11 offset:4512
    s_waitcnt lgkmcnt(9)
    v_mfma_f32_32x32x16_bf16 a[16:31], a[32:35], a[56:59], a[16:31]
    ds_read2_b32 a[44:45], v14 offset0:120 offset1:121
    ds_read2_b32 a[46:47], v14 offset0:122 offset1:123
    s_waitcnt lgkmcnt(10)
    v_mfma_f32_32x32x16_bf16 a[0:15], a[32:35], a[60:63], a[0:15]
    ds_read_b128 a[80:83], v11 offset:7040
    ds_read_b128 a[84:87], v11 offset:4480
    s_waitcnt lgkmcnt(9)
    v_mfma_f32_32x32x16_bf16 a[16:31], a[36:39], a[64:67], a[16:31]
    ds_read2_b32 a[48:49], v14 offset0:128 offset1:129
    ds_read2_b32 a[50:51], v14 offset0:130 offset1:131
    s_waitcnt lgkmcnt(10)
    v_mfma_f32_32x32x16_bf16 a[0:15], a[36:39], a[68:71], a[0:15]
    ds_read_b128 a[56:59], v11 offset:6992
    ds_read_b128 a[60:63], v11 offset:4432
    s_waitcnt lgkmcnt(9)
    v_mfma_f32_32x32x16_bf16 a[16:31], a[40:43], a[72:75], a[16:31]
    ds_read2_b32 a[52:53], v14 offset0:136 offset1:137
    ds_read2_b32 a[54:55], v14 offset0:138 offset1:139
    s_waitcnt lgkmcnt(10)
    v_mfma_f32_32x32x16_bf16 a[0:15], a[40:43], a[76:79], a[0:15]
    ds_read_b128 a[64:67], v11 offset:6960
    ds_read_b128 a[68:71], v11 offset:4400
    s_waitcnt lgkmcnt(9)
    v_mfma_f32_32x32x16_bf16 a[16:31], a[44:47], a[80:83], a[16:31]
    ds_read2_b32 a[32:33], v14 offset0:144 offset1:145
    ds_read2_b32 a[34:35], v14 offset0:146 offset1:147
    s_waitcnt lgkmcnt(10)
    v_mfma_f32_32x32x16_bf16 a[0:15], a[44:47], a[84:87], a[0:15]
    ds_read_b128 a[72:75], v11 offset:6912
    ds_read_b128 a[76:79], v11 offset:4352
    s_waitcnt lgkmcnt(9)
    v_mfma_f32_32x32x16_bf16 a[16:31], a[48:51], a[56:59], a[16:31]
    ds_read2_b32 a[36:37], v14 offset0:152 offset1:153
    ds_read2_b32 a[38:39], v14 offset0:154 offset1:155
    s_waitcnt lgkmcnt(10)
    v_mfma_f32_32x32x16_bf16 a[0:15], a[48:51], a[60:63], a[0:15]
    ds_read_b128 a[80:83], v11 offset:6880
    ds_read_b128 a[84:87], v11 offset:4320
    s_waitcnt lgkmcnt(9)
    v_mfma_f32_32x32x16_bf16 a[16:31], a[52:55], a[64:67], a[16:31]
    ds_read2_b32 a[40:41], v14 offset0:160 offset1:161
    ds_read2_b32 a[42:43], v14 offset0:162 offset1:163
    s_waitcnt lgkmcnt(10)
    v_mfma_f32_32x32x16_bf16 a[0:15], a[52:55], a[68:71], a[0:15]
    ds_read_b128 a[56:59], v11 offset:6832
    ds_read_b128 a[60:63], v11 offset:4272
    s_waitcnt lgkmcnt(9)
    v_mfma_f32_32x32x16_bf16 a[16:31], a[32:35], a[72:75], a[16:31]
    ds_read2_b32 a[44:45], v14 offset0:168 offset1:169
    ds_read2_b32 a[46:47], v14 offset0:170 offset1:171
    s_waitcnt lgkmcnt(10)
    v_mfma_f32_32x32x16_bf16 a[0:15], a[32:35], a[76:79], a[0:15]
    ds_read_b128 a[64:67], v11 offset:6800
    ds_read_b128 a[68:71], v11 offset:4240
    s_waitcnt lgkmcnt(9)
    v_mfma_f32_32x32x16_bf16 a[16:31], a[36:39], a[80:83], a[16:31]
    ds_read2_b32 a[48:49], v14 offset0:176 offset1:177
    ds_read2_b32 a[50:51], v14 offset0:178 offset1:179
    s_waitcnt lgkmcnt(10)
    v_mfma_f32_32x32x16_bf16 a[0:15], a[36:39], a[84:87], a[0:15]
    ds_read_b128 a[72:75], v11 offset:6752
    ds_read_b128 a[76:79], v11 offset:4192
    s_waitcnt lgkmcnt(9)
    v_mfma_f32_32x32x16_bf16 a[16:31], a[40:43], a[56:59], a[16:31]
    ds_read2_b32 a[52:53], v14 offset0:184 offset1:185
    ds_read2_b32 a[54:55], v14 offset0:186 offset1:187
    s_waitcnt lgkmcnt(10)
    v_mfma_f32_32x32x16_bf16 a[0:15], a[40:43], a[60:63], a[0:15]
    ds_read_b128 a[80:83], v11 offset:6720
    ds_read_b128 a[84:87], v11 offset:4160
    s_waitcnt lgkmcnt(9)
    v_mfma_f32_32x32x16_bf16 a[16:31], a[44:47], a[64:67], a[16:31]
    ds_read2_b32 a[32:33], v14 offset0:192 offset1:193
    ds_read2_b32 a[34:35], v14 offset0:194 offset1:195
    s_waitcnt lgkmcnt(10)
    v_mfma_f32_32x32x16_bf16 a[0:15], a[44:47], a[68:71], a[0:15]
    ds_read_b128 a[56:59], v11 offset:6672
    ds_read_b128 a[60:63], v11 offset:4112
    s_waitcnt lgkmcnt(9)
    v_mfma_f32_32x32x16_bf16 a[16:31], a[48:51], a[72:75], a[16:31]
    ds_read2_b32 a[36:37], v14 offset0:200 offset1:201
    ds_read2_b32 a[38:39], v14 offset0:202 offset1:203
    s_waitcnt lgkmcnt(10)
    v_mfma_f32_32x32x16_bf16 a[0:15], a[48:51], a[76:79], a[0:15]
    ds_read_b128 a[64:67], v11 offset:6640
    ds_read_b128 a[68:71], v11 offset:4080
    s_waitcnt lgkmcnt(9)
    v_mfma_f32_32x32x16_bf16 a[16:31], a[52:55], a[80:83], a[16:31]
    ds_read2_b32 a[40:41], v14 offset0:208 offset1:209
    ds_read2_b32 a[42:43], v14 offset0:210 offset1:211
    s_waitcnt lgkmcnt(10)
    v_mfma_f32_32x32x16_bf16 a[0:15], a[52:55], a[84:87], a[0:15]
    ds_read_b128 a[72:75], v11 offset:6592
    ds_read_b128 a[76:79], v11 offset:4032
    s_waitcnt lgkmcnt(9)
    v_mfma_f32_32x32x16_bf16 a[16:31], a[32:35], a[56:59], a[16:31]
    ds_read2_b32 a[44:45], v14 offset0:216 offset1:217
    ds_read2_b32 a[46:47], v14 offset0:218 offset1:219
    s_waitcnt lgkmcnt(10)
    v_mfma_f32_32x32x16_bf16 a[0:15], a[32:35], a[60:63], a[0:15]
    ds_read_b128 a[80:83], v11 offset:6560
    ds_read_b128 a[84:87], v11 offset:4000
    s_waitcnt lgkmcnt(9)
    v_mfma_f32_32x32x16_bf16 a[16:31], a[36:39], a[64:67], a[16:31]
    ds_read2_b32 a[48:49], v14 offset0:224 offset1:225
    ds_read2_b32 a[50:51], v14 offset0:226 offset1:227
    s_waitcnt lgkmcnt(10)
    v_mfma_f32_32x32x16_bf16 a[0:15], a[36:39], a[68:71], a[0:15]
    ds_read_b128 a[56:59], v11 offset:6512
    ds_read_b128 a[60:63], v11 offset:3952
    s_waitcnt lgkmcnt(9)
    v_mfma_f32_32x32x16_bf16 a[16:31], a[40:43], a[72:75], a[16:31]
    ds_read2_b32 a[52:53], v14 offset0:232 offset1:233
    ds_read2_b32 a[54:55], v14 offset0:234 offset1:235
    s_waitcnt lgkmcnt(10)
    v_mfma_f32_32x32x16_bf16 a[0:15], a[40:43], a[76:79], a[0:15]
    ds_read_b128 a[64:67], v11 offset:6480
    ds_read_b128 a[68:71], v11 offset:3920
    s_waitcnt lgkmcnt(9)
    v_mfma_f32_32x32x16_bf16 a[16:31], a[44:47], a[80:83], a[16:31]
    ds_read2_b32 a[32:33], v14 offset0:240 offset1:241
    ds_read2_b32 a[34:35], v14 offset0:242 offset1:243
    s_waitcnt lgkmcnt(10)
    v_mfma_f32_32x32x16_bf16 a[0:15], a[44:47], a[84:87], a[0:15]
    ds_read_b128 a[72:75], v11 offset:6432
    ds_read_b128 a[76:79], v11 offset:3872
    s_waitcnt lgkmcnt(9)
    v_mfma_f32_32x32x16_bf16 a[16:31], a[48:51], a[56:59], a[16:31]
    ds_read2_b32 a[36:37], v14 offset0:248 offset1:249
    ds_read2_b32 a[38:39], v14 offset0:250 offset1:251
    v_add_u32 v14, 1024, v14
    s_waitcnt lgkmcnt(10)
    v_mfma_f32_32x32x16_bf16 a[0:15], a[48:51], a[60:63], a[0:15]
    ds_read_b128 a[80:83], v11 offset:6400
    ds_read_b128 a[84:87], v11 offset:3840
    s_waitcnt lgkmcnt(9)
    v_mfma_f32_32x32x16_bf16 a[16:31], a[52:55], a[64:67], a[16:31]
    ds_read2_b32 a[40:41], v14 offset0:0 offset1:1
    ds_read2_b32 a[42:43], v14 offset0:2 offset1:3
    s_waitcnt lgkmcnt(10)
    v_mfma_f32_32x32x16_bf16 a[0:15], a[52:55], a[68:71], a[0:15]
    ds_read_b128 a[56:59], v11 offset:6352
    ds_read_b128 a[60:63], v11 offset:3792
    s_waitcnt lgkmcnt(9)
    v_mfma_f32_32x32x16_bf16 a[16:31], a[32:35], a[72:75], a[16:31]
    ds_read2_b32 a[44:45], v14 offset0:8 offset1:9
    ds_read2_b32 a[46:47], v14 offset0:10 offset1:11
    s_waitcnt lgkmcnt(10)
    v_mfma_f32_32x32x16_bf16 a[0:15], a[32:35], a[76:79], a[0:15]
    ds_read_b128 a[64:67], v11 offset:6320
    ds_read_b128 a[68:71], v11 offset:3760
    s_waitcnt lgkmcnt(9)
    v_mfma_f32_32x32x16_bf16 a[16:31], a[36:39], a[80:83], a[16:31]
    ds_read2_b32 a[48:49], v14 offset0:16 offset1:17
    ds_read2_b32 a[50:51], v14 offset0:18 offset1:19
    s_waitcnt lgkmcnt(10)
    v_mfma_f32_32x32x16_bf16 a[0:15], a[36:39], a[84:87], a[0:15]
    ds_read_b128 a[72:75], v11 offset:6272
    ds_read_b128 a[76:79], v11 offset:3712
    s_waitcnt lgkmcnt(9)
    v_mfma_f32_32x32x16_bf16 a[16:31], a[40:43], a[56:59], a[16:31]
    ds_read2_b32 a[52:53], v14 offset0:24 offset1:25
    ds_read2_b32 a[54:55], v14 offset0:26 offset1:27
    s_waitcnt lgkmcnt(10)
    v_mfma_f32_32x32x16_bf16 a[0:15], a[40:43], a[60:63], a[0:15]
    ds_read_b128 a[80:83], v11 offset:6240
    ds_read_b128 a[84:87], v11 offset:3680
    s_waitcnt lgkmcnt(9)
    v_mfma_f32_32x32x16_bf16 a[16:31], a[44:47], a[64:67], a[16:31]
    ds_read2_b32 a[32:33], v14 offset0:32 offset1:33
    ds_read2_b32 a[34:35], v14 offset0:34 offset1:35
    s_waitcnt lgkmcnt(10)
    v_mfma_f32_32x32x16_bf16 a[0:15], a[44:47], a[68:71], a[0:15]
    ds_read_b128 a[56:59], v11 offset:6192
    ds_read_b128 a[60:63], v11 offset:3632
    s_waitcnt lgkmcnt(9)
    v_mfma_f32_32x32x16_bf16 a[16:31], a[48:51], a[72:75], a[16:31]
    ds_read2_b32 a[36:37], v14 offset0:40 offset1:41
    ds_read2_b32 a[38:39], v14 offset0:42 offset1:43
    s_waitcnt lgkmcnt(10)
    v_mfma_f32_32x32x16_bf16 a[0:15], a[48:51], a[76:79], a[0:15]
    ds_read_b128 a[64:67], v11 offset:6160
    ds_read_b128 a[68:71], v11 offset:3600
    s_waitcnt lgkmcnt(9)
    v_mfma_f32_32x32x16_bf16 a[16:31], a[52:55], a[80:83], a[16:31]
    ds_read2_b32 a[40:41], v14 offset0:48 offset1:49
    ds_read2_b32 a[42:43], v14 offset0:50 offset1:51
    s_waitcnt lgkmcnt(10)
    v_mfma_f32_32x32x16_bf16 a[0:15], a[52:55], a[84:87], a[0:15]
    ds_read_b128 a[72:75], v11 offset:6112
    ds_read_b128 a[76:79], v11 offset:3552
    s_waitcnt lgkmcnt(9)
    v_mfma_f32_32x32x16_bf16 a[16:31], a[32:35], a[56:59], a[16:31]
    ds_read2_b32 a[44:45], v14 offset0:56 offset1:57
    ds_read2_b32 a[46:47], v14 offset0:58 offset1:59
    s_waitcnt lgkmcnt(10)
    v_mfma_f32_32x32x16_bf16 a[0:15], a[32:35], a[60:63], a[0:15]
    ds_read_b128 a[80:83], v11 offset:6080
    ds_read_b128 a[84:87], v11 offset:3520
    s_waitcnt lgkmcnt(9)
    v_mfma_f32_32x32x16_bf16 a[16:31], a[36:39], a[64:67], a[16:31]
    ds_read2_b32 a[48:49], v14 offset0:64 offset1:65
    ds_read2_b32 a[50:51], v14 offset0:66 offset1:67
    s_waitcnt lgkmcnt(10)
    v_mfma_f32_32x32x16_bf16 a[0:15], a[36:39], a[68:71], a[0:15]
    ds_read_b128 a[56:59], v11 offset:6032
    ds_read_b128 a[60:63], v11 offset:3472
    s_waitcnt lgkmcnt(9)
    v_mfma_f32_32x32x16_bf16 a[16:31], a[40:43], a[72:75], a[16:31]
    ds_read2_b32 a[52:53], v14 offset0:72 offset1:73
    ds_read2_b32 a[54:55], v14 offset0:74 offset1:75
    s_waitcnt lgkmcnt(10)
    v_mfma_f32_32x32x16_bf16 a[0:15], a[40:43], a[76:79], a[0:15]
    ds_read_b128 a[64:67], v11 offset:6000
    ds_read_b128 a[68:71], v11 offset:3440
    s_waitcnt lgkmcnt(9)
    v_mfma_f32_32x32x16_bf16 a[16:31], a[44:47], a[80:83], a[16:31]
    ds_read2_b32 a[32:33], v14 offset0:80 offset1:81
    ds_read2_b32 a[34:35], v14 offset0:82 offset1:83
    s_waitcnt lgkmcnt(10)
    v_mfma_f32_32x32x16_bf16 a[0:15], a[44:47], a[84:87], a[0:15]
    ds_read_b128 a[72:75], v11 offset:5952
    ds_read_b128 a[76:79], v11 offset:3392
    s_waitcnt lgkmcnt(9)
    v_mfma_f32_32x32x16_bf16 a[16:31], a[48:51], a[56:59], a[16:31]
    ds_read2_b32 a[36:37], v14 offset0:88 offset1:89
    ds_read2_b32 a[38:39], v14 offset0:90 offset1:91
    s_waitcnt lgkmcnt(10)
    v_mfma_f32_32x32x16_bf16 a[0:15], a[48:51], a[60:63], a[0:15]
    ds_read_b128 a[80:83], v11 offset:5920
    ds_read_b128 a[84:87], v11 offset:3360
    s_waitcnt lgkmcnt(9)
    v_mfma_f32_32x32x16_bf16 a[16:31], a[52:55], a[64:67], a[16:31]
    ds_read2_b32 a[40:41], v14 offset0:96 offset1:97
    ds_read2_b32 a[42:43], v14 offset0:98 offset1:99
    s_waitcnt lgkmcnt(10)
    v_mfma_f32_32x32x16_bf16 a[0:15], a[52:55], a[68:71], a[0:15]
    ds_read_b128 a[56:59], v11 offset:5872
    ds_read_b128 a[60:63], v11 offset:3312
    s_waitcnt lgkmcnt(9)
    v_mfma_f32_32x32x16_bf16 a[16:31], a[32:35], a[72:75], a[16:31]
    ds_read2_b32 a[44:45], v14 offset0:104 offset1:105
    ds_read2_b32 a[46:47], v14 offset0:106 offset1:107
    s_waitcnt lgkmcnt(10)
    v_mfma_f32_32x32x16_bf16 a[0:15], a[32:35], a[76:79], a[0:15]
    ds_read_b128 a[64:67], v11 offset:5840
    ds_read_b128 a[68:71], v11 offset:3280
    s_waitcnt lgkmcnt(9)
    v_mfma_f32_32x32x16_bf16 a[16:31], a[36:39], a[80:83], a[16:31]
    ds_read2_b32 a[48:49], v14 offset0:112 offset1:113
    ds_read2_b32 a[50:51], v14 offset0:114 offset1:115
    s_waitcnt lgkmcnt(10)
    v_mfma_f32_32x32x16_bf16 a[0:15], a[36:39], a[84:87], a[0:15]
    ds_read_b128 a[72:75], v11 offset:5792
    ds_read_b128 a[76:79], v11 offset:3232
    s_waitcnt lgkmcnt(9)
    v_mfma_f32_32x32x16_bf16 a[16:31], a[40:43], a[56:59], a[16:31]
    ds_read2_b32 a[52:53], v14 offset0:120 offset1:121
    ds_read2_b32 a[54:55], v14 offset0:122 offset1:123
    s_waitcnt lgkmcnt(10)
    v_mfma_f32_32x32x16_bf16 a[0:15], a[40:43], a[60:63], a[0:15]
    ds_read_b128 a[80:83], v11 offset:5760
    ds_read_b128 a[84:87], v11 offset:3200
    s_waitcnt lgkmcnt(9)
    v_mfma_f32_32x32x16_bf16 a[16:31], a[44:47], a[64:67], a[16:31]
    ds_read2_b32 a[32:33], v14 offset0:128 offset1:129
    ds_read2_b32 a[34:35], v14 offset0:130 offset1:131
    s_waitcnt lgkmcnt(10)
    v_mfma_f32_32x32x16_bf16 a[0:15], a[44:47], a[68:71], a[0:15]
    ds_read_b128 a[56:59], v11 offset:5712
    ds_read_b128 a[60:63], v11 offset:3152
    s_waitcnt lgkmcnt(9)
    v_mfma_f32_32x32x16_bf16 a[16:31], a[48:51], a[72:75], a[16:31]
    ds_read2_b32 a[36:37], v14 offset0:136 offset1:137
    ds_read2_b32 a[38:39], v14 offset0:138 offset1:139
    s_waitcnt lgkmcnt(10)
    v_mfma_f32_32x32x16_bf16 a[0:15], a[48:51], a[76:79], a[0:15]
    ds_read_b128 a[64:67], v11 offset:5680
    ds_read_b128 a[68:71], v11 offset:3120
    s_waitcnt lgkmcnt(9)
    v_mfma_f32_32x32x16_bf16 a[16:31], a[52:55], a[80:83], a[16:31]
    ds_read2_b32 a[40:41], v14 offset0:144 offset1:145
    ds_read2_b32 a[42:43], v14 offset0:146 offset1:147
    s_waitcnt lgkmcnt(10)
    v_mfma_f32_32x32x16_bf16 a[0:15], a[52:55], a[84:87], a[0:15]
    ds_read_b128 a[72:75], v11 offset:5632
    ds_read_b128 a[76:79], v11 offset:3072
    s_waitcnt lgkmcnt(9)
    v_mfma_f32_32x32x16_bf16 a[16:31], a[32:35], a[56:59], a[16:31]
    ds_read2_b32 a[44:45], v14 offset0:152 offset1:153
    ds_read2_b32 a[46:47], v14 offset0:154 offset1:155
    s_waitcnt lgkmcnt(10)
    v_mfma_f32_32x32x16_bf16 a[0:15], a[32:35], a[60:63], a[0:15]
    ds_read_b128 a[80:83], v11 offset:5600
    ds_read_b128 a[84:87], v11 offset:3040
    s_waitcnt lgkmcnt(9)
    v_mfma_f32_32x32x16_bf16 a[16:31], a[36:39], a[64:67], a[16:31]
    ds_read2_b32 a[48:49], v14 offset0:160 offset1:161
    ds_read2_b32 a[50:51], v14 offset0:162 offset1:163
    s_waitcnt lgkmcnt(10)
    v_mfma_f32_32x32x16_bf16 a[0:15], a[36:39], a[68:71], a[0:15]
    ds_read_b128 a[56:59], v11 offset:5552
    ds_read_b128 a[60:63], v11 offset:2992
    s_waitcnt lgkmcnt(9)
    v_mfma_f32_32x32x16_bf16 a[16:31], a[40:43], a[72:75], a[16:31]
    ds_read2_b32 a[52:53], v14 offset0:168 offset1:169
    ds_read2_b32 a[54:55], v14 offset0:170 offset1:171
    s_waitcnt lgkmcnt(10)
    v_mfma_f32_32x32x16_bf16 a[0:15], a[40:43], a[76:79], a[0:15]
    ds_read_b128 a[64:67], v11 offset:5520
    ds_read_b128 a[68:71], v11 offset:2960
    s_waitcnt lgkmcnt(9)
    v_mfma_f32_32x32x16_bf16 a[16:31], a[44:47], a[80:83], a[16:31]
    ds_read2_b32 a[32:33], v14 offset0:176 offset1:177
    ds_read2_b32 a[34:35], v14 offset0:178 offset1:179
    s_waitcnt lgkmcnt(10)
    v_mfma_f32_32x32x16_bf16 a[0:15], a[44:47], a[84:87], a[0:15]
    ds_read_b128 a[72:75], v11 offset:5472
    ds_read_b128 a[76:79], v11 offset:2912
    s_waitcnt lgkmcnt(9)
    v_mfma_f32_32x32x16_bf16 a[16:31], a[48:51], a[56:59], a[16:31]
    ds_read2_b32 a[36:37], v14 offset0:184 offset1:185
    ds_read2_b32 a[38:39], v14 offset0:186 offset1:187
    s_waitcnt lgkmcnt(10)
    v_mfma_f32_32x32x16_bf16 a[0:15], a[48:51], a[60:63], a[0:15]
    ds_read_b128 a[80:83], v11 offset:5440
    ds_read_b128 a[84:87], v11 offset:2880
    s_waitcnt lgkmcnt(9)
    v_mfma_f32_32x32x16_bf16 a[16:31], a[52:55], a[64:67], a[16:31]
    ds_read2_b32 a[40:41], v14 offset0:192 offset1:193
    ds_read2_b32 a[42:43], v14 offset0:194 offset1:195
    s_waitcnt lgkmcnt(10)
    v_mfma_f32_32x32x16_bf16 a[0:15], a[52:55], a[68:71], a[0:15]
    ds_read_b128 a[56:59], v11 offset:5392
    ds_read_b128 a[60:63], v11 offset:2832
    s_waitcnt lgkmcnt(9)
    v_mfma_f32_32x32x16_bf16 a[16:31], a[32:35], a[72:75], a[16:31]
    ds_read2_b32 a[44:45], v14 offset0:200 offset1:201
    ds_read2_b32 a[46:47], v14 offset0:202 offset1:203
    s_waitcnt lgkmcnt(10)
    v_mfma_f32_32x32x16_bf16 a[0:15], a[32:35], a[76:79], a[0:15]
    ds_read_b128 a[64:67], v11 offset:5360
    ds_read_b128 a[68:71], v11 offset:2800
    s_waitcnt lgkmcnt(9)
    v_mfma_f32_32x32x16_bf16 a[16:31], a[36:39], a[80:83], a[16:31]
    ds_read2_b32 a[48:49], v14 offset0:208 offset1:209
    ds_read2_b32 a[50:51], v14 offset0:210 offset1:211
    s_waitcnt lgkmcnt(10)
    v_mfma_f32_32x32x16_bf16 a[0:15], a[36:39], a[84:87], a[0:15]
    ds_read_b128 a[72:75], v11 offset:5312
    ds_read_b128 a[76:79], v11 offset:2752
    s_waitcnt lgkmcnt(9)
    v_mfma_f32_32x32x16_bf16 a[16:31], a[40:43], a[56:59], a[16:31]
    ds_read2_b32 a[52:53], v14 offset0:216 offset1:217
    ds_read2_b32 a[54:55], v14 offset0:218 offset1:219
    s_waitcnt lgkmcnt(10)
    v_mfma_f32_32x32x16_bf16 a[0:15], a[40:43], a[60:63], a[0:15]
    ds_read_b128 a[80:83], v11 offset:5280
    ds_read_b128 a[84:87], v11 offset:2720
    s_waitcnt lgkmcnt(9)
    v_mfma_f32_32x32x16_bf16 a[16:31], a[44:47], a[64:67], a[16:31]
    ds_read2_b32 a[32:33], v14 offset0:224 offset1:225
    ds_read2_b32 a[34:35], v14 offset0:226 offset1:227
    s_waitcnt lgkmcnt(10)
    v_mfma_f32_32x32x16_bf16 a[0:15], a[44:47], a[68:71], a[0:15]
    ds_read_b128 a[56:59], v11 offset:5232
    ds_read_b128 a[60:63], v11 offset:2672
    s_waitcnt lgkmcnt(9)
    v_mfma_f32_32x32x16_bf16 a[16:31], a[48:51], a[72:75], a[16:31]
    ds_read2_b32 a[36:37], v14 offset0:232 offset1:233
    ds_read2_b32 a[38:39], v14 offset0:234 offset1:235
    s_waitcnt lgkmcnt(10)
    v_mfma_f32_32x32x16_bf16 a[0:15], a[48:51], a[76:79], a[0:15]
    ds_read_b128 a[64:67], v11 offset:5200
    ds_read_b128 a[68:71], v11 offset:2640
    s_waitcnt lgkmcnt(9)
    v_mfma_f32_32x32x16_bf16 a[16:31], a[52:55], a[80:83], a[16:31]
    ds_read2_b32 a[40:41], v14 offset0:240 offset1:241
    ds_read2_b32 a[42:43], v14 offset0:242 offset1:243
    s_waitcnt lgkmcnt(10)
    v_mfma_f32_32x32x16_bf16 a[0:15], a[52:55], a[84:87], a[0:15]
    ds_read_b128 a[72:75], v11 offset:5152
    ds_read_b128 a[76:79], v11 offset:2592
    s_waitcnt lgkmcnt(9)
    v_mfma_f32_32x32x16_bf16 a[16:31], a[32:35], a[56:59], a[16:31]
    ds_read2_b32 a[44:45], v14 offset0:248 offset1:249
    ds_read2_b32 a[46:47], v14 offset0:250 offset1:251
    v_add_u32 v14, 1024, v14
    s_waitcnt lgkmcnt(10)
    v_mfma_f32_32x32x16_bf16 a[0:15], a[32:35], a[60:63], a[0:15]
    ds_read_b128 a[80:83], v11 offset:5120
    ds_read_b128 a[84:87], v11 offset:2560
    s_waitcnt lgkmcnt(9)
    v_mfma_f32_32x32x16_bf16 a[16:31], a[36:39], a[64:67], a[16:31]
    ds_read2_b32 a[48:49], v14 offset0:0 offset1:1
    ds_read2_b32 a[50:51], v14 offset0:2 offset1:3
    s_waitcnt lgkmcnt(10)
    v_mfma_f32_32x32x16_bf16 a[0:15], a[36:39], a[68:71], a[0:15]
    ds_read_b128 a[56:59], v11 offset:5072
    ds_read2_b32 a[52:53], v14 offset0:8 offset1:9
    ds_read2_b32 a[54:55], v14 offset0:10 offset1:11
    s_waitcnt lgkmcnt(10)
    v_mfma_f32_32x32x16_bf16 a[16:31], a[40:43], a[72:75], a[16:31]
    ds_read_b128 a[60:63], v11 offset:5040
    s_waitcnt lgkmcnt(10)
    v_mfma_f32_32x32x16_bf16 a[0:15], a[40:43], a[76:79], a[0:15]
    ds_read2_b32 a[32:33], v14 offset0:16 offset1:17
    ds_read2_b32 a[34:35], v14 offset0:18 offset1:19
    ds_read_b128 a[64:67], v11 offset:4992
    s_waitcnt lgkmcnt(10)
    v_mfma_f32_32x32x16_bf16 a[16:31], a[44:47], a[80:83], a[16:31]
    ds_read2_b32 a[36:37], v14 offset0:24 offset1:25
    ds_read2_b32 a[38:39], v14 offset0:26 offset1:27
    s_waitcnt lgkmcnt(11)
    v_mfma_f32_32x32x16_bf16 a[0:15], a[44:47], a[84:87], a[0:15]
    ds_read_b128 a[68:71], v11 offset:4960
    ds_read2_b32 a[40:41], v14 offset0:32 offset1:33
    ds_read2_b32 a[42:43], v14 offset0:34 offset1:35
    s_waitcnt lgkmcnt(11)
    v_mfma_f32_32x32x16_bf16 a[16:31], a[48:51], a[56:59], a[16:31]
    ds_read_b128 a[72:75], v11 offset:4912
    ds_read2_b32 a[44:45], v14 offset0:40 offset1:41
    ds_read2_b32 a[46:47], v14 offset0:42 offset1:43
    s_waitcnt lgkmcnt(11)
    v_mfma_f32_32x32x16_bf16 a[16:31], a[52:55], a[60:63], a[16:31]
    ds_read_b128 a[76:79], v11 offset:4880
    ds_read2_b32 a[48:49], v14 offset0:48 offset1:49
    ds_read2_b32 a[50:51], v14 offset0:50 offset1:51
    s_waitcnt lgkmcnt(11)
    v_mfma_f32_32x32x16_bf16 a[16:31], a[32:35], a[64:67], a[16:31]
    ds_read_b128 a[80:83], v11 offset:4832
    ds_read2_b32 a[52:53], v14 offset0:56 offset1:57
    ds_read2_b32 a[54:55], v14 offset0:58 offset1:59
    s_waitcnt lgkmcnt(11)
    v_mfma_f32_32x32x16_bf16 a[16:31], a[36:39], a[68:71], a[16:31]
    ds_read_b128 a[84:87], v11 offset:4800
    ds_read2_b32 a[32:33], v14 offset0:64 offset1:65
    ds_read2_b32 a[34:35], v14 offset0:66 offset1:67
    s_waitcnt lgkmcnt(11)
    v_mfma_f32_32x32x16_bf16 a[16:31], a[40:43], a[72:75], a[16:31]
    ds_read_b128 a[56:59], v11 offset:4752
    ds_read2_b32 a[36:37], v14 offset0:72 offset1:73
    ds_read2_b32 a[38:39], v14 offset0:74 offset1:75
    s_waitcnt lgkmcnt(11)
    v_mfma_f32_32x32x16_bf16 a[16:31], a[44:47], a[76:79], a[16:31]
    ds_read_b128 a[60:63], v11 offset:4720
    ds_read2_b32 a[40:41], v14 offset0:80 offset1:81
    ds_read2_b32 a[42:43], v14 offset0:82 offset1:83
    s_waitcnt lgkmcnt(11)
    v_mfma_f32_32x32x16_bf16 a[16:31], a[48:51], a[80:83], a[16:31]
    ds_read_b128 a[64:67], v11 offset:4672
    ds_read2_b32 a[44:45], v14 offset0:88 offset1:89
    ds_read2_b32 a[46:47], v14 offset0:90 offset1:91
    s_waitcnt lgkmcnt(11)
    v_mfma_f32_32x32x16_bf16 a[16:31], a[52:55], a[84:87], a[16:31]
    ds_read_b128 a[68:71], v11 offset:4640
    ds_read2_b32 a[48:49], v14 offset0:96 offset1:97
    ds_read2_b32 a[50:51], v14 offset0:98 offset1:99
    s_waitcnt lgkmcnt(11)
    v_mfma_f32_32x32x16_bf16 a[16:31], a[32:35], a[56:59], a[16:31]
    ds_read_b128 a[72:75], v11 offset:4592
    ds_read2_b32 a[52:53], v14 offset0:104 offset1:105
    ds_read2_b32 a[54:55], v14 offset0:106 offset1:107
    s_waitcnt lgkmcnt(11)
    v_mfma_f32_32x32x16_bf16 a[16:31], a[36:39], a[60:63], a[16:31]
    ds_read_b128 a[76:79], v11 offset:4560
    ds_read2_b32 a[32:33], v14 offset0:112 offset1:113
    ds_read2_b32 a[34:35], v14 offset0:114 offset1:115
    s_waitcnt lgkmcnt(11)
    v_mfma_f32_32x32x16_bf16 a[16:31], a[40:43], a[64:67], a[16:31]
    ds_read_b128 a[80:83], v11 offset:4512
    ds_read2_b32 a[36:37], v14 offset0:120 offset1:121
    ds_read2_b32 a[38:39], v14 offset0:122 offset1:123
    s_waitcnt lgkmcnt(11)
    v_mfma_f32_32x32x16_bf16 a[16:31], a[44:47], a[68:71], a[16:31]
    ds_read_b128 a[84:87], v11 offset:4480
    ds_read2_b32 a[40:41], v14 offset0:128 offset1:129
    ds_read2_b32 a[42:43], v14 offset0:130 offset1:131
    s_waitcnt lgkmcnt(11)
    v_mfma_f32_32x32x16_bf16 a[16:31], a[48:51], a[72:75], a[16:31]
    ds_read_b128 a[56:59], v11 offset:4432
    ds_read2_b32 a[44:45], v14 offset0:136 offset1:137
    ds_read2_b32 a[46:47], v14 offset0:138 offset1:139
    s_waitcnt lgkmcnt(11)
    v_mfma_f32_32x32x16_bf16 a[16:31], a[52:55], a[76:79], a[16:31]
    ds_read_b128 a[60:63], v11 offset:4400
    ds_read2_b32 a[48:49], v14 offset0:144 offset1:145
    ds_read2_b32 a[50:51], v14 offset0:146 offset1:147
    s_waitcnt lgkmcnt(11)
    v_mfma_f32_32x32x16_bf16 a[16:31], a[32:35], a[80:83], a[16:31]
    ds_read_b128 a[64:67], v11 offset:4352
    ds_read2_b32 a[52:53], v14 offset0:152 offset1:153
    ds_read2_b32 a[54:55], v14 offset0:154 offset1:155
    s_waitcnt lgkmcnt(11)
    v_mfma_f32_32x32x16_bf16 a[16:31], a[36:39], a[84:87], a[16:31]
    ds_read_b128 a[68:71], v11 offset:4320
    ds_read2_b32 a[32:33], v14 offset0:160 offset1:161
    ds_read2_b32 a[34:35], v14 offset0:162 offset1:163
    s_waitcnt lgkmcnt(11)
    v_mfma_f32_32x32x16_bf16 a[16:31], a[40:43], a[56:59], a[16:31]
    ds_read_b128 a[72:75], v11 offset:4272
    ds_read2_b32 a[36:37], v14 offset0:168 offset1:169
    ds_read2_b32 a[38:39], v14 offset0:170 offset1:171
    s_waitcnt lgkmcnt(11)
    v_mfma_f32_32x32x16_bf16 a[16:31], a[44:47], a[60:63], a[16:31]
    ds_read_b128 a[76:79], v11 offset:4240
    ds_read2_b32 a[40:41], v14 offset0:176 offset1:177
    ds_read2_b32 a[42:43], v14 offset0:178 offset1:179
    s_waitcnt lgkmcnt(11)
    v_mfma_f32_32x32x16_bf16 a[16:31], a[48:51], a[64:67], a[16:31]
    ds_read_b128 a[80:83], v11 offset:4192
    ds_read2_b32 a[44:45], v14 offset0:184 offset1:185
    ds_read2_b32 a[46:47], v14 offset0:186 offset1:187
    s_waitcnt lgkmcnt(11)
    v_mfma_f32_32x32x16_bf16 a[16:31], a[52:55], a[68:71], a[16:31]
    ds_read_b128 a[84:87], v11 offset:4160
    ds_read2_b32 a[48:49], v14 offset0:192 offset1:193
    ds_read2_b32 a[50:51], v14 offset0:194 offset1:195
    s_waitcnt lgkmcnt(11)
    v_mfma_f32_32x32x16_bf16 a[16:31], a[32:35], a[72:75], a[16:31]
    ds_read_b128 a[56:59], v11 offset:4112
    ds_read2_b32 a[52:53], v14 offset0:200 offset1:201
    ds_read2_b32 a[54:55], v14 offset0:202 offset1:203
    s_waitcnt lgkmcnt(11)
    v_mfma_f32_32x32x16_bf16 a[16:31], a[36:39], a[76:79], a[16:31]
    ds_read_b128 a[60:63], v11 offset:4080
    ds_read2_b32 a[32:33], v14 offset0:208 offset1:209
    ds_read2_b32 a[34:35], v14 offset0:210 offset1:211
    s_waitcnt lgkmcnt(11)
    v_mfma_f32_32x32x16_bf16 a[16:31], a[40:43], a[80:83], a[16:31]
    ds_read_b128 a[64:67], v11 offset:4032
    ds_read2_b32 a[36:37], v14 offset0:216 offset1:217
    ds_read2_b32 a[38:39], v14 offset0:218 offset1:219
    s_waitcnt lgkmcnt(11)
    v_mfma_f32_32x32x16_bf16 a[16:31], a[44:47], a[84:87], a[16:31]
    ds_read_b128 a[68:71], v11 offset:4000
    ds_read2_b32 a[40:41], v14 offset0:224 offset1:225
    ds_read2_b32 a[42:43], v14 offset0:226 offset1:227
    s_waitcnt lgkmcnt(11)
    v_mfma_f32_32x32x16_bf16 a[16:31], a[48:51], a[56:59], a[16:31]
    ds_read_b128 a[72:75], v11 offset:3952
    ds_read2_b32 a[44:45], v14 offset0:232 offset1:233
    ds_read2_b32 a[46:47], v14 offset0:234 offset1:235
    s_waitcnt lgkmcnt(11)
    v_mfma_f32_32x32x16_bf16 a[16:31], a[52:55], a[60:63], a[16:31]
    ds_read_b128 a[76:79], v11 offset:3920
    ds_read2_b32 a[48:49], v14 offset0:240 offset1:241
    ds_read2_b32 a[50:51], v14 offset0:242 offset1:243
    s_waitcnt lgkmcnt(11)
    v_mfma_f32_32x32x16_bf16 a[16:31], a[32:35], a[64:67], a[16:31]
    ds_read_b128 a[80:83], v11 offset:3872
    ds_read2_b32 a[52:53], v14 offset0:248 offset1:249
    ds_read2_b32 a[54:55], v14 offset0:250 offset1:251
    v_add_u32 v14, 1024, v14
    s_waitcnt lgkmcnt(11)
    v_mfma_f32_32x32x16_bf16 a[16:31], a[36:39], a[68:71], a[16:31]
    ds_read_b128 a[84:87], v11 offset:3840
    ds_read2_b32 a[32:33], v14 offset0:0 offset1:1
    ds_read2_b32 a[34:35], v14 offset0:2 offset1:3
    s_waitcnt lgkmcnt(11)
    v_mfma_f32_32x32x16_bf16 a[16:31], a[40:43], a[72:75], a[16:31]
    ds_read_b128 a[56:59], v11 offset:3792
    ds_read2_b32 a[36:37], v14 offset0:8 offset1:9
    ds_read2_b32 a[38:39], v14 offset0:10 offset1:11
    s_waitcnt lgkmcnt(11)
    v_mfma_f32_32x32x16_bf16 a[16:31], a[44:47], a[76:79], a[16:31]
    ds_read_b128 a[60:63], v11 offset:3760
    ds_read2_b32 a[40:41], v14 offset0:16 offset1:17
    ds_read2_b32 a[42:43], v14 offset0:18 offset1:19
    s_waitcnt lgkmcnt(11)
    v_mfma_f32_32x32x16_bf16 a[16:31], a[48:51], a[80:83], a[16:31]
    ds_read_b128 a[64:67], v11 offset:3712
    ds_read2_b32 a[44:45], v14 offset0:24 offset1:25
    ds_read2_b32 a[46:47], v14 offset0:26 offset1:27
    s_waitcnt lgkmcnt(11)
    v_mfma_f32_32x32x16_bf16 a[16:31], a[52:55], a[84:87], a[16:31]
    ds_read_b128 a[68:71], v11 offset:3680
    ds_read2_b32 a[48:49], v14 offset0:32 offset1:33
    ds_read2_b32 a[50:51], v14 offset0:34 offset1:35
    s_waitcnt lgkmcnt(11)
    v_mfma_f32_32x32x16_bf16 a[16:31], a[32:35], a[56:59], a[16:31]
    ds_read_b128 a[72:75], v11 offset:3632
    ds_read2_b32 a[52:53], v14 offset0:40 offset1:41
    ds_read2_b32 a[54:55], v14 offset0:42 offset1:43
    s_waitcnt lgkmcnt(11)
    v_mfma_f32_32x32x16_bf16 a[16:31], a[36:39], a[60:63], a[16:31]
    ds_read_b128 a[76:79], v11 offset:3600
    ds_read2_b32 a[32:33], v14 offset0:48 offset1:49
    ds_read2_b32 a[34:35], v14 offset0:50 offset1:51
    s_waitcnt lgkmcnt(11)
    v_mfma_f32_32x32x16_bf16 a[16:31], a[40:43], a[64:67], a[16:31]
    ds_read_b128 a[80:83], v11 offset:3552
    ds_read2_b32 a[36:37], v14 offset0:56 offset1:57
    ds_read2_b32 a[38:39], v14 offset0:58 offset1:59
    s_waitcnt lgkmcnt(11)
    v_mfma_f32_32x32x16_bf16 a[16:31], a[44:47], a[68:71], a[16:31]
    ds_read_b128 a[84:87], v11 offset:3520
    ds_read2_b32 a[40:41], v14 offset0:64 offset1:65
    ds_read2_b32 a[42:43], v14 offset0:66 offset1:67
    s_waitcnt lgkmcnt(11)
    v_mfma_f32_32x32x16_bf16 a[16:31], a[48:51], a[72:75], a[16:31]
    ds_read_b128 a[56:59], v11 offset:3472
    ds_read2_b32 a[44:45], v14 offset0:72 offset1:73
    ds_read2_b32 a[46:47], v14 offset0:74 offset1:75
    s_waitcnt lgkmcnt(11)
    v_mfma_f32_32x32x16_bf16 a[16:31], a[52:55], a[76:79], a[16:31]
    ds_read_b128 a[60:63], v11 offset:3440
    ds_read2_b32 a[48:49], v14 offset0:80 offset1:81
    ds_read2_b32 a[50:51], v14 offset0:82 offset1:83
    s_waitcnt lgkmcnt(11)
    v_mfma_f32_32x32x16_bf16 a[16:31], a[32:35], a[80:83], a[16:31]
    ds_read_b128 a[64:67], v11 offset:3392
    ds_read2_b32 a[52:53], v14 offset0:88 offset1:89
    ds_read2_b32 a[54:55], v14 offset0:90 offset1:91
    s_waitcnt lgkmcnt(11)
    v_mfma_f32_32x32x16_bf16 a[16:31], a[36:39], a[84:87], a[16:31]
    ds_read_b128 a[68:71], v11 offset:3360
    ds_read2_b32 a[32:33], v14 offset0:96 offset1:97
    ds_read2_b32 a[34:35], v14 offset0:98 offset1:99
    s_waitcnt lgkmcnt(11)
    v_mfma_f32_32x32x16_bf16 a[16:31], a[40:43], a[56:59], a[16:31]
    ds_read_b128 a[72:75], v11 offset:3312
    ds_read2_b32 a[36:37], v14 offset0:104 offset1:105
    ds_read2_b32 a[38:39], v14 offset0:106 offset1:107
    s_waitcnt lgkmcnt(11)
    v_mfma_f32_32x32x16_bf16 a[16:31], a[44:47], a[60:63], a[16:31]
    ds_read_b128 a[76:79], v11 offset:3280
    ds_read2_b32 a[40:41], v14 offset0:112 offset1:113
    ds_read2_b32 a[42:43], v14 offset0:114 offset1:115
    s_waitcnt lgkmcnt(11)
    v_mfma_f32_32x32x16_bf16 a[16:31], a[48:51], a[64:67], a[16:31]
    ds_read_b128 a[80:83], v11 offset:3232
    ds_read2_b32 a[44:45], v14 offset0:120 offset1:121
    ds_read2_b32 a[46:47], v14 offset0:122 offset1:123
    s_waitcnt lgkmcnt(11)
    v_mfma_f32_32x32x16_bf16 a[16:31], a[52:55], a[68:71], a[16:31]
    ds_read_b128 a[84:87], v11 offset:3200
    ds_read2_b32 a[48:49], v14 offset0:128 offset1:129
    ds_read2_b32 a[50:51], v14 offset0:130 offset1:131
    s_waitcnt lgkmcnt(11)
    v_mfma_f32_32x32x16_bf16 a[16:31], a[32:35], a[72:75], a[16:31]
    ds_read_b128 a[56:59], v11 offset:3152
    ds_read2_b32 a[52:53], v14 offset0:136 offset1:137
    ds_read2_b32 a[54:55], v14 offset0:138 offset1:139
    s_waitcnt lgkmcnt(11)
    v_mfma_f32_32x32x16_bf16 a[16:31], a[36:39], a[76:79], a[16:31]
    ds_read_b128 a[60:63], v11 offset:3120
    ds_read2_b32 a[32:33], v14 offset0:144 offset1:145
    ds_read2_b32 a[34:35], v14 offset0:146 offset1:147
    s_waitcnt lgkmcnt(11)
    v_mfma_f32_32x32x16_bf16 a[16:31], a[40:43], a[80:83], a[16:31]
    ds_read_b128 a[64:67], v11 offset:3072
    ds_read2_b32 a[36:37], v14 offset0:152 offset1:153
    ds_read2_b32 a[38:39], v14 offset0:154 offset1:155
    s_waitcnt lgkmcnt(11)
    v_mfma_f32_32x32x16_bf16 a[16:31], a[44:47], a[84:87], a[16:31]
    ds_read_b128 a[68:71], v11 offset:3040
    ds_read2_b32 a[40:41], v14 offset0:160 offset1:161
    ds_read2_b32 a[42:43], v14 offset0:162 offset1:163
    s_waitcnt lgkmcnt(11)
    v_mfma_f32_32x32x16_bf16 a[16:31], a[48:51], a[56:59], a[16:31]
    ds_read_b128 a[72:75], v11 offset:2992
    ds_read2_b32 a[44:45], v14 offset0:168 offset1:169
    ds_read2_b32 a[46:47], v14 offset0:170 offset1:171
    s_waitcnt lgkmcnt(11)
    v_mfma_f32_32x32x16_bf16 a[16:31], a[52:55], a[60:63], a[16:31]
    ds_read_b128 a[76:79], v11 offset:2960
    ds_read2_b32 a[48:49], v14 offset0:176 offset1:177
    ds_read2_b32 a[50:51], v14 offset0:178 offset1:179
    s_waitcnt lgkmcnt(11)
    v_mfma_f32_32x32x16_bf16 a[16:31], a[32:35], a[64:67], a[16:31]
    ds_read_b128 a[80:83], v11 offset:2912
    ds_read2_b32 a[52:53], v14 offset0:184 offset1:185
    ds_read2_b32 a[54:55], v14 offset0:186 offset1:187
    s_waitcnt lgkmcnt(11)
    v_mfma_f32_32x32x16_bf16 a[16:31], a[36:39], a[68:71], a[16:31]
    ds_read_b128 a[84:87], v11 offset:2880
    ds_read2_b32 a[32:33], v14 offset0:192 offset1:193
    ds_read2_b32 a[34:35], v14 offset0:194 offset1:195
    s_waitcnt lgkmcnt(11)
    v_mfma_f32_32x32x16_bf16 a[16:31], a[40:43], a[72:75], a[16:31]
    ds_read_b128 a[56:59], v11 offset:2832
    ds_read2_b32 a[36:37], v14 offset0:200 offset1:201
    ds_read2_b32 a[38:39], v14 offset0:202 offset1:203
    s_waitcnt lgkmcnt(11)
    v_mfma_f32_32x32x16_bf16 a[16:31], a[44:47], a[76:79], a[16:31]
    ds_read_b128 a[60:63], v11 offset:2800
    ds_read2_b32 a[40:41], v14 offset0:208 offset1:209
    ds_read2_b32 a[42:43], v14 offset0:210 offset1:211
    s_waitcnt lgkmcnt(11)
    v_mfma_f32_32x32x16_bf16 a[16:31], a[48:51], a[80:83], a[16:31]
    ds_read_b128 a[64:67], v11 offset:2752
    ds_read2_b32 a[44:45], v14 offset0:216 offset1:217
    ds_read2_b32 a[46:47], v14 offset0:218 offset1:219
    s_waitcnt lgkmcnt(11)
    v_mfma_f32_32x32x16_bf16 a[16:31], a[52:55], a[84:87], a[16:31]
    ds_read_b128 a[68:71], v11 offset:2720
    ds_read2_b32 a[48:49], v14 offset0:224 offset1:225
    ds_read2_b32 a[50:51], v14 offset0:226 offset1:227
    s_waitcnt lgkmcnt(11)
    v_mfma_f32_32x32x16_bf16 a[16:31], a[32:35], a[56:59], a[16:31]
    ds_read_b128 a[72:75], v11 offset:2672
    ds_read2_b32 a[52:53], v14 offset0:232 offset1:233
    ds_read2_b32 a[54:55], v14 offset0:234 offset1:235
    s_waitcnt lgkmcnt(11)
    v_mfma_f32_32x32x16_bf16 a[16:31], a[36:39], a[60:63], a[16:31]
    ds_read_b128 a[76:79], v11 offset:2640
    ds_read2_b32 a[32:33], v14 offset0:240 offset1:241
    ds_read2_b32 a[34:35], v14 offset0:242 offset1:243
    s_waitcnt lgkmcnt(11)
    v_mfma_f32_32x32x16_bf16 a[16:31], a[40:43], a[64:67], a[16:31]
    ds_read_b128 a[80:83], v11 offset:2592
    ds_read2_b32 a[36:37], v14 offset0:248 offset1:249
    ds_read2_b32 a[38:39], v14 offset0:250 offset1:251
    v_add_u32 v14, 1024, v14
    s_waitcnt lgkmcnt(11)
    v_mfma_f32_32x32x16_bf16 a[16:31], a[44:47], a[68:71], a[16:31]
    ds_read_b128 a[84:87], v11 offset:2560
    s_waitcnt lgkmcnt(9)
    v_mfma_f32_32x32x16_bf16 a[16:31], a[48:51], a[72:75], a[16:31]
    s_waitcnt lgkmcnt(6)
    v_mfma_f32_32x32x16_bf16 a[16:31], a[52:55], a[76:79], a[16:31]
    s_waitcnt lgkmcnt(3)
    v_mfma_f32_32x32x16_bf16 a[16:31], a[32:35], a[80:83], a[16:31]
    s_waitcnt lgkmcnt(0)
    v_mfma_f32_32x32x16_bf16 a[16:31], a[36:39], a[84:87], a[16:31]
    v_accvgpr_read_b32 v220, a0
    v_accvgpr_read_b32 v221, a1
    v_accvgpr_read_b32 v222, a2
    v_accvgpr_read_b32 v223, a3
    v_accvgpr_read_b32 v224, a4
    v_accvgpr_read_b32 v225, a5
    v_accvgpr_read_b32 v226, a6
    v_accvgpr_read_b32 v227, a7
    v_accvgpr_read_b32 v228, a8
    v_accvgpr_read_b32 v229, a9
    v_accvgpr_read_b32 v230, a10
    v_accvgpr_read_b32 v231, a11
    v_accvgpr_read_b32 v232, a12
    v_accvgpr_read_b32 v233, a13
    v_accvgpr_read_b32 v234, a14
    v_accvgpr_read_b32 v235, a15
    v_cvt_pk_bf16_f32 v236, v220, v221
    v_cvt_pk_bf16_f32 v237, v222, v223
    v_cvt_pk_bf16_f32 v238, v224, v225
    v_cvt_pk_bf16_f32 v239, v226, v227
    v_cvt_pk_bf16_f32 v240, v228, v229
    v_cvt_pk_bf16_f32 v241, v230, v231
    v_cvt_pk_bf16_f32 v242, v232, v233
    v_cvt_pk_bf16_f32 v243, v234, v235
    s_nop 0
    v_permlane32_swap_b32 v236, v238
    v_permlane32_swap_b32 v237, v239
    v_permlane32_swap_b32 v240, v242
    v_permlane32_swap_b32 v241, v243
    buffer_store_dwordx4 v[236:239], v2, s[8:11], s7 offen offset:0 sc1
    buffer_store_dwordx4 v[240:243], v2, s[8:11], s7 offen offset:1024 sc1
    v_accvgpr_read_b32 v220, a16
    v_accvgpr_read_b32 v221, a17
    v_accvgpr_read_b32 v222, a18
    v_accvgpr_read_b32 v223, a19
    v_accvgpr_read_b32 v224, a20
    v_accvgpr_read_b32 v225, a21
    v_accvgpr_read_b32 v226, a22
    v_accvgpr_read_b32 v227, a23
    v_accvgpr_read_b32 v228, a24
    v_accvgpr_read_b32 v229, a25
    v_accvgpr_read_b32 v230, a26
    v_accvgpr_read_b32 v231, a27
    v_accvgpr_read_b32 v232, a28
    v_accvgpr_read_b32 v233, a29
    v_accvgpr_read_b32 v234, a30
    v_accvgpr_read_b32 v235, a31
    v_cvt_pk_bf16_f32 v236, v220, v221
    v_cvt_pk_bf16_f32 v237, v222, v223
    v_cvt_pk_bf16_f32 v238, v224, v225
    v_cvt_pk_bf16_f32 v239, v226, v227
    v_cvt_pk_bf16_f32 v240, v228, v229
    v_cvt_pk_bf16_f32 v241, v230, v231
    v_cvt_pk_bf16_f32 v242, v232, v233
    v_cvt_pk_bf16_f32 v243, v234, v235
    s_nop 0
    v_permlane32_swap_b32 v236, v238
    v_permlane32_swap_b32 v237, v239
    v_permlane32_swap_b32 v240, v242
    v_permlane32_swap_b32 v241, v243
    buffer_store_dwordx4 v[236:239], v2, s[8:11], s7 offen offset:2048 sc1
    buffer_store_dwordx4 v[240:243], v2, s[8:11], s7 offen offset:3072 sc1
    v_add_u32 v11, 30720, v11
    s_add_u32 s64, s64, 1
    s_cmp_lt_u32 s64, 4
    s_waitcnt vmcnt(4)
    s_cbranch_scc1 .chan_347
    s_waitcnt vmcnt(0)
    s_barrier
    s_cmp_lg_u32 s24, 0
    s_cbranch_scc1 .sg_349
    s_mov_b64 exec, 1
    v_mov_b32 v4, 1
    v_mov_b32 v3, 0
    buffer_atomic_add v4, v3, s[20:23], 0 offen offset:192 sc1
    s_mov_b64 exec, -1
.sg_349:
    s_branch .fin_350
.qa_341:
    s_and_b32 s34, s24, 1
    s_lshr_b32 s35, s24, 1
    s_lshl_b32 s4, s35, 10
    s_add_u32 s4, s4, 2048
    v_lshlrev_b32 v2, 4, v1
    s_lshl_b32 s5, s24, 10
    s_add_u32 s5, s5, 131072
    v_add_u32 v24, s5, v2
    s_lshl_b32 s5, s34, 12
    s_add_u32 s5, s5, 131072
    v_add_u32 v25, s5, v2
    v_add_u32 v31, 139264, v2
    s_lshl_b32 s5, s35, 12
    v_add_u32 v5, s5, v31
    s_lshl_b32 s43, s24, 11
    v_bfe_u32 v254, v1, 4, 2
    v_mul_u32_u24 v3, 128, v254
    v_bfe_u32 v254, v1, 2, 2
    v_mul_u32_u24 v254, 32, v254
    v_add_u32 v3, v3, v254
    v_bfe_u32 v254, v1, 0, 1
    v_mul_u32_u24 v254, 16, v254
    v_add_u32 v3, v3, v254
    v_add_u32 v3, 155648, v3
    v_bfe_u32 v254, v1, 2, 2
    v_mul_u32_u24 v6, 128, v254
    v_bfe_u32 v254, v1, 0, 2
    v_mul_u32_u24 v254, 16, v254
    v_add_u32 v6, v6, v254
    v_bfe_u32 v254, v1, 4, 2
    v_mul_u32_u24 v254, 4, v254
    v_add_u32 v6, v6, v254
    v_add_u32 v6, 155648, v6
    v_add_u32 v6, s4, v6
    s_lshl_b32 s4, s99, 9
    s_add_u32 s4, s4, 92274688
    v_bfe_u32 v254, v1, 0, 2
    v_mul_u32_u24 v7, 128, v254
    v_add_u32 v7, s4, v7
    v_mov_b32 v232, 0
    v_mov_b32 v233, 0
    v_mov_b32 v234, 0
    v_mov_b32 v235, 0
    v_mov_b32 v236, 0
    v_mov_b32 v237, 0
    v_mov_b32 v238, 0
    v_mov_b32 v239, 0
    v_mov_b32 v240, 0
    v_mov_b32 v241, 0
    v_mov_b32 v40, 0
    v_mov_b32 v44, 0x3f803f80
    v_mov_b32 v41, 0
    v_mov_b32 v45, 0x3f803f80
    v_mov_b32 v42, 0
    v_mov_b32 v46, 0x3f803f80
    v_mov_b32 v43, 0
    v_mov_b32 v47, 0x3f803f80
    s_lshl_b32 s4, s34, 4
    v_and_b32 v48, 15, v1
    v_add_u32 v48, s4, v48
    v_lshrrev_b32 v49, 4, v1
    v_lshlrev_b32 v49, 2, v49
    v_mov_b32 v51, 0xff800000
    v_add_u32 v50, 0, v49
    v_cmp_le_u32 vcc, v50, v48
    s_nop 1
    v_cndmask_b32 v32, v51, v40, vcc
    v_add_u32 v50, 1, v49
    v_cmp_le_u32 vcc, v50, v48
    s_nop 1
    v_cndmask_b32 v33, v51, v40, vcc
    v_add_u32 v50, 2, v49
    v_cmp_le_u32 vcc, v50, v48
    s_nop 1
    v_cndmask_b32 v34, v51, v40, vcc
    v_add_u32 v50, 3, v49
    v_cmp_le_u32 vcc, v50, v48
    s_nop 1
    v_cndmask_b32 v35, v51, v40, vcc
    v_add_u32 v50, 16, v49
    v_cmp_le_u32 vcc, v50, v48
    s_nop 1
    v_cndmask_b32 v36, v51, v40, vcc
    v_add_u32 v50, 17, v49
    v_cmp_le_u32 vcc, v50, v48
    s_nop 1
    v_cndmask_b32 v37, v51, v40, vcc
    v_add_u32 v50, 18, v49
    v_cmp_le_u32 vcc, v50, v48
    s_nop 1
    v_cndmask_b32 v38, v51, v40, vcc
    v_add_u32 v50, 19, v49
    v_cmp_le_u32 vcc, v50, v48
    s_nop 1
    v_cndmask_b32 v39, v51, v40, vcc
    s_lshl_b32 s4, s99, 7
    s_lshl_b32 s5, s24, 2
    s_add_u32 s4, s4, s5
    s_add_u32 s94, s4, 92340224
    s_mov_b32 s46, 16384
    s_mov_b32 s47, 32768
    s_mov_b32 s30, -1
    s_mov_b32 s32, 0
    s_mov_b32 s33, 0
    s_mov_b32 s42, 0
    s_mov_b32 s53, 75497472
    s_mov_b32 s45, 0x3e0293ee
    s_lshl_b32 s36, s99, 13
    s_add_u32 s36, s36, s43
    s_add_u32 s36, s36, 16777216
    s_add_u32 s43, s43, 139264
    s_sub_u32 s37, s36, 0x40000
    v_and_b32 v255, 15, v1
    v_bfe_u32 v254, v1, 4, 1
    v_lshlrev_b32 v255, 7, v255
    v_lshl_add_u32 v255, v254, 24, v255
    s_lshl_b32 s39, s99, 12
    s_lshl_b32 s4, s34, 12
    s_lshl_b32 s40, s99, 13
    s_add_u32 s40, s40, s4
    s_lshl_b32 s4, s35, 11
    s_add_u32 s40, s40, s4
    s_add_u32 s40, s40, 16777216
    s_add_u32 s39, s39, 67108864
    s_lshl_b32 s52, s24, 10
    s_add_u32 s39, s39, s52
    s_add_u32 s52, s52, 155648
    s_mov_b32 s31, 1
    s_sub_u32 s48, s39, 0x20000
    s_mov_b32 s49, s37
    s_mov_b32 vcc_lo, s27
    s_mov_b32 vcc_hi, 0
    s_cmp_gt_u32 s32, 0
    s_cbranch_scc1 .ndd_366
    s_mov_b32 s62, 0
.nd_365:
    buffer_load_dword v29, v7, s[8:11], s46 offen sc1
    buffer_load_dword v30, v7, s[8:11], s47 offen sc1
    s_add_u32 s62, s62, 1
    s_cmp_gt_u32 s62, 0x200000
    s_cbranch_scc1 .mg_end_1
    s_waitcnt vmcnt(0)
    v_min_u32 v29, v29, v30
    s_nop 1
    v_min_u32_dpp v29, v29, v29 quad_perm:[1,0,3,2] row_mask:0xf bank_mask:0xf
    s_nop 1
    v_min_u32_dpp v29, v29, v29 quad_perm:[2,3,0,1] row_mask:0xf bank_mask:0xf
    s_nop 1
    v_readfirstlane_b32 s32, v29
    s_lshl_b32 s55, s32, 18
    s_add_u32 s55, s55, s37
    s_cmp_gt_u32 s32, 0
    s_cbranch_scc1 .ndd_366
    s_sleep 2
    s_branch .nd_365
.ndd_366:
    s_waitcnt lgkmcnt(0)
    s_mov_b32 s14, 3932160
.p2align 6
.ql_367:
    s_waitcnt lgkmcnt(8)
    v_mfma_f32_16x16x32_bf16 v[192:195], a[0:3], v[64:67], 0
    buffer_load_dwordx4 v19, s[12:15], s29 offen offset:2048 lds
    v_mfma_f32_16x16x32_bf16 v[196:199], a[4:7], v[64:67], 0
    ds_read_b128 v[112:115], v10 offset:256
    ds_read_b128 v[116:119], v10 offset:33024
    v_mfma_f32_16x16x32_bf16 v[200:203], a[0:3], v[68:71], 0
    ds_read_b128 v[120:123], v11 offset:256
    ds_read_b128 v[124:127], v11 offset:33024
    v_mfma_f32_16x16x32_bf16 v[204:207], a[4:7], v[68:71], 0
    ds_read_b128 v[64:67], v8 offset:512
    ds_read_b128 v[68:71], v8 offset:33280
    v_mfma_f32_16x16x32_bf16 v[192:195], a[8:11], v[72:75], v[192:195]
    buffer_load_dwordx4 v19, s[12:15], s29 offen offset:3072 lds
    v_mfma_f32_16x16x32_bf16 v[196:199], a[12:15], v[72:75], v[196:199]
    v_cvt_pk_bf16_f32 v224, v208, v209
    v_cvt_pk_bf16_f32 v225, v210, v211
    v_mfma_f32_16x16x32_bf16 v[200:203], a[8:11], v[76:79], v[200:203]
    v_cvt_pk_bf16_f32 v226, v212, v213
    v_cvt_pk_bf16_f32 v227, v214, v215
    v_mfma_f32_16x16x32_bf16 v[204:207], a[12:15], v[76:79], v[204:207]
    ds_write_b128 v24, v[224:227] offset:0
    s_waitcnt lgkmcnt(11)
    v_mfma_f32_16x16x32_bf16 v[192:195], a[16:19], v[80:83], v[192:195]
    s_add_u32 m0, s6, 73728
    v_cvt_pk_bf16_f32 v228, v216, v217
    v_mfma_f32_16x16x32_bf16 v[196:199], a[20:23], v[80:83], v[196:199]
    buffer_load_dwordx4 v20, s[12:15], s29 offen offset:0 lds
    v_mfma_f32_16x16x32_bf16 v[200:203], a[16:19], v[84:87], v[200:203]
    v_cvt_pk_bf16_f32 v229, v218, v219
    v_cvt_pk_bf16_f32 v230, v220, v221
    v_mfma_f32_16x16x32_bf16 v[204:207], a[20:23], v[84:87], v[204:207]
    v_cvt_pk_bf16_f32 v231, v222, v223
    ds_write_b128 v24, v[228:231] offset:4096
    v_mfma_f32_16x16x32_bf16 v[192:195], a[24:27], v[88:91], v[192:195]
    ds_read_b128 v[72:75], v9 offset:512
    ds_read_b128 v[76:79], v9 offset:33280
    v_mfma_f32_16x16x32_bf16 v[196:199], a[28:31], v[88:91], v[196:199]
    buffer_load_dwordx4 v20, s[12:15], s29 offen offset:1024 lds
    v_mfma_f32_16x16x32_bf16 v[200:203], a[24:27], v[92:95], v[200:203]
    ds_read_b128 v[80:83], v10 offset:512
    ds_read_b128 v[84:87], v10 offset:33280
    v_mfma_f32_16x16x32_bf16 v[204:207], a[28:31], v[92:95], v[204:207]
    ds_read_b128 v[88:91], v11 offset:512
    s_waitcnt lgkmcnt(13)
    v_mfma_f32_16x16x32_bf16 v[192:195], a[32:35], v[96:99], v[192:195]
    s_waitcnt vmcnt(13) lgkmcnt(5)
    s_barrier
    v_mfma_f32_16x16x32_bf16 v[196:199], a[36:39], v[96:99], v[196:199]
    buffer_load_dwordx4 v21, s[12:15], s29 offen offset:2048 lds
    v_mfma_f32_16x16x32_bf16 v[200:203], a[32:35], v[100:103], v[200:203]
    ds_read_b128 v[208:211], v25 offset:0
    ds_read_b128 v[128:131], v31 offset:0
    v_mfma_f32_16x16x32_bf16 v[204:207], a[36:39], v[100:103], v[204:207]
    ds_read_b128 v[144:147], v31 offset:4096
    ds_read_b128 v[212:215], v25 offset:1024
    v_mfma_f32_16x16x32_bf16 v[192:195], a[40:43], v[104:107], v[192:195]
    ds_read_b128 v[132:135], v31 offset:1024
    ds_read_b128 v[148:151], v31 offset:5120
    v_mfma_f32_16x16x32_bf16 v[196:199], a[44:47], v[104:107], v[196:199]
    buffer_load_dwordx4 v21, s[12:15], s29 offen offset:3072 lds
    v_mfma_f32_16x16x32_bf16 v[200:203], a[40:43], v[108:111], v[200:203]
    ds_read_b128 v[92:95], v11 offset:33280
    ds_read_b128 v[216:219], v25 offset:2048
    v_mfma_f32_16x16x32_bf16 v[204:207], a[44:47], v[108:111], v[204:207]
    ds_read_b128 v[136:139], v31 offset:2048
    ds_read_b128 v[152:155], v31 offset:6144
    v_mfma_f32_16x16x32_bf16 v[192:195], a[48:51], v[112:115], v[192:195]
    ds_read_b128 v[220:223], v25 offset:3072
    ds_read_b128 v[140:143], v31 offset:3072
    v_mfma_f32_16x16x32_bf16 v[196:199], a[52:55], v[112:115], v[196:199]
    s_add_u32 m0, s6, 77824
    s_waitcnt lgkmcnt(9)
    v_mfma_f32_16x16x32_bf16 v[48:51], v[128:131], v[208:211], v[32:35]
    buffer_load_dwordx4 v22, s[12:15], s29 offen offset:0 lds
    v_mfma_f32_16x16x32_bf16 v[52:55], v[144:147], v[208:211], v[36:39]
    ds_read_b128 v[156:159], v31 offset:7168
    s_waitcnt lgkmcnt(7)
    v_mfma_f32_16x16x32_bf16 v[48:51], v[132:135], v[212:215], v[48:51]
    ds_read_b128 v[160:163], v5 offset:8192
    ds_read_b128 v[164:167], v5 offset:9216
    v_mfma_f32_16x16x32_bf16 v[52:55], v[148:151], v[212:215], v[52:55]
    ds_read_b128 v[96:99], v8 offset:768
    s_waitcnt lgkmcnt(6)
    v_mfma_f32_16x16x32_bf16 v[48:51], v[136:139], v[216:219], v[48:51]
    buffer_load_dwordx4 v22, s[12:15], s29 offen offset:1024 lds
    v_mfma_f32_16x16x32_bf16 v[52:55], v[152:155], v[216:219], v[52:55]
    ds_read_b128 v[100:103], v8 offset:33536
    ds_read_b128 v[104:107], v9 offset:768
    v_mfma_f32_16x16x32_bf16 v[200:203], a[48:51], v[116:119], v[200:203]
    ds_read_b128 v[108:111], v9 offset:33536
    ds_read_b128 v[168:171], v5 offset:10240
    v_mfma_f32_16x16x32_bf16 v[204:207], a[52:55], v[116:119], v[204:207]
    ds_read_b128 v[172:175], v5 offset:11264
    s_waitcnt lgkmcnt(8)
    v_mfma_f32_16x16x32_bf16 v[48:51], v[140:143], v[220:223], v[48:51]
    buffer_load_dwordx4 v23, s[12:15], s29 offen offset:2048 lds
    v_mfma_f32_16x16x32_bf16 v[52:55], v[156:159], v[220:223], v[52:55]
    v_max_i32 v27, s30, v26
    ds_read_b128 v[112:115], v10 offset:768
    v_mfma_f32_16x16x32_bf16 v[192:195], a[56:59], v[120:123], v[192:195]
    s_waitcnt vmcnt(12)
    s_cbranch_vccnz .cp_373
    buffer_store_dword v27, v26, s[8:11], s94 offen
.cb_374:
    v_mfma_f32_16x16x32_bf16 v[196:199], a[60:63], v[120:123], v[196:199]
    ds_read_b128 v[116:119], v10 offset:33536
    ds_read_b128 v[120:123], v11 offset:768
    v_mfma_f32_16x16x32_bf16 v[200:203], a[56:59], v[124:127], v[200:203]
    buffer_load_dwordx4 v23, s[12:15], s29 offen offset:3072 lds
    v_mfma_f32_16x16x32_bf16 v[204:207], a[60:63], v[124:127], v[204:207]
    s_cmp_eq_u32 s31, 0
    s_cbranch_scc1 .cp_377
.cb_378:
    v_mfma_f32_16x16x32_bf16 v[192:195], a[64:67], v[64:67], v[192:195]
    s_waitcnt lgkmcnt(3)
    s_barrier
    v_mfma_f32_16x16x32_bf16 v[196:199], a[68:71], v[64:67], v[196:199]
    ds_read_b128 v[124:127], v11 offset:33536
    ds_read_b128 v[176:179], v3 offset:0
    v_mfma_f32_16x16x32_bf16 v[200:203], a[64:67], v[68:71], v[200:203]
    ds_read_b128 v[180:183], v3 offset:512
    ds_read_b128 v[184:187], v3 offset:1024
    v_mfma_f32_16x16x32_bf16 v[204:207], a[68:71], v[68:71], v[204:207]
    ds_read_b128 v[188:191], v3 offset:1536
    ds_read_b128 v[64:67], v8 offset:1024
    v_mfma_f32_16x16x32_bf16 v[192:195], a[72:75], v[72:75], v[192:195]
    ds_read_b128 v[68:71], v8 offset:33792
    v_max3_f32 v248, v48, v49, v50
    v_mfma_f32_16x16x32_bf16 v[196:199], a[76:79], v[72:75], v[196:199]
    ds_read_b128 v[72:75], v9 offset:1024
    v_max3_f32 v248, v248, v51, v52
    v_mfma_f32_16x16x32_bf16 v[200:203], a[72:75], v[76:79], v[200:203]
    v_max3_f32 v249, v53, v54, v55
    s_add_u32 m0, s52, 4096
    v_mfma_f32_16x16x32_bf16 v[204:207], a[76:79], v[76:79], v[204:207]
    ds_read_b128 v[76:79], v9 offset:33792
    s_add_u32 s48, s48, 0x20000
    v_mfma_f32_16x16x32_bf16 v[192:195], a[80:83], v[80:83], v[192:195]
    s_mov_b32 s31, 1
    buffer_load_dword v29, v28, s[12:15], s29 offen
    v_mfma_f32_16x16x32_bf16 v[196:199], a[84:87], v[80:83], v[196:199]
    s_cmp_gt_u32 s33, s42
    s_cbranch_scc0 .pp_379
    buffer_load_dwordx4 v2, s[8:11], s48 offen lds
.pb_380:
    s_waitcnt lgkmcnt(4)
    v_mfma_f32_16x16x32_bf16 v[56:59], v[176:179], v[208:211], 0
    ds_read_b128 v[80:83], v10 offset:1024
    s_add_u32 s29, s29, 0x10000
    v_mfma_f32_16x16x32_bf16 v[56:59], v[180:183], v[212:215], v[56:59]
    s_cmp_gt_u32 s32, s42
    s_cbranch_scc0 .cp_375
.cb_376:
    v_mfma_f32_16x16x32_bf16 v[56:59], v[184:187], v[216:219], v[56:59]
    ds_read_b32 v232, v6 offset:0
    ds_read_b32 v234, v6 offset:64
    v_mfma_f32_16x16x32_bf16 v[56:59], v[188:191], v[220:223], v[56:59]
    ds_read_b32 v236, v6 offset:512
    ds_read_b32 v238, v6 offset:576
    v_mfma_f32_16x16x32_bf16 v[200:203], a[80:83], v[84:87], v[200:203]
    s_mov_b32 m0, s43
    s_add_u32 s49, s49, 0x40000
    v_mfma_f32_16x16x32_bf16 v[204:207], a[84:87], v[84:87], v[204:207]
    ds_read_b128 v[84:87], v10 offset:33792
    v_mfma_f32_16x16x32_bf16 v[192:195], a[88:91], v[88:91], v[192:195]
    buffer_load_dwordx4 v2, s[8:11], s49 offen lds
    v_mfma_f32_16x16x32_bf16 v[196:199], a[92:95], v[88:91], v[196:199]
    ds_read_b128 v[88:91], v11 offset:1024
    v_max3_f32 v248, v248, v56, v57
    v_mfma_f32_16x16x32_bf16 v[200:203], a[88:91], v[92:95], v[200:203]
    v_max_f32 v30, v248, v249
    v_max_f32 v249, v248, v249
    v_mfma_f32_16x16x32_bf16 v[204:207], a[92:95], v[92:95], v[204:207]
    ds_read_b128 v[92:95], v11 offset:33792
    s_add_u32 s50, s49, 16777216
    v_mfma_f32_16x16x32_bf16 v[192:195], a[96:99], v[96:99], v[192:195]
    v_permlane16_swap_b32 v249, v30
    v_max_f32 v248, v249, v30
    v_mfma_f32_16x16x32_bf16 v[196:199], a[100:103], v[96:99], v[196:199]
    v_max_f32 v249, v249, v30
    ds_read_b128 v[96:99], v8 offset:1280
    v_mfma_f32_16x16x32_bf16 v[200:203], a[96:99], v[100:103], v[200:203]
    buffer_load_dwordx4 v2, s[8:11], s49 offen offset:1024 lds
    v_mfma_f32_16x16x32_bf16 v[204:207], a[100:103], v[100:103], v[204:207]
    v_permlane32_swap_b32 v248, v249
    v_max_f32 v248, v248, v249
    v_mfma_f32_16x16x32_bf16 v[192:195], a[104:107], v[104:107], v[192:195]
    v_mul_f32 v248, s45, v248
    ds_read_b128 v[100:103], v8 offset:34048
    v_mfma_f32_16x16x32_bf16 v[196:199], a[108:111], v[104:107], v[196:199]
    ds_read_b128 v[104:107], v9 offset:1280
    v_fma_f32 v60, v48, s45, -v248
    v_mfma_f32_16x16x32_bf16 v[200:203], a[104:107], v[108:111], v[200:203]
    v_fma_f32 v61, v49, s45, -v248
    v_fma_f32 v62, v50, s45, -v248
    v_mfma_f32_16x16x32_bf16 v[204:207], a[108:111], v[108:111], v[204:207]
    ds_read_b128 v[108:111], v9 offset:34048
    v_fma_f32 v63, v51, s45, -v248
    v_mfma_f32_16x16x32_bf16 v[192:195], a[112:115], v[112:115], v[192:195]
    v_fma_f32 v242, v52, s45, -v248
    v_fma_f32 v243, v53, s45, -v248
    v_mfma_f32_16x16x32_bf16 v[196:199], a[116:119], v[112:115], v[196:199]
    v_fma_f32 v244, v54, s45, -v248
    v_fma_f32 v245, v55, s45, -v248
    v_mfma_f32_16x16x32_bf16 v[200:203], a[112:115], v[116:119], v[200:203]
    v_fma_f32 v246, v56, s45, -v248
    v_fma_f32 v247, v57, s45, -v248
    v_mfma_f32_16x16x32_bf16 v[204:207], a[116:119], v[116:119], v[204:207]
    ds_read_b128 v[112:115], v10 offset:1280
    ds_read_b128 v[116:119], v10 offset:34048
    v_mfma_f32_16x16x32_bf16 v[192:195], a[120:123], v[120:123], v[192:195]
    s_add_u32 m0, s43, 8192
    s_add_u32 s5, s49, 0x40000
    v_mfma_f32_16x16x32_bf16 v[196:199], a[124:127], v[120:123], v[196:199]
    ds_read_b128 v[120:123], v11 offset:1280
    v_mfma_f32_16x16x32_bf16 v[200:203], a[120:123], v[124:127], v[200:203]
    buffer_load_dwordx4 v2, s[8:11], s50 offen lds
    v_mfma_f32_16x16x32_bf16 v[204:207], a[124:127], v[124:127], v[204:207]
    ds_read_b128 v[124:127], v11 offset:34048
    s_waitcnt lgkmcnt(15)
    v_mfma_f32_16x16x32_bf16 v[192:195], a[128:131], v[64:67], v[192:195]
    s_min_u32 s5, s5, s55
    v_mfma_f32_16x16x32_bf16 v[196:199], a[132:135], v[64:67], v[196:199]
    v_exp_f32 v60, v60
    v_mfma_f32_16x16x32_bf16 v[200:203], a[128:131], v[68:71], v[200:203]
    v_exp_f32 v61, v61
    v_mfma_f32_16x16x32_bf16 v[204:207], a[132:135], v[68:71], v[204:207]
    v_exp_f32 v62, v62
    v_mfma_f32_16x16x32_bf16 v[192:195], a[136:139], v[72:75], v[192:195]
    v_exp_f32 v63, v63
    v_mfma_f32_16x16x32_bf16 v[196:199], a[140:143], v[72:75], v[196:199]
    v_exp_f32 v242, v242
    v_mfma_f32_16x16x32_bf16 v[200:203], a[136:139], v[76:79], v[200:203]
    v_exp_f32 v243, v243
    v_mfma_f32_16x16x32_bf16 v[204:207], a[140:143], v[76:79], v[204:207]
    ds_read_b128 v[64:67], v8 offset:1536
    s_waitcnt lgkmcnt(9)
    v_mfma_f32_16x16x32_bf16 v[192:195], a[144:147], v[80:83], v[192:195]
    v_exp_f32 v244, v244
    v_mfma_f32_16x16x32_bf16 v[196:199], a[148:151], v[80:83], v[196:199]
    v_exp_f32 v245, v245
    v_mfma_f32_16x16x32_bf16 v[200:203], a[144:147], v[84:87], v[200:203]
    v_exp_f32 v246, v246
    v_mfma_f32_16x16x32_bf16 v[204:207], a[148:151], v[84:87], v[204:207]
    v_exp_f32 v247, v247
    v_mfma_f32_16x16x32_bf16 v[192:195], a[152:155], v[88:91], v[192:195]
    ds_read_b128 v[68:71], v8 offset:34304
    ds_read_b128 v[72:75], v9 offset:1536
    v_mfma_f32_16x16x32_bf16 v[196:199], a[156:159], v[88:91], v[196:199]
    ds_read_b128 v[76:79], v9 offset:34304
    v_cvt_pk_bf16_f32 v48, v60, v61
    v_mfma_f32_16x16x32_bf16 v[200:203], a[152:155], v[92:95], v[200:203]
    buffer_load_dwordx4 v2, s[8:11], s50 offen offset:1024 lds
    v_mfma_f32_16x16x32_bf16 v[204:207], a[156:159], v[92:95], v[204:207]
    v_cvt_pk_bf16_f32 v49, v62, v63
    s_waitcnt lgkmcnt(8)
    v_mfma_f32_16x16x32_bf16 v[192:195], a[160:163], v[96:99], v[192:195]
    v_cvt_pk_bf16_f32 v50, v242, v243
    v_cvt_pk_bf16_f32 v51, v244, v245
    v_mfma_f32_16x16x32_bf16 v[196:199], a[164:167], v[96:99], v[196:199]
    v_cvt_pk_bf16_f32 v40, v246, v247
    buffer_load_dword v29, v255, s[8:11], s5 offen
    v_mfma_f32_16x16x32_bf16 v[200:203], a[160:163], v[100:103], v[200:203]
    ds_read_b128 v[80:83], v10 offset:1536
    ds_read_b128 v[84:87], v10 offset:34304
    v_mfma_f32_16x16x32_bf16 v[52:55], v[44:47], v[48:51], 0
    ds_read_b128 v[88:91], v11 offset:1536
    ds_read_b128 v[92:95], v11 offset:34304
    v_mfma_f32_16x16x32_bf16 v[52:55], v[44:47], v[40:43], v[52:55]
    ds_read_b128 v[96:99], v8 offset:1792
    v_mfma_f32_16x16x32_bf16 v[208:211], v[160:163], v[48:51], 0
    v_mfma_f32_16x16x32_bf16 v[208:211], v[232:235], v[40:43], v[208:211]
    v_mfma_f32_16x16x32_bf16 v[212:215], v[164:167], v[48:51], 0
    v_mfma_f32_16x16x32_bf16 v[212:215], v[234:237], v[40:43], v[212:215]
    v_mfma_f32_16x16x32_bf16 v[216:219], v[168:171], v[48:51], 0
    v_mfma_f32_16x16x32_bf16 v[216:219], v[236:239], v[40:43], v[216:219]
    v_mfma_f32_16x16x32_bf16 v[220:223], v[172:175], v[48:51], 0
    v_mfma_f32_16x16x32_bf16 v[220:223], v[238:241], v[40:43], v[220:223]
    v_rcp_f32 v248, v52
    v_mfma_f32_16x16x32_bf16 v[204:207], a[164:167], v[100:103], v[204:207]
    ds_read_b128 v[100:103], v8 offset:34560
    v_mul_f32 v208, v248, v208
    v_mfma_f32_16x16x32_bf16 v[192:195], a[168:171], v[104:107], v[192:195]
    v_mul_f32 v209, v248, v209
    v_mul_f32 v210, v248, v210
    v_mfma_f32_16x16x32_bf16 v[196:199], a[172:175], v[104:107], v[196:199]
    ds_read_b128 v[104:107], v9 offset:1792
    v_mul_f32 v211, v248, v211
    v_mfma_f32_16x16x32_bf16 v[200:203], a[168:171], v[108:111], v[200:203]
    v_cvt_pk_bf16_f32 v224, v208, v209
    v_cvt_pk_bf16_f32 v225, v210, v211
    v_mfma_f32_16x16x32_bf16 v[204:207], a[172:175], v[108:111], v[204:207]
    ds_read_b128 v[108:111], v9 offset:34560
    s_waitcnt lgkmcnt(12)
    v_mfma_f32_16x16x32_bf16 v[192:195], a[176:179], v[112:115], v[192:195]
    v_mul_f32 v212, v248, v212
    v_mul_f32 v213, v248, v213
    v_mfma_f32_16x16x32_bf16 v[196:199], a[180:183], v[112:115], v[196:199]
    ds_read_b128 v[112:115], v10 offset:1792
    v_mul_f32 v214, v248, v214
    v_mfma_f32_16x16x32_bf16 v[200:203], a[176:179], v[116:119], v[200:203]
    v_mul_f32 v215, v248, v215
    v_cvt_pk_bf16_f32 v226, v212, v213
    v_mfma_f32_16x16x32_bf16 v[204:207], a[180:183], v[116:119], v[204:207]
    ds_read_b128 v[116:119], v10 offset:34560
    v_cvt_pk_bf16_f32 v227, v214, v215
    v_mfma_f32_16x16x32_bf16 v[192:195], a[184:187], v[120:123], v[192:195]
    v_mfma_f32_16x16x32_bf16 v[196:199], a[188:191], v[120:123], v[196:199]
    ds_read_b128 v[120:123], v11 offset:1792
    v_mfma_f32_16x16x32_bf16 v[200:203], a[184:187], v[124:127], v[200:203]
    v_mfma_f32_16x16x32_bf16 v[204:207], a[188:191], v[124:127], v[204:207]
    ds_read_b128 v[124:127], v11 offset:34560
    s_waitcnt lgkmcnt(12)
    v_mfma_f32_16x16x32_bf16 v[192:195], a[192:195], v[64:67], v[192:195]
    v_mfma_f32_16x16x32_bf16 v[196:199], a[196:199], v[64:67], v[196:199]
    v_mfma_f32_16x16x32_bf16 v[200:203], a[192:195], v[68:71], v[200:203]
    s_cmp_eq_u32 s31, 0
    s_cbranch_scc1 .cp_381
.cb_382:
    v_mfma_f32_16x16x32_bf16 v[204:207], a[196:199], v[68:71], v[204:207]
    s_cbranch_vccnz .cp_369
    buffer_store_dwordx4 v[224:227], v2, s[8:11], s53 offen offset:0
.cb_370:
    v_mfma_f32_16x16x32_bf16 v[192:195], a[200:203], v[72:75], v[192:195]
    s_waitcnt vmcnt(8) lgkmcnt(0)
    s_barrier
    v_mfma_f32_16x16x32_bf16 v[196:199], a[204:207], v[72:75], v[196:199]
    s_add_u32 m0, s6, 0
    ds_read_b128 v[64:67], v12 offset:0
    v_mfma_f32_16x16x32_bf16 v[200:203], a[200:203], v[76:79], v[200:203]
    buffer_load_dwordx4 v16, s[12:15], s29 offen offset:0 lds
    v_mfma_f32_16x16x32_bf16 v[204:207], a[204:207], v[76:79], v[204:207]
    ds_read_b128 v[68:71], v12 offset:32768
    ds_read_b128 v[72:75], v13 offset:0
    v_mfma_f32_16x16x32_bf16 v[192:195], a[208:211], v[80:83], v[192:195]
    ds_read_b128 v[76:79], v13 offset:32768
    v_mul_f32 v216, v248, v216
    v_mfma_f32_16x16x32_bf16 v[196:199], a[212:215], v[80:83], v[196:199]
    v_mul_f32 v217, v248, v217
    v_mul_f32 v218, v248, v218
    v_mfma_f32_16x16x32_bf16 v[200:203], a[208:211], v[84:87], v[200:203]
    buffer_load_dwordx4 v16, s[12:15], s29 offen offset:1024 lds
    v_mfma_f32_16x16x32_bf16 v[204:207], a[212:215], v[84:87], v[204:207]
    v_mul_f32 v219, v248, v219
    v_cvt_pk_bf16_f32 v228, v216, v217
    v_mfma_f32_16x16x32_bf16 v[192:195], a[216:219], v[88:91], v[192:195]
    v_cvt_pk_bf16_f32 v229, v218, v219
    v_mul_f32 v220, v248, v220
    v_mfma_f32_16x16x32_bf16 v[196:199], a[220:223], v[88:91], v[196:199]
    v_mul_f32 v221, v248, v221
    v_mul_f32 v222, v248, v222
    v_mfma_f32_16x16x32_bf16 v[200:203], a[216:219], v[92:95], v[200:203]
    buffer_load_dwordx4 v17, s[12:15], s29 offen offset:2048 lds
    v_mfma_f32_16x16x32_bf16 v[204:207], a[220:223], v[92:95], v[204:207]
    v_mul_f32 v223, v248, v223
    v_cvt_pk_bf16_f32 v230, v220, v221
    v_mfma_f32_16x16x32_bf16 v[192:195], a[224:227], v[96:99], v[192:195]
    v_cvt_pk_bf16_f32 v231, v222, v223
    ds_read_b128 v[80:83], v14 offset:0
    v_mfma_f32_16x16x32_bf16 v[196:199], a[228:231], v[96:99], v[196:199]
    s_cbranch_vccnz .cp_371
    buffer_store_dwordx4 v[228:231], v2, s[8:11], s53 offen offset:1024
.cb_372:
    v_mfma_f32_16x16x32_bf16 v[200:203], a[224:227], v[100:103], v[200:203]
    buffer_load_dwordx4 v17, s[12:15], s29 offen offset:3072 lds
    v_mfma_f32_16x16x32_bf16 v[204:207], a[228:231], v[100:103], v[204:207]
    ds_read_b128 v[84:87], v14 offset:32768
    ds_read_b128 v[88:91], v15 offset:0
    v_mfma_f32_16x16x32_bf16 v[192:195], a[232:235], v[104:107], v[192:195]
    ds_read_b128 v[92:95], v15 offset:32768
    ds_read_b128 v[96:99], v12 offset:256
    v_mfma_f32_16x16x32_bf16 v[196:199], a[236:239], v[104:107], v[196:199]
    ds_read_b128 v[100:103], v12 offset:33024
    ds_read_b128 v[104:107], v13 offset:256
    v_mfma_f32_16x16x32_bf16 v[200:203], a[232:235], v[108:111], v[200:203]
    s_add_u32 m0, s6, 4096
    s_mov_b32 s53, s40
    v_mfma_f32_16x16x32_bf16 v[204:207], a[236:239], v[108:111], v[204:207]
    buffer_load_dwordx4 v18, s[12:15], s29 offen offset:0 lds
    v_mfma_f32_16x16x32_bf16 v[192:195], a[240:243], v[112:115], v[192:195]
    ds_read_b128 v[108:111], v13 offset:33024
    s_add_u32 s40, s40, 0x40000
    v_mfma_f32_16x16x32_bf16 v[196:199], a[244:247], v[112:115], v[196:199]
    s_mov_b32 s30, s42
    s_add_u32 s42, s42, 1
    v_mfma_f32_16x16x32_bf16 v[200:203], a[240:243], v[116:119], v[200:203]
    v_mfma_f32_16x16x32_bf16 v[204:207], a[244:247], v[116:119], v[204:207]
    buffer_load_dwordx4 v18, s[12:15], s29 offen offset:1024 lds
    v_mfma_f32_16x16x32_bf16 v[192:195], a[248:251], v[120:123], v[192:195]
    v_mfma_f32_16x16x32_bf16 v[196:199], a[252:255], v[120:123], v[196:199]
    v_mfma_f32_16x16x32_bf16 v[200:203], a[248:251], v[124:127], v[200:203]
    v_mfma_f32_16x16x32_bf16 v[204:207], a[252:255], v[124:127], v[204:207]
    s_waitcnt lgkmcnt(8)
    v_mfma_f32_16x16x32_bf16 v[208:211], a[0:3], v[64:67], 0
    buffer_load_dwordx4 v19, s[12:15], s29 offen offset:2048 lds
    v_mfma_f32_16x16x32_bf16 v[212:215], a[4:7], v[64:67], 0
    ds_read_b128 v[112:115], v14 offset:256
    ds_read_b128 v[116:119], v14 offset:33024
    v_mfma_f32_16x16x32_bf16 v[216:219], a[0:3], v[68:71], 0
    ds_read_b128 v[120:123], v15 offset:256
    ds_read_b128 v[124:127], v15 offset:33024
    v_mfma_f32_16x16x32_bf16 v[220:223], a[4:7], v[68:71], 0
    ds_read_b128 v[64:67], v12 offset:512
    ds_read_b128 v[68:71], v12 offset:33280
    v_mfma_f32_16x16x32_bf16 v[208:211], a[8:11], v[72:75], v[208:211]
    buffer_load_dwordx4 v19, s[12:15], s29 offen offset:3072 lds
    v_mfma_f32_16x16x32_bf16 v[212:215], a[12:15], v[72:75], v[212:215]
    v_cvt_pk_bf16_f32 v224, v192, v193
    v_cvt_pk_bf16_f32 v225, v194, v195
    v_mfma_f32_16x16x32_bf16 v[216:219], a[8:11], v[76:79], v[216:219]
    v_cvt_pk_bf16_f32 v226, v196, v197
    v_cvt_pk_bf16_f32 v227, v198, v199
    v_mfma_f32_16x16x32_bf16 v[220:223], a[12:15], v[76:79], v[220:223]
    ds_write_b128 v24, v[224:227] offset:0
    s_waitcnt lgkmcnt(11)
    v_mfma_f32_16x16x32_bf16 v[208:211], a[16:19], v[80:83], v[208:211]
    s_add_u32 m0, s6, 8192
    v_cvt_pk_bf16_f32 v228, v200, v201
    v_mfma_f32_16x16x32_bf16 v[212:215], a[20:23], v[80:83], v[212:215]
    buffer_load_dwordx4 v20, s[12:15], s29 offen offset:0 lds
    v_mfma_f32_16x16x32_bf16 v[216:219], a[16:19], v[84:87], v[216:219]
    v_cvt_pk_bf16_f32 v229, v202, v203
    v_cvt_pk_bf16_f32 v230, v204, v205
    v_mfma_f32_16x16x32_bf16 v[220:223], a[20:23], v[84:87], v[220:223]
    v_cvt_pk_bf16_f32 v231, v206, v207
    ds_write_b128 v24, v[228:231] offset:4096
    v_mfma_f32_16x16x32_bf16 v[208:211], a[24:27], v[88:91], v[208:211]
    ds_read_b128 v[72:75], v13 offset:512
    ds_read_b128 v[76:79], v13 offset:33280
    v_mfma_f32_16x16x32_bf16 v[212:215], a[28:31], v[88:91], v[212:215]
    buffer_load_dwordx4 v20, s[12:15], s29 offen offset:1024 lds
    v_mfma_f32_16x16x32_bf16 v[216:219], a[24:27], v[92:95], v[216:219]
    ds_read_b128 v[80:83], v14 offset:512
    ds_read_b128 v[84:87], v14 offset:33280
    v_mfma_f32_16x16x32_bf16 v[220:223], a[28:31], v[92:95], v[220:223]
    ds_read_b128 v[88:91], v15 offset:512
    s_waitcnt lgkmcnt(13)
    v_mfma_f32_16x16x32_bf16 v[208:211], a[32:35], v[96:99], v[208:211]
    s_waitcnt vmcnt(13) lgkmcnt(5)
    s_barrier
    v_mfma_f32_16x16x32_bf16 v[212:215], a[36:39], v[96:99], v[212:215]
    buffer_load_dwordx4 v21, s[12:15], s29 offen offset:2048 lds
    v_mfma_f32_16x16x32_bf16 v[216:219], a[32:35], v[100:103], v[216:219]
    ds_read_b128 v[192:195], v25 offset:0
    ds_read_b128 v[128:131], v31 offset:0
    v_mfma_f32_16x16x32_bf16 v[220:223], a[36:39], v[100:103], v[220:223]
    ds_read_b128 v[144:147], v31 offset:4096
    ds_read_b128 v[196:199], v25 offset:1024
    v_mfma_f32_16x16x32_bf16 v[208:211], a[40:43], v[104:107], v[208:211]
    ds_read_b128 v[132:135], v31 offset:1024
    ds_read_b128 v[148:151], v31 offset:5120
    v_mfma_f32_16x16x32_bf16 v[212:215], a[44:47], v[104:107], v[212:215]
    buffer_load_dwordx4 v21, s[12:15], s29 offen offset:3072 lds
    v_mfma_f32_16x16x32_bf16 v[216:219], a[40:43], v[108:111], v[216:219]
    ds_read_b128 v[92:95], v15 offset:33280
    ds_read_b128 v[200:203], v25 offset:2048
    v_mfma_f32_16x16x32_bf16 v[220:223], a[44:47], v[108:111], v[220:223]
    ds_read_b128 v[136:139], v31 offset:2048
    ds_read_b128 v[152:155], v31 offset:6144
    v_mfma_f32_16x16x32_bf16 v[208:211], a[48:51], v[112:115], v[208:211]
    ds_read_b128 v[204:207], v25 offset:3072
    ds_read_b128 v[140:143], v31 offset:3072
    v_mfma_f32_16x16x32_bf16 v[212:215], a[52:55], v[112:115], v[212:215]
    s_add_u32 m0, s6, 12288
    s_waitcnt lgkmcnt(9)
    v_mfma_f32_16x16x32_bf16 v[48:51], v[128:131], v[192:195], v[32:35]
    buffer_load_dwordx4 v22, s[12:15], s29 offen offset:0 lds
    v_mfma_f32_16x16x32_bf16 v[52:55], v[144:147], v[192:195], v[36:39]
    ds_read_b128 v[156:159], v31 offset:7168
    s_waitcnt lgkmcnt(7)
    v_mfma_f32_16x16x32_bf16 v[48:51], v[132:135], v[196:199], v[48:51]
    ds_read_b128 v[160:163], v5 offset:8192
    ds_read_b128 v[164:167], v5 offset:9216
    v_mfma_f32_16x16x32_bf16 v[52:55], v[148:151], v[196:199], v[52:55]
    ds_read_b128 v[96:99], v12 offset:768
    s_waitcnt lgkmcnt(6)
    v_mfma_f32_16x16x32_bf16 v[48:51], v[136:139], v[200:203], v[48:51]
    buffer_load_dwordx4 v22, s[12:15], s29 offen offset:1024 lds
    v_mfma_f32_16x16x32_bf16 v[52:55], v[152:155], v[200:203], v[52:55]
    ds_read_b128 v[100:103], v12 offset:33536
    ds_read_b128 v[104:107], v13 offset:768
    v_mfma_f32_16x16x32_bf16 v[216:219], a[48:51], v[116:119], v[216:219]
    ds_read_b128 v[108:111], v13 offset:33536
    ds_read_b128 v[168:171], v5 offset:10240
    v_mfma_f32_16x16x32_bf16 v[220:223], a[52:55], v[116:119], v[220:223]
    ds_read_b128 v[172:175], v5 offset:11264
    s_waitcnt lgkmcnt(8)
    v_mfma_f32_16x16x32_bf16 v[48:51], v[140:143], v[204:207], v[48:51]
    buffer_load_dwordx4 v23, s[12:15], s29 offen offset:2048 lds
    v_mfma_f32_16x16x32_bf16 v[52:55], v[156:159], v[204:207], v[52:55]
    v_max_i32 v27, s30, v26
    ds_read_b128 v[112:115], v14 offset:768
    v_mfma_f32_16x16x32_bf16 v[208:211], a[56:59], v[120:123], v[208:211]
    s_waitcnt vmcnt(12)
    s_cbranch_vccnz .cp_387
    buffer_store_dword v27, v26, s[8:11], s94 offen
.cb_388:
    v_mfma_f32_16x16x32_bf16 v[212:215], a[60:63], v[120:123], v[212:215]
    ds_read_b128 v[116:119], v14 offset:33536
    ds_read_b128 v[120:123], v15 offset:768
    v_mfma_f32_16x16x32_bf16 v[216:219], a[56:59], v[124:127], v[216:219]
    buffer_load_dwordx4 v23, s[12:15], s29 offen offset:3072 lds
    v_mfma_f32_16x16x32_bf16 v[220:223], a[60:63], v[124:127], v[220:223]
    s_cmp_eq_u32 s31, 0
    s_cbranch_scc1 .cp_391
.cb_392:
    v_mfma_f32_16x16x32_bf16 v[208:211], a[64:67], v[64:67], v[208:211]
    s_waitcnt lgkmcnt(3)
    s_barrier
    v_mfma_f32_16x16x32_bf16 v[212:215], a[68:71], v[64:67], v[212:215]
    ds_read_b128 v[124:127], v15 offset:33536
    ds_read_b128 v[176:179], v3 offset:4096
    v_mfma_f32_16x16x32_bf16 v[216:219], a[64:67], v[68:71], v[216:219]
    ds_read_b128 v[180:183], v3 offset:4608
    ds_read_b128 v[184:187], v3 offset:5120
    v_mfma_f32_16x16x32_bf16 v[220:223], a[68:71], v[68:71], v[220:223]
    ds_read_b128 v[188:191], v3 offset:5632
    ds_read_b128 v[64:67], v12 offset:1024
    v_mfma_f32_16x16x32_bf16 v[208:211], a[72:75], v[72:75], v[208:211]
    ds_read_b128 v[68:71], v12 offset:33792
    v_max3_f32 v248, v48, v49, v50
    v_mfma_f32_16x16x32_bf16 v[212:215], a[76:79], v[72:75], v[212:215]
    ds_read_b128 v[72:75], v13 offset:1024
    v_max3_f32 v248, v248, v51, v52
    v_mfma_f32_16x16x32_bf16 v[216:219], a[72:75], v[76:79], v[216:219]
    v_max3_f32 v249, v53, v54, v55
    s_add_u32 m0, s52, 0
    v_mfma_f32_16x16x32_bf16 v[220:223], a[76:79], v[76:79], v[220:223]
    ds_read_b128 v[76:79], v13 offset:33792
    s_add_u32 s48, s48, 0x20000
    v_mfma_f32_16x16x32_bf16 v[208:211], a[80:83], v[80:83], v[208:211]
    s_mov_b32 s31, 1
    buffer_load_dword v29, v28, s[12:15], s29 offen
    v_mfma_f32_16x16x32_bf16 v[212:215], a[84:87], v[80:83], v[212:215]
    s_cmp_gt_u32 s33, s42
    s_cbranch_scc0 .pp_393
    buffer_load_dwordx4 v2, s[8:11], s48 offen lds
.pb_394:
    s_waitcnt lgkmcnt(4)
    v_mfma_f32_16x16x32_bf16 v[56:59], v[176:179], v[192:195], 0
    ds_read_b128 v[80:83], v14 offset:1024
    s_add_u32 s29, s29, 0x10000
    v_mfma_f32_16x16x32_bf16 v[56:59], v[180:183], v[196:199], v[56:59]
    s_cmp_gt_u32 s32, s42
    s_cbranch_scc0 .cp_389
.cb_390:
    v_mfma_f32_16x16x32_bf16 v[56:59], v[184:187], v[200:203], v[56:59]
    ds_read_b32 v232, v6 offset:4096
    ds_read_b32 v234, v6 offset:4160
    v_mfma_f32_16x16x32_bf16 v[56:59], v[188:191], v[204:207], v[56:59]
    ds_read_b32 v236, v6 offset:4608
    ds_read_b32 v238, v6 offset:4672
    v_mfma_f32_16x16x32_bf16 v[216:219], a[80:83], v[84:87], v[216:219]
    s_mov_b32 m0, s43
    s_add_u32 s49, s49, 0x40000
    v_mfma_f32_16x16x32_bf16 v[220:223], a[84:87], v[84:87], v[220:223]
    ds_read_b128 v[84:87], v14 offset:33792
    v_mfma_f32_16x16x32_bf16 v[208:211], a[88:91], v[88:91], v[208:211]
    buffer_load_dwordx4 v2, s[8:11], s49 offen lds
    v_mfma_f32_16x16x32_bf16 v[212:215], a[92:95], v[88:91], v[212:215]
    ds_read_b128 v[88:91], v15 offset:1024
    v_max3_f32 v248, v248, v56, v57
    v_mfma_f32_16x16x32_bf16 v[216:219], a[88:91], v[92:95], v[216:219]
    v_max_f32 v30, v248, v249
    v_max_f32 v249, v248, v249
    v_mfma_f32_16x16x32_bf16 v[220:223], a[92:95], v[92:95], v[220:223]
    ds_read_b128 v[92:95], v15 offset:33792
    s_add_u32 s50, s49, 16777216
    v_mfma_f32_16x16x32_bf16 v[208:211], a[96:99], v[96:99], v[208:211]
    v_permlane16_swap_b32 v249, v30
    v_max_f32 v248, v249, v30
    v_mfma_f32_16x16x32_bf16 v[212:215], a[100:103], v[96:99], v[212:215]
    v_max_f32 v249, v249, v30
    ds_read_b128 v[96:99], v12 offset:1280
    v_mfma_f32_16x16x32_bf16 v[216:219], a[96:99], v[100:103], v[216:219]
    buffer_load_dwordx4 v2, s[8:11], s49 offen offset:1024 lds
    v_mfma_f32_16x16x32_bf16 v[220:223], a[100:103], v[100:103], v[220:223]
    v_permlane32_swap_b32 v248, v249
    v_max_f32 v248, v248, v249
    v_mfma_f32_16x16x32_bf16 v[208:211], a[104:107], v[104:107], v[208:211]
    v_mul_f32 v248, s45, v248
    ds_read_b128 v[100:103], v12 offset:34048
    v_mfma_f32_16x16x32_bf16 v[212:215], a[108:111], v[104:107], v[212:215]
    ds_read_b128 v[104:107], v13 offset:1280
    v_fma_f32 v60, v48, s45, -v248
    v_mfma_f32_16x16x32_bf16 v[216:219], a[104:107], v[108:111], v[216:219]
    v_fma_f32 v61, v49, s45, -v248
    v_fma_f32 v62, v50, s45, -v248
    v_mfma_f32_16x16x32_bf16 v[220:223], a[108:111], v[108:111], v[220:223]
    ds_read_b128 v[108:111], v13 offset:34048
    v_fma_f32 v63, v51, s45, -v248
    v_mfma_f32_16x16x32_bf16 v[208:211], a[112:115], v[112:115], v[208:211]
    v_fma_f32 v242, v52, s45, -v248
    v_fma_f32 v243, v53, s45, -v248
    v_mfma_f32_16x16x32_bf16 v[212:215], a[116:119], v[112:115], v[212:215]
    v_fma_f32 v244, v54, s45, -v248
    v_fma_f32 v245, v55, s45, -v248
    v_mfma_f32_16x16x32_bf16 v[216:219], a[112:115], v[116:119], v[216:219]
    v_fma_f32 v246, v56, s45, -v248
    v_fma_f32 v247, v57, s45, -v248
    v_mfma_f32_16x16x32_bf16 v[220:223], a[116:119], v[116:119], v[220:223]
    ds_read_b128 v[112:115], v14 offset:1280
    ds_read_b128 v[116:119], v14 offset:34048
    v_mfma_f32_16x16x32_bf16 v[208:211], a[120:123], v[120:123], v[208:211]
    s_add_u32 m0, s43, 8192
    s_add_u32 s5, s49, 0x40000
    v_mfma_f32_16x16x32_bf16 v[212:215], a[124:127], v[120:123], v[212:215]
    ds_read_b128 v[120:123], v15 offset:1280
    v_mfma_f32_16x16x32_bf16 v[216:219], a[120:123], v[124:127], v[216:219]
    buffer_load_dwordx4 v2, s[8:11], s50 offen lds
    v_mfma_f32_16x16x32_bf16 v[220:223], a[124:127], v[124:127], v[220:223]
    ds_read_b128 v[124:127], v15 offset:34048
    s_waitcnt lgkmcnt(15)
    v_mfma_f32_16x16x32_bf16 v[208:211], a[128:131], v[64:67], v[208:211]
    s_min_u32 s5, s5, s55
    v_mfma_f32_16x16x32_bf16 v[212:215], a[132:135], v[64:67], v[212:215]
    v_exp_f32 v60, v60
    v_mfma_f32_16x16x32_bf16 v[216:219], a[128:131], v[68:71], v[216:219]
    v_exp_f32 v61, v61
    v_mfma_f32_16x16x32_bf16 v[220:223], a[132:135], v[68:71], v[220:223]
    v_exp_f32 v62, v62
    v_mfma_f32_16x16x32_bf16 v[208:211], a[136:139], v[72:75], v[208:211]
    v_exp_f32 v63, v63
    v_mfma_f32_16x16x32_bf16 v[212:215], a[140:143], v[72:75], v[212:215]
    v_exp_f32 v242, v242
    v_mfma_f32_16x16x32_bf16 v[216:219], a[136:139], v[76:79], v[216:219]
    v_exp_f32 v243, v243
    v_mfma_f32_16x16x32_bf16 v[220:223], a[140:143], v[76:79], v[220:223]
    ds_read_b128 v[64:67], v12 offset:1536
    s_waitcnt lgkmcnt(9)
    v_mfma_f32_16x16x32_bf16 v[208:211], a[144:147], v[80:83], v[208:211]
    v_exp_f32 v244, v244
    v_mfma_f32_16x16x32_bf16 v[212:215], a[148:151], v[80:83], v[212:215]
    v_exp_f32 v245, v245
    v_mfma_f32_16x16x32_bf16 v[216:219], a[144:147], v[84:87], v[216:219]
    v_exp_f32 v246, v246
    v_mfma_f32_16x16x32_bf16 v[220:223], a[148:151], v[84:87], v[220:223]
    v_exp_f32 v247, v247
    v_mfma_f32_16x16x32_bf16 v[208:211], a[152:155], v[88:91], v[208:211]
    ds_read_b128 v[68:71], v12 offset:34304
    ds_read_b128 v[72:75], v13 offset:1536
    v_mfma_f32_16x16x32_bf16 v[212:215], a[156:159], v[88:91], v[212:215]
    ds_read_b128 v[76:79], v13 offset:34304
    v_cvt_pk_bf16_f32 v48, v60, v61
    v_mfma_f32_16x16x32_bf16 v[216:219], a[152:155], v[92:95], v[216:219]
    buffer_load_dwordx4 v2, s[8:11], s50 offen offset:1024 lds
    v_mfma_f32_16x16x32_bf16 v[220:223], a[156:159], v[92:95], v[220:223]
    v_cvt_pk_bf16_f32 v49, v62, v63
    s_waitcnt lgkmcnt(8)
    v_mfma_f32_16x16x32_bf16 v[208:211], a[160:163], v[96:99], v[208:211]
    v_cvt_pk_bf16_f32 v50, v242, v243
    v_cvt_pk_bf16_f32 v51, v244, v245
    v_mfma_f32_16x16x32_bf16 v[212:215], a[164:167], v[96:99], v[212:215]
    v_cvt_pk_bf16_f32 v40, v246, v247
    buffer_load_dword v29, v255, s[8:11], s5 offen
    v_mfma_f32_16x16x32_bf16 v[216:219], a[160:163], v[100:103], v[216:219]
    ds_read_b128 v[80:83], v14 offset:1536
    ds_read_b128 v[84:87], v14 offset:34304
    v_mfma_f32_16x16x32_bf16 v[52:55], v[44:47], v[48:51], 0
    ds_read_b128 v[88:91], v15 offset:1536
    ds_read_b128 v[92:95], v15 offset:34304
    v_mfma_f32_16x16x32_bf16 v[52:55], v[44:47], v[40:43], v[52:55]
    ds_read_b128 v[96:99], v12 offset:1792
    v_mfma_f32_16x16x32_bf16 v[192:195], v[160:163], v[48:51], 0
    v_mfma_f32_16x16x32_bf16 v[192:195], v[232:235], v[40:43], v[192:195]
    v_mfma_f32_16x16x32_bf16 v[196:199], v[164:167], v[48:51], 0
    v_mfma_f32_16x16x32_bf16 v[196:199], v[234:237], v[40:43], v[196:199]
    v_mfma_f32_16x16x32_bf16 v[200:203], v[168:171], v[48:51], 0
    v_mfma_f32_16x16x32_bf16 v[200:203], v[236:239], v[40:43], v[200:203]
    v_mfma_f32_16x16x32_bf16 v[204:207], v[172:175], v[48:51], 0
    v_mfma_f32_16x16x32_bf16 v[204:207], v[238:241], v[40:43], v[204:207]
    v_rcp_f32 v248, v52
    v_mfma_f32_16x16x32_bf16 v[220:223], a[164:167], v[100:103], v[220:223]
    ds_read_b128 v[100:103], v12 offset:34560
    v_mul_f32 v192, v248, v192
    v_mfma_f32_16x16x32_bf16 v[208:211], a[168:171], v[104:107], v[208:211]
    v_mul_f32 v193, v248, v193
    v_mul_f32 v194, v248, v194
    v_mfma_f32_16x16x32_bf16 v[212:215], a[172:175], v[104:107], v[212:215]
    ds_read_b128 v[104:107], v13 offset:1792
    v_mul_f32 v195, v248, v195
    v_mfma_f32_16x16x32_bf16 v[216:219], a[168:171], v[108:111], v[216:219]
    v_cvt_pk_bf16_f32 v224, v192, v193
    v_cvt_pk_bf16_f32 v225, v194, v195
    v_mfma_f32_16x16x32_bf16 v[220:223], a[172:175], v[108:111], v[220:223]
    ds_read_b128 v[108:111], v13 offset:34560
    s_waitcnt lgkmcnt(12)
    v_mfma_f32_16x16x32_bf16 v[208:211], a[176:179], v[112:115], v[208:211]
    v_mul_f32 v196, v248, v196
    v_mul_f32 v197, v248, v197
    v_mfma_f32_16x16x32_bf16 v[212:215], a[180:183], v[112:115], v[212:215]
    ds_read_b128 v[112:115], v14 offset:1792
    v_mul_f32 v198, v248, v198
    v_mfma_f32_16x16x32_bf16 v[216:219], a[176:179], v[116:119], v[216:219]
    v_mul_f32 v199, v248, v199
    v_cvt_pk_bf16_f32 v226, v196, v197
    v_mfma_f32_16x16x32_bf16 v[220:223], a[180:183], v[116:119], v[220:223]
    ds_read_b128 v[116:119], v14 offset:34560
    v_cvt_pk_bf16_f32 v227, v198, v199
    v_mfma_f32_16x16x32_bf16 v[208:211], a[184:187], v[120:123], v[208:211]
    v_mfma_f32_16x16x32_bf16 v[212:215], a[188:191], v[120:123], v[212:215]
    ds_read_b128 v[120:123], v15 offset:1792
    v_mfma_f32_16x16x32_bf16 v[216:219], a[184:187], v[124:127], v[216:219]
    v_mfma_f32_16x16x32_bf16 v[220:223], a[188:191], v[124:127], v[220:223]
    ds_read_b128 v[124:127], v15 offset:34560
    s_waitcnt lgkmcnt(12)
    v_mfma_f32_16x16x32_bf16 v[208:211], a[192:195], v[64:67], v[208:211]
    v_mfma_f32_16x16x32_bf16 v[212:215], a[196:199], v[64:67], v[212:215]
    v_mfma_f32_16x16x32_bf16 v[216:219], a[192:195], v[68:71], v[216:219]
    s_cmp_eq_u32 s31, 0
    s_cbranch_scc1 .cp_395
.cb_396:
    v_mfma_f32_16x16x32_bf16 v[220:223], a[196:199], v[68:71], v[220:223]
    s_cbranch_vccnz .cp_383
    buffer_store_dwordx4 v[224:227], v2, s[8:11], s53 offen offset:0
.cb_384:
    v_mfma_f32_16x16x32_bf16 v[208:211], a[200:203], v[72:75], v[208:211]
    s_waitcnt vmcnt(8) lgkmcnt(0)
    s_barrier
    v_mfma_f32_16x16x32_bf16 v[212:215], a[204:207], v[72:75], v[212:215]
    s_add_u32 m0, s6, 65536
    ds_read_b128 v[64:67], v8 offset:0
    v_mfma_f32_16x16x32_bf16 v[216:219], a[200:203], v[76:79], v[216:219]
    buffer_load_dwordx4 v16, s[12:15], s29 offen offset:0 lds
    v_mfma_f32_16x16x32_bf16 v[220:223], a[204:207], v[76:79], v[220:223]
    ds_read_b128 v[68:71], v8 offset:32768
    ds_read_b128 v[72:75], v9 offset:0
    v_mfma_f32_16x16x32_bf16 v[208:211], a[208:211], v[80:83], v[208:211]
    ds_read_b128 v[76:79], v9 offset:32768
    v_mul_f32 v200, v248, v200
    v_mfma_f32_16x16x32_bf16 v[212:215], a[212:215], v[80:83], v[212:215]
    v_mul_f32 v201, v248, v201
    v_mul_f32 v202, v248, v202
    v_mfma_f32_16x16x32_bf16 v[216:219], a[208:211], v[84:87], v[216:219]
    buffer_load_dwordx4 v16, s[12:15], s29 offen offset:1024 lds
    v_mfma_f32_16x16x32_bf16 v[220:223], a[212:215], v[84:87], v[220:223]
    v_mul_f32 v203, v248, v203
    v_cvt_pk_bf16_f32 v228, v200, v201
    v_mfma_f32_16x16x32_bf16 v[208:211], a[216:219], v[88:91], v[208:211]
    v_cvt_pk_bf16_f32 v229, v202, v203
    v_mul_f32 v204, v248, v204
    v_mfma_f32_16x16x32_bf16 v[212:215], a[220:223], v[88:91], v[212:215]
    v_mul_f32 v205, v248, v205
    v_mul_f32 v206, v248, v206
    v_mfma_f32_16x16x32_bf16 v[216:219], a[216:219], v[92:95], v[216:219]
    buffer_load_dwordx4 v17, s[12:15], s29 offen offset:2048 lds
    v_mfma_f32_16x16x32_bf16 v[220:223], a[220:223], v[92:95], v[220:223]
    v_mul_f32 v207, v248, v207
    v_cvt_pk_bf16_f32 v230, v204, v205
    v_mfma_f32_16x16x32_bf16 v[208:211], a[224:227], v[96:99], v[208:211]
    v_cvt_pk_bf16_f32 v231, v206, v207
    ds_read_b128 v[80:83], v10 offset:0
    v_mfma_f32_16x16x32_bf16 v[212:215], a[228:231], v[96:99], v[212:215]
    s_cbranch_vccnz .cp_385
    buffer_store_dwordx4 v[228:231], v2, s[8:11], s53 offen offset:1024
.cb_386:
    v_mfma_f32_16x16x32_bf16 v[216:219], a[224:227], v[100:103], v[216:219]
    buffer_load_dwordx4 v17, s[12:15], s29 offen offset:3072 lds
    v_mfma_f32_16x16x32_bf16 v[220:223], a[228:231], v[100:103], v[220:223]
    ds_read_b128 v[84:87], v10 offset:32768
    ds_read_b128 v[88:91], v11 offset:0
    v_mfma_f32_16x16x32_bf16 v[208:211], a[232:235], v[104:107], v[208:211]
    ds_read_b128 v[92:95], v11 offset:32768
    ds_read_b128 v[96:99], v8 offset:256
    v_mfma_f32_16x16x32_bf16 v[212:215], a[236:239], v[104:107], v[212:215]
    ds_read_b128 v[100:103], v8 offset:33024
    ds_read_b128 v[104:107], v9 offset:256
    v_mfma_f32_16x16x32_bf16 v[216:219], a[232:235], v[108:111], v[216:219]
    s_add_u32 m0, s6, 69632
    s_mov_b32 s53, s40
    v_mfma_f32_16x16x32_bf16 v[220:223], a[236:239], v[108:111], v[220:223]
    buffer_load_dwordx4 v18, s[12:15], s29 offen offset:0 lds
    v_mfma_f32_16x16x32_bf16 v[208:211], a[240:243], v[112:115], v[208:211]
    ds_read_b128 v[108:111], v9 offset:33024
    s_add_u32 s40, s40, 0x40000
    v_mfma_f32_16x16x32_bf16 v[212:215], a[244:247], v[112:115], v[212:215]
    s_mov_b32 s30, s42
    s_add_u32 s42, s42, 1
    v_mfma_f32_16x16x32_bf16 v[216:219], a[240:243], v[116:119], v[216:219]
    v_mfma_f32_16x16x32_bf16 v[220:223], a[244:247], v[116:119], v[220:223]
    buffer_load_dwordx4 v18, s[12:15], s29 offen offset:1024 lds
    v_mfma_f32_16x16x32_bf16 v[208:211], a[248:251], v[120:123], v[208:211]
    v_mfma_f32_16x16x32_bf16 v[212:215], a[252:255], v[120:123], v[212:215]
    v_mfma_f32_16x16x32_bf16 v[216:219], a[248:251], v[124:127], v[216:219]
    v_mfma_f32_16x16x32_bf16 v[220:223], a[252:255], v[124:127], v[220:223]
    s_cmp_lg_u32 s42, 60
    s_cbranch_scc1 .ql_367
    s_nop 5
    v_cvt_pk_bf16_f32 v224, v208, v209
    v_cvt_pk_bf16_f32 v225, v210, v211
    v_cvt_pk_bf16_f32 v226, v212, v213
    v_cvt_pk_bf16_f32 v227, v214, v215
    v_cvt_pk_bf16_f32 v228, v216, v217
    v_cvt_pk_bf16_f32 v229, v218, v219
    v_cvt_pk_bf16_f32 v230, v220, v221
    v_cvt_pk_bf16_f32 v231, v222, v223
    ds_write_b128 v24, v[224:227] offset:0
    ds_write_b128 v24, v[228:231] offset:4096
    s_waitcnt vmcnt(0)
    v_max_i32 v27, s30, v26
    s_cbranch_vccnz .cp_397
    buffer_store_dword v27, v26, s[8:11], s94 offen
.cb_398:
    s_waitcnt lgkmcnt(0)
    s_barrier
    ds_read_b128 v[208:211], v25 offset:0
    ds_read_b128 v[128:131], v31 offset:0
    ds_read_b128 v[144:147], v31 offset:4096
    ds_read_b128 v[212:215], v25 offset:1024
    ds_read_b128 v[132:135], v31 offset:1024
    ds_read_b128 v[148:151], v31 offset:5120
    ds_read_b128 v[216:219], v25 offset:2048
    ds_read_b128 v[136:139], v31 offset:2048
    ds_read_b128 v[152:155], v31 offset:6144
    ds_read_b128 v[220:223], v25 offset:3072
    ds_read_b128 v[140:143], v31 offset:3072
    ds_read_b128 v[156:159], v31 offset:7168
    ds_read_b128 v[160:163], v5 offset:8192
    ds_read_b128 v[164:167], v5 offset:9216
    ds_read_b128 v[168:171], v5 offset:10240
    ds_read_b128 v[172:175], v5 offset:11264
    s_waitcnt lgkmcnt(4)
    v_mfma_f32_16x16x32_bf16 v[48:51], v[128:131], v[208:211], v[32:35]
    v_mfma_f32_16x16x32_bf16 v[52:55], v[144:147], v[208:211], v[36:39]
    v_mfma_f32_16x16x32_bf16 v[48:51], v[132:135], v[212:215], v[48:51]
    v_mfma_f32_16x16x32_bf16 v[52:55], v[148:151], v[212:215], v[52:55]
    v_mfma_f32_16x16x32_bf16 v[48:51], v[136:139], v[216:219], v[48:51]
    v_mfma_f32_16x16x32_bf16 v[52:55], v[152:155], v[216:219], v[52:55]
    v_mfma_f32_16x16x32_bf16 v[48:51], v[140:143], v[220:223], v[48:51]
    v_mfma_f32_16x16x32_bf16 v[52:55], v[156:159], v[220:223], v[52:55]
    s_cmp_eq_u32 s31, 0
    s_cbranch_scc1 .cp_407
.cb_408:
    s_waitcnt vmcnt(0)
    s_barrier
    ds_read_b128 v[176:179], v3 offset:0
    ds_read_b128 v[180:183], v3 offset:512
    ds_read_b128 v[184:187], v3 offset:1024
    ds_read_b128 v[188:191], v3 offset:1536
    ds_read_b32 v232, v6 offset:0
    ds_read_b32 v234, v6 offset:64
    ds_read_b32 v236, v6 offset:512
    ds_read_b32 v238, v6 offset:576
    v_max3_f32 v248, v48, v49, v50
    v_max3_f32 v248, v248, v51, v52
    v_max3_f32 v249, v53, v54, v55
    s_waitcnt lgkmcnt(4)
    v_mfma_f32_16x16x32_bf16 v[56:59], v[176:179], v[208:211], 0
    v_mfma_f32_16x16x32_bf16 v[56:59], v[180:183], v[212:215], v[56:59]
    v_mfma_f32_16x16x32_bf16 v[56:59], v[184:187], v[216:219], v[56:59]
    v_mfma_f32_16x16x32_bf16 v[56:59], v[188:191], v[220:223], v[56:59]
    s_nop 7
    v_max3_f32 v248, v248, v56, v57
    v_max_f32 v30, v248, v249
    v_max_f32 v249, v248, v249
    s_nop 1
    v_permlane16_swap_b32 v249, v30
    v_max_f32 v248, v249, v30
    v_max_f32 v249, v249, v30
    s_nop 1
    v_permlane32_swap_b32 v248, v249
    v_max_f32 v248, v248, v249
    v_mul_f32 v248, s45, v248
    v_fma_f32 v60, v48, s45, -v248
    v_fma_f32 v61, v49, s45, -v248
    v_fma_f32 v62, v50, s45, -v248
    v_fma_f32 v63, v51, s45, -v248
    v_fma_f32 v242, v52, s45, -v248
    v_fma_f32 v243, v53, s45, -v248
    v_fma_f32 v244, v54, s45, -v248
    v_fma_f32 v245, v55, s45, -v248
    v_fma_f32 v246, v56, s45, -v248
    v_fma_f32 v247, v57, s45, -v248
    v_exp_f32 v60, v60
    v_exp_f32 v61, v61
    v_exp_f32 v62, v62
    v_exp_f32 v63, v63
    v_exp_f32 v242, v242
    v_exp_f32 v243, v243
    v_exp_f32 v244, v244
    v_exp_f32 v245, v245
    v_exp_f32 v246, v246
    v_exp_f32 v247, v247
    v_cvt_pk_bf16_f32 v48, v60, v61
    v_cvt_pk_bf16_f32 v49, v62, v63
    v_cvt_pk_bf16_f32 v50, v242, v243
    v_cvt_pk_bf16_f32 v51, v244, v245
    v_cvt_pk_bf16_f32 v40, v246, v247
    s_waitcnt lgkmcnt(0)
    v_mfma_f32_16x16x32_bf16 v[52:55], v[44:47], v[48:51], 0
    v_mfma_f32_16x16x32_bf16 v[52:55], v[44:47], v[40:43], v[52:55]
    v_mfma_f32_16x16x32_bf16 v[208:211], v[160:163], v[48:51], 0
    v_mfma_f32_16x16x32_bf16 v[208:211], v[232:235], v[40:43], v[208:211]
    v_mfma_f32_16x16x32_bf16 v[212:215], v[164:167], v[48:51], 0
    v_mfma_f32_16x16x32_bf16 v[212:215], v[234:237], v[40:43], v[212:215]
    v_mfma_f32_16x16x32_bf16 v[216:219], v[168:171], v[48:51], 0
    v_mfma_f32_16x16x32_bf16 v[216:219], v[236:239], v[40:43], v[216:219]
    v_mfma_f32_16x16x32_bf16 v[220:223], v[172:175], v[48:51], 0
    v_mfma_f32_16x16x32_bf16 v[220:223], v[238:241], v[40:43], v[220:223]
    v_rcp_f32 v248, v52
    s_nop 0
    v_mul_f32 v208, v248, v208
    v_mul_f32 v209, v248, v209
    v_mul_f32 v210, v248, v210
    v_mul_f32 v211, v248, v211
    v_cvt_pk_bf16_f32 v224, v208, v209
    v_cvt_pk_bf16_f32 v225, v210, v211
    v_mul_f32 v212, v248, v212
    v_mul_f32 v213, v248, v213
    v_mul_f32 v214, v248, v214
    v_mul_f32 v215, v248, v215
    v_cvt_pk_bf16_f32 v226, v212, v213
    v_cvt_pk_bf16_f32 v227, v214, v215
    s_cbranch_vccnz .cp_403
    buffer_store_dwordx4 v[224:227], v2, s[8:11], s53 offen offset:0
.cb_404:
    v_mul_f32 v216, v248, v216
    v_mul_f32 v217, v248, v217
    v_mul_f32 v218, v248, v218
    v_mul_f32 v219, v248, v219
    v_cvt_pk_bf16_f32 v228, v216, v217
    v_cvt_pk_bf16_f32 v229, v218, v219
    v_mul_f32 v220, v248, v220
    v_mul_f32 v221, v248, v221
    v_mul_f32 v222, v248, v222
    v_mul_f32 v223, v248, v223
    v_cvt_pk_bf16_f32 v230, v220, v221
    v_cvt_pk_bf16_f32 v231, v222, v223
    s_cbranch_vccnz .cp_405
    buffer_store_dwordx4 v[228:231], v2, s[8:11], s53 offen offset:1024
.cb_406:
    s_add_u32 s30, s30, 1
    s_mov_b32 s53, s40
    s_waitcnt vmcnt(0)
    v_max_i32 v27, s30, v26
    s_cbranch_vccnz .cp_409
    buffer_store_dword v27, v26, s[8:11], s94 offen
.cb_410:
    s_cmp_gt_u32 s32, 63
    s_cbranch_scc1 .ndd_412
    s_mov_b32 s62, 0
.nd_411:
    buffer_load_dword v29, v7, s[8:11], s46 offen sc1
    buffer_load_dword v30, v7, s[8:11], s47 offen sc1
    s_add_u32 s62, s62, 1
    s_cmp_gt_u32 s62, 0x200000
    s_cbranch_scc1 .mg_end_1
    s_waitcnt vmcnt(0)
    v_min_u32 v29, v29, v30
    s_nop 1
    v_min_u32_dpp v29, v29, v29 quad_perm:[1,0,3,2] row_mask:0xf bank_mask:0xf
    s_nop 1
    v_min_u32_dpp v29, v29, v29 quad_perm:[2,3,0,1] row_mask:0xf bank_mask:0xf
    s_nop 1
    v_readfirstlane_b32 s32, v29
    s_lshl_b32 s55, s32, 18
    s_add_u32 s55, s55, s37
    s_cmp_gt_u32 s32, 63
    s_cbranch_scc1 .ndd_412
    s_sleep 2
    s_branch .nd_411
.ndd_412:
    s_sub_u32 s4, s36, 16777216
    s_sub_u32 s5, s43, 139264
    s_add_u32 s49, s49, 0x40000
    s_add_u32 s50, s49, 16777216
    s_add_u32 m0, s5, 0
    s_nop 0
    buffer_load_dwordx4 v2, s[8:11], s4 offen lds
    buffer_load_dwordx4 v2, s[8:11], s4 offen offset:1024 lds
    s_add_u32 m0, s5, 8192
    s_nop 0
    buffer_load_dwordx4 v2, s[8:11], s49 offen lds
    buffer_load_dwordx4 v2, s[8:11], s49 offen offset:1024 lds
    s_add_u32 m0, s5, 16384
    s_nop 0
    buffer_load_dwordx4 v2, s[8:11], s50 offen lds
    buffer_load_dwordx4 v2, s[8:11], s50 offen offset:1024 lds
    s_add_u32 s4, s4, 0x40000
    s_add_u32 s49, s49, 0x40000
    s_add_u32 s50, s49, 16777216
    s_add_u32 m0, s5, 32768
    s_nop 0
    buffer_load_dwordx4 v2, s[8:11], s4 offen lds
    buffer_load_dwordx4 v2, s[8:11], s4 offen offset:1024 lds
    s_add_u32 m0, s5, 40960
    s_nop 0
    buffer_load_dwordx4 v2, s[8:11], s49 offen lds
    buffer_load_dwordx4 v2, s[8:11], s49 offen offset:1024 lds
    s_add_u32 m0, s5, 49152
    s_nop 0
    buffer_load_dwordx4 v2, s[8:11], s50 offen lds
    buffer_load_dwordx4 v2, s[8:11], s50 offen offset:1024 lds
    s_add_u32 s4, s4, 0x40000
    s_add_u32 s49, s49, 0x40000
    s_add_u32 s50, s49, 16777216
    s_add_u32 m0, s5, 65536
    s_nop 0
    buffer_load_dwordx4 v2, s[8:11], s4 offen lds
    buffer_load_dwordx4 v2, s[8:11], s4 offen offset:1024 lds
    s_add_u32 m0, s5, 73728
    s_nop 0
    buffer_load_dwordx4 v2, s[8:11], s49 offen lds
    buffer_load_dwordx4 v2, s[8:11], s49 offen offset:1024 lds
    s_add_u32 m0, s5, 81920
    s_nop 0
    buffer_load_dwordx4 v2, s[8:11], s50 offen lds
    buffer_load_dwordx4 v2, s[8:11], s50 offen offset:1024 lds
    s_add_u32 s4, s4, 0x40000
    s_add_u32 s49, s49, 0x40000
    s_add_u32 s50, s49, 16777216
    s_add_u32 m0, s5, 98304
    s_nop 0
    buffer_load_dwordx4 v2, s[8:11], s4 offen lds
    buffer_load_dwordx4 v2, s[8:11], s4 offen offset:1024 lds
    s_add_u32 m0, s5, 106496
    s_nop 0
    buffer_load_dwordx4 v2, s[8:11], s49 offen lds
    buffer_load_dwordx4 v2, s[8:11], s49 offen offset:1024 lds
    s_add_u32 m0, s5, 114688
    s_nop 0
    buffer_load_dwordx4 v2, s[8:11], s50 offen lds
    buffer_load_dwordx4 v2, s[8:11], s50 offen offset:1024 lds
    s_add_u32 s4, s4, 0x40000
    buffer_load_dword v4, v7, s[8:11], 0 offen sc1
    v_subrev_u32 v25, 131072, v25
    v_subrev_u32 v31, 131072, v31
    v_subrev_u32 v5, 131072, v5
    s_add_u32 s48, s48, 0x20000
    s_mov_b32 s31, 0
    s_add_u32 s40, s40, 0x40000
    s_waitcnt vmcnt(19)
    s_barrier
    ds_read_b128 v[192:195], v25 offset:0
    ds_read_b128 v[128:131], v31 offset:0
    ds_read_b128 v[144:147], v31 offset:4096
    ds_read_b128 v[196:199], v25 offset:1024
    ds_read_b128 v[132:135], v31 offset:1024
    ds_read_b128 v[148:151], v31 offset:5120
    ds_read_b128 v[200:203], v25 offset:2048
    ds_read_b128 v[136:139], v31 offset:2048
    ds_read_b128 v[152:155], v31 offset:6144
    ds_read_b128 v[204:207], v25 offset:3072
    ds_read_b128 v[140:143], v31 offset:3072
    ds_read_b128 v[156:159], v31 offset:7168
    ds_read_b128 v[160:163], v5 offset:8192
    ds_read_b128 v[164:167], v5 offset:9216
    ds_read_b128 v[168:171], v5 offset:10240
    ds_read_b128 v[172:175], v5 offset:11264
    s_waitcnt lgkmcnt(4)
    v_mfma_f32_16x16x32_bf16 v[48:51], v[128:131], v[192:195], v[32:35]
    v_mfma_f32_16x16x32_bf16 v[52:55], v[144:147], v[192:195], v[36:39]
    v_mfma_f32_16x16x32_bf16 v[48:51], v[132:135], v[196:199], v[48:51]
    v_mfma_f32_16x16x32_bf16 v[52:55], v[148:151], v[196:199], v[52:55]
    v_mfma_f32_16x16x32_bf16 v[48:51], v[136:139], v[200:203], v[48:51]
    v_mfma_f32_16x16x32_bf16 v[52:55], v[152:155], v[200:203], v[52:55]
    v_mfma_f32_16x16x32_bf16 v[48:51], v[140:143], v[204:207], v[48:51]
    v_mfma_f32_16x16x32_bf16 v[52:55], v[156:159], v[204:207], v[52:55]
    s_waitcnt vmcnt(0)
    v_min_u32_dpp v4, v4, v4 quad_perm:[1,0,3,2] row_mask:0xf bank_mask:0xf
    s_nop 1
    v_min_u32_dpp v4, v4, v4 quad_perm:[2,3,0,1] row_mask:0xf bank_mask:0xf
    s_nop 1
    v_readfirstlane_b32 s33, v4
    s_cmp_eq_u32 s31, 0
    s_cbranch_scc1 .cp_422
.cb_423:
    s_waitcnt vmcnt(0)
    s_barrier
    ds_read_b128 v[176:179], v3 offset:4096
    ds_read_b128 v[180:183], v3 offset:4608
    ds_read_b128 v[184:187], v3 offset:5120
    ds_read_b128 v[188:191], v3 offset:5632
    ds_read_b32 v232, v6 offset:4096
    ds_read_b32 v234, v6 offset:4160
    ds_read_b32 v236, v6 offset:4608
    ds_read_b32 v238, v6 offset:4672
    v_max3_f32 v248, v48, v49, v50
    v_max3_f32 v248, v248, v51, v52
    v_max3_f32 v249, v53, v54, v55
    s_waitcnt lgkmcnt(4)
    v_mfma_f32_16x16x32_bf16 v[56:59], v[176:179], v[192:195], 0
    v_mfma_f32_16x16x32_bf16 v[56:59], v[180:183], v[196:199], v[56:59]
    v_mfma_f32_16x16x32_bf16 v[56:59], v[184:187], v[200:203], v[56:59]
    v_mfma_f32_16x16x32_bf16 v[56:59], v[188:191], v[204:207], v[56:59]
    s_nop 7
    v_max3_f32 v248, v248, v56, v57
    v_max_f32 v30, v248, v249
    v_max_f32 v249, v248, v249
    s_nop 1
    v_permlane16_swap_b32 v249, v30
    v_max_f32 v248, v249, v30
    v_max_f32 v249, v249, v30
    s_nop 1
    v_permlane32_swap_b32 v248, v249
    v_max_f32 v248, v248, v249
    v_mul_f32 v248, s45, v248
    v_fma_f32 v60, v48, s45, -v248
    v_fma_f32 v61, v49, s45, -v248
    v_fma_f32 v62, v50, s45, -v248
    v_fma_f32 v63, v51, s45, -v248
    v_fma_f32 v242, v52, s45, -v248
    v_fma_f32 v243, v53, s45, -v248
    v_fma_f32 v244, v54, s45, -v248
    v_fma_f32 v245, v55, s45, -v248
    v_fma_f32 v246, v56, s45, -v248
    v_fma_f32 v247, v57, s45, -v248
    v_exp_f32 v60, v60
    v_exp_f32 v61, v61
    v_exp_f32 v62, v62
    v_exp_f32 v63, v63
    v_exp_f32 v242, v242
    v_exp_f32 v243, v243
    v_exp_f32 v244, v244
    v_exp_f32 v245, v245
    v_exp_f32 v246, v246
    v_exp_f32 v247, v247
    v_cvt_pk_bf16_f32 v48, v60, v61
    v_cvt_pk_bf16_f32 v49, v62, v63
    v_cvt_pk_bf16_f32 v50, v242, v243
    v_cvt_pk_bf16_f32 v51, v244, v245
    v_cvt_pk_bf16_f32 v40, v246, v247
    s_waitcnt lgkmcnt(0)
    v_mfma_f32_16x16x32_bf16 v[52:55], v[44:47], v[48:51], 0
    v_mfma_f32_16x16x32_bf16 v[52:55], v[44:47], v[40:43], v[52:55]
    v_mfma_f32_16x16x32_bf16 v[192:195], v[160:163], v[48:51], 0
    v_mfma_f32_16x16x32_bf16 v[192:195], v[232:235], v[40:43], v[192:195]
    v_mfma_f32_16x16x32_bf16 v[196:199], v[164:167], v[48:51], 0
    v_mfma_f32_16x16x32_bf16 v[196:199], v[234:237], v[40:43], v[196:199]
    v_mfma_f32_16x16x32_bf16 v[200:203], v[168:171], v[48:51], 0
    v_mfma_f32_16x16x32_bf16 v[200:203], v[236:239], v[40:43], v[200:203]
    v_mfma_f32_16x16x32_bf16 v[204:207], v[172:175], v[48:51], 0
    v_mfma_f32_16x16x32_bf16 v[204:207], v[238:241], v[40:43], v[204:207]
    v_rcp_f32 v248, v52
    s_nop 0
    v_mul_f32 v192, v248, v192
    v_mul_f32 v193, v248, v193
    v_mul_f32 v194, v248, v194
    v_mul_f32 v195, v248, v195
    v_cvt_pk_bf16_f32 v224, v192, v193
    v_cvt_pk_bf16_f32 v225, v194, v195
    v_mul_f32 v196, v248, v196
    v_mul_f32 v197, v248, v197
    v_mul_f32 v198, v248, v198
    v_mul_f32 v199, v248, v199
    v_cvt_pk_bf16_f32 v226, v196, v197
    v_cvt_pk_bf16_f32 v227, v198, v199
    s_cbranch_vccnz .cp_418
    buffer_store_dwordx4 v[224:227], v2, s[8:11], s53 offen offset:0
.cb_419:
    v_mul_f32 v200, v248, v200
    v_mul_f32 v201, v248, v201
    v_mul_f32 v202, v248, v202
    v_mul_f32 v203, v248, v203
    v_cvt_pk_bf16_f32 v228, v200, v201
    v_cvt_pk_bf16_f32 v229, v202, v203
    v_mul_f32 v204, v248, v204
    v_mul_f32 v205, v248, v205
    v_mul_f32 v206, v248, v206
    v_mul_f32 v207, v248, v207
    v_cvt_pk_bf16_f32 v230, v204, v205
    v_cvt_pk_bf16_f32 v231, v206, v207
    s_cbranch_vccnz .cp_420
    buffer_store_dwordx4 v[228:231], v2, s[8:11], s53 offen offset:1024
.cb_421:
    buffer_load_dword v4, v7, s[8:11], 0 offen sc1
    s_add_u32 s30, s30, 1
    s_mov_b32 s53, s40
    s_waitcnt vmcnt(1)
    v_max_i32 v27, s30, v26
    s_cbranch_vccnz .cp_424
    buffer_store_dword v27, v26, s[8:11], s94 offen
.cb_425:
    v_add_u32 v25, 0x8000, v25
    v_add_u32 v31, 0x8000, v31
    v_add_u32 v5, 0x8000, v5
    s_add_u32 s48, s48, 0x20000
    s_mov_b32 s31, 0
    s_add_u32 s40, s40, 0x40000
    ds_read_b128 v[208:211], v25 offset:0
    ds_read_b128 v[128:131], v31 offset:0
    ds_read_b128 v[144:147], v31 offset:4096
    ds_read_b128 v[212:215], v25 offset:1024
    ds_read_b128 v[132:135], v31 offset:1024
    ds_read_b128 v[148:151], v31 offset:5120
    ds_read_b128 v[216:219], v25 offset:2048
    ds_read_b128 v[136:139], v31 offset:2048
    ds_read_b128 v[152:155], v31 offset:6144
    ds_read_b128 v[220:223], v25 offset:3072
    ds_read_b128 v[140:143], v31 offset:3072
    ds_read_b128 v[156:159], v31 offset:7168
    ds_read_b128 v[160:163], v5 offset:8192
    ds_read_b128 v[164:167], v5 offset:9216
    ds_read_b128 v[168:171], v5 offset:10240
    ds_read_b128 v[172:175], v5 offset:11264
    s_waitcnt lgkmcnt(4)
    v_mfma_f32_16x16x32_bf16 v[48:51], v[128:131], v[208:211], v[32:35]
    v_mfma_f32_16x16x32_bf16 v[52:55], v[144:147], v[208:211], v[36:39]
    v_mfma_f32_16x16x32_bf16 v[48:51], v[132:135], v[212:215], v[48:51]
    v_mfma_f32_16x16x32_bf16 v[52:55], v[148:151], v[212:215], v[52:55]
    v_mfma_f32_16x16x32_bf16 v[48:51], v[136:139], v[216:219], v[48:51]
    v_mfma_f32_16x16x32_bf16 v[52:55], v[152:155], v[216:219], v[52:55]
    v_mfma_f32_16x16x32_bf16 v[48:51], v[140:143], v[220:223], v[48:51]
    v_mfma_f32_16x16x32_bf16 v[52:55], v[156:159], v[220:223], v[52:55]
    s_waitcnt vmcnt(1)
    v_min_u32_dpp v4, v4, v4 quad_perm:[1,0,3,2] row_mask:0xf bank_mask:0xf
    s_nop 1
    v_min_u32_dpp v4, v4, v4 quad_perm:[2,3,0,1] row_mask:0xf bank_mask:0xf
    s_nop 1
    v_readfirstlane_b32 s33, v4
    s_cmp_eq_u32 s31, 0
    s_cbranch_scc1 .cp_435
.cb_436:
    s_waitcnt vmcnt(0)
    s_barrier
    ds_read_b128 v[176:179], v3 offset:0
    ds_read_b128 v[180:183], v3 offset:512
    ds_read_b128 v[184:187], v3 offset:1024
    ds_read_b128 v[188:191], v3 offset:1536
    ds_read_b32 v232, v6 offset:0
    ds_read_b32 v234, v6 offset:64
    ds_read_b32 v236, v6 offset:512
    ds_read_b32 v238, v6 offset:576
    v_max3_f32 v248, v48, v49, v50
    v_max3_f32 v248, v248, v51, v52
    v_max3_f32 v249, v53, v54, v55
    s_waitcnt lgkmcnt(4)
    v_mfma_f32_16x16x32_bf16 v[56:59], v[176:179], v[208:211], 0
    v_mfma_f32_16x16x32_bf16 v[56:59], v[180:183], v[212:215], v[56:59]
    v_mfma_f32_16x16x32_bf16 v[56:59], v[184:187], v[216:219], v[56:59]
    v_mfma_f32_16x16x32_bf16 v[56:59], v[188:191], v[220:223], v[56:59]
    s_nop 7
    v_max3_f32 v248, v248, v56, v57
    v_max_f32 v30, v248, v249
    v_max_f32 v249, v248, v249
    s_nop 1
    v_permlane16_swap_b32 v249, v30
    v_max_f32 v248, v249, v30
    v_max_f32 v249, v249, v30
    s_nop 1
    v_permlane32_swap_b32 v248, v249
    v_max_f32 v248, v248, v249
    v_mul_f32 v248, s45, v248
    v_fma_f32 v60, v48, s45, -v248
    v_fma_f32 v61, v49, s45, -v248
    v_fma_f32 v62, v50, s45, -v248
    v_fma_f32 v63, v51, s45, -v248
    v_fma_f32 v242, v52, s45, -v248
    v_fma_f32 v243, v53, s45, -v248
    v_fma_f32 v244, v54, s45, -v248
    v_fma_f32 v245, v55, s45, -v248
    v_fma_f32 v246, v56, s45, -v248
    v_fma_f32 v247, v57, s45, -v248
    v_exp_f32 v60, v60
    v_exp_f32 v61, v61
    v_exp_f32 v62, v62
    v_exp_f32 v63, v63
    v_exp_f32 v242, v242
    v_exp_f32 v243, v243
    v_exp_f32 v244, v244
    v_exp_f32 v245, v245
    v_exp_f32 v246, v246
    v_exp_f32 v247, v247
    v_cvt_pk_bf16_f32 v48, v60, v61
    v_cvt_pk_bf16_f32 v49, v62, v63
    v_cvt_pk_bf16_f32 v50, v242, v243
    v_cvt_pk_bf16_f32 v51, v244, v245
    v_cvt_pk_bf16_f32 v40, v246, v247
    s_waitcnt lgkmcnt(0)
    v_mfma_f32_16x16x32_bf16 v[52:55], v[44:47], v[48:51], 0
    v_mfma_f32_16x16x32_bf16 v[52:55], v[44:47], v[40:43], v[52:55]
    v_mfma_f32_16x16x32_bf16 v[208:211], v[160:163], v[48:51], 0
    v_mfma_f32_16x16x32_bf16 v[208:211], v[232:235], v[40:43], v[208:211]
    v_mfma_f32_16x16x32_bf16 v[212:215], v[164:167], v[48:51], 0
    v_mfma_f32_16x16x32_bf16 v[212:215], v[234:237], v[40:43], v[212:215]
    v_mfma_f32_16x16x32_bf16 v[216:219], v[168:171], v[48:51], 0
    v_mfma_f32_16x16x32_bf16 v[216:219], v[236:239], v[40:43], v[216:219]
    v_mfma_f32_16x16x32_bf16 v[220:223], v[172:175], v[48:51], 0
    v_mfma_f32_16x16x32_bf16 v[220:223], v[238:241], v[40:43], v[220:223]
    v_rcp_f32 v248, v52
    s_nop 0
    v_mul_f32 v208, v248, v208
    v_mul_f32 v209, v248, v209
    v_mul_f32 v210, v248, v210
    v_mul_f32 v211, v248, v211
    v_cvt_pk_bf16_f32 v224, v208, v209
    v_cvt_pk_bf16_f32 v225, v210, v211
    v_mul_f32 v212, v248, v212
    v_mul_f32 v213, v248, v213
    v_mul_f32 v214, v248, v214
    v_mul_f32 v215, v248, v215
    v_cvt_pk_bf16_f32 v226, v212, v213
    v_cvt_pk_bf16_f32 v227, v214, v215
    s_cbranch_vccnz .cp_431
    buffer_store_dwordx4 v[224:227], v2, s[8:11], s53 offen offset:0
.cb_432:
    v_mul_f32 v216, v248, v216
    v_mul_f32 v217, v248, v217
    v_mul_f32 v218, v248, v218
    v_mul_f32 v219, v248, v219
    v_cvt_pk_bf16_f32 v228, v216, v217
    v_cvt_pk_bf16_f32 v229, v218, v219
    v_mul_f32 v220, v248, v220
    v_mul_f32 v221, v248, v221
    v_mul_f32 v222, v248, v222
    v_mul_f32 v223, v248, v223
    v_cvt_pk_bf16_f32 v230, v220, v221
    v_cvt_pk_bf16_f32 v231, v222, v223
    s_cbranch_vccnz .cp_433
    buffer_store_dwordx4 v[228:231], v2, s[8:11], s53 offen offset:1024
.cb_434:
    buffer_load_dword v4, v7, s[8:11], 0 offen sc1
    s_add_u32 s30, s30, 1
    s_mov_b32 s53, s40
    s_waitcnt vmcnt(1)
    v_max_i32 v27, s30, v26
    s_cbranch_vccnz .cp_437
    buffer_store_dword v27, v26, s[8:11], s94 offen
.cb_438:
    v_add_u32 v25, 0x8000, v25
    v_add_u32 v31, 0x8000, v31
    v_add_u32 v5, 0x8000, v5
    s_add_u32 s48, s48, 0x20000
    s_mov_b32 s31, 0
    s_add_u32 s40, s40, 0x40000
    ds_read_b128 v[192:195], v25 offset:0
    ds_read_b128 v[128:131], v31 offset:0
    ds_read_b128 v[144:147], v31 offset:4096
    ds_read_b128 v[196:199], v25 offset:1024
    ds_read_b128 v[132:135], v31 offset:1024
    ds_read_b128 v[148:151], v31 offset:5120
    ds_read_b128 v[200:203], v25 offset:2048
    ds_read_b128 v[136:139], v31 offset:2048
    ds_read_b128 v[152:155], v31 offset:6144
    ds_read_b128 v[204:207], v25 offset:3072
    ds_read_b128 v[140:143], v31 offset:3072
    ds_read_b128 v[156:159], v31 offset:7168
    ds_read_b128 v[160:163], v5 offset:8192
    ds_read_b128 v[164:167], v5 offset:9216
    ds_read_b128 v[168:171], v5 offset:10240
    ds_read_b128 v[172:175], v5 offset:11264
    s_waitcnt lgkmcnt(4)
    v_mfma_f32_16x16x32_bf16 v[48:51], v[128:131], v[192:195], v[32:35]
    v_mfma_f32_16x16x32_bf16 v[52:55], v[144:147], v[192:195], v[36:39]
    v_mfma_f32_16x16x32_bf16 v[48:51], v[132:135], v[196:199], v[48:51]
    v_mfma_f32_16x16x32_bf16 v[52:55], v[148:151], v[196:199], v[52:55]
    v_mfma_f32_16x16x32_bf16 v[48:51], v[136:139], v[200:203], v[48:51]
    v_mfma_f32_16x16x32_bf16 v[52:55], v[152:155], v[200:203], v[52:55]
    v_mfma_f32_16x16x32_bf16 v[48:51], v[140:143], v[204:207], v[48:51]
    v_mfma_f32_16x16x32_bf16 v[52:55], v[156:159], v[204:207], v[52:55]
    s_waitcnt vmcnt(1)
    v_min_u32_dpp v4, v4, v4 quad_perm:[1,0,3,2] row_mask:0xf bank_mask:0xf
    s_nop 1
    v_min_u32_dpp v4, v4, v4 quad_perm:[2,3,0,1] row_mask:0xf bank_mask:0xf
    s_nop 1
    v_readfirstlane_b32 s33, v4
    s_cmp_eq_u32 s31, 0
    s_cbranch_scc1 .cp_448
.cb_449:
    s_waitcnt vmcnt(0)
    s_barrier
    ds_read_b128 v[176:179], v3 offset:4096
    ds_read_b128 v[180:183], v3 offset:4608
    ds_read_b128 v[184:187], v3 offset:5120
    ds_read_b128 v[188:191], v3 offset:5632
    ds_read_b32 v232, v6 offset:4096
    ds_read_b32 v234, v6 offset:4160
    ds_read_b32 v236, v6 offset:4608
    ds_read_b32 v238, v6 offset:4672
    v_max3_f32 v248, v48, v49, v50
    v_max3_f32 v248, v248, v51, v52
    v_max3_f32 v249, v53, v54, v55
    s_waitcnt lgkmcnt(4)
    v_mfma_f32_16x16x32_bf16 v[56:59], v[176:179], v[192:195], 0
    v_mfma_f32_16x16x32_bf16 v[56:59], v[180:183], v[196:199], v[56:59]
    v_mfma_f32_16x16x32_bf16 v[56:59], v[184:187], v[200:203], v[56:59]
    v_mfma_f32_16x16x32_bf16 v[56:59], v[188:191], v[204:207], v[56:59]
    s_nop 7
    v_max3_f32 v248, v248, v56, v57
    v_max_f32 v30, v248, v249
    v_max_f32 v249, v248, v249
    s_nop 1
    v_permlane16_swap_b32 v249, v30
    v_max_f32 v248, v249, v30
    v_max_f32 v249, v249, v30
    s_nop 1
    v_permlane32_swap_b32 v248, v249
    v_max_f32 v248, v248, v249
    v_mul_f32 v248, s45, v248
    v_fma_f32 v60, v48, s45, -v248
    v_fma_f32 v61, v49, s45, -v248
    v_fma_f32 v62, v50, s45, -v248
    v_fma_f32 v63, v51, s45, -v248
    v_fma_f32 v242, v52, s45, -v248
    v_fma_f32 v243, v53, s45, -v248
    v_fma_f32 v244, v54, s45, -v248
    v_fma_f32 v245, v55, s45, -v248
    v_fma_f32 v246, v56, s45, -v248
    v_fma_f32 v247, v57, s45, -v248
    v_exp_f32 v60, v60
    v_exp_f32 v61, v61
    v_exp_f32 v62, v62
    v_exp_f32 v63, v63
    v_exp_f32 v242, v242
    v_exp_f32 v243, v243
    v_exp_f32 v244, v244
    v_exp_f32 v245, v245
    v_exp_f32 v246, v246
    v_exp_f32 v247, v247
    v_cvt_pk_bf16_f32 v48, v60, v61
    v_cvt_pk_bf16_f32 v49, v62, v63
    v_cvt_pk_bf16_f32 v50, v242, v243
    v_cvt_pk_bf16_f32 v51, v244, v245
    v_cvt_pk_bf16_f32 v40, v246, v247
    s_waitcnt lgkmcnt(0)
    v_mfma_f32_16x16x32_bf16 v[52:55], v[44:47], v[48:51], 0
    v_mfma_f32_16x16x32_bf16 v[52:55], v[44:47], v[40:43], v[52:55]
    v_mfma_f32_16x16x32_bf16 v[192:195], v[160:163], v[48:51], 0
    v_mfma_f32_16x16x32_bf16 v[192:195], v[232:235], v[40:43], v[192:195]
    v_mfma_f32_16x16x32_bf16 v[196:199], v[164:167], v[48:51], 0
    v_mfma_f32_16x16x32_bf16 v[196:199], v[234:237], v[40:43], v[196:199]
    v_mfma_f32_16x16x32_bf16 v[200:203], v[168:171], v[48:51], 0
    v_mfma_f32_16x16x32_bf16 v[200:203], v[236:239], v[40:43], v[200:203]
    v_mfma_f32_16x16x32_bf16 v[204:207], v[172:175], v[48:51], 0
    v_mfma_f32_16x16x32_bf16 v[204:207], v[238:241], v[40:43], v[204:207]
    v_rcp_f32 v248, v52
    s_nop 0
    v_mul_f32 v192, v248, v192
    v_mul_f32 v193, v248, v193
    v_mul_f32 v194, v248, v194
    v_mul_f32 v195, v248, v195
    v_cvt_pk_bf16_f32 v224, v192, v193
    v_cvt_pk_bf16_f32 v225, v194, v195
    v_mul_f32 v196, v248, v196
    v_mul_f32 v197, v248, v197
    v_mul_f32 v198, v248, v198
    v_mul_f32 v199, v248, v199
    v_cvt_pk_bf16_f32 v226, v196, v197
    v_cvt_pk_bf16_f32 v227, v198, v199
    s_cbranch_vccnz .cp_444
    buffer_store_dwordx4 v[224:227], v2, s[8:11], s53 offen offset:0
.cb_445:
    v_mul_f32 v200, v248, v200
    v_mul_f32 v201, v248, v201
    v_mul_f32 v202, v248, v202
    v_mul_f32 v203, v248, v203
    v_cvt_pk_bf16_f32 v228, v200, v201
    v_cvt_pk_bf16_f32 v229, v202, v203
    v_mul_f32 v204, v248, v204
    v_mul_f32 v205, v248, v205
    v_mul_f32 v206, v248, v206
    v_mul_f32 v207, v248, v207
    v_cvt_pk_bf16_f32 v230, v204, v205
    v_cvt_pk_bf16_f32 v231, v206, v207
    s_cbranch_vccnz .cp_446
    buffer_store_dwordx4 v[228:231], v2, s[8:11], s53 offen offset:1024
.cb_447:
    buffer_load_dword v4, v7, s[8:11], 0 offen sc1
    s_add_u32 s30, s30, 1
    s_mov_b32 s53, s40
    s_waitcnt vmcnt(1)
    v_max_i32 v27, s30, v26
    s_cbranch_vccnz .cp_450
    buffer_store_dword v27, v26, s[8:11], s94 offen
.cb_451:
    v_add_u32 v25, 0x8000, v25
    v_add_u32 v31, 0x8000, v31
    v_add_u32 v5, 0x8000, v5
    s_add_u32 s48, s48, 0x20000
    s_mov_b32 s31, 0
    s_add_u32 s40, s40, 0x40000
    ds_read_b128 v[208:211], v25 offset:0
    ds_read_b128 v[128:131], v31 offset:0
    ds_read_b128 v[144:147], v31 offset:4096
    ds_read_b128 v[212:215], v25 offset:1024
    ds_read_b128 v[132:135], v31 offset:1024
    ds_read_b128 v[148:151], v31 offset:5120
    ds_read_b128 v[216:219], v25 offset:2048
    ds_read_b128 v[136:139], v31 offset:2048
    ds_read_b128 v[152:155], v31 offset:6144
    ds_read_b128 v[220:223], v25 offset:3072
    ds_read_b128 v[140:143], v31 offset:3072
    ds_read_b128 v[156:159], v31 offset:7168
    ds_read_b128 v[160:163], v5 offset:8192
    ds_read_b128 v[164:167], v5 offset:9216
    ds_read_b128 v[168:171], v5 offset:10240
    ds_read_b128 v[172:175], v5 offset:11264
    s_waitcnt lgkmcnt(4)
    v_mfma_f32_16x16x32_bf16 v[48:51], v[128:131], v[208:211], v[32:35]
    v_mfma_f32_16x16x32_bf16 v[52:55], v[144:147], v[208:211], v[36:39]
    v_mfma_f32_16x16x32_bf16 v[48:51], v[132:135], v[212:215], v[48:51]
    v_mfma_f32_16x16x32_bf16 v[52:55], v[148:151], v[212:215], v[52:55]
    v_mfma_f32_16x16x32_bf16 v[48:51], v[136:139], v[216:219], v[48:51]
    v_mfma_f32_16x16x32_bf16 v[52:55], v[152:155], v[216:219], v[52:55]
    v_mfma_f32_16x16x32_bf16 v[48:51], v[140:143], v[220:223], v[48:51]
    v_mfma_f32_16x16x32_bf16 v[52:55], v[156:159], v[220:223], v[52:55]
    s_waitcnt vmcnt(1)
    v_min_u32_dpp v4, v4, v4 quad_perm:[1,0,3,2] row_mask:0xf bank_mask:0xf
    s_nop 1
    v_min_u32_dpp v4, v4, v4 quad_perm:[2,3,0,1] row_mask:0xf bank_mask:0xf
    s_nop 1
    v_readfirstlane_b32 s33, v4
    s_cmp_eq_u32 s31, 0
    s_cbranch_scc1 .cp_461
.cb_462:
    s_waitcnt vmcnt(0)
    s_barrier
    ds_read_b128 v[176:179], v3 offset:0
    ds_read_b128 v[180:183], v3 offset:512
    ds_read_b128 v[184:187], v3 offset:1024
    ds_read_b128 v[188:191], v3 offset:1536
    ds_read_b32 v232, v6 offset:0
    ds_read_b32 v234, v6 offset:64
    ds_read_b32 v236, v6 offset:512
    ds_read_b32 v238, v6 offset:576
    v_max3_f32 v248, v48, v49, v50
    v_max3_f32 v248, v248, v51, v52
    v_max3_f32 v249, v53, v54, v55
    s_waitcnt lgkmcnt(4)
    v_mfma_f32_16x16x32_bf16 v[56:59], v[176:179], v[208:211], 0
    v_mfma_f32_16x16x32_bf16 v[56:59], v[180:183], v[212:215], v[56:59]
    v_mfma_f32_16x16x32_bf16 v[56:59], v[184:187], v[216:219], v[56:59]
    v_mfma_f32_16x16x32_bf16 v[56:59], v[188:191], v[220:223], v[56:59]
    s_nop 7
    v_max3_f32 v248, v248, v56, v57
    v_max_f32 v30, v248, v249
    v_max_f32 v249, v248, v249
    s_nop 1
    v_permlane16_swap_b32 v249, v30
    v_max_f32 v248, v249, v30
    v_max_f32 v249, v249, v30
    s_nop 1
    v_permlane32_swap_b32 v248, v249
    v_max_f32 v248, v248, v249
    v_mul_f32 v248, s45, v248
    v_fma_f32 v60, v48, s45, -v248
    v_fma_f32 v61, v49, s45, -v248
    v_fma_f32 v62, v50, s45, -v248
    v_fma_f32 v63, v51, s45, -v248
    v_fma_f32 v242, v52, s45, -v248
    v_fma_f32 v243, v53, s45, -v248
    v_fma_f32 v244, v54, s45, -v248
    v_fma_f32 v245, v55, s45, -v248
    v_fma_f32 v246, v56, s45, -v248
    v_fma_f32 v247, v57, s45, -v248
    v_exp_f32 v60, v60
    v_exp_f32 v61, v61
    v_exp_f32 v62, v62
    v_exp_f32 v63, v63
    v_exp_f32 v242, v242
    v_exp_f32 v243, v243
    v_exp_f32 v244, v244
    v_exp_f32 v245, v245
    v_exp_f32 v246, v246
    v_exp_f32 v247, v247
    v_cvt_pk_bf16_f32 v48, v60, v61
    v_cvt_pk_bf16_f32 v49, v62, v63
    v_cvt_pk_bf16_f32 v50, v242, v243
    v_cvt_pk_bf16_f32 v51, v244, v245
    v_cvt_pk_bf16_f32 v40, v246, v247
    s_waitcnt lgkmcnt(0)
    v_mfma_f32_16x16x32_bf16 v[52:55], v[44:47], v[48:51], 0
    v_mfma_f32_16x16x32_bf16 v[52:55], v[44:47], v[40:43], v[52:55]
    v_mfma_f32_16x16x32_bf16 v[208:211], v[160:163], v[48:51], 0
    v_mfma_f32_16x16x32_bf16 v[208:211], v[232:235], v[40:43], v[208:211]
    v_mfma_f32_16x16x32_bf16 v[212:215], v[164:167], v[48:51], 0
    v_mfma_f32_16x16x32_bf16 v[212:215], v[234:237], v[40:43], v[212:215]
    v_mfma_f32_16x16x32_bf16 v[216:219], v[168:171], v[48:51], 0
    v_mfma_f32_16x16x32_bf16 v[216:219], v[236:239], v[40:43], v[216:219]
    v_mfma_f32_16x16x32_bf16 v[220:223], v[172:175], v[48:51], 0
    v_mfma_f32_16x16x32_bf16 v[220:223], v[238:241], v[40:43], v[220:223]
    v_rcp_f32 v248, v52
    s_nop 0
    v_mul_f32 v208, v248, v208
    v_mul_f32 v209, v248, v209
    v_mul_f32 v210, v248, v210
    v_mul_f32 v211, v248, v211
    v_cvt_pk_bf16_f32 v224, v208, v209
    v_cvt_pk_bf16_f32 v225, v210, v211
    v_mul_f32 v212, v248, v212
    v_mul_f32 v213, v248, v213
    v_mul_f32 v214, v248, v214
    v_mul_f32 v215, v248, v215
    v_cvt_pk_bf16_f32 v226, v212, v213
    v_cvt_pk_bf16_f32 v227, v214, v215
    s_cbranch_vccnz .cp_457
    buffer_store_dwordx4 v[224:227], v2, s[8:11], s53 offen offset:0
.cb_458:
    v_mul_f32 v216, v248, v216
    v_mul_f32 v217, v248, v217
    v_mul_f32 v218, v248, v218
    v_mul_f32 v219, v248, v219
    v_cvt_pk_bf16_f32 v228, v216, v217
    v_cvt_pk_bf16_f32 v229, v218, v219
    v_mul_f32 v220, v248, v220
    v_mul_f32 v221, v248, v221
    v_mul_f32 v222, v248, v222
    v_mul_f32 v223, v248, v223
    v_cvt_pk_bf16_f32 v230, v220, v221
    v_cvt_pk_bf16_f32 v231, v222, v223
    s_cbranch_vccnz .cp_459
    buffer_store_dwordx4 v[228:231], v2, s[8:11], s53 offen offset:1024
.cb_460:
    s_add_u32 s30, s30, 1
    s_mov_b32 s53, s40
    s_waitcnt vmcnt(0)
    v_max_i32 v27, s30, v26
    s_cbranch_vccnz .cp_463
    buffer_store_dword v27, v26, s[8:11], s94 offen
.cb_464:
    s_endpgm
.cp_369:
    buffer_store_dwordx4 v[224:227], v2, s[8:11], s53 offen offset:0 sc1
    s_branch .cb_370
.cp_371:
    buffer_store_dwordx4 v[228:231], v2, s[8:11], s53 offen offset:1024 sc1
    s_branch .cb_372
.cp_373:
    buffer_store_dword v27, v26, s[8:11], s94 offen sc1
    s_branch .cb_374
.cp_375:
    s_cmp_gt_u32 s32, s42
    s_cbranch_scc1 .ndd_466
    s_mov_b32 s62, 0
.nd_465:
    buffer_load_dword v29, v7, s[8:11], s46 offen sc1
    buffer_load_dword v30, v7, s[8:11], s47 offen sc1
    s_add_u32 s62, s62, 1
    s_cmp_gt_u32 s62, 0x200000
    s_cbranch_scc1 .mg_end_1
    s_waitcnt vmcnt(0)
    v_min_u32 v29, v29, v30
    s_nop 1
    v_min_u32_dpp v29, v29, v29 quad_perm:[1,0,3,2] row_mask:0xf bank_mask:0xf
    s_nop 1
    v_min_u32_dpp v29, v29, v29 quad_perm:[2,3,0,1] row_mask:0xf bank_mask:0xf
    s_nop 1
    v_readfirstlane_b32 s32, v29
    s_lshl_b32 s55, s32, 18
    s_add_u32 s55, s55, s37
    s_cmp_gt_u32 s32, s42
    s_cbranch_scc1 .ndd_466
    s_sleep 2
    s_branch .nd_465
.ndd_466:
    s_branch .cb_376
.cp_377:
    s_cmp_gt_u32 s33, s30
    s_cbranch_scc1 .ndd_468
    s_mov_b32 s62, 0
.nd_467:
    buffer_load_dword v4, v7, s[8:11], 0 offen sc1
    s_add_u32 s62, s62, 1
    s_cmp_gt_u32 s62, 0x200000
    s_cbranch_scc1 .mg_end_1
    s_waitcnt vmcnt(0)
    v_min_u32_dpp v4, v4, v4 quad_perm:[1,0,3,2] row_mask:0xf bank_mask:0xf
    s_nop 1
    v_min_u32_dpp v4, v4, v4 quad_perm:[2,3,0,1] row_mask:0xf bank_mask:0xf
    s_nop 1
    v_readfirstlane_b32 s33, v4
    s_cmp_gt_u32 s33, s30
    s_cbranch_scc1 .ndd_468
    s_sleep 2
    s_branch .nd_467
.ndd_468:
    s_add_u32 m0, s52, 0
    s_nop 0
    buffer_load_dwordx4 v2, s[8:11], s48 offen lds
    s_waitcnt vmcnt(0)
    s_branch .cb_378
.pp_379:
    buffer_load_dword v4, v7, s[8:11], 0 offen sc1
    s_mov_b32 s31, 0
    s_branch .pb_380
.cp_381:
    s_waitcnt vmcnt(1)
    v_min_u32_dpp v4, v4, v4 quad_perm:[1,0,3,2] row_mask:0xf bank_mask:0xf
    s_nop 1
    v_min_u32_dpp v4, v4, v4 quad_perm:[2,3,0,1] row_mask:0xf bank_mask:0xf
    s_nop 1
    v_readfirstlane_b32 s33, v4
    s_cmp_gt_u32 s33, s42
    s_cbranch_scc0 .cb_382
    s_mov_b32 s31, 1
    s_add_u32 m0, s52, 4096
    s_nop 0
    buffer_load_dwordx4 v2, s[8:11], s48 offen lds
    s_branch .cb_382
.cp_383:
    buffer_store_dwordx4 v[224:227], v2, s[8:11], s53 offen offset:0 sc1
    s_branch .cb_384
.cp_385:
    buffer_store_dwordx4 v[228:231], v2, s[8:11], s53 offen offset:1024 sc1
    s_branch .cb_386
.cp_387:
    buffer_store_dword v27, v26, s[8:11], s94 offen sc1
    s_branch .cb_388
.cp_389:
    s_cmp_gt_u32 s32, s42
    s_cbranch_scc1 .ndd_470
    s_mov_b32 s62, 0
.nd_469:
    buffer_load_dword v29, v7, s[8:11], s46 offen sc1
    buffer_load_dword v30, v7, s[8:11], s47 offen sc1
    s_add_u32 s62, s62, 1
    s_cmp_gt_u32 s62, 0x200000
    s_cbranch_scc1 .mg_end_1
    s_waitcnt vmcnt(0)
    v_min_u32 v29, v29, v30
    s_nop 1
    v_min_u32_dpp v29, v29, v29 quad_perm:[1,0,3,2] row_mask:0xf bank_mask:0xf
    s_nop 1
    v_min_u32_dpp v29, v29, v29 quad_perm:[2,3,0,1] row_mask:0xf bank_mask:0xf
    s_nop 1
    v_readfirstlane_b32 s32, v29
    s_lshl_b32 s55, s32, 18
    s_add_u32 s55, s55, s37
    s_cmp_gt_u32 s32, s42
    s_cbranch_scc1 .ndd_470
    s_sleep 2
    s_branch .nd_469
.ndd_470:
    s_branch .cb_390
.cp_391:
    s_cmp_gt_u32 s33, s30
    s_cbranch_scc1 .ndd_472
    s_mov_b32 s62, 0
.nd_471:
    buffer_load_dword v4, v7, s[8:11], 0 offen sc1
    s_add_u32 s62, s62, 1
    s_cmp_gt_u32 s62, 0x200000
    s_cbranch_scc1 .mg_end_1
    s_waitcnt vmcnt(0)
    v_min_u32_dpp v4, v4, v4 quad_perm:[1,0,3,2] row_mask:0xf bank_mask:0xf
    s_nop 1
    v_min_u32_dpp v4, v4, v4 quad_perm:[2,3,0,1] row_mask:0xf bank_mask:0xf
    s_nop 1
    v_readfirstlane_b32 s33, v4
    s_cmp_gt_u32 s33, s30
    s_cbranch_scc1 .ndd_472
    s_sleep 2
    s_branch .nd_471
.ndd_472:
    s_add_u32 m0, s52, 4096
    s_nop 0
    buffer_load_dwordx4 v2, s[8:11], s48 offen lds
    s_waitcnt vmcnt(0)
    s_branch .cb_392
.pp_393:
    buffer_load_dword v4, v7, s[8:11], 0 offen sc1
    s_mov_b32 s31, 0
    s_branch .pb_394
.cp_395:
    s_waitcnt vmcnt(1)
    v_min_u32_dpp v4, v4, v4 quad_perm:[1,0,3,2] row_mask:0xf bank_mask:0xf
    s_nop 1
    v_min_u32_dpp v4, v4, v4 quad_perm:[2,3,0,1] row_mask:0xf bank_mask:0xf
    s_nop 1
    v_readfirstlane_b32 s33, v4
    s_cmp_gt_u32 s33, s42
    s_cbranch_scc0 .cb_396
    s_mov_b32 s31, 1
    s_add_u32 m0, s52, 0
    s_nop 0
    buffer_load_dwordx4 v2, s[8:11], s48 offen lds
    s_branch .cb_396
.cp_397:
    buffer_store_dword v27, v26, s[8:11], s94 offen sc1
    s_branch .cb_398
.cp_403:
    buffer_store_dwordx4 v[224:227], v2, s[8:11], s53 offen offset:0 sc1
    s_branch .cb_404
.cp_405:
    buffer_store_dwordx4 v[228:231], v2, s[8:11], s53 offen offset:1024 sc1
    s_branch .cb_406
.cp_407:
    s_cmp_gt_u32 s33, s30
    s_cbranch_scc1 .ndd_474
    s_mov_b32 s62, 0
.nd_473:
    buffer_load_dword v4, v7, s[8:11], 0 offen sc1
    s_add_u32 s62, s62, 1
    s_cmp_gt_u32 s62, 0x200000
    s_cbranch_scc1 .mg_end_1
    s_waitcnt vmcnt(0)
    v_min_u32_dpp v4, v4, v4 quad_perm:[1,0,3,2] row_mask:0xf bank_mask:0xf
    s_nop 1
    v_min_u32_dpp v4, v4, v4 quad_perm:[2,3,0,1] row_mask:0xf bank_mask:0xf
    s_nop 1
    v_readfirstlane_b32 s33, v4
    s_cmp_gt_u32 s33, s30
    s_cbranch_scc1 .ndd_474
    s_sleep 2
    s_branch .nd_473
.ndd_474:
    s_add_u32 m0, s52, 0
    s_nop 0
    buffer_load_dwordx4 v2, s[8:11], s48 offen lds
    s_waitcnt vmcnt(0)
    s_branch .cb_408
.cp_409:
    buffer_store_dword v27, v26, s[8:11], s94 offen sc1
    s_branch .cb_410
.cp_418:
    buffer_store_dwordx4 v[224:227], v2, s[8:11], s53 offen offset:0 sc1
    s_branch .cb_419
.cp_420:
    buffer_store_dwordx4 v[228:231], v2, s[8:11], s53 offen offset:1024 sc1
    s_branch .cb_421
.cp_422:
    s_cmp_gt_u32 s33, s30
    s_cbranch_scc1 .ndd_476
    s_mov_b32 s62, 0
.nd_475:
    buffer_load_dword v4, v7, s[8:11], 0 offen sc1
    s_add_u32 s62, s62, 1
    s_cmp_gt_u32 s62, 0x200000
    s_cbranch_scc1 .mg_end_1
    s_waitcnt vmcnt(0)
    v_min_u32_dpp v4, v4, v4 quad_perm:[1,0,3,2] row_mask:0xf bank_mask:0xf
    s_nop 1
    v_min_u32_dpp v4, v4, v4 quad_perm:[2,3,0,1] row_mask:0xf bank_mask:0xf
    s_nop 1
    v_readfirstlane_b32 s33, v4
    s_cmp_gt_u32 s33, s30
    s_cbranch_scc1 .ndd_476
    s_sleep 2
    s_branch .nd_475
.ndd_476:
    s_add_u32 m0, s52, 4096
    s_nop 0
    buffer_load_dwordx4 v2, s[8:11], s48 offen lds
    s_waitcnt vmcnt(0)
    s_branch .cb_423
.cp_424:
    buffer_store_dword v27, v26, s[8:11], s94 offen sc1
    s_branch .cb_425
.cp_431:
    buffer_store_dwordx4 v[224:227], v2, s[8:11], s53 offen offset:0 sc1
    s_branch .cb_432
.cp_433:
    buffer_store_dwordx4 v[228:231], v2, s[8:11], s53 offen offset:1024 sc1
    s_branch .cb_434
.cp_435:
    s_cmp_gt_u32 s33, s30
    s_cbranch_scc1 .ndd_478
    s_mov_b32 s62, 0
.nd_477:
    buffer_load_dword v4, v7, s[8:11], 0 offen sc1
    s_add_u32 s62, s62, 1
    s_cmp_gt_u32 s62, 0x200000
    s_cbranch_scc1 .mg_end_1
    s_waitcnt vmcnt(0)
    v_min_u32_dpp v4, v4, v4 quad_perm:[1,0,3,2] row_mask:0xf bank_mask:0xf
    s_nop 1
    v_min_u32_dpp v4, v4, v4 quad_perm:[2,3,0,1] row_mask:0xf bank_mask:0xf
    s_nop 1
    v_readfirstlane_b32 s33, v4
    s_cmp_gt_u32 s33, s30
    s_cbranch_scc1 .ndd_478
    s_sleep 2
    s_branch .nd_477
.ndd_478:
    s_add_u32 m0, s52, 0
    s_nop 0
    buffer_load_dwordx4 v2, s[8:11], s48 offen lds
    s_waitcnt vmcnt(0)
    s_branch .cb_436
.cp_437:
    buffer_store_dword v27, v26, s[8:11], s94 offen sc1
    s_branch .cb_438
.cp_444:
    buffer_store_dwordx4 v[224:227], v2, s[8:11], s53 offen offset:0 sc1
    s_branch .cb_445
.cp_446:
    buffer_store_dwordx4 v[228:231], v2, s[8:11], s53 offen offset:1024 sc1
    s_branch .cb_447
.cp_448:
    s_cmp_gt_u32 s33, s30
    s_cbranch_scc1 .ndd_480
    s_mov_b32 s62, 0
.nd_479:
    buffer_load_dword v4, v7, s[8:11], 0 offen sc1
    s_add_u32 s62, s62, 1
    s_cmp_gt_u32 s62, 0x200000
    s_cbranch_scc1 .mg_end_1
    s_waitcnt vmcnt(0)
    v_min_u32_dpp v4, v4, v4 quad_perm:[1,0,3,2] row_mask:0xf bank_mask:0xf
    s_nop 1
    v_min_u32_dpp v4, v4, v4 quad_perm:[2,3,0,1] row_mask:0xf bank_mask:0xf
    s_nop 1
    v_readfirstlane_b32 s33, v4
    s_cmp_gt_u32 s33, s30
    s_cbranch_scc1 .ndd_480
    s_sleep 2
    s_branch .nd_479
.ndd_480:
    s_add_u32 m0, s52, 4096
    s_nop 0
    buffer_load_dwordx4 v2, s[8:11], s48 offen lds
    s_waitcnt vmcnt(0)
    s_branch .cb_449
.cp_450:
    buffer_store_dword v27, v26, s[8:11], s94 offen sc1
    s_branch .cb_451
.cp_457:
    buffer_store_dwordx4 v[224:227], v2, s[8:11], s53 offen offset:0 sc1
    s_branch .cb_458
.cp_459:
    buffer_store_dwordx4 v[228:231], v2, s[8:11], s53 offen offset:1024 sc1
    s_branch .cb_460
.cp_461:
    s_cmp_gt_u32 s33, s30
    s_cbranch_scc1 .ndd_482
    s_mov_b32 s62, 0
.nd_481:
    buffer_load_dword v4, v7, s[8:11], 0 offen sc1
    s_add_u32 s62, s62, 1
    s_cmp_gt_u32 s62, 0x200000
    s_cbranch_scc1 .mg_end_1
    s_waitcnt vmcnt(0)
    v_min_u32_dpp v4, v4, v4 quad_perm:[1,0,3,2] row_mask:0xf bank_mask:0xf
    s_nop 1
    v_min_u32_dpp v4, v4, v4 quad_perm:[2,3,0,1] row_mask:0xf bank_mask:0xf
    s_nop 1
    v_readfirstlane_b32 s33, v4
    s_cmp_gt_u32 s33, s30
    s_cbranch_scc1 .ndd_482
    s_sleep 2
    s_branch .nd_481
.ndd_482:
    s_add_u32 m0, s52, 0
    s_nop 0
    buffer_load_dwordx4 v2, s[8:11], s48 offen lds
    s_waitcnt vmcnt(0)
    s_branch .cb_462
.cp_463:
    buffer_store_dword v27, v26, s[8:11], s94 offen sc1
    s_branch .cb_464
.ph2_328:
    s_load_dwordx2 s[42:43], s[0:1], 88
    s_lshr_b32 s34, s99, 3
    s_and_b32 s35, s99, 7
    s_lshl_b32 s4, s34, 21
    s_lshl_b32 s5, s35, 8
    s_add_u32 s4, s4, s5
    s_lshl_b32 s6, s24, 14
    s_mul_i32 s5, s24, 131072
    s_add_u32 s4, s4, s5
    v_bfe_u32 v2, v1, 4, 1
    v_lshlrev_b32 v2, 2, v2
    v_and_b32 v3, 7, v1
    v_xor_b32 v2, v2, v3
    v_lshlrev_b32 v2, 4, v2
    v_bfe_u32 v254, v1, 3, 2
    v_mul_u32_u24 v240, 2048, v254
    v_bfe_u32 v254, v1, 5, 1
    v_mul_u32_u24 v254, 128, v254
    v_add_u32 v240, v240, v254
    v_add_u32 v240, s4, v240
    v_add_u32 v240, v2, v240
    s_lshr_b32 s5, s24, 1
    s_lshl_b32 s5, s5, 9
    v_bfe_u32 v2, v1, 3, 1
    v_xor_b32 v2, s24, v2
    v_and_b32 v2, 1, v2
    v_lshlrev_b32 v2, 6, v2
    v_bfe_u32 v254, v1, 4, 2
    v_mul_u32_u24 v242, 2048, v254
    v_bfe_u32 v254, v1, 2, 2
    v_mul_u32_u24 v254, 128, v254
    v_add_u32 v242, v242, v254
    v_bfe_u32 v254, v1, 0, 2
    v_mul_u32_u24 v254, 16, v254
    v_add_u32 v242, v242, v254
    v_add_u32 v242, s5, v242
    v_add_u32 v242, v2, v242
    v_add_u32 v243, 0x10000, v242
    s_waitcnt lgkmcnt(0)
    s_mov_b32 s16, s42
    s_and_b32 s17, s43, 0xffff
    s_mov_b32 s18, 0x800000
    s_mov_b32 s19, 0x00020000
    s_add_u32 m0, s6, 0
    s_mov_b32 s5, 0
    buffer_load_dwordx4 v240, s[16:19], s5 offen nt lds
    s_add_u32 m0, s6, 1024
    s_mov_b32 s5, 8192
    buffer_load_dwordx4 v240, s[16:19], s5 offen nt lds
    s_add_u32 m0, s6, 2048
    s_mov_b32 s5, 16384
    buffer_load_dwordx4 v240, s[16:19], s5 offen nt lds
    s_add_u32 m0, s6, 3072
    s_mov_b32 s5, 24576
    buffer_load_dwordx4 v240, s[16:19], s5 offen nt lds
    s_add_u32 m0, s6, 4096
    s_mov_b32 s5, 32768
    buffer_load_dwordx4 v240, s[16:19], s5 offen nt lds
    s_add_u32 m0, s6, 5120
    s_mov_b32 s5, 40960
    buffer_load_dwordx4 v240, s[16:19], s5 offen nt lds
    s_add_u32 m0, s6, 6144
    s_mov_b32 s5, 49152
    buffer_load_dwordx4 v240, s[16:19], s5 offen nt lds
    s_add_u32 m0, s6, 7168
    s_mov_b32 s5, 57344
    buffer_load_dwordx4 v240, s[16:19], s5 offen nt lds
    s_add_u32 m0, s6, 8192
    s_mov_b32 s5, 65536
    buffer_load_dwordx4 v240, s[16:19], s5 offen nt lds
    s_add_u32 m0, s6, 9216
    s_mov_b32 s5, 73728
    buffer_load_dwordx4 v240, s[16:19], s5 offen nt lds
    s_add_u32 m0, s6, 10240
    s_mov_b32 s5, 81920
    buffer_load_dwordx4 v240, s[16:19], s5 offen nt lds
    s_add_u32 m0, s6, 11264
    s_mov_b32 s5, 90112
    buffer_load_dwordx4 v240, s[16:19], s5 offen nt lds
    s_add_u32 m0, s6, 12288
    s_mov_b32 s5, 98304
    buffer_load_dwordx4 v240, s[16:19], s5 offen nt lds
    s_add_u32 m0, s6, 13312
    s_mov_b32 s5, 106496
    buffer_load_dwordx4 v240, s[16:19], s5 offen nt lds
    s_add_u32 m0, s6, 14336
    s_mov_b32 s5, 114688
    buffer_load_dwordx4 v240, s[16:19], s5 offen nt lds
    s_add_u32 m0, s6, 15360
    s_mov_b32 s5, 122880
    buffer_load_dwordx4 v240, s[16:19], s5 offen nt lds
    s_add_u32 m0, s6, 65536
    s_mov_b32 s5, 524288
    buffer_load_dwordx4 v240, s[16:19], s5 offen nt lds
    s_add_u32 m0, s6, 66560
    s_mov_b32 s5, 532480
    buffer_load_dwordx4 v240, s[16:19], s5 offen nt lds
    s_add_u32 m0, s6, 67584
    s_mov_b32 s5, 540672
    buffer_load_dwordx4 v240, s[16:19], s5 offen nt lds
    s_add_u32 m0, s6, 68608
    s_mov_b32 s5, 548864
    buffer_load_dwordx4 v240, s[16:19], s5 offen nt lds
    s_add_u32 m0, s6, 69632
    s_mov_b32 s5, 557056
    buffer_load_dwordx4 v240, s[16:19], s5 offen nt lds
    s_add_u32 m0, s6, 70656
    s_mov_b32 s5, 565248
    buffer_load_dwordx4 v240, s[16:19], s5 offen nt lds
    s_add_u32 m0, s6, 71680
    s_mov_b32 s5, 573440
    buffer_load_dwordx4 v240, s[16:19], s5 offen nt lds
    s_add_u32 m0, s6, 72704
    s_mov_b32 s5, 581632
    buffer_load_dwordx4 v240, s[16:19], s5 offen nt lds
    s_add_u32 m0, s6, 73728
    s_mov_b32 s5, 589824
    buffer_load_dwordx4 v240, s[16:19], s5 offen nt lds
    s_add_u32 m0, s6, 74752
    s_mov_b32 s5, 598016
    buffer_load_dwordx4 v240, s[16:19], s5 offen nt lds
    s_add_u32 m0, s6, 75776
    s_mov_b32 s5, 606208
    buffer_load_dwordx4 v240, s[16:19], s5 offen nt lds
    s_add_u32 m0, s6, 76800
    s_mov_b32 s5, 614400
    buffer_load_dwordx4 v240, s[16:19], s5 offen nt lds
    s_add_u32 m0, s6, 77824
    s_mov_b32 s5, 622592
    buffer_load_dwordx4 v240, s[16:19], s5 offen nt lds
    s_add_u32 m0, s6, 78848
    s_mov_b32 s5, 630784
    buffer_load_dwordx4 v240, s[16:19], s5 offen nt lds
    s_add_u32 m0, s6, 79872
    s_mov_b32 s5, 638976
    buffer_load_dwordx4 v240, s[16:19], s5 offen nt lds
    s_add_u32 m0, s6, 80896
    s_mov_b32 s5, 647168
    buffer_load_dwordx4 v240, s[16:19], s5 offen nt lds
    v_lshlrev_b32 v2, 4, v1
    v_mov_b32 v8, v2
    s_lshl_b32 s36, s24, 12
    s_lshl_b32 s4, s34, 16
    s_add_u32 s4, s4, s36
    v_add_u32 v9, s4, v2
    s_lshl_b32 s4, s34, 10
    s_add_u32 s4, s4, 92340224
    v_bfe_u32 v254, v1, 0, 3
    v_mul_u32_u24 v7, 128, v254
    v_add_u32 v7, s4, v7
    s_lshl_b32 s4, s35, 2
    s_add_u32 s4, s4, s24
    s_lshl_b32 s5, s4, 9
    s_lshl_b32 s94, s34, 7
    s_add_u32 s94, s94, s5
    s_add_u32 s94, s94, 92323840
    s_lshl_b32 s38, s4, 1
    s_and_b32 s5, s34, 1
    s_or_b32 s38, s38, s5
    s_lshl_b32 s4, s35, 22
    s_lshl_b32 s37, s34, 20
    s_add_u32 s37, s37, s4
    s_lshl_b32 s4, s24, 18
    s_add_u32 s37, s37, s4
    s_add_u32 s37, s37, 150994944
    s_mov_b32 s29, 16777216
    s_mov_b32 s28, 0
    s_mov_b32 s33, 0
    s_mov_b32 s39, 0
    v_mov_b32 v26, 0
    s_waitcnt vmcnt(16)
    s_barrier
    ds_read_b64_tr_b16 a[0:1], v242 offset:0
    ds_read_b64_tr_b16 a[2:3], v242 offset:1024
    ds_read_b64_tr_b16 a[4:5], v242 offset:8
    ds_read_b64_tr_b16 a[6:7], v242 offset:1032
    ds_read_b64_tr_b16 a[8:9], v242 offset:8192
    ds_read_b64_tr_b16 a[10:11], v242 offset:9216
    ds_read_b64_tr_b16 a[12:13], v242 offset:8200
    ds_read_b64_tr_b16 a[14:15], v242 offset:9224
    ds_read_b64_tr_b16 a[16:17], v242 offset:16384
    ds_read_b64_tr_b16 a[18:19], v242 offset:17408
    ds_read_b64_tr_b16 a[20:21], v242 offset:16392
    ds_read_b64_tr_b16 a[22:23], v242 offset:17416
    ds_read_b64_tr_b16 a[24:25], v242 offset:24576
    ds_read_b64_tr_b16 a[26:27], v242 offset:25600
    ds_read_b64_tr_b16 a[28:29], v242 offset:24584
    ds_read_b64_tr_b16 a[30:31], v242 offset:25608
    ds_read_b64_tr_b16 a[32:33], v242 offset:32768
    ds_read_b64_tr_b16 a[34:35], v242 offset:33792
    ds_read_b64_tr_b16 a[36:37], v242 offset:32776
    ds_read_b64_tr_b16 a[38:39], v242 offset:33800
    ds_read_b64_tr_b16 a[40:41], v242 offset:40960
    ds_read_b64_tr_b16 a[42:43], v242 offset:41984
    ds_read_b64_tr_b16 a[44:45], v242 offset:40968
    ds_read_b64_tr_b16 a[46:47], v242 offset:41992
    ds_read_b64_tr_b16 a[48:49], v242 offset:49152
    ds_read_b64_tr_b16 a[50:51], v242 offset:50176
    ds_read_b64_tr_b16 a[52:53], v242 offset:49160
    ds_read_b64_tr_b16 a[54:55], v242 offset:50184
    ds_read_b64_tr_b16 a[56:57], v242 offset:57344
    ds_read_b64_tr_b16 a[58:59], v242 offset:58368
    ds_read_b64_tr_b16 a[60:61], v242 offset:57352
    ds_read_b64_tr_b16 a[62:63], v242 offset:58376
    s_waitcnt lgkmcnt(0)
    s_barrier
    s_add_u32 m0, s6, 0
    s_mov_b32 s5, 1048576
    buffer_load_dwordx4 v240, s[16:19], s5 offen nt lds
    s_add_u32 m0, s6, 1024
    s_mov_b32 s5, 1056768
    buffer_load_dwordx4 v240, s[16:19], s5 offen nt lds
    s_add_u32 m0, s6, 2048
    s_mov_b32 s5, 1064960
    buffer_load_dwordx4 v240, s[16:19], s5 offen nt lds
    s_add_u32 m0, s6, 3072
    s_mov_b32 s5, 1073152
    buffer_load_dwordx4 v240, s[16:19], s5 offen nt lds
    s_add_u32 m0, s6, 4096
    s_mov_b32 s5, 1081344
    buffer_load_dwordx4 v240, s[16:19], s5 offen nt lds
    s_add_u32 m0, s6, 5120
    s_mov_b32 s5, 1089536
    buffer_load_dwordx4 v240, s[16:19], s5 offen nt lds
    s_add_u32 m0, s6, 6144
    s_mov_b32 s5, 1097728
    buffer_load_dwordx4 v240, s[16:19], s5 offen nt lds
    s_add_u32 m0, s6, 7168
    s_mov_b32 s5, 1105920
    buffer_load_dwordx4 v240, s[16:19], s5 offen nt lds
    s_add_u32 m0, s6, 8192
    s_mov_b32 s5, 1114112
    buffer_load_dwordx4 v240, s[16:19], s5 offen nt lds
    s_add_u32 m0, s6, 9216
    s_mov_b32 s5, 1122304
    buffer_load_dwordx4 v240, s[16:19], s5 offen nt lds
    s_add_u32 m0, s6, 10240
    s_mov_b32 s5, 1130496
    buffer_load_dwordx4 v240, s[16:19], s5 offen nt lds
    s_add_u32 m0, s6, 11264
    s_mov_b32 s5, 1138688
    buffer_load_dwordx4 v240, s[16:19], s5 offen nt lds
    s_add_u32 m0, s6, 12288
    s_mov_b32 s5, 1146880
    buffer_load_dwordx4 v240, s[16:19], s5 offen nt lds
    s_add_u32 m0, s6, 13312
    s_mov_b32 s5, 1155072
    buffer_load_dwordx4 v240, s[16:19], s5 offen nt lds
    s_add_u32 m0, s6, 14336
    s_mov_b32 s5, 1163264
    buffer_load_dwordx4 v240, s[16:19], s5 offen nt lds
    s_add_u32 m0, s6, 15360
    s_mov_b32 s5, 1171456
    buffer_load_dwordx4 v240, s[16:19], s5 offen nt lds
    s_waitcnt vmcnt(16)
    s_barrier
    ds_read_b64_tr_b16 a[64:65], v243 offset:0
    ds_read_b64_tr_b16 a[66:67], v243 offset:1024
    ds_read_b64_tr_b16 a[68:69], v243 offset:8
    ds_read_b64_tr_b16 a[70:71], v243 offset:1032
    ds_read_b64_tr_b16 a[72:73], v243 offset:8192
    ds_read_b64_tr_b16 a[74:75], v243 offset:9216
    ds_read_b64_tr_b16 a[76:77], v243 offset:8200
    ds_read_b64_tr_b16 a[78:79], v243 offset:9224
    ds_read_b64_tr_b16 a[80:81], v243 offset:16384
    ds_read_b64_tr_b16 a[82:83], v243 offset:17408
    ds_read_b64_tr_b16 a[84:85], v243 offset:16392
    ds_read_b64_tr_b16 a[86:87], v243 offset:17416
    ds_read_b64_tr_b16 a[88:89], v243 offset:24576
    ds_read_b64_tr_b16 a[90:91], v243 offset:25600
    ds_read_b64_tr_b16 a[92:93], v243 offset:24584
    ds_read_b64_tr_b16 a[94:95], v243 offset:25608
    ds_read_b64_tr_b16 a[96:97], v243 offset:32768
    ds_read_b64_tr_b16 a[98:99], v243 offset:33792
    ds_read_b64_tr_b16 a[100:101], v243 offset:32776
    ds_read_b64_tr_b16 a[102:103], v243 offset:33800
    ds_read_b64_tr_b16 a[104:105], v243 offset:40960
    ds_read_b64_tr_b16 a[106:107], v243 offset:41984
    ds_read_b64_tr_b16 a[108:109], v243 offset:40968
    ds_read_b64_tr_b16 a[110:111], v243 offset:41992
    ds_read_b64_tr_b16 a[112:113], v243 offset:49152
    ds_read_b64_tr_b16 a[114:115], v243 offset:50176
    ds_read_b64_tr_b16 a[116:117], v243 offset:49160
    ds_read_b64_tr_b16 a[118:119], v243 offset:50184
    ds_read_b64_tr_b16 a[120:121], v243 offset:57344
    ds_read_b64_tr_b16 a[122:123], v243 offset:58368
    ds_read_b64_tr_b16 a[124:125], v243 offset:57352
    ds_read_b64_tr_b16 a[126:127], v243 offset:58376
    s_waitcnt lgkmcnt(0)
    s_barrier
    s_add_u32 m0, s6, 65536
    s_mov_b32 s5, 1572864
    buffer_load_dwordx4 v240, s[16:19], s5 offen nt lds
    s_add_u32 m0, s6, 66560
    s_mov_b32 s5, 1581056
    buffer_load_dwordx4 v240, s[16:19], s5 offen nt lds
    s_add_u32 m0, s6, 67584
    s_mov_b32 s5, 1589248
    buffer_load_dwordx4 v240, s[16:19], s5 offen nt lds
    s_add_u32 m0, s6, 68608
    s_mov_b32 s5, 1597440
    buffer_load_dwordx4 v240, s[16:19], s5 offen nt lds
    s_add_u32 m0, s6, 69632
    s_mov_b32 s5, 1605632
    buffer_load_dwordx4 v240, s[16:19], s5 offen nt lds
    s_add_u32 m0, s6, 70656
    s_mov_b32 s5, 1613824
    buffer_load_dwordx4 v240, s[16:19], s5 offen nt lds
    s_add_u32 m0, s6, 71680
    s_mov_b32 s5, 1622016
    buffer_load_dwordx4 v240, s[16:19], s5 offen nt lds
    s_add_u32 m0, s6, 72704
    s_mov_b32 s5, 1630208
    buffer_load_dwordx4 v240, s[16:19], s5 offen nt lds
    s_add_u32 m0, s6, 73728
    s_mov_b32 s5, 1638400
    buffer_load_dwordx4 v240, s[16:19], s5 offen nt lds
    s_add_u32 m0, s6, 74752
    s_mov_b32 s5, 1646592
    buffer_load_dwordx4 v240, s[16:19], s5 offen nt lds
    s_add_u32 m0, s6, 75776
    s_mov_b32 s5, 1654784
    buffer_load_dwordx4 v240, s[16:19], s5 offen nt lds
    s_add_u32 m0, s6, 76800
    s_mov_b32 s5, 1662976
    buffer_load_dwordx4 v240, s[16:19], s5 offen nt lds
    s_add_u32 m0, s6, 77824
    s_mov_b32 s5, 1671168
    buffer_load_dwordx4 v240, s[16:19], s5 offen nt lds
    s_add_u32 m0, s6, 78848
    s_mov_b32 s5, 1679360
    buffer_load_dwordx4 v240, s[16:19], s5 offen nt lds
    s_add_u32 m0, s6, 79872
    s_mov_b32 s5, 1687552
    buffer_load_dwordx4 v240, s[16:19], s5 offen nt lds
    s_add_u32 m0, s6, 80896
    s_mov_b32 s5, 1695744
    buffer_load_dwordx4 v240, s[16:19], s5 offen nt lds
    s_waitcnt vmcnt(16)
    s_barrier
    ds_read_b64_tr_b16 a[128:129], v242 offset:0
    ds_read_b64_tr_b16 a[130:131], v242 offset:1024
    ds_read_b64_tr_b16 a[132:133], v242 offset:8
    ds_read_b64_tr_b16 a[134:135], v242 offset:1032
    ds_read_b64_tr_b16 a[136:137], v242 offset:8192
    ds_read_b64_tr_b16 a[138:139], v242 offset:9216
    ds_read_b64_tr_b16 a[140:141], v242 offset:8200
    ds_read_b64_tr_b16 a[142:143], v242 offset:9224
    ds_read_b64_tr_b16 a[144:145], v242 offset:16384
    ds_read_b64_tr_b16 a[146:147], v242 offset:17408
    ds_read_b64_tr_b16 a[148:149], v242 offset:16392
    ds_read_b64_tr_b16 a[150:151], v242 offset:17416
    ds_read_b64_tr_b16 a[152:153], v242 offset:24576
    ds_read_b64_tr_b16 a[154:155], v242 offset:25600
    ds_read_b64_tr_b16 a[156:157], v242 offset:24584
    ds_read_b64_tr_b16 a[158:159], v242 offset:25608
    ds_read_b64_tr_b16 a[160:161], v242 offset:32768
    ds_read_b64_tr_b16 a[162:163], v242 offset:33792
    ds_read_b64_tr_b16 a[164:165], v242 offset:32776
    ds_read_b64_tr_b16 a[166:167], v242 offset:33800
    ds_read_b64_tr_b16 a[168:169], v242 offset:40960
    ds_read_b64_tr_b16 a[170:171], v242 offset:41984
    ds_read_b64_tr_b16 a[172:173], v242 offset:40968
    ds_read_b64_tr_b16 a[174:175], v242 offset:41992
    ds_read_b64_tr_b16 a[176:177], v242 offset:49152
    ds_read_b64_tr_b16 a[178:179], v242 offset:50176
    ds_read_b64_tr_b16 a[180:181], v242 offset:49160
    ds_read_b64_tr_b16 a[182:183], v242 offset:50184
    ds_read_b64_tr_b16 a[184:185], v242 offset:57344
    ds_read_b64_tr_b16 a[186:187], v242 offset:58368
    ds_read_b64_tr_b16 a[188:189], v242 offset:57352
    ds_read_b64_tr_b16 a[190:191], v242 offset:58376
    s_waitcnt lgkmcnt(0)
    s_barrier
    s_waitcnt vmcnt(0)
    s_barrier
    ds_read_b64_tr_b16 a[192:193], v243 offset:0
    ds_read_b64_tr_b16 a[194:195], v243 offset:1024
    ds_read_b64_tr_b16 a[196:197], v243 offset:8
    ds_read_b64_tr_b16 a[198:199], v243 offset:1032
    ds_read_b64_tr_b16 a[200:201], v243 offset:8192
    ds_read_b64_tr_b16 a[202:203], v243 offset:9216
    ds_read_b64_tr_b16 a[204:205], v243 offset:8200
    ds_read_b64_tr_b16 a[206:207], v243 offset:9224
    ds_read_b64_tr_b16 a[208:209], v243 offset:16384
    ds_read_b64_tr_b16 a[210:211], v243 offset:17408
    ds_read_b64_tr_b16 a[212:213], v243 offset:16392
    ds_read_b64_tr_b16 a[214:215], v243 offset:17416
    ds_read_b64_tr_b16 a[216:217], v243 offset:24576
    ds_read_b64_tr_b16 a[218:219], v243 offset:25600
    ds_read_b64_tr_b16 a[220:221], v243 offset:24584
    ds_read_b64_tr_b16 a[222:223], v243 offset:25608
    ds_read_b64_tr_b16 a[224:225], v243 offset:32768
    ds_read_b64_tr_b16 a[226:227], v243 offset:33792
    ds_read_b64_tr_b16 a[228:229], v243 offset:32776
    ds_read_b64_tr_b16 a[230:231], v243 offset:33800
    ds_read_b64_tr_b16 a[232:233], v243 offset:40960
    ds_read_b64_tr_b16 a[234:235], v243 offset:41984
    ds_read_b64_tr_b16 a[236:237], v243 offset:40968
    ds_read_b64_tr_b16 a[238:239], v243 offset:41992
    ds_read_b64_tr_b16 a[240:241], v243 offset:49152
    ds_read_b64_tr_b16 a[242:243], v243 offset:50176
    ds_read_b64_tr_b16 a[244:245], v243 offset:49160
    ds_read_b64_tr_b16 a[246:247], v243 offset:50184
    ds_read_b64_tr_b16 a[248:249], v243 offset:57344
    ds_read_b64_tr_b16 a[250:251], v243 offset:58368
    ds_read_b64_tr_b16 a[252:253], v243 offset:57352
    ds_read_b64_tr_b16 a[254:255], v243 offset:58376
    s_waitcnt lgkmcnt(0)
    s_barrier
.cold_483:
    s_mov_b32 s62, 0
.gp_487:
    buffer_load_dwordx4 v[12:15], v7, s[8:11], 0 offen sc1
    s_add_u32 s62, s62, 1
    s_cmp_gt_u32 s62, 0x200000
    s_cbranch_scc1 .mg_end_1
    s_waitcnt vmcnt(0)
    v_min3_u32 v4, v12, v13, v14
    v_min_u32 v4, v4, v15
    s_nop 1
    v_min_u32_dpp v4, v4, v4 quad_perm:[1,0,3,2] row_mask:0xf bank_mask:0xf
    s_nop 1
    v_min_u32_dpp v4, v4, v4 quad_perm:[2,3,0,1] row_mask:0xf bank_mask:0xf
    s_nop 1
    v_min_u32_dpp v4, v4, v4 row_half_mirror row_mask:0xf bank_mask:0xf
    s_nop 1
    v_readfirstlane_b32 s33, v4
    s_cmp_gt_u32 s33, s28
    s_cbranch_scc1 .go_484
    s_sleep 1
    s_branch .gp_487
.go_484:
    s_add_u32 m0, s36, 0
    s_add_u32 s31, s29, 0
    buffer_load_dwordx4 v9, s[8:11], s31 offen offset:0 sc1 lds
    buffer_load_dwordx4 v9, s[8:11], s31 offen offset:1024 sc1 lds
    buffer_load_dwordx4 v9, s[8:11], s31 offen offset:2048 sc1 lds
    buffer_load_dwordx4 v9, s[8:11], s31 offen offset:3072 sc1 lds
    s_add_u32 m0, s36, 16384
    s_add_u32 s31, s29, 16384
    buffer_load_dwordx4 v9, s[8:11], s31 offen offset:0 sc1 lds
    buffer_load_dwordx4 v9, s[8:11], s31 offen offset:1024 sc1 lds
    buffer_load_dwordx4 v9, s[8:11], s31 offen offset:2048 sc1 lds
    buffer_load_dwordx4 v9, s[8:11], s31 offen offset:3072 sc1 lds
.body_485:
    s_waitcnt vmcnt(4)
    s_barrier
    ds_read_b128 v[64:67], v8 offset:0
    ds_read_b128 v[68:71], v8 offset:4096
    ds_read_b128 v[72:75], v8 offset:1024
    ds_read_b128 v[76:79], v8 offset:5120
    ds_read_b128 v[80:83], v8 offset:2048
    ds_read_b128 v[84:87], v8 offset:6144
    ds_read_b128 v[88:91], v8 offset:3072
    ds_read_b128 v[92:95], v8 offset:7168
    s_waitcnt lgkmcnt(6)
    v_mfma_f32_16x16x32_bf16 v[192:195], a[0:3], v[64:67], 0
    s_add_u32 m0, s36, 32768
    s_add_u32 s31, s29, 32768
    v_mfma_f32_16x16x32_bf16 v[196:199], a[4:7], v[64:67], 0
    buffer_load_dwordx4 v9, s[8:11], s31 offen offset:0 sc1 lds
    v_mfma_f32_16x16x32_bf16 v[200:203], a[0:3], v[68:71], 0
    ds_read_b128 v[96:99], v8 offset:8192
    ds_read_b128 v[100:103], v8 offset:12288
    v_mfma_f32_16x16x32_bf16 v[204:207], a[4:7], v[68:71], 0
    ds_read_b128 v[104:107], v8 offset:9216
    s_waitcnt lgkmcnt(7)
    v_mfma_f32_16x16x32_bf16 v[192:195], a[8:11], v[72:75], v[192:195]
    ds_read_b128 v[108:111], v8 offset:13312
    ds_read_b128 v[112:115], v8 offset:10240
    v_mfma_f32_16x16x32_bf16 v[196:199], a[12:15], v[72:75], v[196:199]
    buffer_load_dwordx4 v9, s[8:11], s31 offen offset:1024 sc1 lds
    v_mfma_f32_16x16x32_bf16 v[200:203], a[8:11], v[76:79], v[200:203]
    ds_read_b128 v[116:119], v8 offset:14336
    ds_read_b128 v[120:123], v8 offset:11264
    v_mfma_f32_16x16x32_bf16 v[204:207], a[12:15], v[76:79], v[204:207]
    ds_read_b128 v[124:127], v8 offset:15360
    s_waitcnt lgkmcnt(10)
    v_mfma_f32_16x16x32_bf16 v[192:195], a[16:19], v[80:83], v[192:195]
    buffer_load_dwordx4 v9, s[8:11], s31 offen offset:2048 sc1 lds
    v_mfma_f32_16x16x32_bf16 v[196:199], a[20:23], v[80:83], v[196:199]
    v_mfma_f32_16x16x32_bf16 v[200:203], a[16:19], v[84:87], v[200:203]
    v_mfma_f32_16x16x32_bf16 v[204:207], a[20:23], v[84:87], v[204:207]
    s_waitcnt lgkmcnt(8)
    v_mfma_f32_16x16x32_bf16 v[192:195], a[24:27], v[88:91], v[192:195]
    buffer_load_dwordx4 v9, s[8:11], s31 offen offset:3072 sc1 lds
    v_mfma_f32_16x16x32_bf16 v[196:199], a[28:31], v[88:91], v[196:199]
    v_mfma_f32_16x16x32_bf16 v[200:203], a[24:27], v[92:95], v[200:203]
    s_waitcnt vmcnt(4)
    s_barrier
    v_mfma_f32_16x16x32_bf16 v[204:207], a[28:31], v[92:95], v[204:207]
    ds_read_b128 v[128:131], v8 offset:16384
    s_waitcnt lgkmcnt(5)
    v_mfma_f32_16x16x32_bf16 v[192:195], a[32:35], v[96:99], v[192:195]
    s_add_u32 m0, s36, 49152
    s_add_u32 s31, s29, 49152
    v_mfma_f32_16x16x32_bf16 v[196:199], a[36:39], v[96:99], v[196:199]
    buffer_load_dwordx4 v9, s[8:11], s31 offen offset:0 sc1 lds
    v_mfma_f32_16x16x32_bf16 v[200:203], a[32:35], v[100:103], v[200:203]
    ds_read_b128 v[132:135], v8 offset:20480
    ds_read_b128 v[136:139], v8 offset:17408
    v_mfma_f32_16x16x32_bf16 v[204:207], a[36:39], v[100:103], v[204:207]
    ds_read_b128 v[140:143], v8 offset:21504
    ds_read_b128 v[144:147], v8 offset:18432
    v_mfma_f32_16x16x32_bf16 v[192:195], a[40:43], v[104:107], v[192:195]
    buffer_load_dwordx4 v9, s[8:11], s31 offen offset:1024 sc1 lds
    v_mfma_f32_16x16x32_bf16 v[196:199], a[44:47], v[104:107], v[196:199]
    ds_read_b128 v[148:151], v8 offset:22528
    ds_read_b128 v[152:155], v8 offset:19456
    v_mfma_f32_16x16x32_bf16 v[200:203], a[40:43], v[108:111], v[200:203]
    ds_read_b128 v[156:159], v8 offset:23552
    ds_read_b128 v[160:163], v8 offset:24576
    v_mfma_f32_16x16x32_bf16 v[204:207], a[44:47], v[108:111], v[204:207]
    ds_read_b128 v[164:167], v8 offset:28672
    s_waitcnt lgkmcnt(10)
    v_mfma_f32_16x16x32_bf16 v[192:195], a[48:51], v[112:115], v[192:195]
    buffer_load_dwordx4 v9, s[8:11], s31 offen offset:2048 sc1 lds
    v_mfma_f32_16x16x32_bf16 v[196:199], a[52:55], v[112:115], v[196:199]
    ds_read_b128 v[168:171], v8 offset:25600
    ds_read_b128 v[172:175], v8 offset:29696
    v_mfma_f32_16x16x32_bf16 v[200:203], a[48:51], v[116:119], v[200:203]
    ds_read_b128 v[176:179], v8 offset:26624
    ds_read_b128 v[180:183], v8 offset:30720
    v_mfma_f32_16x16x32_bf16 v[204:207], a[52:55], v[116:119], v[204:207]
    buffer_load_dwordx4 v9, s[8:11], s31 offen offset:3072 sc1 lds
    v_mfma_f32_16x16x32_bf16 v[192:195], a[56:59], v[120:123], v[192:195]
    ds_read_b128 v[184:187], v8 offset:27648
    ds_read_b128 v[188:191], v8 offset:31744
    v_mfma_f32_16x16x32_bf16 v[196:199], a[60:63], v[120:123], v[196:199]
    buffer_load_dwordx4 v[12:15], v7, s[8:11], 0 offen sc1
    s_xor_b32 s36, s36, 0x10000
    v_mfma_f32_16x16x32_bf16 v[200:203], a[56:59], v[124:127], v[200:203]
    s_add_u32 s29, s29, 0x40000
    v_mfma_f32_16x16x32_bf16 v[204:207], a[60:63], v[124:127], v[204:207]
    s_waitcnt lgkmcnt(12)
    v_mfma_f32_16x16x32_bf16 v[192:195], a[64:67], v[128:131], v[192:195]
    v_mfma_f32_16x16x32_bf16 v[196:199], a[68:71], v[128:131], v[196:199]
    v_mfma_f32_16x16x32_bf16 v[200:203], a[64:67], v[132:135], v[200:203]
    v_mfma_f32_16x16x32_bf16 v[204:207], a[68:71], v[132:135], v[204:207]
    v_mfma_f32_16x16x32_bf16 v[192:195], a[72:75], v[136:139], v[192:195]
    v_mfma_f32_16x16x32_bf16 v[196:199], a[76:79], v[136:139], v[196:199]
    v_mfma_f32_16x16x32_bf16 v[200:203], a[72:75], v[140:143], v[200:203]
    v_mfma_f32_16x16x32_bf16 v[204:207], a[76:79], v[140:143], v[204:207]
    s_waitcnt lgkmcnt(8)
    v_mfma_f32_16x16x32_bf16 v[192:195], a[80:83], v[144:147], v[192:195]
    v_mfma_f32_16x16x32_bf16 v[196:199], a[84:87], v[144:147], v[196:199]
    v_mfma_f32_16x16x32_bf16 v[200:203], a[80:83], v[148:151], v[200:203]
    v_mfma_f32_16x16x32_bf16 v[204:207], a[84:87], v[148:151], v[204:207]
    v_mfma_f32_16x16x32_bf16 v[192:195], a[88:91], v[152:155], v[192:195]
    v_mfma_f32_16x16x32_bf16 v[196:199], a[92:95], v[152:155], v[196:199]
    v_mfma_f32_16x16x32_bf16 v[200:203], a[88:91], v[156:159], v[200:203]
    v_mfma_f32_16x16x32_bf16 v[204:207], a[92:95], v[156:159], v[204:207]
    s_waitcnt lgkmcnt(4)
    v_mfma_f32_16x16x32_bf16 v[192:195], a[96:99], v[160:163], v[192:195]
    v_mfma_f32_16x16x32_bf16 v[196:199], a[100:103], v[160:163], v[196:199]
    v_mfma_f32_16x16x32_bf16 v[200:203], a[96:99], v[164:167], v[200:203]
    s_waitcnt vmcnt(0)
    s_barrier
    v_mfma_f32_16x16x32_bf16 v[204:207], a[100:103], v[164:167], v[204:207]
    ds_read_b128 v[64:67], v8 offset:32768
    ds_read_b128 v[68:71], v8 offset:36864
    v_mfma_f32_16x16x32_bf16 v[192:195], a[104:107], v[168:171], v[192:195]
    ds_read_b128 v[72:75], v8 offset:33792
    ds_read_b128 v[76:79], v8 offset:37888
    v_mfma_f32_16x16x32_bf16 v[196:199], a[108:111], v[168:171], v[196:199]
    ds_read_b128 v[80:83], v8 offset:34816
    ds_read_b128 v[84:87], v8 offset:38912
    v_mfma_f32_16x16x32_bf16 v[200:203], a[104:107], v[172:175], v[200:203]
    s_cmp_lg_u32 s39, 0
    s_cbranch_scc1 .pd_489
.pdb_490:
    v_mfma_f32_16x16x32_bf16 v[204:207], a[108:111], v[172:175], v[204:207]
    ds_read_b128 v[88:91], v8 offset:35840
    s_waitcnt lgkmcnt(7)
    v_mfma_f32_16x16x32_bf16 v[192:195], a[112:115], v[176:179], v[192:195]
    ds_read_b128 v[92:95], v8 offset:39936
    s_xor_b32 s30, s28, s38
    v_mfma_f32_16x16x32_bf16 v[196:199], a[116:119], v[176:179], v[196:199]
    s_lshl_b32 s30, s30, 12
    s_add_u32 s30, s30, s37
    v_mfma_f32_16x16x32_bf16 v[200:203], a[112:115], v[180:183], v[200:203]
    s_add_u32 s28, s28, 1
    v_min3_u32 v4, v12, v13, v14
    v_min_u32 v4, v4, v15
    v_mfma_f32_16x16x32_bf16 v[204:207], a[116:119], v[180:183], v[204:207]
    ds_read_b128 v[96:99], v8 offset:40960
    ds_read_b128 v[100:103], v8 offset:45056
    v_mfma_f32_16x16x32_bf16 v[192:195], a[120:123], v[184:187], v[192:195]
    v_min_u32_dpp v4, v4, v4 quad_perm:[1,0,3,2] row_mask:0xf bank_mask:0xf
    ds_read_b128 v[104:107], v8 offset:41984
    v_mfma_f32_16x16x32_bf16 v[196:199], a[124:127], v[184:187], v[196:199]
    ds_read_b128 v[108:111], v8 offset:46080
    ds_read_b128 v[112:115], v8 offset:43008
    v_mfma_f32_16x16x32_bf16 v[200:203], a[120:123], v[188:191], v[200:203]
    v_min_u32_dpp v4, v4, v4 quad_perm:[2,3,0,1] row_mask:0xf bank_mask:0xf
    ds_read_b128 v[116:119], v8 offset:47104
    v_mfma_f32_16x16x32_bf16 v[204:207], a[124:127], v[188:191], v[204:207]
    ds_read_b128 v[120:123], v8 offset:44032
    s_waitcnt lgkmcnt(11)
    v_mfma_f32_16x16x32_bf16 v[192:195], a[128:131], v[64:67], v[192:195]
    v_min_u32_dpp v4, v4, v4 row_half_mirror row_mask:0xf bank_mask:0xf
    ds_read_b128 v[124:127], v8 offset:48128
    v_mfma_f32_16x16x32_bf16 v[196:199], a[132:135], v[64:67], v[196:199]
    ds_read_b128 v[128:131], v8 offset:49152
    ds_read_b128 v[132:135], v8 offset:53248
    v_mfma_f32_16x16x32_bf16 v[200:203], a[128:131], v[68:71], v[200:203]
    v_readfirstlane_b32 s33, v4
    s_cmp_gt_u32 s33, s28
    s_cbranch_scc1 .hot_486
    v_mfma_f32_16x16x32_bf16 v[204:207], a[132:135], v[68:71], v[204:207]
    ds_read_b128 v[136:139], v8 offset:50176
    ds_read_b128 v[140:143], v8 offset:54272
    v_mfma_f32_16x16x32_bf16 v[192:195], a[136:139], v[72:75], v[192:195]
    ds_read_b128 v[144:147], v8 offset:51200
    ds_read_b128 v[148:151], v8 offset:55296
    v_mfma_f32_16x16x32_bf16 v[196:199], a[140:143], v[72:75], v[196:199]
    ds_read_b128 v[152:155], v8 offset:52224
    ds_read_b128 v[156:159], v8 offset:56320
    v_mfma_f32_16x16x32_bf16 v[200:203], a[136:139], v[76:79], v[200:203]
    ds_read_b128 v[160:163], v8 offset:57344
    ds_read_b128 v[164:167], v8 offset:61440
    v_mfma_f32_16x16x32_bf16 v[204:207], a[140:143], v[76:79], v[204:207]
    ds_read_b128 v[168:171], v8 offset:58368
    s_waitcnt lgkmcnt(15)
    v_mfma_f32_16x16x32_bf16 v[192:195], a[144:147], v[80:83], v[192:195]
    ds_read_b128 v[172:175], v8 offset:62464
    ds_read_b128 v[176:179], v8 offset:59392
    v_mfma_f32_16x16x32_bf16 v[196:199], a[148:151], v[80:83], v[196:199]
    ds_read_b128 v[180:183], v8 offset:63488
    ds_read_b128 v[184:187], v8 offset:60416
    v_mfma_f32_16x16x32_bf16 v[200:203], a[144:147], v[84:87], v[200:203]
    ds_read_b128 v[188:191], v8 offset:64512
    v_xor_b32 v8, 0x10000, v8
    v_mfma_f32_16x16x32_bf16 v[204:207], a[148:151], v[84:87], v[204:207]
    v_mfma_f32_16x16x32_bf16 v[192:195], a[152:155], v[88:91], v[192:195]
    v_mfma_f32_16x16x32_bf16 v[196:199], a[156:159], v[88:91], v[196:199]
    v_mfma_f32_16x16x32_bf16 v[200:203], a[152:155], v[92:95], v[200:203]
    v_mfma_f32_16x16x32_bf16 v[204:207], a[156:159], v[92:95], v[204:207]
    v_mfma_f32_16x16x32_bf16 v[192:195], a[160:163], v[96:99], v[192:195]
    v_mfma_f32_16x16x32_bf16 v[196:199], a[164:167], v[96:99], v[196:199]
    v_mfma_f32_16x16x32_bf16 v[200:203], a[160:163], v[100:103], v[200:203]
    v_mfma_f32_16x16x32_bf16 v[204:207], a[164:167], v[100:103], v[204:207]
    v_mfma_f32_16x16x32_bf16 v[192:195], a[168:171], v[104:107], v[192:195]
    v_mfma_f32_16x16x32_bf16 v[196:199], a[172:175], v[104:107], v[196:199]
    v_mfma_f32_16x16x32_bf16 v[200:203], a[168:171], v[108:111], v[200:203]
    v_mfma_f32_16x16x32_bf16 v[204:207], a[172:175], v[108:111], v[204:207]
    s_waitcnt lgkmcnt(15)
    v_mfma_f32_16x16x32_bf16 v[192:195], a[176:179], v[112:115], v[192:195]
    v_mfma_f32_16x16x32_bf16 v[196:199], a[180:183], v[112:115], v[196:199]
    v_mfma_f32_16x16x32_bf16 v[200:203], a[176:179], v[116:119], v[200:203]
    v_mfma_f32_16x16x32_bf16 v[204:207], a[180:183], v[116:119], v[204:207]
    v_mfma_f32_16x16x32_bf16 v[192:195], a[184:187], v[120:123], v[192:195]
    buffer_load_dwordx4 v[12:15], v7, s[8:11], 0 offen sc1
    v_mfma_f32_16x16x32_bf16 v[196:199], a[188:191], v[120:123], v[196:199]
    v_mfma_f32_16x16x32_bf16 v[200:203], a[184:187], v[124:127], v[200:203]
    v_mfma_f32_16x16x32_bf16 v[204:207], a[188:191], v[124:127], v[204:207]
    s_waitcnt lgkmcnt(12)
    v_mfma_f32_16x16x32_bf16 v[192:195], a[192:195], v[128:131], v[192:195]
    v_mfma_f32_16x16x32_bf16 v[196:199], a[196:199], v[128:131], v[196:199]
    v_mfma_f32_16x16x32_bf16 v[200:203], a[192:195], v[132:135], v[200:203]
    v_mfma_f32_16x16x32_bf16 v[204:207], a[196:199], v[132:135], v[204:207]
    v_mfma_f32_16x16x32_bf16 v[192:195], a[200:203], v[136:139], v[192:195]
    v_mfma_f32_16x16x32_bf16 v[196:199], a[204:207], v[136:139], v[196:199]
    v_mfma_f32_16x16x32_bf16 v[200:203], a[200:203], v[140:143], v[200:203]
    v_mfma_f32_16x16x32_bf16 v[204:207], a[204:207], v[140:143], v[204:207]
    s_waitcnt lgkmcnt(8)
    v_mfma_f32_16x16x32_bf16 v[192:195], a[208:211], v[144:147], v[192:195]
    v_mfma_f32_16x16x32_bf16 v[196:199], a[212:215], v[144:147], v[196:199]
    v_mfma_f32_16x16x32_bf16 v[200:203], a[208:211], v[148:151], v[200:203]
    v_mfma_f32_16x16x32_bf16 v[204:207], a[212:215], v[148:151], v[204:207]
    v_mfma_f32_16x16x32_bf16 v[192:195], a[216:219], v[152:155], v[192:195]
    v_mfma_f32_16x16x32_bf16 v[196:199], a[220:223], v[152:155], v[196:199]
    v_mfma_f32_16x16x32_bf16 v[200:203], a[216:219], v[156:159], v[200:203]
    v_mfma_f32_16x16x32_bf16 v[204:207], a[220:223], v[156:159], v[204:207]
    s_waitcnt lgkmcnt(4)
    v_mfma_f32_16x16x32_bf16 v[192:195], a[224:227], v[160:163], v[192:195]
    v_mfma_f32_16x16x32_bf16 v[196:199], a[228:231], v[160:163], v[196:199]
    v_mfma_f32_16x16x32_bf16 v[200:203], a[224:227], v[164:167], v[200:203]
    v_mfma_f32_16x16x32_bf16 v[204:207], a[228:231], v[164:167], v[204:207]
    v_mfma_f32_16x16x32_bf16 v[192:195], a[232:235], v[168:171], v[192:195]
    v_mfma_f32_16x16x32_bf16 v[196:199], a[236:239], v[168:171], v[196:199]
    v_mfma_f32_16x16x32_bf16 v[200:203], a[232:235], v[172:175], v[200:203]
    s_waitcnt vmcnt(0)
    v_min3_u32 v4, v12, v13, v14
    v_min_u32 v4, v4, v15
    v_mfma_f32_16x16x32_bf16 v[204:207], a[236:239], v[172:175], v[204:207]
    s_waitcnt lgkmcnt(0)
    v_mfma_f32_16x16x32_bf16 v[192:195], a[240:243], v[176:179], v[192:195]
    v_min_u32_dpp v4, v4, v4 quad_perm:[1,0,3,2] row_mask:0xf bank_mask:0xf
    v_mfma_f32_16x16x32_bf16 v[196:199], a[244:247], v[176:179], v[196:199]
    v_mfma_f32_16x16x32_bf16 v[200:203], a[240:243], v[180:183], v[200:203]
    v_min_u32_dpp v4, v4, v4 quad_perm:[2,3,0,1] row_mask:0xf bank_mask:0xf
    v_mfma_f32_16x16x32_bf16 v[204:207], a[244:247], v[180:183], v[204:207]
    v_mfma_f32_16x16x32_bf16 v[192:195], a[248:251], v[184:187], v[192:195]
    v_min_u32_dpp v4, v4, v4 row_half_mirror row_mask:0xf bank_mask:0xf
    v_mfma_f32_16x16x32_bf16 v[196:199], a[252:255], v[184:187], v[196:199]
    v_mfma_f32_16x16x32_bf16 v[200:203], a[248:251], v[188:191], v[200:203]
    v_readfirstlane_b32 s33, v4
    v_mfma_f32_16x16x32_bf16 v[204:207], a[252:255], v[188:191], v[204:207]
    s_cmp_gt_u32 s33, s28
    s_cbranch_scc1 .gx_488
    s_cmp_ge_u32 s28, 64
    s_cbranch_scc1 .last_492
    s_mov_b32 s39, 1
    s_nop 2
    v_pk_mov_b32 v[208:209], v[192:193], v[192:193] op_sel:[0,1]
    v_pk_mov_b32 v[210:211], v[194:195], v[194:195] op_sel:[0,1]
    v_pk_mov_b32 v[212:213], v[196:197], v[196:197] op_sel:[0,1]
    v_pk_mov_b32 v[214:215], v[198:199], v[198:199] op_sel:[0,1]
    v_pk_mov_b32 v[216:217], v[200:201], v[200:201] op_sel:[0,1]
    v_pk_mov_b32 v[218:219], v[202:203], v[202:203] op_sel:[0,1]
    v_pk_mov_b32 v[220:221], v[204:205], v[204:205] op_sel:[0,1]
    v_pk_mov_b32 v[222:223], v[206:207], v[206:207] op_sel:[0,1]
    s_branch .cold_483
.last_492:
    s_nop 3
    buffer_store_dwordx4 v[192:195], v2, s[8:11], s30 offen offset:0 sc1
    buffer_store_dwordx4 v[196:199], v2, s[8:11], s30 offen offset:1024 sc1
    buffer_store_dwordx4 v[200:203], v2, s[8:11], s30 offen offset:2048 sc1
    buffer_store_dwordx4 v[204:207], v2, s[8:11], s30 offen offset:3072 sc1
    s_mov_b32 s39, 0
    s_waitcnt vmcnt(0)
    v_mov_b32 v27, s28
    s_mov_b64 exec, 1
    buffer_store_dword v27, v26, s[8:11], s94 offen sc1
    s_mov_b64 exec, -1
    s_cmp_lt_u32 s28, 64
    s_cbranch_scc1 .cold_483
    s_endpgm
.gx_488:
    s_add_u32 m0, s36, 0
    s_add_u32 s31, s29, 0
    buffer_load_dwordx4 v9, s[8:11], s31 offen offset:0 sc1 lds
    buffer_load_dwordx4 v9, s[8:11], s31 offen offset:1024 sc1 lds
    buffer_load_dwordx4 v9, s[8:11], s31 offen offset:2048 sc1 lds
    buffer_load_dwordx4 v9, s[8:11], s31 offen offset:3072 sc1 lds
    s_add_u32 m0, s36, 16384
    s_add_u32 s31, s29, 16384
    buffer_load_dwordx4 v9, s[8:11], s31 offen offset:0 sc1 lds
    buffer_load_dwordx4 v9, s[8:11], s31 offen offset:1024 sc1 lds
    buffer_load_dwordx4 v9, s[8:11], s31 offen offset:2048 sc1 lds
    buffer_load_dwordx4 v9, s[8:11], s31 offen offset:3072 sc1 lds
    s_branch .cpy_491
.hot_486:
    v_mfma_f32_16x16x32_bf16 v[204:207], a[132:135], v[68:71], v[204:207]
    s_add_u32 m0, s36, 0
    s_add_u32 s31, s29, 0
    v_mfma_f32_16x16x32_bf16 v[192:195], a[136:139], v[72:75], v[192:195]
    buffer_load_dwordx4 v9, s[8:11], s31 offen offset:0 sc1 lds
    v_mfma_f32_16x16x32_bf16 v[196:199], a[140:143], v[72:75], v[196:199]
    ds_read_b128 v[136:139], v8 offset:50176
    ds_read_b128 v[140:143], v8 offset:54272
    v_mfma_f32_16x16x32_bf16 v[200:203], a[136:139], v[76:79], v[200:203]
    ds_read_b128 v[144:147], v8 offset:51200
    ds_read_b128 v[148:151], v8 offset:55296
    v_mfma_f32_16x16x32_bf16 v[204:207], a[140:143], v[76:79], v[204:207]
    ds_read_b128 v[152:155], v8 offset:52224
    s_waitcnt lgkmcnt(15)
    v_mfma_f32_16x16x32_bf16 v[192:195], a[144:147], v[80:83], v[192:195]
    ds_read_b128 v[156:159], v8 offset:56320
    ds_read_b128 v[160:163], v8 offset:57344
    v_mfma_f32_16x16x32_bf16 v[196:199], a[148:151], v[80:83], v[196:199]
    buffer_load_dwordx4 v9, s[8:11], s31 offen offset:1024 sc1 lds
    v_mfma_f32_16x16x32_bf16 v[200:203], a[144:147], v[84:87], v[200:203]
    ds_read_b128 v[164:167], v8 offset:61440
    ds_read_b128 v[168:171], v8 offset:58368
    v_mfma_f32_16x16x32_bf16 v[204:207], a[148:151], v[84:87], v[204:207]
    ds_read_b128 v[172:175], v8 offset:62464
    ds_read_b128 v[176:179], v8 offset:59392
    v_mfma_f32_16x16x32_bf16 v[192:195], a[152:155], v[88:91], v[192:195]
    ds_read_b128 v[180:183], v8 offset:63488
    ds_read_b128 v[184:187], v8 offset:60416
    v_mfma_f32_16x16x32_bf16 v[196:199], a[156:159], v[88:91], v[196:199]
    ds_read_b128 v[188:191], v8 offset:64512
    v_xor_b32 v8, 0x10000, v8
    v_mfma_f32_16x16x32_bf16 v[200:203], a[152:155], v[92:95], v[200:203]
    buffer_load_dwordx4 v9, s[8:11], s31 offen offset:2048 sc1 lds
    v_mfma_f32_16x16x32_bf16 v[204:207], a[156:159], v[92:95], v[204:207]
    s_waitcnt lgkmcnt(15)
    v_mfma_f32_16x16x32_bf16 v[192:195], a[160:163], v[96:99], v[192:195]
    v_mfma_f32_16x16x32_bf16 v[196:199], a[164:167], v[96:99], v[196:199]
    v_mfma_f32_16x16x32_bf16 v[200:203], a[160:163], v[100:103], v[200:203]
    v_mfma_f32_16x16x32_bf16 v[204:207], a[164:167], v[100:103], v[204:207]
    buffer_load_dwordx4 v9, s[8:11], s31 offen offset:3072 sc1 lds
    v_mfma_f32_16x16x32_bf16 v[192:195], a[168:171], v[104:107], v[192:195]
    v_mfma_f32_16x16x32_bf16 v[196:199], a[172:175], v[104:107], v[196:199]
    v_mfma_f32_16x16x32_bf16 v[200:203], a[168:171], v[108:111], v[200:203]
    v_mfma_f32_16x16x32_bf16 v[204:207], a[172:175], v[108:111], v[204:207]
    v_mfma_f32_16x16x32_bf16 v[192:195], a[176:179], v[112:115], v[192:195]
    s_add_u32 m0, s36, 16384
    s_add_u32 s31, s29, 16384
    v_mfma_f32_16x16x32_bf16 v[196:199], a[180:183], v[112:115], v[196:199]
    buffer_load_dwordx4 v9, s[8:11], s31 offen offset:0 sc1 lds
    v_mfma_f32_16x16x32_bf16 v[200:203], a[176:179], v[116:119], v[200:203]
    v_mfma_f32_16x16x32_bf16 v[204:207], a[180:183], v[116:119], v[204:207]
    v_mfma_f32_16x16x32_bf16 v[192:195], a[184:187], v[120:123], v[192:195]
    v_mfma_f32_16x16x32_bf16 v[196:199], a[188:191], v[120:123], v[196:199]
    v_mfma_f32_16x16x32_bf16 v[200:203], a[184:187], v[124:127], v[200:203]
    buffer_load_dwordx4 v9, s[8:11], s31 offen offset:1024 sc1 lds
    v_mfma_f32_16x16x32_bf16 v[204:207], a[188:191], v[124:127], v[204:207]
    s_waitcnt lgkmcnt(12)
    v_mfma_f32_16x16x32_bf16 v[192:195], a[192:195], v[128:131], v[192:195]
    v_mfma_f32_16x16x32_bf16 v[196:199], a[196:199], v[128:131], v[196:199]
    v_mfma_f32_16x16x32_bf16 v[200:203], a[192:195], v[132:135], v[200:203]
    v_mfma_f32_16x16x32_bf16 v[204:207], a[196:199], v[132:135], v[204:207]
    buffer_load_dwordx4 v9, s[8:11], s31 offen offset:2048 sc1 lds
    v_mfma_f32_16x16x32_bf16 v[192:195], a[200:203], v[136:139], v[192:195]
    v_mfma_f32_16x16x32_bf16 v[196:199], a[204:207], v[136:139], v[196:199]
    v_mfma_f32_16x16x32_bf16 v[200:203], a[200:203], v[140:143], v[200:203]
    v_mfma_f32_16x16x32_bf16 v[204:207], a[204:207], v[140:143], v[204:207]
    s_waitcnt lgkmcnt(8)
    v_mfma_f32_16x16x32_bf16 v[192:195], a[208:211], v[144:147], v[192:195]
    buffer_load_dwordx4 v9, s[8:11], s31 offen offset:3072 sc1 lds
    v_mfma_f32_16x16x32_bf16 v[196:199], a[212:215], v[144:147], v[196:199]
    v_mfma_f32_16x16x32_bf16 v[200:203], a[208:211], v[148:151], v[200:203]
    v_mfma_f32_16x16x32_bf16 v[204:207], a[212:215], v[148:151], v[204:207]
    v_mfma_f32_16x16x32_bf16 v[192:195], a[216:219], v[152:155], v[192:195]
    v_mfma_f32_16x16x32_bf16 v[196:199], a[220:223], v[152:155], v[196:199]
    v_mfma_f32_16x16x32_bf16 v[200:203], a[216:219], v[156:159], v[200:203]
    v_mfma_f32_16x16x32_bf16 v[204:207], a[220:223], v[156:159], v[204:207]
    s_waitcnt lgkmcnt(4)
    v_mfma_f32_16x16x32_bf16 v[192:195], a[224:227], v[160:163], v[192:195]
    v_mfma_f32_16x16x32_bf16 v[196:199], a[228:231], v[160:163], v[196:199]
    v_mfma_f32_16x16x32_bf16 v[200:203], a[224:227], v[164:167], v[200:203]
    v_mfma_f32_16x16x32_bf16 v[204:207], a[228:231], v[164:167], v[204:207]
    v_mfma_f32_16x16x32_bf16 v[192:195], a[232:235], v[168:171], v[192:195]
    v_mfma_f32_16x16x32_bf16 v[196:199], a[236:239], v[168:171], v[196:199]
    v_mfma_f32_16x16x32_bf16 v[200:203], a[232:235], v[172:175], v[200:203]
    v_mfma_f32_16x16x32_bf16 v[204:207], a[236:239], v[172:175], v[204:207]
    s_waitcnt lgkmcnt(0)
    v_mfma_f32_16x16x32_bf16 v[192:195], a[240:243], v[176:179], v[192:195]
    v_mfma_f32_16x16x32_bf16 v[196:199], a[244:247], v[176:179], v[196:199]
    v_mfma_f32_16x16x32_bf16 v[200:203], a[240:243], v[180:183], v[200:203]
    v_mfma_f32_16x16x32_bf16 v[204:207], a[244:247], v[180:183], v[204:207]
    v_mfma_f32_16x16x32_bf16 v[192:195], a[248:251], v[184:187], v[192:195]
    v_mfma_f32_16x16x32_bf16 v[196:199], a[252:255], v[184:187], v[196:199]
    v_mfma_f32_16x16x32_bf16 v[200:203], a[248:251], v[188:191], v[200:203]
    v_mfma_f32_16x16x32_bf16 v[204:207], a[252:255], v[188:191], v[204:207]
.cpy_491:
    s_mov_b32 s39, 1
    s_nop 2
    v_pk_mov_b32 v[208:209], v[192:193], v[192:193] op_sel:[0,1]
    v_pk_mov_b32 v[210:211], v[194:195], v[194:195] op_sel:[0,1]
    v_pk_mov_b32 v[212:213], v[196:197], v[196:197] op_sel:[0,1]
    v_pk_mov_b32 v[214:215], v[198:199], v[198:199] op_sel:[0,1]
    v_pk_mov_b32 v[216:217], v[200:201], v[200:201] op_sel:[0,1]
    v_pk_mov_b32 v[218:219], v[202:203], v[202:203] op_sel:[0,1]
    v_pk_mov_b32 v[220:221], v[204:205], v[204:205] op_sel:[0,1]
    v_pk_mov_b32 v[222:223], v[206:207], v[206:207] op_sel:[0,1]
    s_branch .body_485
.pd_489:
    s_sub_u32 s4, s28, 1
    v_mov_b32 v27, s4
    s_mov_b64 exec, 1
    buffer_store_dword v27, v26, s[8:11], s94 offen sc1
    s_mov_b64 exec, -1
    buffer_store_dwordx4 v[208:211], v2, s[8:11], s30 offen offset:0 sc1
    buffer_store_dwordx4 v[212:215], v2, s[8:11], s30 offen offset:1024 sc1
    buffer_store_dwordx4 v[216:219], v2, s[8:11], s30 offen offset:2048 sc1
    buffer_store_dwordx4 v[220:223], v2, s[8:11], s30 offen offset:3072 sc1
    s_branch .pdb_490
.fin_350:
    s_load_dwordx2 s[44:45], s[0:1], 112
    s_sub_u32 s34, s98, 1
    s_lshl_b32 s4, s34, 11
    s_lshr_b32 s5, s99, 2
    s_lshl_b32 s5, s5, 22
    s_add_u32 s4, s4, s5
    s_and_b32 s5, s99, 3
    s_lshl_b32 s5, s5, 18
    s_add_u32 s4, s4, s5
    s_lshl_b32 s38, s99, 1
    v_lshlrev_b32 v2, 4, v1
    v_add_u32 v2, s4, v2
    s_lshl_b32 s4, s34, 15
    s_lshl_b32 s5, s99, 6
    s_add_u32 s4, s4, s5
    v_bfe_u32 v254, v1, 0, 4
    v_mul_u32_u24 v13, 2048, v254
    v_bfe_u32 v254, v1, 4, 2
    v_mul_u32_u24 v254, 16, v254
    v_add_u32 v13, v13, v254
    v_add_u32 v13, s4, v13
    s_lshl_b32 s4, s99, 17
    s_lshl_b32 s5, s34, 10
    s_add_u32 s4, s4, s5
    v_bfe_u32 v254, v1, 4, 2
    v_mul_u32_u24 v14, 32768, v254
    v_bfe_u32 v254, v1, 3, 1
    v_mul_u32_u24 v254, 512, v254
    v_add_u32 v14, v14, v254
    v_bfe_u32 v254, v1, 0, 3
    v_mul_u32_u24 v254, 2, v254
    v_add_u32 v14, v14, v254
    v_add_u32 v14, s4, v14
    v_add_u32 v15, 4096, v14
    v_add_u32 v16, 8192, v14
    v_add_u32 v17, 12288, v14
    v_add_u32 v18, 16384, v14
    v_add_u32 v19, 20480, v14
    v_add_u32 v20, 24576, v14
    v_add_u32 v21, 28672, v14
    s_lshl_b32 s4, s34, 6
    v_bfe_u32 v254, v1, 0, 4
    v_mul_u32_u24 v22, 4, v254
    v_add_u32 v22, s4, v22
    s_lshl_b32 s4, s99, 9
    s_add_u32 s4, s4, 92323840
    v_bfe_u32 v254, v1, 0, 2
    v_mul_u32_u24 v7, 128, v254
    v_add_u32 v7, s4, v7
    s_mov_b32 s28, s24
    s_mov_b32 s33, 0
    s_waitcnt lgkmcnt(0)
    s_mov_b32 s84, s44
    s_and_b32 s85, s45, 0xffff
    s_mov_b32 s86, 0x400000
    s_mov_b32 s87, 0x00020000
    s_mov_b32 s62, 0
    v_mov_b32 v5, 0
.wc_493:
    buffer_load_dword v4, v5, s[20:23], 0 offen offset:192 sc1
    s_add_u32 s62, s62, 1
    s_cmp_gt_u32 s62, 0x200000
    s_cbranch_scc1 .mg_end_1
    s_waitcnt vmcnt(0)
    v_readfirstlane_b32 s4, v4
    s_cmp_ge_u32 s4, 64
    s_cbranch_scc1 .wd_494
    s_sleep 8
    s_branch .wc_493
.wd_494:
.fl_495:
    s_lshl_b32 s57, s28, 16
    s_and_b32 s4, s28, 31
    s_lshl_b32 s4, s4, 4
    s_lshr_b32 s5, s28, 5
    s_lshl_b32 s5, s5, 11
    s_add_u32 s58, s4, s5
    s_add_u32 s58, s58, 130023424
    s_lshl_b32 s59, s28, 7
    s_add_u32 s59, s59, 121634816
    buffer_load_dwordx4 v[32:35], v13, s[12:15], s57 offen
    buffer_load_dword v44, v22, s[8:11], s59 offen
    buffer_load_ushort v36, v14, s[8:11], s58 offen
    buffer_load_ushort v37, v15, s[8:11], s58 offen
    buffer_load_ushort v38, v16, s[8:11], s58 offen
    buffer_load_ushort v39, v17, s[8:11], s58 offen
    buffer_load_ushort v40, v18, s[8:11], s58 offen
    buffer_load_ushort v41, v19, s[8:11], s58 offen
    buffer_load_ushort v42, v20, s[8:11], s58 offen
    buffer_load_ushort v43, v21, s[8:11], s58 offen
    s_xor_b32 s48, s28, s38
    s_lshl_b32 s48, s48, 12
    s_add_u32 s48, s48, 150994944
    s_xor_b32 s49, s48, 0x101000
    s_add_u32 s50, s48, 0x200000
    s_add_u32 s51, s49, 0x200000
    s_cmp_gt_u32 s33, s28
    s_cbranch_scc1 .fd_497
    s_mov_b32 s62, 0
.fp_496:
    buffer_load_dword v4, v7, s[8:11], 0 offen sc1
    s_add_u32 s62, s62, 1
    s_cmp_gt_u32 s62, 0x200000
    s_cbranch_scc1 .mg_end_1
    s_waitcnt vmcnt(0)
    v_min_u32_dpp v4, v4, v4 quad_perm:[1,0,3,2] row_mask:0xf bank_mask:0xf
    s_nop 1
    v_min_u32_dpp v4, v4, v4 quad_perm:[2,3,0,1] row_mask:0xf bank_mask:0xf
    s_nop 1
    v_readfirstlane_b32 s33, v4
    s_cmp_gt_u32 s33, s28
    s_cbranch_scc1 .fd_497
    s_sleep 2
    s_add_u32 s4, s33, 1
    s_cmp_ge_u32 s4, s28
    s_cbranch_scc1 .fp_496
    s_sleep 12
    s_branch .fp_496
.fd_497:
    buffer_load_dwordx4 v[64:67], v2, s[8:11], s48 offen offset:0
    buffer_load_dwordx4 v[68:71], v2, s[8:11], s48 offen offset:1024
    buffer_load_dwordx4 v[72:75], v2, s[8:11], s49 offen offset:0
    buffer_load_dwordx4 v[76:79], v2, s[8:11], s49 offen offset:1024
    buffer_load_dwordx4 v[80:83], v2, s[8:11], s50 offen offset:0
    buffer_load_dwordx4 v[84:87], v2, s[8:11], s50 offen offset:1024
    buffer_load_dwordx4 v[88:91], v2, s[8:11], s51 offen offset:0
    buffer_load_dwordx4 v[92:95], v2, s[8:11], s51 offen offset:1024
    s_waitcnt vmcnt(8)
    v_lshlrev_b32 v48, 16, v32
    v_lshlrev_b32 v36, 16, v36
    v_and_b32 v49, 0xffff0000, v32
    v_lshlrev_b32 v37, 16, v37
    v_lshlrev_b32 v50, 16, v33
    v_lshlrev_b32 v38, 16, v38
    v_and_b32 v51, 0xffff0000, v33
    v_lshlrev_b32 v39, 16, v39
    v_lshlrev_b32 v52, 16, v34
    v_lshlrev_b32 v40, 16, v40
    v_and_b32 v53, 0xffff0000, v34
    v_lshlrev_b32 v41, 16, v41
    v_lshlrev_b32 v54, 16, v35
    v_lshlrev_b32 v42, 16, v42
    v_and_b32 v55, 0xffff0000, v35
    v_lshlrev_b32 v43, 16, v43
    v_mul_f32 v48, v48, v36
    v_mul_f32 v49, v49, v37
    v_mul_f32 v50, v50, v38
    v_mul_f32 v51, v51, v39
    v_mul_f32 v52, v52, v40
    v_mul_f32 v53, v53, v41
    v_mul_f32 v54, v54, v42
    v_mul_f32 v55, v55, v43
    v_mul_f32 v48, v48, v44
    v_mul_f32 v49, v49, v44
    v_mul_f32 v50, v50, v44
    v_mul_f32 v51, v51, v44
    v_mul_f32 v52, v52, v44
    v_mul_f32 v53, v53, v44
    v_mul_f32 v54, v54, v44
    v_mul_f32 v55, v55, v44
    v_sub_f32 v44, 1.0, v44
    s_waitcnt vmcnt(4)
    v_add_f32 v64, v64, v72
    v_add_f32 v65, v65, v73
    v_add_f32 v66, v66, v74
    v_add_f32 v67, v67, v75
    v_add_f32 v68, v68, v76
    v_add_f32 v69, v69, v77
    v_add_f32 v70, v70, v78
    v_add_f32 v71, v71, v79
    s_waitcnt vmcnt(0)
    v_add_f32 v80, v80, v88
    v_add_f32 v81, v81, v89
    v_add_f32 v82, v82, v90
    v_add_f32 v83, v83, v91
    v_add_f32 v84, v84, v92
    v_add_f32 v85, v85, v93
    v_add_f32 v86, v86, v94
    v_add_f32 v87, v87, v95
    v_add_f32 v64, v64, v80
    v_add_f32 v65, v65, v81
    v_add_f32 v66, v66, v82
    v_add_f32 v67, v67, v83
    v_add_f32 v68, v68, v84
    v_add_f32 v69, v69, v85
    v_add_f32 v70, v70, v86
    v_add_f32 v71, v71, v87
    v_fma_f32 v64, v64, v44, v48
    v_fma_f32 v65, v65, v44, v49
    v_fma_f32 v66, v66, v44, v50
    v_fma_f32 v67, v67, v44, v51
    v_fma_f32 v68, v68, v44, v52
    v_fma_f32 v69, v69, v44, v53
    v_fma_f32 v70, v70, v44, v54
    v_fma_f32 v71, v71, v44, v55
    v_cvt_pk_bf16_f32 v56, v64, v65
    v_cvt_pk_bf16_f32 v57, v66, v67
    v_cvt_pk_bf16_f32 v58, v68, v69
    v_cvt_pk_bf16_f32 v59, v70, v71
    buffer_store_dwordx4 v[56:59], v13, s[84:87], s57 offen
    s_add_u32 s28, s28, 4
    s_cmp_lt_u32 s28, 64
    s_cbranch_scc1 .fl_495
    s_endpgm
.mg_end_1:
    s_endpgm
.section .rodata,"a"
.p2align 6
.amdhsa_kernel mega_kernel
  .amdhsa_next_free_vgpr 512
  .amdhsa_next_free_sgpr 102
  .amdhsa_accum_offset 256
  .amdhsa_group_segment_fixed_size 0
  .amdhsa_kernarg_size 136
  .amdhsa_user_sgpr_count 2
  .amdhsa_user_sgpr_kernarg_segment_ptr 1
  .amdhsa_system_sgpr_workgroup_id_x 1
.end_amdhsa_kernel
```

```asm
; @launch kernel=mega_kernel grid=(256,1,1) block=(256,1,1) lds=163840
.amdgcn_target "amdgcn-amd-amdhsa--gfx950"
.text
.globl mega_kernel
.p2align 8
.type mega_kernel,@function
mega_kernel:
    s_cmp_ge_u32 s2, 256
    s_cbranch_scc1 .mg_end_1
    s_load_dwordx4 s[52:55], s[0:1], 120
    s_getreg_b32 s3, hwreg(HW_REG_XCC_ID)
    v_and_b32 v1, 63, v0
    v_lshrrev_b32 v4, 6, v0
    s_and_b32 s3, s3, 7
    v_readfirstlane_b32 s24, v4
    s_waitcnt lgkmcnt(0)
    s_mov_b32 s8, s54
    s_and_b32 s9, s55, 0xffff
    s_mov_b32 s10, 0x10000000
    s_mov_b32 s11, 0x00020000
    s_mov_b32 s20, s52
    s_and_b32 s21, s53, 0xffff
    s_mov_b32 s22, 0x100
    s_mov_b32 s23, 0x00020000
    s_mov_b32 s100, s54
    v_mov_b32 v7, 163832
    s_cmp_lg_u32 s24, 0
    s_cbranch_scc1 .noat_4
    s_mov_b64 exec, 1
    v_mov_b32 v5, 1
    s_lshl_b32 s4, s3, 3
    s_mov_b32 s6, 0x60402000
    s_mov_b32 s7, 0xe4e08480
    s_lshr_b64 s[6:7], s[6:7], s4
    s_and_b32 s4, s6, 0xff
    v_mov_b32 v6, s4
    buffer_atomic_add v5, v6, s[20:23], 0 offen sc0 sc1
    s_mov_b64 exec, -1
.noat_4:
    s_sub_u32 s101, 0, s100
    s_and_b32 s101, s101, 0x1fffff
    s_add_u32 s101, s101, 184549376
    s_lshl_b32 s4, s2, 2
    s_add_u32 s4, s4, s24
    s_lshl_b32 s5, s4, 11
    s_add_u32 s5, s5, s101
    v_lshlrev_b32 v8, 4, v1
    v_mov_b32 v20, -1
    v_mov_b32 v21, -1
    v_mov_b32 v22, -1
    v_mov_b32 v23, -1
    s_lshl_b32 s4, s4, 10
    s_add_u32 s4, s4, 83886080
    buffer_store_dwordx4 v[20:23], v8, s[8:11], s5 offen sc1
    buffer_store_dwordx4 v[20:23], v8, s[8:11], s5 offen offset:1024 sc1
    buffer_store_dwordx4 v[20:23], v8, s[8:11], s4 offen sc1
    s_cmp_eq_u32 s24, 2
    s_cselect_b32 s6, s2, -1
    s_cmp_ge_u32 s6, 128
    s_cbranch_scc1 .nr_7
    s_lshl_b32 s6, s6, 10
    s_add_u32 s6, s6, 84934656
    buffer_store_dwordx4 v[20:23], v8, s[8:11], s6 offen sc1
.nr_7:
    s_cmp_eq_u32 s24, 3
    s_cselect_b32 s6, s2, -1
    s_cmp_ge_u32 s6, 72
    s_cbranch_scc1 .nf_5
    v_mov_b32 v24, 0
    v_mov_b32 v25, 0
    v_mov_b32 v26, 0
    v_mov_b32 v27, 0
    s_lshl_b32 s6, s6, 10
    s_add_u32 s6, s6, 92274688
    buffer_store_dwordx4 v[24:27], v8, s[8:11], s6 offen sc1
.nf_5:
    s_cmp_lg_u32 s24, 0
    s_cbranch_scc1 .nw_6
    s_mov_b64 exec, 1
    s_waitcnt vmcnt(3)
    ds_write_b32 v7, v5
    s_waitcnt lgkmcnt(0)
    s_mov_b64 exec, -1
.nw_6:
    s_barrier
    ds_read_b32 v5, v7
    s_mov_b32 s25, s3
    s_mov_b32 s27, 0
    s_waitcnt lgkmcnt(0)
    v_readfirstlane_b32 s26, v5
    s_cmp_ge_u32 s26, 32
    s_cselect_b32 s3, 0x10001, 1
    s_and_b32 s26, s26, 31
.mg_role_3:
    s_cmp_ge_u32 s25, 4
    s_cbranch_scc1 .mg_bg_2
    s_load_dwordx8 s[84:91], s[0:1], 64
    s_load_dwordx2 s[40:41], s[0:1], 56
    v_and_b32 v1, 63, v0
    s_lshl_b32 s4, s25, 4
    s_andn2_b32 s5, 8, s26
    s_or_b32 s4, s4, s5
    s_cbranch_scc1 .nocal_8
    s_cmp_lg_u32 s24, 3
    s_cbranch_scc1 .calb_9
    s_lshr_b32 s4, s26, 1
    s_and_b32 s4, s4, 8
    s_and_b32 s5, s26, 7
    s_or_b32 s4, s4, s5
    s_lshl_b32 s5, s4, 21
    s_add_u32 s5, s5, s101
    s_mov_b64 exec, 1
    v_mov_b32 v4, -1
    v_mov_b32 v5, 0
    s_mov_b32 s7, 0xffff
    s_mov_b32 s6, 0xffff
    s_memtime s[72:73]
    s_waitcnt lgkmcnt(0)
    buffer_store_dword v4, v5, s[8:11], s5 offen sc1
    s_waitcnt vmcnt(0)
    s_memtime s[74:75]
    s_waitcnt lgkmcnt(0)
    s_sub_u32 s74, s74, s72
    s_min_u32 s7, s7, s74
    v_xor_b32 v5, 0x2000, v5
    s_memtime s[72:73]
    s_waitcnt lgkmcnt(0)
    buffer_store_dword v4, v5, s[8:11], s5 offen sc1
    s_waitcnt vmcnt(0)
    s_memtime s[74:75]
    s_waitcnt lgkmcnt(0)
    s_sub_u32 s74, s74, s72
    s_min_u32 s6, s6, s74
    v_xor_b32 v5, 0x2000, v5
    s_memtime s[72:73]
    s_waitcnt lgkmcnt(0)
    buffer_store_dword v4, v5, s[8:11], s5 offen sc1
    s_waitcnt vmcnt(0)
    s_memtime s[74:75]
    s_waitcnt lgkmcnt(0)
    s_sub_u32 s74, s74, s72
    s_min_u32 s7, s7, s74
    v_xor_b32 v5, 0x2000, v5
    s_memtime s[72:73]
    s_waitcnt lgkmcnt(0)
    buffer_store_dword v4, v5, s[8:11], s5 offen sc1
    s_waitcnt vmcnt(0)
    s_memtime s[74:75]
    s_waitcnt lgkmcnt(0)
    s_sub_u32 s74, s74, s72
    s_min_u32 s6, s6, s74
    v_xor_b32 v5, 0x2000, v5
    s_memtime s[72:73]
    s_waitcnt lgkmcnt(0)
    buffer_store_dword v4, v5, s[8:11], s5 offen sc1
    s_waitcnt vmcnt(0)
    s_memtime s[74:75]
    s_waitcnt lgkmcnt(0)
    s_sub_u32 s74, s74, s72
    s_min_u32 s7, s7, s74
    v_xor_b32 v5, 0x2000, v5
    s_cmp_lt_u32 s6, s7
    s_cselect_b32 s7, 2, 1
    v_mov_b32 v5, 0
    s_lshr_b32 s5, s4, 3
    s_and_b32 s4, s4, 7
    s_lshl_b32 s4, s4, 1
    s_or_b32 s4, s4, s5
    s_lshl_b32 s5, s4, 1
    s_add_u32 s5, s5, 160
    v_mov_b32 v4, s7
    buffer_store_short v4, v5, s[20:23], s5 offen sc1
    s_mov_b64 exec, -1
.calb_9:
    s_barrier
.nocal_8:
    s_lshl_b32 s4, s25, 11
    s_lshl_b32 s5, s26, 6
    s_add_u32 s4, s4, s5
    s_lshl_b32 s6, s24, 21
    s_add_u32 s4, s4, s6
    s_lshl_b32 s7, s25, 21
    s_lshl_b32 s6, s24, 19
    s_add_u32 s7, s7, s6
    s_add_u32 s7, s7, s5
    s_lshl_b32 s6, s24, 15
    v_bfe_u32 v4, v1, 4, 1
    v_lshlrev_b32 v4, 1, v4
    v_and_b32 v5, 3, v1
    v_xor_b32 v4, v4, v5
    v_lshlrev_b32 v4, 4, v4
    v_bfe_u32 v254, v1, 2, 1
    v_mul_u32_u24 v5, 1, v254
    v_bfe_u32 v254, v1, 3, 1
    v_mul_u32_u24 v254, 8, v254
    v_add_u32 v5, v5, v254
    v_bfe_u32 v254, v1, 4, 1
    v_mul_u32_u24 v254, 4, v254
    v_add_u32 v5, v5, v254
    v_bfe_u32 v254, v1, 5, 1
    v_mul_u32_u24 v254, 2, v254
    v_add_u32 v5, v5, v254
    v_lshlrev_b32 v6, 13, v5
    v_add_u32 v6, v6, v4
    v_add_u32 v240, s4, v6
    v_lshlrev_b32 v6, 11, v5
    v_add_u32 v6, v6, v4
    v_add_u32 v241, s7, v6
    v_xor_b32 v241, 256, v241
    v_bfe_u32 v254, v1, 2, 2
    v_mul_u32_u24 v242, 64, v254
    v_bfe_u32 v254, v1, 4, 1
    v_mul_u32_u24 v254, 288, v254
    v_add_u32 v242, v242, v254
    v_bfe_u32 v254, v1, 5, 1
    v_mul_u32_u24 v254, 1024, v254
    v_add_u32 v242, v242, v254
    v_bfe_u32 v254, v1, 0, 2
    v_mul_u32_u24 v254, 8, v254
    v_add_u32 v242, v242, v254
    v_add_u32 v242, s6, v242
    v_xor_b32 v243, 32, v242
    s_waitcnt lgkmcnt(0)
    s_mov_b32 s16, s84
    s_and_b32 s17, s85, 0xffff
    s_mov_b32 s18, 0x800000
    s_mov_b32 s19, 0x00020000
    v_xor_b32 v240, 128, v240
    s_and_b32 s4, s26, 1
    s_lshl_b32 s98, s4, 11
    s_lshl_b32 s99, s4, 18
    s_add_u32 s98, s98, s6
    s_xor_b32 m0, s98, 0
    s_xor_b32 s5, s99, 0
    buffer_load_dwordx4 v240, s[16:19], s5 offen nt lds
    s_xor_b32 m0, s98, 1024
    s_xor_b32 s5, s99, 131072
    buffer_load_dwordx4 v240, s[16:19], s5 offen nt lds
    s_xor_b32 m0, s98, 2048
    s_xor_b32 s5, s99, 262144
    buffer_load_dwordx4 v240, s[16:19], s5 offen nt lds
    s_xor_b32 m0, s98, 3072
    s_xor_b32 s5, s99, 393216
    buffer_load_dwordx4 v240, s[16:19], s5 offen nt lds
    s_xor_b32 m0, s98, 4096
    s_xor_b32 s5, s99, 524288
    buffer_load_dwordx4 v240, s[16:19], s5 offen nt lds
    s_xor_b32 m0, s98, 5120
    s_xor_b32 s5, s99, 655360
    buffer_load_dwordx4 v240, s[16:19], s5 offen nt lds
    s_xor_b32 m0, s98, 6144
    s_xor_b32 s5, s99, 786432
    buffer_load_dwordx4 v240, s[16:19], s5 offen nt lds
    s_xor_b32 m0, s98, 7168
    s_xor_b32 s5, s99, 917504
    buffer_load_dwordx4 v240, s[16:19], s5 offen nt lds
    s_xor_b32 m0, s98, 8192
    s_xor_b32 s5, s99, 1048576
    buffer_load_dwordx4 v240, s[16:19], s5 offen nt lds
    s_xor_b32 m0, s98, 9216
    s_xor_b32 s5, s99, 1179648
    buffer_load_dwordx4 v240, s[16:19], s5 offen nt lds
    s_xor_b32 m0, s98, 10240
    s_xor_b32 s5, s99, 1310720
    buffer_load_dwordx4 v240, s[16:19], s5 offen nt lds
    s_xor_b32 m0, s98, 11264
    s_xor_b32 s5, s99, 1441792
    buffer_load_dwordx4 v240, s[16:19], s5 offen nt lds
    s_xor_b32 m0, s98, 12288
    s_xor_b32 s5, s99, 1572864
    buffer_load_dwordx4 v240, s[16:19], s5 offen nt lds
    s_xor_b32 m0, s98, 13312
    s_xor_b32 s5, s99, 1703936
    buffer_load_dwordx4 v240, s[16:19], s5 offen nt lds
    s_xor_b32 m0, s98, 14336
    s_xor_b32 s5, s99, 1835008
    buffer_load_dwordx4 v240, s[16:19], s5 offen nt lds
    s_xor_b32 m0, s98, 15360
    s_xor_b32 s5, s99, 1966080
    buffer_load_dwordx4 v240, s[16:19], s5 offen nt lds
    s_waitcnt vmcnt(16)
    s_barrier
    s_cmp_lg_u32 s24, 1
    s_cbranch_scc1 .ns_10
    s_mov_b64 exec, 1
    v_mov_b32 v238, s3
    v_mov_b32 v239, 0
    buffer_atomic_add v238, v239, s[20:23], 0 offen offset:196 sc1
    s_mov_b64 exec, -1
.ns_10:
    s_mov_b32 s16, s86
    s_and_b32 s17, s87, 0xffff
    s_mov_b32 s18, 0x800000
    s_mov_b32 s19, 0x00020000
    v_xor_b32 v240, 0, v240
    s_and_b32 s4, s26, 1
    s_lshl_b32 s98, s4, 11
    s_lshl_b32 s99, s4, 18
    s_add_u32 s98, s98, s6
    s_xor_b32 m0, s98, 16384
    s_xor_b32 s5, s99, 0
    buffer_load_dwordx4 v240, s[16:19], s5 offen nt lds
    s_xor_b32 m0, s98, 17408
    s_xor_b32 s5, s99, 131072
    buffer_load_dwordx4 v240, s[16:19], s5 offen nt lds
    s_xor_b32 m0, s98, 18432
    s_xor_b32 s5, s99, 262144
    buffer_load_dwordx4 v240, s[16:19], s5 offen nt lds
    s_xor_b32 m0, s98, 19456
    s_xor_b32 s5, s99, 393216
    buffer_load_dwordx4 v240, s[16:19], s5 offen nt lds
    s_xor_b32 m0, s98, 20480
    s_xor_b32 s5, s99, 524288
    buffer_load_dwordx4 v240, s[16:19], s5 offen nt lds
    s_xor_b32 m0, s98, 21504
    s_xor_b32 s5, s99, 655360
    buffer_load_dwordx4 v240, s[16:19], s5 offen nt lds
    s_xor_b32 m0, s98, 22528
    s_xor_b32 s5, s99, 786432
    buffer_load_dwordx4 v240, s[16:19], s5 offen nt lds
    s_xor_b32 m0, s98, 23552
    s_xor_b32 s5, s99, 917504
    buffer_load_dwordx4 v240, s[16:19], s5 offen nt lds
    s_xor_b32 m0, s98, 24576
    s_xor_b32 s5, s99, 1048576
    buffer_load_dwordx4 v240, s[16:19], s5 offen nt lds
    s_xor_b32 m0, s98, 25600
    s_xor_b32 s5, s99, 1179648
    buffer_load_dwordx4 v240, s[16:19], s5 offen nt lds
    s_xor_b32 m0, s98, 26624
    s_xor_b32 s5, s99, 1310720
    buffer_load_dwordx4 v240, s[16:19], s5 offen nt lds
    s_xor_b32 m0, s98, 27648
    s_xor_b32 s5, s99, 1441792
    buffer_load_dwordx4 v240, s[16:19], s5 offen nt lds
    s_xor_b32 m0, s98, 28672
    s_xor_b32 s5, s99, 1572864
    buffer_load_dwordx4 v240, s[16:19], s5 offen nt lds
    s_xor_b32 m0, s98, 29696
    s_xor_b32 s5, s99, 1703936
    buffer_load_dwordx4 v240, s[16:19], s5 offen nt lds
    s_xor_b32 m0, s98, 30720
    s_xor_b32 s5, s99, 1835008
    buffer_load_dwordx4 v240, s[16:19], s5 offen nt lds
    s_xor_b32 m0, s98, 31744
    s_xor_b32 s5, s99, 1966080
    buffer_load_dwordx4 v240, s[16:19], s5 offen nt lds
    s_lshr_b32 s52, s26, 2
    s_and_b32 s53, s26, 3
    s_lshl_b32 s54, s25, 14
    s_lshl_b32 s55, s26, 9
    s_add_u32 s55, s55, s54
    s_lshl_b32 s56, s25, 3
    s_add_u32 s56, s56, s52
    s_lshl_b32 s57, s56, 12
    s_lshl_b32 s58, s53, 9
    s_add_u32 s58, s58, s57
    s_mov_b32 s48, 0x00ff00ff
    s_mov_b32 s49, 0x00ff00ff
    s_mov_b32 s50, 0xff00ff00
    s_mov_b32 s51, 0xff00ff00
    v_mov_b32 v2, 0x4444
    v_mov_b32 v4, 0xeeee
    s_lshl_b32 s4, s24, 12
    s_add_u32 s4, s4, s54
    s_mov_b32 vcc_lo, 0x33333333
    s_mov_b32 vcc_hi, 0x33333333
    v_cndmask_b32 v2, v4, v2, vcc
    v_bfe_u32 v254, v1, 0, 6
    v_mul_u32_u24 v3, 16, v254
    v_add_u32 v3, s4, v3
    v_add_u32 v4, 0x10000, v3
    s_mul_i32 s4, s24, 1152
    v_bfe_u32 v254, v1, 4, 1
    v_mul_u32_u24 v5, 576, v254
    v_bfe_u32 v254, v1, 5, 1
    v_mul_u32_u24 v254, 288, v254
    v_add_u32 v5, v5, v254
    v_bfe_u32 v254, v1, 0, 4
    v_mul_u32_u24 v254, 4, v254
    v_add_u32 v5, v5, v254
    v_add_u32 v5, s4, v5
    v_bfe_u32 v254, v1, 4, 1
    v_mul_u32_u24 v7, 576, v254
    v_bfe_u32 v254, v1, 5, 1
    v_mul_u32_u24 v254, 288, v254
    v_add_u32 v7, v7, v254
    v_bfe_u32 v254, v1, 0, 4
    v_mul_u32_u24 v254, 4, v254
    v_add_u32 v7, v7, v254
    v_add_u32 v7, 9472, v7
    v_add_u32 v7, s4, v7
    v_add_u32 v6, 4736, v5
    s_lshl_b32 s4, s24, 10
    v_bfe_u32 v254, v1, 0, 6
    v_mul_u32_u24 v8, 16, v254
    v_add_u32 v8, 14080, v8
    v_add_u32 v8, s4, v8
    s_and_b32 s4, s24, 1
    s_lshr_b32 s5, s24, 1
    s_lshl_b32 s59, s4, 6
    s_mul_i32 s60, s5, 4736
    s_add_u32 s59, s59, s60
    s_lshl_b32 s4, s4, 8
    s_add_u32 s60, s58, s4
    s_lshl_b32 s5, s5, 11
    s_add_u32 s61, s60, s5
    s_cmp_lt_u32 s24, 2
    s_cselect_b32 s5, 8, 1
    s_lshl_b32 s5, s5, 10
    s_xor_b32 s61, s61, s5
    v_bfe_u32 v254, v1, 2, 3
    v_mul_u32_u24 v9, 144, v254
    v_bfe_u32 v254, v1, 5, 1
    v_mul_u32_u24 v254, 32, v254
    v_add_u32 v9, v9, v254
    v_bfe_u32 v254, v1, 0, 2
    v_mul_u32_u24 v254, 8, v254
    v_add_u32 v9, v9, v254
    v_add_u32 v9, s59, v9
    v_bfe_u32 v254, v1, 0, 6
    v_mul_u32_u24 v10, 4, v254
    v_add_u32 v10, 131072, v10
    v_add_u32 v10, s61, v10
    v_bfe_u32 v254, v1, 0, 6
    v_mul_u32_u24 v11, 4, v254
    v_add_u32 v11, 18176, v11
    v_add_u32 v11, s4, v11
    s_lshl_b32 s4, s24, 2
    v_bfe_u32 v254, v1, 2, 1
    v_mul_u32_u24 v255, 1024, v254
    v_bfe_u32 v254, v1, 4, 1
    v_mul_u32_u24 v254, 512, v254
    v_add_u32 v255, v255, v254
    v_bfe_u32 v254, v1, 5, 1
    v_mul_u32_u24 v254, 256, v254
    v_add_u32 v255, v255, v254
    v_bfe_u32 v254, v1, 3, 1
    v_mul_u32_u24 v254, 64, v254
    v_add_u32 v255, v255, v254
    v_bfe_u32 v254, v1, 0, 2
    v_mul_u32_u24 v254, 16, v254
    v_add_u32 v255, v255, v254
    v_add_u32 v255, 20224, v255
    v_add_u32 v255, s4, v255
    v_mov_b32 v20, -1
    v_mov_b32 v21, -1
    v_mov_b32 v22, -1
    v_mov_b32 v23, -1
    v_mov_b32 v40, 0
    v_mov_b32 v41, 0
    v_mov_b32 v42, 0
    v_mov_b32 v43, 0
    v_mov_b32 v44, 0
    v_mov_b32 v45, 0
    v_mov_b32 v46, 0
    v_mov_b32 v47, 0
    v_mov_b32 v48, 0
    v_mov_b32 v49, 0
    v_mov_b32 v50, 0
    v_mov_b32 v51, 0
    v_mov_b32 v52, 0
    v_mov_b32 v53, 0
    v_mov_b32 v54, 0
    v_mov_b32 v55, 0
    v_mov_b32 v56, 0
    v_mov_b32 v57, 0
    v_mov_b32 v58, 0
    v_mov_b32 v59, 0
    v_mov_b32 v60, 0
    v_mov_b32 v61, 0
    v_mov_b32 v62, 0
    v_mov_b32 v63, 0
    v_mov_b32 v64, 0
    v_mov_b32 v65, 0
    v_mov_b32 v66, 0
    v_mov_b32 v67, 0
    v_mov_b32 v68, 0
    v_mov_b32 v69, 0
    v_mov_b32 v70, 0
    v_mov_b32 v71, 0
    v_bfe_u32 v254, v1, 0, 5
    v_mul_u32_u24 v244, 16, v254
    v_bfe_u32 v254, v1, 5, 1
    v_mul_u32_u24 v254, 2048, v254
    v_add_u32 v244, v244, v254
    v_add_u32 v244, 131072, v244
    v_add_u32 v244, s58, v244
    v_bfe_u32 v254, v1, 0, 5
    v_mul_u32_u24 v245, 16, v254
    v_bfe_u32 v254, v1, 5, 1
    v_mul_u32_u24 v254, 65536, v254
    v_add_u32 v245, v245, v254
    v_add_u32 v245, s55, v245
    s_lshl_b32 s4, s53, 10
    s_add_u32 s4, s4, s57
    v_bfe_u32 v254, v1, 0, 6
    v_mul_u32_u24 v246, 16, v254
    v_add_u32 v246, 131072, v246
    v_add_u32 v246, s4, v246
    v_subrev_u32 v237, 0x20000, v246
    v_lshrrev_b32 v237, 2, v237
    v_add_u32 v237, 262144, v237
    s_waitcnt vmcnt(16)
    ds_read_b64_tr_b16 a[0:1], v242 offset:0
    ds_read_b64_tr_b16 a[2:3], v242 offset:512
    ds_read_b64_tr_b16 a[4:5], v242 offset:2048
    ds_read_b64_tr_b16 a[6:7], v242 offset:2560
    ds_read_b64_tr_b16 a[8:9], v242 offset:4096
    ds_read_b64_tr_b16 a[10:11], v242 offset:4608
    ds_read_b64_tr_b16 a[12:13], v242 offset:6144
    ds_read_b64_tr_b16 a[14:15], v242 offset:6656
    ds_read_b64_tr_b16 a[16:17], v242 offset:8192
    ds_read_b64_tr_b16 a[18:19], v242 offset:8704
    ds_read_b64_tr_b16 a[20:21], v242 offset:10240
    ds_read_b64_tr_b16 a[22:23], v242 offset:10752
    ds_read_b64_tr_b16 a[24:25], v242 offset:12288
    ds_read_b64_tr_b16 a[26:27], v242 offset:12800
    ds_read_b64_tr_b16 a[28:29], v242 offset:14336
    ds_read_b64_tr_b16 a[30:31], v242 offset:14848
    ds_read_b64_tr_b16 a[32:33], v243 offset:0
    ds_read_b64_tr_b16 a[34:35], v243 offset:512
    ds_read_b64_tr_b16 a[36:37], v243 offset:2048
    ds_read_b64_tr_b16 a[38:39], v243 offset:2560
    ds_read_b64_tr_b16 a[40:41], v243 offset:4096
    ds_read_b64_tr_b16 a[42:43], v243 offset:4608
    ds_read_b64_tr_b16 a[44:45], v243 offset:6144
    ds_read_b64_tr_b16 a[46:47], v243 offset:6656
    ds_read_b64_tr_b16 a[48:49], v243 offset:8192
    ds_read_b64_tr_b16 a[50:51], v243 offset:8704
    ds_read_b64_tr_b16 a[52:53], v243 offset:10240
    ds_read_b64_tr_b16 a[54:55], v243 offset:10752
    ds_read_b64_tr_b16 a[56:57], v243 offset:12288
    ds_read_b64_tr_b16 a[58:59], v243 offset:12800
    ds_read_b64_tr_b16 a[60:61], v243 offset:14336
    ds_read_b64_tr_b16 a[62:63], v243 offset:14848
    s_waitcnt lgkmcnt(0)
    s_mov_b32 s16, s88
    s_and_b32 s17, s89, 0xffff
    s_mov_b32 s18, 0x800000
    s_mov_b32 s19, 0x00020000
    v_xor_b32 v240, 128, v240
    s_and_b32 s4, s26, 1
    s_lshl_b32 s98, s4, 11
    s_lshl_b32 s99, s4, 18
    s_add_u32 s98, s98, s6
    s_xor_b32 m0, s98, 0
    s_xor_b32 s5, s99, 0
    buffer_load_dwordx4 v240, s[16:19], s5 offen nt lds
    s_xor_b32 m0, s98, 1024
    s_xor_b32 s5, s99, 131072
    buffer_load_dwordx4 v240, s[16:19], s5 offen nt lds
    s_xor_b32 m0, s98, 2048
    s_xor_b32 s5, s99, 262144
    buffer_load_dwordx4 v240, s[16:19], s5 offen nt lds
    s_xor_b32 m0, s98, 3072
    s_xor_b32 s5, s99, 393216
    buffer_load_dwordx4 v240, s[16:19], s5 offen nt lds
    s_xor_b32 m0, s98, 4096
    s_xor_b32 s5, s99, 524288
    buffer_load_dwordx4 v240, s[16:19], s5 offen nt lds
    s_xor_b32 m0, s98, 5120
    s_xor_b32 s5, s99, 655360
    buffer_load_dwordx4 v240, s[16:19], s5 offen nt lds
    s_xor_b32 m0, s98, 6144
    s_xor_b32 s5, s99, 786432
    buffer_load_dwordx4 v240, s[16:19], s5 offen nt lds
    s_xor_b32 m0, s98, 7168
    s_xor_b32 s5, s99, 917504
    buffer_load_dwordx4 v240, s[16:19], s5 offen nt lds
    s_xor_b32 m0, s98, 8192
    s_xor_b32 s5, s99, 1048576
    buffer_load_dwordx4 v240, s[16:19], s5 offen nt lds
    s_xor_b32 m0, s98, 9216
    s_xor_b32 s5, s99, 1179648
    buffer_load_dwordx4 v240, s[16:19], s5 offen nt lds
    s_xor_b32 m0, s98, 10240
    s_xor_b32 s5, s99, 1310720
    buffer_load_dwordx4 v240, s[16:19], s5 offen nt lds
    s_xor_b32 m0, s98, 11264
    s_xor_b32 s5, s99, 1441792
    buffer_load_dwordx4 v240, s[16:19], s5 offen nt lds
    s_xor_b32 m0, s98, 12288
    s_xor_b32 s5, s99, 1572864
    buffer_load_dwordx4 v240, s[16:19], s5 offen nt lds
    s_xor_b32 m0, s98, 13312
    s_xor_b32 s5, s99, 1703936
    buffer_load_dwordx4 v240, s[16:19], s5 offen nt lds
    s_xor_b32 m0, s98, 14336
    s_xor_b32 s5, s99, 1835008
    buffer_load_dwordx4 v240, s[16:19], s5 offen nt lds
    s_xor_b32 m0, s98, 15360
    s_xor_b32 s5, s99, 1966080
    buffer_load_dwordx4 v240, s[16:19], s5 offen nt lds
    s_waitcnt vmcnt(16)
    ds_read_b64_tr_b16 a[64:65], v242 offset:16384
    ds_read_b64_tr_b16 a[66:67], v242 offset:16896
    ds_read_b64_tr_b16 a[68:69], v242 offset:18432
    ds_read_b64_tr_b16 a[70:71], v242 offset:18944
    ds_read_b64_tr_b16 a[72:73], v242 offset:20480
    ds_read_b64_tr_b16 a[74:75], v242 offset:20992
    ds_read_b64_tr_b16 a[76:77], v242 offset:22528
    ds_read_b64_tr_b16 a[78:79], v242 offset:23040
    ds_read_b64_tr_b16 a[80:81], v242 offset:24576
    ds_read_b64_tr_b16 a[82:83], v242 offset:25088
    ds_read_b64_tr_b16 a[84:85], v242 offset:26624
    ds_read_b64_tr_b16 a[86:87], v242 offset:27136
    ds_read_b64_tr_b16 a[88:89], v242 offset:28672
    ds_read_b64_tr_b16 a[90:91], v242 offset:29184
    ds_read_b64_tr_b16 a[92:93], v242 offset:30720
    ds_read_b64_tr_b16 a[94:95], v242 offset:31232
    ds_read_b64_tr_b16 a[96:97], v243 offset:16384
    ds_read_b64_tr_b16 a[98:99], v243 offset:16896
    ds_read_b64_tr_b16 a[100:101], v243 offset:18432
    ds_read_b64_tr_b16 a[102:103], v243 offset:18944
    ds_read_b64_tr_b16 a[104:105], v243 offset:20480
    ds_read_b64_tr_b16 a[106:107], v243 offset:20992
    ds_read_b64_tr_b16 a[108:109], v243 offset:22528
    ds_read_b64_tr_b16 a[110:111], v243 offset:23040
    ds_read_b64_tr_b16 a[112:113], v243 offset:24576
    ds_read_b64_tr_b16 a[114:115], v243 offset:25088
    ds_read_b64_tr_b16 a[116:117], v243 offset:26624
    ds_read_b64_tr_b16 a[118:119], v243 offset:27136
    ds_read_b64_tr_b16 a[120:121], v243 offset:28672
    ds_read_b64_tr_b16 a[122:123], v243 offset:29184
    ds_read_b64_tr_b16 a[124:125], v243 offset:30720
    ds_read_b64_tr_b16 a[126:127], v243 offset:31232
    s_waitcnt lgkmcnt(0)
    v_or_b32 v239, 32, v1
    v_lshlrev_b32 v239, 2, v239
    buffer_load_dword v238, v239, s[20:23], 0 offen sc1
    s_mov_b32 s12, s40
    s_and_b32 s13, s41, 0xffff
    s_mov_b32 s14, 0x4000
    s_mov_b32 s15, 0x00020000
    s_xor_b32 s4, s26, 4
    s_lshl_b32 s4, s4, 6
    v_bfe_u32 v254, v1, 1, 1
    v_mul_u32_u24 v247, 2048, v254
    v_bfe_u32 v254, v1, 5, 1
    v_mul_u32_u24 v254, 4096, v254
    v_add_u32 v247, v247, v254
    v_bfe_u32 v254, v1, 3, 1
    v_mul_u32_u24 v254, 8192, v254
    v_add_u32 v247, v247, v254
    v_bfe_u32 v254, v1, 4, 1
    v_mul_u32_u24 v254, 16, v254
    v_add_u32 v247, v247, v254
    v_bfe_u32 v254, v1, 2, 1
    v_mul_u32_u24 v254, 32, v254
    v_add_u32 v247, v247, v254
    v_bfe_u32 v254, v1, 0, 1
    v_mul_u32_u24 v254, 8, v254
    v_add_u32 v247, v247, v254
    buffer_load_dwordx2 v[248:249], v247, s[12:15], s4 offen
    s_mov_b32 s16, s90
    s_and_b32 s17, s91, 0xffff
    s_mov_b32 s18, 0x800000
    s_mov_b32 s19, 0x00020000
    s_and_b32 s4, s26, 1
    s_lshl_b32 s98, s4, 11
    s_lshl_b32 s99, s4, 16
    s_add_u32 s98, s98, s6
    s_xor_b32 m0, s98, 16384
    s_xor_b32 s5, s99, 0
    buffer_load_dwordx4 v241, s[16:19], s5 offen nt lds
    s_xor_b32 m0, s98, 17408
    s_xor_b32 s5, s99, 32768
    buffer_load_dwordx4 v241, s[16:19], s5 offen nt lds
    s_xor_b32 m0, s98, 18432
    s_xor_b32 s5, s99, 65536
    buffer_load_dwordx4 v241, s[16:19], s5 offen nt lds
    s_xor_b32 m0, s98, 19456
    s_xor_b32 s5, s99, 98304
    buffer_load_dwordx4 v241, s[16:19], s5 offen nt lds
    s_xor_b32 m0, s98, 20480
    s_xor_b32 s5, s99, 131072
    buffer_load_dwordx4 v241, s[16:19], s5 offen nt lds
    s_xor_b32 m0, s98, 21504
    s_xor_b32 s5, s99, 163840
    buffer_load_dwordx4 v241, s[16:19], s5 offen nt lds
    s_xor_b32 m0, s98, 22528
    s_xor_b32 s5, s99, 196608
    buffer_load_dwordx4 v241, s[16:19], s5 offen nt lds
    s_xor_b32 m0, s98, 23552
    s_xor_b32 s5, s99, 229376
    buffer_load_dwordx4 v241, s[16:19], s5 offen nt lds
    s_xor_b32 m0, s98, 24576
    s_xor_b32 s5, s99, 262144
    buffer_load_dwordx4 v241, s[16:19], s5 offen nt lds
    s_xor_b32 m0, s98, 25600
    s_xor_b32 s5, s99, 294912
    buffer_load_dwordx4 v241, s[16:19], s5 offen nt lds
    s_xor_b32 m0, s98, 26624
    s_xor_b32 s5, s99, 327680
    buffer_load_dwordx4 v241, s[16:19], s5 offen nt lds
    s_xor_b32 m0, s98, 27648
    s_xor_b32 s5, s99, 360448
    buffer_load_dwordx4 v241, s[16:19], s5 offen nt lds
    s_xor_b32 m0, s98, 28672
    s_xor_b32 s5, s99, 393216
    buffer_load_dwordx4 v241, s[16:19], s5 offen nt lds
    s_xor_b32 m0, s98, 29696
    s_xor_b32 s5, s99, 425984
    buffer_load_dwordx4 v241, s[16:19], s5 offen nt lds
    s_xor_b32 m0, s98, 30720
    s_xor_b32 s5, s99, 458752
    buffer_load_dwordx4 v241, s[16:19], s5 offen nt lds
    s_xor_b32 m0, s98, 31744
    s_xor_b32 s5, s99, 491520
    buffer_load_dwordx4 v241, s[16:19], s5 offen nt lds
    s_waitcnt vmcnt(16)
    s_cmp_lg_u32 s27, 0
    s_cbranch_scc1 .vd_12
    s_mov_b32 s62, 0
.vp_11:
    v_readlane_b32 s4, v238, 49
    s_and_b32 s5, s4, 0xffff
    s_cmp_ge_u32 s5, 256
    s_cbranch_scc1 .va_13
    s_add_u32 s62, s62, 1
    s_cmp_gt_u32 s62, 0x100000
    s_cbranch_scc1 .mg_end_1
    s_sleep 16
    buffer_load_dword v238, v239, s[20:23], 0 offen sc1
    s_waitcnt vmcnt(0)
    s_branch .vp_11
.va_13:
    s_lshr_b32 s4, s4, 16
    s_cbranch_scc0 .vd_12
    s_lshr_b32 s25, s2, 5
    s_and_b32 s26, s2, 31
    s_mov_b32 s27, 1
    s_waitcnt vmcnt(0) lgkmcnt(0)
    s_barrier
    s_branch .mg_role_3
.vd_12:
    ds_read_b64_tr_b16 a[128:129], v242 offset:0
    ds_read_b64_tr_b16 a[130:131], v242 offset:512
    ds_read_b64_tr_b16 a[132:133], v242 offset:2048
    ds_read_b64_tr_b16 a[134:135], v242 offset:2560
    ds_read_b64_tr_b16 a[136:137], v242 offset:4096
    ds_read_b64_tr_b16 a[138:139], v242 offset:4608
    ds_read_b64_tr_b16 a[140:141], v242 offset:6144
    ds_read_b64_tr_b16 a[142:143], v242 offset:6656
    ds_read_b64_tr_b16 a[144:145], v242 offset:8192
    ds_read_b64_tr_b16 a[146:147], v242 offset:8704
    ds_read_b64_tr_b16 a[148:149], v242 offset:10240
    ds_read_b64_tr_b16 a[150:151], v242 offset:10752
    ds_read_b64_tr_b16 a[152:153], v242 offset:12288
    ds_read_b64_tr_b16 a[154:155], v242 offset:12800
    ds_read_b64_tr_b16 a[156:157], v242 offset:14336
    ds_read_b64_tr_b16 a[158:159], v242 offset:14848
    ds_read_b64_tr_b16 a[160:161], v243 offset:0
    ds_read_b64_tr_b16 a[162:163], v243 offset:512
    ds_read_b64_tr_b16 a[164:165], v243 offset:2048
    ds_read_b64_tr_b16 a[166:167], v243 offset:2560
    ds_read_b64_tr_b16 a[168:169], v243 offset:4096
    ds_read_b64_tr_b16 a[170:171], v243 offset:4608
    ds_read_b64_tr_b16 a[172:173], v243 offset:6144
    ds_read_b64_tr_b16 a[174:175], v243 offset:6656
    ds_read_b64_tr_b16 a[176:177], v243 offset:8192
    ds_read_b64_tr_b16 a[178:179], v243 offset:8704
    ds_read_b64_tr_b16 a[180:181], v243 offset:10240
    ds_read_b64_tr_b16 a[182:183], v243 offset:10752
    ds_read_b64_tr_b16 a[184:185], v243 offset:12288
    ds_read_b64_tr_b16 a[186:187], v243 offset:12800
    ds_read_b64_tr_b16 a[188:189], v243 offset:14336
    ds_read_b64_tr_b16 a[190:191], v243 offset:14848
    s_waitcnt lgkmcnt(0)
    s_mov_b32 s63, 0
    s_cmp_lg_u32 s27, 0
    s_cbranch_scc1 .cd_15
    s_mov_b32 s62, 0
.cp_14:
    v_and_b32 v18, 0xffff, v238
    v_lshrrev_b32 v19, 16, v238
    v_min_u32 v17, v18, v19
    v_cmp_eq_u32 vcc, 0, v17
    s_and_b32 s4, vcc_hi, 65280
    s_cbranch_scc0 .cg_16
    s_add_u32 s62, s62, 1
    s_cmp_gt_u32 s62, 0x100000
    s_cbranch_scc1 .mg_end_1
    s_sleep 16
    buffer_load_dword v238, v239, s[20:23], 0 offen sc1
    s_waitcnt vmcnt(0)
    s_branch .cp_14
.cg_16:
    v_cmp_eq_u32 vcc, 2, v18
    s_bfe_u32 s63, vcc_hi, 524296
    v_cmp_eq_u32 vcc, 2, v19
    s_bfe_u32 s4, vcc_hi, 524296
    s_lshl_b32 s4, s4, 8
    s_or_b32 s63, s63, s4
    s_xor_b32 s4, s63, 0xaaaa
    s_bcnt1_i32_b32 s4, s4
    s_cmp_le_u32 s4, 3
    s_cselect_b32 s63, 0xaaaa, s63
    s_cmp_ge_u32 s4, 13
    s_cselect_b32 s63, 0x5555, s63
.cd_15:
    s_cmp_lg_u32 s27, 0
    s_cbranch_scc1 .slowv_17
    s_mov_b32 s28, 0
    s_mov_b32 s30, 83886080
    s_mov_b32 s31, 84180992
    s_mov_b32 s32, 84475904
    s_mov_b32 s33, 84770816
    s_mov_b32 s41, 66977792
    s_lshl_b32 s42, s56, 13
    s_lshl_b32 s4, s53, 11
    s_add_u32 s44, s42, s4
    s_add_u32 s44, s44, 33554432
    s_add_u32 s42, s42, 16777216
    s_xor_b32 s4, s53, 2
    s_lshl_b32 s4, s4, 10
    s_add_u32 s42, s42, s4
    s_add_u32 s43, s42, 4096
    s_add_u32 s96, s44, 524288
    s_sub_u32 s95, s96, 16777216
    s_mov_b32 s62, 0
    s_mov_b32 s45, 0x3e0293ee
    s_mov_b32 s46, 0
    s_and_b32 s4, s25, 1
    s_lshl_b32 s4, s4, 14
    s_lshr_b32 s5, s25, 1
    s_lshl_b32 s5, s5, 12
    s_or_b32 s4, s4, s5
    s_xor_b32 s47, s47, s4
    s_and_b32 s5, s26, 1
    s_lshl_b32 s5, s5, 11
    s_lshr_b32 s4, s26, 1
    s_lshl_b32 s4, s4, 15
    s_or_b32 s5, s5, s4
    s_bfe_u32 s4, s26, 0x10004
    s_lshl_b32 s4, s4, 11
    s_xor_b32 s5, s5, s4
    s_xor_b32 s34, s5, s47
    s_xor_b32 s35, s34, 0x84000
    s_xor_b32 s36, s34, 0x101000
    s_xor_b32 s37, s34, 0x185000
    s_and_b32 s4, s25, 1
    s_lshl_b32 s35, s4, 14
    s_lshr_b32 s4, s25, 1
    s_lshl_b32 s4, s4, 12
    s_or_b32 s35, s35, s4
    s_and_b32 s4, s26, 1
    s_lshl_b32 s4, s4, 11
    s_or_b32 s35, s35, s4
    s_lshr_b32 s4, s26, 1
    s_lshl_b32 s4, s4, 15
    s_or_b32 s35, s35, s4
    s_cmp_eq_u32 s24, 1
    s_cbranch_scc1 .w1_19
    s_cmp_eq_u32 s24, 2
    s_cbranch_scc1 .w2_20
    s_cmp_eq_u32 s24, 3
    s_cbranch_scc1 .w3_21
.w0_18:
    v_bfe_u32 v254, v1, 4, 1
    v_mul_u32_u24 v168, 1024, v254
    v_bfe_u32 v254, v1, 5, 1
    v_mul_u32_u24 v254, 128, v254
    v_add_u32 v168, v168, v254
    v_bfe_u32 v254, v1, 3, 1
    v_mul_u32_u24 v254, 64, v254
    v_add_u32 v168, v168, v254
    v_bfe_u32 v254, v1, 0, 2
    v_mul_u32_u24 v254, 16, v254
    v_add_u32 v168, v168, v254
    v_bfe_u32 v254, v1, 2, 1
    v_mul_u32_u24 v254, 8, v254
    v_add_u32 v168, v168, v254
    v_add_u32 v168, s101, v168
    v_bfe_u32 v254, v1, 0, 1
    v_mul_u32_u24 v9, 144, v254
    v_bfe_u32 v254, v1, 1, 1
    v_mul_u32_u24 v254, 576, v254
    v_add_u32 v9, v9, v254
    v_bfe_u32 v254, v1, 2, 1
    v_mul_u32_u24 v254, 288, v254
    v_add_u32 v9, v9, v254
    v_bfe_u32 v254, v1, 3, 1
    v_mul_u32_u24 v254, 1152, v254
    v_add_u32 v9, v9, v254
    v_bfe_u32 v254, v1, 4, 2
    v_mul_u32_u24 v254, 32, v254
    v_add_u32 v9, v9, v254
    s_lshl_b32 s4, s56, 10
    v_bfe_u32 v254, v1, 0, 6
    v_mul_u32_u24 v13, 16, v254
    v_add_u32 v13, 262144, v13
    v_add_u32 v13, s4, v13
    v_xor_b32 v156, 1024, v246
    v_xor_b32 v157, 2048, v246
    v_xor_b32 v158, 3072, v246
    v_bfe_u32 v254, v1, 0, 1
    v_mul_u32_u24 v14, 16, v254
    v_bfe_u32 v254, v1, 4, 1
    v_mul_u32_u24 v254, 32, v254
    v_add_u32 v14, v14, v254
    v_bfe_u32 v254, v1, 1, 2
    v_mul_u32_u24 v254, 64, v254
    v_add_u32 v14, v14, v254
    v_bfe_u32 v254, v1, 5, 1
    v_mul_u32_u24 v254, 256, v254
    v_add_u32 v14, v14, v254
    v_add_u32 v14, 65536, v14
    v_add_u32 v14, s55, v14
    v_bfe_u32 v254, v1, 0, 6
    v_mul_u32_u24 v15, 16, v254
    v_bfe_u32 v254, v1, 2, 2
    v_mul_u32_u24 v16, 128, v254
    v_bfe_u32 v254, v1, 0, 2
    v_mul_u32_u24 v254, 16, v254
    v_add_u32 v16, v16, v254
    v_bfe_u32 v254, v1, 4, 2
    v_mul_u32_u24 v254, 4, v254
    v_add_u32 v16, v16, v254
    v_add_u32 v16, 18688, v16
    v_mov_b32 v208, 0
    v_mov_b32 v209, 0
    v_mov_b32 v210, 0
    v_mov_b32 v211, 0
    v_mov_b32 v212, 0
    v_mov_b32 v213, 0
    v_mov_b32 v214, 0
    v_mov_b32 v215, 0
    v_mov_b32 v216, 0
    v_mov_b32 v217, 0
    v_mov_b32 v218, 0
    v_mov_b32 v219, 0
    s_mov_b64 s[50:51], s[48:49]
    v_mov_b32 v164, 0
    v_mov_b32 v165, 0
    v_mov_b32 v166, 0
    v_mov_b32 v167, 0
    v_mov_b32 v164, 0x3f803f80
    v_mov_b32 v200, s45
    v_mov_b32 v220, 0x3f803f80
    v_mov_b32 v201, s45
    v_mov_b32 v221, 0x3f803f80
    v_mov_b32 v202, s45
    v_mov_b32 v222, 0x3f803f80
    v_mov_b32 v203, s45
    v_mov_b32 v223, 0x3f803f80
    buffer_load_dwordx4 v[24:27], v246, s[8:11], s30 offen sc1
    buffer_load_dwordx4 v[28:31], v245, s[8:11], s30 offen sc1
    buffer_load_dword v32, v237, s[8:11], s30 offen sc1
    s_waitcnt vmcnt(0)
    ds_read_b64_tr_b16 a[192:193], v242 offset:16384
    ds_read_b64_tr_b16 a[194:195], v242 offset:16896
    ds_read_b64_tr_b16 a[196:197], v242 offset:18432
    ds_read_b64_tr_b16 a[198:199], v242 offset:18944
    ds_read_b64_tr_b16 a[200:201], v242 offset:20480
    ds_read_b64_tr_b16 a[202:203], v242 offset:20992
    ds_read_b64_tr_b16 a[204:205], v242 offset:22528
    ds_read_b64_tr_b16 a[206:207], v242 offset:23040
    ds_read_b64_tr_b16 a[208:209], v242 offset:24576
    ds_read_b64_tr_b16 a[210:211], v242 offset:25088
    ds_read_b64_tr_b16 a[212:213], v242 offset:26624
    ds_read_b64_tr_b16 a[214:215], v242 offset:27136
    ds_read_b64_tr_b16 a[216:217], v242 offset:28672
    ds_read_b64_tr_b16 a[218:219], v242 offset:29184
    ds_read_b64_tr_b16 a[220:221], v242 offset:30720
    ds_read_b64_tr_b16 a[222:223], v242 offset:31232
    ds_read_b64_tr_b16 a[224:225], v243 offset:16384
    ds_read_b64_tr_b16 a[226:227], v243 offset:16896
    ds_read_b64_tr_b16 a[228:229], v243 offset:18432
    ds_read_b64_tr_b16 a[230:231], v243 offset:18944
    ds_read_b64_tr_b16 a[232:233], v243 offset:20480
    ds_read_b64_tr_b16 a[234:235], v243 offset:20992
    ds_read_b64_tr_b16 a[236:237], v243 offset:22528
    ds_read_b64_tr_b16 a[238:239], v243 offset:23040
    ds_read_b64_tr_b16 a[240:241], v243 offset:24576
    ds_read_b64_tr_b16 a[242:243], v243 offset:25088
    ds_read_b64_tr_b16 a[244:245], v243 offset:26624
    ds_read_b64_tr_b16 a[246:247], v243 offset:27136
    ds_read_b64_tr_b16 a[248:249], v243 offset:28672
    ds_read_b64_tr_b16 a[250:251], v243 offset:29184
    ds_read_b64_tr_b16 a[252:253], v243 offset:30720
    ds_read_b64_tr_b16 a[254:255], v243 offset:31232
    s_waitcnt lgkmcnt(0)
    s_barrier
    buffer_load_dwordx4 v[104:107], v15, s[8:11], s42 offen offset:0
    buffer_load_dwordx4 v[120:123], v15, s[8:11], s43 offen offset:0
    buffer_load_dwordx4 v[136:139], v15, s[8:11], s44 offen offset:0
    buffer_load_dwordx4 v[140:143], v15, s[8:11], s44 offen offset:1024
    s_add_u32 s42, s42, 262144
    s_add_u32 s43, s43, 262144
    s_add_u32 s44, s44, 262144
    s_add_u32 s37, s28, 0
    s_bitcmp1_b32 s37, 0
    s_cselect_b32 s4, 0x84000, 0
    s_xor_b32 s34, s35, s4
    s_bitcmp1_b32 s37, 1
    s_cselect_b32 s4, 0x101000, 0
    s_xor_b32 s34, s34, s4
    s_lshr_b32 s37, s37, 2
    s_bitcmp1_b32 s63, s37
    s_cselect_b32 s4, 0x2000, 0
    s_xor_b32 s34, s34, s4
    s_lshl_b32 s37, s37, 21
    s_add_u32 s34, s34, s37
.p2align 6
.step_24:
    s_barrier
    s_setprio 3
    buffer_load_dwordx4 v[24:27], v3, s[8:11], s30 offen offset:0 sc1
    s_setprio 2
    buffer_load_dwordx4 v[28:31], v3, s[8:11], s30 offen offset:1024 sc1
    s_setprio 1
    buffer_load_dwordx4 v[32:35], v3, s[8:11], s30 offen offset:2048 sc1
    s_setprio 0
    buffer_load_dwordx4 v[36:39], v3, s[8:11], s30 offen offset:3072 sc1
    s_call_b64 s[98:99], .gm_22
    v_pk_add_f32 v[40:41], v[40:41], v[42:43]
    v_pk_add_f32 v[42:43], v[44:45], v[46:47]
    ds_write2_b32 v5, v40, v41 offset0:0 offset1:36
    ds_write2_b32 v5, v42, v43 offset0:16 offset1:52
    s_nop 1
    v_pk_add_f32 v[48:49], v[48:49], v[50:51]
    v_pk_add_f32 v[50:51], v[52:53], v[54:55]
    ds_write2_b32 v6, v48, v49 offset0:0 offset1:36
    ds_write2_b32 v6, v50, v51 offset0:16 offset1:52
    s_waitcnt lgkmcnt(2)
    s_barrier
    ds_read_b128 v[72:75], v9 offset:0
    ds_read_b128 v[76:79], v9 offset:2304
    ds_read_b128 v[80:83], v9 offset:16
    ds_read_b128 v[84:87], v9 offset:2320
    v_smfmac_f32_16x16x64_bf16 v[56:59], v[24:27], a[128:135], v2
    v_smfmac_f32_16x16x64_bf16 v[60:63], v[24:27], a[160:167], v2
    s_waitcnt lgkmcnt(4)
    s_barrier
    v_smfmac_f32_16x16x64_bf16 v[56:59], v[28:31], a[136:143], v2
    s_waitcnt lgkmcnt(2)
    v_pk_add_f32 v[72:73], v[72:73], v[76:77]
    v_pk_add_f32 v[74:75], v[74:75], v[78:79]
    v_cvt_pk_bf16_f32 v144, v72, v73
    v_cvt_pk_bf16_f32 v145, v74, v75
    s_waitcnt lgkmcnt(0)
    v_pk_add_f32 v[80:81], v[80:81], v[84:85]
    v_pk_add_f32 v[82:83], v[82:83], v[86:87]
    v_cvt_pk_bf16_f32 v146, v80, v81
    v_cvt_pk_bf16_f32 v147, v82, v83
    s_nop 1
    v_mfma_f32_16x16x32_bf16 v[192:195], v[104:107], v[144:147], 0
    v_mfma_f32_16x16x32_bf16 v[160:163], v[120:123], v[144:147], 0
    v_smfmac_f32_16x16x64_bf16 v[60:63], v[28:31], a[168:175], v2
    v_add_f32_dpp v151, v195, v195 row_ror:8 row_mask:0xf bank_mask:0x3
    v_add_f32_dpp v148, v192, v192 row_ror:8 row_mask:0xf bank_mask:0x3
    v_add_f32_dpp v149, v193, v193 row_ror:8 row_mask:0xf bank_mask:0x3
    v_add_f32_dpp v150, v194, v194 row_ror:8 row_mask:0xf bank_mask:0x3
    v_add_f32_dpp v151, v163, v163 row_ror:8 row_mask:0xf bank_mask:0xc
    v_add_f32_dpp v148, v160, v160 row_ror:8 row_mask:0xf bank_mask:0xc
    v_add_f32_dpp v149, v161, v161 row_ror:8 row_mask:0xf bank_mask:0xc
    v_add_f32_dpp v150, v162, v162 row_ror:8 row_mask:0xf bank_mask:0xc
    v_min_u32 v151, 0xfffffffe, v151
    buffer_store_dwordx4 v[148:151], v246, s[8:11], s30 offen
    v_smfmac_f32_16x16x64_bf16 v[56:59], v[32:35], a[144:151], v2
    v_smfmac_f32_16x16x64_bf16 v[60:63], v[32:35], a[176:183], v2
    v_smfmac_f32_16x16x64_bf16 v[56:59], v[36:39], a[152:159], v2
    v_smfmac_f32_16x16x64_bf16 v[60:63], v[36:39], a[184:191], v2
    v_mov_b32 v40, 0
    v_mov_b32 v41, 0
    v_mov_b32 v42, 0
    v_mov_b32 v43, 0
    v_mov_b32 v44, 0
    v_mov_b32 v45, 0
    v_mov_b32 v46, 0
    v_mov_b32 v47, 0
    v_pk_add_f32 v[56:57], v[56:57], v[58:59]
    v_pk_add_f32 v[58:59], v[60:61], v[62:63]
    v_cvt_pk_bf16_f32 v60, v56, v57
    v_cvt_pk_bf16_f32 v61, v58, v59
    ds_write2_b32 v255, v60, v61 offset0:0 offset1:32
    ds_write_b128 v8, v[56:59]
    s_cmp_eq_u32 s28, 63
    s_cbranch_scc1 .fin_25
    buffer_load_dwordx4 v[176:179], v13, s[8:11], s30 offen sc1
    buffer_load_dwordx4 v[180:183], v156, s[8:11], s30 offen sc1
    buffer_load_dwordx4 v[184:187], v157, s[8:11], s30 offen sc1
    buffer_load_dwordx4 v[188:191], v158, s[8:11], s30 offen sc1
    s_waitcnt lgkmcnt(0)
    s_barrier
    ds_read_b128 v[212:215], v15 offset:20224
    ds_read_b128 v[216:219], v15 offset:21248
    v_mov_b32 v48, 0
    v_mov_b32 v49, 0
    v_mov_b32 v50, 0
    v_mov_b32 v51, 0
    v_mov_b32 v52, 0
    v_mov_b32 v53, 0
    v_mov_b32 v54, 0
    v_mov_b32 v55, 0
    v_mov_b32 v56, 0
    v_mov_b32 v57, 0
    v_mov_b32 v58, 0
    v_mov_b32 v59, 0
    v_mov_b32 v60, 0
    v_mov_b32 v61, 0
    v_mov_b32 v62, 0
    v_mov_b32 v63, 0
    buffer_load_dwordx4 v[72:75], v13, s[8:11], s30 offen sc1
    buffer_load_dwordx4 v[76:79], v156, s[8:11], s30 offen sc1
    buffer_load_dwordx4 v[80:83], v157, s[8:11], s30 offen sc1
    buffer_load_dwordx4 v[84:87], v158, s[8:11], s30 offen sc1
.mf_26:
    s_waitcnt vmcnt(7)
    v_max3_u32 v18, v176, v177, v178
    v_pk_add_f32 v[196:197], v[176:177], v[178:179]
    s_waitcnt vmcnt(6)
    v_max3_u32 v18, v18, v179, v183
    v_pk_add_f32 v[192:193], v[148:149], v[180:181]
    v_pk_add_f32 v[194:195], v[150:151], v[182:183]
    v_add_f32 v196, v196, v197
    s_waitcnt vmcnt(5)
    v_pk_add_f32 v[192:193], v[192:193], v[184:185]
    v_pk_add_f32 v[194:195], v[194:195], v[186:187]
    s_waitcnt vmcnt(4)
    v_max3_u32 v18, v18, v187, v191
    v_pk_add_f32 v[192:193], v[192:193], v[188:189]
    v_pk_add_f32 v[194:195], v[194:195], v[190:191]
    v_cmp_eq_u32 vcc, -1, v18
    v_max3_f32 v19, v192, v193, v196
    v_max3_f32 v19, v19, v194, v195
    s_cbranch_vccnz .re_27
.sj_28:
    s_nop 0
    v_max_f32_dpp v18, v19, v19 row_ror:8 row_mask:0xf bank_mask:0xf
    v_max_f32_dpp v17, v19, v19 row_ror:8 row_mask:0xf bank_mask:0xf
    s_nop 1
    v_permlane16_swap_b32 v18, v17
    v_max_f32 v19, v18, v17
    v_max_f32 v18, v18, v17
    s_nop 1
    v_permlane32_swap_b32 v18, v19
    v_max_f32 v18, v18, v19
    v_mul_f32 v18, s45, v18
    v_fma_f32 v244, v196, s45, -v18
    v_pk_fma_f32 v[240:241], v[192:193], v[200:201], v[18:19] op_sel_hi:[1,1,0] neg_lo:[0,0,1] neg_hi:[0,0,1]
    v_exp_f32 v244, v244
    v_pk_fma_f32 v[242:243], v[194:195], v[200:201], v[18:19] op_sel_hi:[1,1,0] neg_lo:[0,0,1] neg_hi:[0,0,1]
    v_exp_f32 v240, v240
    v_mov_b32_dpp v245, v244 row_ror:8 row_mask:0xf bank_mask:0xf
    v_cvt_pk_bf16_f32 v208, v244, v245
    v_cvt_pk_bf16_f32 v209, v244, v245
    v_pk_mov_b32 v[210:211], v[208:209], v[208:209] op_sel:[0,1]
    v_exp_f32 v241, v241
    s_waitcnt lgkmcnt(0)
    v_mfma_f32_16x16x32_bf16 v[228:231], v[212:215], v[208:211], 0
    v_exp_f32 v242, v242
    v_mfma_f32_16x16x32_bf16 v[224:227], v[164:167], v[208:211], 0
    v_exp_f32 v243, v243
    v_cvt_pk_bf16_f32 v204, v240, v241
    v_cvt_pk_bf16_f32 v205, v242, v243
    v_mfma_f32_16x16x32_bf16 v[232:235], v[216:219], v[208:211], 0
    v_mov_b32_dpp v206, v204 row_ror:8 row_mask:0xf bank_mask:0xf
    v_mov_b32_dpp v207, v205 row_ror:8 row_mask:0xf bank_mask:0xf
    s_nop 1
    v_mfma_f32_16x16x32_bf16 v[224:227], v[220:223], v[204:207], v[224:227]
    v_mfma_f32_16x16x32_bf16 v[228:231], v[136:139], v[204:207], v[228:231]
    v_mfma_f32_16x16x32_bf16 v[232:235], v[140:143], v[204:207], v[232:235]
    s_mov_b64 exec, s[50:51]
    v_rcp_f32 v18, v224
    s_nop 1
    v_mul_f32 v228, v18, v228
    v_mul_f32 v229, v18, v229
    v_mul_f32 v230, v18, v230
    v_mul_f32 v231, v18, v231
    v_pk_mul_f32 v[232:233], v[18:19], v[232:233] op_sel_hi:[0,1]
    v_pk_mul_f32 v[234:235], v[18:19], v[234:235] op_sel_hi:[0,1]
    v_cvt_pk_bf16_f32 v236, v228, v229
    v_cvt_pk_bf16_f32 v239, v234, v235
    v_cvt_pk_bf16_f32 v237, v230, v231
    v_cvt_pk_bf16_f32 v238, v232, v233
    v_min_u32 v239, 0xfffffffe, v239
    buffer_store_dwordx4 v[236:239], v14, s[8:11], s30 offen
    s_mov_b64 exec, -1
    v_mov_b32 v48, 0
    v_mov_b32 v49, 0
    v_mov_b32 v50, 0
    v_mov_b32 v51, 0
    v_mov_b32 v52, 0
    v_mov_b32 v53, 0
    v_mov_b32 v54, 0
    v_mov_b32 v55, 0
    v_mov_b32 v56, 0
    v_mov_b32 v57, 0
    v_mov_b32 v58, 0
    v_mov_b32 v59, 0
    v_mov_b32 v60, 0
    v_mov_b32 v61, 0
    v_mov_b32 v62, 0
    v_mov_b32 v63, 0
    s_waitcnt vmcnt(0)
    s_barrier
    s_setprio 3
    buffer_load_dwordx4 v[24:27], v4, s[8:11], s30 offen offset:0 sc1
    s_setprio 2
    buffer_load_dwordx4 v[28:31], v4, s[8:11], s30 offen offset:1024 sc1
    s_setprio 1
    buffer_load_dwordx4 v[32:35], v4, s[8:11], s30 offen offset:2048 sc1
    s_setprio 0
    buffer_load_dwordx4 v[36:39], v4, s[8:11], s30 offen offset:3072 sc1
    s_call_b64 s[98:99], .gm_23
    s_nop 4
    v_pk_add_f32 v[64:65], v[64:65], v[66:67]
    v_cvt_pk_bf16_f32 v66, v64, v65
    v_pk_add_f32 v[68:69], v[68:69], v[70:71]
    v_cvt_pk_bf16_f32 v67, v68, v69
    v_min_u32 v67, 0xfffffffe, v67
    buffer_store_dwordx2 v[66:67], v168, s[8:11], s34 offen sc1
    ds_write2_b32 v7, v64, v65 offset0:0 offset1:36
    ds_write2_b32 v7, v68, v69 offset0:16 offset1:52
    s_waitcnt lgkmcnt(0)
    s_barrier
    buffer_load_dwordx4 v[104:107], v15, s[8:11], s42 offen offset:0
    buffer_load_dwordx4 v[120:123], v15, s[8:11], s43 offen offset:0
    buffer_load_dwordx4 v[136:139], v15, s[8:11], s44 offen offset:0
    buffer_load_dwordx4 v[140:143], v15, s[8:11], s44 offen offset:1024
    s_add_u32 s42, s42, 262144
    s_add_u32 s43, s43, 262144
    s_add_u32 s44, s44, 262144
    s_add_u32 s37, s28, 1
    s_bitcmp1_b32 s37, 0
    s_cselect_b32 s4, 0x84000, 0
    s_xor_b32 s34, s35, s4
    s_bitcmp1_b32 s37, 1
    s_cselect_b32 s4, 0x101000, 0
    s_xor_b32 s34, s34, s4
    s_lshr_b32 s37, s37, 2
    s_bitcmp1_b32 s63, s37
    s_cselect_b32 s4, 0x2000, 0
    s_xor_b32 s34, s34, s4
    s_lshl_b32 s37, s37, 21
    s_add_u32 s34, s34, s37
    v_mov_b32 v64, 0
    v_mov_b32 v65, 0
    v_mov_b32 v66, 0
    v_mov_b32 v67, 0
    v_mov_b32 v68, 0
    v_mov_b32 v69, 0
    v_mov_b32 v70, 0
    v_mov_b32 v71, 0
    s_mov_b32 s4, s30
    s_mov_b32 s30, s31
    s_mov_b32 s31, s32
    s_mov_b32 s32, s33
    s_mov_b32 s33, s4
    s_add_u32 s28, s28, 1
    s_mov_b32 s62, 0
    s_branch .step_24
.fin_25:
    s_waitcnt lgkmcnt(0)
    s_barrier
    s_barrier
    s_endpgm
.re_27:
    buffer_load_dwordx4 v[176:179], v13, s[8:11], s30 offen sc1
    buffer_load_dwordx4 v[180:183], v156, s[8:11], s30 offen sc1
    buffer_load_dwordx4 v[184:187], v157, s[8:11], s30 offen sc1
    buffer_load_dwordx4 v[188:191], v158, s[8:11], s30 offen sc1
    s_waitcnt vmcnt(7)
    v_max3_u32 v18, v72, v73, v74
    v_pk_add_f32 v[196:197], v[72:73], v[74:75]
    s_waitcnt vmcnt(6)
    v_max3_u32 v18, v18, v75, v79
    v_pk_add_f32 v[192:193], v[148:149], v[76:77]
    v_pk_add_f32 v[194:195], v[150:151], v[78:79]
    v_add_f32 v196, v196, v197
    s_waitcnt vmcnt(5)
    v_pk_add_f32 v[192:193], v[192:193], v[80:81]
    v_pk_add_f32 v[194:195], v[194:195], v[82:83]
    s_waitcnt vmcnt(4)
    v_max3_u32 v18, v18, v83, v87
    v_pk_add_f32 v[192:193], v[192:193], v[84:85]
    v_pk_add_f32 v[194:195], v[194:195], v[86:87]
    v_cmp_eq_u32 vcc, -1, v18
    v_max3_f32 v19, v192, v193, v196
    v_max3_f32 v19, v19, v194, v195
    s_cbranch_vccnz .re_29
    s_branch .sj_28
.re_29:
    buffer_load_dwordx4 v[72:75], v13, s[8:11], s30 offen sc1
    buffer_load_dwordx4 v[76:79], v156, s[8:11], s30 offen sc1
    buffer_load_dwordx4 v[80:83], v157, s[8:11], s30 offen sc1
    buffer_load_dwordx4 v[84:87], v158, s[8:11], s30 offen sc1
    s_add_u32 s62, s62, 1
    s_cmp_gt_u32 s62, 0x100000
    s_cbranch_scc1 .mg_end_1
    s_branch .mf_26
.w1_19:
    v_bfe_u32 v254, v1, 4, 1
    v_mul_u32_u24 v168, 1024, v254
    v_bfe_u32 v254, v1, 5, 1
    v_mul_u32_u24 v254, 128, v254
    v_add_u32 v168, v168, v254
    v_bfe_u32 v254, v1, 3, 1
    v_mul_u32_u24 v254, 64, v254
    v_add_u32 v168, v168, v254
    v_bfe_u32 v254, v1, 0, 2
    v_mul_u32_u24 v254, 16, v254
    v_add_u32 v168, v168, v254
    v_bfe_u32 v254, v1, 2, 1
    v_mul_u32_u24 v254, 8, v254
    v_add_u32 v168, v168, v254
    v_add_u32 v168, 256, v168
    v_add_u32 v168, s101, v168
    v_bfe_u32 v254, v1, 0, 1
    v_mul_u32_u24 v17, 2, v254
    v_bfe_u32 v254, v1, 2, 1
    v_mul_u32_u24 v254, 1, v254
    v_add_u32 v17, v17, v254
    v_bfe_u32 v254, v1, 3, 1
    v_mul_u32_u24 v254, 4, v254
    v_add_u32 v17, v17, v254
    v_bfe_u32 v254, v1, 1, 1
    v_mul_u32_u24 v18, 16, v254
    v_mov_b32 v19, 0x3f80
    v_lshlrev_b32 v18, v18, v19
    v_cmp_eq_u32 vcc, 0, v17
    s_nop 1
    v_cndmask_b32 v124, 0, v18, vcc
    v_cmp_eq_u32 vcc, 1, v17
    s_nop 1
    v_cndmask_b32 v125, 0, v18, vcc
    v_cmp_eq_u32 vcc, 2, v17
    s_nop 1
    v_cndmask_b32 v126, 0, v18, vcc
    v_cmp_eq_u32 vcc, 3, v17
    s_nop 1
    v_cndmask_b32 v127, 0, v18, vcc
    v_cmp_eq_u32 vcc, 4, v17
    s_nop 1
    v_cndmask_b32 v128, 0, v18, vcc
    v_cmp_eq_u32 vcc, 5, v17
    s_nop 1
    v_cndmask_b32 v129, 0, v18, vcc
    v_cmp_eq_u32 vcc, 6, v17
    s_nop 1
    v_cndmask_b32 v130, 0, v18, vcc
    v_cmp_eq_u32 vcc, 7, v17
    s_nop 1
    v_cndmask_b32 v131, 0, v18, vcc
    v_bfe_u32 v254, v1, 0, 1
    v_mul_u32_u24 v9, 144, v254
    v_bfe_u32 v254, v1, 1, 1
    v_mul_u32_u24 v254, 576, v254
    v_add_u32 v9, v9, v254
    v_bfe_u32 v254, v1, 2, 1
    v_mul_u32_u24 v254, 288, v254
    v_add_u32 v9, v9, v254
    v_bfe_u32 v254, v1, 3, 1
    v_mul_u32_u24 v254, 1152, v254
    v_add_u32 v9, v9, v254
    v_bfe_u32 v254, v1, 4, 2
    v_mul_u32_u24 v254, 32, v254
    v_add_u32 v9, v9, v254
    v_bfe_u32 v254, v1, 0, 1
    v_mul_u32_u24 v11, 144, v254
    v_bfe_u32 v254, v1, 2, 2
    v_mul_u32_u24 v254, 288, v254
    v_add_u32 v11, v11, v254
    v_bfe_u32 v254, v1, 1, 1
    v_mul_u32_u24 v254, 1152, v254
    v_add_u32 v11, v11, v254
    v_bfe_u32 v254, v1, 4, 2
    v_mul_u32_u24 v254, 32, v254
    v_add_u32 v11, v11, v254
    v_add_u32 v11, 4736, v11
    s_lshl_b32 s4, s56, 10
    s_lshl_b32 s5, s53, 2
    v_bfe_u32 v254, v1, 0, 6
    v_mul_u32_u24 v10, 16, v254
    v_add_u32 v10, 262144, v10
    v_add_u32 v10, s4, v10
    v_add_u32 v10, s5, v10
    v_bfe_u32 v254, v1, 1, 1
    v_mul_u32_u24 v12, 144, v254
    v_bfe_u32 v254, v1, 5, 1
    v_mul_u32_u24 v254, 288, v254
    v_add_u32 v12, v12, v254
    v_bfe_u32 v254, v1, 3, 1
    v_mul_u32_u24 v254, 576, v254
    v_add_u32 v12, v12, v254
    v_bfe_u32 v254, v1, 4, 1
    v_mul_u32_u24 v254, 32, v254
    v_add_u32 v12, v12, v254
    v_bfe_u32 v254, v1, 2, 1
    v_mul_u32_u24 v254, 64, v254
    v_add_u32 v12, v12, v254
    v_bfe_u32 v254, v1, 0, 1
    v_mul_u32_u24 v254, 16, v254
    v_add_u32 v12, v12, v254
    v_add_u32 v12, 9472, v12
    v_bfe_u32 v254, v1, 0, 6
    v_mul_u32_u24 v13, 16, v254
    v_add_u32 v13, s101, v13
    v_bfe_u32 v254, v1, 0, 2
    v_mul_u32_u24 v14, 8, v254
    v_bfe_u32 v254, v1, 4, 1
    v_mul_u32_u24 v254, 32, v254
    v_add_u32 v14, v14, v254
    v_bfe_u32 v254, v1, 3, 1
    v_mul_u32_u24 v254, 64, v254
    v_add_u32 v14, v14, v254
    v_bfe_u32 v254, v1, 5, 1
    v_mul_u32_u24 v254, 128, v254
    v_add_u32 v14, v14, v254
    v_bfe_u32 v254, v1, 2, 1
    v_mul_u32_u24 v254, 256, v254
    v_add_u32 v14, v14, v254
    v_add_u32 v14, s55, v14
    v_xor_b32 v14, 2048, v14
    v_min_u32 v249, 0xfffffffe, v249
    buffer_store_dwordx2 v[248:249], v14, s[8:11], s30 offen
    v_bfe_u32 v254, v1, 0, 6
    v_mul_u32_u24 v15, 16, v254
    s_add_u32 s42, s42, 262144
    s_add_u32 s43, s43, 262144
    s_add_u32 s44, s44, 262144
    buffer_load_dwordx4 v[24:27], v246, s[8:11], s31 offen sc1
    buffer_load_dwordx4 v[28:31], v245, s[8:11], s31 offen sc1
    buffer_load_dword v32, v237, s[8:11], s31 offen sc1
    s_waitcnt vmcnt(0)
    ds_read_b64_tr_b16 a[192:193], v242 offset:16384
    ds_read_b64_tr_b16 a[194:195], v242 offset:16896
    ds_read_b64_tr_b16 a[196:197], v242 offset:18432
    ds_read_b64_tr_b16 a[198:199], v242 offset:18944
    ds_read_b64_tr_b16 a[200:201], v242 offset:20480
    ds_read_b64_tr_b16 a[202:203], v242 offset:20992
    ds_read_b64_tr_b16 a[204:205], v242 offset:22528
    ds_read_b64_tr_b16 a[206:207], v242 offset:23040
    ds_read_b64_tr_b16 a[208:209], v242 offset:24576
    ds_read_b64_tr_b16 a[210:211], v242 offset:25088
    ds_read_b64_tr_b16 a[212:213], v242 offset:26624
    ds_read_b64_tr_b16 a[214:215], v242 offset:27136
    ds_read_b64_tr_b16 a[216:217], v242 offset:28672
    ds_read_b64_tr_b16 a[218:219], v242 offset:29184
    ds_read_b64_tr_b16 a[220:221], v242 offset:30720
    ds_read_b64_tr_b16 a[222:223], v242 offset:31232
    ds_read_b64_tr_b16 a[224:225], v243 offset:16384
    ds_read_b64_tr_b16 a[226:227], v243 offset:16896
    ds_read_b64_tr_b16 a[228:229], v243 offset:18432
    ds_read_b64_tr_b16 a[230:231], v243 offset:18944
    ds_read_b64_tr_b16 a[232:233], v243 offset:20480
    ds_read_b64_tr_b16 a[234:235], v243 offset:20992
    ds_read_b64_tr_b16 a[236:237], v243 offset:22528
    ds_read_b64_tr_b16 a[238:239], v243 offset:23040
    ds_read_b64_tr_b16 a[240:241], v243 offset:24576
    ds_read_b64_tr_b16 a[242:243], v243 offset:25088
    ds_read_b64_tr_b16 a[244:245], v243 offset:26624
    ds_read_b64_tr_b16 a[246:247], v243 offset:27136
    ds_read_b64_tr_b16 a[248:249], v243 offset:28672
    ds_read_b64_tr_b16 a[250:251], v243 offset:29184
    ds_read_b64_tr_b16 a[252:253], v243 offset:30720
    ds_read_b64_tr_b16 a[254:255], v243 offset:31232
    s_waitcnt lgkmcnt(0)
    s_barrier
.p2align 6
.step_30:
    s_barrier
    s_setprio 3
    buffer_load_dwordx4 v[24:27], v3, s[8:11], s30 offen offset:0 sc1
    s_setprio 2
    buffer_load_dwordx4 v[28:31], v3, s[8:11], s30 offen offset:1024 sc1
    s_setprio 1
    buffer_load_dwordx4 v[32:35], v3, s[8:11], s30 offen offset:2048 sc1
    s_setprio 0
    buffer_load_dwordx4 v[36:39], v3, s[8:11], s30 offen offset:3072 sc1
    s_call_b64 s[98:99], .gm_22
    v_pk_add_f32 v[40:41], v[40:41], v[42:43]
    v_pk_add_f32 v[42:43], v[44:45], v[46:47]
    ds_write2_b32 v5, v40, v41 offset0:0 offset1:36
    ds_write2_b32 v5, v42, v43 offset0:16 offset1:52
    s_nop 1
    v_pk_add_f32 v[48:49], v[48:49], v[50:51]
    v_pk_add_f32 v[50:51], v[52:53], v[54:55]
    ds_write2_b32 v6, v48, v49 offset0:0 offset1:36
    ds_write2_b32 v6, v50, v51 offset0:16 offset1:52
    s_waitcnt lgkmcnt(2)
    s_barrier
    ds_read_b128 v[72:75], v9 offset:0
    ds_read_b128 v[76:79], v9 offset:2304
    ds_read_b128 v[80:83], v9 offset:16
    ds_read_b128 v[84:87], v9 offset:2320
    v_smfmac_f32_16x16x64_bf16 v[56:59], v[24:27], a[128:135], v2
    v_smfmac_f32_16x16x64_bf16 v[60:63], v[24:27], a[160:167], v2
    s_waitcnt lgkmcnt(4)
    s_barrier
    ds_read_b128 v[88:91], v11 offset:0
    ds_read_b128 v[92:95], v11 offset:2304
    ds_read_b128 v[96:99], v11 offset:16
    ds_read_b128 v[100:103], v11 offset:2320
    v_smfmac_f32_16x16x64_bf16 v[56:59], v[28:31], a[136:143], v2
    s_waitcnt lgkmcnt(6)
    v_pk_add_f32 v[72:73], v[72:73], v[76:77]
    v_pk_add_f32 v[74:75], v[74:75], v[78:79]
    v_cvt_pk_bf16_f32 v144, v72, v73
    v_cvt_pk_bf16_f32 v145, v74, v75
    s_waitcnt lgkmcnt(4)
    v_pk_add_f32 v[80:81], v[80:81], v[84:85]
    v_pk_add_f32 v[82:83], v[82:83], v[86:87]
    v_cvt_pk_bf16_f32 v146, v80, v81
    v_cvt_pk_bf16_f32 v147, v82, v83
    s_waitcnt lgkmcnt(2)
    v_pk_add_f32 v[88:89], v[88:89], v[92:93]
    v_pk_add_f32 v[90:91], v[90:91], v[94:95]
    v_cvt_pk_bf16_f32 v148, v88, v89
    v_cvt_pk_bf16_f32 v149, v90, v91
    s_waitcnt lgkmcnt(0)
    v_pk_add_f32 v[96:97], v[96:97], v[100:101]
    v_pk_add_f32 v[98:99], v[98:99], v[102:103]
    v_cvt_pk_bf16_f32 v150, v96, v97
    v_cvt_pk_bf16_f32 v151, v98, v99
    s_nop 1
    v_mfma_f32_16x16x32_bf16 v[196:199], v[148:151], v[144:147], 0
    v_smfmac_f32_16x16x64_bf16 v[60:63], v[28:31], a[168:175], v2
    v_smfmac_f32_16x16x64_bf16 v[56:59], v[32:35], a[144:151], v2
    v_pk_add_f32 v[196:197], v[196:197], v[198:199]
    s_nop 1
    v_add_f32_dpp v198, v196, v196 row_ror:8 row_mask:0xf bank_mask:0xf
    v_add_f32_dpp v199, v197, v197 row_ror:8 row_mask:0xf bank_mask:0xf
    v_cndmask_b32 v198, v199, v198, s[48:49]
    v_min_u32 v198, 0xfffffffe, v198
    buffer_store_dword v198, v10, s[8:11], s30 offen
    v_smfmac_f32_16x16x64_bf16 v[60:63], v[32:35], a[176:183], v2
    v_smfmac_f32_16x16x64_bf16 v[56:59], v[36:39], a[152:159], v2
    v_smfmac_f32_16x16x64_bf16 v[60:63], v[36:39], a[184:191], v2
    v_mov_b32 v40, 0
    v_mov_b32 v41, 0
    v_mov_b32 v42, 0
    v_mov_b32 v43, 0
    v_mov_b32 v44, 0
    v_mov_b32 v45, 0
    v_mov_b32 v46, 0
    v_mov_b32 v47, 0
    v_pk_add_f32 v[56:57], v[56:57], v[58:59]
    v_pk_add_f32 v[58:59], v[60:61], v[62:63]
    v_cvt_pk_bf16_f32 v60, v56, v57
    v_cvt_pk_bf16_f32 v61, v58, v59
    ds_write2_b32 v255, v60, v61 offset0:0 offset1:32
    ds_write_b128 v8, v[56:59]
    s_waitcnt lgkmcnt(0)
    s_barrier
    s_cmp_eq_u32 s28, 63
    s_cbranch_scc1 .fin_31
    s_add_u32 s37, s28, 0
    s_bitcmp1_b32 s37, 0
    s_cselect_b32 s4, 0x84000, 0
    s_xor_b32 s34, s35, s4
    s_bitcmp1_b32 s37, 1
    s_cselect_b32 s4, 0x101000, 0
    s_xor_b32 s34, s34, s4
    s_lshr_b32 s37, s37, 2
    s_bitcmp1_b32 s63, s37
    s_cselect_b32 s4, 0x2000, 0
    s_xor_b32 s34, s34, s4
    s_lshl_b32 s37, s37, 21
    s_add_u32 s34, s34, s37
    s_xor_b32 s38, s34, 0x4000
    s_xor_b32 s39, s34, 0x1000
    s_xor_b32 s40, s34, 0x5000
    v_mov_b32 v48, 0
    v_mov_b32 v49, 0
    v_mov_b32 v50, 0
    v_mov_b32 v51, 0
    v_mov_b32 v52, 0
    v_mov_b32 v53, 0
    v_mov_b32 v54, 0
    v_mov_b32 v55, 0
    v_mov_b32 v56, 0
    v_mov_b32 v57, 0
    v_mov_b32 v58, 0
    v_mov_b32 v59, 0
    v_mov_b32 v60, 0
    v_mov_b32 v61, 0
    v_mov_b32 v62, 0
    v_mov_b32 v63, 0
    s_barrier
    s_setprio 3
    buffer_load_dwordx4 v[24:27], v4, s[8:11], s30 offen offset:0 sc1
    s_setprio 2
    buffer_load_dwordx4 v[28:31], v4, s[8:11], s30 offen offset:1024 sc1
    s_setprio 1
    buffer_load_dwordx4 v[32:35], v4, s[8:11], s30 offen offset:2048 sc1
    s_setprio 0
    buffer_load_dwordx4 v[36:39], v4, s[8:11], s30 offen offset:3072 sc1
    s_call_b64 s[98:99], .gm_23
    s_nop 4
    v_pk_add_f32 v[64:65], v[64:65], v[66:67]
    v_cvt_pk_bf16_f32 v66, v64, v65
    v_pk_add_f32 v[68:69], v[68:69], v[70:71]
    v_cvt_pk_bf16_f32 v67, v68, v69
    v_min_u32 v67, 0xfffffffe, v67
    buffer_store_dwordx2 v[66:67], v168, s[8:11], s34 offen sc1
    ds_write2_b32 v7, v64, v65 offset0:0 offset1:36
    ds_write2_b32 v7, v68, v69 offset0:16 offset1:52
    s_waitcnt lgkmcnt(0)
    s_barrier
    ds_read_b128 v[72:75], v12 offset:0
    ds_read_b128 v[76:79], v12 offset:1152
    ds_read_b128 v[80:83], v12 offset:2304
    ds_read_b128 v[84:87], v12 offset:3456
    s_waitcnt lgkmcnt(2)
    v_pk_add_f32 v[72:73], v[72:73], v[76:77]
    v_pk_add_f32 v[74:75], v[74:75], v[78:79]
    s_waitcnt lgkmcnt(0)
    v_pk_add_f32 v[80:81], v[80:81], v[84:85]
    v_pk_add_f32 v[82:83], v[82:83], v[86:87]
    v_pk_add_f32 v[72:73], v[72:73], v[80:81]
    v_pk_add_f32 v[74:75], v[74:75], v[82:83]
    v_mov_b32 v64, 0
    v_mov_b32 v65, 0
    v_mov_b32 v66, 0
    v_mov_b32 v67, 0
    v_mov_b32 v68, 0
    v_mov_b32 v69, 0
    v_mov_b32 v70, 0
    v_mov_b32 v71, 0
.pl_32:
    buffer_load_dwordx4 v[76:79], v13, s[8:11], s38 offen offset:0 sc1
    buffer_load_dwordx4 v[80:83], v13, s[8:11], s38 offen offset:1024 sc1
    buffer_load_dwordx4 v[84:87], v13, s[8:11], s39 offen offset:0 sc1
    buffer_load_dwordx4 v[88:91], v13, s[8:11], s39 offen offset:1024 sc1
    buffer_load_dwordx4 v[92:95], v13, s[8:11], s40 offen offset:0 sc1
    buffer_load_dwordx4 v[96:99], v13, s[8:11], s40 offen offset:1024 sc1
.pk_35:
    s_waitcnt vmcnt(5)
    v_mfma_f32_16x16x32_bf16 v[108:111], v[76:79], v[124:127], v[72:75]
    v_max_u32 v18, v77, v79
    s_waitcnt vmcnt(4)
    v_mfma_f32_16x16x32_bf16 v[108:111], v[80:83], v[128:131], v[108:111]
    v_max3_u32 v18, v18, v81, v83
    v_cmp_eq_u32 vcc, -1, v18
    s_cbranch_vccnz .pf_36
.pk_37:
    s_waitcnt vmcnt(3)
    v_mfma_f32_16x16x32_bf16 v[112:115], v[84:87], v[124:127], v[108:111]
    v_max_u32 v18, v85, v87
    s_waitcnt vmcnt(2)
    v_mfma_f32_16x16x32_bf16 v[112:115], v[88:91], v[128:131], v[112:115]
    v_max3_u32 v18, v18, v89, v91
    v_cmp_eq_u32 vcc, -1, v18
    s_cbranch_vccnz .pf_38
.pk_39:
    s_waitcnt vmcnt(1)
    v_mfma_f32_16x16x32_bf16 v[100:103], v[92:95], v[124:127], v[112:115]
    v_max_u32 v18, v93, v95
    s_waitcnt vmcnt(0)
    v_mfma_f32_16x16x32_bf16 v[100:103], v[96:99], v[128:131], v[100:103]
    v_max3_u32 v18, v18, v97, v99
    v_cmp_eq_u32 vcc, -1, v18
    s_cbranch_vccnz .pf_40
.pd_34:
    s_nop 4
    v_cvt_pk_bf16_f32 v105, v102, v103
    v_cvt_pk_bf16_f32 v104, v100, v101
    v_min_u32 v105, 0xfffffffe, v105
    buffer_store_dwordx2 v[104:105], v14, s[8:11], s31 offen
    s_mov_b32 s4, s30
    s_mov_b32 s30, s31
    s_mov_b32 s31, s32
    s_mov_b32 s32, s33
    s_mov_b32 s33, s4
    s_add_u32 s28, s28, 1
    s_mov_b32 s62, 0
    s_branch .step_30
.fin_31:
    s_barrier
    s_waitcnt vmcnt(0)
    s_endpgm
.pf_36:
    buffer_load_dwordx4 v[76:79], v13, s[8:11], s38 offen offset:0 sc1
    buffer_load_dwordx4 v[80:83], v13, s[8:11], s38 offen offset:1024 sc1
    s_add_u32 s62, s62, 1
    s_cmp_gt_u32 s62, 0x100000
    s_cbranch_scc1 .mg_end_1
.pk_41:
    s_waitcnt vmcnt(5)
    v_mfma_f32_16x16x32_bf16 v[108:111], v[84:87], v[124:127], v[72:75]
    v_max_u32 v18, v85, v87
    s_waitcnt vmcnt(4)
    v_mfma_f32_16x16x32_bf16 v[108:111], v[88:91], v[128:131], v[108:111]
    v_max3_u32 v18, v18, v89, v91
    v_cmp_eq_u32 vcc, -1, v18
    s_cbranch_vccnz .pf_42
.pk_43:
    s_waitcnt vmcnt(3)
    v_mfma_f32_16x16x32_bf16 v[112:115], v[92:95], v[124:127], v[108:111]
    v_max_u32 v18, v93, v95
    s_waitcnt vmcnt(2)
    v_mfma_f32_16x16x32_bf16 v[112:115], v[96:99], v[128:131], v[112:115]
    v_max3_u32 v18, v18, v97, v99
    v_cmp_eq_u32 vcc, -1, v18
    s_cbranch_vccnz .pf_44
.pk_45:
    s_waitcnt vmcnt(1)
    v_mfma_f32_16x16x32_bf16 v[100:103], v[76:79], v[124:127], v[112:115]
    v_max_u32 v18, v77, v79
    s_waitcnt vmcnt(0)
    v_mfma_f32_16x16x32_bf16 v[100:103], v[80:83], v[128:131], v[100:103]
    v_max3_u32 v18, v18, v81, v83
    v_cmp_eq_u32 vcc, -1, v18
    s_cbranch_vccnz .pf_46
    s_branch .pd_34
.pf_38:
    buffer_load_dwordx4 v[84:87], v13, s[8:11], s39 offen offset:0 sc1
    buffer_load_dwordx4 v[88:91], v13, s[8:11], s39 offen offset:1024 sc1
    s_add_u32 s62, s62, 1
    s_cmp_gt_u32 s62, 0x100000
    s_cbranch_scc1 .mg_end_1
.pk_47:
    s_waitcnt vmcnt(3)
    v_mfma_f32_16x16x32_bf16 v[112:115], v[92:95], v[124:127], v[108:111]
    v_max_u32 v18, v93, v95
    s_waitcnt vmcnt(2)
    v_mfma_f32_16x16x32_bf16 v[112:115], v[96:99], v[128:131], v[112:115]
    v_max3_u32 v18, v18, v97, v99
    v_cmp_eq_u32 vcc, -1, v18
    s_cbranch_vccnz .pf_48
.pk_49:
    s_waitcnt vmcnt(1)
    v_mfma_f32_16x16x32_bf16 v[100:103], v[84:87], v[124:127], v[112:115]
    v_max_u32 v18, v85, v87
    s_waitcnt vmcnt(0)
    v_mfma_f32_16x16x32_bf16 v[100:103], v[88:91], v[128:131], v[100:103]
    v_max3_u32 v18, v18, v89, v91
    v_cmp_eq_u32 vcc, -1, v18
    s_cbranch_vccnz .pf_50
    s_branch .pd_34
.pf_40:
    buffer_load_dwordx4 v[92:95], v13, s[8:11], s40 offen offset:0 sc1
    buffer_load_dwordx4 v[96:99], v13, s[8:11], s40 offen offset:1024 sc1
    s_add_u32 s62, s62, 1
    s_cmp_gt_u32 s62, 0x100000
    s_cbranch_scc1 .mg_end_1
    s_branch .pk_39
.pf_42:
    buffer_load_dwordx4 v[84:87], v13, s[8:11], s39 offen offset:0 sc1
    buffer_load_dwordx4 v[88:91], v13, s[8:11], s39 offen offset:1024 sc1
    s_add_u32 s62, s62, 1
    s_cmp_gt_u32 s62, 0x100000
    s_cbranch_scc1 .mg_end_1
.pk_51:
    s_waitcnt vmcnt(5)
    v_mfma_f32_16x16x32_bf16 v[108:111], v[92:95], v[124:127], v[72:75]
    v_max_u32 v18, v93, v95
    s_waitcnt vmcnt(4)
    v_mfma_f32_16x16x32_bf16 v[108:111], v[96:99], v[128:131], v[108:111]
    v_max3_u32 v18, v18, v97, v99
    v_cmp_eq_u32 vcc, -1, v18
    s_cbranch_vccnz .pf_52
.pk_53:
    s_waitcnt vmcnt(3)
    v_mfma_f32_16x16x32_bf16 v[112:115], v[76:79], v[124:127], v[108:111]
    v_max_u32 v18, v77, v79
    s_waitcnt vmcnt(2)
    v_mfma_f32_16x16x32_bf16 v[112:115], v[80:83], v[128:131], v[112:115]
    v_max3_u32 v18, v18, v81, v83
    v_cmp_eq_u32 vcc, -1, v18
    s_cbranch_vccnz .pf_54
    s_branch .pk_49
.pf_44:
    buffer_load_dwordx4 v[92:95], v13, s[8:11], s40 offen offset:0 sc1
    buffer_load_dwordx4 v[96:99], v13, s[8:11], s40 offen offset:1024 sc1
    s_add_u32 s62, s62, 1
    s_cmp_gt_u32 s62, 0x100000
    s_cbranch_scc1 .mg_end_1
.pk_55:
    s_waitcnt vmcnt(3)
    v_mfma_f32_16x16x32_bf16 v[112:115], v[76:79], v[124:127], v[108:111]
    v_max_u32 v18, v77, v79
    s_waitcnt vmcnt(2)
    v_mfma_f32_16x16x32_bf16 v[112:115], v[80:83], v[128:131], v[112:115]
    v_max3_u32 v18, v18, v81, v83
    v_cmp_eq_u32 vcc, -1, v18
    s_cbranch_vccnz .pf_56
    s_branch .pk_39
.pf_46:
    buffer_load_dwordx4 v[76:79], v13, s[8:11], s38 offen offset:0 sc1
    buffer_load_dwordx4 v[80:83], v13, s[8:11], s38 offen offset:1024 sc1
    s_add_u32 s62, s62, 1
    s_cmp_gt_u32 s62, 0x100000
    s_cbranch_scc1 .mg_end_1
    s_branch .pk_45
.pf_48:
    buffer_load_dwordx4 v[92:95], v13, s[8:11], s40 offen offset:0 sc1
    buffer_load_dwordx4 v[96:99], v13, s[8:11], s40 offen offset:1024 sc1
    s_add_u32 s62, s62, 1
    s_cmp_gt_u32 s62, 0x100000
    s_cbranch_scc1 .mg_end_1
    s_branch .pk_37
.pf_50:
    buffer_load_dwordx4 v[84:87], v13, s[8:11], s39 offen offset:0 sc1
    buffer_load_dwordx4 v[88:91], v13, s[8:11], s39 offen offset:1024 sc1
    s_add_u32 s62, s62, 1
    s_cmp_gt_u32 s62, 0x100000
    s_cbranch_scc1 .mg_end_1
    s_branch .pk_49
.pf_52:
    buffer_load_dwordx4 v[92:95], v13, s[8:11], s40 offen offset:0 sc1
    buffer_load_dwordx4 v[96:99], v13, s[8:11], s40 offen offset:1024 sc1
    s_add_u32 s62, s62, 1
    s_cmp_gt_u32 s62, 0x100000
    s_cbranch_scc1 .mg_end_1
    s_branch .pk_35
.pf_54:
    buffer_load_dwordx4 v[76:79], v13, s[8:11], s38 offen offset:0 sc1
    buffer_load_dwordx4 v[80:83], v13, s[8:11], s38 offen offset:1024 sc1
    s_add_u32 s62, s62, 1
    s_cmp_gt_u32 s62, 0x100000
    s_cbranch_scc1 .mg_end_1
.pk_57:
    s_waitcnt vmcnt(3)
    v_mfma_f32_16x16x32_bf16 v[112:115], v[84:87], v[124:127], v[108:111]
    v_max_u32 v18, v85, v87
    s_waitcnt vmcnt(2)
    v_mfma_f32_16x16x32_bf16 v[112:115], v[88:91], v[128:131], v[112:115]
    v_max3_u32 v18, v18, v89, v91
    v_cmp_eq_u32 vcc, -1, v18
    s_cbranch_vccnz .pf_58
    s_branch .pk_45
.pf_56:
    buffer_load_dwordx4 v[76:79], v13, s[8:11], s38 offen offset:0 sc1
    buffer_load_dwordx4 v[80:83], v13, s[8:11], s38 offen offset:1024 sc1
    s_add_u32 s62, s62, 1
    s_cmp_gt_u32 s62, 0x100000
    s_cbranch_scc1 .mg_end_1
    s_branch .pk_43
.pf_58:
    buffer_load_dwordx4 v[84:87], v13, s[8:11], s39 offen offset:0 sc1
    buffer_load_dwordx4 v[88:91], v13, s[8:11], s39 offen offset:1024 sc1
    s_add_u32 s62, s62, 1
    s_cmp_gt_u32 s62, 0x100000
    s_cbranch_scc1 .mg_end_1
    s_branch .pk_53
.pr_33:
    s_add_u32 s62, s62, 1
    s_cmp_gt_u32 s62, 0x100000
    s_cbranch_scc1 .mg_end_1
    s_branch .pl_32
.w2_20:
    v_bfe_u32 v254, v1, 4, 1
    v_mul_u32_u24 v168, 1024, v254
    v_bfe_u32 v254, v1, 5, 1
    v_mul_u32_u24 v254, 128, v254
    v_add_u32 v168, v168, v254
    v_bfe_u32 v254, v1, 3, 1
    v_mul_u32_u24 v254, 64, v254
    v_add_u32 v168, v168, v254
    v_bfe_u32 v254, v1, 0, 2
    v_mul_u32_u24 v254, 16, v254
    v_add_u32 v168, v168, v254
    v_bfe_u32 v254, v1, 2, 1
    v_mul_u32_u24 v254, 8, v254
    v_add_u32 v168, v168, v254
    v_add_u32 v168, 512, v168
    v_add_u32 v168, s101, v168
    s_lshl_b32 s4, s56, 9
    s_lshl_b32 s5, s53, 7
    s_add_u32 s4, s4, s5
    s_add_u32 s4, s4, 92274688
    v_mov_b32 v14, s4
    v_bfe_u32 v254, v1, 0, 6
    v_mul_u32_u24 v12, 16, v254
    v_add_u32 v12, 18176, v12
    v_bfe_u32 v254, v1, 0, 6
    v_mul_u32_u24 v15, 16, v254
    s_add_u32 s42, s42, 262144
    s_add_u32 s43, s43, 262144
    s_add_u32 s44, s44, 262144
    s_mov_b32 exec_hi, 0
    v_xor_b32 v244, 1024, v244
    s_mov_b32 exec_hi, -1
    buffer_load_dwordx4 v[24:27], v246, s[8:11], s32 offen sc1
    buffer_load_dwordx4 v[28:31], v245, s[8:11], s32 offen sc1
    buffer_load_dword v32, v237, s[8:11], s32 offen sc1
    s_waitcnt vmcnt(0)
    ds_read_b64_tr_b16 a[192:193], v242 offset:16384
    ds_read_b64_tr_b16 a[194:195], v242 offset:16896
    ds_read_b64_tr_b16 a[196:197], v242 offset:18432
    ds_read_b64_tr_b16 a[198:199], v242 offset:18944
    ds_read_b64_tr_b16 a[200:201], v242 offset:20480
    ds_read_b64_tr_b16 a[202:203], v242 offset:20992
    ds_read_b64_tr_b16 a[204:205], v242 offset:22528
    ds_read_b64_tr_b16 a[206:207], v242 offset:23040
    ds_read_b64_tr_b16 a[208:209], v242 offset:24576
    ds_read_b64_tr_b16 a[210:211], v242 offset:25088
    ds_read_b64_tr_b16 a[212:213], v242 offset:26624
    ds_read_b64_tr_b16 a[214:215], v242 offset:27136
    ds_read_b64_tr_b16 a[216:217], v242 offset:28672
    ds_read_b64_tr_b16 a[218:219], v242 offset:29184
    ds_read_b64_tr_b16 a[220:221], v242 offset:30720
    ds_read_b64_tr_b16 a[222:223], v242 offset:31232
    ds_read_b64_tr_b16 a[224:225], v243 offset:16384
    ds_read_b64_tr_b16 a[226:227], v243 offset:16896
    ds_read_b64_tr_b16 a[228:229], v243 offset:18432
    ds_read_b64_tr_b16 a[230:231], v243 offset:18944
    ds_read_b64_tr_b16 a[232:233], v243 offset:20480
    ds_read_b64_tr_b16 a[234:235], v243 offset:20992
    ds_read_b64_tr_b16 a[236:237], v243 offset:22528
    ds_read_b64_tr_b16 a[238:239], v243 offset:23040
    ds_read_b64_tr_b16 a[240:241], v243 offset:24576
    ds_read_b64_tr_b16 a[242:243], v243 offset:25088
    ds_read_b64_tr_b16 a[244:245], v243 offset:26624
    ds_read_b64_tr_b16 a[246:247], v243 offset:27136
    ds_read_b64_tr_b16 a[248:249], v243 offset:28672
    ds_read_b64_tr_b16 a[250:251], v243 offset:29184
    ds_read_b64_tr_b16 a[252:253], v243 offset:30720
    ds_read_b64_tr_b16 a[254:255], v243 offset:31232
    s_waitcnt lgkmcnt(0)
    s_barrier
.p2align 6
.step_59:
    s_barrier
    s_setprio 3
    buffer_load_dwordx4 v[24:27], v3, s[8:11], s30 offen offset:0 sc1
    s_setprio 2
    buffer_load_dwordx4 v[28:31], v3, s[8:11], s30 offen offset:1024 sc1
    s_setprio 1
    buffer_load_dwordx4 v[32:35], v3, s[8:11], s30 offen offset:2048 sc1
    s_setprio 0
    buffer_load_dwordx4 v[36:39], v3, s[8:11], s30 offen offset:3072 sc1
    s_call_b64 s[98:99], .gm_22
    v_pk_add_f32 v[40:41], v[40:41], v[42:43]
    v_pk_add_f32 v[42:43], v[44:45], v[46:47]
    ds_write2_b32 v5, v40, v41 offset0:0 offset1:36
    ds_write2_b32 v5, v42, v43 offset0:16 offset1:52
    s_nop 1
    v_pk_add_f32 v[48:49], v[48:49], v[50:51]
    v_pk_add_f32 v[50:51], v[52:53], v[54:55]
    ds_write2_b32 v6, v48, v49 offset0:0 offset1:36
    ds_write2_b32 v6, v50, v51 offset0:16 offset1:52
    s_waitcnt lgkmcnt(2)
    s_barrier
    s_waitcnt lgkmcnt(0)
    s_barrier
    v_smfmac_f32_16x16x64_bf16 v[56:59], v[24:27], a[128:135], v2
    v_smfmac_f32_16x16x64_bf16 v[60:63], v[24:27], a[160:167], v2
    v_smfmac_f32_16x16x64_bf16 v[56:59], v[28:31], a[136:143], v2
    v_smfmac_f32_16x16x64_bf16 v[60:63], v[28:31], a[168:175], v2
    v_smfmac_f32_16x16x64_bf16 v[56:59], v[32:35], a[144:151], v2
    v_smfmac_f32_16x16x64_bf16 v[60:63], v[32:35], a[176:183], v2
    v_smfmac_f32_16x16x64_bf16 v[56:59], v[36:39], a[152:159], v2
    v_smfmac_f32_16x16x64_bf16 v[60:63], v[36:39], a[184:191], v2
    ds_read_b64 v[72:73], v9 offset:0
    ds_read_b64 v[74:75], v9 offset:1152
    ds_read_b64 v[76:77], v9 offset:2304
    ds_read_b64 v[78:79], v9 offset:3456
    s_waitcnt lgkmcnt(0)
    v_pk_add_f32 v[72:73], v[72:73], v[74:75]
    v_pk_add_f32 v[76:77], v[76:77], v[78:79]
    v_pk_add_f32 v[72:73], v[72:73], v[76:77]
    v_cvt_pk_bf16_f32 v72, v72, v73
    ds_write_b32 v11, v72
    v_mov_b32 v40, 0
    v_mov_b32 v41, 0
    v_mov_b32 v42, 0
    v_mov_b32 v43, 0
    v_mov_b32 v44, 0
    v_mov_b32 v45, 0
    v_mov_b32 v46, 0
    v_mov_b32 v47, 0
    v_pk_add_f32 v[56:57], v[56:57], v[58:59]
    v_pk_add_f32 v[58:59], v[60:61], v[62:63]
    v_cvt_pk_bf16_f32 v60, v56, v57
    v_cvt_pk_bf16_f32 v61, v58, v59
    ds_write2_b32 v255, v60, v61 offset0:0 offset1:32
    ds_write_b128 v8, v[56:59]
    s_waitcnt lgkmcnt(0)
    s_barrier
    s_cmp_eq_u32 s28, 63
    s_cbranch_scc1 .fin_60
    s_add_u32 s37, s28, 0
    s_bitcmp1_b32 s37, 0
    s_cselect_b32 s4, 0x84000, 0
    s_xor_b32 s34, s35, s4
    s_bitcmp1_b32 s37, 1
    s_cselect_b32 s4, 0x101000, 0
    s_xor_b32 s34, s34, s4
    s_lshr_b32 s37, s37, 2
    s_bitcmp1_b32 s63, s37
    s_cselect_b32 s4, 0x2000, 0
    s_xor_b32 s34, s34, s4
    s_lshl_b32 s37, s37, 21
    s_add_u32 s34, s34, s37
    s_waitcnt lgkmcnt(0)
    v_mov_b32 v48, 0
    v_mov_b32 v49, 0
    v_mov_b32 v50, 0
    v_mov_b32 v51, 0
    v_mov_b32 v52, 0
    v_mov_b32 v53, 0
    v_mov_b32 v54, 0
    v_mov_b32 v55, 0
    v_mov_b32 v56, 0
    v_mov_b32 v57, 0
    v_mov_b32 v58, 0
    v_mov_b32 v59, 0
    v_mov_b32 v60, 0
    v_mov_b32 v61, 0
    v_mov_b32 v62, 0
    v_mov_b32 v63, 0
    s_barrier
    ds_read_b128 v[72:75], v12
    s_setprio 3
    buffer_load_dwordx4 v[24:27], v4, s[8:11], s30 offen offset:0 sc1
    s_setprio 2
    buffer_load_dwordx4 v[28:31], v4, s[8:11], s30 offen offset:1024 sc1
    s_setprio 1
    buffer_load_dwordx4 v[32:35], v4, s[8:11], s30 offen offset:2048 sc1
    s_setprio 0
    buffer_load_dwordx4 v[36:39], v4, s[8:11], s30 offen offset:3072 sc1
    s_call_b64 s[98:99], .gm_23
    s_waitcnt lgkmcnt(0)
    buffer_store_dwordx4 v[72:75], v244, s[8:11], s41 offen sc1
    s_nop 3
    v_pk_add_f32 v[64:65], v[64:65], v[66:67]
    v_cvt_pk_bf16_f32 v66, v64, v65
    v_pk_add_f32 v[68:69], v[68:69], v[70:71]
    v_cvt_pk_bf16_f32 v67, v68, v69
    v_min_u32 v67, 0xfffffffe, v67
    buffer_store_dwordx2 v[66:67], v168, s[8:11], s34 offen sc1
    ds_write2_b32 v7, v64, v65 offset0:0 offset1:36
    ds_write2_b32 v7, v68, v69 offset0:16 offset1:52
    s_waitcnt lgkmcnt(0)
    s_barrier
    s_cmp_lt_u32 s28, 52
    s_cselect_b32 s4, 1, 0
    s_andn2_b32 s4, s4, s28
    s_cbranch_scc1 .nl_61
    v_mov_b32 v18, s28
    v_add_u32 v18, 1, v18
    s_mov_b64 exec, 1
    s_waitcnt vmcnt(0)
    buffer_store_dword v18, v14, s[8:11], 0 offen sc1
    s_mov_b64 exec, -1
.nl_61:
    v_mov_b32 v64, 0
    v_mov_b32 v65, 0
    v_mov_b32 v66, 0
    v_mov_b32 v67, 0
    v_mov_b32 v68, 0
    v_mov_b32 v69, 0
    v_mov_b32 v70, 0
    v_mov_b32 v71, 0
    s_mov_b32 s4, s30
    s_mov_b32 s30, s31
    s_mov_b32 s31, s32
    s_mov_b32 s32, s33
    s_mov_b32 s33, s4
    s_add_u32 s28, s28, 1
    s_mov_b32 s62, 0
    s_add_u32 s41, s41, 0x20000
    s_branch .step_59
.fin_60:
    s_barrier
    s_endpgm
.w3_21:
    v_bfe_u32 v254, v1, 4, 1
    v_mul_u32_u24 v168, 1024, v254
    v_bfe_u32 v254, v1, 5, 1
    v_mul_u32_u24 v254, 128, v254
    v_add_u32 v168, v168, v254
    v_bfe_u32 v254, v1, 3, 1
    v_mul_u32_u24 v254, 64, v254
    v_add_u32 v168, v168, v254
    v_bfe_u32 v254, v1, 0, 2
    v_mul_u32_u24 v254, 16, v254
    v_add_u32 v168, v168, v254
    v_bfe_u32 v254, v1, 2, 1
    v_mul_u32_u24 v254, 8, v254
    v_add_u32 v168, v168, v254
    v_add_u32 v168, 768, v168
    v_add_u32 v168, s101, v168
    v_bfe_u32 v254, v1, 3, 1
    v_mul_u32_u24 v12, 8, v254
    v_bfe_u32 v254, v1, 5, 1
    v_mul_u32_u24 v254, 256, v254
    v_add_u32 v12, v12, v254
    v_bfe_u32 v254, v1, 2, 1
    v_mul_u32_u24 v254, 128, v254
    v_add_u32 v12, v12, v254
    v_bfe_u32 v254, v1, 0, 2
    v_mul_u32_u24 v254, 16, v254
    v_add_u32 v12, v12, v254
    v_bfe_u32 v254, v1, 4, 1
    v_mul_u32_u24 v254, 512, v254
    v_add_u32 v12, v12, v254
    v_add_u32 v12, 14080, v12
    v_bfe_u32 v254, v1, 2, 2
    v_mul_u32_u24 v14, 128, v254
    v_bfe_u32 v254, v1, 0, 2
    v_mul_u32_u24 v254, 16, v254
    v_add_u32 v14, v14, v254
    v_bfe_u32 v254, v1, 4, 2
    v_mul_u32_u24 v254, 4, v254
    v_add_u32 v14, v14, v254
    v_add_u32 v14, 18688, v14
    v_bfe_u32 v254, v1, 0, 6
    v_mul_u32_u24 v15, 16, v254
    v_add_u32 v15, s101, v15
    v_bfe_u32 v254, v1, 2, 2
    v_mul_u32_u24 v16, 128, v254
    v_bfe_u32 v254, v1, 0, 2
    v_mul_u32_u24 v254, 16, v254
    v_add_u32 v16, v16, v254
    v_bfe_u32 v254, v1, 4, 2
    v_mul_u32_u24 v254, 4, v254
    v_add_u32 v16, v16, v254
    v_add_u32 v16, 135168, v16
    v_add_u32 v16, s58, v16
    s_lshl_b32 s4, s56, 9
    s_add_u32 s4, s4, 92291072
    v_bfe_u32 v254, v1, 0, 2
    v_mul_u32_u24 v13, 128, v254
    v_bfe_u32 v254, v1, 2, 1
    v_mul_u32_u24 v254, 16384, v254
    v_add_u32 v13, v13, v254
    v_add_u32 v13, s4, v13
    s_lshl_b32 s4, s56, 9
    s_lshl_b32 s5, s53, 7
    s_add_u32 s4, s4, s5
    s_add_u32 s4, s4, 92274688
    v_mov_b32 v174, s4
    v_bfe_u32 v254, v1, 0, 6
    v_mul_u32_u24 v175, 16, v254
    v_add_u32 v175, 18176, v175
    s_mov_b32 exec_hi, 0
    v_xor_b32 v244, 1024, v244
    s_mov_b32 exec_hi, -1
    buffer_load_dwordx4 v[24:27], v246, s[8:11], s33 offen sc1
    buffer_load_dwordx4 v[28:31], v245, s[8:11], s33 offen sc1
    buffer_load_dword v32, v237, s[8:11], s33 offen sc1
    s_waitcnt vmcnt(0)
    ds_read_b64_tr_b16 a[192:193], v242 offset:16384
    ds_read_b64_tr_b16 a[194:195], v242 offset:16896
    ds_read_b64_tr_b16 a[196:197], v242 offset:18432
    ds_read_b64_tr_b16 a[198:199], v242 offset:18944
    ds_read_b64_tr_b16 a[200:201], v242 offset:20480
    ds_read_b64_tr_b16 a[202:203], v242 offset:20992
    ds_read_b64_tr_b16 a[204:205], v242 offset:22528
    ds_read_b64_tr_b16 a[206:207], v242 offset:23040
    ds_read_b64_tr_b16 a[208:209], v242 offset:24576
    ds_read_b64_tr_b16 a[210:211], v242 offset:25088
    ds_read_b64_tr_b16 a[212:213], v242 offset:26624
    ds_read_b64_tr_b16 a[214:215], v242 offset:27136
    ds_read_b64_tr_b16 a[216:217], v242 offset:28672
    ds_read_b64_tr_b16 a[218:219], v242 offset:29184
    ds_read_b64_tr_b16 a[220:221], v242 offset:30720
    ds_read_b64_tr_b16 a[222:223], v242 offset:31232
    ds_read_b64_tr_b16 a[224:225], v243 offset:16384
    ds_read_b64_tr_b16 a[226:227], v243 offset:16896
    ds_read_b64_tr_b16 a[228:229], v243 offset:18432
    ds_read_b64_tr_b16 a[230:231], v243 offset:18944
    ds_read_b64_tr_b16 a[232:233], v243 offset:20480
    ds_read_b64_tr_b16 a[234:235], v243 offset:20992
    ds_read_b64_tr_b16 a[236:237], v243 offset:22528
    ds_read_b64_tr_b16 a[238:239], v243 offset:23040
    ds_read_b64_tr_b16 a[240:241], v243 offset:24576
    ds_read_b64_tr_b16 a[242:243], v243 offset:25088
    ds_read_b64_tr_b16 a[244:245], v243 offset:26624
    ds_read_b64_tr_b16 a[246:247], v243 offset:27136
    ds_read_b64_tr_b16 a[248:249], v243 offset:28672
    ds_read_b64_tr_b16 a[250:251], v243 offset:29184
    ds_read_b64_tr_b16 a[252:253], v243 offset:30720
    ds_read_b64_tr_b16 a[254:255], v243 offset:31232
    s_waitcnt lgkmcnt(0)
    s_cmp_ge_u32 s46, 1
    s_cbranch_scc1 .kvd_63
    s_mov_b32 s62, 0
.kv_62:
    buffer_load_dword v18, v13, s[8:11], 0 offen sc1
    s_add_u32 s62, s62, 1
    s_cmp_gt_u32 s62, 0x100000
    s_cbranch_scc1 .mg_end_1
    s_waitcnt vmcnt(0)
    v_min_u32_dpp v18, v18, v18 quad_perm:[1,0,3,2] row_mask:0xf bank_mask:0xf
    s_nop 1
    v_min_u32_dpp v18, v18, v18 quad_perm:[2,3,0,1] row_mask:0xf bank_mask:0xf
    s_nop 1
    v_min_u32_dpp v18, v18, v18 row_half_mirror row_mask:0xf bank_mask:0xf
    s_nop 0
    v_readfirstlane_b32 s46, v18
    s_cmp_lt_u32 s46, 1
    s_cbranch_scc1 .kv_62
.kvd_63:
    s_barrier
.p2align 6
.step_64:
    s_barrier
    s_setprio 3
    buffer_load_dwordx4 v[24:27], v3, s[8:11], s30 offen offset:0 sc1
    s_setprio 2
    buffer_load_dwordx4 v[28:31], v3, s[8:11], s30 offen offset:1024 sc1
    s_setprio 1
    buffer_load_dwordx4 v[32:35], v3, s[8:11], s30 offen offset:2048 sc1
    s_setprio 0
    buffer_load_dwordx4 v[36:39], v3, s[8:11], s30 offen offset:3072 sc1
    s_call_b64 s[98:99], .gm_22
    v_pk_add_f32 v[40:41], v[40:41], v[42:43]
    v_pk_add_f32 v[42:43], v[44:45], v[46:47]
    ds_write2_b32 v5, v40, v41 offset0:0 offset1:36
    ds_write2_b32 v5, v42, v43 offset0:16 offset1:52
    s_nop 1
    v_pk_add_f32 v[48:49], v[48:49], v[50:51]
    v_pk_add_f32 v[50:51], v[52:53], v[54:55]
    ds_write2_b32 v6, v48, v49 offset0:0 offset1:36
    ds_write2_b32 v6, v50, v51 offset0:16 offset1:52
    s_waitcnt lgkmcnt(2)
    s_barrier
    s_waitcnt lgkmcnt(0)
    s_barrier
    v_smfmac_f32_16x16x64_bf16 v[56:59], v[24:27], a[128:135], v2
    v_smfmac_f32_16x16x64_bf16 v[60:63], v[24:27], a[160:167], v2
    v_smfmac_f32_16x16x64_bf16 v[56:59], v[28:31], a[136:143], v2
    v_smfmac_f32_16x16x64_bf16 v[60:63], v[28:31], a[168:175], v2
    v_smfmac_f32_16x16x64_bf16 v[56:59], v[32:35], a[144:151], v2
    v_smfmac_f32_16x16x64_bf16 v[60:63], v[32:35], a[176:183], v2
    v_smfmac_f32_16x16x64_bf16 v[56:59], v[36:39], a[152:159], v2
    v_smfmac_f32_16x16x64_bf16 v[60:63], v[36:39], a[184:191], v2
    ds_read_b64 v[72:73], v9 offset:0
    ds_read_b64 v[74:75], v9 offset:1152
    ds_read_b64 v[76:77], v9 offset:2304
    ds_read_b64 v[78:79], v9 offset:3456
    s_waitcnt lgkmcnt(0)
    v_pk_add_f32 v[72:73], v[72:73], v[74:75]
    v_pk_add_f32 v[76:77], v[76:77], v[78:79]
    v_pk_add_f32 v[72:73], v[72:73], v[76:77]
    v_cvt_pk_bf16_f32 v72, v72, v73
    ds_write_b32 v11, v72
    v_mov_b32 v40, 0
    v_mov_b32 v41, 0
    v_mov_b32 v42, 0
    v_mov_b32 v43, 0
    v_mov_b32 v44, 0
    v_mov_b32 v45, 0
    v_mov_b32 v46, 0
    v_mov_b32 v47, 0
    v_pk_add_f32 v[56:57], v[56:57], v[58:59]
    v_pk_add_f32 v[58:59], v[60:61], v[62:63]
    v_cvt_pk_bf16_f32 v60, v56, v57
    v_cvt_pk_bf16_f32 v61, v58, v59
    ds_write2_b32 v255, v60, v61 offset0:0 offset1:32
    ds_write_b128 v8, v[56:59]
    s_waitcnt lgkmcnt(0)
    s_barrier
    ds_read_b64 v[72:73], v12 offset:0
    ds_read_b64 v[74:75], v12 offset:1024
    ds_read_b64 v[76:77], v12 offset:2048
    ds_read_b64 v[78:79], v12 offset:3072
    ds_read_b64 v[80:81], v12 offset:64
    ds_read_b64 v[82:83], v12 offset:1088
    ds_read_b64 v[84:85], v12 offset:2112
    ds_read_b64 v[86:87], v12 offset:3136
    s_waitcnt lgkmcnt(4)
    v_add_f32 v72, v72, v74
    v_add_f32 v73, v73, v75
    v_add_f32 v76, v76, v78
    v_add_f32 v77, v77, v79
    v_add_f32 v72, v72, v76
    v_add_f32 v73, v73, v77
    v_cvt_pk_bf16_f32 v72, v72, v73
    s_waitcnt lgkmcnt(0)
    v_add_f32 v80, v80, v82
    v_add_f32 v81, v81, v83
    v_add_f32 v84, v84, v86
    v_add_f32 v85, v85, v87
    v_add_f32 v80, v80, v84
    v_add_f32 v81, v81, v85
    v_cvt_pk_bf16_f32 v80, v80, v81
    ds_write_b32 v14, v72
    ds_write_b32 v14, v80 offset:64
    s_waitcnt lgkmcnt(0)
    s_cmp_ge_u32 s28, 62
    s_cbranch_scc1 .ke_66
.kb_67:
    s_cmp_eq_u32 s28, 63
    s_cbranch_scc1 .fin_65
    s_add_u32 s37, s28, 0
    s_bitcmp1_b32 s37, 0
    s_cselect_b32 s4, 0x84000, 0
    s_xor_b32 s34, s35, s4
    s_bitcmp1_b32 s37, 1
    s_cselect_b32 s4, 0x101000, 0
    s_xor_b32 s34, s34, s4
    s_lshr_b32 s37, s37, 2
    s_bitcmp1_b32 s63, s37
    s_cselect_b32 s4, 0x2000, 0
    s_xor_b32 s34, s34, s4
    s_lshl_b32 s37, s37, 21
    s_add_u32 s34, s34, s37
    buffer_store_dwordx4 v[20:23], v246, s[8:11], s32 offen
    buffer_store_dwordx4 v[20:23], v245, s[8:11], s32 offen
    buffer_store_dword v20, v237, s[8:11], s32 offen
    s_add_u32 s5, s28, 2
    s_cmp_ge_u32 s46, s5
    s_cbranch_scc1 .kvd_71
    s_mov_b32 s62, 0
.kv_70:
    buffer_load_dword v18, v13, s[8:11], 0 offen sc1
    s_add_u32 s62, s62, 1
    s_cmp_gt_u32 s62, 0x100000
    s_cbranch_scc1 .mg_end_1
    s_waitcnt vmcnt(0)
    v_min_u32_dpp v18, v18, v18 quad_perm:[1,0,3,2] row_mask:0xf bank_mask:0xf
    s_nop 1
    v_min_u32_dpp v18, v18, v18 quad_perm:[2,3,0,1] row_mask:0xf bank_mask:0xf
    s_nop 1
    v_min_u32_dpp v18, v18, v18 row_half_mirror row_mask:0xf bank_mask:0xf
    s_nop 0
    v_readfirstlane_b32 s46, v18
    s_cmp_lt_u32 s46, s5
    s_cbranch_scc1 .kv_70
.kvd_71:
    v_mov_b32 v48, 0
    v_mov_b32 v49, 0
    v_mov_b32 v50, 0
    v_mov_b32 v51, 0
    v_mov_b32 v52, 0
    v_mov_b32 v53, 0
    v_mov_b32 v54, 0
    v_mov_b32 v55, 0
    v_mov_b32 v56, 0
    v_mov_b32 v57, 0
    v_mov_b32 v58, 0
    v_mov_b32 v59, 0
    v_mov_b32 v60, 0
    v_mov_b32 v61, 0
    v_mov_b32 v62, 0
    v_mov_b32 v63, 0
    s_cmp_ge_u32 s28, 62
    s_cbranch_scc1 .kf_68
.kg_69:
    s_barrier
    s_setprio 3
    buffer_load_dwordx4 v[24:27], v4, s[8:11], s30 offen offset:0 sc1
    s_setprio 2
    buffer_load_dwordx4 v[28:31], v4, s[8:11], s30 offen offset:1024 sc1
    s_setprio 1
    buffer_load_dwordx4 v[32:35], v4, s[8:11], s30 offen offset:2048 sc1
    s_setprio 0
    buffer_load_dwordx4 v[36:39], v4, s[8:11], s30 offen offset:3072 sc1
    s_call_b64 s[98:99], .gm_23
    s_nop 4
    v_pk_add_f32 v[64:65], v[64:65], v[66:67]
    v_cvt_pk_bf16_f32 v66, v64, v65
    v_pk_add_f32 v[68:69], v[68:69], v[70:71]
    v_cvt_pk_bf16_f32 v67, v68, v69
    v_min_u32 v67, 0xfffffffe, v67
    buffer_store_dwordx2 v[66:67], v168, s[8:11], s34 offen sc1
    ds_write2_b32 v7, v64, v65 offset0:0 offset1:36
    ds_write2_b32 v7, v68, v69 offset0:16 offset1:52
    s_waitcnt lgkmcnt(0)
    s_barrier
    s_add_u32 s5, s28, 3
    s_min_u32 s5, s5, 64
    s_cmp_ge_u32 s46, s5
    s_cbranch_scc1 .kvd_73
    s_mov_b32 s62, 0
.kv_72:
    buffer_load_dword v18, v13, s[8:11], 0 offen sc1
    s_add_u32 s62, s62, 1
    s_cmp_gt_u32 s62, 0x100000
    s_cbranch_scc1 .mg_end_1
    s_waitcnt vmcnt(0)
    v_min_u32_dpp v18, v18, v18 quad_perm:[1,0,3,2] row_mask:0xf bank_mask:0xf
    s_nop 1
    v_min_u32_dpp v18, v18, v18 quad_perm:[2,3,0,1] row_mask:0xf bank_mask:0xf
    s_nop 1
    v_min_u32_dpp v18, v18, v18 row_half_mirror row_mask:0xf bank_mask:0xf
    s_nop 0
    v_readfirstlane_b32 s46, v18
.kvd_73:
    v_mov_b32 v64, 0
    v_mov_b32 v65, 0
    v_mov_b32 v66, 0
    v_mov_b32 v67, 0
    v_mov_b32 v68, 0
    v_mov_b32 v69, 0
    v_mov_b32 v70, 0
    v_mov_b32 v71, 0
    s_mov_b32 s4, s30
    s_mov_b32 s30, s31
    s_mov_b32 s31, s32
    s_mov_b32 s32, s33
    s_mov_b32 s33, s4
    s_add_u32 s28, s28, 1
    s_mov_b32 s62, 0
    s_add_u32 s41, s41, 0x20000
    s_branch .step_64
.fin_65:
    s_barrier
    s_add_u32 s4, s28, 1
    v_mov_b32 v18, s4
    s_mov_b64 exec, 1
    s_waitcnt vmcnt(0)
    buffer_store_dword v18, v174, s[8:11], 0 offen sc1
    s_mov_b64 exec, -1
    s_endpgm
.ke_66:
    ds_read_b128 v[72:75], v175
    s_waitcnt lgkmcnt(0)
    buffer_store_dwordx4 v[72:75], v244, s[8:11], s41 offen sc1
    s_branch .kb_67
.kf_68:
    s_add_u32 s4, s28, 1
    v_mov_b32 v18, s4
    s_mov_b64 exec, 1
    s_waitcnt vmcnt(0)
    buffer_store_dword v18, v174, s[8:11], 0 offen sc1
    s_mov_b64 exec, -1
    s_branch .kg_69
.p2align 6
.gm_22:
    s_waitcnt vmcnt(3)
    v_max_u32 v18, v25, v27
    v_cmp_eq_u32 vcc, -1, v18
    s_cbranch_vccnz .nk_74
.ok_75:
    v_smfmac_f32_16x16x64_bf16 v[40:43], v[24:27], a[0:7], v2
    v_smfmac_f32_16x16x64_bf16 v[44:47], v[24:27], a[32:39], v2
    s_waitcnt vmcnt(2)
    v_max_u32 v18, v29, v31
    v_cmp_eq_u32 vcc, -1, v18
    v_smfmac_f32_16x16x64_bf16 v[48:51], v[24:27], a[64:71], v2
    v_smfmac_f32_16x16x64_bf16 v[52:55], v[24:27], a[96:103], v2
    s_cbranch_vccnz .nk_76
.ok_77:
    v_smfmac_f32_16x16x64_bf16 v[40:43], v[28:31], a[8:15], v2
    v_smfmac_f32_16x16x64_bf16 v[44:47], v[28:31], a[40:47], v2
    s_waitcnt vmcnt(1)
    v_max_u32 v18, v33, v35
    v_cmp_eq_u32 vcc, -1, v18
    v_smfmac_f32_16x16x64_bf16 v[48:51], v[28:31], a[72:79], v2
    v_smfmac_f32_16x16x64_bf16 v[52:55], v[28:31], a[104:111], v2
    s_cbranch_vccnz .nk_78
.ok_79:
    v_smfmac_f32_16x16x64_bf16 v[40:43], v[32:35], a[16:23], v2
    v_smfmac_f32_16x16x64_bf16 v[44:47], v[32:35], a[48:55], v2
    s_waitcnt vmcnt(0)
    v_max_u32 v18, v37, v39
    v_cmp_eq_u32 vcc, -1, v18
    v_smfmac_f32_16x16x64_bf16 v[48:51], v[32:35], a[80:87], v2
    v_smfmac_f32_16x16x64_bf16 v[52:55], v[32:35], a[112:119], v2
    s_cbranch_vccnz .nk_80
.ok_81:
    v_smfmac_f32_16x16x64_bf16 v[40:43], v[36:39], a[24:31], v2
    v_smfmac_f32_16x16x64_bf16 v[44:47], v[36:39], a[56:63], v2
    v_smfmac_f32_16x16x64_bf16 v[48:51], v[36:39], a[88:95], v2
    v_smfmac_f32_16x16x64_bf16 v[52:55], v[36:39], a[120:127], v2
    s_setpc_b64 s[98:99]
.nk_74:
    buffer_load_dwordx4 v[24:27], v3, s[8:11], s30 offen offset:0 sc1
    s_add_u32 s62, s62, 1
    s_cmp_gt_u32 s62, 0x100000
    s_cbranch_scc1 .mg_end_1
    s_waitcnt vmcnt(3)
    v_max_u32 v18, v29, v31
    v_cmp_eq_u32 vcc, -1, v18
    s_cbranch_vccnz .nk_82
.ok_83:
    v_smfmac_f32_16x16x64_bf16 v[40:43], v[28:31], a[8:15], v2
    v_smfmac_f32_16x16x64_bf16 v[44:47], v[28:31], a[40:47], v2
    s_waitcnt vmcnt(2)
    v_max_u32 v18, v33, v35
    v_cmp_eq_u32 vcc, -1, v18
    v_smfmac_f32_16x16x64_bf16 v[48:51], v[28:31], a[72:79], v2
    v_smfmac_f32_16x16x64_bf16 v[52:55], v[28:31], a[104:111], v2
    s_cbranch_vccnz .nk_84
.ok_85:
    v_smfmac_f32_16x16x64_bf16 v[40:43], v[32:35], a[16:23], v2
    v_smfmac_f32_16x16x64_bf16 v[44:47], v[32:35], a[48:55], v2
    s_waitcnt vmcnt(1)
    v_max_u32 v18, v37, v39
    v_cmp_eq_u32 vcc, -1, v18
    v_smfmac_f32_16x16x64_bf16 v[48:51], v[32:35], a[80:87], v2
    v_smfmac_f32_16x16x64_bf16 v[52:55], v[32:35], a[112:119], v2
    s_cbranch_vccnz .nk_86
.ok_87:
    v_smfmac_f32_16x16x64_bf16 v[40:43], v[36:39], a[24:31], v2
    v_smfmac_f32_16x16x64_bf16 v[44:47], v[36:39], a[56:63], v2
    s_waitcnt vmcnt(0)
    v_max_u32 v18, v25, v27
    v_cmp_eq_u32 vcc, -1, v18
    v_smfmac_f32_16x16x64_bf16 v[48:51], v[36:39], a[88:95], v2
    v_smfmac_f32_16x16x64_bf16 v[52:55], v[36:39], a[120:127], v2
    s_cbranch_vccnz .nk_88
.ok_89:
    v_smfmac_f32_16x16x64_bf16 v[40:43], v[24:27], a[0:7], v2
    v_smfmac_f32_16x16x64_bf16 v[44:47], v[24:27], a[32:39], v2
    v_smfmac_f32_16x16x64_bf16 v[48:51], v[24:27], a[64:71], v2
    v_smfmac_f32_16x16x64_bf16 v[52:55], v[24:27], a[96:103], v2
    s_setpc_b64 s[98:99]
.nk_76:
    buffer_load_dwordx4 v[28:31], v3, s[8:11], s30 offen offset:1024 sc1
    s_add_u32 s62, s62, 1
    s_cmp_gt_u32 s62, 0x100000
    s_cbranch_scc1 .mg_end_1
    s_waitcnt vmcnt(2)
    v_max_u32 v18, v33, v35
    v_cmp_eq_u32 vcc, -1, v18
    s_cbranch_vccnz .nk_90
.ok_91:
    v_smfmac_f32_16x16x64_bf16 v[40:43], v[32:35], a[16:23], v2
    v_smfmac_f32_16x16x64_bf16 v[44:47], v[32:35], a[48:55], v2
    s_waitcnt vmcnt(1)
    v_max_u32 v18, v37, v39
    v_cmp_eq_u32 vcc, -1, v18
    v_smfmac_f32_16x16x64_bf16 v[48:51], v[32:35], a[80:87], v2
    v_smfmac_f32_16x16x64_bf16 v[52:55], v[32:35], a[112:119], v2
    s_cbranch_vccnz .nk_92
.ok_93:
    v_smfmac_f32_16x16x64_bf16 v[40:43], v[36:39], a[24:31], v2
    v_smfmac_f32_16x16x64_bf16 v[44:47], v[36:39], a[56:63], v2
    s_waitcnt vmcnt(0)
    v_max_u32 v18, v29, v31
    v_cmp_eq_u32 vcc, -1, v18
    v_smfmac_f32_16x16x64_bf16 v[48:51], v[36:39], a[88:95], v2
    v_smfmac_f32_16x16x64_bf16 v[52:55], v[36:39], a[120:127], v2
    s_cbranch_vccnz .nk_94
.ok_95:
    v_smfmac_f32_16x16x64_bf16 v[40:43], v[28:31], a[8:15], v2
    v_smfmac_f32_16x16x64_bf16 v[44:47], v[28:31], a[40:47], v2
    v_smfmac_f32_16x16x64_bf16 v[48:51], v[28:31], a[72:79], v2
    v_smfmac_f32_16x16x64_bf16 v[52:55], v[28:31], a[104:111], v2
    s_setpc_b64 s[98:99]
.nk_78:
    buffer_load_dwordx4 v[32:35], v3, s[8:11], s30 offen offset:2048 sc1
    s_add_u32 s62, s62, 1
    s_cmp_gt_u32 s62, 0x100000
    s_cbranch_scc1 .mg_end_1
    s_waitcnt vmcnt(1)
    v_max_u32 v18, v37, v39
    v_cmp_eq_u32 vcc, -1, v18
    s_cbranch_vccnz .nk_96
.ok_97:
    v_smfmac_f32_16x16x64_bf16 v[40:43], v[36:39], a[24:31], v2
    v_smfmac_f32_16x16x64_bf16 v[44:47], v[36:39], a[56:63], v2
    s_waitcnt vmcnt(0)
    v_max_u32 v18, v33, v35
    v_cmp_eq_u32 vcc, -1, v18
    v_smfmac_f32_16x16x64_bf16 v[48:51], v[36:39], a[88:95], v2
    v_smfmac_f32_16x16x64_bf16 v[52:55], v[36:39], a[120:127], v2
    s_cbranch_vccnz .nk_98
.ok_99:
    v_smfmac_f32_16x16x64_bf16 v[40:43], v[32:35], a[16:23], v2
    v_smfmac_f32_16x16x64_bf16 v[44:47], v[32:35], a[48:55], v2
    v_smfmac_f32_16x16x64_bf16 v[48:51], v[32:35], a[80:87], v2
    v_smfmac_f32_16x16x64_bf16 v[52:55], v[32:35], a[112:119], v2
    s_setpc_b64 s[98:99]
.nk_80:
    buffer_load_dwordx4 v[36:39], v3, s[8:11], s30 offen offset:3072 sc1
    s_add_u32 s62, s62, 1
    s_cmp_gt_u32 s62, 0x100000
    s_cbranch_scc1 .mg_end_1
    s_waitcnt vmcnt(0)
    v_max_u32 v18, v37, v39
    v_cmp_eq_u32 vcc, -1, v18
    s_cbranch_vccnz .nk_80
    s_branch .ok_81
.nk_82:
    buffer_load_dwordx4 v[28:31], v3, s[8:11], s30 offen offset:1024 sc1
    s_add_u32 s62, s62, 1
    s_cmp_gt_u32 s62, 0x100000
    s_cbranch_scc1 .mg_end_1
    s_waitcnt vmcnt(3)
    v_max_u32 v18, v33, v35
    v_cmp_eq_u32 vcc, -1, v18
    s_cbranch_vccnz .nk_100
.ok_101:
    v_smfmac_f32_16x16x64_bf16 v[40:43], v[32:35], a[16:23], v2
    v_smfmac_f32_16x16x64_bf16 v[44:47], v[32:35], a[48:55], v2
    s_waitcnt vmcnt(2)
    v_max_u32 v18, v37, v39
    v_cmp_eq_u32 vcc, -1, v18
    v_smfmac_f32_16x16x64_bf16 v[48:51], v[32:35], a[80:87], v2
    v_smfmac_f32_16x16x64_bf16 v[52:55], v[32:35], a[112:119], v2
    s_cbranch_vccnz .nk_102
.ok_103:
    v_smfmac_f32_16x16x64_bf16 v[40:43], v[36:39], a[24:31], v2
    v_smfmac_f32_16x16x64_bf16 v[44:47], v[36:39], a[56:63], v2
    s_waitcnt vmcnt(1)
    v_max_u32 v18, v25, v27
    v_cmp_eq_u32 vcc, -1, v18
    v_smfmac_f32_16x16x64_bf16 v[48:51], v[36:39], a[88:95], v2
    v_smfmac_f32_16x16x64_bf16 v[52:55], v[36:39], a[120:127], v2
    s_cbranch_vccnz .nk_104
.ok_105:
    v_smfmac_f32_16x16x64_bf16 v[40:43], v[24:27], a[0:7], v2
    v_smfmac_f32_16x16x64_bf16 v[44:47], v[24:27], a[32:39], v2
    s_waitcnt vmcnt(0)
    v_max_u32 v18, v29, v31
    v_cmp_eq_u32 vcc, -1, v18
    v_smfmac_f32_16x16x64_bf16 v[48:51], v[24:27], a[64:71], v2
    v_smfmac_f32_16x16x64_bf16 v[52:55], v[24:27], a[96:103], v2
    s_cbranch_vccnz .nk_94
    s_branch .ok_95
.nk_84:
    buffer_load_dwordx4 v[32:35], v3, s[8:11], s30 offen offset:2048 sc1
    s_add_u32 s62, s62, 1
    s_cmp_gt_u32 s62, 0x100000
    s_cbranch_scc1 .mg_end_1
    s_waitcnt vmcnt(2)
    v_max_u32 v18, v37, v39
    v_cmp_eq_u32 vcc, -1, v18
    s_cbranch_vccnz .nk_106
.ok_107:
    v_smfmac_f32_16x16x64_bf16 v[40:43], v[36:39], a[24:31], v2
    v_smfmac_f32_16x16x64_bf16 v[44:47], v[36:39], a[56:63], v2
    s_waitcnt vmcnt(1)
    v_max_u32 v18, v25, v27
    v_cmp_eq_u32 vcc, -1, v18
    v_smfmac_f32_16x16x64_bf16 v[48:51], v[36:39], a[88:95], v2
    v_smfmac_f32_16x16x64_bf16 v[52:55], v[36:39], a[120:127], v2
    s_cbranch_vccnz .nk_108
.ok_109:
    v_smfmac_f32_16x16x64_bf16 v[40:43], v[24:27], a[0:7], v2
    v_smfmac_f32_16x16x64_bf16 v[44:47], v[24:27], a[32:39], v2
    s_waitcnt vmcnt(0)
    v_max_u32 v18, v33, v35
    v_cmp_eq_u32 vcc, -1, v18
    v_smfmac_f32_16x16x64_bf16 v[48:51], v[24:27], a[64:71], v2
    v_smfmac_f32_16x16x64_bf16 v[52:55], v[24:27], a[96:103], v2
    s_cbranch_vccnz .nk_98
    s_branch .ok_99
.nk_86:
    buffer_load_dwordx4 v[36:39], v3, s[8:11], s30 offen offset:3072 sc1
    s_add_u32 s62, s62, 1
    s_cmp_gt_u32 s62, 0x100000
    s_cbranch_scc1 .mg_end_1
    s_waitcnt vmcnt(1)
    v_max_u32 v18, v25, v27
    v_cmp_eq_u32 vcc, -1, v18
    s_cbranch_vccnz .nk_110
.ok_111:
    v_smfmac_f32_16x16x64_bf16 v[40:43], v[24:27], a[0:7], v2
    v_smfmac_f32_16x16x64_bf16 v[44:47], v[24:27], a[32:39], v2
    s_waitcnt vmcnt(0)
    v_max_u32 v18, v37, v39
    v_cmp_eq_u32 vcc, -1, v18
    v_smfmac_f32_16x16x64_bf16 v[48:51], v[24:27], a[64:71], v2
    v_smfmac_f32_16x16x64_bf16 v[52:55], v[24:27], a[96:103], v2
    s_cbranch_vccnz .nk_80
    s_branch .ok_81
.nk_88:
    buffer_load_dwordx4 v[24:27], v3, s[8:11], s30 offen offset:0 sc1
    s_add_u32 s62, s62, 1
    s_cmp_gt_u32 s62, 0x100000
    s_cbranch_scc1 .mg_end_1
    s_waitcnt vmcnt(0)
    v_max_u32 v18, v25, v27
    v_cmp_eq_u32 vcc, -1, v18
    s_cbranch_vccnz .nk_88
    s_branch .ok_89
.nk_90:
    buffer_load_dwordx4 v[32:35], v3, s[8:11], s30 offen offset:2048 sc1
    s_add_u32 s62, s62, 1
    s_cmp_gt_u32 s62, 0x100000
    s_cbranch_scc1 .mg_end_1
    s_waitcnt vmcnt(2)
    v_max_u32 v18, v37, v39
    v_cmp_eq_u32 vcc, -1, v18
    s_cbranch_vccnz .nk_112
.ok_113:
    v_smfmac_f32_16x16x64_bf16 v[40:43], v[36:39], a[24:31], v2
    v_smfmac_f32_16x16x64_bf16 v[44:47], v[36:39], a[56:63], v2
    s_waitcnt vmcnt(1)
    v_max_u32 v18, v29, v31
    v_cmp_eq_u32 vcc, -1, v18
    v_smfmac_f32_16x16x64_bf16 v[48:51], v[36:39], a[88:95], v2
    v_smfmac_f32_16x16x64_bf16 v[52:55], v[36:39], a[120:127], v2
    s_cbranch_vccnz .nk_114
.ok_115:
    v_smfmac_f32_16x16x64_bf16 v[40:43], v[28:31], a[8:15], v2
    v_smfmac_f32_16x16x64_bf16 v[44:47], v[28:31], a[40:47], v2
    s_waitcnt vmcnt(0)
    v_max_u32 v18, v33, v35
    v_cmp_eq_u32 vcc, -1, v18
    v_smfmac_f32_16x16x64_bf16 v[48:51], v[28:31], a[72:79], v2
    v_smfmac_f32_16x16x64_bf16 v[52:55], v[28:31], a[104:111], v2
    s_cbranch_vccnz .nk_98
    s_branch .ok_99
.nk_92:
    buffer_load_dwordx4 v[36:39], v3, s[8:11], s30 offen offset:3072 sc1
    s_add_u32 s62, s62, 1
    s_cmp_gt_u32 s62, 0x100000
    s_cbranch_scc1 .mg_end_1
    s_waitcnt vmcnt(1)
    v_max_u32 v18, v29, v31
    v_cmp_eq_u32 vcc, -1, v18
    s_cbranch_vccnz .nk_116
.ok_117:
    v_smfmac_f32_16x16x64_bf16 v[40:43], v[28:31], a[8:15], v2
    v_smfmac_f32_16x16x64_bf16 v[44:47], v[28:31], a[40:47], v2
    s_waitcnt vmcnt(0)
    v_max_u32 v18, v37, v39
    v_cmp_eq_u32 vcc, -1, v18
    v_smfmac_f32_16x16x64_bf16 v[48:51], v[28:31], a[72:79], v2
    v_smfmac_f32_16x16x64_bf16 v[52:55], v[28:31], a[104:111], v2
    s_cbranch_vccnz .nk_80
    s_branch .ok_81
.nk_94:
    buffer_load_dwordx4 v[28:31], v3, s[8:11], s30 offen offset:1024 sc1
    s_add_u32 s62, s62, 1
    s_cmp_gt_u32 s62, 0x100000
    s_cbranch_scc1 .mg_end_1
    s_waitcnt vmcnt(0)
    v_max_u32 v18, v29, v31
    v_cmp_eq_u32 vcc, -1, v18
    s_cbranch_vccnz .nk_94
    s_branch .ok_95
.nk_96:
    buffer_load_dwordx4 v[36:39], v3, s[8:11], s30 offen offset:3072 sc1
    s_add_u32 s62, s62, 1
    s_cmp_gt_u32 s62, 0x100000
    s_cbranch_scc1 .mg_end_1
    s_waitcnt vmcnt(1)
    v_max_u32 v18, v33, v35
    v_cmp_eq_u32 vcc, -1, v18
    s_cbranch_vccnz .nk_78
    s_branch .ok_79
.nk_98:
    buffer_load_dwordx4 v[32:35], v3, s[8:11], s30 offen offset:2048 sc1
    s_add_u32 s62, s62, 1
    s_cmp_gt_u32 s62, 0x100000
    s_cbranch_scc1 .mg_end_1
    s_waitcnt vmcnt(0)
    v_max_u32 v18, v33, v35
    v_cmp_eq_u32 vcc, -1, v18
    s_cbranch_vccnz .nk_98
    s_branch .ok_99
.nk_100:
    buffer_load_dwordx4 v[32:35], v3, s[8:11], s30 offen offset:2048 sc1
    s_add_u32 s62, s62, 1
    s_cmp_gt_u32 s62, 0x100000
    s_cbranch_scc1 .mg_end_1
    s_waitcnt vmcnt(3)
    v_max_u32 v18, v37, v39
    v_cmp_eq_u32 vcc, -1, v18
    s_cbranch_vccnz .nk_118
.ok_119:
    v_smfmac_f32_16x16x64_bf16 v[40:43], v[36:39], a[24:31], v2
    v_smfmac_f32_16x16x64_bf16 v[44:47], v[36:39], a[56:63], v2
    s_waitcnt vmcnt(2)
    v_max_u32 v18, v25, v27
    v_cmp_eq_u32 vcc, -1, v18
    v_smfmac_f32_16x16x64_bf16 v[48:51], v[36:39], a[88:95], v2
    v_smfmac_f32_16x16x64_bf16 v[52:55], v[36:39], a[120:127], v2
    s_cbranch_vccnz .nk_120
.ok_121:
    v_smfmac_f32_16x16x64_bf16 v[40:43], v[24:27], a[0:7], v2
    v_smfmac_f32_16x16x64_bf16 v[44:47], v[24:27], a[32:39], v2
    s_waitcnt vmcnt(1)
    v_max_u32 v18, v29, v31
    v_cmp_eq_u32 vcc, -1, v18
    v_smfmac_f32_16x16x64_bf16 v[48:51], v[24:27], a[64:71], v2
    v_smfmac_f32_16x16x64_bf16 v[52:55], v[24:27], a[96:103], v2
    s_cbranch_vccnz .nk_114
    s_branch .ok_115
.nk_102:
    buffer_load_dwordx4 v[36:39], v3, s[8:11], s30 offen offset:3072 sc1
    s_add_u32 s62, s62, 1
    s_cmp_gt_u32 s62, 0x100000
    s_cbranch_scc1 .mg_end_1
    s_waitcnt vmcnt(2)
    v_max_u32 v18, v25, v27
    v_cmp_eq_u32 vcc, -1, v18
    s_cbranch_vccnz .nk_122
.ok_123:
    v_smfmac_f32_16x16x64_bf16 v[40:43], v[24:27], a[0:7], v2
    v_smfmac_f32_16x16x64_bf16 v[44:47], v[24:27], a[32:39], v2
    s_waitcnt vmcnt(1)
    v_max_u32 v18, v29, v31
    v_cmp_eq_u32 vcc, -1, v18
    v_smfmac_f32_16x16x64_bf16 v[48:51], v[24:27], a[64:71], v2
    v_smfmac_f32_16x16x64_bf16 v[52:55], v[24:27], a[96:103], v2
    s_cbranch_vccnz .nk_116
    s_branch .ok_117
.nk_104:
    buffer_load_dwordx4 v[24:27], v3, s[8:11], s30 offen offset:0 sc1
    s_add_u32 s62, s62, 1
    s_cmp_gt_u32 s62, 0x100000
    s_cbranch_scc1 .mg_end_1
    s_waitcnt vmcnt(1)
    v_max_u32 v18, v29, v31
    v_cmp_eq_u32 vcc, -1, v18
    s_cbranch_vccnz .nk_124
.ok_125:
    v_smfmac_f32_16x16x64_bf16 v[40:43], v[28:31], a[8:15], v2
    v_smfmac_f32_16x16x64_bf16 v[44:47], v[28:31], a[40:47], v2
    s_waitcnt vmcnt(0)
    v_max_u32 v18, v25, v27
    v_cmp_eq_u32 vcc, -1, v18
    v_smfmac_f32_16x16x64_bf16 v[48:51], v[28:31], a[72:79], v2
    v_smfmac_f32_16x16x64_bf16 v[52:55], v[28:31], a[104:111], v2
    s_cbranch_vccnz .nk_88
    s_branch .ok_89
.nk_106:
    buffer_load_dwordx4 v[36:39], v3, s[8:11], s30 offen offset:3072 sc1
    s_add_u32 s62, s62, 1
    s_cmp_gt_u32 s62, 0x100000
    s_cbranch_scc1 .mg_end_1
    s_waitcnt vmcnt(2)
    v_max_u32 v18, v25, v27
    v_cmp_eq_u32 vcc, -1, v18
    s_cbranch_vccnz .nk_126
.ok_127:
    v_smfmac_f32_16x16x64_bf16 v[40:43], v[24:27], a[0:7], v2
    v_smfmac_f32_16x16x64_bf16 v[44:47], v[24:27], a[32:39], v2
    s_waitcnt vmcnt(1)
    v_max_u32 v18, v33, v35
    v_cmp_eq_u32 vcc, -1, v18
    v_smfmac_f32_16x16x64_bf16 v[48:51], v[24:27], a[64:71], v2
    v_smfmac_f32_16x16x64_bf16 v[52:55], v[24:27], a[96:103], v2
    s_cbranch_vccnz .nk_78
    s_branch .ok_79
.nk_108:
    buffer_load_dwordx4 v[24:27], v3, s[8:11], s30 offen offset:0 sc1
    s_add_u32 s62, s62, 1
    s_cmp_gt_u32 s62, 0x100000
    s_cbranch_scc1 .mg_end_1
    s_waitcnt vmcnt(1)
    v_max_u32 v18, v33, v35
    v_cmp_eq_u32 vcc, -1, v18
    s_cbranch_vccnz .nk_128
.ok_129:
    v_smfmac_f32_16x16x64_bf16 v[40:43], v[32:35], a[16:23], v2
    v_smfmac_f32_16x16x64_bf16 v[44:47], v[32:35], a[48:55], v2
    s_waitcnt vmcnt(0)
    v_max_u32 v18, v25, v27
    v_cmp_eq_u32 vcc, -1, v18
    v_smfmac_f32_16x16x64_bf16 v[48:51], v[32:35], a[80:87], v2
    v_smfmac_f32_16x16x64_bf16 v[52:55], v[32:35], a[112:119], v2
    s_cbranch_vccnz .nk_88
    s_branch .ok_89
.nk_110:
    buffer_load_dwordx4 v[24:27], v3, s[8:11], s30 offen offset:0 sc1
    s_add_u32 s62, s62, 1
    s_cmp_gt_u32 s62, 0x100000
    s_cbranch_scc1 .mg_end_1
    s_waitcnt vmcnt(1)
    v_max_u32 v18, v37, v39
    v_cmp_eq_u32 vcc, -1, v18
    s_cbranch_vccnz .nk_86
    s_branch .ok_87
.nk_112:
    buffer_load_dwordx4 v[36:39], v3, s[8:11], s30 offen offset:3072 sc1
    s_add_u32 s62, s62, 1
    s_cmp_gt_u32 s62, 0x100000
    s_cbranch_scc1 .mg_end_1
    s_waitcnt vmcnt(2)
    v_max_u32 v18, v29, v31
    v_cmp_eq_u32 vcc, -1, v18
    s_cbranch_vccnz .nk_76
    s_branch .ok_77
.nk_114:
    buffer_load_dwordx4 v[28:31], v3, s[8:11], s30 offen offset:1024 sc1
    s_add_u32 s62, s62, 1
    s_cmp_gt_u32 s62, 0x100000
    s_cbranch_scc1 .mg_end_1
    s_waitcnt vmcnt(1)
    v_max_u32 v18, v33, v35
    v_cmp_eq_u32 vcc, -1, v18
    s_cbranch_vccnz .nk_130
.ok_131:
    v_smfmac_f32_16x16x64_bf16 v[40:43], v[32:35], a[16:23], v2
    v_smfmac_f32_16x16x64_bf16 v[44:47], v[32:35], a[48:55], v2
    s_waitcnt vmcnt(0)
    v_max_u32 v18, v29, v31
    v_cmp_eq_u32 vcc, -1, v18
    v_smfmac_f32_16x16x64_bf16 v[48:51], v[32:35], a[80:87], v2
    v_smfmac_f32_16x16x64_bf16 v[52:55], v[32:35], a[112:119], v2
    s_cbranch_vccnz .nk_94
    s_branch .ok_95
.nk_116:
    buffer_load_dwordx4 v[28:31], v3, s[8:11], s30 offen offset:1024 sc1
    s_add_u32 s62, s62, 1
    s_cmp_gt_u32 s62, 0x100000
    s_cbranch_scc1 .mg_end_1
    s_waitcnt vmcnt(1)
    v_max_u32 v18, v37, v39
    v_cmp_eq_u32 vcc, -1, v18
    s_cbranch_vccnz .nk_92
    s_branch .ok_93
.nk_118:
    buffer_load_dwordx4 v[36:39], v3, s[8:11], s30 offen offset:3072 sc1
    s_add_u32 s62, s62, 1
    s_cmp_gt_u32 s62, 0x100000
    s_cbranch_scc1 .mg_end_1
    s_waitcnt vmcnt(3)
    v_max_u32 v18, v25, v27
    v_cmp_eq_u32 vcc, -1, v18
    s_cbranch_vccnz .nk_74
    s_branch .ok_75
.nk_120:
    buffer_load_dwordx4 v[24:27], v3, s[8:11], s30 offen offset:0 sc1
    s_add_u32 s62, s62, 1
    s_cmp_gt_u32 s62, 0x100000
    s_cbranch_scc1 .mg_end_1
    s_waitcnt vmcnt(2)
    v_max_u32 v18, v29, v31
    v_cmp_eq_u32 vcc, -1, v18
    s_cbranch_vccnz .nk_132
.ok_133:
    v_smfmac_f32_16x16x64_bf16 v[40:43], v[28:31], a[8:15], v2
    v_smfmac_f32_16x16x64_bf16 v[44:47], v[28:31], a[40:47], v2
    s_waitcnt vmcnt(1)
    v_max_u32 v18, v33, v35
    v_cmp_eq_u32 vcc, -1, v18
    v_smfmac_f32_16x16x64_bf16 v[48:51], v[28:31], a[72:79], v2
    v_smfmac_f32_16x16x64_bf16 v[52:55], v[28:31], a[104:111], v2
    s_cbranch_vccnz .nk_128
    s_branch .ok_129
.nk_122:
    buffer_load_dwordx4 v[24:27], v3, s[8:11], s30 offen offset:0 sc1
    s_add_u32 s62, s62, 1
    s_cmp_gt_u32 s62, 0x100000
    s_cbranch_scc1 .mg_end_1
    s_waitcnt vmcnt(2)
    v_max_u32 v18, v29, v31
    v_cmp_eq_u32 vcc, -1, v18
    s_cbranch_vccnz .nk_134
.ok_135:
    v_smfmac_f32_16x16x64_bf16 v[40:43], v[28:31], a[8:15], v2
    v_smfmac_f32_16x16x64_bf16 v[44:47], v[28:31], a[40:47], v2
    s_waitcnt vmcnt(1)
    v_max_u32 v18, v37, v39
    v_cmp_eq_u32 vcc, -1, v18
    v_smfmac_f32_16x16x64_bf16 v[48:51], v[28:31], a[72:79], v2
    v_smfmac_f32_16x16x64_bf16 v[52:55], v[28:31], a[104:111], v2
    s_cbranch_vccnz .nk_86
    s_branch .ok_87
.nk_124:
    buffer_load_dwordx4 v[28:31], v3, s[8:11], s30 offen offset:1024 sc1
    s_add_u32 s62, s62, 1
    s_cmp_gt_u32 s62, 0x100000
    s_cbranch_scc1 .mg_end_1
    s_waitcnt vmcnt(1)
    v_max_u32 v18, v25, v27
    v_cmp_eq_u32 vcc, -1, v18
    s_cbranch_vccnz .nk_104
    s_branch .ok_105
.nk_126:
    buffer_load_dwordx4 v[24:27], v3, s[8:11], s30 offen offset:0 sc1
    s_add_u32 s62, s62, 1
    s_cmp_gt_u32 s62, 0x100000
    s_cbranch_scc1 .mg_end_1
    s_waitcnt vmcnt(2)
    v_max_u32 v18, v33, v35
    v_cmp_eq_u32 vcc, -1, v18
    s_cbranch_vccnz .nk_84
    s_branch .ok_85
.nk_128:
    buffer_load_dwordx4 v[32:35], v3, s[8:11], s30 offen offset:2048 sc1
    s_add_u32 s62, s62, 1
    s_cmp_gt_u32 s62, 0x100000
    s_cbranch_scc1 .mg_end_1
    s_waitcnt vmcnt(1)
    v_max_u32 v18, v25, v27
    v_cmp_eq_u32 vcc, -1, v18
    s_cbranch_vccnz .nk_108
    s_branch .ok_109
.nk_130:
    buffer_load_dwordx4 v[32:35], v3, s[8:11], s30 offen offset:2048 sc1
    s_add_u32 s62, s62, 1
    s_cmp_gt_u32 s62, 0x100000
    s_cbranch_scc1 .mg_end_1
    s_waitcnt vmcnt(1)
    v_max_u32 v18, v29, v31
    v_cmp_eq_u32 vcc, -1, v18
    s_cbranch_vccnz .nk_114
    s_branch .ok_115
.nk_132:
    buffer_load_dwordx4 v[28:31], v3, s[8:11], s30 offen offset:1024 sc1
    s_add_u32 s62, s62, 1
    s_cmp_gt_u32 s62, 0x100000
    s_cbranch_scc1 .mg_end_1
    s_waitcnt vmcnt(2)
    v_max_u32 v18, v33, v35
    v_cmp_eq_u32 vcc, -1, v18
    s_cbranch_vccnz .nk_136
.ok_137:
    v_smfmac_f32_16x16x64_bf16 v[40:43], v[32:35], a[16:23], v2
    v_smfmac_f32_16x16x64_bf16 v[44:47], v[32:35], a[48:55], v2
    s_waitcnt vmcnt(1)
    v_max_u32 v18, v25, v27
    v_cmp_eq_u32 vcc, -1, v18
    v_smfmac_f32_16x16x64_bf16 v[48:51], v[32:35], a[80:87], v2
    v_smfmac_f32_16x16x64_bf16 v[52:55], v[32:35], a[112:119], v2
    s_cbranch_vccnz .nk_104
    s_branch .ok_105
.nk_134:
    buffer_load_dwordx4 v[28:31], v3, s[8:11], s30 offen offset:1024 sc1
    s_add_u32 s62, s62, 1
    s_cmp_gt_u32 s62, 0x100000
    s_cbranch_scc1 .mg_end_1
    s_waitcnt vmcnt(2)
    v_max_u32 v18, v37, v39
    v_cmp_eq_u32 vcc, -1, v18
    s_cbranch_vccnz .nk_102
    s_branch .ok_103
.nk_136:
    buffer_load_dwordx4 v[32:35], v3, s[8:11], s30 offen offset:2048 sc1
    s_add_u32 s62, s62, 1
    s_cmp_gt_u32 s62, 0x100000
    s_cbranch_scc1 .mg_end_1
    s_waitcnt vmcnt(2)
    v_max_u32 v18, v25, v27
    v_cmp_eq_u32 vcc, -1, v18
    s_cbranch_vccnz .nk_120
    s_branch .ok_121
.p2align 6
.gm_23:
    s_waitcnt vmcnt(3)
    v_cmp_eq_u32 vcc, -1, v27
    s_cbranch_vccnz .nk_138
.ok_139:
    v_smfmac_f32_16x16x64_bf16 v[64:67], v[24:27], a[192:199], v2
    s_waitcnt vmcnt(2)
    v_cmp_eq_u32 vcc, -1, v31
    v_smfmac_f32_16x16x64_bf16 v[68:71], v[24:27], a[224:231], v2
    s_cbranch_vccnz .nk_140
.ok_141:
    v_smfmac_f32_16x16x64_bf16 v[64:67], v[28:31], a[200:207], v2
    s_waitcnt vmcnt(1)
    v_cmp_eq_u32 vcc, -1, v35
    v_smfmac_f32_16x16x64_bf16 v[68:71], v[28:31], a[232:239], v2
    s_cbranch_vccnz .nk_142
.ok_143:
    v_smfmac_f32_16x16x64_bf16 v[64:67], v[32:35], a[208:215], v2
    s_waitcnt vmcnt(0)
    v_cmp_eq_u32 vcc, -1, v39
    v_smfmac_f32_16x16x64_bf16 v[68:71], v[32:35], a[240:247], v2
    s_cbranch_vccnz .nk_144
.ok_145:
    v_smfmac_f32_16x16x64_bf16 v[64:67], v[36:39], a[216:223], v2
    v_smfmac_f32_16x16x64_bf16 v[68:71], v[36:39], a[248:255], v2
    s_setpc_b64 s[98:99]
.nk_138:
    buffer_load_dwordx4 v[24:27], v4, s[8:11], s30 offen offset:0 sc1
    s_add_u32 s62, s62, 1
    s_cmp_gt_u32 s62, 0x100000
    s_cbranch_scc1 .mg_end_1
    s_waitcnt vmcnt(3)
    v_cmp_eq_u32 vcc, -1, v31
    s_cbranch_vccnz .nk_146
.ok_147:
    v_smfmac_f32_16x16x64_bf16 v[64:67], v[28:31], a[200:207], v2
    s_waitcnt vmcnt(2)
    v_cmp_eq_u32 vcc, -1, v35
    v_smfmac_f32_16x16x64_bf16 v[68:71], v[28:31], a[232:239], v2
    s_cbranch_vccnz .nk_148
.ok_149:
    v_smfmac_f32_16x16x64_bf16 v[64:67], v[32:35], a[208:215], v2
    s_waitcnt vmcnt(1)
    v_cmp_eq_u32 vcc, -1, v39
    v_smfmac_f32_16x16x64_bf16 v[68:71], v[32:35], a[240:247], v2
    s_cbranch_vccnz .nk_150
.ok_151:
    v_smfmac_f32_16x16x64_bf16 v[64:67], v[36:39], a[216:223], v2
    s_waitcnt vmcnt(0)
    v_cmp_eq_u32 vcc, -1, v27
    v_smfmac_f32_16x16x64_bf16 v[68:71], v[36:39], a[248:255], v2
    s_cbranch_vccnz .nk_152
.ok_153:
    v_smfmac_f32_16x16x64_bf16 v[64:67], v[24:27], a[192:199], v2
    v_smfmac_f32_16x16x64_bf16 v[68:71], v[24:27], a[224:231], v2
    s_setpc_b64 s[98:99]
.nk_140:
    buffer_load_dwordx4 v[28:31], v4, s[8:11], s30 offen offset:1024 sc1
    s_add_u32 s62, s62, 1
    s_cmp_gt_u32 s62, 0x100000
    s_cbranch_scc1 .mg_end_1
    s_waitcnt vmcnt(2)
    v_cmp_eq_u32 vcc, -1, v35
    s_cbranch_vccnz .nk_154
.ok_155:
    v_smfmac_f32_16x16x64_bf16 v[64:67], v[32:35], a[208:215], v2
    s_waitcnt vmcnt(1)
    v_cmp_eq_u32 vcc, -1, v39
    v_smfmac_f32_16x16x64_bf16 v[68:71], v[32:35], a[240:247], v2
    s_cbranch_vccnz .nk_156
.ok_157:
    v_smfmac_f32_16x16x64_bf16 v[64:67], v[36:39], a[216:223], v2
    s_waitcnt vmcnt(0)
    v_cmp_eq_u32 vcc, -1, v31
    v_smfmac_f32_16x16x64_bf16 v[68:71], v[36:39], a[248:255], v2
    s_cbranch_vccnz .nk_158
.ok_159:
    v_smfmac_f32_16x16x64_bf16 v[64:67], v[28:31], a[200:207], v2
    v_smfmac_f32_16x16x64_bf16 v[68:71], v[28:31], a[232:239], v2
    s_setpc_b64 s[98:99]
.nk_142:
    buffer_load_dwordx4 v[32:35], v4, s[8:11], s30 offen offset:2048 sc1
    s_add_u32 s62, s62, 1
    s_cmp_gt_u32 s62, 0x100000
    s_cbranch_scc1 .mg_end_1
    s_waitcnt vmcnt(1)
    v_cmp_eq_u32 vcc, -1, v39
    s_cbranch_vccnz .nk_160
.ok_161:
    v_smfmac_f32_16x16x64_bf16 v[64:67], v[36:39], a[216:223], v2
    s_waitcnt vmcnt(0)
    v_cmp_eq_u32 vcc, -1, v35
    v_smfmac_f32_16x16x64_bf16 v[68:71], v[36:39], a[248:255], v2
    s_cbranch_vccnz .nk_162
.ok_163:
    v_smfmac_f32_16x16x64_bf16 v[64:67], v[32:35], a[208:215], v2
    v_smfmac_f32_16x16x64_bf16 v[68:71], v[32:35], a[240:247], v2
    s_setpc_b64 s[98:99]
.nk_144:
    buffer_load_dwordx4 v[36:39], v4, s[8:11], s30 offen offset:3072 sc1
    s_add_u32 s62, s62, 1
    s_cmp_gt_u32 s62, 0x100000
    s_cbranch_scc1 .mg_end_1
    s_waitcnt vmcnt(0)
    v_cmp_eq_u32 vcc, -1, v39
    s_cbranch_vccnz .nk_144
    s_branch .ok_145
.nk_146:
    buffer_load_dwordx4 v[28:31], v4, s[8:11], s30 offen offset:1024 sc1
    s_add_u32 s62, s62, 1
    s_cmp_gt_u32 s62, 0x100000
    s_cbranch_scc1 .mg_end_1
    s_waitcnt vmcnt(3)
    v_cmp_eq_u32 vcc, -1, v35
    s_cbranch_vccnz .nk_164
.ok_165:
    v_smfmac_f32_16x16x64_bf16 v[64:67], v[32:35], a[208:215], v2
    s_waitcnt vmcnt(2)
    v_cmp_eq_u32 vcc, -1, v39
    v_smfmac_f32_16x16x64_bf16 v[68:71], v[32:35], a[240:247], v2
    s_cbranch_vccnz .nk_166
.ok_167:
    v_smfmac_f32_16x16x64_bf16 v[64:67], v[36:39], a[216:223], v2
    s_waitcnt vmcnt(1)
    v_cmp_eq_u32 vcc, -1, v27
    v_smfmac_f32_16x16x64_bf16 v[68:71], v[36:39], a[248:255], v2
    s_cbranch_vccnz .nk_168
.ok_169:
    v_smfmac_f32_16x16x64_bf16 v[64:67], v[24:27], a[192:199], v2
    s_waitcnt vmcnt(0)
    v_cmp_eq_u32 vcc, -1, v31
    v_smfmac_f32_16x16x64_bf16 v[68:71], v[24:27], a[224:231], v2
    s_cbranch_vccnz .nk_158
    s_branch .ok_159
.nk_148:
    buffer_load_dwordx4 v[32:35], v4, s[8:11], s30 offen offset:2048 sc1
    s_add_u32 s62, s62, 1
    s_cmp_gt_u32 s62, 0x100000
    s_cbranch_scc1 .mg_end_1
    s_waitcnt vmcnt(2)
    v_cmp_eq_u32 vcc, -1, v39
    s_cbranch_vccnz .nk_170
.ok_171:
    v_smfmac_f32_16x16x64_bf16 v[64:67], v[36:39], a[216:223], v2
    s_waitcnt vmcnt(1)
    v_cmp_eq_u32 vcc, -1, v27
    v_smfmac_f32_16x16x64_bf16 v[68:71], v[36:39], a[248:255], v2
    s_cbranch_vccnz .nk_172
.ok_173:
    v_smfmac_f32_16x16x64_bf16 v[64:67], v[24:27], a[192:199], v2
    s_waitcnt vmcnt(0)
    v_cmp_eq_u32 vcc, -1, v35
    v_smfmac_f32_16x16x64_bf16 v[68:71], v[24:27], a[224:231], v2
    s_cbranch_vccnz .nk_162
    s_branch .ok_163
.nk_150:
    buffer_load_dwordx4 v[36:39], v4, s[8:11], s30 offen offset:3072 sc1
    s_add_u32 s62, s62, 1
    s_cmp_gt_u32 s62, 0x100000
    s_cbranch_scc1 .mg_end_1
    s_waitcnt vmcnt(1)
    v_cmp_eq_u32 vcc, -1, v27
    s_cbranch_vccnz .nk_174
.ok_175:
    v_smfmac_f32_16x16x64_bf16 v[64:67], v[24:27], a[192:199], v2
    s_waitcnt vmcnt(0)
    v_cmp_eq_u32 vcc, -1, v39
    v_smfmac_f32_16x16x64_bf16 v[68:71], v[24:27], a[224:231], v2
    s_cbranch_vccnz .nk_144
    s_branch .ok_145
.nk_152:
    buffer_load_dwordx4 v[24:27], v4, s[8:11], s30 offen offset:0 sc1
    s_add_u32 s62, s62, 1
    s_cmp_gt_u32 s62, 0x100000
    s_cbranch_scc1 .mg_end_1
    s_waitcnt vmcnt(0)
    v_cmp_eq_u32 vcc, -1, v27
    s_cbranch_vccnz .nk_152
    s_branch .ok_153
.nk_154:
    buffer_load_dwordx4 v[32:35], v4, s[8:11], s30 offen offset:2048 sc1
    s_add_u32 s62, s62, 1
    s_cmp_gt_u32 s62, 0x100000
    s_cbranch_scc1 .mg_end_1
    s_waitcnt vmcnt(2)
    v_cmp_eq_u32 vcc, -1, v39
    s_cbranch_vccnz .nk_176
.ok_177:
    v_smfmac_f32_16x16x64_bf16 v[64:67], v[36:39], a[216:223], v2
    s_waitcnt vmcnt(1)
    v_cmp_eq_u32 vcc, -1, v31
    v_smfmac_f32_16x16x64_bf16 v[68:71], v[36:39], a[248:255], v2
    s_cbranch_vccnz .nk_178
.ok_179:
    v_smfmac_f32_16x16x64_bf16 v[64:67], v[28:31], a[200:207], v2
    s_waitcnt vmcnt(0)
    v_cmp_eq_u32 vcc, -1, v35
    v_smfmac_f32_16x16x64_bf16 v[68:71], v[28:31], a[232:239], v2
    s_cbranch_vccnz .nk_162
    s_branch .ok_163
.nk_156:
    buffer_load_dwordx4 v[36:39], v4, s[8:11], s30 offen offset:3072 sc1
    s_add_u32 s62, s62, 1
    s_cmp_gt_u32 s62, 0x100000
    s_cbranch_scc1 .mg_end_1
    s_waitcnt vmcnt(1)
    v_cmp_eq_u32 vcc, -1, v31
    s_cbranch_vccnz .nk_180
.ok_181:
    v_smfmac_f32_16x16x64_bf16 v[64:67], v[28:31], a[200:207], v2
    s_waitcnt vmcnt(0)
    v_cmp_eq_u32 vcc, -1, v39
    v_smfmac_f32_16x16x64_bf16 v[68:71], v[28:31], a[232:239], v2
    s_cbranch_vccnz .nk_144
    s_branch .ok_145
.nk_158:
    buffer_load_dwordx4 v[28:31], v4, s[8:11], s30 offen offset:1024 sc1
    s_add_u32 s62, s62, 1
    s_cmp_gt_u32 s62, 0x100000
    s_cbranch_scc1 .mg_end_1
    s_waitcnt vmcnt(0)
    v_cmp_eq_u32 vcc, -1, v31
    s_cbranch_vccnz .nk_158
    s_branch .ok_159
.nk_160:
    buffer_load_dwordx4 v[36:39], v4, s[8:11], s30 offen offset:3072 sc1
    s_add_u32 s62, s62, 1
    s_cmp_gt_u32 s62, 0x100000
    s_cbranch_scc1 .mg_end_1
    s_waitcnt vmcnt(1)
    v_cmp_eq_u32 vcc, -1, v35
    s_cbranch_vccnz .nk_142
    s_branch .ok_143
.nk_162:
    buffer_load_dwordx4 v[32:35], v4, s[8:11], s30 offen offset:2048 sc1
    s_add_u32 s62, s62, 1
    s_cmp_gt_u32 s62, 0x100000
    s_cbranch_scc1 .mg_end_1
    s_waitcnt vmcnt(0)
    v_cmp_eq_u32 vcc, -1, v35
    s_cbranch_vccnz .nk_162
    s_branch .ok_163
.nk_164:
    buffer_load_dwordx4 v[32:35], v4, s[8:11], s30 offen offset:2048 sc1
    s_add_u32 s62, s62, 1
    s_cmp_gt_u32 s62, 0x100000
    s_cbranch_scc1 .mg_end_1
    s_waitcnt vmcnt(3)
    v_cmp_eq_u32 vcc, -1, v39
    s_cbranch_vccnz .nk_182
.ok_183:
    v_smfmac_f32_16x16x64_bf16 v[64:67], v[36:39], a[216:223], v2
    s_waitcnt vmcnt(2)
    v_cmp_eq_u32 vcc, -1, v27
    v_smfmac_f32_16x16x64_bf16 v[68:71], v[36:39], a[248:255], v2
    s_cbranch_vccnz .nk_184
.ok_185:
    v_smfmac_f32_16x16x64_bf16 v[64:67], v[24:27], a[192:199], v2
    s_waitcnt vmcnt(1)
    v_cmp_eq_u32 vcc, -1, v31
    v_smfmac_f32_16x16x64_bf16 v[68:71], v[24:27], a[224:231], v2
    s_cbranch_vccnz .nk_178
    s_branch .ok_179
.nk_166:
    buffer_load_dwordx4 v[36:39], v4, s[8:11], s30 offen offset:3072 sc1
    s_add_u32 s62, s62, 1
    s_cmp_gt_u32 s62, 0x100000
    s_cbranch_scc1 .mg_end_1
    s_waitcnt vmcnt(2)
    v_cmp_eq_u32 vcc, -1, v27
    s_cbranch_vccnz .nk_186
.ok_187:
    v_smfmac_f32_16x16x64_bf16 v[64:67], v[24:27], a[192:199], v2
    s_waitcnt vmcnt(1)
    v_cmp_eq_u32 vcc, -1, v31
    v_smfmac_f32_16x16x64_bf16 v[68:71], v[24:27], a[224:231], v2
    s_cbranch_vccnz .nk_180
    s_branch .ok_181
.nk_168:
    buffer_load_dwordx4 v[24:27], v4, s[8:11], s30 offen offset:0 sc1
    s_add_u32 s62, s62, 1
    s_cmp_gt_u32 s62, 0x100000
    s_cbranch_scc1 .mg_end_1
    s_waitcnt vmcnt(1)
    v_cmp_eq_u32 vcc, -1, v31
    s_cbranch_vccnz .nk_188
.ok_189:
    v_smfmac_f32_16x16x64_bf16 v[64:67], v[28:31], a[200:207], v2
    s_waitcnt vmcnt(0)
    v_cmp_eq_u32 vcc, -1, v27
    v_smfmac_f32_16x16x64_bf16 v[68:71], v[28:31], a[232:239], v2
    s_cbranch_vccnz .nk_152
    s_branch .ok_153
.nk_170:
    buffer_load_dwordx4 v[36:39], v4, s[8:11], s30 offen offset:3072 sc1
    s_add_u32 s62, s62, 1
    s_cmp_gt_u32 s62, 0x100000
    s_cbranch_scc1 .mg_end_1
    s_waitcnt vmcnt(2)
    v_cmp_eq_u32 vcc, -1, v27
    s_cbranch_vccnz .nk_190
.ok_191:
    v_smfmac_f32_16x16x64_bf16 v[64:67], v[24:27], a[192:199], v2
    s_waitcnt vmcnt(1)
    v_cmp_eq_u32 vcc, -1, v35
    v_smfmac_f32_16x16x64_bf16 v[68:71], v[24:27], a[224:231], v2
    s_cbranch_vccnz .nk_142
    s_branch .ok_143
.nk_172:
    buffer_load_dwordx4 v[24:27], v4, s[8:11], s30 offen offset:0 sc1
    s_add_u32 s62, s62, 1
    s_cmp_gt_u32 s62, 0x100000
    s_cbranch_scc1 .mg_end_1
    s_waitcnt vmcnt(1)
    v_cmp_eq_u32 vcc, -1, v35
    s_cbranch_vccnz .nk_192
.ok_193:
    v_smfmac_f32_16x16x64_bf16 v[64:67], v[32:35], a[208:215], v2
    s_waitcnt vmcnt(0)
    v_cmp_eq_u32 vcc, -1, v27
    v_smfmac_f32_16x16x64_bf16 v[68:71], v[32:35], a[240:247], v2
    s_cbranch_vccnz .nk_152
    s_branch .ok_153
.nk_174:
    buffer_load_dwordx4 v[24:27], v4, s[8:11], s30 offen offset:0 sc1
    s_add_u32 s62, s62, 1
    s_cmp_gt_u32 s62, 0x100000
    s_cbranch_scc1 .mg_end_1
    s_waitcnt vmcnt(1)
    v_cmp_eq_u32 vcc, -1, v39
    s_cbranch_vccnz .nk_150
    s_branch .ok_151
.nk_176:
    buffer_load_dwordx4 v[36:39], v4, s[8:11], s30 offen offset:3072 sc1
    s_add_u32 s62, s62, 1
    s_cmp_gt_u32 s62, 0x100000
    s_cbranch_scc1 .mg_end_1
    s_waitcnt vmcnt(2)
    v_cmp_eq_u32 vcc, -1, v31
    s_cbranch_vccnz .nk_140
    s_branch .ok_141
.nk_178:
    buffer_load_dwordx4 v[28:31], v4, s[8:11], s30 offen offset:1024 sc1
    s_add_u32 s62, s62, 1
    s_cmp_gt_u32 s62, 0x100000
    s_cbranch_scc1 .mg_end_1
    s_waitcnt vmcnt(1)
    v_cmp_eq_u32 vcc, -1, v35
    s_cbranch_vccnz .nk_194
.ok_195:
    v_smfmac_f32_16x16x64_bf16 v[64:67], v[32:35], a[208:215], v2
    s_waitcnt vmcnt(0)
    v_cmp_eq_u32 vcc, -1, v31
    v_smfmac_f32_16x16x64_bf16 v[68:71], v[32:35], a[240:247], v2
    s_cbranch_vccnz .nk_158
    s_branch .ok_159
.nk_180:
    buffer_load_dwordx4 v[28:31], v4, s[8:11], s30 offen offset:1024 sc1
    s_add_u32 s62, s62, 1
    s_cmp_gt_u32 s62, 0x100000
    s_cbranch_scc1 .mg_end_1
    s_waitcnt vmcnt(1)
    v_cmp_eq_u32 vcc, -1, v39
    s_cbranch_vccnz .nk_156
    s_branch .ok_157
.nk_182:
    buffer_load_dwordx4 v[36:39], v4, s[8:11], s30 offen offset:3072 sc1
    s_add_u32 s62, s62, 1
    s_cmp_gt_u32 s62, 0x100000
    s_cbranch_scc1 .mg_end_1
    s_waitcnt vmcnt(3)
    v_cmp_eq_u32 vcc, -1, v27
    s_cbranch_vccnz .nk_138
    s_branch .ok_139
.nk_184:
    buffer_load_dwordx4 v[24:27], v4, s[8:11], s30 offen offset:0 sc1
    s_add_u32 s62, s62, 1
    s_cmp_gt_u32 s62, 0x100000
    s_cbranch_scc1 .mg_end_1
    s_waitcnt vmcnt(2)
    v_cmp_eq_u32 vcc, -1, v31
    s_cbranch_vccnz .nk_196
.ok_197:
    v_smfmac_f32_16x16x64_bf16 v[64:67], v[28:31], a[200:207], v2
    s_waitcnt vmcnt(1)
    v_cmp_eq_u32 vcc, -1, v35
    v_smfmac_f32_16x16x64_bf16 v[68:71], v[28:31], a[232:239], v2
    s_cbranch_vccnz .nk_192
    s_branch .ok_193
.nk_186:
    buffer_load_dwordx4 v[24:27], v4, s[8:11], s30 offen offset:0 sc1
    s_add_u32 s62, s62, 1
    s_cmp_gt_u32 s62, 0x100000
    s_cbranch_scc1 .mg_end_1
    s_waitcnt vmcnt(2)
    v_cmp_eq_u32 vcc, -1, v31
    s_cbranch_vccnz .nk_198
.ok_199:
    v_smfmac_f32_16x16x64_bf16 v[64:67], v[28:31], a[200:207], v2
    s_waitcnt vmcnt(1)
    v_cmp_eq_u32 vcc, -1, v39
    v_smfmac_f32_16x16x64_bf16 v[68:71], v[28:31], a[232:239], v2
    s_cbranch_vccnz .nk_150
    s_branch .ok_151
.nk_188:
    buffer_load_dwordx4 v[28:31], v4, s[8:11], s30 offen offset:1024 sc1
    s_add_u32 s62, s62, 1
    s_cmp_gt_u32 s62, 0x100000
    s_cbranch_scc1 .mg_end_1
    s_waitcnt vmcnt(1)
    v_cmp_eq_u32 vcc, -1, v27
    s_cbranch_vccnz .nk_168
    s_branch .ok_169
.nk_190:
    buffer_load_dwordx4 v[24:27], v4, s[8:11], s30 offen offset:0 sc1
    s_add_u32 s62, s62, 1
    s_cmp_gt_u32 s62, 0x100000
    s_cbranch_scc1 .mg_end_1
    s_waitcnt vmcnt(2)
    v_cmp_eq_u32 vcc, -1, v35
    s_cbranch_vccnz .nk_148
    s_branch .ok_149
.nk_192:
    buffer_load_dwordx4 v[32:35], v4, s[8:11], s30 offen offset:2048 sc1
    s_add_u32 s62, s62, 1
    s_cmp_gt_u32 s62, 0x100000
    s_cbranch_scc1 .mg_end_1
    s_waitcnt vmcnt(1)
    v_cmp_eq_u32 vcc, -1, v27
    s_cbranch_vccnz .nk_172
    s_branch .ok_173
.nk_194:
    buffer_load_dwordx4 v[32:35], v4, s[8:11], s30 offen offset:2048 sc1
    s_add_u32 s62, s62, 1
    s_cmp_gt_u32 s62, 0x100000
    s_cbranch_scc1 .mg_end_1
    s_waitcnt vmcnt(1)
    v_cmp_eq_u32 vcc, -1, v31
    s_cbranch_vccnz .nk_178
    s_branch .ok_179
.nk_196:
    buffer_load_dwordx4 v[28:31], v4, s[8:11], s30 offen offset:1024 sc1
    s_add_u32 s62, s62, 1
    s_cmp_gt_u32 s62, 0x100000
    s_cbranch_scc1 .mg_end_1
    s_waitcnt vmcnt(2)
    v_cmp_eq_u32 vcc, -1, v35
    s_cbranch_vccnz .nk_200
.ok_201:
    v_smfmac_f32_16x16x64_bf16 v[64:67], v[32:35], a[208:215], v2
    s_waitcnt vmcnt(1)
    v_cmp_eq_u32 vcc, -1, v27
    v_smfmac_f32_16x16x64_bf16 v[68:71], v[32:35], a[240:247], v2
    s_cbranch_vccnz .nk_168
    s_branch .ok_169
.nk_198:
    buffer_load_dwordx4 v[28:31], v4, s[8:11], s30 offen offset:1024 sc1
    s_add_u32 s62, s62, 1
    s_cmp_gt_u32 s62, 0x100000
    s_cbranch_scc1 .mg_end_1
    s_waitcnt vmcnt(2)
    v_cmp_eq_u32 vcc, -1, v39
    s_cbranch_vccnz .nk_166
    s_branch .ok_167
.nk_200:
    buffer_load_dwordx4 v[32:35], v4, s[8:11], s30 offen offset:2048 sc1
    s_add_u32 s62, s62, 1
    s_cmp_gt_u32 s62, 0x100000
    s_cbranch_scc1 .mg_end_1
    s_waitcnt vmcnt(2)
    v_cmp_eq_u32 vcc, -1, v27
    s_cbranch_vccnz .nk_184
    s_branch .ok_185
.slowv_17:
    s_mov_b32 s28, 0
    s_mov_b32 s30, 83886080
    s_mov_b32 s31, 84180992
    s_mov_b32 s32, 84475904
    s_mov_b32 s33, 84770816
    s_mov_b32 s41, 66977792
    s_lshl_b32 s42, s56, 13
    s_lshl_b32 s4, s53, 11
    s_add_u32 s44, s42, s4
    s_add_u32 s44, s44, 33554432
    s_add_u32 s42, s42, 16777216
    s_xor_b32 s4, s53, 2
    s_lshl_b32 s4, s4, 10
    s_add_u32 s42, s42, s4
    s_add_u32 s43, s42, 4096
    s_add_u32 s96, s44, 524288
    s_sub_u32 s95, s96, 16777216
    s_mov_b32 s62, 0
    s_mov_b32 s45, 0x3e0293ee
    s_mov_b32 s46, 0
    s_and_b32 s4, s25, 1
    s_lshl_b32 s4, s4, 14
    s_lshr_b32 s5, s25, 1
    s_lshl_b32 s5, s5, 12
    s_or_b32 s4, s4, s5
    s_xor_b32 s47, s47, s4
    s_and_b32 s5, s26, 1
    s_lshl_b32 s5, s5, 11
    s_lshr_b32 s4, s26, 1
    s_lshl_b32 s4, s4, 15
    s_or_b32 s5, s5, s4
    s_bfe_u32 s4, s26, 0x10004
    s_lshl_b32 s4, s4, 11
    s_xor_b32 s5, s5, s4
    s_xor_b32 s34, s5, s47
    s_xor_b32 s35, s34, 0x84000
    s_xor_b32 s36, s34, 0x101000
    s_xor_b32 s37, s34, 0x185000
    s_and_b32 s4, s25, 1
    s_lshl_b32 s35, s4, 14
    s_lshr_b32 s4, s25, 1
    s_lshl_b32 s4, s4, 12
    s_or_b32 s35, s35, s4
    s_and_b32 s4, s26, 1
    s_lshl_b32 s4, s4, 11
    s_or_b32 s35, s35, s4
    s_lshr_b32 s4, s26, 1
    s_lshl_b32 s4, s4, 15
    s_or_b32 s35, s35, s4
    s_cmp_eq_u32 s24, 1
    s_cbranch_scc1 .w1_203
    s_cmp_eq_u32 s24, 2
    s_cbranch_scc1 .w2_204
    s_cmp_eq_u32 s24, 3
    s_cbranch_scc1 .w3_205
.w0_202:
    v_bfe_u32 v254, v1, 4, 1
    v_mul_u32_u24 v168, 1024, v254
    v_bfe_u32 v254, v1, 5, 1
    v_mul_u32_u24 v254, 128, v254
    v_add_u32 v168, v168, v254
    v_bfe_u32 v254, v1, 3, 1
    v_mul_u32_u24 v254, 64, v254
    v_add_u32 v168, v168, v254
    v_bfe_u32 v254, v1, 0, 2
    v_mul_u32_u24 v254, 16, v254
    v_add_u32 v168, v168, v254
    v_bfe_u32 v254, v1, 2, 1
    v_mul_u32_u24 v254, 8, v254
    v_add_u32 v168, v168, v254
    v_add_u32 v168, s101, v168
    v_bfe_u32 v254, v1, 0, 1
    v_mul_u32_u24 v9, 144, v254
    v_bfe_u32 v254, v1, 1, 1
    v_mul_u32_u24 v254, 576, v254
    v_add_u32 v9, v9, v254
    v_bfe_u32 v254, v1, 2, 1
    v_mul_u32_u24 v254, 288, v254
    v_add_u32 v9, v9, v254
    v_bfe_u32 v254, v1, 3, 1
    v_mul_u32_u24 v254, 1152, v254
    v_add_u32 v9, v9, v254
    v_bfe_u32 v254, v1, 4, 2
    v_mul_u32_u24 v254, 32, v254
    v_add_u32 v9, v9, v254
    s_lshl_b32 s4, s56, 10
    v_bfe_u32 v254, v1, 0, 6
    v_mul_u32_u24 v13, 16, v254
    v_add_u32 v13, 262144, v13
    v_add_u32 v13, s4, v13
    v_xor_b32 v156, 1024, v246
    v_xor_b32 v157, 2048, v246
    v_xor_b32 v158, 3072, v246
    v_bfe_u32 v254, v1, 0, 1
    v_mul_u32_u24 v14, 16, v254
    v_bfe_u32 v254, v1, 4, 1
    v_mul_u32_u24 v254, 32, v254
    v_add_u32 v14, v14, v254
    v_bfe_u32 v254, v1, 1, 2
    v_mul_u32_u24 v254, 64, v254
    v_add_u32 v14, v14, v254
    v_bfe_u32 v254, v1, 5, 1
    v_mul_u32_u24 v254, 256, v254
    v_add_u32 v14, v14, v254
    v_add_u32 v14, 65536, v14
    v_add_u32 v14, s55, v14
    v_bfe_u32 v254, v1, 0, 6
    v_mul_u32_u24 v15, 16, v254
    v_bfe_u32 v254, v1, 2, 2
    v_mul_u32_u24 v16, 128, v254
    v_bfe_u32 v254, v1, 0, 2
    v_mul_u32_u24 v254, 16, v254
    v_add_u32 v16, v16, v254
    v_bfe_u32 v254, v1, 4, 2
    v_mul_u32_u24 v254, 4, v254
    v_add_u32 v16, v16, v254
    v_add_u32 v16, 18688, v16
    v_mov_b32 v208, 0
    v_mov_b32 v209, 0
    v_mov_b32 v210, 0
    v_mov_b32 v211, 0
    v_mov_b32 v212, 0
    v_mov_b32 v213, 0
    v_mov_b32 v214, 0
    v_mov_b32 v215, 0
    v_mov_b32 v216, 0
    v_mov_b32 v217, 0
    v_mov_b32 v218, 0
    v_mov_b32 v219, 0
    s_mov_b64 s[50:51], s[48:49]
    v_mov_b32 v164, 0
    v_mov_b32 v165, 0
    v_mov_b32 v166, 0
    v_mov_b32 v167, 0
    v_mov_b32 v164, 0x3f803f80
    v_mov_b32 v200, s45
    v_mov_b32 v220, 0x3f803f80
    v_mov_b32 v201, s45
    v_mov_b32 v221, 0x3f803f80
    v_mov_b32 v202, s45
    v_mov_b32 v222, 0x3f803f80
    v_mov_b32 v203, s45
    v_mov_b32 v223, 0x3f803f80
    s_waitcnt vmcnt(0)
    ds_read_b64_tr_b16 a[192:193], v242 offset:16384
    ds_read_b64_tr_b16 a[194:195], v242 offset:16896
    ds_read_b64_tr_b16 a[196:197], v242 offset:18432
    ds_read_b64_tr_b16 a[198:199], v242 offset:18944
    ds_read_b64_tr_b16 a[200:201], v242 offset:20480
    ds_read_b64_tr_b16 a[202:203], v242 offset:20992
    ds_read_b64_tr_b16 a[204:205], v242 offset:22528
    ds_read_b64_tr_b16 a[206:207], v242 offset:23040
    ds_read_b64_tr_b16 a[208:209], v242 offset:24576
    ds_read_b64_tr_b16 a[210:211], v242 offset:25088
    ds_read_b64_tr_b16 a[212:213], v242 offset:26624
    ds_read_b64_tr_b16 a[214:215], v242 offset:27136
    ds_read_b64_tr_b16 a[216:217], v242 offset:28672
    ds_read_b64_tr_b16 a[218:219], v242 offset:29184
    ds_read_b64_tr_b16 a[220:221], v242 offset:30720
    ds_read_b64_tr_b16 a[222:223], v242 offset:31232
    ds_read_b64_tr_b16 a[224:225], v243 offset:16384
    ds_read_b64_tr_b16 a[226:227], v243 offset:16896
    ds_read_b64_tr_b16 a[228:229], v243 offset:18432
    ds_read_b64_tr_b16 a[230:231], v243 offset:18944
    ds_read_b64_tr_b16 a[232:233], v243 offset:20480
    ds_read_b64_tr_b16 a[234:235], v243 offset:20992
    ds_read_b64_tr_b16 a[236:237], v243 offset:22528
    ds_read_b64_tr_b16 a[238:239], v243 offset:23040
    ds_read_b64_tr_b16 a[240:241], v243 offset:24576
    ds_read_b64_tr_b16 a[242:243], v243 offset:25088
    ds_read_b64_tr_b16 a[244:245], v243 offset:26624
    ds_read_b64_tr_b16 a[246:247], v243 offset:27136
    ds_read_b64_tr_b16 a[248:249], v243 offset:28672
    ds_read_b64_tr_b16 a[250:251], v243 offset:29184
    ds_read_b64_tr_b16 a[252:253], v243 offset:30720
    ds_read_b64_tr_b16 a[254:255], v243 offset:31232
    s_waitcnt lgkmcnt(0)
    s_barrier
    buffer_load_dwordx4 v[104:107], v15, s[8:11], s42 offen offset:0
    buffer_load_dwordx4 v[120:123], v15, s[8:11], s43 offen offset:0
    buffer_load_dwordx4 v[136:139], v15, s[8:11], s44 offen offset:0
    buffer_load_dwordx4 v[140:143], v15, s[8:11], s44 offen offset:1024
    s_add_u32 s42, s42, 262144
    s_add_u32 s43, s43, 262144
    s_add_u32 s44, s44, 262144
    s_add_u32 s37, s28, 0
    s_bitcmp1_b32 s37, 0
    s_cselect_b32 s4, 0x84000, 0
    s_xor_b32 s34, s35, s4
    s_bitcmp1_b32 s37, 1
    s_cselect_b32 s4, 0x101000, 0
    s_xor_b32 s34, s34, s4
    s_lshr_b32 s37, s37, 2
    s_bitcmp1_b32 s63, s37
    s_cselect_b32 s4, 0x2000, 0
    s_xor_b32 s34, s34, s4
    s_lshl_b32 s37, s37, 21
    s_add_u32 s34, s34, s37
.p2align 6
.step_208:
    s_barrier
    s_setprio 3
    buffer_load_dwordx4 v[24:27], v3, s[8:11], s30 offen offset:0 sc1
    s_setprio 2
    buffer_load_dwordx4 v[28:31], v3, s[8:11], s30 offen offset:1024 sc1
    s_setprio 1
    buffer_load_dwordx4 v[32:35], v3, s[8:11], s30 offen offset:2048 sc1
    s_setprio 0
    buffer_load_dwordx4 v[36:39], v3, s[8:11], s30 offen offset:3072 sc1
    s_call_b64 s[98:99], .gm_206
    v_pk_add_f32 v[40:41], v[40:41], v[42:43]
    v_pk_add_f32 v[42:43], v[44:45], v[46:47]
    ds_write2_b32 v5, v40, v41 offset0:0 offset1:36
    ds_write2_b32 v5, v42, v43 offset0:16 offset1:52
    s_nop 1
    v_pk_add_f32 v[48:49], v[48:49], v[50:51]
    v_pk_add_f32 v[50:51], v[52:53], v[54:55]
    ds_write2_b32 v6, v48, v49 offset0:0 offset1:36
    ds_write2_b32 v6, v50, v51 offset0:16 offset1:52
    s_waitcnt lgkmcnt(2)
    s_barrier
    ds_read_b128 v[72:75], v9 offset:0
    ds_read_b128 v[76:79], v9 offset:2304
    ds_read_b128 v[80:83], v9 offset:16
    ds_read_b128 v[84:87], v9 offset:2320
    v_smfmac_f32_16x16x64_bf16 v[56:59], v[24:27], a[128:135], v2
    v_smfmac_f32_16x16x64_bf16 v[60:63], v[24:27], a[160:167], v2
    s_waitcnt lgkmcnt(4)
    s_barrier
    v_smfmac_f32_16x16x64_bf16 v[56:59], v[28:31], a[136:143], v2
    s_waitcnt lgkmcnt(2)
    v_pk_add_f32 v[72:73], v[72:73], v[76:77]
    v_pk_add_f32 v[74:75], v[74:75], v[78:79]
    v_cvt_pk_bf16_f32 v144, v72, v73
    v_cvt_pk_bf16_f32 v145, v74, v75
    s_waitcnt lgkmcnt(0)
    v_pk_add_f32 v[80:81], v[80:81], v[84:85]
    v_pk_add_f32 v[82:83], v[82:83], v[86:87]
    v_cvt_pk_bf16_f32 v146, v80, v81
    v_cvt_pk_bf16_f32 v147, v82, v83
    s_nop 1
    v_mfma_f32_16x16x32_bf16 v[192:195], v[104:107], v[144:147], 0
    v_mfma_f32_16x16x32_bf16 v[160:163], v[120:123], v[144:147], 0
    v_smfmac_f32_16x16x64_bf16 v[60:63], v[28:31], a[168:175], v2
    v_add_f32_dpp v151, v195, v195 row_ror:8 row_mask:0xf bank_mask:0x3
    v_add_f32_dpp v148, v192, v192 row_ror:8 row_mask:0xf bank_mask:0x3
    v_add_f32_dpp v149, v193, v193 row_ror:8 row_mask:0xf bank_mask:0x3
    v_add_f32_dpp v150, v194, v194 row_ror:8 row_mask:0xf bank_mask:0x3
    v_add_f32_dpp v151, v163, v163 row_ror:8 row_mask:0xf bank_mask:0xc
    v_add_f32_dpp v148, v160, v160 row_ror:8 row_mask:0xf bank_mask:0xc
    v_add_f32_dpp v149, v161, v161 row_ror:8 row_mask:0xf bank_mask:0xc
    v_add_f32_dpp v150, v162, v162 row_ror:8 row_mask:0xf bank_mask:0xc
    v_min_u32 v151, 0xfffffffe, v151
    buffer_store_dwordx4 v[148:151], v246, s[8:11], s30 offen sc1
    v_smfmac_f32_16x16x64_bf16 v[56:59], v[32:35], a[144:151], v2
    v_smfmac_f32_16x16x64_bf16 v[60:63], v[32:35], a[176:183], v2
    v_smfmac_f32_16x16x64_bf16 v[56:59], v[36:39], a[152:159], v2
    v_smfmac_f32_16x16x64_bf16 v[60:63], v[36:39], a[184:191], v2
    v_mov_b32 v40, 0
    v_mov_b32 v41, 0
    v_mov_b32 v42, 0
    v_mov_b32 v43, 0
    v_mov_b32 v44, 0
    v_mov_b32 v45, 0
    v_mov_b32 v46, 0
    v_mov_b32 v47, 0
    v_pk_add_f32 v[56:57], v[56:57], v[58:59]
    v_pk_add_f32 v[58:59], v[60:61], v[62:63]
    v_cvt_pk_bf16_f32 v60, v56, v57
    v_cvt_pk_bf16_f32 v61, v58, v59
    ds_write2_b32 v255, v60, v61 offset0:0 offset1:32
    ds_write_b128 v8, v[56:59]
    s_cmp_eq_u32 s28, 63
    s_cbranch_scc1 .fin_209
    buffer_load_dwordx4 v[176:179], v13, s[8:11], s30 offen sc1
    buffer_load_dwordx4 v[180:183], v156, s[8:11], s30 offen sc1
    buffer_load_dwordx4 v[184:187], v157, s[8:11], s30 offen sc1
    buffer_load_dwordx4 v[188:191], v158, s[8:11], s30 offen sc1
    s_waitcnt lgkmcnt(0)
    s_barrier
    ds_read_b128 v[212:215], v15 offset:20224
    ds_read_b128 v[216:219], v15 offset:21248
    v_mov_b32 v48, 0
    v_mov_b32 v49, 0
    v_mov_b32 v50, 0
    v_mov_b32 v51, 0
    v_mov_b32 v52, 0
    v_mov_b32 v53, 0
    v_mov_b32 v54, 0
    v_mov_b32 v55, 0
    v_mov_b32 v56, 0
    v_mov_b32 v57, 0
    v_mov_b32 v58, 0
    v_mov_b32 v59, 0
    v_mov_b32 v60, 0
    v_mov_b32 v61, 0
    v_mov_b32 v62, 0
    v_mov_b32 v63, 0
    buffer_load_dwordx4 v[72:75], v13, s[8:11], s30 offen sc1
    buffer_load_dwordx4 v[76:79], v156, s[8:11], s30 offen sc1
    buffer_load_dwordx4 v[80:83], v157, s[8:11], s30 offen sc1
    buffer_load_dwordx4 v[84:87], v158, s[8:11], s30 offen sc1
.mf_210:
    s_waitcnt vmcnt(7)
    v_max3_u32 v18, v176, v177, v178
    v_pk_add_f32 v[196:197], v[176:177], v[178:179]
    s_waitcnt vmcnt(6)
    v_max3_u32 v18, v18, v179, v183
    v_pk_add_f32 v[192:193], v[148:149], v[180:181]
    v_pk_add_f32 v[194:195], v[150:151], v[182:183]
    v_add_f32 v196, v196, v197
    s_waitcnt vmcnt(5)
    v_pk_add_f32 v[192:193], v[192:193], v[184:185]
    v_pk_add_f32 v[194:195], v[194:195], v[186:187]
    s_waitcnt vmcnt(4)
    v_max3_u32 v18, v18, v187, v191
    v_pk_add_f32 v[192:193], v[192:193], v[188:189]
    v_pk_add_f32 v[194:195], v[194:195], v[190:191]
    v_cmp_eq_u32 vcc, -1, v18
    v_max3_f32 v19, v192, v193, v196
    v_max3_f32 v19, v19, v194, v195
    s_cbranch_vccnz .re_211
.sj_212:
    s_nop 0
    v_max_f32_dpp v18, v19, v19 row_ror:8 row_mask:0xf bank_mask:0xf
    v_max_f32_dpp v17, v19, v19 row_ror:8 row_mask:0xf bank_mask:0xf
    s_nop 1
    v_permlane16_swap_b32 v18, v17
    v_max_f32 v19, v18, v17
    v_max_f32 v18, v18, v17
    s_nop 1
    v_permlane32_swap_b32 v18, v19
    v_max_f32 v18, v18, v19
    v_mul_f32 v18, s45, v18
    v_fma_f32 v244, v196, s45, -v18
    v_pk_fma_f32 v[240:241], v[192:193], v[200:201], v[18:19] op_sel_hi:[1,1,0] neg_lo:[0,0,1] neg_hi:[0,0,1]
    v_exp_f32 v244, v244
    v_pk_fma_f32 v[242:243], v[194:195], v[200:201], v[18:19] op_sel_hi:[1,1,0] neg_lo:[0,0,1] neg_hi:[0,0,1]
    v_exp_f32 v240, v240
    v_mov_b32_dpp v245, v244 row_ror:8 row_mask:0xf bank_mask:0xf
    v_cvt_pk_bf16_f32 v208, v244, v245
    v_cvt_pk_bf16_f32 v209, v244, v245
    v_pk_mov_b32 v[210:211], v[208:209], v[208:209] op_sel:[0,1]
    v_exp_f32 v241, v241
    s_waitcnt lgkmcnt(0)
    v_mfma_f32_16x16x32_bf16 v[228:231], v[212:215], v[208:211], 0
    v_exp_f32 v242, v242
    v_mfma_f32_16x16x32_bf16 v[224:227], v[164:167], v[208:211], 0
    v_exp_f32 v243, v243
    v_cvt_pk_bf16_f32 v204, v240, v241
    v_cvt_pk_bf16_f32 v205, v242, v243
    v_mfma_f32_16x16x32_bf16 v[232:235], v[216:219], v[208:211], 0
    v_mov_b32_dpp v206, v204 row_ror:8 row_mask:0xf bank_mask:0xf
    v_mov_b32_dpp v207, v205 row_ror:8 row_mask:0xf bank_mask:0xf
    s_nop 1
    v_mfma_f32_16x16x32_bf16 v[224:227], v[220:223], v[204:207], v[224:227]
    v_mfma_f32_16x16x32_bf16 v[228:231], v[136:139], v[204:207], v[228:231]
    v_mfma_f32_16x16x32_bf16 v[232:235], v[140:143], v[204:207], v[232:235]
    s_mov_b64 exec, s[50:51]
    v_rcp_f32 v18, v224
    s_nop 1
    v_mul_f32 v228, v18, v228
    v_mul_f32 v229, v18, v229
    v_mul_f32 v230, v18, v230
    v_mul_f32 v231, v18, v231
    v_pk_mul_f32 v[232:233], v[18:19], v[232:233] op_sel_hi:[0,1]
    v_pk_mul_f32 v[234:235], v[18:19], v[234:235] op_sel_hi:[0,1]
    v_cvt_pk_bf16_f32 v236, v228, v229
    v_cvt_pk_bf16_f32 v239, v234, v235
    v_cvt_pk_bf16_f32 v237, v230, v231
    v_cvt_pk_bf16_f32 v238, v232, v233
    v_min_u32 v239, 0xfffffffe, v239
    buffer_store_dwordx4 v[236:239], v14, s[8:11], s30 offen sc1
    s_mov_b64 exec, -1
    v_mov_b32 v48, 0
    v_mov_b32 v49, 0
    v_mov_b32 v50, 0
    v_mov_b32 v51, 0
    v_mov_b32 v52, 0
    v_mov_b32 v53, 0
    v_mov_b32 v54, 0
    v_mov_b32 v55, 0
    v_mov_b32 v56, 0
    v_mov_b32 v57, 0
    v_mov_b32 v58, 0
    v_mov_b32 v59, 0
    v_mov_b32 v60, 0
    v_mov_b32 v61, 0
    v_mov_b32 v62, 0
    v_mov_b32 v63, 0
    s_waitcnt vmcnt(0)
    s_barrier
    s_setprio 3
    buffer_load_dwordx4 v[24:27], v4, s[8:11], s30 offen offset:0 sc1
    s_setprio 2
    buffer_load_dwordx4 v[28:31], v4, s[8:11], s30 offen offset:1024 sc1
    s_setprio 1
    buffer_load_dwordx4 v[32:35], v4, s[8:11], s30 offen offset:2048 sc1
    s_setprio 0
    buffer_load_dwordx4 v[36:39], v4, s[8:11], s30 offen offset:3072 sc1
    s_call_b64 s[98:99], .gm_207
    s_nop 4
    v_pk_add_f32 v[64:65], v[64:65], v[66:67]
    v_cvt_pk_bf16_f32 v66, v64, v65
    v_pk_add_f32 v[68:69], v[68:69], v[70:71]
    v_cvt_pk_bf16_f32 v67, v68, v69
    v_min_u32 v67, 0xfffffffe, v67
    buffer_store_dwordx2 v[66:67], v168, s[8:11], s34 offen sc1
    ds_write2_b32 v7, v64, v65 offset0:0 offset1:36
    ds_write2_b32 v7, v68, v69 offset0:16 offset1:52
    s_waitcnt lgkmcnt(0)
    s_barrier
    buffer_load_dwordx4 v[104:107], v15, s[8:11], s42 offen offset:0
    buffer_load_dwordx4 v[120:123], v15, s[8:11], s43 offen offset:0
    buffer_load_dwordx4 v[136:139], v15, s[8:11], s44 offen offset:0
    buffer_load_dwordx4 v[140:143], v15, s[8:11], s44 offen offset:1024
    s_add_u32 s42, s42, 262144
    s_add_u32 s43, s43, 262144
    s_add_u32 s44, s44, 262144
    s_add_u32 s37, s28, 1
    s_bitcmp1_b32 s37, 0
    s_cselect_b32 s4, 0x84000, 0
    s_xor_b32 s34, s35, s4
    s_bitcmp1_b32 s37, 1
    s_cselect_b32 s4, 0x101000, 0
    s_xor_b32 s34, s34, s4
    s_lshr_b32 s37, s37, 2
    s_bitcmp1_b32 s63, s37
    s_cselect_b32 s4, 0x2000, 0
    s_xor_b32 s34, s34, s4
    s_lshl_b32 s37, s37, 21
    s_add_u32 s34, s34, s37
    v_mov_b32 v64, 0
    v_mov_b32 v65, 0
    v_mov_b32 v66, 0
    v_mov_b32 v67, 0
    v_mov_b32 v68, 0
    v_mov_b32 v69, 0
    v_mov_b32 v70, 0
    v_mov_b32 v71, 0
    s_mov_b32 s4, s30
    s_mov_b32 s30, s31
    s_mov_b32 s31, s32
    s_mov_b32 s32, s33
    s_mov_b32 s33, s4
    s_add_u32 s28, s28, 1
    s_mov_b32 s62, 0
    s_branch .step_208
.fin_209:
    s_waitcnt lgkmcnt(0)
    s_barrier
    s_barrier
    s_endpgm
.re_211:
    buffer_load_dwordx4 v[176:179], v13, s[8:11], s30 offen sc1
    buffer_load_dwordx4 v[180:183], v156, s[8:11], s30 offen sc1
    buffer_load_dwordx4 v[184:187], v157, s[8:11], s30 offen sc1
    buffer_load_dwordx4 v[188:191], v158, s[8:11], s30 offen sc1
    s_waitcnt vmcnt(7)
    v_max3_u32 v18, v72, v73, v74
    v_pk_add_f32 v[196:197], v[72:73], v[74:75]
    s_waitcnt vmcnt(6)
    v_max3_u32 v18, v18, v75, v79
    v_pk_add_f32 v[192:193], v[148:149], v[76:77]
    v_pk_add_f32 v[194:195], v[150:151], v[78:79]
    v_add_f32 v196, v196, v197
    s_waitcnt vmcnt(5)
    v_pk_add_f32 v[192:193], v[192:193], v[80:81]
    v_pk_add_f32 v[194:195], v[194:195], v[82:83]
    s_waitcnt vmcnt(4)
    v_max3_u32 v18, v18, v83, v87
    v_pk_add_f32 v[192:193], v[192:193], v[84:85]
    v_pk_add_f32 v[194:195], v[194:195], v[86:87]
    v_cmp_eq_u32 vcc, -1, v18
    v_max3_f32 v19, v192, v193, v196
    v_max3_f32 v19, v19, v194, v195
    s_cbranch_vccnz .re_213
    s_branch .sj_212
.re_213:
    buffer_load_dwordx4 v[72:75], v13, s[8:11], s30 offen sc1
    buffer_load_dwordx4 v[76:79], v156, s[8:11], s30 offen sc1
    buffer_load_dwordx4 v[80:83], v157, s[8:11], s30 offen sc1
    buffer_load_dwordx4 v[84:87], v158, s[8:11], s30 offen sc1
    s_add_u32 s62, s62, 1
    s_cmp_gt_u32 s62, 0x100000
    s_cbranch_scc1 .mg_end_1
    s_branch .mf_210
.w1_203:
    v_bfe_u32 v254, v1, 4, 1
    v_mul_u32_u24 v168, 1024, v254
    v_bfe_u32 v254, v1, 5, 1
    v_mul_u32_u24 v254, 128, v254
    v_add_u32 v168, v168, v254
    v_bfe_u32 v254, v1, 3, 1
    v_mul_u32_u24 v254, 64, v254
    v_add_u32 v168, v168, v254
    v_bfe_u32 v254, v1, 0, 2
    v_mul_u32_u24 v254, 16, v254
    v_add_u32 v168, v168, v254
    v_bfe_u32 v254, v1, 2, 1
    v_mul_u32_u24 v254, 8, v254
    v_add_u32 v168, v168, v254
    v_add_u32 v168, 256, v168
    v_add_u32 v168, s101, v168
    v_bfe_u32 v254, v1, 0, 1
    v_mul_u32_u24 v17, 2, v254
    v_bfe_u32 v254, v1, 2, 1
    v_mul_u32_u24 v254, 1, v254
    v_add_u32 v17, v17, v254
    v_bfe_u32 v254, v1, 3, 1
    v_mul_u32_u24 v254, 4, v254
    v_add_u32 v17, v17, v254
    v_bfe_u32 v254, v1, 1, 1
    v_mul_u32_u24 v18, 16, v254
    v_mov_b32 v19, 0x3f80
    v_lshlrev_b32 v18, v18, v19
    v_cmp_eq_u32 vcc, 0, v17
    s_nop 1
    v_cndmask_b32 v124, 0, v18, vcc
    v_cmp_eq_u32 vcc, 1, v17
    s_nop 1
    v_cndmask_b32 v125, 0, v18, vcc
    v_cmp_eq_u32 vcc, 2, v17
    s_nop 1
    v_cndmask_b32 v126, 0, v18, vcc
    v_cmp_eq_u32 vcc, 3, v17
    s_nop 1
    v_cndmask_b32 v127, 0, v18, vcc
    v_cmp_eq_u32 vcc, 4, v17
    s_nop 1
    v_cndmask_b32 v128, 0, v18, vcc
    v_cmp_eq_u32 vcc, 5, v17
    s_nop 1
    v_cndmask_b32 v129, 0, v18, vcc
    v_cmp_eq_u32 vcc, 6, v17
    s_nop 1
    v_cndmask_b32 v130, 0, v18, vcc
    v_cmp_eq_u32 vcc, 7, v17
    s_nop 1
    v_cndmask_b32 v131, 0, v18, vcc
    v_bfe_u32 v254, v1, 0, 1
    v_mul_u32_u24 v9, 144, v254
    v_bfe_u32 v254, v1, 1, 1
    v_mul_u32_u24 v254, 576, v254
    v_add_u32 v9, v9, v254
    v_bfe_u32 v254, v1, 2, 1
    v_mul_u32_u24 v254, 288, v254
    v_add_u32 v9, v9, v254
    v_bfe_u32 v254, v1, 3, 1
    v_mul_u32_u24 v254, 1152, v254
    v_add_u32 v9, v9, v254
    v_bfe_u32 v254, v1, 4, 2
    v_mul_u32_u24 v254, 32, v254
    v_add_u32 v9, v9, v254
    v_bfe_u32 v254, v1, 0, 1
    v_mul_u32_u24 v11, 144, v254
    v_bfe_u32 v254, v1, 2, 2
    v_mul_u32_u24 v254, 288, v254
    v_add_u32 v11, v11, v254
    v_bfe_u32 v254, v1, 1, 1
    v_mul_u32_u24 v254, 1152, v254
    v_add_u32 v11, v11, v254
    v_bfe_u32 v254, v1, 4, 2
    v_mul_u32_u24 v254, 32, v254
    v_add_u32 v11, v11, v254
    v_add_u32 v11, 4736, v11
    s_lshl_b32 s4, s56, 10
    s_lshl_b32 s5, s53, 2
    v_bfe_u32 v254, v1, 0, 6
    v_mul_u32_u24 v10, 16, v254
    v_add_u32 v10, 262144, v10
    v_add_u32 v10, s4, v10
    v_add_u32 v10, s5, v10
    v_bfe_u32 v254, v1, 1, 1
    v_mul_u32_u24 v12, 144, v254
    v_bfe_u32 v254, v1, 5, 1
    v_mul_u32_u24 v254, 288, v254
    v_add_u32 v12, v12, v254
    v_bfe_u32 v254, v1, 3, 1
    v_mul_u32_u24 v254, 576, v254
    v_add_u32 v12, v12, v254
    v_bfe_u32 v254, v1, 4, 1
    v_mul_u32_u24 v254, 32, v254
    v_add_u32 v12, v12, v254
    v_bfe_u32 v254, v1, 2, 1
    v_mul_u32_u24 v254, 64, v254
    v_add_u32 v12, v12, v254
    v_bfe_u32 v254, v1, 0, 1
    v_mul_u32_u24 v254, 16, v254
    v_add_u32 v12, v12, v254
    v_add_u32 v12, 9472, v12
    v_bfe_u32 v254, v1, 0, 6
    v_mul_u32_u24 v13, 16, v254
    v_add_u32 v13, s101, v13
    v_bfe_u32 v254, v1, 0, 2
    v_mul_u32_u24 v14, 8, v254
    v_bfe_u32 v254, v1, 4, 1
    v_mul_u32_u24 v254, 32, v254
    v_add_u32 v14, v14, v254
    v_bfe_u32 v254, v1, 3, 1
    v_mul_u32_u24 v254, 64, v254
    v_add_u32 v14, v14, v254
    v_bfe_u32 v254, v1, 5, 1
    v_mul_u32_u24 v254, 128, v254
    v_add_u32 v14, v14, v254
    v_bfe_u32 v254, v1, 2, 1
    v_mul_u32_u24 v254, 256, v254
    v_add_u32 v14, v14, v254
    v_add_u32 v14, s55, v14
    v_xor_b32 v14, 2048, v14
    v_min_u32 v249, 0xfffffffe, v249
    buffer_store_dwordx2 v[248:249], v14, s[8:11], s30 offen sc1
    v_bfe_u32 v254, v1, 0, 6
    v_mul_u32_u24 v15, 16, v254
    s_add_u32 s42, s42, 262144
    s_add_u32 s43, s43, 262144
    s_add_u32 s44, s44, 262144
    s_waitcnt vmcnt(0)
    ds_read_b64_tr_b16 a[192:193], v242 offset:16384
    ds_read_b64_tr_b16 a[194:195], v242 offset:16896
    ds_read_b64_tr_b16 a[196:197], v242 offset:18432
    ds_read_b64_tr_b16 a[198:199], v242 offset:18944
    ds_read_b64_tr_b16 a[200:201], v242 offset:20480
    ds_read_b64_tr_b16 a[202:203], v242 offset:20992
    ds_read_b64_tr_b16 a[204:205], v242 offset:22528
    ds_read_b64_tr_b16 a[206:207], v242 offset:23040
    ds_read_b64_tr_b16 a[208:209], v242 offset:24576
    ds_read_b64_tr_b16 a[210:211], v242 offset:25088
    ds_read_b64_tr_b16 a[212:213], v242 offset:26624
    ds_read_b64_tr_b16 a[214:215], v242 offset:27136
    ds_read_b64_tr_b16 a[216:217], v242 offset:28672
    ds_read_b64_tr_b16 a[218:219], v242 offset:29184
    ds_read_b64_tr_b16 a[220:221], v242 offset:30720
    ds_read_b64_tr_b16 a[222:223], v242 offset:31232
    ds_read_b64_tr_b16 a[224:225], v243 offset:16384
    ds_read_b64_tr_b16 a[226:227], v243 offset:16896
    ds_read_b64_tr_b16 a[228:229], v243 offset:18432
    ds_read_b64_tr_b16 a[230:231], v243 offset:18944
    ds_read_b64_tr_b16 a[232:233], v243 offset:20480
    ds_read_b64_tr_b16 a[234:235], v243 offset:20992
    ds_read_b64_tr_b16 a[236:237], v243 offset:22528
    ds_read_b64_tr_b16 a[238:239], v243 offset:23040
    ds_read_b64_tr_b16 a[240:241], v243 offset:24576
    ds_read_b64_tr_b16 a[242:243], v243 offset:25088
    ds_read_b64_tr_b16 a[244:245], v243 offset:26624
    ds_read_b64_tr_b16 a[246:247], v243 offset:27136
    ds_read_b64_tr_b16 a[248:249], v243 offset:28672
    ds_read_b64_tr_b16 a[250:251], v243 offset:29184
    ds_read_b64_tr_b16 a[252:253], v243 offset:30720
    ds_read_b64_tr_b16 a[254:255], v243 offset:31232
    s_waitcnt lgkmcnt(0)
    s_barrier
.p2align 6
.step_214:
    s_barrier
    s_setprio 3
    buffer_load_dwordx4 v[24:27], v3, s[8:11], s30 offen offset:0 sc1
    s_setprio 2
    buffer_load_dwordx4 v[28:31], v3, s[8:11], s30 offen offset:1024 sc1
    s_setprio 1
    buffer_load_dwordx4 v[32:35], v3, s[8:11], s30 offen offset:2048 sc1
    s_setprio 0
    buffer_load_dwordx4 v[36:39], v3, s[8:11], s30 offen offset:3072 sc1
    s_call_b64 s[98:99], .gm_206
    v_pk_add_f32 v[40:41], v[40:41], v[42:43]
    v_pk_add_f32 v[42:43], v[44:45], v[46:47]
    ds_write2_b32 v5, v40, v41 offset0:0 offset1:36
    ds_write2_b32 v5, v42, v43 offset0:16 offset1:52
    s_nop 1
    v_pk_add_f32 v[48:49], v[48:49], v[50:51]
    v_pk_add_f32 v[50:51], v[52:53], v[54:55]
    ds_write2_b32 v6, v48, v49 offset0:0 offset1:36
    ds_write2_b32 v6, v50, v51 offset0:16 offset1:52
    s_waitcnt lgkmcnt(2)
    s_barrier
    ds_read_b128 v[72:75], v9 offset:0
    ds_read_b128 v[76:79], v9 offset:2304
    ds_read_b128 v[80:83], v9 offset:16
    ds_read_b128 v[84:87], v9 offset:2320
    v_smfmac_f32_16x16x64_bf16 v[56:59], v[24:27], a[128:135], v2
    v_smfmac_f32_16x16x64_bf16 v[60:63], v[24:27], a[160:167], v2
    s_waitcnt lgkmcnt(4)
    s_barrier
    ds_read_b128 v[88:91], v11 offset:0
    ds_read_b128 v[92:95], v11 offset:2304
    ds_read_b128 v[96:99], v11 offset:16
    ds_read_b128 v[100:103], v11 offset:2320
    v_smfmac_f32_16x16x64_bf16 v[56:59], v[28:31], a[136:143], v2
    s_waitcnt lgkmcnt(6)
    v_pk_add_f32 v[72:73], v[72:73], v[76:77]
    v_pk_add_f32 v[74:75], v[74:75], v[78:79]
    v_cvt_pk_bf16_f32 v144, v72, v73
    v_cvt_pk_bf16_f32 v145, v74, v75
    s_waitcnt lgkmcnt(4)
    v_pk_add_f32 v[80:81], v[80:81], v[84:85]
    v_pk_add_f32 v[82:83], v[82:83], v[86:87]
    v_cvt_pk_bf16_f32 v146, v80, v81
    v_cvt_pk_bf16_f32 v147, v82, v83
    s_waitcnt lgkmcnt(2)
    v_pk_add_f32 v[88:89], v[88:89], v[92:93]
    v_pk_add_f32 v[90:91], v[90:91], v[94:95]
    v_cvt_pk_bf16_f32 v148, v88, v89
    v_cvt_pk_bf16_f32 v149, v90, v91
    s_waitcnt lgkmcnt(0)
    v_pk_add_f32 v[96:97], v[96:97], v[100:101]
    v_pk_add_f32 v[98:99], v[98:99], v[102:103]
    v_cvt_pk_bf16_f32 v150, v96, v97
    v_cvt_pk_bf16_f32 v151, v98, v99
    s_nop 1
    v_mfma_f32_16x16x32_bf16 v[196:199], v[148:151], v[144:147], 0
    v_smfmac_f32_16x16x64_bf16 v[60:63], v[28:31], a[168:175], v2
    v_smfmac_f32_16x16x64_bf16 v[56:59], v[32:35], a[144:151], v2
    v_pk_add_f32 v[196:197], v[196:197], v[198:199]
    s_nop 1
    v_add_f32_dpp v198, v196, v196 row_ror:8 row_mask:0xf bank_mask:0xf
    v_add_f32_dpp v199, v197, v197 row_ror:8 row_mask:0xf bank_mask:0xf
    v_cndmask_b32 v198, v199, v198, s[48:49]
    v_min_u32 v198, 0xfffffffe, v198
    buffer_store_dword v198, v10, s[8:11], s30 offen sc1
    v_smfmac_f32_16x16x64_bf16 v[60:63], v[32:35], a[176:183], v2
    v_smfmac_f32_16x16x64_bf16 v[56:59], v[36:39], a[152:159], v2
    v_smfmac_f32_16x16x64_bf16 v[60:63], v[36:39], a[184:191], v2
    v_mov_b32 v40, 0
    v_mov_b32 v41, 0
    v_mov_b32 v42, 0
    v_mov_b32 v43, 0
    v_mov_b32 v44, 0
    v_mov_b32 v45, 0
    v_mov_b32 v46, 0
    v_mov_b32 v47, 0
    v_pk_add_f32 v[56:57], v[56:57], v[58:59]
    v_pk_add_f32 v[58:59], v[60:61], v[62:63]
    v_cvt_pk_bf16_f32 v60, v56, v57
    v_cvt_pk_bf16_f32 v61, v58, v59
    ds_write2_b32 v255, v60, v61 offset0:0 offset1:32
    ds_write_b128 v8, v[56:59]
    s_waitcnt lgkmcnt(0)
    s_barrier
    s_cmp_eq_u32 s28, 63
    s_cbranch_scc1 .fin_215
    s_add_u32 s37, s28, 0
    s_bitcmp1_b32 s37, 0
    s_cselect_b32 s4, 0x84000, 0
    s_xor_b32 s34, s35, s4
    s_bitcmp1_b32 s37, 1
    s_cselect_b32 s4, 0x101000, 0
    s_xor_b32 s34, s34, s4
    s_lshr_b32 s37, s37, 2
    s_bitcmp1_b32 s63, s37
    s_cselect_b32 s4, 0x2000, 0
    s_xor_b32 s34, s34, s4
    s_lshl_b32 s37, s37, 21
    s_add_u32 s34, s34, s37
    s_xor_b32 s38, s34, 0x4000
    s_xor_b32 s39, s34, 0x1000
    s_xor_b32 s40, s34, 0x5000
    v_mov_b32 v48, 0
    v_mov_b32 v49, 0
    v_mov_b32 v50, 0
    v_mov_b32 v51, 0
    v_mov_b32 v52, 0
    v_mov_b32 v53, 0
    v_mov_b32 v54, 0
    v_mov_b32 v55, 0
    v_mov_b32 v56, 0
    v_mov_b32 v57, 0
    v_mov_b32 v58, 0
    v_mov_b32 v59, 0
    v_mov_b32 v60, 0
    v_mov_b32 v61, 0
    v_mov_b32 v62, 0
    v_mov_b32 v63, 0
    s_barrier
    s_setprio 3
    buffer_load_dwordx4 v[24:27], v4, s[8:11], s30 offen offset:0 sc1
    s_setprio 2
    buffer_load_dwordx4 v[28:31], v4, s[8:11], s30 offen offset:1024 sc1
    s_setprio 1
    buffer_load_dwordx4 v[32:35], v4, s[8:11], s30 offen offset:2048 sc1
    s_setprio 0
    buffer_load_dwordx4 v[36:39], v4, s[8:11], s30 offen offset:3072 sc1
    s_call_b64 s[98:99], .gm_207
    s_nop 4
    v_pk_add_f32 v[64:65], v[64:65], v[66:67]
    v_cvt_pk_bf16_f32 v66, v64, v65
    v_pk_add_f32 v[68:69], v[68:69], v[70:71]
    v_cvt_pk_bf16_f32 v67, v68, v69
    v_min_u32 v67, 0xfffffffe, v67
    buffer_store_dwordx2 v[66:67], v168, s[8:11], s34 offen sc1
    ds_write2_b32 v7, v64, v65 offset0:0 offset1:36
    ds_write2_b32 v7, v68, v69 offset0:16 offset1:52
    s_waitcnt lgkmcnt(0)
    s_barrier
    ds_read_b128 v[72:75], v12 offset:0
    ds_read_b128 v[76:79], v12 offset:1152
    ds_read_b128 v[80:83], v12 offset:2304
    ds_read_b128 v[84:87], v12 offset:3456
    s_waitcnt lgkmcnt(2)
    v_pk_add_f32 v[72:73], v[72:73], v[76:77]
    v_pk_add_f32 v[74:75], v[74:75], v[78:79]
    s_waitcnt lgkmcnt(0)
    v_pk_add_f32 v[80:81], v[80:81], v[84:85]
    v_pk_add_f32 v[82:83], v[82:83], v[86:87]
    v_pk_add_f32 v[72:73], v[72:73], v[80:81]
    v_pk_add_f32 v[74:75], v[74:75], v[82:83]
    v_mov_b32 v64, 0
    v_mov_b32 v65, 0
    v_mov_b32 v66, 0
    v_mov_b32 v67, 0
    v_mov_b32 v68, 0
    v_mov_b32 v69, 0
    v_mov_b32 v70, 0
    v_mov_b32 v71, 0
.pl_216:
    buffer_load_dwordx4 v[76:79], v13, s[8:11], s38 offen offset:0 sc1
    buffer_load_dwordx4 v[80:83], v13, s[8:11], s38 offen offset:1024 sc1
    buffer_load_dwordx4 v[84:87], v13, s[8:11], s39 offen offset:0 sc1
    buffer_load_dwordx4 v[88:91], v13, s[8:11], s39 offen offset:1024 sc1
    buffer_load_dwordx4 v[92:95], v13, s[8:11], s40 offen offset:0 sc1
    buffer_load_dwordx4 v[96:99], v13, s[8:11], s40 offen offset:1024 sc1
.pk_219:
    s_waitcnt vmcnt(5)
    v_mfma_f32_16x16x32_bf16 v[108:111], v[76:79], v[124:127], v[72:75]
    v_max_u32 v18, v77, v79
    s_waitcnt vmcnt(4)
    v_mfma_f32_16x16x32_bf16 v[108:111], v[80:83], v[128:131], v[108:111]
    v_max3_u32 v18, v18, v81, v83
    v_cmp_eq_u32 vcc, -1, v18
    s_cbranch_vccnz .pf_220
.pk_221:
    s_waitcnt vmcnt(3)
    v_mfma_f32_16x16x32_bf16 v[112:115], v[84:87], v[124:127], v[108:111]
    v_max_u32 v18, v85, v87
    s_waitcnt vmcnt(2)
    v_mfma_f32_16x16x32_bf16 v[112:115], v[88:91], v[128:131], v[112:115]
    v_max3_u32 v18, v18, v89, v91
    v_cmp_eq_u32 vcc, -1, v18
    s_cbranch_vccnz .pf_222
.pk_223:
    s_waitcnt vmcnt(1)
    v_mfma_f32_16x16x32_bf16 v[100:103], v[92:95], v[124:127], v[112:115]
    v_max_u32 v18, v93, v95
    s_waitcnt vmcnt(0)
    v_mfma_f32_16x16x32_bf16 v[100:103], v[96:99], v[128:131], v[100:103]
    v_max3_u32 v18, v18, v97, v99
    v_cmp_eq_u32 vcc, -1, v18
    s_cbranch_vccnz .pf_224
.pd_218:
    s_nop 4
    v_cvt_pk_bf16_f32 v105, v102, v103
    v_cvt_pk_bf16_f32 v104, v100, v101
    v_min_u32 v105, 0xfffffffe, v105
    buffer_store_dwordx2 v[104:105], v14, s[8:11], s31 offen sc1
    s_mov_b32 s4, s30
    s_mov_b32 s30, s31
    s_mov_b32 s31, s32
    s_mov_b32 s32, s33
    s_mov_b32 s33, s4
    s_add_u32 s28, s28, 1
    s_mov_b32 s62, 0
    s_branch .step_214
.fin_215:
    s_barrier
    s_waitcnt vmcnt(0)
    s_endpgm
.pf_220:
    buffer_load_dwordx4 v[76:79], v13, s[8:11], s38 offen offset:0 sc1
    buffer_load_dwordx4 v[80:83], v13, s[8:11], s38 offen offset:1024 sc1
    s_add_u32 s62, s62, 1
    s_cmp_gt_u32 s62, 0x100000
    s_cbranch_scc1 .mg_end_1
.pk_225:
    s_waitcnt vmcnt(5)
    v_mfma_f32_16x16x32_bf16 v[108:111], v[84:87], v[124:127], v[72:75]
    v_max_u32 v18, v85, v87
    s_waitcnt vmcnt(4)
    v_mfma_f32_16x16x32_bf16 v[108:111], v[88:91], v[128:131], v[108:111]
    v_max3_u32 v18, v18, v89, v91
    v_cmp_eq_u32 vcc, -1, v18
    s_cbranch_vccnz .pf_226
.pk_227:
    s_waitcnt vmcnt(3)
    v_mfma_f32_16x16x32_bf16 v[112:115], v[92:95], v[124:127], v[108:111]
    v_max_u32 v18, v93, v95
    s_waitcnt vmcnt(2)
    v_mfma_f32_16x16x32_bf16 v[112:115], v[96:99], v[128:131], v[112:115]
    v_max3_u32 v18, v18, v97, v99
    v_cmp_eq_u32 vcc, -1, v18
    s_cbranch_vccnz .pf_228
.pk_229:
    s_waitcnt vmcnt(1)
    v_mfma_f32_16x16x32_bf16 v[100:103], v[76:79], v[124:127], v[112:115]
    v_max_u32 v18, v77, v79
    s_waitcnt vmcnt(0)
    v_mfma_f32_16x16x32_bf16 v[100:103], v[80:83], v[128:131], v[100:103]
    v_max3_u32 v18, v18, v81, v83
    v_cmp_eq_u32 vcc, -1, v18
    s_cbranch_vccnz .pf_230
    s_branch .pd_218
.pf_222:
    buffer_load_dwordx4 v[84:87], v13, s[8:11], s39 offen offset:0 sc1
    buffer_load_dwordx4 v[88:91], v13, s[8:11], s39 offen offset:1024 sc1
    s_add_u32 s62, s62, 1
    s_cmp_gt_u32 s62, 0x100000
    s_cbranch_scc1 .mg_end_1
.pk_231:
    s_waitcnt vmcnt(3)
    v_mfma_f32_16x16x32_bf16 v[112:115], v[92:95], v[124:127], v[108:111]
    v_max_u32 v18, v93, v95
    s_waitcnt vmcnt(2)
    v_mfma_f32_16x16x32_bf16 v[112:115], v[96:99], v[128:131], v[112:115]
    v_max3_u32 v18, v18, v97, v99
    v_cmp_eq_u32 vcc, -1, v18
    s_cbranch_vccnz .pf_232
.pk_233:
    s_waitcnt vmcnt(1)
    v_mfma_f32_16x16x32_bf16 v[100:103], v[84:87], v[124:127], v[112:115]
    v_max_u32 v18, v85, v87
    s_waitcnt vmcnt(0)
    v_mfma_f32_16x16x32_bf16 v[100:103], v[88:91], v[128:131], v[100:103]
    v_max3_u32 v18, v18, v89, v91
    v_cmp_eq_u32 vcc, -1, v18
    s_cbranch_vccnz .pf_234
    s_branch .pd_218
.pf_224:
    buffer_load_dwordx4 v[92:95], v13, s[8:11], s40 offen offset:0 sc1
    buffer_load_dwordx4 v[96:99], v13, s[8:11], s40 offen offset:1024 sc1
    s_add_u32 s62, s62, 1
    s_cmp_gt_u32 s62, 0x100000
    s_cbranch_scc1 .mg_end_1
    s_branch .pk_223
.pf_226:
    buffer_load_dwordx4 v[84:87], v13, s[8:11], s39 offen offset:0 sc1
    buffer_load_dwordx4 v[88:91], v13, s[8:11], s39 offen offset:1024 sc1
    s_add_u32 s62, s62, 1
    s_cmp_gt_u32 s62, 0x100000
    s_cbranch_scc1 .mg_end_1
.pk_235:
    s_waitcnt vmcnt(5)
    v_mfma_f32_16x16x32_bf16 v[108:111], v[92:95], v[124:127], v[72:75]
    v_max_u32 v18, v93, v95
    s_waitcnt vmcnt(4)
    v_mfma_f32_16x16x32_bf16 v[108:111], v[96:99], v[128:131], v[108:111]
    v_max3_u32 v18, v18, v97, v99
    v_cmp_eq_u32 vcc, -1, v18
    s_cbranch_vccnz .pf_236
.pk_237:
    s_waitcnt vmcnt(3)
    v_mfma_f32_16x16x32_bf16 v[112:115], v[76:79], v[124:127], v[108:111]
    v_max_u32 v18, v77, v79
    s_waitcnt vmcnt(2)
    v_mfma_f32_16x16x32_bf16 v[112:115], v[80:83], v[128:131], v[112:115]
    v_max3_u32 v18, v18, v81, v83
    v_cmp_eq_u32 vcc, -1, v18
    s_cbranch_vccnz .pf_238
    s_branch .pk_233
.pf_228:
    buffer_load_dwordx4 v[92:95], v13, s[8:11], s40 offen offset:0 sc1
    buffer_load_dwordx4 v[96:99], v13, s[8:11], s40 offen offset:1024 sc1
    s_add_u32 s62, s62, 1
    s_cmp_gt_u32 s62, 0x100000
    s_cbranch_scc1 .mg_end_1
.pk_239:
    s_waitcnt vmcnt(3)
    v_mfma_f32_16x16x32_bf16 v[112:115], v[76:79], v[124:127], v[108:111]
    v_max_u32 v18, v77, v79
    s_waitcnt vmcnt(2)
    v_mfma_f32_16x16x32_bf16 v[112:115], v[80:83], v[128:131], v[112:115]
    v_max3_u32 v18, v18, v81, v83
    v_cmp_eq_u32 vcc, -1, v18
    s_cbranch_vccnz .pf_240
    s_branch .pk_223
.pf_230:
    buffer_load_dwordx4 v[76:79], v13, s[8:11], s38 offen offset:0 sc1
    buffer_load_dwordx4 v[80:83], v13, s[8:11], s38 offen offset:1024 sc1
    s_add_u32 s62, s62, 1
    s_cmp_gt_u32 s62, 0x100000
    s_cbranch_scc1 .mg_end_1
    s_branch .pk_229
.pf_232:
    buffer_load_dwordx4 v[92:95], v13, s[8:11], s40 offen offset:0 sc1
    buffer_load_dwordx4 v[96:99], v13, s[8:11], s40 offen offset:1024 sc1
    s_add_u32 s62, s62, 1
    s_cmp_gt_u32 s62, 0x100000
    s_cbranch_scc1 .mg_end_1
    s_branch .pk_221
.pf_234:
    buffer_load_dwordx4 v[84:87], v13, s[8:11], s39 offen offset:0 sc1
    buffer_load_dwordx4 v[88:91], v13, s[8:11], s39 offen offset:1024 sc1
    s_add_u32 s62, s62, 1
    s_cmp_gt_u32 s62, 0x100000
    s_cbranch_scc1 .mg_end_1
    s_branch .pk_233
.pf_236:
    buffer_load_dwordx4 v[92:95], v13, s[8:11], s40 offen offset:0 sc1
    buffer_load_dwordx4 v[96:99], v13, s[8:11], s40 offen offset:1024 sc1
    s_add_u32 s62, s62, 1
    s_cmp_gt_u32 s62, 0x100000
    s_cbranch_scc1 .mg_end_1
    s_branch .pk_219
.pf_238:
    buffer_load_dwordx4 v[76:79], v13, s[8:11], s38 offen offset:0 sc1
    buffer_load_dwordx4 v[80:83], v13, s[8:11], s38 offen offset:1024 sc1
    s_add_u32 s62, s62, 1
    s_cmp_gt_u32 s62, 0x100000
    s_cbranch_scc1 .mg_end_1
.pk_241:
    s_waitcnt vmcnt(3)
    v_mfma_f32_16x16x32_bf16 v[112:115], v[84:87], v[124:127], v[108:111]
    v_max_u32 v18, v85, v87
    s_waitcnt vmcnt(2)
    v_mfma_f32_16x16x32_bf16 v[112:115], v[88:91], v[128:131], v[112:115]
    v_max3_u32 v18, v18, v89, v91
    v_cmp_eq_u32 vcc, -1, v18
    s_cbranch_vccnz .pf_242
    s_branch .pk_229
.pf_240:
    buffer_load_dwordx4 v[76:79], v13, s[8:11], s38 offen offset:0 sc1
    buffer_load_dwordx4 v[80:83], v13, s[8:11], s38 offen offset:1024 sc1
    s_add_u32 s62, s62, 1
    s_cmp_gt_u32 s62, 0x100000
    s_cbranch_scc1 .mg_end_1
    s_branch .pk_227
.pf_242:
    buffer_load_dwordx4 v[84:87], v13, s[8:11], s39 offen offset:0 sc1
    buffer_load_dwordx4 v[88:91], v13, s[8:11], s39 offen offset:1024 sc1
    s_add_u32 s62, s62, 1
    s_cmp_gt_u32 s62, 0x100000
    s_cbranch_scc1 .mg_end_1
    s_branch .pk_237
.pr_217:
    s_add_u32 s62, s62, 1
    s_cmp_gt_u32 s62, 0x100000
    s_cbranch_scc1 .mg_end_1
    s_branch .pl_216
.w2_204:
    v_bfe_u32 v254, v1, 4, 1
    v_mul_u32_u24 v168, 1024, v254
    v_bfe_u32 v254, v1, 5, 1
    v_mul_u32_u24 v254, 128, v254
    v_add_u32 v168, v168, v254
    v_bfe_u32 v254, v1, 3, 1
    v_mul_u32_u24 v254, 64, v254
    v_add_u32 v168, v168, v254
    v_bfe_u32 v254, v1, 0, 2
    v_mul_u32_u24 v254, 16, v254
    v_add_u32 v168, v168, v254
    v_bfe_u32 v254, v1, 2, 1
    v_mul_u32_u24 v254, 8, v254
    v_add_u32 v168, v168, v254
    v_add_u32 v168, 512, v168
    v_add_u32 v168, s101, v168
    s_lshl_b32 s4, s56, 9
    s_lshl_b32 s5, s53, 7
    s_add_u32 s4, s4, s5
    s_add_u32 s4, s4, 92274688
    v_mov_b32 v14, s4
    v_bfe_u32 v254, v1, 0, 6
    v_mul_u32_u24 v12, 16, v254
    v_add_u32 v12, 18176, v12
    v_bfe_u32 v254, v1, 0, 6
    v_mul_u32_u24 v15, 16, v254
    s_add_u32 s42, s42, 262144
    s_add_u32 s43, s43, 262144
    s_add_u32 s44, s44, 262144
    s_mov_b32 exec_hi, 0
    v_xor_b32 v244, 1024, v244
    s_mov_b32 exec_hi, -1
    s_waitcnt vmcnt(0)
    ds_read_b64_tr_b16 a[192:193], v242 offset:16384
    ds_read_b64_tr_b16 a[194:195], v242 offset:16896
    ds_read_b64_tr_b16 a[196:197], v242 offset:18432
    ds_read_b64_tr_b16 a[198:199], v242 offset:18944
    ds_read_b64_tr_b16 a[200:201], v242 offset:20480
    ds_read_b64_tr_b16 a[202:203], v242 offset:20992
    ds_read_b64_tr_b16 a[204:205], v242 offset:22528
    ds_read_b64_tr_b16 a[206:207], v242 offset:23040
    ds_read_b64_tr_b16 a[208:209], v242 offset:24576
    ds_read_b64_tr_b16 a[210:211], v242 offset:25088
    ds_read_b64_tr_b16 a[212:213], v242 offset:26624
    ds_read_b64_tr_b16 a[214:215], v242 offset:27136
    ds_read_b64_tr_b16 a[216:217], v242 offset:28672
    ds_read_b64_tr_b16 a[218:219], v242 offset:29184
    ds_read_b64_tr_b16 a[220:221], v242 offset:30720
    ds_read_b64_tr_b16 a[222:223], v242 offset:31232
    ds_read_b64_tr_b16 a[224:225], v243 offset:16384
    ds_read_b64_tr_b16 a[226:227], v243 offset:16896
    ds_read_b64_tr_b16 a[228:229], v243 offset:18432
    ds_read_b64_tr_b16 a[230:231], v243 offset:18944
    ds_read_b64_tr_b16 a[232:233], v243 offset:20480
    ds_read_b64_tr_b16 a[234:235], v243 offset:20992
    ds_read_b64_tr_b16 a[236:237], v243 offset:22528
    ds_read_b64_tr_b16 a[238:239], v243 offset:23040
    ds_read_b64_tr_b16 a[240:241], v243 offset:24576
    ds_read_b64_tr_b16 a[242:243], v243 offset:25088
    ds_read_b64_tr_b16 a[244:245], v243 offset:26624
    ds_read_b64_tr_b16 a[246:247], v243 offset:27136
    ds_read_b64_tr_b16 a[248:249], v243 offset:28672
    ds_read_b64_tr_b16 a[250:251], v243 offset:29184
    ds_read_b64_tr_b16 a[252:253], v243 offset:30720
    ds_read_b64_tr_b16 a[254:255], v243 offset:31232
    s_waitcnt lgkmcnt(0)
    s_barrier
.p2align 6
.step_243:
    s_barrier
    s_setprio 3
    buffer_load_dwordx4 v[24:27], v3, s[8:11], s30 offen offset:0 sc1
    s_setprio 2
    buffer_load_dwordx4 v[28:31], v3, s[8:11], s30 offen offset:1024 sc1
    s_setprio 1
    buffer_load_dwordx4 v[32:35], v3, s[8:11], s30 offen offset:2048 sc1
    s_setprio 0
    buffer_load_dwordx4 v[36:39], v3, s[8:11], s30 offen offset:3072 sc1
    s_call_b64 s[98:99], .gm_206
    v_pk_add_f32 v[40:41], v[40:41], v[42:43]
    v_pk_add_f32 v[42:43], v[44:45], v[46:47]
    ds_write2_b32 v5, v40, v41 offset0:0 offset1:36
    ds_write2_b32 v5, v42, v43 offset0:16 offset1:52
    s_nop 1
    v_pk_add_f32 v[48:49], v[48:49], v[50:51]
    v_pk_add_f32 v[50:51], v[52:53], v[54:55]
    ds_write2_b32 v6, v48, v49 offset0:0 offset1:36
    ds_write2_b32 v6, v50, v51 offset0:16 offset1:52
    s_waitcnt lgkmcnt(2)
    s_barrier
    s_waitcnt lgkmcnt(0)
    s_barrier
    v_smfmac_f32_16x16x64_bf16 v[56:59], v[24:27], a[128:135], v2
    v_smfmac_f32_16x16x64_bf16 v[60:63], v[24:27], a[160:167], v2
    v_smfmac_f32_16x16x64_bf16 v[56:59], v[28:31], a[136:143], v2
    v_smfmac_f32_16x16x64_bf16 v[60:63], v[28:31], a[168:175], v2
    v_smfmac_f32_16x16x64_bf16 v[56:59], v[32:35], a[144:151], v2
    v_smfmac_f32_16x16x64_bf16 v[60:63], v[32:35], a[176:183], v2
    v_smfmac_f32_16x16x64_bf16 v[56:59], v[36:39], a[152:159], v2
    v_smfmac_f32_16x16x64_bf16 v[60:63], v[36:39], a[184:191], v2
    ds_read_b64 v[72:73], v9 offset:0
    ds_read_b64 v[74:75], v9 offset:1152
    ds_read_b64 v[76:77], v9 offset:2304
    ds_read_b64 v[78:79], v9 offset:3456
    s_waitcnt lgkmcnt(0)
    v_pk_add_f32 v[72:73], v[72:73], v[74:75]
    v_pk_add_f32 v[76:77], v[76:77], v[78:79]
    v_pk_add_f32 v[72:73], v[72:73], v[76:77]
    v_cvt_pk_bf16_f32 v72, v72, v73
    ds_write_b32 v11, v72
    v_mov_b32 v40, 0
    v_mov_b32 v41, 0
    v_mov_b32 v42, 0
    v_mov_b32 v43, 0
    v_mov_b32 v44, 0
    v_mov_b32 v45, 0
    v_mov_b32 v46, 0
    v_mov_b32 v47, 0
    v_pk_add_f32 v[56:57], v[56:57], v[58:59]
    v_pk_add_f32 v[58:59], v[60:61], v[62:63]
    v_cvt_pk_bf16_f32 v60, v56, v57
    v_cvt_pk_bf16_f32 v61, v58, v59
    ds_write2_b32 v255, v60, v61 offset0:0 offset1:32
    ds_write_b128 v8, v[56:59]
    s_waitcnt lgkmcnt(0)
    s_barrier
    s_cmp_eq_u32 s28, 63
    s_cbranch_scc1 .fin_244
    s_add_u32 s37, s28, 0
    s_bitcmp1_b32 s37, 0
    s_cselect_b32 s4, 0x84000, 0
    s_xor_b32 s34, s35, s4
    s_bitcmp1_b32 s37, 1
    s_cselect_b32 s4, 0x101000, 0
    s_xor_b32 s34, s34, s4
    s_lshr_b32 s37, s37, 2
    s_bitcmp1_b32 s63, s37
    s_cselect_b32 s4, 0x2000, 0
    s_xor_b32 s34, s34, s4
    s_lshl_b32 s37, s37, 21
    s_add_u32 s34, s34, s37
    s_waitcnt lgkmcnt(0)
    v_mov_b32 v48, 0
    v_mov_b32 v49, 0
    v_mov_b32 v50, 0
    v_mov_b32 v51, 0
    v_mov_b32 v52, 0
    v_mov_b32 v53, 0
    v_mov_b32 v54, 0
    v_mov_b32 v55, 0
    v_mov_b32 v56, 0
    v_mov_b32 v57, 0
    v_mov_b32 v58, 0
    v_mov_b32 v59, 0
    v_mov_b32 v60, 0
    v_mov_b32 v61, 0
    v_mov_b32 v62, 0
    v_mov_b32 v63, 0
    s_barrier
    ds_read_b128 v[72:75], v12
    s_setprio 3
    buffer_load_dwordx4 v[24:27], v4, s[8:11], s30 offen offset:0 sc1
    s_setprio 2
    buffer_load_dwordx4 v[28:31], v4, s[8:11], s30 offen offset:1024 sc1
    s_setprio 1
    buffer_load_dwordx4 v[32:35], v4, s[8:11], s30 offen offset:2048 sc1
    s_setprio 0
    buffer_load_dwordx4 v[36:39], v4, s[8:11], s30 offen offset:3072 sc1
    s_call_b64 s[98:99], .gm_207
    s_waitcnt lgkmcnt(0)
    buffer_store_dwordx4 v[72:75], v244, s[8:11], s41 offen sc1
    s_nop 3
    v_pk_add_f32 v[64:65], v[64:65], v[66:67]
    v_cvt_pk_bf16_f32 v66, v64, v65
    v_pk_add_f32 v[68:69], v[68:69], v[70:71]
    v_cvt_pk_bf16_f32 v67, v68, v69
    v_min_u32 v67, 0xfffffffe, v67
    buffer_store_dwordx2 v[66:67], v168, s[8:11], s34 offen sc1
    ds_write2_b32 v7, v64, v65 offset0:0 offset1:36
    ds_write2_b32 v7, v68, v69 offset0:16 offset1:52
    s_waitcnt lgkmcnt(0)
    s_barrier
    s_cmp_lt_u32 s28, 52
    s_cselect_b32 s4, 1, 0
    s_andn2_b32 s4, s4, s28
    s_cbranch_scc1 .nl_245
    v_mov_b32 v18, s28
    v_add_u32 v18, 1, v18
    s_mov_b64 exec, 1
    s_waitcnt vmcnt(0)
    buffer_store_dword v18, v14, s[8:11], 0 offen sc1
    s_mov_b64 exec, -1
.nl_245:
    v_mov_b32 v64, 0
    v_mov_b32 v65, 0
    v_mov_b32 v66, 0
    v_mov_b32 v67, 0
    v_mov_b32 v68, 0
    v_mov_b32 v69, 0
    v_mov_b32 v70, 0
    v_mov_b32 v71, 0
    s_mov_b32 s4, s30
    s_mov_b32 s30, s31
    s_mov_b32 s31, s32
    s_mov_b32 s32, s33
    s_mov_b32 s33, s4
    s_add_u32 s28, s28, 1
    s_mov_b32 s62, 0
    s_add_u32 s41, s41, 0x20000
    s_branch .step_243
.fin_244:
    s_barrier
    s_endpgm
.w3_205:
    v_bfe_u32 v254, v1, 4, 1
    v_mul_u32_u24 v168, 1024, v254
    v_bfe_u32 v254, v1, 5, 1
    v_mul_u32_u24 v254, 128, v254
    v_add_u32 v168, v168, v254
    v_bfe_u32 v254, v1, 3, 1
    v_mul_u32_u24 v254, 64, v254
    v_add_u32 v168, v168, v254
    v_bfe_u32 v254, v1, 0, 2
    v_mul_u32_u24 v254, 16, v254
    v_add_u32 v168, v168, v254
    v_bfe_u32 v254, v1, 2, 1
    v_mul_u32_u24 v254, 8, v254
    v_add_u32 v168, v168, v254
    v_add_u32 v168, 768, v168
    v_add_u32 v168, s101, v168
    v_bfe_u32 v254, v1, 3, 1
    v_mul_u32_u24 v12, 8, v254
    v_bfe_u32 v254, v1, 5, 1
    v_mul_u32_u24 v254, 256, v254
    v_add_u32 v12, v12, v254
    v_bfe_u32 v254, v1, 2, 1
    v_mul_u32_u24 v254, 128, v254
    v_add_u32 v12, v12, v254
    v_bfe_u32 v254, v1, 0, 2
    v_mul_u32_u24 v254, 16, v254
    v_add_u32 v12, v12, v254
    v_bfe_u32 v254, v1, 4, 1
    v_mul_u32_u24 v254, 512, v254
    v_add_u32 v12, v12, v254
    v_add_u32 v12, 14080, v12
    v_bfe_u32 v254, v1, 2, 2
    v_mul_u32_u24 v14, 128, v254
    v_bfe_u32 v254, v1, 0, 2
    v_mul_u32_u24 v254, 16, v254
    v_add_u32 v14, v14, v254
    v_bfe_u32 v254, v1, 4, 2
    v_mul_u32_u24 v254, 4, v254
    v_add_u32 v14, v14, v254
    v_add_u32 v14, 18688, v14
    v_bfe_u32 v254, v1, 0, 6
    v_mul_u32_u24 v15, 16, v254
    v_add_u32 v15, s101, v15
    v_bfe_u32 v254, v1, 2, 2
    v_mul_u32_u24 v16, 128, v254
    v_bfe_u32 v254, v1, 0, 2
    v_mul_u32_u24 v254, 16, v254
    v_add_u32 v16, v16, v254
    v_bfe_u32 v254, v1, 4, 2
    v_mul_u32_u24 v254, 4, v254
    v_add_u32 v16, v16, v254
    v_add_u32 v16, 135168, v16
    v_add_u32 v16, s58, v16
    s_lshl_b32 s4, s56, 9
    s_add_u32 s4, s4, 92291072
    v_bfe_u32 v254, v1, 0, 2
    v_mul_u32_u24 v13, 128, v254
    v_bfe_u32 v254, v1, 2, 1
    v_mul_u32_u24 v254, 16384, v254
    v_add_u32 v13, v13, v254
    v_add_u32 v13, s4, v13
    s_lshl_b32 s4, s56, 9
    s_lshl_b32 s5, s53, 7
    s_add_u32 s4, s4, s5
    s_add_u32 s4, s4, 92274688
    v_mov_b32 v174, s4
    v_bfe_u32 v254, v1, 0, 6
    v_mul_u32_u24 v175, 16, v254
    v_add_u32 v175, 18176, v175
    s_mov_b32 exec_hi, 0
    v_xor_b32 v244, 1024, v244
    s_mov_b32 exec_hi, -1
    s_waitcnt vmcnt(0)
    ds_read_b64_tr_b16 a[192:193], v242 offset:16384
    ds_read_b64_tr_b16 a[194:195], v242 offset:16896
    ds_read_b64_tr_b16 a[196:197], v242 offset:18432
    ds_read_b64_tr_b16 a[198:199], v242 offset:18944
    ds_read_b64_tr_b16 a[200:201], v242 offset:20480
    ds_read_b64_tr_b16 a[202:203], v242 offset:20992
    ds_read_b64_tr_b16 a[204:205], v242 offset:22528
    ds_read_b64_tr_b16 a[206:207], v242 offset:23040
    ds_read_b64_tr_b16 a[208:209], v242 offset:24576
    ds_read_b64_tr_b16 a[210:211], v242 offset:25088
    ds_read_b64_tr_b16 a[212:213], v242 offset:26624
    ds_read_b64_tr_b16 a[214:215], v242 offset:27136
    ds_read_b64_tr_b16 a[216:217], v242 offset:28672
    ds_read_b64_tr_b16 a[218:219], v242 offset:29184
    ds_read_b64_tr_b16 a[220:221], v242 offset:30720
    ds_read_b64_tr_b16 a[222:223], v242 offset:31232
    ds_read_b64_tr_b16 a[224:225], v243 offset:16384
    ds_read_b64_tr_b16 a[226:227], v243 offset:16896
    ds_read_b64_tr_b16 a[228:229], v243 offset:18432
    ds_read_b64_tr_b16 a[230:231], v243 offset:18944
    ds_read_b64_tr_b16 a[232:233], v243 offset:20480
    ds_read_b64_tr_b16 a[234:235], v243 offset:20992
    ds_read_b64_tr_b16 a[236:237], v243 offset:22528
    ds_read_b64_tr_b16 a[238:239], v243 offset:23040
    ds_read_b64_tr_b16 a[240:241], v243 offset:24576
    ds_read_b64_tr_b16 a[242:243], v243 offset:25088
    ds_read_b64_tr_b16 a[244:245], v243 offset:26624
    ds_read_b64_tr_b16 a[246:247], v243 offset:27136
    ds_read_b64_tr_b16 a[248:249], v243 offset:28672
    ds_read_b64_tr_b16 a[250:251], v243 offset:29184
    ds_read_b64_tr_b16 a[252:253], v243 offset:30720
    ds_read_b64_tr_b16 a[254:255], v243 offset:31232
    s_waitcnt lgkmcnt(0)
    s_cmp_ge_u32 s46, 1
    s_cbranch_scc1 .kvd_247
    s_mov_b32 s62, 0
.kv_246:
    buffer_load_dword v18, v13, s[8:11], 0 offen sc1
    s_add_u32 s62, s62, 1
    s_cmp_gt_u32 s62, 0x100000
    s_cbranch_scc1 .mg_end_1
    s_waitcnt vmcnt(0)
    v_min_u32_dpp v18, v18, v18 quad_perm:[1,0,3,2] row_mask:0xf bank_mask:0xf
    s_nop 1
    v_min_u32_dpp v18, v18, v18 quad_perm:[2,3,0,1] row_mask:0xf bank_mask:0xf
    s_nop 1
    v_min_u32_dpp v18, v18, v18 row_half_mirror row_mask:0xf bank_mask:0xf
    s_nop 0
    v_readfirstlane_b32 s46, v18
    s_cmp_lt_u32 s46, 1
    s_cbranch_scc1 .kv_246
.kvd_247:
    s_barrier
.p2align 6
.step_248:
    s_barrier
    s_setprio 3
    buffer_load_dwordx4 v[24:27], v3, s[8:11], s30 offen offset:0 sc1
    s_setprio 2
    buffer_load_dwordx4 v[28:31], v3, s[8:11], s30 offen offset:1024 sc1
    s_setprio 1
    buffer_load_dwordx4 v[32:35], v3, s[8:11], s30 offen offset:2048 sc1
    s_setprio 0
    buffer_load_dwordx4 v[36:39], v3, s[8:11], s30 offen offset:3072 sc1
    s_call_b64 s[98:99], .gm_206
    v_pk_add_f32 v[40:41], v[40:41], v[42:43]
    v_pk_add_f32 v[42:43], v[44:45], v[46:47]
    ds_write2_b32 v5, v40, v41 offset0:0 offset1:36
    ds_write2_b32 v5, v42, v43 offset0:16 offset1:52
    s_nop 1
    v_pk_add_f32 v[48:49], v[48:49], v[50:51]
    v_pk_add_f32 v[50:51], v[52:53], v[54:55]
    ds_write2_b32 v6, v48, v49 offset0:0 offset1:36
    ds_write2_b32 v6, v50, v51 offset0:16 offset1:52
    s_waitcnt lgkmcnt(2)
    s_barrier
    s_waitcnt lgkmcnt(0)
    s_barrier
    v_smfmac_f32_16x16x64_bf16 v[56:59], v[24:27], a[128:135], v2
    v_smfmac_f32_16x16x64_bf16 v[60:63], v[24:27], a[160:167], v2
    v_smfmac_f32_16x16x64_bf16 v[56:59], v[28:31], a[136:143], v2
    v_smfmac_f32_16x16x64_bf16 v[60:63], v[28:31], a[168:175], v2
    v_smfmac_f32_16x16x64_bf16 v[56:59], v[32:35], a[144:151], v2
    v_smfmac_f32_16x16x64_bf16 v[60:63], v[32:35], a[176:183], v2
    v_smfmac_f32_16x16x64_bf16 v[56:59], v[36:39], a[152:159], v2
    v_smfmac_f32_16x16x64_bf16 v[60:63], v[36:39], a[184:191], v2
    ds_read_b64 v[72:73], v9 offset:0
    ds_read_b64 v[74:75], v9 offset:1152
    ds_read_b64 v[76:77], v9 offset:2304
    ds_read_b64 v[78:79], v9 offset:3456
    s_waitcnt lgkmcnt(0)
    v_pk_add_f32 v[72:73], v[72:73], v[74:75]
    v_pk_add_f32 v[76:77], v[76:77], v[78:79]
    v_pk_add_f32 v[72:73], v[72:73], v[76:77]
    v_cvt_pk_bf16_f32 v72, v72, v73
    ds_write_b32 v11, v72
    v_mov_b32 v40, 0
    v_mov_b32 v41, 0
    v_mov_b32 v42, 0
    v_mov_b32 v43, 0
    v_mov_b32 v44, 0
    v_mov_b32 v45, 0
    v_mov_b32 v46, 0
    v_mov_b32 v47, 0
    v_pk_add_f32 v[56:57], v[56:57], v[58:59]
    v_pk_add_f32 v[58:59], v[60:61], v[62:63]
    v_cvt_pk_bf16_f32 v60, v56, v57
    v_cvt_pk_bf16_f32 v61, v58, v59
    ds_write2_b32 v255, v60, v61 offset0:0 offset1:32
    ds_write_b128 v8, v[56:59]
    s_waitcnt lgkmcnt(0)
    s_barrier
    ds_read_b64 v[72:73], v12 offset:0
    ds_read_b64 v[74:75], v12 offset:1024
    ds_read_b64 v[76:77], v12 offset:2048
    ds_read_b64 v[78:79], v12 offset:3072
    ds_read_b64 v[80:81], v12 offset:64
    ds_read_b64 v[82:83], v12 offset:1088
    ds_read_b64 v[84:85], v12 offset:2112
    ds_read_b64 v[86:87], v12 offset:3136
    s_waitcnt lgkmcnt(4)
    v_add_f32 v72, v72, v74
    v_add_f32 v73, v73, v75
    v_add_f32 v76, v76, v78
    v_add_f32 v77, v77, v79
    v_add_f32 v72, v72, v76
    v_add_f32 v73, v73, v77
    v_cvt_pk_bf16_f32 v72, v72, v73
    s_waitcnt lgkmcnt(0)
    v_add_f32 v80, v80, v82
    v_add_f32 v81, v81, v83
    v_add_f32 v84, v84, v86
    v_add_f32 v85, v85, v87
    v_add_f32 v80, v80, v84
    v_add_f32 v81, v81, v85
    v_cvt_pk_bf16_f32 v80, v80, v81
    ds_write_b32 v14, v72
    ds_write_b32 v14, v80 offset:64
    s_waitcnt lgkmcnt(0)
    s_cmp_ge_u32 s28, 62
    s_cbranch_scc1 .ke_250
.kb_251:
    s_cmp_eq_u32 s28, 63
    s_cbranch_scc1 .fin_249
    s_add_u32 s37, s28, 0
    s_bitcmp1_b32 s37, 0
    s_cselect_b32 s4, 0x84000, 0
    s_xor_b32 s34, s35, s4
    s_bitcmp1_b32 s37, 1
    s_cselect_b32 s4, 0x101000, 0
    s_xor_b32 s34, s34, s4
    s_lshr_b32 s37, s37, 2
    s_bitcmp1_b32 s63, s37
    s_cselect_b32 s4, 0x2000, 0
    s_xor_b32 s34, s34, s4
    s_lshl_b32 s37, s37, 21
    s_add_u32 s34, s34, s37
    buffer_store_dwordx4 v[20:23], v246, s[8:11], s32 offen sc1
    buffer_store_dwordx4 v[20:23], v245, s[8:11], s32 offen sc1
    buffer_store_dword v20, v237, s[8:11], s32 offen sc1
    s_add_u32 s5, s28, 2
    s_cmp_ge_u32 s46, s5
    s_cbranch_scc1 .kvd_255
    s_mov_b32 s62, 0
.kv_254:
    buffer_load_dword v18, v13, s[8:11], 0 offen sc1
    s_add_u32 s62, s62, 1
    s_cmp_gt_u32 s62, 0x100000
    s_cbranch_scc1 .mg_end_1
    s_waitcnt vmcnt(0)
    v_min_u32_dpp v18, v18, v18 quad_perm:[1,0,3,2] row_mask:0xf bank_mask:0xf
    s_nop 1
    v_min_u32_dpp v18, v18, v18 quad_perm:[2,3,0,1] row_mask:0xf bank_mask:0xf
    s_nop 1
    v_min_u32_dpp v18, v18, v18 row_half_mirror row_mask:0xf bank_mask:0xf
    s_nop 0
    v_readfirstlane_b32 s46, v18
    s_cmp_lt_u32 s46, s5
    s_cbranch_scc1 .kv_254
.kvd_255:
    v_mov_b32 v48, 0
    v_mov_b32 v49, 0
    v_mov_b32 v50, 0
    v_mov_b32 v51, 0
    v_mov_b32 v52, 0
    v_mov_b32 v53, 0
    v_mov_b32 v54, 0
    v_mov_b32 v55, 0
    v_mov_b32 v56, 0
    v_mov_b32 v57, 0
    v_mov_b32 v58, 0
    v_mov_b32 v59, 0
    v_mov_b32 v60, 0
    v_mov_b32 v61, 0
    v_mov_b32 v62, 0
    v_mov_b32 v63, 0
    s_cmp_ge_u32 s28, 62
    s_cbranch_scc1 .kf_252
.kg_253:
    s_barrier
    s_setprio 3
    buffer_load_dwordx4 v[24:27], v4, s[8:11], s30 offen offset:0 sc1
    s_setprio 2
    buffer_load_dwordx4 v[28:31], v4, s[8:11], s30 offen offset:1024 sc1
    s_setprio 1
    buffer_load_dwordx4 v[32:35], v4, s[8:11], s30 offen offset:2048 sc1
    s_setprio 0
    buffer_load_dwordx4 v[36:39], v4, s[8:11], s30 offen offset:3072 sc1
    s_call_b64 s[98:99], .gm_207
    s_nop 4
    v_pk_add_f32 v[64:65], v[64:65], v[66:67]
    v_cvt_pk_bf16_f32 v66, v64, v65
    v_pk_add_f32 v[68:69], v[68:69], v[70:71]
    v_cvt_pk_bf16_f32 v67, v68, v69
    v_min_u32 v67, 0xfffffffe, v67
    buffer_store_dwordx2 v[66:67], v168, s[8:11], s34 offen sc1
    ds_write2_b32 v7, v64, v65 offset0:0 offset1:36
    ds_write2_b32 v7, v68, v69 offset0:16 offset1:52
    s_waitcnt lgkmcnt(0)
    s_barrier
    s_add_u32 s5, s28, 3
    s_min_u32 s5, s5, 64
    s_cmp_ge_u32 s46, s5
    s_cbranch_scc1 .kvd_257
    s_mov_b32 s62, 0
.kv_256:
    buffer_load_dword v18, v13, s[8:11], 0 offen sc1
    s_add_u32 s62, s62, 1
    s_cmp_gt_u32 s62, 0x100000
    s_cbranch_scc1 .mg_end_1
    s_waitcnt vmcnt(0)
    v_min_u32_dpp v18, v18, v18 quad_perm:[1,0,3,2] row_mask:0xf bank_mask:0xf
    s_nop 1
    v_min_u32_dpp v18, v18, v18 quad_perm:[2,3,0,1] row_mask:0xf bank_mask:0xf
    s_nop 1
    v_min_u32_dpp v18, v18, v18 row_half_mirror row_mask:0xf bank_mask:0xf
    s_nop 0
    v_readfirstlane_b32 s46, v18
.kvd_257:
    v_mov_b32 v64, 0
    v_mov_b32 v65, 0
    v_mov_b32 v66, 0
    v_mov_b32 v67, 0
    v_mov_b32 v68, 0
    v_mov_b32 v69, 0
    v_mov_b32 v70, 0
    v_mov_b32 v71, 0
    s_mov_b32 s4, s30
    s_mov_b32 s30, s31
    s_mov_b32 s31, s32
    s_mov_b32 s32, s33
    s_mov_b32 s33, s4
    s_add_u32 s28, s28, 1
    s_mov_b32 s62, 0
    s_add_u32 s41, s41, 0x20000
    s_branch .step_248
.fin_249:
    s_barrier
    s_add_u32 s4, s28, 1
    v_mov_b32 v18, s4
    s_mov_b64 exec, 1
    s_waitcnt vmcnt(0)
    buffer_store_dword v18, v174, s[8:11], 0 offen sc1
    s_mov_b64 exec, -1
    s_endpgm
.ke_250:
    ds_read_b128 v[72:75], v175
    s_waitcnt lgkmcnt(0)
    buffer_store_dwordx4 v[72:75], v244, s[8:11], s41 offen sc1
    s_branch .kb_251
.kf_252:
    s_add_u32 s4, s28, 1
    v_mov_b32 v18, s4
    s_mov_b64 exec, 1
    s_waitcnt vmcnt(0)
    buffer_store_dword v18, v174, s[8:11], 0 offen sc1
    s_mov_b64 exec, -1
    s_branch .kg_253
.p2align 6
.gm_206:
    s_waitcnt vmcnt(3)
    v_max_u32 v18, v25, v27
    v_cmp_eq_u32 vcc, -1, v18
    s_cbranch_vccnz .nk_258
.ok_259:
    v_smfmac_f32_16x16x64_bf16 v[40:43], v[24:27], a[0:7], v2
    v_smfmac_f32_16x16x64_bf16 v[44:47], v[24:27], a[32:39], v2
    s_waitcnt vmcnt(2)
    v_max_u32 v18, v29, v31
    v_cmp_eq_u32 vcc, -1, v18
    v_smfmac_f32_16x16x64_bf16 v[48:51], v[24:27], a[64:71], v2
    v_smfmac_f32_16x16x64_bf16 v[52:55], v[24:27], a[96:103], v2
    s_cbranch_vccnz .nk_260
.ok_261:
    v_smfmac_f32_16x16x64_bf16 v[40:43], v[28:31], a[8:15], v2
    v_smfmac_f32_16x16x64_bf16 v[44:47], v[28:31], a[40:47], v2
    s_waitcnt vmcnt(1)
    v_max_u32 v18, v33, v35
    v_cmp_eq_u32 vcc, -1, v18
    v_smfmac_f32_16x16x64_bf16 v[48:51], v[28:31], a[72:79], v2
    v_smfmac_f32_16x16x64_bf16 v[52:55], v[28:31], a[104:111], v2
    s_cbranch_vccnz .nk_262
.ok_263:
    v_smfmac_f32_16x16x64_bf16 v[40:43], v[32:35], a[16:23], v2
    v_smfmac_f32_16x16x64_bf16 v[44:47], v[32:35], a[48:55], v2
    s_waitcnt vmcnt(0)
    v_max_u32 v18, v37, v39
    v_cmp_eq_u32 vcc, -1, v18
    v_smfmac_f32_16x16x64_bf16 v[48:51], v[32:35], a[80:87], v2
    v_smfmac_f32_16x16x64_bf16 v[52:55], v[32:35], a[112:119], v2
    s_cbranch_vccnz .nk_264
.ok_265:
    v_smfmac_f32_16x16x64_bf16 v[40:43], v[36:39], a[24:31], v2
    v_smfmac_f32_16x16x64_bf16 v[44:47], v[36:39], a[56:63], v2
    v_smfmac_f32_16x16x64_bf16 v[48:51], v[36:39], a[88:95], v2
    v_smfmac_f32_16x16x64_bf16 v[52:55], v[36:39], a[120:127], v2
    s_setpc_b64 s[98:99]
.nk_258:
    buffer_load_dwordx4 v[24:27], v3, s[8:11], s30 offen offset:0 sc1
    s_add_u32 s62, s62, 1
    s_cmp_gt_u32 s62, 0x100000
    s_cbranch_scc1 .mg_end_1
    s_waitcnt vmcnt(3)
    v_max_u32 v18, v29, v31
    v_cmp_eq_u32 vcc, -1, v18
    s_cbranch_vccnz .nk_266
.ok_267:
    v_smfmac_f32_16x16x64_bf16 v[40:43], v[28:31], a[8:15], v2
    v_smfmac_f32_16x16x64_bf16 v[44:47], v[28:31], a[40:47], v2
    s_waitcnt vmcnt(2)
    v_max_u32 v18, v33, v35
    v_cmp_eq_u32 vcc, -1, v18
    v_smfmac_f32_16x16x64_bf16 v[48:51], v[28:31], a[72:79], v2
    v_smfmac_f32_16x16x64_bf16 v[52:55], v[28:31], a[104:111], v2
    s_cbranch_vccnz .nk_268
.ok_269:
    v_smfmac_f32_16x16x64_bf16 v[40:43], v[32:35], a[16:23], v2
    v_smfmac_f32_16x16x64_bf16 v[44:47], v[32:35], a[48:55], v2
    s_waitcnt vmcnt(1)
    v_max_u32 v18, v37, v39
    v_cmp_eq_u32 vcc, -1, v18
    v_smfmac_f32_16x16x64_bf16 v[48:51], v[32:35], a[80:87], v2
    v_smfmac_f32_16x16x64_bf16 v[52:55], v[32:35], a[112:119], v2
    s_cbranch_vccnz .nk_270
.ok_271:
    v_smfmac_f32_16x16x64_bf16 v[40:43], v[36:39], a[24:31], v2
    v_smfmac_f32_16x16x64_bf16 v[44:47], v[36:39], a[56:63], v2
    s_waitcnt vmcnt(0)
    v_max_u32 v18, v25, v27
    v_cmp_eq_u32 vcc, -1, v18
    v_smfmac_f32_16x16x64_bf16 v[48:51], v[36:39], a[88:95], v2
    v_smfmac_f32_16x16x64_bf16 v[52:55], v[36:39], a[120:127], v2
    s_cbranch_vccnz .nk_272
.ok_273:
    v_smfmac_f32_16x16x64_bf16 v[40:43], v[24:27], a[0:7], v2
    v_smfmac_f32_16x16x64_bf16 v[44:47], v[24:27], a[32:39], v2
    v_smfmac_f32_16x16x64_bf16 v[48:51], v[24:27], a[64:71], v2
    v_smfmac_f32_16x16x64_bf16 v[52:55], v[24:27], a[96:103], v2
    s_setpc_b64 s[98:99]
.nk_260:
    buffer_load_dwordx4 v[28:31], v3, s[8:11], s30 offen offset:1024 sc1
    s_add_u32 s62, s62, 1
    s_cmp_gt_u32 s62, 0x100000
    s_cbranch_scc1 .mg_end_1
    s_waitcnt vmcnt(2)
    v_max_u32 v18, v33, v35
    v_cmp_eq_u32 vcc, -1, v18
    s_cbranch_vccnz .nk_274
.ok_275:
    v_smfmac_f32_16x16x64_bf16 v[40:43], v[32:35], a[16:23], v2
    v_smfmac_f32_16x16x64_bf16 v[44:47], v[32:35], a[48:55], v2
    s_waitcnt vmcnt(1)
    v_max_u32 v18, v37, v39
    v_cmp_eq_u32 vcc, -1, v18
    v_smfmac_f32_16x16x64_bf16 v[48:51], v[32:35], a[80:87], v2
    v_smfmac_f32_16x16x64_bf16 v[52:55], v[32:35], a[112:119], v2
    s_cbranch_vccnz .nk_276
.ok_277:
    v_smfmac_f32_16x16x64_bf16 v[40:43], v[36:39], a[24:31], v2
    v_smfmac_f32_16x16x64_bf16 v[44:47], v[36:39], a[56:63], v2
    s_waitcnt vmcnt(0)
    v_max_u32 v18, v29, v31
    v_cmp_eq_u32 vcc, -1, v18
    v_smfmac_f32_16x16x64_bf16 v[48:51], v[36:39], a[88:95], v2
    v_smfmac_f32_16x16x64_bf16 v[52:55], v[36:39], a[120:127], v2
    s_cbranch_vccnz .nk_278
.ok_279:
    v_smfmac_f32_16x16x64_bf16 v[40:43], v[28:31], a[8:15], v2
    v_smfmac_f32_16x16x64_bf16 v[44:47], v[28:31], a[40:47], v2
    v_smfmac_f32_16x16x64_bf16 v[48:51], v[28:31], a[72:79], v2
    v_smfmac_f32_16x16x64_bf16 v[52:55], v[28:31], a[104:111], v2
    s_setpc_b64 s[98:99]
.nk_262:
    buffer_load_dwordx4 v[32:35], v3, s[8:11], s30 offen offset:2048 sc1
    s_add_u32 s62, s62, 1
    s_cmp_gt_u32 s62, 0x100000
    s_cbranch_scc1 .mg_end_1
    s_waitcnt vmcnt(1)
    v_max_u32 v18, v37, v39
    v_cmp_eq_u32 vcc, -1, v18
    s_cbranch_vccnz .nk_280
.ok_281:
    v_smfmac_f32_16x16x64_bf16 v[40:43], v[36:39], a[24:31], v2
    v_smfmac_f32_16x16x64_bf16 v[44:47], v[36:39], a[56:63], v2
    s_waitcnt vmcnt(0)
    v_max_u32 v18, v33, v35
    v_cmp_eq_u32 vcc, -1, v18
    v_smfmac_f32_16x16x64_bf16 v[48:51], v[36:39], a[88:95], v2
    v_smfmac_f32_16x16x64_bf16 v[52:55], v[36:39], a[120:127], v2
    s_cbranch_vccnz .nk_282
.ok_283:
    v_smfmac_f32_16x16x64_bf16 v[40:43], v[32:35], a[16:23], v2
    v_smfmac_f32_16x16x64_bf16 v[44:47], v[32:35], a[48:55], v2
    v_smfmac_f32_16x16x64_bf16 v[48:51], v[32:35], a[80:87], v2
    v_smfmac_f32_16x16x64_bf16 v[52:55], v[32:35], a[112:119], v2
    s_setpc_b64 s[98:99]
.nk_264:
    buffer_load_dwordx4 v[36:39], v3, s[8:11], s30 offen offset:3072 sc1
    s_add_u32 s62, s62, 1
    s_cmp_gt_u32 s62, 0x100000
    s_cbranch_scc1 .mg_end_1
    s_waitcnt vmcnt(0)
    v_max_u32 v18, v37, v39
    v_cmp_eq_u32 vcc, -1, v18
    s_cbranch_vccnz .nk_264
    s_branch .ok_265
.nk_266:
    buffer_load_dwordx4 v[28:31], v3, s[8:11], s30 offen offset:1024 sc1
    s_add_u32 s62, s62, 1
    s_cmp_gt_u32 s62, 0x100000
    s_cbranch_scc1 .mg_end_1
    s_waitcnt vmcnt(3)
    v_max_u32 v18, v33, v35
    v_cmp_eq_u32 vcc, -1, v18
    s_cbranch_vccnz .nk_284
.ok_285:
    v_smfmac_f32_16x16x64_bf16 v[40:43], v[32:35], a[16:23], v2
    v_smfmac_f32_16x16x64_bf16 v[44:47], v[32:35], a[48:55], v2
    s_waitcnt vmcnt(2)
    v_max_u32 v18, v37, v39
    v_cmp_eq_u32 vcc, -1, v18
    v_smfmac_f32_16x16x64_bf16 v[48:51], v[32:35], a[80:87], v2
    v_smfmac_f32_16x16x64_bf16 v[52:55], v[32:35], a[112:119], v2
    s_cbranch_vccnz .nk_286
.ok_287:
    v_smfmac_f32_16x16x64_bf16 v[40:43], v[36:39], a[24:31], v2
    v_smfmac_f32_16x16x64_bf16 v[44:47], v[36:39], a[56:63], v2
    s_waitcnt vmcnt(1)
    v_max_u32 v18, v25, v27
    v_cmp_eq_u32 vcc, -1, v18
    v_smfmac_f32_16x16x64_bf16 v[48:51], v[36:39], a[88:95], v2
    v_smfmac_f32_16x16x64_bf16 v[52:55], v[36:39], a[120:127], v2
    s_cbranch_vccnz .nk_288
.ok_289:
    v_smfmac_f32_16x16x64_bf16 v[40:43], v[24:27], a[0:7], v2
    v_smfmac_f32_16x16x64_bf16 v[44:47], v[24:27], a[32:39], v2
    s_waitcnt vmcnt(0)
    v_max_u32 v18, v29, v31
    v_cmp_eq_u32 vcc, -1, v18
    v_smfmac_f32_16x16x64_bf16 v[48:51], v[24:27], a[64:71], v2
    v_smfmac_f32_16x16x64_bf16 v[52:55], v[24:27], a[96:103], v2
    s_cbranch_vccnz .nk_278
    s_branch .ok_279
.nk_268:
    buffer_load_dwordx4 v[32:35], v3, s[8:11], s30 offen offset:2048 sc1
    s_add_u32 s62, s62, 1
    s_cmp_gt_u32 s62, 0x100000
    s_cbranch_scc1 .mg_end_1
    s_waitcnt vmcnt(2)
    v_max_u32 v18, v37, v39
    v_cmp_eq_u32 vcc, -1, v18
    s_cbranch_vccnz .nk_290
.ok_291:
    v_smfmac_f32_16x16x64_bf16 v[40:43], v[36:39], a[24:31], v2
    v_smfmac_f32_16x16x64_bf16 v[44:47], v[36:39], a[56:63], v2
    s_waitcnt vmcnt(1)
    v_max_u32 v18, v25, v27
    v_cmp_eq_u32 vcc, -1, v18
    v_smfmac_f32_16x16x64_bf16 v[48:51], v[36:39], a[88:95], v2
    v_smfmac_f32_16x16x64_bf16 v[52:55], v[36:39], a[120:127], v2
    s_cbranch_vccnz .nk_292
.ok_293:
    v_smfmac_f32_16x16x64_bf16 v[40:43], v[24:27], a[0:7], v2
    v_smfmac_f32_16x16x64_bf16 v[44:47], v[24:27], a[32:39], v2
    s_waitcnt vmcnt(0)
    v_max_u32 v18, v33, v35
    v_cmp_eq_u32 vcc, -1, v18
    v_smfmac_f32_16x16x64_bf16 v[48:51], v[24:27], a[64:71], v2
    v_smfmac_f32_16x16x64_bf16 v[52:55], v[24:27], a[96:103], v2
    s_cbranch_vccnz .nk_282
    s_branch .ok_283
.nk_270:
    buffer_load_dwordx4 v[36:39], v3, s[8:11], s30 offen offset:3072 sc1
    s_add_u32 s62, s62, 1
    s_cmp_gt_u32 s62, 0x100000
    s_cbranch_scc1 .mg_end_1
    s_waitcnt vmcnt(1)
    v_max_u32 v18, v25, v27
    v_cmp_eq_u32 vcc, -1, v18
    s_cbranch_vccnz .nk_294
.ok_295:
    v_smfmac_f32_16x16x64_bf16 v[40:43], v[24:27], a[0:7], v2
    v_smfmac_f32_16x16x64_bf16 v[44:47], v[24:27], a[32:39], v2
    s_waitcnt vmcnt(0)
    v_max_u32 v18, v37, v39
    v_cmp_eq_u32 vcc, -1, v18
    v_smfmac_f32_16x16x64_bf16 v[48:51], v[24:27], a[64:71], v2
    v_smfmac_f32_16x16x64_bf16 v[52:55], v[24:27], a[96:103], v2
    s_cbranch_vccnz .nk_264
    s_branch .ok_265
.nk_272:
    buffer_load_dwordx4 v[24:27], v3, s[8:11], s30 offen offset:0 sc1
    s_add_u32 s62, s62, 1
    s_cmp_gt_u32 s62, 0x100000
    s_cbranch_scc1 .mg_end_1
    s_waitcnt vmcnt(0)
    v_max_u32 v18, v25, v27
    v_cmp_eq_u32 vcc, -1, v18
    s_cbranch_vccnz .nk_272
    s_branch .ok_273
.nk_274:
    buffer_load_dwordx4 v[32:35], v3, s[8:11], s30 offen offset:2048 sc1
    s_add_u32 s62, s62, 1
    s_cmp_gt_u32 s62, 0x100000
    s_cbranch_scc1 .mg_end_1
    s_waitcnt vmcnt(2)
    v_max_u32 v18, v37, v39
    v_cmp_eq_u32 vcc, -1, v18
    s_cbranch_vccnz .nk_296
.ok_297:
    v_smfmac_f32_16x16x64_bf16 v[40:43], v[36:39], a[24:31], v2
    v_smfmac_f32_16x16x64_bf16 v[44:47], v[36:39], a[56:63], v2
    s_waitcnt vmcnt(1)
    v_max_u32 v18, v29, v31
    v_cmp_eq_u32 vcc, -1, v18
    v_smfmac_f32_16x16x64_bf16 v[48:51], v[36:39], a[88:95], v2
    v_smfmac_f32_16x16x64_bf16 v[52:55], v[36:39], a[120:127], v2
    s_cbranch_vccnz .nk_298
.ok_299:
    v_smfmac_f32_16x16x64_bf16 v[40:43], v[28:31], a[8:15], v2
    v_smfmac_f32_16x16x64_bf16 v[44:47], v[28:31], a[40:47], v2
    s_waitcnt vmcnt(0)
    v_max_u32 v18, v33, v35
    v_cmp_eq_u32 vcc, -1, v18
    v_smfmac_f32_16x16x64_bf16 v[48:51], v[28:31], a[72:79], v2
    v_smfmac_f32_16x16x64_bf16 v[52:55], v[28:31], a[104:111], v2
    s_cbranch_vccnz .nk_282
    s_branch .ok_283
.nk_276:
    buffer_load_dwordx4 v[36:39], v3, s[8:11], s30 offen offset:3072 sc1
    s_add_u32 s62, s62, 1
    s_cmp_gt_u32 s62, 0x100000
    s_cbranch_scc1 .mg_end_1
    s_waitcnt vmcnt(1)
    v_max_u32 v18, v29, v31
    v_cmp_eq_u32 vcc, -1, v18
    s_cbranch_vccnz .nk_300
.ok_301:
    v_smfmac_f32_16x16x64_bf16 v[40:43], v[28:31], a[8:15], v2
    v_smfmac_f32_16x16x64_bf16 v[44:47], v[28:31], a[40:47], v2
    s_waitcnt vmcnt(0)
    v_max_u32 v18, v37, v39
    v_cmp_eq_u32 vcc, -1, v18
    v_smfmac_f32_16x16x64_bf16 v[48:51], v[28:31], a[72:79], v2
    v_smfmac_f32_16x16x64_bf16 v[52:55], v[28:31], a[104:111], v2
    s_cbranch_vccnz .nk_264
    s_branch .ok_265
.nk_278:
    buffer_load_dwordx4 v[28:31], v3, s[8:11], s30 offen offset:1024 sc1
    s_add_u32 s62, s62, 1
    s_cmp_gt_u32 s62, 0x100000
    s_cbranch_scc1 .mg_end_1
    s_waitcnt vmcnt(0)
    v_max_u32 v18, v29, v31
    v_cmp_eq_u32 vcc, -1, v18
    s_cbranch_vccnz .nk_278
    s_branch .ok_279
.nk_280:
    buffer_load_dwordx4 v[36:39], v3, s[8:11], s30 offen offset:3072 sc1
    s_add_u32 s62, s62, 1
    s_cmp_gt_u32 s62, 0x100000
    s_cbranch_scc1 .mg_end_1
    s_waitcnt vmcnt(1)
    v_max_u32 v18, v33, v35
    v_cmp_eq_u32 vcc, -1, v18
    s_cbranch_vccnz .nk_262
    s_branch .ok_263
.nk_282:
    buffer_load_dwordx4 v[32:35], v3, s[8:11], s30 offen offset:2048 sc1
    s_add_u32 s62, s62, 1
    s_cmp_gt_u32 s62, 0x100000
    s_cbranch_scc1 .mg_end_1
    s_waitcnt vmcnt(0)
    v_max_u32 v18, v33, v35
    v_cmp_eq_u32 vcc, -1, v18
    s_cbranch_vccnz .nk_282
    s_branch .ok_283
.nk_284:
    buffer_load_dwordx4 v[32:35], v3, s[8:11], s30 offen offset:2048 sc1
    s_add_u32 s62, s62, 1
    s_cmp_gt_u32 s62, 0x100000
    s_cbranch_scc1 .mg_end_1
    s_waitcnt vmcnt(3)
    v_max_u32 v18, v37, v39
    v_cmp_eq_u32 vcc, -1, v18
    s_cbranch_vccnz .nk_302
.ok_303:
    v_smfmac_f32_16x16x64_bf16 v[40:43], v[36:39], a[24:31], v2
    v_smfmac_f32_16x16x64_bf16 v[44:47], v[36:39], a[56:63], v2
    s_waitcnt vmcnt(2)
    v_max_u32 v18, v25, v27
    v_cmp_eq_u32 vcc, -1, v18
    v_smfmac_f32_16x16x64_bf16 v[48:51], v[36:39], a[88:95], v2
    v_smfmac_f32_16x16x64_bf16 v[52:55], v[36:39], a[120:127], v2
    s_cbranch_vccnz .nk_304
.ok_305:
    v_smfmac_f32_16x16x64_bf16 v[40:43], v[24:27], a[0:7], v2
    v_smfmac_f32_16x16x64_bf16 v[44:47], v[24:27], a[32:39], v2
    s_waitcnt vmcnt(1)
    v_max_u32 v18, v29, v31
    v_cmp_eq_u32 vcc, -1, v18
    v_smfmac_f32_16x16x64_bf16 v[48:51], v[24:27], a[64:71], v2
    v_smfmac_f32_16x16x64_bf16 v[52:55], v[24:27], a[96:103], v2
    s_cbranch_vccnz .nk_298
    s_branch .ok_299
.nk_286:
    buffer_load_dwordx4 v[36:39], v3, s[8:11], s30 offen offset:3072 sc1
    s_add_u32 s62, s62, 1
    s_cmp_gt_u32 s62, 0x100000
    s_cbranch_scc1 .mg_end_1
    s_waitcnt vmcnt(2)
    v_max_u32 v18, v25, v27
    v_cmp_eq_u32 vcc, -1, v18
    s_cbranch_vccnz .nk_306
.ok_307:
    v_smfmac_f32_16x16x64_bf16 v[40:43], v[24:27], a[0:7], v2
    v_smfmac_f32_16x16x64_bf16 v[44:47], v[24:27], a[32:39], v2
    s_waitcnt vmcnt(1)
    v_max_u32 v18, v29, v31
    v_cmp_eq_u32 vcc, -1, v18
    v_smfmac_f32_16x16x64_bf16 v[48:51], v[24:27], a[64:71], v2
    v_smfmac_f32_16x16x64_bf16 v[52:55], v[24:27], a[96:103], v2
    s_cbranch_vccnz .nk_300
    s_branch .ok_301
.nk_288:
    buffer_load_dwordx4 v[24:27], v3, s[8:11], s30 offen offset:0 sc1
    s_add_u32 s62, s62, 1
    s_cmp_gt_u32 s62, 0x100000
    s_cbranch_scc1 .mg_end_1
    s_waitcnt vmcnt(1)
    v_max_u32 v18, v29, v31
    v_cmp_eq_u32 vcc, -1, v18
    s_cbranch_vccnz .nk_308
.ok_309:
    v_smfmac_f32_16x16x64_bf16 v[40:43], v[28:31], a[8:15], v2
    v_smfmac_f32_16x16x64_bf16 v[44:47], v[28:31], a[40:47], v2
    s_waitcnt vmcnt(0)
    v_max_u32 v18, v25, v27
    v_cmp_eq_u32 vcc, -1, v18
    v_smfmac_f32_16x16x64_bf16 v[48:51], v[28:31], a[72:79], v2
    v_smfmac_f32_16x16x64_bf16 v[52:55], v[28:31], a[104:111], v2
    s_cbranch_vccnz .nk_272
    s_branch .ok_273
.nk_290:
    buffer_load_dwordx4 v[36:39], v3, s[8:11], s30 offen offset:3072 sc1
    s_add_u32 s62, s62, 1
    s_cmp_gt_u32 s62, 0x100000
    s_cbranch_scc1 .mg_end_1
    s_waitcnt vmcnt(2)
    v_max_u32 v18, v25, v27
    v_cmp_eq_u32 vcc, -1, v18
    s_cbranch_vccnz .nk_310
.ok_311:
    v_smfmac_f32_16x16x64_bf16 v[40:43], v[24:27], a[0:7], v2
    v_smfmac_f32_16x16x64_bf16 v[44:47], v[24:27], a[32:39], v2
    s_waitcnt vmcnt(1)
    v_max_u32 v18, v33, v35
    v_cmp_eq_u32 vcc, -1, v18
    v_smfmac_f32_16x16x64_bf16 v[48:51], v[24:27], a[64:71], v2
    v_smfmac_f32_16x16x64_bf16 v[52:55], v[24:27], a[96:103], v2
    s_cbranch_vccnz .nk_262
    s_branch .ok_263
.nk_292:
    buffer_load_dwordx4 v[24:27], v3, s[8:11], s30 offen offset:0 sc1
    s_add_u32 s62, s62, 1
    s_cmp_gt_u32 s62, 0x100000
    s_cbranch_scc1 .mg_end_1
    s_waitcnt vmcnt(1)
    v_max_u32 v18, v33, v35
    v_cmp_eq_u32 vcc, -1, v18
    s_cbranch_vccnz .nk_312
.ok_313:
    v_smfmac_f32_16x16x64_bf16 v[40:43], v[32:35], a[16:23], v2
    v_smfmac_f32_16x16x64_bf16 v[44:47], v[32:35], a[48:55], v2
    s_waitcnt vmcnt(0)
    v_max_u32 v18, v25, v27
    v_cmp_eq_u32 vcc, -1, v18
    v_smfmac_f32_16x16x64_bf16 v[48:51], v[32:35], a[80:87], v2
    v_smfmac_f32_16x16x64_bf16 v[52:55], v[32:35], a[112:119], v2
    s_cbranch_vccnz .nk_272
    s_branch .ok_273
.nk_294:
    buffer_load_dwordx4 v[24:27], v3, s[8:11], s30 offen offset:0 sc1
    s_add_u32 s62, s62, 1
    s_cmp_gt_u32 s62, 0x100000
    s_cbranch_scc1 .mg_end_1
    s_waitcnt vmcnt(1)
    v_max_u32 v18, v37, v39
    v_cmp_eq_u32 vcc, -1, v18
    s_cbranch_vccnz .nk_270
    s_branch .ok_271
.nk_296:
    buffer_load_dwordx4 v[36:39], v3, s[8:11], s30 offen offset:3072 sc1
    s_add_u32 s62, s62, 1
    s_cmp_gt_u32 s62, 0x100000
    s_cbranch_scc1 .mg_end_1
    s_waitcnt vmcnt(2)
    v_max_u32 v18, v29, v31
    v_cmp_eq_u32 vcc, -1, v18
    s_cbranch_vccnz .nk_260
    s_branch .ok_261
.nk_298:
    buffer_load_dwordx4 v[28:31], v3, s[8:11], s30 offen offset:1024 sc1
    s_add_u32 s62, s62, 1
    s_cmp_gt_u32 s62, 0x100000
    s_cbranch_scc1 .mg_end_1
    s_waitcnt vmcnt(1)
    v_max_u32 v18, v33, v35
    v_cmp_eq_u32 vcc, -1, v18
    s_cbranch_vccnz .nk_314
.ok_315:
    v_smfmac_f32_16x16x64_bf16 v[40:43], v[32:35], a[16:23], v2
    v_smfmac_f32_16x16x64_bf16 v[44:47], v[32:35], a[48:55], v2
    s_waitcnt vmcnt(0)
    v_max_u32 v18, v29, v31
    v_cmp_eq_u32 vcc, -1, v18
    v_smfmac_f32_16x16x64_bf16 v[48:51], v[32:35], a[80:87], v2
    v_smfmac_f32_16x16x64_bf16 v[52:55], v[32:35], a[112:119], v2
    s_cbranch_vccnz .nk_278
    s_branch .ok_279
.nk_300:
    buffer_load_dwordx4 v[28:31], v3, s[8:11], s30 offen offset:1024 sc1
    s_add_u32 s62, s62, 1
    s_cmp_gt_u32 s62, 0x100000
    s_cbranch_scc1 .mg_end_1
    s_waitcnt vmcnt(1)
    v_max_u32 v18, v37, v39
    v_cmp_eq_u32 vcc, -1, v18
    s_cbranch_vccnz .nk_276
    s_branch .ok_277
.nk_302:
    buffer_load_dwordx4 v[36:39], v3, s[8:11], s30 offen offset:3072 sc1
    s_add_u32 s62, s62, 1
    s_cmp_gt_u32 s62, 0x100000
    s_cbranch_scc1 .mg_end_1
    s_waitcnt vmcnt(3)
    v_max_u32 v18, v25, v27
    v_cmp_eq_u32 vcc, -1, v18
    s_cbranch_vccnz .nk_258
    s_branch .ok_259
.nk_304:
    buffer_load_dwordx4 v[24:27], v3, s[8:11], s30 offen offset:0 sc1
    s_add_u32 s62, s62, 1
    s_cmp_gt_u32 s62, 0x100000
    s_cbranch_scc1 .mg_end_1
    s_waitcnt vmcnt(2)
    v_max_u32 v18, v29, v31
    v_cmp_eq_u32 vcc, -1, v18
    s_cbranch_vccnz .nk_316
.ok_317:
    v_smfmac_f32_16x16x64_bf16 v[40:43], v[28:31], a[8:15], v2
    v_smfmac_f32_16x16x64_bf16 v[44:47], v[28:31], a[40:47], v2
    s_waitcnt vmcnt(1)
    v_max_u32 v18, v33, v35
    v_cmp_eq_u32 vcc, -1, v18
    v_smfmac_f32_16x16x64_bf16 v[48:51], v[28:31], a[72:79], v2
    v_smfmac_f32_16x16x64_bf16 v[52:55], v[28:31], a[104:111], v2
    s_cbranch_vccnz .nk_312
    s_branch .ok_313
.nk_306:
    buffer_load_dwordx4 v[24:27], v3, s[8:11], s30 offen offset:0 sc1
    s_add_u32 s62, s62, 1
    s_cmp_gt_u32 s62, 0x100000
    s_cbranch_scc1 .mg_end_1
    s_waitcnt vmcnt(2)
    v_max_u32 v18, v29, v31
    v_cmp_eq_u32 vcc, -1, v18
    s_cbranch_vccnz .nk_318
.ok_319:
    v_smfmac_f32_16x16x64_bf16 v[40:43], v[28:31], a[8:15], v2
    v_smfmac_f32_16x16x64_bf16 v[44:47], v[28:31], a[40:47], v2
    s_waitcnt vmcnt(1)
    v_max_u32 v18, v37, v39
    v_cmp_eq_u32 vcc, -1, v18
    v_smfmac_f32_16x16x64_bf16 v[48:51], v[28:31], a[72:79], v2
    v_smfmac_f32_16x16x64_bf16 v[52:55], v[28:31], a[104:111], v2
    s_cbranch_vccnz .nk_270
    s_branch .ok_271
.nk_308:
    buffer_load_dwordx4 v[28:31], v3, s[8:11], s30 offen offset:1024 sc1
    s_add_u32 s62, s62, 1
    s_cmp_gt_u32 s62, 0x100000
    s_cbranch_scc1 .mg_end_1
    s_waitcnt vmcnt(1)
    v_max_u32 v18, v25, v27
    v_cmp_eq_u32 vcc, -1, v18
    s_cbranch_vccnz .nk_288
    s_branch .ok_289
.nk_310:
    buffer_load_dwordx4 v[24:27], v3, s[8:11], s30 offen offset:0 sc1
    s_add_u32 s62, s62, 1
    s_cmp_gt_u32 s62, 0x100000
    s_cbranch_scc1 .mg_end_1
    s_waitcnt vmcnt(2)
    v_max_u32 v18, v33, v35
    v_cmp_eq_u32 vcc, -1, v18
    s_cbranch_vccnz .nk_268
    s_branch .ok_269
.nk_312:
    buffer_load_dwordx4 v[32:35], v3, s[8:11], s30 offen offset:2048 sc1
    s_add_u32 s62, s62, 1
    s_cmp_gt_u32 s62, 0x100000
    s_cbranch_scc1 .mg_end_1
    s_waitcnt vmcnt(1)
    v_max_u32 v18, v25, v27
    v_cmp_eq_u32 vcc, -1, v18
    s_cbranch_vccnz .nk_292
    s_branch .ok_293
.nk_314:
    buffer_load_dwordx4 v[32:35], v3, s[8:11], s30 offen offset:2048 sc1
    s_add_u32 s62, s62, 1
    s_cmp_gt_u32 s62, 0x100000
    s_cbranch_scc1 .mg_end_1
    s_waitcnt vmcnt(1)
    v_max_u32 v18, v29, v31
    v_cmp_eq_u32 vcc, -1, v18
    s_cbranch_vccnz .nk_298
    s_branch .ok_299
.nk_316:
    buffer_load_dwordx4 v[28:31], v3, s[8:11], s30 offen offset:1024 sc1
    s_add_u32 s62, s62, 1
    s_cmp_gt_u32 s62, 0x100000
    s_cbranch_scc1 .mg_end_1
    s_waitcnt vmcnt(2)
    v_max_u32 v18, v33, v35
    v_cmp_eq_u32 vcc, -1, v18
    s_cbranch_vccnz .nk_320
.ok_321:
    v_smfmac_f32_16x16x64_bf16 v[40:43], v[32:35], a[16:23], v2
    v_smfmac_f32_16x16x64_bf16 v[44:47], v[32:35], a[48:55], v2
    s_waitcnt vmcnt(1)
    v_max_u32 v18, v25, v27
    v_cmp_eq_u32 vcc, -1, v18
    v_smfmac_f32_16x16x64_bf16 v[48:51], v[32:35], a[80:87], v2
    v_smfmac_f32_16x16x64_bf16 v[52:55], v[32:35], a[112:119], v2
    s_cbranch_vccnz .nk_288
    s_branch .ok_289
.nk_318:
    buffer_load_dwordx4 v[28:31], v3, s[8:11], s30 offen offset:1024 sc1
    s_add_u32 s62, s62, 1
    s_cmp_gt_u32 s62, 0x100000
    s_cbranch_scc1 .mg_end_1
    s_waitcnt vmcnt(2)
    v_max_u32 v18, v37, v39
    v_cmp_eq_u32 vcc, -1, v18
    s_cbranch_vccnz .nk_286
    s_branch .ok_287
.nk_320:
    buffer_load_dwordx4 v[32:35], v3, s[8:11], s30 offen offset:2048 sc1
    s_add_u32 s62, s62, 1
    s_cmp_gt_u32 s62, 0x100000
    s_cbranch_scc1 .mg_end_1
    s_waitcnt vmcnt(2)
    v_max_u32 v18, v25, v27
    v_cmp_eq_u32 vcc, -1, v18
    s_cbranch_vccnz .nk_304
    s_branch .ok_305
.p2align 6
.gm_207:
    s_waitcnt vmcnt(3)
    v_cmp_eq_u32 vcc, -1, v27
    s_cbranch_vccnz .nk_322
.ok_323:
    v_smfmac_f32_16x16x64_bf16 v[64:67], v[24:27], a[192:199], v2
    s_waitcnt vmcnt(2)
    v_cmp_eq_u32 vcc, -1, v31
    v_smfmac_f32_16x16x64_bf16 v[68:71], v[24:27], a[224:231], v2
    s_cbranch_vccnz .nk_324
.ok_325:
    v_smfmac_f32_16x16x64_bf16 v[64:67], v[28:31], a[200:207], v2
    s_waitcnt vmcnt(1)
    v_cmp_eq_u32 vcc, -1, v35
    v_smfmac_f32_16x16x64_bf16 v[68:71], v[28:31], a[232:239], v2
    s_cbranch_vccnz .nk_326
.ok_327:
    v_smfmac_f32_16x16x64_bf16 v[64:67], v[32:35], a[208:215], v2
    s_waitcnt vmcnt(0)
    v_cmp_eq_u32 vcc, -1, v39
    v_smfmac_f32_16x16x64_bf16 v[68:71], v[32:35], a[240:247], v2
    s_cbranch_vccnz .nk_328
.ok_329:
    v_smfmac_f32_16x16x64_bf16 v[64:67], v[36:39], a[216:223], v2
    v_smfmac_f32_16x16x64_bf16 v[68:71], v[36:39], a[248:255], v2
    s_setpc_b64 s[98:99]
.nk_322:
    buffer_load_dwordx4 v[24:27], v4, s[8:11], s30 offen offset:0 sc1
    s_add_u32 s62, s62, 1
    s_cmp_gt_u32 s62, 0x100000
    s_cbranch_scc1 .mg_end_1
    s_waitcnt vmcnt(3)
    v_cmp_eq_u32 vcc, -1, v31
    s_cbranch_vccnz .nk_330
.ok_331:
    v_smfmac_f32_16x16x64_bf16 v[64:67], v[28:31], a[200:207], v2
    s_waitcnt vmcnt(2)
    v_cmp_eq_u32 vcc, -1, v35
    v_smfmac_f32_16x16x64_bf16 v[68:71], v[28:31], a[232:239], v2
    s_cbranch_vccnz .nk_332
.ok_333:
    v_smfmac_f32_16x16x64_bf16 v[64:67], v[32:35], a[208:215], v2
    s_waitcnt vmcnt(1)
    v_cmp_eq_u32 vcc, -1, v39
    v_smfmac_f32_16x16x64_bf16 v[68:71], v[32:35], a[240:247], v2
    s_cbranch_vccnz .nk_334
.ok_335:
    v_smfmac_f32_16x16x64_bf16 v[64:67], v[36:39], a[216:223], v2
    s_waitcnt vmcnt(0)
    v_cmp_eq_u32 vcc, -1, v27
    v_smfmac_f32_16x16x64_bf16 v[68:71], v[36:39], a[248:255], v2
    s_cbranch_vccnz .nk_336
.ok_337:
    v_smfmac_f32_16x16x64_bf16 v[64:67], v[24:27], a[192:199], v2
    v_smfmac_f32_16x16x64_bf16 v[68:71], v[24:27], a[224:231], v2
    s_setpc_b64 s[98:99]
.nk_324:
    buffer_load_dwordx4 v[28:31], v4, s[8:11], s30 offen offset:1024 sc1
    s_add_u32 s62, s62, 1
    s_cmp_gt_u32 s62, 0x100000
    s_cbranch_scc1 .mg_end_1
    s_waitcnt vmcnt(2)
    v_cmp_eq_u32 vcc, -1, v35
    s_cbranch_vccnz .nk_338
.ok_339:
    v_smfmac_f32_16x16x64_bf16 v[64:67], v[32:35], a[208:215], v2
    s_waitcnt vmcnt(1)
    v_cmp_eq_u32 vcc, -1, v39
    v_smfmac_f32_16x16x64_bf16 v[68:71], v[32:35], a[240:247], v2
    s_cbranch_vccnz .nk_340
.ok_341:
    v_smfmac_f32_16x16x64_bf16 v[64:67], v[36:39], a[216:223], v2
    s_waitcnt vmcnt(0)
    v_cmp_eq_u32 vcc, -1, v31
    v_smfmac_f32_16x16x64_bf16 v[68:71], v[36:39], a[248:255], v2
    s_cbranch_vccnz .nk_342
.ok_343:
    v_smfmac_f32_16x16x64_bf16 v[64:67], v[28:31], a[200:207], v2
    v_smfmac_f32_16x16x64_bf16 v[68:71], v[28:31], a[232:239], v2
    s_setpc_b64 s[98:99]
.nk_326:
    buffer_load_dwordx4 v[32:35], v4, s[8:11], s30 offen offset:2048 sc1
    s_add_u32 s62, s62, 1
    s_cmp_gt_u32 s62, 0x100000
    s_cbranch_scc1 .mg_end_1
    s_waitcnt vmcnt(1)
    v_cmp_eq_u32 vcc, -1, v39
    s_cbranch_vccnz .nk_344
.ok_345:
    v_smfmac_f32_16x16x64_bf16 v[64:67], v[36:39], a[216:223], v2
    s_waitcnt vmcnt(0)
    v_cmp_eq_u32 vcc, -1, v35
    v_smfmac_f32_16x16x64_bf16 v[68:71], v[36:39], a[248:255], v2
    s_cbranch_vccnz .nk_346
.ok_347:
    v_smfmac_f32_16x16x64_bf16 v[64:67], v[32:35], a[208:215], v2
    v_smfmac_f32_16x16x64_bf16 v[68:71], v[32:35], a[240:247], v2
    s_setpc_b64 s[98:99]
.nk_328:
    buffer_load_dwordx4 v[36:39], v4, s[8:11], s30 offen offset:3072 sc1
    s_add_u32 s62, s62, 1
    s_cmp_gt_u32 s62, 0x100000
    s_cbranch_scc1 .mg_end_1
    s_waitcnt vmcnt(0)
    v_cmp_eq_u32 vcc, -1, v39
    s_cbranch_vccnz .nk_328
    s_branch .ok_329
.nk_330:
    buffer_load_dwordx4 v[28:31], v4, s[8:11], s30 offen offset:1024 sc1
    s_add_u32 s62, s62, 1
    s_cmp_gt_u32 s62, 0x100000
    s_cbranch_scc1 .mg_end_1
    s_waitcnt vmcnt(3)
    v_cmp_eq_u32 vcc, -1, v35
    s_cbranch_vccnz .nk_348
.ok_349:
    v_smfmac_f32_16x16x64_bf16 v[64:67], v[32:35], a[208:215], v2
    s_waitcnt vmcnt(2)
    v_cmp_eq_u32 vcc, -1, v39
    v_smfmac_f32_16x16x64_bf16 v[68:71], v[32:35], a[240:247], v2
    s_cbranch_vccnz .nk_350
.ok_351:
    v_smfmac_f32_16x16x64_bf16 v[64:67], v[36:39], a[216:223], v2
    s_waitcnt vmcnt(1)
    v_cmp_eq_u32 vcc, -1, v27
    v_smfmac_f32_16x16x64_bf16 v[68:71], v[36:39], a[248:255], v2
    s_cbranch_vccnz .nk_352
.ok_353:
    v_smfmac_f32_16x16x64_bf16 v[64:67], v[24:27], a[192:199], v2
    s_waitcnt vmcnt(0)
    v_cmp_eq_u32 vcc, -1, v31
    v_smfmac_f32_16x16x64_bf16 v[68:71], v[24:27], a[224:231], v2
    s_cbranch_vccnz .nk_342
    s_branch .ok_343
.nk_332:
    buffer_load_dwordx4 v[32:35], v4, s[8:11], s30 offen offset:2048 sc1
    s_add_u32 s62, s62, 1
    s_cmp_gt_u32 s62, 0x100000
    s_cbranch_scc1 .mg_end_1
    s_waitcnt vmcnt(2)
    v_cmp_eq_u32 vcc, -1, v39
    s_cbranch_vccnz .nk_354
.ok_355:
    v_smfmac_f32_16x16x64_bf16 v[64:67], v[36:39], a[216:223], v2
    s_waitcnt vmcnt(1)
    v_cmp_eq_u32 vcc, -1, v27
    v_smfmac_f32_16x16x64_bf16 v[68:71], v[36:39], a[248:255], v2
    s_cbranch_vccnz .nk_356
.ok_357:
    v_smfmac_f32_16x16x64_bf16 v[64:67], v[24:27], a[192:199], v2
    s_waitcnt vmcnt(0)
    v_cmp_eq_u32 vcc, -1, v35
    v_smfmac_f32_16x16x64_bf16 v[68:71], v[24:27], a[224:231], v2
    s_cbranch_vccnz .nk_346
    s_branch .ok_347
.nk_334:
    buffer_load_dwordx4 v[36:39], v4, s[8:11], s30 offen offset:3072 sc1
    s_add_u32 s62, s62, 1
    s_cmp_gt_u32 s62, 0x100000
    s_cbranch_scc1 .mg_end_1
    s_waitcnt vmcnt(1)
    v_cmp_eq_u32 vcc, -1, v27
    s_cbranch_vccnz .nk_358
.ok_359:
    v_smfmac_f32_16x16x64_bf16 v[64:67], v[24:27], a[192:199], v2
    s_waitcnt vmcnt(0)
    v_cmp_eq_u32 vcc, -1, v39
    v_smfmac_f32_16x16x64_bf16 v[68:71], v[24:27], a[224:231], v2
    s_cbranch_vccnz .nk_328
    s_branch .ok_329
.nk_336:
    buffer_load_dwordx4 v[24:27], v4, s[8:11], s30 offen offset:0 sc1
    s_add_u32 s62, s62, 1
    s_cmp_gt_u32 s62, 0x100000
    s_cbranch_scc1 .mg_end_1
    s_waitcnt vmcnt(0)
    v_cmp_eq_u32 vcc, -1, v27
    s_cbranch_vccnz .nk_336
    s_branch .ok_337
.nk_338:
    buffer_load_dwordx4 v[32:35], v4, s[8:11], s30 offen offset:2048 sc1
    s_add_u32 s62, s62, 1
    s_cmp_gt_u32 s62, 0x100000
    s_cbranch_scc1 .mg_end_1
    s_waitcnt vmcnt(2)
    v_cmp_eq_u32 vcc, -1, v39
    s_cbranch_vccnz .nk_360
.ok_361:
    v_smfmac_f32_16x16x64_bf16 v[64:67], v[36:39], a[216:223], v2
    s_waitcnt vmcnt(1)
    v_cmp_eq_u32 vcc, -1, v31
    v_smfmac_f32_16x16x64_bf16 v[68:71], v[36:39], a[248:255], v2
    s_cbranch_vccnz .nk_362
.ok_363:
    v_smfmac_f32_16x16x64_bf16 v[64:67], v[28:31], a[200:207], v2
    s_waitcnt vmcnt(0)
    v_cmp_eq_u32 vcc, -1, v35
    v_smfmac_f32_16x16x64_bf16 v[68:71], v[28:31], a[232:239], v2
    s_cbranch_vccnz .nk_346
    s_branch .ok_347
.nk_340:
    buffer_load_dwordx4 v[36:39], v4, s[8:11], s30 offen offset:3072 sc1
    s_add_u32 s62, s62, 1
    s_cmp_gt_u32 s62, 0x100000
    s_cbranch_scc1 .mg_end_1
    s_waitcnt vmcnt(1)
    v_cmp_eq_u32 vcc, -1, v31
    s_cbranch_vccnz .nk_364
.ok_365:
    v_smfmac_f32_16x16x64_bf16 v[64:67], v[28:31], a[200:207], v2
    s_waitcnt vmcnt(0)
    v_cmp_eq_u32 vcc, -1, v39
    v_smfmac_f32_16x16x64_bf16 v[68:71], v[28:31], a[232:239], v2
    s_cbranch_vccnz .nk_328
    s_branch .ok_329
.nk_342:
    buffer_load_dwordx4 v[28:31], v4, s[8:11], s30 offen offset:1024 sc1
    s_add_u32 s62, s62, 1
    s_cmp_gt_u32 s62, 0x100000
    s_cbranch_scc1 .mg_end_1
    s_waitcnt vmcnt(0)
    v_cmp_eq_u32 vcc, -1, v31
    s_cbranch_vccnz .nk_342
    s_branch .ok_343
.nk_344:
    buffer_load_dwordx4 v[36:39], v4, s[8:11], s30 offen offset:3072 sc1
    s_add_u32 s62, s62, 1
    s_cmp_gt_u32 s62, 0x100000
    s_cbranch_scc1 .mg_end_1
    s_waitcnt vmcnt(1)
    v_cmp_eq_u32 vcc, -1, v35
    s_cbranch_vccnz .nk_326
    s_branch .ok_327
.nk_346:
    buffer_load_dwordx4 v[32:35], v4, s[8:11], s30 offen offset:2048 sc1
    s_add_u32 s62, s62, 1
    s_cmp_gt_u32 s62, 0x100000
    s_cbranch_scc1 .mg_end_1
    s_waitcnt vmcnt(0)
    v_cmp_eq_u32 vcc, -1, v35
    s_cbranch_vccnz .nk_346
    s_branch .ok_347
.nk_348:
    buffer_load_dwordx4 v[32:35], v4, s[8:11], s30 offen offset:2048 sc1
    s_add_u32 s62, s62, 1
    s_cmp_gt_u32 s62, 0x100000
    s_cbranch_scc1 .mg_end_1
    s_waitcnt vmcnt(3)
    v_cmp_eq_u32 vcc, -1, v39
    s_cbranch_vccnz .nk_366
.ok_367:
    v_smfmac_f32_16x16x64_bf16 v[64:67], v[36:39], a[216:223], v2
    s_waitcnt vmcnt(2)
    v_cmp_eq_u32 vcc, -1, v27
    v_smfmac_f32_16x16x64_bf16 v[68:71], v[36:39], a[248:255], v2
    s_cbranch_vccnz .nk_368
.ok_369:
    v_smfmac_f32_16x16x64_bf16 v[64:67], v[24:27], a[192:199], v2
    s_waitcnt vmcnt(1)
    v_cmp_eq_u32 vcc, -1, v31
    v_smfmac_f32_16x16x64_bf16 v[68:71], v[24:27], a[224:231], v2
    s_cbranch_vccnz .nk_362
    s_branch .ok_363
.nk_350:
    buffer_load_dwordx4 v[36:39], v4, s[8:11], s30 offen offset:3072 sc1
    s_add_u32 s62, s62, 1
    s_cmp_gt_u32 s62, 0x100000
    s_cbranch_scc1 .mg_end_1
    s_waitcnt vmcnt(2)
    v_cmp_eq_u32 vcc, -1, v27
    s_cbranch_vccnz .nk_370
.ok_371:
    v_smfmac_f32_16x16x64_bf16 v[64:67], v[24:27], a[192:199], v2
    s_waitcnt vmcnt(1)
    v_cmp_eq_u32 vcc, -1, v31
    v_smfmac_f32_16x16x64_bf16 v[68:71], v[24:27], a[224:231], v2
    s_cbranch_vccnz .nk_364
    s_branch .ok_365
.nk_352:
    buffer_load_dwordx4 v[24:27], v4, s[8:11], s30 offen offset:0 sc1
    s_add_u32 s62, s62, 1
    s_cmp_gt_u32 s62, 0x100000
    s_cbranch_scc1 .mg_end_1
    s_waitcnt vmcnt(1)
    v_cmp_eq_u32 vcc, -1, v31
    s_cbranch_vccnz .nk_372
.ok_373:
    v_smfmac_f32_16x16x64_bf16 v[64:67], v[28:31], a[200:207], v2
    s_waitcnt vmcnt(0)
    v_cmp_eq_u32 vcc, -1, v27
    v_smfmac_f32_16x16x64_bf16 v[68:71], v[28:31], a[232:239], v2
    s_cbranch_vccnz .nk_336
    s_branch .ok_337
.nk_354:
    buffer_load_dwordx4 v[36:39], v4, s[8:11], s30 offen offset:3072 sc1
    s_add_u32 s62, s62, 1
    s_cmp_gt_u32 s62, 0x100000
    s_cbranch_scc1 .mg_end_1
    s_waitcnt vmcnt(2)
    v_cmp_eq_u32 vcc, -1, v27
    s_cbranch_vccnz .nk_374
.ok_375:
    v_smfmac_f32_16x16x64_bf16 v[64:67], v[24:27], a[192:199], v2
    s_waitcnt vmcnt(1)
    v_cmp_eq_u32 vcc, -1, v35
    v_smfmac_f32_16x16x64_bf16 v[68:71], v[24:27], a[224:231], v2
    s_cbranch_vccnz .nk_326
    s_branch .ok_327
.nk_356:
    buffer_load_dwordx4 v[24:27], v4, s[8:11], s30 offen offset:0 sc1
    s_add_u32 s62, s62, 1
    s_cmp_gt_u32 s62, 0x100000
    s_cbranch_scc1 .mg_end_1
    s_waitcnt vmcnt(1)
    v_cmp_eq_u32 vcc, -1, v35
    s_cbranch_vccnz .nk_376
.ok_377:
    v_smfmac_f32_16x16x64_bf16 v[64:67], v[32:35], a[208:215], v2
    s_waitcnt vmcnt(0)
    v_cmp_eq_u32 vcc, -1, v27
    v_smfmac_f32_16x16x64_bf16 v[68:71], v[32:35], a[240:247], v2
    s_cbranch_vccnz .nk_336
    s_branch .ok_337
.nk_358:
    buffer_load_dwordx4 v[24:27], v4, s[8:11], s30 offen offset:0 sc1
    s_add_u32 s62, s62, 1
    s_cmp_gt_u32 s62, 0x100000
    s_cbranch_scc1 .mg_end_1
    s_waitcnt vmcnt(1)
    v_cmp_eq_u32 vcc, -1, v39
    s_cbranch_vccnz .nk_334
    s_branch .ok_335
.nk_360:
    buffer_load_dwordx4 v[36:39], v4, s[8:11], s30 offen offset:3072 sc1
    s_add_u32 s62, s62, 1
    s_cmp_gt_u32 s62, 0x100000
    s_cbranch_scc1 .mg_end_1
    s_waitcnt vmcnt(2)
    v_cmp_eq_u32 vcc, -1, v31
    s_cbranch_vccnz .nk_324
    s_branch .ok_325
.nk_362:
    buffer_load_dwordx4 v[28:31], v4, s[8:11], s30 offen offset:1024 sc1
    s_add_u32 s62, s62, 1
    s_cmp_gt_u32 s62, 0x100000
    s_cbranch_scc1 .mg_end_1
    s_waitcnt vmcnt(1)
    v_cmp_eq_u32 vcc, -1, v35
    s_cbranch_vccnz .nk_378
.ok_379:
    v_smfmac_f32_16x16x64_bf16 v[64:67], v[32:35], a[208:215], v2
    s_waitcnt vmcnt(0)
    v_cmp_eq_u32 vcc, -1, v31
    v_smfmac_f32_16x16x64_bf16 v[68:71], v[32:35], a[240:247], v2
    s_cbranch_vccnz .nk_342
    s_branch .ok_343
.nk_364:
    buffer_load_dwordx4 v[28:31], v4, s[8:11], s30 offen offset:1024 sc1
    s_add_u32 s62, s62, 1
    s_cmp_gt_u32 s62, 0x100000
    s_cbranch_scc1 .mg_end_1
    s_waitcnt vmcnt(1)
    v_cmp_eq_u32 vcc, -1, v39
    s_cbranch_vccnz .nk_340
    s_branch .ok_341
.nk_366:
    buffer_load_dwordx4 v[36:39], v4, s[8:11], s30 offen offset:3072 sc1
    s_add_u32 s62, s62, 1
    s_cmp_gt_u32 s62, 0x100000
    s_cbranch_scc1 .mg_end_1
    s_waitcnt vmcnt(3)
    v_cmp_eq_u32 vcc, -1, v27
    s_cbranch_vccnz .nk_322
    s_branch .ok_323
.nk_368:
    buffer_load_dwordx4 v[24:27], v4, s[8:11], s30 offen offset:0 sc1
    s_add_u32 s62, s62, 1
    s_cmp_gt_u32 s62, 0x100000
    s_cbranch_scc1 .mg_end_1
    s_waitcnt vmcnt(2)
    v_cmp_eq_u32 vcc, -1, v31
    s_cbranch_vccnz .nk_380
.ok_381:
    v_smfmac_f32_16x16x64_bf16 v[64:67], v[28:31], a[200:207], v2
    s_waitcnt vmcnt(1)
    v_cmp_eq_u32 vcc, -1, v35
    v_smfmac_f32_16x16x64_bf16 v[68:71], v[28:31], a[232:239], v2
    s_cbranch_vccnz .nk_376
    s_branch .ok_377
.nk_370:
    buffer_load_dwordx4 v[24:27], v4, s[8:11], s30 offen offset:0 sc1
    s_add_u32 s62, s62, 1
    s_cmp_gt_u32 s62, 0x100000
    s_cbranch_scc1 .mg_end_1
    s_waitcnt vmcnt(2)
    v_cmp_eq_u32 vcc, -1, v31
    s_cbranch_vccnz .nk_382
.ok_383:
    v_smfmac_f32_16x16x64_bf16 v[64:67], v[28:31], a[200:207], v2
    s_waitcnt vmcnt(1)
    v_cmp_eq_u32 vcc, -1, v39
    v_smfmac_f32_16x16x64_bf16 v[68:71], v[28:31], a[232:239], v2
    s_cbranch_vccnz .nk_334
    s_branch .ok_335
.nk_372:
    buffer_load_dwordx4 v[28:31], v4, s[8:11], s30 offen offset:1024 sc1
    s_add_u32 s62, s62, 1
    s_cmp_gt_u32 s62, 0x100000
    s_cbranch_scc1 .mg_end_1
    s_waitcnt vmcnt(1)
    v_cmp_eq_u32 vcc, -1, v27
    s_cbranch_vccnz .nk_352
    s_branch .ok_353
.nk_374:
    buffer_load_dwordx4 v[24:27], v4, s[8:11], s30 offen offset:0 sc1
    s_add_u32 s62, s62, 1
    s_cmp_gt_u32 s62, 0x100000
    s_cbranch_scc1 .mg_end_1
    s_waitcnt vmcnt(2)
    v_cmp_eq_u32 vcc, -1, v35
    s_cbranch_vccnz .nk_332
    s_branch .ok_333
.nk_376:
    buffer_load_dwordx4 v[32:35], v4, s[8:11], s30 offen offset:2048 sc1
    s_add_u32 s62, s62, 1
    s_cmp_gt_u32 s62, 0x100000
    s_cbranch_scc1 .mg_end_1
    s_waitcnt vmcnt(1)
    v_cmp_eq_u32 vcc, -1, v27
    s_cbranch_vccnz .nk_356
    s_branch .ok_357
.nk_378:
    buffer_load_dwordx4 v[32:35], v4, s[8:11], s30 offen offset:2048 sc1
    s_add_u32 s62, s62, 1
    s_cmp_gt_u32 s62, 0x100000
    s_cbranch_scc1 .mg_end_1
    s_waitcnt vmcnt(1)
    v_cmp_eq_u32 vcc, -1, v31
    s_cbranch_vccnz .nk_362
    s_branch .ok_363
.nk_380:
    buffer_load_dwordx4 v[28:31], v4, s[8:11], s30 offen offset:1024 sc1
    s_add_u32 s62, s62, 1
    s_cmp_gt_u32 s62, 0x100000
    s_cbranch_scc1 .mg_end_1
    s_waitcnt vmcnt(2)
    v_cmp_eq_u32 vcc, -1, v35
    s_cbranch_vccnz .nk_384
.ok_385:
    v_smfmac_f32_16x16x64_bf16 v[64:67], v[32:35], a[208:215], v2
    s_waitcnt vmcnt(1)
    v_cmp_eq_u32 vcc, -1, v27
    v_smfmac_f32_16x16x64_bf16 v[68:71], v[32:35], a[240:247], v2
    s_cbranch_vccnz .nk_352
    s_branch .ok_353
.nk_382:
    buffer_load_dwordx4 v[28:31], v4, s[8:11], s30 offen offset:1024 sc1
    s_add_u32 s62, s62, 1
    s_cmp_gt_u32 s62, 0x100000
    s_cbranch_scc1 .mg_end_1
    s_waitcnt vmcnt(2)
    v_cmp_eq_u32 vcc, -1, v39
    s_cbranch_vccnz .nk_350
    s_branch .ok_351
.nk_384:
    buffer_load_dwordx4 v[32:35], v4, s[8:11], s30 offen offset:2048 sc1
    s_add_u32 s62, s62, 1
    s_cmp_gt_u32 s62, 0x100000
    s_cbranch_scc1 .mg_end_1
    s_waitcnt vmcnt(2)
    v_cmp_eq_u32 vcc, -1, v27
    s_cbranch_vccnz .nk_368
    s_branch .ok_369
.mg_bg_2:
    s_lshr_b32 s98, s26, 3
    s_add_u32 s98, s98, 1
    s_and_b32 s98, s98, 3
    s_and_b32 s99, s25, 3
    s_lshl_b32 s99, s99, 3
    s_and_b32 s4, s26, 7
    s_add_u32 s99, s99, s4
    s_mov_b32 s96, 0
    v_and_b32 v1, 63, v0
    v_mov_b32 v250, 0
    v_mov_b32 v251, 0
    s_bitcmp0_b32 s26, 4
    s_cbranch_scc1 .qkv_387
    s_bfe_u32 s95, s26, 0x10003
    s_load_dwordx2 s[40:41], s[0:1], 0
    s_lshl_b32 s4, s95, 3
    s_add_u32 s4, s4, 72
    s_load_dwordx2 s[42:43], s[0:1], s4
    s_lshl_b32 s4, s99, 8
    s_lshl_b32 s6, s24, 14
    s_mul_i32 s5, s24, 524288
    s_add_u32 s4, s4, s5
    v_bfe_u32 v2, v1, 4, 1
    v_lshlrev_b32 v2, 2, v2
    v_and_b32 v3, 7, v1
    v_xor_b32 v2, v2, v3
    v_lshlrev_b32 v2, 4, v2
    v_bfe_u32 v254, v1, 3, 2
    v_mul_u32_u24 v240, 8192, v254
    v_bfe_u32 v254, v1, 5, 1
    v_mul_u32_u24 v254, 128, v254
    v_add_u32 v240, v240, v254
    v_add_u32 v240, s4, v240
    v_add_u32 v240, v2, v240
    s_lshr_b32 s5, s24, 1
    s_lshl_b32 s5, s5, 9
    v_bfe_u32 v2, v1, 3, 1
    v_xor_b32 v2, s24, v2
    v_and_b32 v2, 1, v2
    v_lshlrev_b32 v2, 6, v2
    v_bfe_u32 v254, v1, 4, 2
    v_mul_u32_u24 v242, 2048, v254
    v_bfe_u32 v254, v1, 2, 2
    v_mul_u32_u24 v254, 128, v254
    v_add_u32 v242, v242, v254
    v_bfe_u32 v254, v1, 0, 2
    v_mul_u32_u24 v254, 16, v254
    v_add_u32 v242, v242, v254
    v_add_u32 v242, s5, v242
    v_add_u32 v242, v2, v242
    v_add_u32 v243, 0x10000, v242
    s_waitcnt lgkmcnt(0)
    s_mov_b32 s16, s42
    s_and_b32 s17, s43, 0xffff
    s_mov_b32 s18, 0x800000
    s_mov_b32 s19, 0x00020000
    s_add_u32 m0, s6, 0
    s_mov_b32 s5, 4194304
    buffer_load_dwordx4 v240, s[16:19], s5 offen  lds
    s_add_u32 m0, s6, 1024
    s_mov_b32 s5, 4227072
    buffer_load_dwordx4 v240, s[16:19], s5 offen  lds
    s_add_u32 m0, s6, 2048
    s_mov_b32 s5, 4259840
    buffer_load_dwordx4 v240, s[16:19], s5 offen  lds
    s_add_u32 m0, s6, 3072
    s_mov_b32 s5, 4292608
    buffer_load_dwordx4 v240, s[16:19], s5 offen  lds
    s_add_u32 m0, s6, 4096
    s_mov_b32 s5, 4325376
    buffer_load_dwordx4 v240, s[16:19], s5 offen  lds
    s_add_u32 m0, s6, 5120
    s_mov_b32 s5, 4358144
    buffer_load_dwordx4 v240, s[16:19], s5 offen  lds
    s_add_u32 m0, s6, 6144
    s_mov_b32 s5, 4390912
    buffer_load_dwordx4 v240, s[16:19], s5 offen  lds
    s_add_u32 m0, s6, 7168
    s_mov_b32 s5, 4423680
    buffer_load_dwordx4 v240, s[16:19], s5 offen  lds
    s_add_u32 m0, s6, 8192
    s_mov_b32 s5, 4456448
    buffer_load_dwordx4 v240, s[16:19], s5 offen  lds
    s_add_u32 m0, s6, 9216
    s_mov_b32 s5, 4489216
    buffer_load_dwordx4 v240, s[16:19], s5 offen  lds
    s_add_u32 m0, s6, 10240
    s_mov_b32 s5, 4521984
    buffer_load_dwordx4 v240, s[16:19], s5 offen  lds
    s_add_u32 m0, s6, 11264
    s_mov_b32 s5, 4554752
    buffer_load_dwordx4 v240, s[16:19], s5 offen  lds
    s_add_u32 m0, s6, 12288
    s_mov_b32 s5, 4587520
    buffer_load_dwordx4 v240, s[16:19], s5 offen  lds
    s_add_u32 m0, s6, 13312
    s_mov_b32 s5, 4620288
    buffer_load_dwordx4 v240, s[16:19], s5 offen  lds
    s_add_u32 m0, s6, 14336
    s_mov_b32 s5, 4653056
    buffer_load_dwordx4 v240, s[16:19], s5 offen  lds
    s_add_u32 m0, s6, 15360
    s_mov_b32 s5, 4685824
    buffer_load_dwordx4 v240, s[16:19], s5 offen  lds
    s_waitcnt vmcnt(16)
    s_barrier
    s_cmp_lg_u32 s24, 1
    s_cbranch_scc1 .ns_388
    s_mov_b64 exec, 1
    v_mov_b32 v238, s3
    v_mov_b32 v239, 0
    buffer_atomic_add v238, v239, s[20:23], 0 offen offset:196 sc1
    s_mov_b64 exec, -1
.ns_388:
    s_and_b32 s4, s26, 15
    s_lshl_b32 s4, s4, 2
    s_add_u32 s4, s4, s24
    s_lshl_b32 s5, s4, 13
    v_lshlrev_b32 v6, 7, v1
    s_waitcnt lgkmcnt(0)
    s_mov_b32 s12, s40
    s_and_b32 s13, s41, 0xffff
    s_mov_b32 s14, 0x400000
    s_mov_b32 s15, 0x00020000
    buffer_load_dword v7, v6, s[12:15], s5 offen
    s_and_b32 s5, s25, 3
    s_lshl_b32 s5, s5, 6
    s_add_u32 s4, s4, s5
    s_lshl_b32 s4, s4, 14
    s_add_u32 s4, s4, 0x80000
    v_add_u32 v6, s4, v6
    v_add_u32 v8, 0x2000, v6
    s_add_u32 m0, s6, 65536
    s_mov_b32 s5, 6291456
    buffer_load_dwordx4 v240, s[16:19], s5 offen  lds
    s_add_u32 m0, s6, 66560
    s_mov_b32 s5, 6324224
    buffer_load_dwordx4 v240, s[16:19], s5 offen  lds
    s_add_u32 m0, s6, 67584
    s_mov_b32 s5, 6356992
    buffer_load_dwordx4 v240, s[16:19], s5 offen  lds
    s_add_u32 m0, s6, 68608
    s_mov_b32 s5, 6389760
    buffer_load_dwordx4 v240, s[16:19], s5 offen  lds
    s_add_u32 m0, s6, 69632
    s_mov_b32 s5, 6422528
    buffer_load_dwordx4 v240, s[16:19], s5 offen  lds
    s_add_u32 m0, s6, 70656
    s_mov_b32 s5, 6455296
    buffer_load_dwordx4 v240, s[16:19], s5 offen  lds
    s_add_u32 m0, s6, 71680
    s_mov_b32 s5, 6488064
    buffer_load_dwordx4 v240, s[16:19], s5 offen  lds
    s_add_u32 m0, s6, 72704
    s_mov_b32 s5, 6520832
    buffer_load_dwordx4 v240, s[16:19], s5 offen  lds
    s_add_u32 m0, s6, 73728
    s_mov_b32 s5, 6553600
    buffer_load_dwordx4 v240, s[16:19], s5 offen  lds
    s_add_u32 m0, s6, 74752
    s_mov_b32 s5, 6586368
    buffer_load_dwordx4 v240, s[16:19], s5 offen  lds
    s_add_u32 m0, s6, 75776
    s_mov_b32 s5, 6619136
    buffer_load_dwordx4 v240, s[16:19], s5 offen  lds
    s_add_u32 m0, s6, 76800
    s_mov_b32 s5, 6651904
    buffer_load_dwordx4 v240, s[16:19], s5 offen  lds
    s_add_u32 m0, s6, 77824
    s_mov_b32 s5, 6684672
    buffer_load_dwordx4 v240, s[16:19], s5 offen  lds
    s_add_u32 m0, s6, 78848
    s_mov_b32 s5, 6717440
    buffer_load_dwordx4 v240, s[16:19], s5 offen  lds
    s_add_u32 m0, s6, 79872
    s_mov_b32 s5, 6750208
    buffer_load_dwordx4 v240, s[16:19], s5 offen  lds
    s_add_u32 m0, s6, 80896
    s_mov_b32 s5, 6782976
    buffer_load_dwordx4 v240, s[16:19], s5 offen  lds
    s_cmp_lg_u32 s24, 0
    s_cbranch_scc1 .aw_389
    s_mov_b32 s62, 0
.aw_390:
    s_sleep 64
    s_add_u32 s62, s62, 1
    s_cmp_gt_u32 s62, 0x200000
    s_cbranch_scc1 .mg_end_1
    v_or_b32 v239, 32, v1
    v_lshlrev_b32 v239, 2, v239
    buffer_load_dword v238, v239, s[20:23], 0 offen sc1
    s_waitcnt vmcnt(0)
    v_readlane_b32 s4, v238, 49
    s_and_b32 s5, s4, 0xffff
    s_cmp_lt_u32 s5, 256
    s_cbranch_scc1 .aw_390
    s_lshr_b32 s4, s4, 16
    s_cbranch_scc1 .aw_389
    s_and_b32 s4, s99, 30
    s_lshl_b32 s4, s4, 9
    s_lshl_b32 s5, s95, 14
    s_add_u32 s4, s4, s5
    s_and_b32 s5, s99, 1
    s_lshl_b32 s5, s5, 7
    s_add_u32 s4, s4, s5
    s_lshl_b32 s4, s99, 9
    s_add_u32 s4, s4, 92291072
    v_mov_b32 v5, 0
    s_mov_b32 s62, 0
.aw_391:
    buffer_load_dword v4, v5, s[8:11], s4 offen sc1
    s_add_u32 s62, s62, 1
    s_cmp_gt_u32 s62, 0x200000
    s_cbranch_scc1 .mg_end_1
    s_waitcnt vmcnt(0)
    v_readfirstlane_b32 s5, v4
    s_cmp_ge_u32 s5, 3
    s_cbranch_scc1 .aw_389
    s_sleep 16
    s_branch .aw_391
.aw_389:
    s_barrier
    v_or_b32 v239, 32, v1
    v_lshlrev_b32 v239, 2, v239
    buffer_load_dword v238, v239, s[20:23], 0 offen sc1
    s_waitcnt vmcnt(0)
    s_cmp_lg_u32 s27, 0
    s_cbranch_scc1 .vd_393
    s_mov_b32 s62, 0
.vp_392:
    v_readlane_b32 s4, v238, 49
    s_and_b32 s5, s4, 0xffff
    s_cmp_ge_u32 s5, 256
    s_cbranch_scc1 .va_394
    s_add_u32 s62, s62, 1
    s_cmp_gt_u32 s62, 0x100000
    s_cbranch_scc1 .mg_end_1
    s_sleep 16
    buffer_load_dword v238, v239, s[20:23], 0 offen sc1
    s_waitcnt vmcnt(0)
    s_branch .vp_392
.va_394:
    s_lshr_b32 s4, s4, 16
    s_cbranch_scc0 .vd_393
    s_lshr_b32 s25, s2, 5
    s_and_b32 s26, s2, 31
    s_mov_b32 s27, 1
    s_waitcnt vmcnt(0) lgkmcnt(0)
    s_barrier
    s_branch .mg_role_3
.vd_393:
    s_cmp_eq_u32 s98, 3
    s_cbranch_scc1 .ph2_386
.qkv_387:
    s_lshl_b32 s4, s98, 3
    s_add_u32 s4, s4, 64
    s_load_dwordx2 s[40:41], s[0:1], 0
    s_load_dwordx2 s[42:43], s[0:1], s4
    s_lshl_b32 s4, s99, 8
    s_lshl_b32 s6, s24, 14
    s_mul_i32 s5, s24, 524288
    s_add_u32 s4, s4, s5
    v_bfe_u32 v2, v1, 4, 1
    v_lshlrev_b32 v2, 2, v2
    v_and_b32 v3, 7, v1
    v_xor_b32 v2, v2, v3
    v_lshlrev_b32 v2, 4, v2
    v_bfe_u32 v254, v1, 3, 2
    v_mul_u32_u24 v240, 8192, v254
    v_bfe_u32 v254, v1, 5, 1
    v_mul_u32_u24 v254, 128, v254
    v_add_u32 v240, v240, v254
    v_add_u32 v240, s4, v240
    v_add_u32 v240, v2, v240
    s_lshr_b32 s5, s24, 1
    s_lshl_b32 s5, s5, 9
    v_bfe_u32 v2, v1, 3, 1
    v_xor_b32 v2, s24, v2
    v_and_b32 v2, 1, v2
    v_lshlrev_b32 v2, 6, v2
    v_bfe_u32 v254, v1, 4, 2
    v_mul_u32_u24 v242, 2048, v254
    v_bfe_u32 v254, v1, 2, 2
    v_mul_u32_u24 v254, 128, v254
    v_add_u32 v242, v242, v254
    v_bfe_u32 v254, v1, 0, 2
    v_mul_u32_u24 v254, 16, v254
    v_add_u32 v242, v242, v254
    v_add_u32 v242, s5, v242
    v_add_u32 v242, v2, v242
    v_add_u32 v243, 0x10000, v242
    s_waitcnt lgkmcnt(0)
    s_mov_b32 s12, s40
    s_and_b32 s13, s41, 0xffff
    s_mov_b32 s14, 0x400000
    s_mov_b32 s15, 0x00020000
    s_mov_b32 s16, s42
    s_and_b32 s17, s43, 0xffff
    s_mov_b32 s18, 0x800000
    s_mov_b32 s19, 0x00020000
    s_add_u32 m0, s6, 0
    s_mov_b32 s5, 0
    buffer_load_dwordx4 v240, s[16:19], s5 offen nt lds
    s_add_u32 m0, s6, 1024
    s_mov_b32 s5, 32768
    buffer_load_dwordx4 v240, s[16:19], s5 offen nt lds
    s_add_u32 m0, s6, 2048
    s_mov_b32 s5, 65536
    buffer_load_dwordx4 v240, s[16:19], s5 offen nt lds
    s_add_u32 m0, s6, 3072
    s_mov_b32 s5, 98304
    buffer_load_dwordx4 v240, s[16:19], s5 offen nt lds
    s_add_u32 m0, s6, 4096
    s_mov_b32 s5, 131072
    buffer_load_dwordx4 v240, s[16:19], s5 offen nt lds
    s_add_u32 m0, s6, 5120
    s_mov_b32 s5, 163840
    buffer_load_dwordx4 v240, s[16:19], s5 offen nt lds
    s_add_u32 m0, s6, 6144
    s_mov_b32 s5, 196608
    buffer_load_dwordx4 v240, s[16:19], s5 offen nt lds
    s_add_u32 m0, s6, 7168
    s_mov_b32 s5, 229376
    buffer_load_dwordx4 v240, s[16:19], s5 offen nt lds
    s_add_u32 m0, s6, 8192
    s_mov_b32 s5, 262144
    buffer_load_dwordx4 v240, s[16:19], s5 offen nt lds
    s_add_u32 m0, s6, 9216
    s_mov_b32 s5, 294912
    buffer_load_dwordx4 v240, s[16:19], s5 offen nt lds
    s_add_u32 m0, s6, 10240
    s_mov_b32 s5, 327680
    buffer_load_dwordx4 v240, s[16:19], s5 offen nt lds
    s_add_u32 m0, s6, 11264
    s_mov_b32 s5, 360448
    buffer_load_dwordx4 v240, s[16:19], s5 offen nt lds
    s_add_u32 m0, s6, 12288
    s_mov_b32 s5, 393216
    buffer_load_dwordx4 v240, s[16:19], s5 offen nt lds
    s_add_u32 m0, s6, 13312
    s_mov_b32 s5, 425984
    buffer_load_dwordx4 v240, s[16:19], s5 offen nt lds
    s_add_u32 m0, s6, 14336
    s_mov_b32 s5, 458752
    buffer_load_dwordx4 v240, s[16:19], s5 offen nt lds
    s_add_u32 m0, s6, 15360
    s_mov_b32 s5, 491520
    buffer_load_dwordx4 v240, s[16:19], s5 offen nt lds
    s_waitcnt vmcnt(16)
    s_barrier
    s_cmp_lg_u32 s24, 1
    s_cbranch_scc1 .ns_395
    s_mov_b64 exec, 1
    v_mov_b32 v238, s3
    v_mov_b32 v239, 0
    buffer_atomic_add v238, v239, s[20:23], 0 offen offset:196 sc1
    s_mov_b64 exec, -1
.ns_395:
    s_add_u32 m0, s6, 65536
    s_mov_b32 s5, 2097152
    buffer_load_dwordx4 v240, s[16:19], s5 offen nt lds
    s_add_u32 m0, s6, 66560
    s_mov_b32 s5, 2129920
    buffer_load_dwordx4 v240, s[16:19], s5 offen nt lds
    s_add_u32 m0, s6, 67584
    s_mov_b32 s5, 2162688
    buffer_load_dwordx4 v240, s[16:19], s5 offen nt lds
    s_add_u32 m0, s6, 68608
    s_mov_b32 s5, 2195456
    buffer_load_dwordx4 v240, s[16:19], s5 offen nt lds
    s_add_u32 m0, s6, 69632
    s_mov_b32 s5, 2228224
    buffer_load_dwordx4 v240, s[16:19], s5 offen nt lds
    s_add_u32 m0, s6, 70656
    s_mov_b32 s5, 2260992
    buffer_load_dwordx4 v240, s[16:19], s5 offen nt lds
    s_add_u32 m0, s6, 71680
    s_mov_b32 s5, 2293760
    buffer_load_dwordx4 v240, s[16:19], s5 offen nt lds
    s_add_u32 m0, s6, 72704
    s_mov_b32 s5, 2326528
    buffer_load_dwordx4 v240, s[16:19], s5 offen nt lds
    s_add_u32 m0, s6, 73728
    s_mov_b32 s5, 2359296
    buffer_load_dwordx4 v240, s[16:19], s5 offen nt lds
    s_add_u32 m0, s6, 74752
    s_mov_b32 s5, 2392064
    buffer_load_dwordx4 v240, s[16:19], s5 offen nt lds
    s_add_u32 m0, s6, 75776
    s_mov_b32 s5, 2424832
    buffer_load_dwordx4 v240, s[16:19], s5 offen nt lds
    s_add_u32 m0, s6, 76800
    s_mov_b32 s5, 2457600
    buffer_load_dwordx4 v240, s[16:19], s5 offen nt lds
    s_add_u32 m0, s6, 77824
    s_mov_b32 s5, 2490368
    buffer_load_dwordx4 v240, s[16:19], s5 offen nt lds
    s_add_u32 m0, s6, 78848
    s_mov_b32 s5, 2523136
    buffer_load_dwordx4 v240, s[16:19], s5 offen nt lds
    s_add_u32 m0, s6, 79872
    s_mov_b32 s5, 2555904
    buffer_load_dwordx4 v240, s[16:19], s5 offen nt lds
    s_add_u32 m0, s6, 80896
    s_mov_b32 s5, 2588672
    buffer_load_dwordx4 v240, s[16:19], s5 offen nt lds
    v_and_b32 v2, 15, v1
    v_lshrrev_b32 v3, 4, v1
    v_lshlrev_b32 v4, 11, v2
    v_add_u32 v5, 0, v3
    v_xor_b32 v5, v5, v2
    v_lshl_add_u32 v8, v5, 4, v4
    v_add_u32 v12, 0x10000, v8
    v_add_u32 v5, 4, v3
    v_xor_b32 v5, v5, v2
    v_lshl_add_u32 v9, v5, 4, v4
    v_add_u32 v13, 0x10000, v9
    v_add_u32 v5, 8, v3
    v_xor_b32 v5, v5, v2
    v_lshl_add_u32 v10, v5, 4, v4
    v_add_u32 v14, 0x10000, v10
    v_add_u32 v5, 12, v3
    v_xor_b32 v5, v5, v2
    v_lshl_add_u32 v11, v5, 4, v4
    v_add_u32 v15, 0x10000, v11
    s_lshl_b32 s4, s24, 3
    s_and_b32 s4, s4, 8
    s_add_u32 s5, s4, 0
    v_xor_b32 v5, s5, v1
    s_add_u32 s5, s6, 0
    v_lshlrev_b32 v5, 4, v5
    v_add_u32 v16, s5, v5
    s_add_u32 s5, s4, 1
    v_xor_b32 v5, s5, v1
    s_add_u32 s5, s6, 0
    v_lshlrev_b32 v5, 4, v5
    v_add_u32 v17, s5, v5
    s_add_u32 s5, s4, 2
    v_xor_b32 v5, s5, v1
    s_add_u32 s5, s6, 4096
    v_lshlrev_b32 v5, 4, v5
    v_add_u32 v18, s5, v5
    s_add_u32 s5, s4, 3
    v_xor_b32 v5, s5, v1
    s_add_u32 s5, s6, 4096
    v_lshlrev_b32 v5, 4, v5
    v_add_u32 v19, s5, v5
    s_add_u32 s5, s4, 4
    v_xor_b32 v5, s5, v1
    s_add_u32 s5, s6, 8192
    v_lshlrev_b32 v5, 4, v5
    v_add_u32 v20, s5, v5
    s_add_u32 s5, s4, 5
    v_xor_b32 v5, s5, v1
    s_add_u32 s5, s6, 8192
    v_lshlrev_b32 v5, 4, v5
    v_add_u32 v21, s5, v5
    s_add_u32 s5, s4, 6
    v_xor_b32 v5, s5, v1
    s_add_u32 s5, s6, 12288
    v_lshlrev_b32 v5, 4, v5
    v_add_u32 v22, s5, v5
    s_add_u32 s5, s4, 7
    v_xor_b32 v5, s5, v1
    s_add_u32 s5, s6, 12288
    v_lshlrev_b32 v5, 4, v5
    v_add_u32 v23, s5, v5
    s_cmp_eq_u32 s98, 2
    s_cselect_b32 s4, 11, 10
    s_cselect_b32 s5, 1, 4
    s_lshl_b32 s5, s5, 10
    s_lshl_b32 s4, s24, s4
    v_lshlrev_b32 v24, 4, v1
    v_add_u32 v24, s4, v24
    v_add_u32 v25, s5, v24
    v_mov_b32 v26, 0
    s_and_b32 s4, s99, 7
    s_lshl_b32 s4, s4, 13
    s_lshl_b32 s5, s24, 11
    s_add_u32 s4, s4, s5
    s_add_u32 s4, s4, 196608
    v_lshlrev_b32 v28, 5, v1
    v_add_u32 v28, s4, v28
    s_lshl_b32 s31, s98, 24
    s_lshl_b32 s4, s99, 13
    s_add_u32 s31, s31, s4
    s_mov_b32 s30, 75497472
    s_cmp_eq_u32 s98, 0
    s_cselect_b32 s28, 58, 0
    s_lshl_b32 s29, s28, 16
    s_waitcnt vmcnt(16)
    s_barrier
    ds_read_b64_tr_b16 a[0:1], v242 offset:0
    ds_read_b64_tr_b16 a[2:3], v242 offset:1024
    ds_read_b64_tr_b16 a[4:5], v242 offset:8
    ds_read_b64_tr_b16 a[6:7], v242 offset:1032
    ds_read_b64_tr_b16 a[8:9], v242 offset:8192
    ds_read_b64_tr_b16 a[10:11], v242 offset:9216
    ds_read_b64_tr_b16 a[12:13], v242 offset:8200
    ds_read_b64_tr_b16 a[14:15], v242 offset:9224
    ds_read_b64_tr_b16 a[16:17], v242 offset:16384
    ds_read_b64_tr_b16 a[18:19], v242 offset:17408
    ds_read_b64_tr_b16 a[20:21], v242 offset:16392
    ds_read_b64_tr_b16 a[22:23], v242 offset:17416
    ds_read_b64_tr_b16 a[24:25], v242 offset:24576
    ds_read_b64_tr_b16 a[26:27], v242 offset:25600
    ds_read_b64_tr_b16 a[28:29], v242 offset:24584
    ds_read_b64_tr_b16 a[30:31], v242 offset:25608
    ds_read_b64_tr_b16 a[32:33], v242 offset:32768
    ds_read_b64_tr_b16 a[34:35], v242 offset:33792
    ds_read_b64_tr_b16 a[36:37], v242 offset:32776
    ds_read_b64_tr_b16 a[38:39], v242 offset:33800
    ds_read_b64_tr_b16 a[40:41], v242 offset:40960
    ds_read_b64_tr_b16 a[42:43], v242 offset:41984
    ds_read_b64_tr_b16 a[44:45], v242 offset:40968
    ds_read_b64_tr_b16 a[46:47], v242 offset:41992
    ds_read_b64_tr_b16 a[48:49], v242 offset:49152
    ds_read_b64_tr_b16 a[50:51], v242 offset:50176
    ds_read_b64_tr_b16 a[52:53], v242 offset:49160
    ds_read_b64_tr_b16 a[54:55], v242 offset:50184
    ds_read_b64_tr_b16 a[56:57], v242 offset:57344
    ds_read_b64_tr_b16 a[58:59], v242 offset:58368
    ds_read_b64_tr_b16 a[60:61], v242 offset:57352
    ds_read_b64_tr_b16 a[62:63], v242 offset:58376
    s_waitcnt lgkmcnt(0)
    s_barrier
    s_add_u32 m0, s6, 0
    s_mov_b32 s5, 4194304
    buffer_load_dwordx4 v240, s[16:19], s5 offen nt lds
    s_add_u32 m0, s6, 1024
    s_mov_b32 s5, 4227072
    buffer_load_dwordx4 v240, s[16:19], s5 offen nt lds
    s_add_u32 m0, s6, 2048
    s_mov_b32 s5, 4259840
    buffer_load_dwordx4 v240, s[16:19], s5 offen nt lds
    s_add_u32 m0, s6, 3072
    s_mov_b32 s5, 4292608
    buffer_load_dwordx4 v240, s[16:19], s5 offen nt lds
    s_add_u32 m0, s6, 4096
    s_mov_b32 s5, 4325376
    buffer_load_dwordx4 v240, s[16:19], s5 offen nt lds
    s_add_u32 m0, s6, 5120
    s_mov_b32 s5, 4358144
    buffer_load_dwordx4 v240, s[16:19], s5 offen nt lds
    s_add_u32 m0, s6, 6144
    s_mov_b32 s5, 4390912
    buffer_load_dwordx4 v240, s[16:19], s5 offen nt lds
    s_add_u32 m0, s6, 7168
    s_mov_b32 s5, 4423680
    buffer_load_dwordx4 v240, s[16:19], s5 offen nt lds
    s_add_u32 m0, s6, 8192
    s_mov_b32 s5, 4456448
    buffer_load_dwordx4 v240, s[16:19], s5 offen nt lds
    s_add_u32 m0, s6, 9216
    s_mov_b32 s5, 4489216
    buffer_load_dwordx4 v240, s[16:19], s5 offen nt lds
    s_add_u32 m0, s6, 10240
    s_mov_b32 s5, 4521984
    buffer_load_dwordx4 v240, s[16:19], s5 offen nt lds
    s_add_u32 m0, s6, 11264
    s_mov_b32 s5, 4554752
    buffer_load_dwordx4 v240, s[16:19], s5 offen nt lds
    s_add_u32 m0, s6, 12288
    s_mov_b32 s5, 4587520
    buffer_load_dwordx4 v240, s[16:19], s5 offen nt lds
    s_add_u32 m0, s6, 13312
    s_mov_b32 s5, 4620288
    buffer_load_dwordx4 v240, s[16:19], s5 offen nt lds
    s_add_u32 m0, s6, 14336
    s_mov_b32 s5, 4653056
    buffer_load_dwordx4 v240, s[16:19], s5 offen nt lds
    s_add_u32 m0, s6, 15360
    s_mov_b32 s5, 4685824
    buffer_load_dwordx4 v240, s[16:19], s5 offen nt lds
    s_waitcnt vmcnt(16)
    s_lshl_b32 s4, s99, 9
    s_lshl_b32 s5, s24, 7
    s_add_u32 s4, s4, s5
    s_lshl_b32 s5, s98, 14
    s_add_u32 s4, s4, s5
    s_add_u32 s94, s4, 92274688
    s_add_u32 s4, s4, 76546048
    s_cmp_eq_u32 s98, 0
    s_cselect_b32 s94, s4, s94
    s_barrier
    ds_read_b64_tr_b16 a[64:65], v243 offset:0
    ds_read_b64_tr_b16 a[66:67], v243 offset:1024
    ds_read_b64_tr_b16 a[68:69], v243 offset:8
    ds_read_b64_tr_b16 a[70:71], v243 offset:1032
    ds_read_b64_tr_b16 a[72:73], v243 offset:8192
    ds_read_b64_tr_b16 a[74:75], v243 offset:9216
    ds_read_b64_tr_b16 a[76:77], v243 offset:8200
    ds_read_b64_tr_b16 a[78:79], v243 offset:9224
    ds_read_b64_tr_b16 a[80:81], v243 offset:16384
    ds_read_b64_tr_b16 a[82:83], v243 offset:17408
    ds_read_b64_tr_b16 a[84:85], v243 offset:16392
    ds_read_b64_tr_b16 a[86:87], v243 offset:17416
    ds_read_b64_tr_b16 a[88:89], v243 offset:24576
    ds_read_b64_tr_b16 a[90:91], v243 offset:25600
    ds_read_b64_tr_b16 a[92:93], v243 offset:24584
    ds_read_b64_tr_b16 a[94:95], v243 offset:25608
    ds_read_b64_tr_b16 a[96:97], v243 offset:32768
    ds_read_b64_tr_b16 a[98:99], v243 offset:33792
    ds_read_b64_tr_b16 a[100:101], v243 offset:32776
    ds_read_b64_tr_b16 a[102:103], v243 offset:33800
    ds_read_b64_tr_b16 a[104:105], v243 offset:40960
    ds_read_b64_tr_b16 a[106:107], v243 offset:41984
    ds_read_b64_tr_b16 a[108:109], v243 offset:40968
    ds_read_b64_tr_b16 a[110:111], v243 offset:41992
    ds_read_b64_tr_b16 a[112:113], v243 offset:49152
    ds_read_b64_tr_b16 a[114:115], v243 offset:50176
    ds_read_b64_tr_b16 a[116:117], v243 offset:49160
    ds_read_b64_tr_b16 a[118:119], v243 offset:50184
    ds_read_b64_tr_b16 a[120:121], v243 offset:57344
    ds_read_b64_tr_b16 a[122:123], v243 offset:58368
    ds_read_b64_tr_b16 a[124:125], v243 offset:57352
    ds_read_b64_tr_b16 a[126:127], v243 offset:58376
    s_waitcnt lgkmcnt(0)
    s_barrier
    v_or_b32 v239, 32, v1
    v_lshlrev_b32 v239, 2, v239
    buffer_load_dword v238, v239, s[20:23], 0 offen sc1
    s_add_u32 m0, s6, 65536
    s_mov_b32 s5, 6291456
    buffer_load_dwordx4 v240, s[16:19], s5 offen nt lds
    s_add_u32 m0, s6, 66560
    s_mov_b32 s5, 6324224
    buffer_load_dwordx4 v240, s[16:19], s5 offen nt lds
    s_add_u32 m0, s6, 67584
    s_mov_b32 s5, 6356992
    buffer_load_dwordx4 v240, s[16:19], s5 offen nt lds
    s_add_u32 m0, s6, 68608
    s_mov_b32 s5, 6389760
    buffer_load_dwordx4 v240, s[16:19], s5 offen nt lds
    s_add_u32 m0, s6, 69632
    s_mov_b32 s5, 6422528
    buffer_load_dwordx4 v240, s[16:19], s5 offen nt lds
    s_add_u32 m0, s6, 70656
    s_mov_b32 s5, 6455296
    buffer_load_dwordx4 v240, s[16:19], s5 offen nt lds
    s_add_u32 m0, s6, 71680
    s_mov_b32 s5, 6488064
    buffer_load_dwordx4 v240, s[16:19], s5 offen nt lds
    s_add_u32 m0, s6, 72704
    s_mov_b32 s5, 6520832
    buffer_load_dwordx4 v240, s[16:19], s5 offen nt lds
    s_add_u32 m0, s6, 73728
    s_mov_b32 s5, 6553600
    buffer_load_dwordx4 v240, s[16:19], s5 offen nt lds
    s_add_u32 m0, s6, 74752
    s_mov_b32 s5, 6586368
    buffer_load_dwordx4 v240, s[16:19], s5 offen nt lds
    s_add_u32 m0, s6, 75776
    s_mov_b32 s5, 6619136
    buffer_load_dwordx4 v240, s[16:19], s5 offen nt lds
    s_add_u32 m0, s6, 76800
    s_mov_b32 s5, 6651904
    buffer_load_dwordx4 v240, s[16:19], s5 offen nt lds
    s_add_u32 m0, s6, 77824
    s_mov_b32 s5, 6684672
    buffer_load_dwordx4 v240, s[16:19], s5 offen nt lds
    s_add_u32 m0, s6, 78848
    s_mov_b32 s5, 6717440
    buffer_load_dwordx4 v240, s[16:19], s5 offen nt lds
    s_add_u32 m0, s6, 79872
    s_mov_b32 s5, 6750208
    buffer_load_dwordx4 v240, s[16:19], s5 offen nt lds
    s_add_u32 m0, s6, 80896
    s_mov_b32 s5, 6782976
    buffer_load_dwordx4 v240, s[16:19], s5 offen nt lds
    s_waitcnt vmcnt(16)
    s_cmp_lg_u32 s27, 0
    s_cbranch_scc1 .vd_397
    s_mov_b32 s62, 0
.vp_396:
    v_readlane_b32 s4, v238, 49
    s_and_b32 s5, s4, 0xffff
    s_cmp_ge_u32 s5, 256
    s_cbranch_scc1 .va_398
    s_add_u32 s62, s62, 1
    s_cmp_gt_u32 s62, 0x100000
    s_cbranch_scc1 .mg_end_1
    s_sleep 16
    buffer_load_dword v238, v239, s[20:23], 0 offen sc1
    s_waitcnt vmcnt(0)
    s_branch .vp_396
.va_398:
    s_lshr_b32 s4, s4, 16
    s_cbranch_scc0 .vd_397
    s_lshr_b32 s25, s2, 5
    s_and_b32 s26, s2, 31
    s_mov_b32 s27, 1
    s_waitcnt vmcnt(0) lgkmcnt(0)
    s_barrier
    s_branch .mg_role_3
.vd_397:
    s_mov_b32 s63, 0
    s_cmp_lg_u32 s27, 0
    s_cbranch_scc1 .cd_400
    s_mov_b32 s62, 0
.cp_399:
    v_and_b32 v33, 0xffff, v238
    v_lshrrev_b32 v34, 16, v238
    v_min_u32 v32, v33, v34
    v_cmp_eq_u32 vcc, 0, v32
    s_and_b32 s4, vcc_hi, 65280
    s_cbranch_scc0 .cg_401
    s_add_u32 s62, s62, 1
    s_cmp_gt_u32 s62, 0x100000
    s_cbranch_scc1 .mg_end_1
    s_sleep 16
    buffer_load_dword v238, v239, s[20:23], 0 offen sc1
    s_waitcnt vmcnt(0)
    s_branch .cp_399
.cg_401:
    v_cmp_eq_u32 vcc, 2, v33
    s_bfe_u32 s63, vcc_hi, 524296
    v_cmp_eq_u32 vcc, 2, v34
    s_bfe_u32 s4, vcc_hi, 524296
    s_lshl_b32 s4, s4, 8
    s_or_b32 s63, s63, s4
    s_xor_b32 s4, s63, 0xaaaa
    s_bcnt1_i32_b32 s4, s4
    s_cmp_le_u32 s4, 3
    s_cselect_b32 s63, 0xaaaa, s63
    s_cmp_ge_u32 s4, 13
    s_cselect_b32 s63, 0x5555, s63
.cd_400:
    s_lshr_b32 s36, s99, 3
    s_and_b32 s37, s99, 7
    s_lshl_b32 s37, s37, 2
    s_add_u32 s37, s37, s24
    s_and_b32 s4, s36, 1
    s_lshl_b32 s35, s4, 14
    s_lshr_b32 s4, s36, 1
    s_lshl_b32 s4, s4, 12
    s_or_b32 s35, s35, s4
    s_and_b32 s4, s37, 1
    s_lshl_b32 s4, s4, 11
    s_or_b32 s35, s35, s4
    s_lshr_b32 s4, s37, 1
    s_lshl_b32 s4, s4, 15
    s_or_b32 s35, s35, s4
    s_and_b32 s4, s98, 1
    s_lshl_b32 s4, s4, 10
    s_add_u32 s4, s4, s101
    v_lshlrev_b32 v36, 4, v1
    v_add_u32 v36, s4, v36
    v_mov_b32 v32, -1
    v_mov_b32 v33, -1
    v_mov_b32 v34, -1
    v_mov_b32 v35, -1
    s_add_u32 s37, s28, 4
    s_bitcmp1_b32 s37, 0
    s_cselect_b32 s4, 0x84000, 0
    s_xor_b32 s34, s35, s4
    s_bitcmp1_b32 s37, 1
    s_cselect_b32 s4, 0x101000, 0
    s_xor_b32 s34, s34, s4
    s_lshr_b32 s37, s37, 2
    s_bitcmp1_b32 s63, s37
    s_cselect_b32 s4, 0x2000, 0
    s_xor_b32 s34, s34, s4
    s_lshl_b32 s37, s37, 21
    s_add_u32 s34, s34, s37
    s_barrier
    ds_read_b64_tr_b16 a[128:129], v242 offset:0
    ds_read_b64_tr_b16 a[130:131], v242 offset:1024
    ds_read_b64_tr_b16 a[132:133], v242 offset:8
    ds_read_b64_tr_b16 a[134:135], v242 offset:1032
    ds_read_b64_tr_b16 a[136:137], v242 offset:8192
    ds_read_b64_tr_b16 a[138:139], v242 offset:9216
    ds_read_b64_tr_b16 a[140:141], v242 offset:8200
    ds_read_b64_tr_b16 a[142:143], v242 offset:9224
    ds_read_b64_tr_b16 a[144:145], v242 offset:16384
    ds_read_b64_tr_b16 a[146:147], v242 offset:17408
    ds_read_b64_tr_b16 a[148:149], v242 offset:16392
    ds_read_b64_tr_b16 a[150:151], v242 offset:17416
    ds_read_b64_tr_b16 a[152:153], v242 offset:24576
    ds_read_b64_tr_b16 a[154:155], v242 offset:25600
    ds_read_b64_tr_b16 a[156:157], v242 offset:24584
    ds_read_b64_tr_b16 a[158:159], v242 offset:25608
    ds_read_b64_tr_b16 a[160:161], v242 offset:32768
    ds_read_b64_tr_b16 a[162:163], v242 offset:33792
    ds_read_b64_tr_b16 a[164:165], v242 offset:32776
    ds_read_b64_tr_b16 a[166:167], v242 offset:33800
    ds_read_b64_tr_b16 a[168:169], v242 offset:40960
    ds_read_b64_tr_b16 a[170:171], v242 offset:41984
    ds_read_b64_tr_b16 a[172:173], v242 offset:40968
    ds_read_b64_tr_b16 a[174:175], v242 offset:41992
    ds_read_b64_tr_b16 a[176:177], v242 offset:49152
    ds_read_b64_tr_b16 a[178:179], v242 offset:50176
    ds_read_b64_tr_b16 a[180:181], v242 offset:49160
    ds_read_b64_tr_b16 a[182:183], v242 offset:50184
    ds_read_b64_tr_b16 a[184:185], v242 offset:57344
    ds_read_b64_tr_b16 a[186:187], v242 offset:58368
    ds_read_b64_tr_b16 a[188:189], v242 offset:57352
    ds_read_b64_tr_b16 a[190:191], v242 offset:58376
    s_waitcnt lgkmcnt(0)
    s_barrier
    s_add_u32 m0, s6, 0
    s_nop 0
    buffer_load_dwordx4 v16, s[12:15], s29 offen offset:0 lds
    buffer_load_dwordx4 v16, s[12:15], s29 offen offset:1024 lds
    buffer_load_dwordx4 v17, s[12:15], s29 offen offset:2048 lds
    buffer_load_dwordx4 v17, s[12:15], s29 offen offset:3072 lds
    s_add_u32 m0, s6, 4096
    s_nop 0
    buffer_load_dwordx4 v18, s[12:15], s29 offen offset:0 lds
    buffer_load_dwordx4 v18, s[12:15], s29 offen offset:1024 lds
    buffer_load_dwordx4 v19, s[12:15], s29 offen offset:2048 lds
    buffer_load_dwordx4 v19, s[12:15], s29 offen offset:3072 lds
    s_add_u32 m0, s6, 8192
    s_nop 0
    buffer_load_dwordx4 v20, s[12:15], s29 offen offset:0 lds
    buffer_load_dwordx4 v20, s[12:15], s29 offen offset:1024 lds
    buffer_load_dwordx4 v21, s[12:15], s29 offen offset:2048 lds
    buffer_load_dwordx4 v21, s[12:15], s29 offen offset:3072 lds
    s_add_u32 m0, s6, 12288
    s_nop 0
    buffer_load_dwordx4 v22, s[12:15], s29 offen offset:0 lds
    buffer_load_dwordx4 v22, s[12:15], s29 offen offset:1024 lds
    buffer_load_dwordx4 v23, s[12:15], s29 offen offset:2048 lds
    buffer_load_dwordx4 v23, s[12:15], s29 offen offset:3072 lds
    s_waitcnt vmcnt(16)
    s_barrier
    ds_read_b64_tr_b16 a[192:193], v243 offset:0
    ds_read_b64_tr_b16 a[194:195], v243 offset:1024
    ds_read_b64_tr_b16 a[196:197], v243 offset:8
    ds_read_b64_tr_b16 a[198:199], v243 offset:1032
    ds_read_b64_tr_b16 a[200:201], v243 offset:8192
    ds_read_b64_tr_b16 a[202:203], v243 offset:9216
    ds_read_b64_tr_b16 a[204:205], v243 offset:8200
    ds_read_b64_tr_b16 a[206:207], v243 offset:9224
    ds_read_b64_tr_b16 a[208:209], v243 offset:16384
    ds_read_b64_tr_b16 a[210:211], v243 offset:17408
    ds_read_b64_tr_b16 a[212:213], v243 offset:16392
    ds_read_b64_tr_b16 a[214:215], v243 offset:17416
    ds_read_b64_tr_b16 a[216:217], v243 offset:24576
    ds_read_b64_tr_b16 a[218:219], v243 offset:25600
    ds_read_b64_tr_b16 a[220:221], v243 offset:24584
    ds_read_b64_tr_b16 a[222:223], v243 offset:25608
    ds_read_b64_tr_b16 a[224:225], v243 offset:32768
    ds_read_b64_tr_b16 a[226:227], v243 offset:33792
    ds_read_b64_tr_b16 a[228:229], v243 offset:32776
    ds_read_b64_tr_b16 a[230:231], v243 offset:33800
    ds_read_b64_tr_b16 a[232:233], v243 offset:40960
    ds_read_b64_tr_b16 a[234:235], v243 offset:41984
    ds_read_b64_tr_b16 a[236:237], v243 offset:40968
    ds_read_b64_tr_b16 a[238:239], v243 offset:41992
    ds_read_b64_tr_b16 a[240:241], v243 offset:49152
    ds_read_b64_tr_b16 a[242:243], v243 offset:50176
    ds_read_b64_tr_b16 a[244:245], v243 offset:49160
    ds_read_b64_tr_b16 a[246:247], v243 offset:50184
    ds_read_b64_tr_b16 a[248:249], v243 offset:57344
    ds_read_b64_tr_b16 a[250:251], v243 offset:58368
    ds_read_b64_tr_b16 a[252:253], v243 offset:57352
    ds_read_b64_tr_b16 a[254:255], v243 offset:58376
    s_waitcnt lgkmcnt(0)
    s_barrier
    s_waitcnt vmcnt(0)
    s_barrier
    s_add_u32 s29, s29, 0x10000
    ds_read_b128 v[64:67], v8 offset:0
    ds_read_b128 v[68:71], v8 offset:32768
    ds_read_b128 v[72:75], v9 offset:0
    ds_read_b128 v[76:79], v9 offset:32768
    ds_read_b128 v[80:83], v10 offset:0
    ds_read_b128 v[84:87], v10 offset:32768
    ds_read_b128 v[88:91], v11 offset:0
    ds_read_b128 v[92:95], v11 offset:32768
    ds_read_b128 v[96:99], v8 offset:256
    ds_read_b128 v[100:103], v8 offset:33024
    ds_read_b128 v[104:107], v9 offset:256
    ds_read_b128 v[108:111], v9 offset:33024
    ds_read_b128 v[112:115], v10 offset:256
    ds_read_b128 v[116:119], v10 offset:33024
    ds_read_b128 v[120:123], v11 offset:256
    ds_read_b128 v[124:127], v11 offset:33024
    s_add_u32 m0, s6, 65536
    s_nop 0
    buffer_load_dwordx4 v16, s[12:15], s29 offen offset:0 lds
    buffer_load_dwordx4 v16, s[12:15], s29 offen offset:1024 lds
    buffer_load_dwordx4 v17, s[12:15], s29 offen offset:2048 lds
    buffer_load_dwordx4 v17, s[12:15], s29 offen offset:3072 lds
    s_add_u32 m0, s6, 69632
    s_nop 0
    buffer_load_dwordx4 v18, s[12:15], s29 offen offset:0 lds
    buffer_load_dwordx4 v18, s[12:15], s29 offen offset:1024 lds
    s_cmp_eq_u32 s98, 2
    s_cbranch_scc1 .vt_403
.p2align 6
.ql_405:
    s_waitcnt lgkmcnt(12)
    v_mfma_f32_16x16x32_bf16 v[192:195], a[0:3], v[64:67], 0
    ds_read_b128 v[128:131], v8 offset:512
    v_mfma_f32_16x16x32_bf16 v[196:199], a[4:7], v[64:67], 0
    v_mfma_f32_16x16x32_bf16 v[200:203], a[0:3], v[68:71], 0
    ds_read_b128 v[132:135], v8 offset:33280
    v_mfma_f32_16x16x32_bf16 v[204:207], a[4:7], v[68:71], 0
    buffer_load_dwordx4 v19, s[12:15], s29 offen offset:2048 lds
    v_mfma_f32_16x16x32_bf16 v[192:195], a[8:11], v[72:75], v[192:195]
    ds_read_b128 v[136:139], v9 offset:512
    v_mfma_f32_16x16x32_bf16 v[196:199], a[12:15], v[72:75], v[196:199]
    v_cvt_pk_bf16_f32 v224, v208, v209
    v_cvt_pk_bf16_f32 v225, v210, v211
    v_mfma_f32_16x16x32_bf16 v[200:203], a[8:11], v[76:79], v[200:203]
    ds_read_b128 v[140:143], v9 offset:33280
    v_mfma_f32_16x16x32_bf16 v[204:207], a[12:15], v[76:79], v[204:207]
    buffer_load_dwordx4 v19, s[12:15], s29 offen offset:3072 lds
    s_waitcnt lgkmcnt(12)
    v_mfma_f32_16x16x32_bf16 v[192:195], a[16:19], v[80:83], v[192:195]
    ds_read_b128 v[144:147], v10 offset:512
    v_mfma_f32_16x16x32_bf16 v[196:199], a[20:23], v[80:83], v[196:199]
    s_add_u32 m0, s6, 73728
    v_cvt_pk_bf16_f32 v226, v212, v213
    v_cvt_pk_bf16_f32 v227, v214, v215
    v_mfma_f32_16x16x32_bf16 v[200:203], a[16:19], v[84:87], v[200:203]
    ds_read_b128 v[148:151], v10 offset:33280
    v_mfma_f32_16x16x32_bf16 v[204:207], a[20:23], v[84:87], v[204:207]
    buffer_load_dwordx4 v20, s[12:15], s29 offen offset:0 lds
    v_mfma_f32_16x16x32_bf16 v[192:195], a[24:27], v[88:91], v[192:195]
    ds_read_b128 v[152:155], v11 offset:512
    v_cvt_pk_bf16_f32 v228, v216, v217
    v_mfma_f32_16x16x32_bf16 v[196:199], a[28:31], v[88:91], v[196:199]
    buffer_store_dwordx4 v[224:227], v24, s[8:11], s30 offen sc1
    v_mfma_f32_16x16x32_bf16 v[200:203], a[24:27], v[92:95], v[200:203]
    ds_read_b128 v[156:159], v11 offset:33280
    v_cvt_pk_bf16_f32 v229, v218, v219
    v_mfma_f32_16x16x32_bf16 v[204:207], a[28:31], v[92:95], v[204:207]
    buffer_load_dwordx4 v20, s[12:15], s29 offen offset:1024 lds
    s_waitcnt lgkmcnt(12)
    v_mfma_f32_16x16x32_bf16 v[192:195], a[32:35], v[96:99], v[192:195]
    ds_read_b128 v[160:163], v8 offset:768
    v_mfma_f32_16x16x32_bf16 v[196:199], a[36:39], v[96:99], v[196:199]
    v_cvt_pk_bf16_f32 v230, v220, v221
    v_cvt_pk_bf16_f32 v231, v222, v223
    v_mfma_f32_16x16x32_bf16 v[200:203], a[32:35], v[100:103], v[200:203]
    ds_read_b128 v[164:167], v8 offset:33536
    v_mfma_f32_16x16x32_bf16 v[204:207], a[36:39], v[100:103], v[204:207]
    buffer_load_dwordx4 v21, s[12:15], s29 offen offset:2048 lds
    v_mfma_f32_16x16x32_bf16 v[192:195], a[40:43], v[104:107], v[192:195]
    ds_read_b128 v[168:171], v9 offset:768
    v_mfma_f32_16x16x32_bf16 v[196:199], a[44:47], v[104:107], v[196:199]
    buffer_store_dwordx4 v[228:231], v25, s[8:11], s30 offen sc1
    v_mfma_f32_16x16x32_bf16 v[200:203], a[40:43], v[108:111], v[200:203]
    ds_read_b128 v[172:175], v9 offset:33536
    v_mfma_f32_16x16x32_bf16 v[204:207], a[44:47], v[108:111], v[204:207]
    buffer_load_dwordx4 v21, s[12:15], s29 offen offset:3072 lds
    s_waitcnt lgkmcnt(12)
    v_mfma_f32_16x16x32_bf16 v[192:195], a[48:51], v[112:115], v[192:195]
    ds_read_b128 v[176:179], v10 offset:768
    v_mfma_f32_16x16x32_bf16 v[196:199], a[52:55], v[112:115], v[196:199]
    s_add_u32 m0, s6, 77824
    s_mov_b32 s30, s31
    v_mfma_f32_16x16x32_bf16 v[200:203], a[48:51], v[116:119], v[200:203]
    ds_read_b128 v[180:183], v10 offset:33536
    v_mfma_f32_16x16x32_bf16 v[204:207], a[52:55], v[116:119], v[204:207]
    buffer_load_dwordx4 v22, s[12:15], s29 offen offset:0 lds
    v_mfma_f32_16x16x32_bf16 v[192:195], a[56:59], v[120:123], v[192:195]
    ds_read_b128 v[184:187], v11 offset:768
    v_mfma_f32_16x16x32_bf16 v[196:199], a[60:63], v[120:123], v[196:199]
    s_add_u32 s31, s31, 262144
    v_mfma_f32_16x16x32_bf16 v[200:203], a[56:59], v[124:127], v[200:203]
    ds_read_b128 v[188:191], v11 offset:33536
    v_mfma_f32_16x16x32_bf16 v[204:207], a[60:63], v[124:127], v[204:207]
    buffer_load_dwordx4 v22, s[12:15], s29 offen offset:1024 lds
    s_waitcnt lgkmcnt(12)
    v_mfma_f32_16x16x32_bf16 v[192:195], a[64:67], v[128:131], v[192:195]
    ds_read_b128 v[64:67], v8 offset:1024
    v_mfma_f32_16x16x32_bf16 v[196:199], a[68:71], v[128:131], v[196:199]
    v_mfma_f32_16x16x32_bf16 v[200:203], a[64:67], v[132:135], v[200:203]
    ds_read_b128 v[68:71], v8 offset:33792
    v_mfma_f32_16x16x32_bf16 v[204:207], a[68:71], v[132:135], v[204:207]
    buffer_load_dwordx4 v23, s[12:15], s29 offen offset:2048 lds
    v_mfma_f32_16x16x32_bf16 v[192:195], a[72:75], v[136:139], v[192:195]
    ds_read_b128 v[72:75], v9 offset:1024
    v_mfma_f32_16x16x32_bf16 v[196:199], a[76:79], v[136:139], v[196:199]
    v_mfma_f32_16x16x32_bf16 v[200:203], a[72:75], v[140:143], v[200:203]
    ds_read_b128 v[76:79], v9 offset:33792
    v_mfma_f32_16x16x32_bf16 v[204:207], a[76:79], v[140:143], v[204:207]
    buffer_load_dwordx4 v23, s[12:15], s29 offen offset:3072 lds
    s_waitcnt lgkmcnt(12)
    v_mfma_f32_16x16x32_bf16 v[192:195], a[80:83], v[144:147], v[192:195]
    ds_read_b128 v[80:83], v10 offset:1024
    v_mfma_f32_16x16x32_bf16 v[196:199], a[84:87], v[144:147], v[196:199]
    v_mfma_f32_16x16x32_bf16 v[200:203], a[80:83], v[148:151], v[200:203]
    ds_read_b128 v[84:87], v10 offset:33792
    v_mfma_f32_16x16x32_bf16 v[204:207], a[84:87], v[148:151], v[204:207]
    buffer_load_dword v29, v28, s[12:15], s29 offen
    v_mfma_f32_16x16x32_bf16 v[192:195], a[88:91], v[152:155], v[192:195]
    ds_read_b128 v[88:91], v11 offset:1024
    v_mfma_f32_16x16x32_bf16 v[196:199], a[92:95], v[152:155], v[196:199]
    v_mfma_f32_16x16x32_bf16 v[200:203], a[88:91], v[156:159], v[200:203]
    ds_read_b128 v[92:95], v11 offset:33792
    v_mfma_f32_16x16x32_bf16 v[204:207], a[92:95], v[156:159], v[204:207]
    buffer_store_dwordx4 v[32:35], v36, s[8:11], s34 offen sc1
    s_waitcnt lgkmcnt(12)
    v_mfma_f32_16x16x32_bf16 v[192:195], a[96:99], v[160:163], v[192:195]
    ds_read_b128 v[96:99], v8 offset:1280
    v_mfma_f32_16x16x32_bf16 v[196:199], a[100:103], v[160:163], v[196:199]
    v_mfma_f32_16x16x32_bf16 v[200:203], a[96:99], v[164:167], v[200:203]
    ds_read_b128 v[100:103], v8 offset:34048
    v_mfma_f32_16x16x32_bf16 v[204:207], a[100:103], v[164:167], v[204:207]
    v_mfma_f32_16x16x32_bf16 v[192:195], a[104:107], v[168:171], v[192:195]
    ds_read_b128 v[104:107], v9 offset:1280
    v_mfma_f32_16x16x32_bf16 v[196:199], a[108:111], v[168:171], v[196:199]
    v_mfma_f32_16x16x32_bf16 v[200:203], a[104:107], v[172:175], v[200:203]
    ds_read_b128 v[108:111], v9 offset:34048
    v_mfma_f32_16x16x32_bf16 v[204:207], a[108:111], v[172:175], v[204:207]
    s_waitcnt lgkmcnt(12)
    v_mfma_f32_16x16x32_bf16 v[192:195], a[112:115], v[176:179], v[192:195]
    ds_read_b128 v[112:115], v10 offset:1280
    v_mfma_f32_16x16x32_bf16 v[196:199], a[116:119], v[176:179], v[196:199]
    v_mfma_f32_16x16x32_bf16 v[200:203], a[112:115], v[180:183], v[200:203]
    ds_read_b128 v[116:119], v10 offset:34048
    v_mfma_f32_16x16x32_bf16 v[204:207], a[116:119], v[180:183], v[204:207]
    v_mfma_f32_16x16x32_bf16 v[192:195], a[120:123], v[184:187], v[192:195]
    ds_read_b128 v[120:123], v11 offset:1280
    v_mfma_f32_16x16x32_bf16 v[196:199], a[124:127], v[184:187], v[196:199]
    v_mfma_f32_16x16x32_bf16 v[200:203], a[120:123], v[188:191], v[200:203]
    ds_read_b128 v[124:127], v11 offset:34048
    v_mfma_f32_16x16x32_bf16 v[204:207], a[124:127], v[188:191], v[204:207]
    s_waitcnt lgkmcnt(12)
    v_mfma_f32_16x16x32_bf16 v[192:195], a[128:131], v[64:67], v[192:195]
    ds_read_b128 v[128:131], v8 offset:1536
    v_mfma_f32_16x16x32_bf16 v[196:199], a[132:135], v[64:67], v[196:199]
    v_mfma_f32_16x16x32_bf16 v[200:203], a[128:131], v[68:71], v[200:203]
    ds_read_b128 v[132:135], v8 offset:34304
    v_mfma_f32_16x16x32_bf16 v[204:207], a[132:135], v[68:71], v[204:207]
    v_mfma_f32_16x16x32_bf16 v[192:195], a[136:139], v[72:75], v[192:195]
    ds_read_b128 v[136:139], v9 offset:1536
    v_mfma_f32_16x16x32_bf16 v[196:199], a[140:143], v[72:75], v[196:199]
    s_add_u32 s37, s28, 5
    v_mfma_f32_16x16x32_bf16 v[200:203], a[136:139], v[76:79], v[200:203]
    ds_read_b128 v[140:143], v9 offset:34304
    v_mfma_f32_16x16x32_bf16 v[204:207], a[140:143], v[76:79], v[204:207]
    s_bitcmp1_b32 s37, 0
    s_cselect_b32 s4, 0x84000, 0
    s_waitcnt lgkmcnt(12)
    v_mfma_f32_16x16x32_bf16 v[192:195], a[144:147], v[80:83], v[192:195]
    ds_read_b128 v[144:147], v10 offset:1536
    v_mfma_f32_16x16x32_bf16 v[196:199], a[148:151], v[80:83], v[196:199]
    s_xor_b32 s34, s35, s4
    v_mfma_f32_16x16x32_bf16 v[200:203], a[144:147], v[84:87], v[200:203]
    ds_read_b128 v[148:151], v10 offset:34304
    v_mfma_f32_16x16x32_bf16 v[204:207], a[148:151], v[84:87], v[204:207]
    s_bitcmp1_b32 s37, 1
    s_cselect_b32 s4, 0x101000, 0
    v_mfma_f32_16x16x32_bf16 v[192:195], a[152:155], v[88:91], v[192:195]
    ds_read_b128 v[152:155], v11 offset:1536
    v_mfma_f32_16x16x32_bf16 v[196:199], a[156:159], v[88:91], v[196:199]
    s_xor_b32 s34, s34, s4
    s_lshr_b32 s37, s37, 2
    v_mfma_f32_16x16x32_bf16 v[200:203], a[152:155], v[92:95], v[200:203]
    ds_read_b128 v[156:159], v11 offset:34304
    v_mfma_f32_16x16x32_bf16 v[204:207], a[156:159], v[92:95], v[204:207]
    s_bitcmp1_b32 s63, s37
    s_cselect_b32 s4, 0x2000, 0
    s_waitcnt lgkmcnt(12)
    v_mfma_f32_16x16x32_bf16 v[192:195], a[160:163], v[96:99], v[192:195]
    ds_read_b128 v[160:163], v8 offset:1792
    v_mfma_f32_16x16x32_bf16 v[196:199], a[164:167], v[96:99], v[196:199]
    s_xor_b32 s34, s34, s4
    s_lshl_b32 s37, s37, 21
    v_mfma_f32_16x16x32_bf16 v[200:203], a[160:163], v[100:103], v[200:203]
    ds_read_b128 v[164:167], v8 offset:34560
    v_mfma_f32_16x16x32_bf16 v[204:207], a[164:167], v[100:103], v[204:207]
    s_add_u32 s34, s34, s37
    v_mfma_f32_16x16x32_bf16 v[192:195], a[168:171], v[104:107], v[192:195]
    ds_read_b128 v[168:171], v9 offset:1792
    v_mfma_f32_16x16x32_bf16 v[196:199], a[172:175], v[104:107], v[196:199]
    v_mfma_f32_16x16x32_bf16 v[200:203], a[168:171], v[108:111], v[200:203]
    ds_read_b128 v[172:175], v9 offset:34560
    v_mfma_f32_16x16x32_bf16 v[204:207], a[172:175], v[108:111], v[204:207]
    s_waitcnt lgkmcnt(12)
    v_mfma_f32_16x16x32_bf16 v[192:195], a[176:179], v[112:115], v[192:195]
    ds_read_b128 v[176:179], v10 offset:1792
    v_mfma_f32_16x16x32_bf16 v[196:199], a[180:183], v[112:115], v[196:199]
    s_waitcnt vmcnt(7)
    v_mov_b32 v27, s28
    s_mov_b64 exec, 1
    buffer_store_dword v27, v26, s[8:11], s94 offen sc1
    s_mov_b64 exec, -1
    v_mfma_f32_16x16x32_bf16 v[200:203], a[176:179], v[116:119], v[200:203]
    ds_read_b128 v[180:183], v10 offset:34560
    v_mfma_f32_16x16x32_bf16 v[204:207], a[180:183], v[116:119], v[204:207]
    v_mfma_f32_16x16x32_bf16 v[192:195], a[184:187], v[120:123], v[192:195]
    ds_read_b128 v[184:187], v11 offset:1792
    v_mfma_f32_16x16x32_bf16 v[196:199], a[188:191], v[120:123], v[196:199]
    s_add_u32 s28, s28, 1
    v_mfma_f32_16x16x32_bf16 v[200:203], a[184:187], v[124:127], v[200:203]
    ds_read_b128 v[188:191], v11 offset:34560
    v_mfma_f32_16x16x32_bf16 v[204:207], a[188:191], v[124:127], v[204:207]
    s_waitcnt lgkmcnt(12)
    v_mfma_f32_16x16x32_bf16 v[192:195], a[192:195], v[128:131], v[192:195]
    v_mfma_f32_16x16x32_bf16 v[196:199], a[196:199], v[128:131], v[196:199]
    v_mfma_f32_16x16x32_bf16 v[200:203], a[192:195], v[132:135], v[200:203]
    v_mfma_f32_16x16x32_bf16 v[204:207], a[196:199], v[132:135], v[204:207]
    v_mfma_f32_16x16x32_bf16 v[192:195], a[200:203], v[136:139], v[192:195]
    v_mfma_f32_16x16x32_bf16 v[196:199], a[204:207], v[136:139], v[196:199]
    s_add_u32 s29, s29, 0x10000
    s_and_b32 s29, s29, 0x3fffff
    v_mfma_f32_16x16x32_bf16 v[200:203], a[200:203], v[140:143], v[200:203]
    v_mfma_f32_16x16x32_bf16 v[204:207], a[204:207], v[140:143], v[204:207]
    s_waitcnt vmcnt(3) lgkmcnt(0)
    s_barrier
    v_mfma_f32_16x16x32_bf16 v[192:195], a[208:211], v[144:147], v[192:195]
    ds_read_b128 v[64:67], v12 offset:0
    ds_read_b128 v[68:71], v12 offset:32768
    v_mfma_f32_16x16x32_bf16 v[196:199], a[212:215], v[144:147], v[196:199]
    s_add_u32 m0, s6, 0
    v_mfma_f32_16x16x32_bf16 v[200:203], a[208:211], v[148:151], v[200:203]
    ds_read_b128 v[72:75], v13 offset:0
    ds_read_b128 v[76:79], v13 offset:32768
    v_mfma_f32_16x16x32_bf16 v[204:207], a[212:215], v[148:151], v[204:207]
    buffer_load_dwordx4 v16, s[12:15], s29 offen offset:0 lds
    v_mfma_f32_16x16x32_bf16 v[192:195], a[216:219], v[152:155], v[192:195]
    ds_read_b128 v[80:83], v14 offset:0
    ds_read_b128 v[84:87], v14 offset:32768
    v_mfma_f32_16x16x32_bf16 v[196:199], a[220:223], v[152:155], v[196:199]
    v_mfma_f32_16x16x32_bf16 v[200:203], a[216:219], v[156:159], v[200:203]
    ds_read_b128 v[88:91], v15 offset:0
    ds_read_b128 v[92:95], v15 offset:32768
    v_mfma_f32_16x16x32_bf16 v[204:207], a[220:223], v[156:159], v[204:207]
    buffer_load_dwordx4 v16, s[12:15], s29 offen offset:1024 lds
    v_mfma_f32_16x16x32_bf16 v[192:195], a[224:227], v[160:163], v[192:195]
    ds_read_b128 v[96:99], v12 offset:256
    v_mfma_f32_16x16x32_bf16 v[196:199], a[228:231], v[160:163], v[196:199]
    v_mfma_f32_16x16x32_bf16 v[200:203], a[224:227], v[164:167], v[200:203]
    ds_read_b128 v[100:103], v12 offset:33024
    v_mfma_f32_16x16x32_bf16 v[204:207], a[228:231], v[164:167], v[204:207]
    buffer_load_dwordx4 v17, s[12:15], s29 offen offset:2048 lds
    v_mfma_f32_16x16x32_bf16 v[192:195], a[232:235], v[168:171], v[192:195]
    ds_read_b128 v[104:107], v13 offset:256
    v_mfma_f32_16x16x32_bf16 v[196:199], a[236:239], v[168:171], v[196:199]
    v_mfma_f32_16x16x32_bf16 v[200:203], a[232:235], v[172:175], v[200:203]
    ds_read_b128 v[108:111], v13 offset:33024
    v_mfma_f32_16x16x32_bf16 v[204:207], a[236:239], v[172:175], v[204:207]
    buffer_load_dwordx4 v17, s[12:15], s29 offen offset:3072 lds
    v_mfma_f32_16x16x32_bf16 v[192:195], a[240:243], v[176:179], v[192:195]
    ds_read_b128 v[112:115], v14 offset:256
    v_mfma_f32_16x16x32_bf16 v[196:199], a[244:247], v[176:179], v[196:199]
    s_add_u32 m0, s6, 4096
    v_mfma_f32_16x16x32_bf16 v[200:203], a[240:243], v[180:183], v[200:203]
    ds_read_b128 v[116:119], v14 offset:33024
    v_mfma_f32_16x16x32_bf16 v[204:207], a[244:247], v[180:183], v[204:207]
    buffer_load_dwordx4 v18, s[12:15], s29 offen offset:0 lds
    v_mfma_f32_16x16x32_bf16 v[192:195], a[248:251], v[184:187], v[192:195]
    ds_read_b128 v[120:123], v15 offset:256
    v_mfma_f32_16x16x32_bf16 v[196:199], a[252:255], v[184:187], v[196:199]
    v_mfma_f32_16x16x32_bf16 v[200:203], a[248:251], v[188:191], v[200:203]
    ds_read_b128 v[124:127], v15 offset:33024
    v_mfma_f32_16x16x32_bf16 v[204:207], a[252:255], v[188:191], v[204:207]
    buffer_load_dwordx4 v18, s[12:15], s29 offen offset:1024 lds
    s_waitcnt lgkmcnt(12)
    v_mfma_f32_16x16x32_bf16 v[208:211], a[0:3], v[64:67], 0
    ds_read_b128 v[128:131], v12 offset:512
    v_mfma_f32_16x16x32_bf16 v[212:215], a[4:7], v[64:67], 0
    v_mfma_f32_16x16x32_bf16 v[216:219], a[0:3], v[68:71], 0
    ds_read_b128 v[132:135], v12 offset:33280
    v_mfma_f32_16x16x32_bf16 v[220:223], a[4:7], v[68:71], 0
    buffer_load_dwordx4 v19, s[12:15], s29 offen offset:2048 lds
    v_mfma_f32_16x16x32_bf16 v[208:211], a[8:11], v[72:75], v[208:211]
    ds_read_b128 v[136:139], v13 offset:512
    v_mfma_f32_16x16x32_bf16 v[212:215], a[12:15], v[72:75], v[212:215]
    v_cvt_pk_bf16_f32 v224, v192, v193
    v_cvt_pk_bf16_f32 v225, v194, v195
    v_mfma_f32_16x16x32_bf16 v[216:219], a[8:11], v[76:79], v[216:219]
    ds_read_b128 v[140:143], v13 offset:33280
    v_mfma_f32_16x16x32_bf16 v[220:223], a[12:15], v[76:79], v[220:223]
    buffer_load_dwordx4 v19, s[12:15], s29 offen offset:3072 lds
    s_waitcnt lgkmcnt(12)
    v_mfma_f32_16x16x32_bf16 v[208:211], a[16:19], v[80:83], v[208:211]
    ds_read_b128 v[144:147], v14 offset:512
    v_mfma_f32_16x16x32_bf16 v[212:215], a[20:23], v[80:83], v[212:215]
    s_add_u32 m0, s6, 8192
    v_cvt_pk_bf16_f32 v226, v196, v197
    v_cvt_pk_bf16_f32 v227, v198, v199
    v_mfma_f32_16x16x32_bf16 v[216:219], a[16:19], v[84:87], v[216:219]
    ds_read_b128 v[148:151], v14 offset:33280
    v_mfma_f32_16x16x32_bf16 v[220:223], a[20:23], v[84:87], v[220:223]
    buffer_load_dwordx4 v20, s[12:15], s29 offen offset:0 lds
    v_mfma_f32_16x16x32_bf16 v[208:211], a[24:27], v[88:91], v[208:211]
    ds_read_b128 v[152:155], v15 offset:512
    v_cvt_pk_bf16_f32 v228, v200, v201
    v_mfma_f32_16x16x32_bf16 v[212:215], a[28:31], v[88:91], v[212:215]
    buffer_store_dwordx4 v[224:227], v24, s[8:11], s30 offen sc1
    v_mfma_f32_16x16x32_bf16 v[216:219], a[24:27], v[92:95], v[216:219]
    ds_read_b128 v[156:159], v15 offset:33280
    v_cvt_pk_bf16_f32 v229, v202, v203
    v_mfma_f32_16x16x32_bf16 v[220:223], a[28:31], v[92:95], v[220:223]
    buffer_load_dwordx4 v20, s[12:15], s29 offen offset:1024 lds
    s_waitcnt lgkmcnt(12)
    v_mfma_f32_16x16x32_bf16 v[208:211], a[32:35], v[96:99], v[208:211]
    ds_read_b128 v[160:163], v12 offset:768
    v_mfma_f32_16x16x32_bf16 v[212:215], a[36:39], v[96:99], v[212:215]
    v_cvt_pk_bf16_f32 v230, v204, v205
    v_cvt_pk_bf16_f32 v231, v206, v207
    v_mfma_f32_16x16x32_bf16 v[216:219], a[32:35], v[100:103], v[216:219]
    ds_read_b128 v[164:167], v12 offset:33536
    v_mfma_f32_16x16x32_bf16 v[220:223], a[36:39], v[100:103], v[220:223]
    buffer_load_dwordx4 v21, s[12:15], s29 offen offset:2048 lds
    v_mfma_f32_16x16x32_bf16 v[208:211], a[40:43], v[104:107], v[208:211]
    ds_read_b128 v[168:171], v13 offset:768
    v_mfma_f32_16x16x32_bf16 v[212:215], a[44:47], v[104:107], v[212:215]
    buffer_store_dwordx4 v[228:231], v25, s[8:11], s30 offen sc1
    v_mfma_f32_16x16x32_bf16 v[216:219], a[40:43], v[108:111], v[216:219]
    ds_read_b128 v[172:175], v13 offset:33536
    v_mfma_f32_16x16x32_bf16 v[220:223], a[44:47], v[108:111], v[220:223]
    buffer_load_dwordx4 v21, s[12:15], s29 offen offset:3072 lds
    s_waitcnt lgkmcnt(12)
    v_mfma_f32_16x16x32_bf16 v[208:211], a[48:51], v[112:115], v[208:211]
    ds_read_b128 v[176:179], v14 offset:768
    v_mfma_f32_16x16x32_bf16 v[212:215], a[52:55], v[112:115], v[212:215]
    s_add_u32 m0, s6, 12288
    s_mov_b32 s30, s31
    v_mfma_f32_16x16x32_bf16 v[216:219], a[48:51], v[116:119], v[216:219]
    ds_read_b128 v[180:183], v14 offset:33536
    v_mfma_f32_16x16x32_bf16 v[220:223], a[52:55], v[116:119], v[220:223]
    buffer_load_dwordx4 v22, s[12:15], s29 offen offset:0 lds
    v_mfma_f32_16x16x32_bf16 v[208:211], a[56:59], v[120:123], v[208:211]
    ds_read_b128 v[184:187], v15 offset:768
    v_mfma_f32_16x16x32_bf16 v[212:215], a[60:63], v[120:123], v[212:215]
    s_add_u32 s31, s31, 262144
    v_mfma_f32_16x16x32_bf16 v[216:219], a[56:59], v[124:127], v[216:219]
    ds_read_b128 v[188:191], v15 offset:33536
    v_mfma_f32_16x16x32_bf16 v[220:223], a[60:63], v[124:127], v[220:223]
    buffer_load_dwordx4 v22, s[12:15], s29 offen offset:1024 lds
    s_waitcnt lgkmcnt(12)
    v_mfma_f32_16x16x32_bf16 v[208:211], a[64:67], v[128:131], v[208:211]
    ds_read_b128 v[64:67], v12 offset:1024
    v_mfma_f32_16x16x32_bf16 v[212:215], a[68:71], v[128:131], v[212:215]
    v_mfma_f32_16x16x32_bf16 v[216:219], a[64:67], v[132:135], v[216:219]
    ds_read_b128 v[68:71], v12 offset:33792
    v_mfma_f32_16x16x32_bf16 v[220:223], a[68:71], v[132:135], v[220:223]
    buffer_load_dwordx4 v23, s[12:15], s29 offen offset:2048 lds
    v_mfma_f32_16x16x32_bf16 v[208:211], a[72:75], v[136:139], v[208:211]
    ds_read_b128 v[72:75], v13 offset:1024
    v_mfma_f32_16x16x32_bf16 v[212:215], a[76:79], v[136:139], v[212:215]
    v_mfma_f32_16x16x32_bf16 v[216:219], a[72:75], v[140:143], v[216:219]
    ds_read_b128 v[76:79], v13 offset:33792
    v_mfma_f32_16x16x32_bf16 v[220:223], a[76:79], v[140:143], v[220:223]
    buffer_load_dwordx4 v23, s[12:15], s29 offen offset:3072 lds
    s_waitcnt lgkmcnt(12)
    v_mfma_f32_16x16x32_bf16 v[208:211], a[80:83], v[144:147], v[208:211]
    ds_read_b128 v[80:83], v14 offset:1024
    v_mfma_f32_16x16x32_bf16 v[212:215], a[84:87], v[144:147], v[212:215]
    v_mfma_f32_16x16x32_bf16 v[216:219], a[80:83], v[148:151], v[216:219]
    ds_read_b128 v[84:87], v14 offset:33792
    v_mfma_f32_16x16x32_bf16 v[220:223], a[84:87], v[148:151], v[220:223]
    buffer_load_dword v29, v28, s[12:15], s29 offen
    v_mfma_f32_16x16x32_bf16 v[208:211], a[88:91], v[152:155], v[208:211]
    ds_read_b128 v[88:91], v15 offset:1024
    v_mfma_f32_16x16x32_bf16 v[212:215], a[92:95], v[152:155], v[212:215]
    v_mfma_f32_16x16x32_bf16 v[216:219], a[88:91], v[156:159], v[216:219]
    ds_read_b128 v[92:95], v15 offset:33792
    v_mfma_f32_16x16x32_bf16 v[220:223], a[92:95], v[156:159], v[220:223]
    buffer_store_dwordx4 v[32:35], v36, s[8:11], s34 offen sc1
    s_waitcnt lgkmcnt(12)
    v_mfma_f32_16x16x32_bf16 v[208:211], a[96:99], v[160:163], v[208:211]
    ds_read_b128 v[96:99], v12 offset:1280
    v_mfma_f32_16x16x32_bf16 v[212:215], a[100:103], v[160:163], v[212:215]
    v_mfma_f32_16x16x32_bf16 v[216:219], a[96:99], v[164:167], v[216:219]
    ds_read_b128 v[100:103], v12 offset:34048
    v_mfma_f32_16x16x32_bf16 v[220:223], a[100:103], v[164:167], v[220:223]
    v_mfma_f32_16x16x32_bf16 v[208:211], a[104:107], v[168:171], v[208:211]
    ds_read_b128 v[104:107], v13 offset:1280
    v_mfma_f32_16x16x32_bf16 v[212:215], a[108:111], v[168:171], v[212:215]
    v_mfma_f32_16x16x32_bf16 v[216:219], a[104:107], v[172:175], v[216:219]
    ds_read_b128 v[108:111], v13 offset:34048
    v_mfma_f32_16x16x32_bf16 v[220:223], a[108:111], v[172:175], v[220:223]
    s_waitcnt lgkmcnt(12)
    v_mfma_f32_16x16x32_bf16 v[208:211], a[112:115], v[176:179], v[208:211]
    ds_read_b128 v[112:115], v14 offset:1280
    v_mfma_f32_16x16x32_bf16 v[212:215], a[116:119], v[176:179], v[212:215]
    v_mfma_f32_16x16x32_bf16 v[216:219], a[112:115], v[180:183], v[216:219]
    ds_read_b128 v[116:119], v14 offset:34048
    v_mfma_f32_16x16x32_bf16 v[220:223], a[116:119], v[180:183], v[220:223]
    v_mfma_f32_16x16x32_bf16 v[208:211], a[120:123], v[184:187], v[208:211]
    ds_read_b128 v[120:123], v15 offset:1280
    v_mfma_f32_16x16x32_bf16 v[212:215], a[124:127], v[184:187], v[212:215]
    v_mfma_f32_16x16x32_bf16 v[216:219], a[120:123], v[188:191], v[216:219]
    ds_read_b128 v[124:127], v15 offset:34048
    v_mfma_f32_16x16x32_bf16 v[220:223], a[124:127], v[188:191], v[220:223]
    s_waitcnt lgkmcnt(12)
    v_mfma_f32_16x16x32_bf16 v[208:211], a[128:131], v[64:67], v[208:211]
    ds_read_b128 v[128:131], v12 offset:1536
    v_mfma_f32_16x16x32_bf16 v[212:215], a[132:135], v[64:67], v[212:215]
    v_mfma_f32_16x16x32_bf16 v[216:219], a[128:131], v[68:71], v[216:219]
    ds_read_b128 v[132:135], v12 offset:34304
    v_mfma_f32_16x16x32_bf16 v[220:223], a[132:135], v[68:71], v[220:223]
    v_mfma_f32_16x16x32_bf16 v[208:211], a[136:139], v[72:75], v[208:211]
    ds_read_b128 v[136:139], v13 offset:1536
    v_mfma_f32_16x16x32_bf16 v[212:215], a[140:143], v[72:75], v[212:215]
    s_add_u32 s37, s28, 5
    v_mfma_f32_16x16x32_bf16 v[216:219], a[136:139], v[76:79], v[216:219]
    ds_read_b128 v[140:143], v13 offset:34304
    v_mfma_f32_16x16x32_bf16 v[220:223], a[140:143], v[76:79], v[220:223]
    s_bitcmp1_b32 s37, 0
    s_cselect_b32 s4, 0x84000, 0
    s_waitcnt lgkmcnt(12)
    v_mfma_f32_16x16x32_bf16 v[208:211], a[144:147], v[80:83], v[208:211]
    ds_read_b128 v[144:147], v14 offset:1536
    v_mfma_f32_16x16x32_bf16 v[212:215], a[148:151], v[80:83], v[212:215]
    s_xor_b32 s34, s35, s4
    v_mfma_f32_16x16x32_bf16 v[216:219], a[144:147], v[84:87], v[216:219]
    ds_read_b128 v[148:151], v14 offset:34304
    v_mfma_f32_16x16x32_bf16 v[220:223], a[148:151], v[84:87], v[220:223]
    s_bitcmp1_b32 s37, 1
    s_cselect_b32 s4, 0x101000, 0
    v_mfma_f32_16x16x32_bf16 v[208:211], a[152:155], v[88:91], v[208:211]
    ds_read_b128 v[152:155], v15 offset:1536
    v_mfma_f32_16x16x32_bf16 v[212:215], a[156:159], v[88:91], v[212:215]
    s_xor_b32 s34, s34, s4
    s_lshr_b32 s37, s37, 2
    v_mfma_f32_16x16x32_bf16 v[216:219], a[152:155], v[92:95], v[216:219]
    ds_read_b128 v[156:159], v15 offset:34304
    v_mfma_f32_16x16x32_bf16 v[220:223], a[156:159], v[92:95], v[220:223]
    s_bitcmp1_b32 s63, s37
    s_cselect_b32 s4, 0x2000, 0
    s_waitcnt lgkmcnt(12)
    v_mfma_f32_16x16x32_bf16 v[208:211], a[160:163], v[96:99], v[208:211]
    ds_read_b128 v[160:163], v12 offset:1792
    v_mfma_f32_16x16x32_bf16 v[212:215], a[164:167], v[96:99], v[212:215]
    s_xor_b32 s34, s34, s4
    s_lshl_b32 s37, s37, 21
    v_mfma_f32_16x16x32_bf16 v[216:219], a[160:163], v[100:103], v[216:219]
    ds_read_b128 v[164:167], v12 offset:34560
    v_mfma_f32_16x16x32_bf16 v[220:223], a[164:167], v[100:103], v[220:223]
    s_add_u32 s34, s34, s37
    v_mfma_f32_16x16x32_bf16 v[208:211], a[168:171], v[104:107], v[208:211]
    ds_read_b128 v[168:171], v13 offset:1792
    v_mfma_f32_16x16x32_bf16 v[212:215], a[172:175], v[104:107], v[212:215]
    v_mfma_f32_16x16x32_bf16 v[216:219], a[168:171], v[108:111], v[216:219]
    ds_read_b128 v[172:175], v13 offset:34560
    v_mfma_f32_16x16x32_bf16 v[220:223], a[172:175], v[108:111], v[220:223]
    s_waitcnt lgkmcnt(12)
    v_mfma_f32_16x16x32_bf16 v[208:211], a[176:179], v[112:115], v[208:211]
    ds_read_b128 v[176:179], v14 offset:1792
    v_mfma_f32_16x16x32_bf16 v[212:215], a[180:183], v[112:115], v[212:215]
    s_waitcnt vmcnt(7)
    v_mov_b32 v27, s28
    s_mov_b64 exec, 1
    buffer_store_dword v27, v26, s[8:11], s94 offen sc1
    s_mov_b64 exec, -1
    v_mfma_f32_16x16x32_bf16 v[216:219], a[176:179], v[116:119], v[216:219]
    ds_read_b128 v[180:183], v14 offset:34560
    v_mfma_f32_16x16x32_bf16 v[220:223], a[180:183], v[116:119], v[220:223]
    v_mfma_f32_16x16x32_bf16 v[208:211], a[184:187], v[120:123], v[208:211]
    ds_read_b128 v[184:187], v15 offset:1792
    v_mfma_f32_16x16x32_bf16 v[212:215], a[188:191], v[120:123], v[212:215]
    s_add_u32 s28, s28, 1
    v_mfma_f32_16x16x32_bf16 v[216:219], a[184:187], v[124:127], v[216:219]
    ds_read_b128 v[188:191], v15 offset:34560
    v_mfma_f32_16x16x32_bf16 v[220:223], a[188:191], v[124:127], v[220:223]
    s_waitcnt lgkmcnt(12)
    v_mfma_f32_16x16x32_bf16 v[208:211], a[192:195], v[128:131], v[208:211]
    v_mfma_f32_16x16x32_bf16 v[212:215], a[196:199], v[128:131], v[212:215]
    v_mfma_f32_16x16x32_bf16 v[216:219], a[192:195], v[132:135], v[216:219]
    v_mfma_f32_16x16x32_bf16 v[220:223], a[196:199], v[132:135], v[220:223]
    v_mfma_f32_16x16x32_bf16 v[208:211], a[200:203], v[136:139], v[208:211]
    v_mfma_f32_16x16x32_bf16 v[212:215], a[204:207], v[136:139], v[212:215]
    s_add_u32 s29, s29, 0x10000
    s_and_b32 s29, s29, 0x3fffff
    v_mfma_f32_16x16x32_bf16 v[216:219], a[200:203], v[140:143], v[216:219]
    v_mfma_f32_16x16x32_bf16 v[220:223], a[204:207], v[140:143], v[220:223]
    s_waitcnt vmcnt(3) lgkmcnt(0)
    s_barrier
    v_mfma_f32_16x16x32_bf16 v[208:211], a[208:211], v[144:147], v[208:211]
    ds_read_b128 v[64:67], v8 offset:0
    ds_read_b128 v[68:71], v8 offset:32768
    v_mfma_f32_16x16x32_bf16 v[212:215], a[212:215], v[144:147], v[212:215]
    s_add_u32 m0, s6, 65536
    v_mfma_f32_16x16x32_bf16 v[216:219], a[208:211], v[148:151], v[216:219]
    ds_read_b128 v[72:75], v9 offset:0
    ds_read_b128 v[76:79], v9 offset:32768
    v_mfma_f32_16x16x32_bf16 v[220:223], a[212:215], v[148:151], v[220:223]
    buffer_load_dwordx4 v16, s[12:15], s29 offen offset:0 lds
    v_mfma_f32_16x16x32_bf16 v[208:211], a[216:219], v[152:155], v[208:211]
    ds_read_b128 v[80:83], v10 offset:0
    ds_read_b128 v[84:87], v10 offset:32768
    v_mfma_f32_16x16x32_bf16 v[212:215], a[220:223], v[152:155], v[212:215]
    v_mfma_f32_16x16x32_bf16 v[216:219], a[216:219], v[156:159], v[216:219]
    ds_read_b128 v[88:91], v11 offset:0
    ds_read_b128 v[92:95], v11 offset:32768
    v_mfma_f32_16x16x32_bf16 v[220:223], a[220:223], v[156:159], v[220:223]
    buffer_load_dwordx4 v16, s[12:15], s29 offen offset:1024 lds
    v_mfma_f32_16x16x32_bf16 v[208:211], a[224:227], v[160:163], v[208:211]
    ds_read_b128 v[96:99], v8 offset:256
    v_mfma_f32_16x16x32_bf16 v[212:215], a[228:231], v[160:163], v[212:215]
    v_mfma_f32_16x16x32_bf16 v[216:219], a[224:227], v[164:167], v[216:219]
    ds_read_b128 v[100:103], v8 offset:33024
    v_mfma_f32_16x16x32_bf16 v[220:223], a[228:231], v[164:167], v[220:223]
    buffer_load_dwordx4 v17, s[12:15], s29 offen offset:2048 lds
    v_mfma_f32_16x16x32_bf16 v[208:211], a[232:235], v[168:171], v[208:211]
    ds_read_b128 v[104:107], v9 offset:256
    v_mfma_f32_16x16x32_bf16 v[212:215], a[236:239], v[168:171], v[212:215]
    v_mfma_f32_16x16x32_bf16 v[216:219], a[232:235], v[172:175], v[216:219]
    ds_read_b128 v[108:111], v9 offset:33024
    v_mfma_f32_16x16x32_bf16 v[220:223], a[236:239], v[172:175], v[220:223]
    buffer_load_dwordx4 v17, s[12:15], s29 offen offset:3072 lds
    v_mfma_f32_16x16x32_bf16 v[208:211], a[240:243], v[176:179], v[208:211]
    ds_read_b128 v[112:115], v10 offset:256
    v_mfma_f32_16x16x32_bf16 v[212:215], a[244:247], v[176:179], v[212:215]
    s_add_u32 m0, s6, 69632
    v_mfma_f32_16x16x32_bf16 v[216:219], a[240:243], v[180:183], v[216:219]
    ds_read_b128 v[116:119], v10 offset:33024
    v_mfma_f32_16x16x32_bf16 v[220:223], a[244:247], v[180:183], v[220:223]
    buffer_load_dwordx4 v18, s[12:15], s29 offen offset:0 lds
    v_mfma_f32_16x16x32_bf16 v[208:211], a[248:251], v[184:187], v[208:211]
    ds_read_b128 v[120:123], v11 offset:256
    v_mfma_f32_16x16x32_bf16 v[212:215], a[252:255], v[184:187], v[212:215]
    v_mfma_f32_16x16x32_bf16 v[216:219], a[248:251], v[188:191], v[216:219]
    ds_read_b128 v[124:127], v11 offset:33024
    v_mfma_f32_16x16x32_bf16 v[220:223], a[252:255], v[188:191], v[220:223]
    buffer_load_dwordx4 v18, s[12:15], s29 offen offset:1024 lds
    s_cmp_lt_u32 s28, 64
    s_cbranch_scc1 .ql_405
    s_branch .qe_404
.vt_403:
.p2align 6
.ql_406:
    s_waitcnt lgkmcnt(12)
    v_mfma_f32_16x16x32_bf16 v[192:195], v[64:67], a[0:3], 0
    ds_read_b128 v[128:131], v8 offset:512
    v_mfma_f32_16x16x32_bf16 v[200:203], v[64:67], a[4:7], 0
    v_mfma_f32_16x16x32_bf16 v[196:199], v[68:71], a[0:3], 0
    ds_read_b128 v[132:135], v8 offset:33280
    v_mfma_f32_16x16x32_bf16 v[204:207], v[68:71], a[4:7], 0
    buffer_load_dwordx4 v19, s[12:15], s29 offen offset:2048 lds
    v_mfma_f32_16x16x32_bf16 v[192:195], v[72:75], a[8:11], v[192:195]
    ds_read_b128 v[136:139], v9 offset:512
    v_mfma_f32_16x16x32_bf16 v[200:203], v[72:75], a[12:15], v[200:203]
    v_cvt_pk_bf16_f32 v224, v208, v209
    v_cvt_pk_bf16_f32 v225, v210, v211
    v_mfma_f32_16x16x32_bf16 v[196:199], v[76:79], a[8:11], v[196:199]
    ds_read_b128 v[140:143], v9 offset:33280
    v_mfma_f32_16x16x32_bf16 v[204:207], v[76:79], a[12:15], v[204:207]
    buffer_load_dwordx4 v19, s[12:15], s29 offen offset:3072 lds
    s_waitcnt lgkmcnt(12)
    v_mfma_f32_16x16x32_bf16 v[192:195], v[80:83], a[16:19], v[192:195]
    ds_read_b128 v[144:147], v10 offset:512
    v_mfma_f32_16x16x32_bf16 v[200:203], v[80:83], a[20:23], v[200:203]
    s_add_u32 m0, s6, 73728
    v_cvt_pk_bf16_f32 v226, v212, v213
    v_cvt_pk_bf16_f32 v227, v214, v215
    v_mfma_f32_16x16x32_bf16 v[196:199], v[84:87], a[16:19], v[196:199]
    ds_read_b128 v[148:151], v10 offset:33280
    v_mfma_f32_16x16x32_bf16 v[204:207], v[84:87], a[20:23], v[204:207]
    buffer_load_dwordx4 v20, s[12:15], s29 offen offset:0 lds
    v_mfma_f32_16x16x32_bf16 v[192:195], v[88:91], a[24:27], v[192:195]
    ds_read_b128 v[152:155], v11 offset:512
    v_cvt_pk_bf16_f32 v228, v216, v217
    v_mfma_f32_16x16x32_bf16 v[200:203], v[88:91], a[28:31], v[200:203]
    buffer_store_dwordx4 v[224:227], v24, s[8:11], s30 offen sc1
    v_mfma_f32_16x16x32_bf16 v[196:199], v[92:95], a[24:27], v[196:199]
    ds_read_b128 v[156:159], v11 offset:33280
    v_cvt_pk_bf16_f32 v229, v218, v219
    v_mfma_f32_16x16x32_bf16 v[204:207], v[92:95], a[28:31], v[204:207]
    buffer_load_dwordx4 v20, s[12:15], s29 offen offset:1024 lds
    s_waitcnt lgkmcnt(12)
    v_mfma_f32_16x16x32_bf16 v[192:195], v[96:99], a[32:35], v[192:195]
    ds_read_b128 v[160:163], v8 offset:768
    v_mfma_f32_16x16x32_bf16 v[200:203], v[96:99], a[36:39], v[200:203]
    v_cvt_pk_bf16_f32 v230, v220, v221
    v_cvt_pk_bf16_f32 v231, v222, v223
    v_mfma_f32_16x16x32_bf16 v[196:199], v[100:103], a[32:35], v[196:199]
    ds_read_b128 v[164:167], v8 offset:33536
    v_mfma_f32_16x16x32_bf16 v[204:207], v[100:103], a[36:39], v[204:207]
    buffer_load_dwordx4 v21, s[12:15], s29 offen offset:2048 lds
    v_mfma_f32_16x16x32_bf16 v[192:195], v[104:107], a[40:43], v[192:195]
    ds_read_b128 v[168:171], v9 offset:768
    v_mfma_f32_16x16x32_bf16 v[200:203], v[104:107], a[44:47], v[200:203]
    buffer_store_dwordx4 v[228:231], v25, s[8:11], s30 offen sc1
    v_mfma_f32_16x16x32_bf16 v[196:199], v[108:111], a[40:43], v[196:199]
    ds_read_b128 v[172:175], v9 offset:33536
    v_mfma_f32_16x16x32_bf16 v[204:207], v[108:111], a[44:47], v[204:207]
    buffer_load_dwordx4 v21, s[12:15], s29 offen offset:3072 lds
    s_waitcnt lgkmcnt(12)
    v_mfma_f32_16x16x32_bf16 v[192:195], v[112:115], a[48:51], v[192:195]
    ds_read_b128 v[176:179], v10 offset:768
    v_mfma_f32_16x16x32_bf16 v[200:203], v[112:115], a[52:55], v[200:203]
    s_add_u32 m0, s6, 77824
    s_mov_b32 s30, s31
    v_mfma_f32_16x16x32_bf16 v[196:199], v[116:119], a[48:51], v[196:199]
    ds_read_b128 v[180:183], v10 offset:33536
    v_mfma_f32_16x16x32_bf16 v[204:207], v[116:119], a[52:55], v[204:207]
    buffer_load_dwordx4 v22, s[12:15], s29 offen offset:0 lds
    v_mfma_f32_16x16x32_bf16 v[192:195], v[120:123], a[56:59], v[192:195]
    ds_read_b128 v[184:187], v11 offset:768
    v_mfma_f32_16x16x32_bf16 v[200:203], v[120:123], a[60:63], v[200:203]
    s_add_u32 s31, s31, 262144
    v_mfma_f32_16x16x32_bf16 v[196:199], v[124:127], a[56:59], v[196:199]
    ds_read_b128 v[188:191], v11 offset:33536
    v_mfma_f32_16x16x32_bf16 v[204:207], v[124:127], a[60:63], v[204:207]
    buffer_load_dwordx4 v22, s[12:15], s29 offen offset:1024 lds
    s_waitcnt lgkmcnt(12)
    v_mfma_f32_16x16x32_bf16 v[192:195], v[128:131], a[64:67], v[192:195]
    ds_read_b128 v[64:67], v8 offset:1024
    v_mfma_f32_16x16x32_bf16 v[200:203], v[128:131], a[68:71], v[200:203]
    v_mfma_f32_16x16x32_bf16 v[196:199], v[132:135], a[64:67], v[196:199]
    ds_read_b128 v[68:71], v8 offset:33792
    v_mfma_f32_16x16x32_bf16 v[204:207], v[132:135], a[68:71], v[204:207]
    buffer_load_dwordx4 v23, s[12:15], s29 offen offset:2048 lds
    v_mfma_f32_16x16x32_bf16 v[192:195], v[136:139], a[72:75], v[192:195]
    ds_read_b128 v[72:75], v9 offset:1024
    v_mfma_f32_16x16x32_bf16 v[200:203], v[136:139], a[76:79], v[200:203]
    v_mfma_f32_16x16x32_bf16 v[196:199], v[140:143], a[72:75], v[196:199]
    ds_read_b128 v[76:79], v9 offset:33792
    v_mfma_f32_16x16x32_bf16 v[204:207], v[140:143], a[76:79], v[204:207]
    buffer_load_dwordx4 v23, s[12:15], s29 offen offset:3072 lds
    s_waitcnt lgkmcnt(12)
    v_mfma_f32_16x16x32_bf16 v[192:195], v[144:147], a[80:83], v[192:195]
    ds_read_b128 v[80:83], v10 offset:1024
    v_mfma_f32_16x16x32_bf16 v[200:203], v[144:147], a[84:87], v[200:203]
    v_mfma_f32_16x16x32_bf16 v[196:199], v[148:151], a[80:83], v[196:199]
    ds_read_b128 v[84:87], v10 offset:33792
    v_mfma_f32_16x16x32_bf16 v[204:207], v[148:151], a[84:87], v[204:207]
    buffer_load_dword v29, v28, s[12:15], s29 offen
    v_mfma_f32_16x16x32_bf16 v[192:195], v[152:155], a[88:91], v[192:195]
    ds_read_b128 v[88:91], v11 offset:1024
    v_mfma_f32_16x16x32_bf16 v[200:203], v[152:155], a[92:95], v[200:203]
    v_mfma_f32_16x16x32_bf16 v[196:199], v[156:159], a[88:91], v[196:199]
    ds_read_b128 v[92:95], v11 offset:33792
    v_mfma_f32_16x16x32_bf16 v[204:207], v[156:159], a[92:95], v[204:207]
    buffer_store_dwordx4 v[32:35], v36, s[8:11], s34 offen sc1
    s_waitcnt lgkmcnt(12)
    v_mfma_f32_16x16x32_bf16 v[192:195], v[160:163], a[96:99], v[192:195]
    ds_read_b128 v[96:99], v8 offset:1280
    v_mfma_f32_16x16x32_bf16 v[200:203], v[160:163], a[100:103], v[200:203]
    v_mfma_f32_16x16x32_bf16 v[196:199], v[164:167], a[96:99], v[196:199]
    ds_read_b128 v[100:103], v8 offset:34048
    v_mfma_f32_16x16x32_bf16 v[204:207], v[164:167], a[100:103], v[204:207]
    v_mfma_f32_16x16x32_bf16 v[192:195], v[168:171], a[104:107], v[192:195]
    ds_read_b128 v[104:107], v9 offset:1280
    v_mfma_f32_16x16x32_bf16 v[200:203], v[168:171], a[108:111], v[200:203]
    v_mfma_f32_16x16x32_bf16 v[196:199], v[172:175], a[104:107], v[196:199]
    ds_read_b128 v[108:111], v9 offset:34048
    v_mfma_f32_16x16x32_bf16 v[204:207], v[172:175], a[108:111], v[204:207]
    s_waitcnt lgkmcnt(12)
    v_mfma_f32_16x16x32_bf16 v[192:195], v[176:179], a[112:115], v[192:195]
    ds_read_b128 v[112:115], v10 offset:1280
    v_mfma_f32_16x16x32_bf16 v[200:203], v[176:179], a[116:119], v[200:203]
    v_mfma_f32_16x16x32_bf16 v[196:199], v[180:183], a[112:115], v[196:199]
    ds_read_b128 v[116:119], v10 offset:34048
    v_mfma_f32_16x16x32_bf16 v[204:207], v[180:183], a[116:119], v[204:207]
    v_mfma_f32_16x16x32_bf16 v[192:195], v[184:187], a[120:123], v[192:195]
    ds_read_b128 v[120:123], v11 offset:1280
    v_mfma_f32_16x16x32_bf16 v[200:203], v[184:187], a[124:127], v[200:203]
    v_mfma_f32_16x16x32_bf16 v[196:199], v[188:191], a[120:123], v[196:199]
    ds_read_b128 v[124:127], v11 offset:34048
    v_mfma_f32_16x16x32_bf16 v[204:207], v[188:191], a[124:127], v[204:207]
    s_waitcnt lgkmcnt(12)
    v_mfma_f32_16x16x32_bf16 v[192:195], v[64:67], a[128:131], v[192:195]
    ds_read_b128 v[128:131], v8 offset:1536
    v_mfma_f32_16x16x32_bf16 v[200:203], v[64:67], a[132:135], v[200:203]
    v_mfma_f32_16x16x32_bf16 v[196:199], v[68:71], a[128:131], v[196:199]
    ds_read_b128 v[132:135], v8 offset:34304
    v_mfma_f32_16x16x32_bf16 v[204:207], v[68:71], a[132:135], v[204:207]
    v_mfma_f32_16x16x32_bf16 v[192:195], v[72:75], a[136:139], v[192:195]
    ds_read_b128 v[136:139], v9 offset:1536
    v_mfma_f32_16x16x32_bf16 v[200:203], v[72:75], a[140:143], v[200:203]
    s_add_u32 s37, s28, 5
    v_mfma_f32_16x16x32_bf16 v[196:199], v[76:79], a[136:139], v[196:199]
    ds_read_b128 v[140:143], v9 offset:34304
    v_mfma_f32_16x16x32_bf16 v[204:207], v[76:79], a[140:143], v[204:207]
    s_bitcmp1_b32 s37, 0
    s_cselect_b32 s4, 0x84000, 0
    s_waitcnt lgkmcnt(12)
    v_mfma_f32_16x16x32_bf16 v[192:195], v[80:83], a[144:147], v[192:195]
    ds_read_b128 v[144:147], v10 offset:1536
    v_mfma_f32_16x16x32_bf16 v[200:203], v[80:83], a[148:151], v[200:203]
    s_xor_b32 s34, s35, s4
    v_mfma_f32_16x16x32_bf16 v[196:199], v[84:87], a[144:147], v[196:199]
    ds_read_b128 v[148:151], v10 offset:34304
    v_mfma_f32_16x16x32_bf16 v[204:207], v[84:87], a[148:151], v[204:207]
    s_bitcmp1_b32 s37, 1
    s_cselect_b32 s4, 0x101000, 0
    v_mfma_f32_16x16x32_bf16 v[192:195], v[88:91], a[152:155], v[192:195]
    ds_read_b128 v[152:155], v11 offset:1536
    v_mfma_f32_16x16x32_bf16 v[200:203], v[88:91], a[156:159], v[200:203]
    s_xor_b32 s34, s34, s4
    s_lshr_b32 s37, s37, 2
    v_mfma_f32_16x16x32_bf16 v[196:199], v[92:95], a[152:155], v[196:199]
    ds_read_b128 v[156:159], v11 offset:34304
    v_mfma_f32_16x16x32_bf16 v[204:207], v[92:95], a[156:159], v[204:207]
    s_bitcmp1_b32 s63, s37
    s_cselect_b32 s4, 0x2000, 0
    s_waitcnt lgkmcnt(12)
    v_mfma_f32_16x16x32_bf16 v[192:195], v[96:99], a[160:163], v[192:195]
    ds_read_b128 v[160:163], v8 offset:1792
    v_mfma_f32_16x16x32_bf16 v[200:203], v[96:99], a[164:167], v[200:203]
    s_xor_b32 s34, s34, s4
    s_lshl_b32 s37, s37, 21
    v_mfma_f32_16x16x32_bf16 v[196:199], v[100:103], a[160:163], v[196:199]
    ds_read_b128 v[164:167], v8 offset:34560
    v_mfma_f32_16x16x32_bf16 v[204:207], v[100:103], a[164:167], v[204:207]
    s_add_u32 s34, s34, s37
    v_mfma_f32_16x16x32_bf16 v[192:195], v[104:107], a[168:171], v[192:195]
    ds_read_b128 v[168:171], v9 offset:1792
    v_mfma_f32_16x16x32_bf16 v[200:203], v[104:107], a[172:175], v[200:203]
    v_mfma_f32_16x16x32_bf16 v[196:199], v[108:111], a[168:171], v[196:199]
    ds_read_b128 v[172:175], v9 offset:34560
    v_mfma_f32_16x16x32_bf16 v[204:207], v[108:111], a[172:175], v[204:207]
    s_waitcnt lgkmcnt(12)
    v_mfma_f32_16x16x32_bf16 v[192:195], v[112:115], a[176:179], v[192:195]
    ds_read_b128 v[176:179], v10 offset:1792
    v_mfma_f32_16x16x32_bf16 v[200:203], v[112:115], a[180:183], v[200:203]
    s_waitcnt vmcnt(7)
    v_mov_b32 v27, s28
    s_mov_b64 exec, 1
    buffer_store_dword v27, v26, s[8:11], s94 offen sc1
    s_mov_b64 exec, -1
    v_mfma_f32_16x16x32_bf16 v[196:199], v[116:119], a[176:179], v[196:199]
    ds_read_b128 v[180:183], v10 offset:34560
    v_mfma_f32_16x16x32_bf16 v[204:207], v[116:119], a[180:183], v[204:207]
    v_mfma_f32_16x16x32_bf16 v[192:195], v[120:123], a[184:187], v[192:195]
    ds_read_b128 v[184:187], v11 offset:1792
    v_mfma_f32_16x16x32_bf16 v[200:203], v[120:123], a[188:191], v[200:203]
    s_add_u32 s28, s28, 1
    v_mfma_f32_16x16x32_bf16 v[196:199], v[124:127], a[184:187], v[196:199]
    ds_read_b128 v[188:191], v11 offset:34560
    v_mfma_f32_16x16x32_bf16 v[204:207], v[124:127], a[188:191], v[204:207]
    s_waitcnt lgkmcnt(12)
    v_mfma_f32_16x16x32_bf16 v[192:195], v[128:131], a[192:195], v[192:195]
    v_mfma_f32_16x16x32_bf16 v[200:203], v[128:131], a[196:199], v[200:203]
    v_mfma_f32_16x16x32_bf16 v[196:199], v[132:135], a[192:195], v[196:199]
    v_mfma_f32_16x16x32_bf16 v[204:207], v[132:135], a[196:199], v[204:207]
    v_mfma_f32_16x16x32_bf16 v[192:195], v[136:139], a[200:203], v[192:195]
    v_mfma_f32_16x16x32_bf16 v[200:203], v[136:139], a[204:207], v[200:203]
    s_add_u32 s29, s29, 0x10000
    s_and_b32 s29, s29, 0x3fffff
    v_mfma_f32_16x16x32_bf16 v[196:199], v[140:143], a[200:203], v[196:199]
    v_mfma_f32_16x16x32_bf16 v[204:207], v[140:143], a[204:207], v[204:207]
    s_waitcnt vmcnt(3) lgkmcnt(0)
    s_barrier
    v_mfma_f32_16x16x32_bf16 v[192:195], v[144:147], a[208:211], v[192:195]
    ds_read_b128 v[64:67], v12 offset:0
    ds_read_b128 v[68:71], v12 offset:32768
    v_mfma_f32_16x16x32_bf16 v[200:203], v[144:147], a[212:215], v[200:203]
    s_add_u32 m0, s6, 0
    v_mfma_f32_16x16x32_bf16 v[196:199], v[148:151], a[208:211], v[196:199]
    ds_read_b128 v[72:75], v13 offset:0
    ds_read_b128 v[76:79], v13 offset:32768
    v_mfma_f32_16x16x32_bf16 v[204:207], v[148:151], a[212:215], v[204:207]
    buffer_load_dwordx4 v16, s[12:15], s29 offen offset:0 lds
    v_mfma_f32_16x16x32_bf16 v[192:195], v[152:155], a[216:219], v[192:195]
    ds_read_b128 v[80:83], v14 offset:0
    ds_read_b128 v[84:87], v14 offset:32768
    v_mfma_f32_16x16x32_bf16 v[200:203], v[152:155], a[220:223], v[200:203]
    v_mfma_f32_16x16x32_bf16 v[196:199], v[156:159], a[216:219], v[196:199]
    ds_read_b128 v[88:91], v15 offset:0
    ds_read_b128 v[92:95], v15 offset:32768
    v_mfma_f32_16x16x32_bf16 v[204:207], v[156:159], a[220:223], v[204:207]
    buffer_load_dwordx4 v16, s[12:15], s29 offen offset:1024 lds
    v_mfma_f32_16x16x32_bf16 v[192:195], v[160:163], a[224:227], v[192:195]
    ds_read_b128 v[96:99], v12 offset:256
    v_mfma_f32_16x16x32_bf16 v[200:203], v[160:163], a[228:231], v[200:203]
    v_mfma_f32_16x16x32_bf16 v[196:199], v[164:167], a[224:227], v[196:199]
    ds_read_b128 v[100:103], v12 offset:33024
    v_mfma_f32_16x16x32_bf16 v[204:207], v[164:167], a[228:231], v[204:207]
    buffer_load_dwordx4 v17, s[12:15], s29 offen offset:2048 lds
    v_mfma_f32_16x16x32_bf16 v[192:195], v[168:171], a[232:235], v[192:195]
    ds_read_b128 v[104:107], v13 offset:256
    v_mfma_f32_16x16x32_bf16 v[200:203], v[168:171], a[236:239], v[200:203]
    v_mfma_f32_16x16x32_bf16 v[196:199], v[172:175], a[232:235], v[196:199]
    ds_read_b128 v[108:111], v13 offset:33024
    v_mfma_f32_16x16x32_bf16 v[204:207], v[172:175], a[236:239], v[204:207]
    buffer_load_dwordx4 v17, s[12:15], s29 offen offset:3072 lds
    v_mfma_f32_16x16x32_bf16 v[192:195], v[176:179], a[240:243], v[192:195]
    ds_read_b128 v[112:115], v14 offset:256
    v_mfma_f32_16x16x32_bf16 v[200:203], v[176:179], a[244:247], v[200:203]
    s_add_u32 m0, s6, 4096
    v_mfma_f32_16x16x32_bf16 v[196:199], v[180:183], a[240:243], v[196:199]
    ds_read_b128 v[116:119], v14 offset:33024
    v_mfma_f32_16x16x32_bf16 v[204:207], v[180:183], a[244:247], v[204:207]
    buffer_load_dwordx4 v18, s[12:15], s29 offen offset:0 lds
    v_mfma_f32_16x16x32_bf16 v[192:195], v[184:187], a[248:251], v[192:195]
    ds_read_b128 v[120:123], v15 offset:256
    v_mfma_f32_16x16x32_bf16 v[200:203], v[184:187], a[252:255], v[200:203]
    v_mfma_f32_16x16x32_bf16 v[196:199], v[188:191], a[248:251], v[196:199]
    ds_read_b128 v[124:127], v15 offset:33024
    v_mfma_f32_16x16x32_bf16 v[204:207], v[188:191], a[252:255], v[204:207]
    buffer_load_dwordx4 v18, s[12:15], s29 offen offset:1024 lds
    s_waitcnt lgkmcnt(12)
    v_mfma_f32_16x16x32_bf16 v[208:211], v[64:67], a[0:3], 0
    ds_read_b128 v[128:131], v12 offset:512
    v_mfma_f32_16x16x32_bf16 v[216:219], v[64:67], a[4:7], 0
    v_mfma_f32_16x16x32_bf16 v[212:215], v[68:71], a[0:3], 0
    ds_read_b128 v[132:135], v12 offset:33280
    v_mfma_f32_16x16x32_bf16 v[220:223], v[68:71], a[4:7], 0
    buffer_load_dwordx4 v19, s[12:15], s29 offen offset:2048 lds
    v_mfma_f32_16x16x32_bf16 v[208:211], v[72:75], a[8:11], v[208:211]
    ds_read_b128 v[136:139], v13 offset:512
    v_mfma_f32_16x16x32_bf16 v[216:219], v[72:75], a[12:15], v[216:219]
    v_cvt_pk_bf16_f32 v224, v192, v193
    v_cvt_pk_bf16_f32 v225, v194, v195
    v_mfma_f32_16x16x32_bf16 v[212:215], v[76:79], a[8:11], v[212:215]
    ds_read_b128 v[140:143], v13 offset:33280
    v_mfma_f32_16x16x32_bf16 v[220:223], v[76:79], a[12:15], v[220:223]
    buffer_load_dwordx4 v19, s[12:15], s29 offen offset:3072 lds
    s_waitcnt lgkmcnt(12)
    v_mfma_f32_16x16x32_bf16 v[208:211], v[80:83], a[16:19], v[208:211]
    ds_read_b128 v[144:147], v14 offset:512
    v_mfma_f32_16x16x32_bf16 v[216:219], v[80:83], a[20:23], v[216:219]
    s_add_u32 m0, s6, 8192
    v_cvt_pk_bf16_f32 v226, v196, v197
    v_cvt_pk_bf16_f32 v227, v198, v199
    v_mfma_f32_16x16x32_bf16 v[212:215], v[84:87], a[16:19], v[212:215]
    ds_read_b128 v[148:151], v14 offset:33280
    v_mfma_f32_16x16x32_bf16 v[220:223], v[84:87], a[20:23], v[220:223]
    buffer_load_dwordx4 v20, s[12:15], s29 offen offset:0 lds
    v_mfma_f32_16x16x32_bf16 v[208:211], v[88:91], a[24:27], v[208:211]
    ds_read_b128 v[152:155], v15 offset:512
    v_cvt_pk_bf16_f32 v228, v200, v201
    v_mfma_f32_16x16x32_bf16 v[216:219], v[88:91], a[28:31], v[216:219]
    buffer_store_dwordx4 v[224:227], v24, s[8:11], s30 offen sc1
    v_mfma_f32_16x16x32_bf16 v[212:215], v[92:95], a[24:27], v[212:215]
    ds_read_b128 v[156:159], v15 offset:33280
    v_cvt_pk_bf16_f32 v229, v202, v203
    v_mfma_f32_16x16x32_bf16 v[220:223], v[92:95], a[28:31], v[220:223]
    buffer_load_dwordx4 v20, s[12:15], s29 offen offset:1024 lds
    s_waitcnt lgkmcnt(12)
    v_mfma_f32_16x16x32_bf16 v[208:211], v[96:99], a[32:35], v[208:211]
    ds_read_b128 v[160:163], v12 offset:768
    v_mfma_f32_16x16x32_bf16 v[216:219], v[96:99], a[36:39], v[216:219]
    v_cvt_pk_bf16_f32 v230, v204, v205
    v_cvt_pk_bf16_f32 v231, v206, v207
    v_mfma_f32_16x16x32_bf16 v[212:215], v[100:103], a[32:35], v[212:215]
    ds_read_b128 v[164:167], v12 offset:33536
    v_mfma_f32_16x16x32_bf16 v[220:223], v[100:103], a[36:39], v[220:223]
    buffer_load_dwordx4 v21, s[12:15], s29 offen offset:2048 lds
    v_mfma_f32_16x16x32_bf16 v[208:211], v[104:107], a[40:43], v[208:211]
    ds_read_b128 v[168:171], v13 offset:768
    v_mfma_f32_16x16x32_bf16 v[216:219], v[104:107], a[44:47], v[216:219]
    buffer_store_dwordx4 v[228:231], v25, s[8:11], s30 offen sc1
    v_mfma_f32_16x16x32_bf16 v[212:215], v[108:111], a[40:43], v[212:215]
    ds_read_b128 v[172:175], v13 offset:33536
    v_mfma_f32_16x16x32_bf16 v[220:223], v[108:111], a[44:47], v[220:223]
    buffer_load_dwordx4 v21, s[12:15], s29 offen offset:3072 lds
    s_waitcnt lgkmcnt(12)
    v_mfma_f32_16x16x32_bf16 v[208:211], v[112:115], a[48:51], v[208:211]
    ds_read_b128 v[176:179], v14 offset:768
    v_mfma_f32_16x16x32_bf16 v[216:219], v[112:115], a[52:55], v[216:219]
    s_add_u32 m0, s6, 12288
    s_mov_b32 s30, s31
    v_mfma_f32_16x16x32_bf16 v[212:215], v[116:119], a[48:51], v[212:215]
    ds_read_b128 v[180:183], v14 offset:33536
    v_mfma_f32_16x16x32_bf16 v[220:223], v[116:119], a[52:55], v[220:223]
    buffer_load_dwordx4 v22, s[12:15], s29 offen offset:0 lds
    v_mfma_f32_16x16x32_bf16 v[208:211], v[120:123], a[56:59], v[208:211]
    ds_read_b128 v[184:187], v15 offset:768
    v_mfma_f32_16x16x32_bf16 v[216:219], v[120:123], a[60:63], v[216:219]
    s_add_u32 s31, s31, 262144
    v_mfma_f32_16x16x32_bf16 v[212:215], v[124:127], a[56:59], v[212:215]
    ds_read_b128 v[188:191], v15 offset:33536
    v_mfma_f32_16x16x32_bf16 v[220:223], v[124:127], a[60:63], v[220:223]
    buffer_load_dwordx4 v22, s[12:15], s29 offen offset:1024 lds
    s_waitcnt lgkmcnt(12)
    v_mfma_f32_16x16x32_bf16 v[208:211], v[128:131], a[64:67], v[208:211]
    ds_read_b128 v[64:67], v12 offset:1024
    v_mfma_f32_16x16x32_bf16 v[216:219], v[128:131], a[68:71], v[216:219]
    v_mfma_f32_16x16x32_bf16 v[212:215], v[132:135], a[64:67], v[212:215]
    ds_read_b128 v[68:71], v12 offset:33792
    v_mfma_f32_16x16x32_bf16 v[220:223], v[132:135], a[68:71], v[220:223]
    buffer_load_dwordx4 v23, s[12:15], s29 offen offset:2048 lds
    v_mfma_f32_16x16x32_bf16 v[208:211], v[136:139], a[72:75], v[208:211]
    ds_read_b128 v[72:75], v13 offset:1024
    v_mfma_f32_16x16x32_bf16 v[216:219], v[136:139], a[76:79], v[216:219]
    v_mfma_f32_16x16x32_bf16 v[212:215], v[140:143], a[72:75], v[212:215]
    ds_read_b128 v[76:79], v13 offset:33792
    v_mfma_f32_16x16x32_bf16 v[220:223], v[140:143], a[76:79], v[220:223]
    buffer_load_dwordx4 v23, s[12:15], s29 offen offset:3072 lds
    s_waitcnt lgkmcnt(12)
    v_mfma_f32_16x16x32_bf16 v[208:211], v[144:147], a[80:83], v[208:211]
    ds_read_b128 v[80:83], v14 offset:1024
    v_mfma_f32_16x16x32_bf16 v[216:219], v[144:147], a[84:87], v[216:219]
    v_mfma_f32_16x16x32_bf16 v[212:215], v[148:151], a[80:83], v[212:215]
    ds_read_b128 v[84:87], v14 offset:33792
    v_mfma_f32_16x16x32_bf16 v[220:223], v[148:151], a[84:87], v[220:223]
    buffer_load_dword v29, v28, s[12:15], s29 offen
    v_mfma_f32_16x16x32_bf16 v[208:211], v[152:155], a[88:91], v[208:211]
    ds_read_b128 v[88:91], v15 offset:1024
    v_mfma_f32_16x16x32_bf16 v[216:219], v[152:155], a[92:95], v[216:219]
    v_mfma_f32_16x16x32_bf16 v[212:215], v[156:159], a[88:91], v[212:215]
    ds_read_b128 v[92:95], v15 offset:33792
    v_mfma_f32_16x16x32_bf16 v[220:223], v[156:159], a[92:95], v[220:223]
    buffer_store_dwordx4 v[32:35], v36, s[8:11], s34 offen sc1
    s_waitcnt lgkmcnt(12)
    v_mfma_f32_16x16x32_bf16 v[208:211], v[160:163], a[96:99], v[208:211]
    ds_read_b128 v[96:99], v12 offset:1280
    v_mfma_f32_16x16x32_bf16 v[216:219], v[160:163], a[100:103], v[216:219]
    v_mfma_f32_16x16x32_bf16 v[212:215], v[164:167], a[96:99], v[212:215]
    ds_read_b128 v[100:103], v12 offset:34048
    v_mfma_f32_16x16x32_bf16 v[220:223], v[164:167], a[100:103], v[220:223]
    v_mfma_f32_16x16x32_bf16 v[208:211], v[168:171], a[104:107], v[208:211]
    ds_read_b128 v[104:107], v13 offset:1280
    v_mfma_f32_16x16x32_bf16 v[216:219], v[168:171], a[108:111], v[216:219]
    v_mfma_f32_16x16x32_bf16 v[212:215], v[172:175], a[104:107], v[212:215]
    ds_read_b128 v[108:111], v13 offset:34048
    v_mfma_f32_16x16x32_bf16 v[220:223], v[172:175], a[108:111], v[220:223]
    s_waitcnt lgkmcnt(12)
    v_mfma_f32_16x16x32_bf16 v[208:211], v[176:179], a[112:115], v[208:211]
    ds_read_b128 v[112:115], v14 offset:1280
    v_mfma_f32_16x16x32_bf16 v[216:219], v[176:179], a[116:119], v[216:219]
    v_mfma_f32_16x16x32_bf16 v[212:215], v[180:183], a[112:115], v[212:215]
    ds_read_b128 v[116:119], v14 offset:34048
    v_mfma_f32_16x16x32_bf16 v[220:223], v[180:183], a[116:119], v[220:223]
    v_mfma_f32_16x16x32_bf16 v[208:211], v[184:187], a[120:123], v[208:211]
    ds_read_b128 v[120:123], v15 offset:1280
    v_mfma_f32_16x16x32_bf16 v[216:219], v[184:187], a[124:127], v[216:219]
    v_mfma_f32_16x16x32_bf16 v[212:215], v[188:191], a[120:123], v[212:215]
    ds_read_b128 v[124:127], v15 offset:34048
    v_mfma_f32_16x16x32_bf16 v[220:223], v[188:191], a[124:127], v[220:223]
    s_waitcnt lgkmcnt(12)
    v_mfma_f32_16x16x32_bf16 v[208:211], v[64:67], a[128:131], v[208:211]
    ds_read_b128 v[128:131], v12 offset:1536
    v_mfma_f32_16x16x32_bf16 v[216:219], v[64:67], a[132:135], v[216:219]
    v_mfma_f32_16x16x32_bf16 v[212:215], v[68:71], a[128:131], v[212:215]
    ds_read_b128 v[132:135], v12 offset:34304
    v_mfma_f32_16x16x32_bf16 v[220:223], v[68:71], a[132:135], v[220:223]
    v_mfma_f32_16x16x32_bf16 v[208:211], v[72:75], a[136:139], v[208:211]
    ds_read_b128 v[136:139], v13 offset:1536
    v_mfma_f32_16x16x32_bf16 v[216:219], v[72:75], a[140:143], v[216:219]
    s_add_u32 s37, s28, 5
    v_mfma_f32_16x16x32_bf16 v[212:215], v[76:79], a[136:139], v[212:215]
    ds_read_b128 v[140:143], v13 offset:34304
    v_mfma_f32_16x16x32_bf16 v[220:223], v[76:79], a[140:143], v[220:223]
    s_bitcmp1_b32 s37, 0
    s_cselect_b32 s4, 0x84000, 0
    s_waitcnt lgkmcnt(12)
    v_mfma_f32_16x16x32_bf16 v[208:211], v[80:83], a[144:147], v[208:211]
    ds_read_b128 v[144:147], v14 offset:1536
    v_mfma_f32_16x16x32_bf16 v[216:219], v[80:83], a[148:151], v[216:219]
    s_xor_b32 s34, s35, s4
    v_mfma_f32_16x16x32_bf16 v[212:215], v[84:87], a[144:147], v[212:215]
    ds_read_b128 v[148:151], v14 offset:34304
    v_mfma_f32_16x16x32_bf16 v[220:223], v[84:87], a[148:151], v[220:223]
    s_bitcmp1_b32 s37, 1
    s_cselect_b32 s4, 0x101000, 0
    v_mfma_f32_16x16x32_bf16 v[208:211], v[88:91], a[152:155], v[208:211]
    ds_read_b128 v[152:155], v15 offset:1536
    v_mfma_f32_16x16x32_bf16 v[216:219], v[88:91], a[156:159], v[216:219]
    s_xor_b32 s34, s34, s4
    s_lshr_b32 s37, s37, 2
    v_mfma_f32_16x16x32_bf16 v[212:215], v[92:95], a[152:155], v[212:215]
    ds_read_b128 v[156:159], v15 offset:34304
    v_mfma_f32_16x16x32_bf16 v[220:223], v[92:95], a[156:159], v[220:223]
    s_bitcmp1_b32 s63, s37
    s_cselect_b32 s4, 0x2000, 0
    s_waitcnt lgkmcnt(12)
    v_mfma_f32_16x16x32_bf16 v[208:211], v[96:99], a[160:163], v[208:211]
    ds_read_b128 v[160:163], v12 offset:1792
    v_mfma_f32_16x16x32_bf16 v[216:219], v[96:99], a[164:167], v[216:219]
    s_xor_b32 s34, s34, s4
    s_lshl_b32 s37, s37, 21
    v_mfma_f32_16x16x32_bf16 v[212:215], v[100:103], a[160:163], v[212:215]
    ds_read_b128 v[164:167], v12 offset:34560
    v_mfma_f32_16x16x32_bf16 v[220:223], v[100:103], a[164:167], v[220:223]
    s_add_u32 s34, s34, s37
    v_mfma_f32_16x16x32_bf16 v[208:211], v[104:107], a[168:171], v[208:211]
    ds_read_b128 v[168:171], v13 offset:1792
    v_mfma_f32_16x16x32_bf16 v[216:219], v[104:107], a[172:175], v[216:219]
    v_mfma_f32_16x16x32_bf16 v[212:215], v[108:111], a[168:171], v[212:215]
    ds_read_b128 v[172:175], v13 offset:34560
    v_mfma_f32_16x16x32_bf16 v[220:223], v[108:111], a[172:175], v[220:223]
    s_waitcnt lgkmcnt(12)
    v_mfma_f32_16x16x32_bf16 v[208:211], v[112:115], a[176:179], v[208:211]
    ds_read_b128 v[176:179], v14 offset:1792
    v_mfma_f32_16x16x32_bf16 v[216:219], v[112:115], a[180:183], v[216:219]
    s_waitcnt vmcnt(7)
    v_mov_b32 v27, s28
    s_mov_b64 exec, 1
    buffer_store_dword v27, v26, s[8:11], s94 offen sc1
    s_mov_b64 exec, -1
    v_mfma_f32_16x16x32_bf16 v[212:215], v[116:119], a[176:179], v[212:215]
    ds_read_b128 v[180:183], v14 offset:34560
    v_mfma_f32_16x16x32_bf16 v[220:223], v[116:119], a[180:183], v[220:223]
    v_mfma_f32_16x16x32_bf16 v[208:211], v[120:123], a[184:187], v[208:211]
    ds_read_b128 v[184:187], v15 offset:1792
    v_mfma_f32_16x16x32_bf16 v[216:219], v[120:123], a[188:191], v[216:219]
    s_add_u32 s28, s28, 1
    v_mfma_f32_16x16x32_bf16 v[212:215], v[124:127], a[184:187], v[212:215]
    ds_read_b128 v[188:191], v15 offset:34560
    v_mfma_f32_16x16x32_bf16 v[220:223], v[124:127], a[188:191], v[220:223]
    s_waitcnt lgkmcnt(12)
    v_mfma_f32_16x16x32_bf16 v[208:211], v[128:131], a[192:195], v[208:211]
    v_mfma_f32_16x16x32_bf16 v[216:219], v[128:131], a[196:199], v[216:219]
    v_mfma_f32_16x16x32_bf16 v[212:215], v[132:135], a[192:195], v[212:215]
    v_mfma_f32_16x16x32_bf16 v[220:223], v[132:135], a[196:199], v[220:223]
    v_mfma_f32_16x16x32_bf16 v[208:211], v[136:139], a[200:203], v[208:211]
    v_mfma_f32_16x16x32_bf16 v[216:219], v[136:139], a[204:207], v[216:219]
    s_add_u32 s29, s29, 0x10000
    s_and_b32 s29, s29, 0x3fffff
    v_mfma_f32_16x16x32_bf16 v[212:215], v[140:143], a[200:203], v[212:215]
    v_mfma_f32_16x16x32_bf16 v[220:223], v[140:143], a[204:207], v[220:223]
    s_waitcnt vmcnt(3) lgkmcnt(0)
    s_barrier
    v_mfma_f32_16x16x32_bf16 v[208:211], v[144:147], a[208:211], v[208:211]
    ds_read_b128 v[64:67], v8 offset:0
    ds_read_b128 v[68:71], v8 offset:32768
    v_mfma_f32_16x16x32_bf16 v[216:219], v[144:147], a[212:215], v[216:219]
    s_add_u32 m0, s6, 65536
    v_mfma_f32_16x16x32_bf16 v[212:215], v[148:151], a[208:211], v[212:215]
    ds_read_b128 v[72:75], v9 offset:0
    ds_read_b128 v[76:79], v9 offset:32768
    v_mfma_f32_16x16x32_bf16 v[220:223], v[148:151], a[212:215], v[220:223]
    buffer_load_dwordx4 v16, s[12:15], s29 offen offset:0 lds
    v_mfma_f32_16x16x32_bf16 v[208:211], v[152:155], a[216:219], v[208:211]
    ds_read_b128 v[80:83], v10 offset:0
    ds_read_b128 v[84:87], v10 offset:32768
    v_mfma_f32_16x16x32_bf16 v[216:219], v[152:155], a[220:223], v[216:219]
    v_mfma_f32_16x16x32_bf16 v[212:215], v[156:159], a[216:219], v[212:215]
    ds_read_b128 v[88:91], v11 offset:0
    ds_read_b128 v[92:95], v11 offset:32768
    v_mfma_f32_16x16x32_bf16 v[220:223], v[156:159], a[220:223], v[220:223]
    buffer_load_dwordx4 v16, s[12:15], s29 offen offset:1024 lds
    v_mfma_f32_16x16x32_bf16 v[208:211], v[160:163], a[224:227], v[208:211]
    ds_read_b128 v[96:99], v8 offset:256
    v_mfma_f32_16x16x32_bf16 v[216:219], v[160:163], a[228:231], v[216:219]
    v_mfma_f32_16x16x32_bf16 v[212:215], v[164:167], a[224:227], v[212:215]
    ds_read_b128 v[100:103], v8 offset:33024
    v_mfma_f32_16x16x32_bf16 v[220:223], v[164:167], a[228:231], v[220:223]
    buffer_load_dwordx4 v17, s[12:15], s29 offen offset:2048 lds
    v_mfma_f32_16x16x32_bf16 v[208:211], v[168:171], a[232:235], v[208:211]
    ds_read_b128 v[104:107], v9 offset:256
    v_mfma_f32_16x16x32_bf16 v[216:219], v[168:171], a[236:239], v[216:219]
    v_mfma_f32_16x16x32_bf16 v[212:215], v[172:175], a[232:235], v[212:215]
    ds_read_b128 v[108:111], v9 offset:33024
    v_mfma_f32_16x16x32_bf16 v[220:223], v[172:175], a[236:239], v[220:223]
    buffer_load_dwordx4 v17, s[12:15], s29 offen offset:3072 lds
    v_mfma_f32_16x16x32_bf16 v[208:211], v[176:179], a[240:243], v[208:211]
    ds_read_b128 v[112:115], v10 offset:256
    v_mfma_f32_16x16x32_bf16 v[216:219], v[176:179], a[244:247], v[216:219]
    s_add_u32 m0, s6, 69632
    v_mfma_f32_16x16x32_bf16 v[212:215], v[180:183], a[240:243], v[212:215]
    ds_read_b128 v[116:119], v10 offset:33024
    v_mfma_f32_16x16x32_bf16 v[220:223], v[180:183], a[244:247], v[220:223]
    buffer_load_dwordx4 v18, s[12:15], s29 offen offset:0 lds
    v_mfma_f32_16x16x32_bf16 v[208:211], v[184:187], a[248:251], v[208:211]
    ds_read_b128 v[120:123], v11 offset:256
    v_mfma_f32_16x16x32_bf16 v[216:219], v[184:187], a[252:255], v[216:219]
    v_mfma_f32_16x16x32_bf16 v[212:215], v[188:191], a[248:251], v[212:215]
    ds_read_b128 v[124:127], v11 offset:33024
    v_mfma_f32_16x16x32_bf16 v[220:223], v[188:191], a[252:255], v[220:223]
    buffer_load_dwordx4 v18, s[12:15], s29 offen offset:1024 lds
    s_cmp_lt_u32 s28, 64
    s_cbranch_scc1 .ql_406
.qe_404:
    s_nop 7
    v_cvt_pk_bf16_f32 v224, v208, v209
    v_cvt_pk_bf16_f32 v225, v210, v211
    v_cvt_pk_bf16_f32 v226, v212, v213
    v_cvt_pk_bf16_f32 v227, v214, v215
    v_cvt_pk_bf16_f32 v228, v216, v217
    v_cvt_pk_bf16_f32 v229, v218, v219
    v_cvt_pk_bf16_f32 v230, v220, v221
    v_cvt_pk_bf16_f32 v231, v222, v223
    buffer_store_dwordx4 v[224:227], v24, s[8:11], s30 offen sc1
    buffer_store_dwordx4 v[228:231], v25, s[8:11], s30 offen sc1
    s_cmp_eq_u32 s98, 0
    s_cbranch_scc1 .qa_402
    s_waitcnt vmcnt(0) lgkmcnt(0)
    v_mov_b32 v27, s28
    s_mov_b64 exec, 1
    buffer_store_dword v27, v26, s[8:11], s94 offen sc1
    s_mov_b64 exec, -1
    s_barrier
    s_sub_u32 s95, s98, 1
    s_load_dwordx8 s[40:47], s[0:1], 0
    s_load_dwordx4 s[48:51], s[0:1], 32
    s_load_dwordx2 s[52:53], s[0:1], 104
    s_mul_i32 s6, s24, 8320
    s_add_u32 s6, s6, 122880
    s_lshl_b32 s97, s95, 4
    s_and_b32 s4, s99, 16
    s_add_u32 s97, s97, s4
    s_add_u32 s97, s97, s99
    s_lshl1_add_u32 s97, s99, s95
    s_lshl_b32 s4, s97, 16
    s_lshl_b32 s5, s24, 14
    s_add_u32 s4, s4, s5
    v_lshlrev_b32 v2, 4, v1
    v_bfe_u32 v254, v1, 0, 3
    v_mul_u32_u24 v3, 2048, v254
    v_bfe_u32 v254, v1, 4, 2
    v_mul_u32_u24 v254, 16, v254
    v_add_u32 v3, v3, v254
    v_add_u32 v3, s4, v3
    v_bfe_u32 v254, v1, 4, 2
    v_mul_u32_u24 v4, 16, v254
    v_add_u32 v4, s6, v4
    s_waitcnt lgkmcnt(0)
    s_mov_b32 s12, s40
    s_and_b32 s13, s41, 0xffff
    s_mov_b32 s14, 0x400000
    s_mov_b32 s15, 0x00020000
    s_mov_b32 s16, s42
    s_and_b32 s17, s43, 0xffff
    s_mov_b32 s18, 0x400000
    s_mov_b32 s19, 0x00020000
    s_mov_b32 s28, s44
    s_and_b32 s29, s45, 0xffff
    s_mov_b32 s30, 0x400000
    s_mov_b32 s31, 0x00020000
    s_mov_b32 s32, s46
    s_and_b32 s33, s47, 0xffff
    s_mov_b32 s34, 0x2000
    s_mov_b32 s35, 0x00020000
    s_mov_b32 s36, s48
    s_and_b32 s37, s49, 0xffff
    s_mov_b32 s38, 0x400000
    s_mov_b32 s39, 0x00020000
    s_mov_b32 s56, s52
    s_and_b32 s57, s53, 0xffff
    s_mov_b32 s58, 0x800
    s_mov_b32 s59, 0x00020000
    s_lshr_b32 s4, s97, 4
    s_lshl_b32 s4, s4, 2
    s_add_u32 s4, s4, 92344320
    v_bfe_u32 v254, v1, 0, 5
    v_mul_u32_u24 v8, 128, v254
    v_add_u32 v8, s4, v8
    s_lshl_b32 s4, s97, 16
    s_lshr_b32 s5, s24, 1
    s_lshl_b32 s5, s5, 15
    s_add_u32 s4, s4, s5
    s_and_b32 s5, s24, 1
    s_lshl_b32 s5, s5, 10
    s_add_u32 s4, s4, s5
    s_add_u32 s4, s4, 125829120
    v_add_u32 v7, s4, v2
    s_mov_b32 s62, 0
.kw_407:
    buffer_load_dword v12, v8, s[8:11], 0 offen sc1
    s_add_u32 s62, s62, 1
    s_cmp_gt_u32 s62, 0x100000
    s_cbranch_scc1 .mg_end_1
    s_waitcnt vmcnt(0)
    v_cmp_eq_u32 vcc, 0, v12
    s_cbranch_vccz .kw_408
    s_sleep 16
    s_branch .kw_407
.kw_408:
    s_mov_b32 m0, s6
    s_lshl_b32 s60, s97, 4
    buffer_load_dwordx4 v2, s[56:59], 0 offen lds
    buffer_load_dwordx4 v2, s[56:59], 0 offen offset:1024 lds
    s_add_u32 s61, s60, s24
    v_subrev_u32 v5, 4, v2
    buffer_load_dwordx4 a[0:3], v3, s[12:15], 0 offen offset:0
    buffer_load_dwordx4 a[4:7], v3, s[12:15], 0 offen offset:64
    buffer_load_dwordx4 a[8:11], v3, s[12:15], 0 offen offset:128
    buffer_load_dwordx4 a[12:15], v3, s[12:15], 0 offen offset:192
    buffer_load_dwordx4 a[16:19], v3, s[12:15], 0 offen offset:256
    buffer_load_dwordx4 a[20:23], v3, s[12:15], 0 offen offset:320
    buffer_load_dwordx4 a[24:27], v3, s[12:15], 0 offen offset:384
    buffer_load_dwordx4 a[28:31], v3, s[12:15], 0 offen offset:448
    buffer_load_dwordx4 a[32:35], v3, s[12:15], 0 offen offset:512
    buffer_load_dwordx4 a[36:39], v3, s[12:15], 0 offen offset:576
    buffer_load_dwordx4 a[40:43], v3, s[12:15], 0 offen offset:640
    buffer_load_dwordx4 a[44:47], v3, s[12:15], 0 offen offset:704
    buffer_load_dwordx4 a[48:51], v3, s[12:15], 0 offen offset:768
    buffer_load_dwordx4 a[52:55], v3, s[12:15], 0 offen offset:832
    buffer_load_dwordx4 a[56:59], v3, s[12:15], 0 offen offset:896
    buffer_load_dwordx4 a[60:63], v3, s[12:15], 0 offen offset:960
    buffer_load_dwordx4 a[64:67], v3, s[12:15], 0 offen offset:1024
    buffer_load_dwordx4 a[68:71], v3, s[12:15], 0 offen offset:1088
    buffer_load_dwordx4 a[72:75], v3, s[12:15], 0 offen offset:1152
    buffer_load_dwordx4 a[76:79], v3, s[12:15], 0 offen offset:1216
    buffer_load_dwordx4 a[80:83], v3, s[12:15], 0 offen offset:1280
    buffer_load_dwordx4 a[84:87], v3, s[12:15], 0 offen offset:1344
    buffer_load_dwordx4 a[88:91], v3, s[12:15], 0 offen offset:1408
    buffer_load_dwordx4 a[92:95], v3, s[12:15], 0 offen offset:1472
    buffer_load_dwordx4 a[96:99], v3, s[12:15], 0 offen offset:1536
    buffer_load_dwordx4 a[100:103], v3, s[12:15], 0 offen offset:1600
    buffer_load_dwordx4 a[104:107], v3, s[12:15], 0 offen offset:1664
    buffer_load_dwordx4 a[108:111], v3, s[12:15], 0 offen offset:1728
    buffer_load_dwordx4 a[112:115], v3, s[12:15], 0 offen offset:1792
    buffer_load_dwordx4 a[116:119], v3, s[12:15], 0 offen offset:1856
    buffer_load_dwordx4 a[120:123], v3, s[12:15], 0 offen offset:1920
    buffer_load_dwordx4 a[124:127], v3, s[12:15], 0 offen offset:1984
    s_waitcnt vmcnt(32)
    ds_read_b128 a[128:131], v4 offset:0
    ds_read_b128 a[132:135], v4 offset:64
    ds_read_b128 a[136:139], v4 offset:128
    ds_read_b128 a[140:143], v4 offset:192
    ds_read_b128 a[144:147], v4 offset:256
    ds_read_b128 a[148:151], v4 offset:320
    ds_read_b128 a[152:155], v4 offset:384
    ds_read_b128 a[156:159], v4 offset:448
    ds_read_b128 a[160:163], v4 offset:512
    ds_read_b128 a[164:167], v4 offset:576
    ds_read_b128 a[168:171], v4 offset:640
    ds_read_b128 a[172:175], v4 offset:704
    ds_read_b128 a[176:179], v4 offset:768
    ds_read_b128 a[180:183], v4 offset:832
    ds_read_b128 a[184:187], v4 offset:896
    ds_read_b128 a[188:191], v4 offset:960
    ds_read_b128 a[192:195], v4 offset:1024
    ds_read_b128 a[196:199], v4 offset:1088
    ds_read_b128 a[200:203], v4 offset:1152
    ds_read_b128 a[204:207], v4 offset:1216
    ds_read_b128 a[208:211], v4 offset:1280
    ds_read_b128 a[212:215], v4 offset:1344
    ds_read_b128 a[216:219], v4 offset:1408
    ds_read_b128 a[220:223], v4 offset:1472
    ds_read_b128 a[224:227], v4 offset:1536
    ds_read_b128 a[228:231], v4 offset:1600
    ds_read_b128 a[232:235], v4 offset:1664
    ds_read_b128 a[236:239], v4 offset:1728
    ds_read_b128 a[240:243], v4 offset:1792
    ds_read_b128 a[244:247], v4 offset:1856
    ds_read_b128 a[248:251], v4 offset:1920
    ds_read_b128 a[252:255], v4 offset:1984
    s_mov_b32 s4, 0
    buffer_load_dwordx4 v[32:35], v7, s[8:11], s4 offen offset:0
    buffer_load_dwordx4 v[36:39], v7, s[8:11], s4 offen offset:2048
    s_mov_b32 s4, 4096
    buffer_load_dwordx4 v[40:43], v7, s[8:11], s4 offen offset:0
    buffer_load_dwordx4 v[44:47], v7, s[8:11], s4 offen offset:2048
    s_mov_b32 s4, 8192
    buffer_load_dwordx4 v[48:51], v7, s[8:11], s4 offen offset:0
    buffer_load_dwordx4 v[52:55], v7, s[8:11], s4 offen offset:2048
    s_mov_b32 s4, 12288
    buffer_load_dwordx4 v[56:59], v7, s[8:11], s4 offen offset:0
    buffer_load_dwordx4 v[60:63], v7, s[8:11], s4 offen offset:2048
    s_mov_b32 s4, 16384
    buffer_load_dwordx4 v[64:67], v7, s[8:11], s4 offen offset:0
    buffer_load_dwordx4 v[68:71], v7, s[8:11], s4 offen offset:2048
    s_mov_b32 s4, 20480
    buffer_load_dwordx4 v[72:75], v7, s[8:11], s4 offen offset:0
    buffer_load_dwordx4 v[76:79], v7, s[8:11], s4 offen offset:2048
    s_mov_b32 s4, 24576
    buffer_load_dwordx4 v[80:83], v7, s[8:11], s4 offen offset:0
    buffer_load_dwordx4 v[84:87], v7, s[8:11], s4 offen offset:2048
    s_mov_b32 s4, 28672
    buffer_load_dwordx4 v[88:91], v7, s[8:11], s4 offen offset:0
    buffer_load_dwordx4 v[92:95], v7, s[8:11], s4 offen offset:2048
    v_add_u32 v9, s6, v2
    v_and_b32 v12, 31, v1
    v_lshrrev_b32 v13, 5, v1
    v_lshlrev_b32 v14, 3, v13
    v_sub_u32 v14, v12, v14
    v_add_u32 v15, 10, v14
    v_and_b32 v10, 1, v15
    v_xor_b32 v10, 1, v10
    v_mul_u32_u24 v10, 4160, v10
    v_lshrrev_b32 v15, 1, v15
    v_lshl_add_u32 v10, v15, 2, v10
    v_add_u32 v10, s6, v10
    v_mul_u32_u24 v11, 80, v12
    v_lshl_add_u32 v11, v13, 4, v11
    s_mul_i32 s4, s24, 7680
    s_sub_u32 s4, s4, 2480
    v_add_u32 v11, s4, v11
    v_cmp_eq_u32 vcc, 7, v14
    v_mov_b32 v15, 0xffff
    s_nop 0
    v_cndmask_b32 v24, 0, v15, vcc
    v_cmp_eq_u32 vcc, 6, v14
    v_mov_b32 v15, 0xffff0000
    s_nop 0
    v_cndmask_b32 v24, v24, v15, vcc
    v_cmp_eq_u32 vcc, 5, v14
    v_mov_b32 v15, 0xffff
    s_nop 0
    v_cndmask_b32 v25, 0, v15, vcc
    v_cmp_eq_u32 vcc, 4, v14
    v_mov_b32 v15, 0xffff0000
    s_nop 0
    v_cndmask_b32 v25, v25, v15, vcc
    v_cmp_eq_u32 vcc, 3, v14
    v_mov_b32 v15, 0xffff
    s_nop 0
    v_cndmask_b32 v26, 0, v15, vcc
    v_cmp_eq_u32 vcc, 2, v14
    v_mov_b32 v15, 0xffff0000
    s_nop 0
    v_cndmask_b32 v26, v26, v15, vcc
    v_cmp_eq_u32 vcc, 1, v14
    v_mov_b32 v15, 0xffff
    s_nop 0
    v_cndmask_b32 v27, 0, v15, vcc
    v_cmp_eq_u32 vcc, 0, v14
    v_mov_b32 v15, 0xffff0000
    s_nop 0
    v_cndmask_b32 v27, v27, v15, vcc
    v_cmp_eq_u32 vcc, 23, v14
    v_mov_b32 v15, 0xffff
    s_nop 0
    v_cndmask_b32 v28, 0, v15, vcc
    v_cmp_eq_u32 vcc, 22, v14
    v_mov_b32 v15, 0xffff0000
    s_nop 0
    v_cndmask_b32 v28, v28, v15, vcc
    v_cmp_eq_u32 vcc, 21, v14
    v_mov_b32 v15, 0xffff
    s_nop 0
    v_cndmask_b32 v29, 0, v15, vcc
    v_cmp_eq_u32 vcc, 20, v14
    v_mov_b32 v15, 0xffff0000
    s_nop 0
    v_cndmask_b32 v29, v29, v15, vcc
    v_cmp_eq_u32 vcc, 19, v14
    v_mov_b32 v15, 0xffff
    s_nop 0
    v_cndmask_b32 v30, 0, v15, vcc
    v_cmp_eq_u32 vcc, 18, v14
    v_mov_b32 v15, 0xffff0000
    s_nop 0
    v_cndmask_b32 v30, v30, v15, vcc
    v_cmp_eq_u32 vcc, 17, v14
    v_mov_b32 v15, 0xffff
    s_nop 0
    v_cndmask_b32 v31, 0, v15, vcc
    v_cmp_eq_u32 vcc, 16, v14
    v_mov_b32 v15, 0xffff0000
    s_nop 0
    v_cndmask_b32 v31, v31, v15, vcc
    s_waitcnt lgkmcnt(0)
    s_waitcnt vmcnt(47)
    v_mfma_f32_16x16x32_bf16 v[216:219], a[128:131], a[0:3], 0
    s_waitcnt vmcnt(46)
    v_mfma_f32_16x16x32_bf16 v[216:219], a[132:135], a[4:7], v[216:219]
    s_waitcnt vmcnt(45)
    v_mfma_f32_16x16x32_bf16 v[216:219], a[136:139], a[8:11], v[216:219]
    s_waitcnt vmcnt(44)
    v_mfma_f32_16x16x32_bf16 v[216:219], a[140:143], a[12:15], v[216:219]
    s_waitcnt vmcnt(43)
    v_mfma_f32_16x16x32_bf16 v[216:219], a[144:147], a[16:19], v[216:219]
    s_waitcnt vmcnt(42)
    v_mfma_f32_16x16x32_bf16 v[216:219], a[148:151], a[20:23], v[216:219]
    s_waitcnt vmcnt(41)
    v_mfma_f32_16x16x32_bf16 v[216:219], a[152:155], a[24:27], v[216:219]
    s_waitcnt vmcnt(40)
    v_mfma_f32_16x16x32_bf16 v[216:219], a[156:159], a[28:31], v[216:219]
    s_waitcnt vmcnt(39)
    v_mfma_f32_16x16x32_bf16 v[216:219], a[160:163], a[32:35], v[216:219]
    s_waitcnt vmcnt(38)
    v_mfma_f32_16x16x32_bf16 v[216:219], a[164:167], a[36:39], v[216:219]
    s_waitcnt vmcnt(37)
    v_mfma_f32_16x16x32_bf16 v[216:219], a[168:171], a[40:43], v[216:219]
    s_waitcnt vmcnt(36)
    v_mfma_f32_16x16x32_bf16 v[216:219], a[172:175], a[44:47], v[216:219]
    s_waitcnt vmcnt(35)
    v_mfma_f32_16x16x32_bf16 v[216:219], a[176:179], a[48:51], v[216:219]
    s_waitcnt vmcnt(34)
    v_mfma_f32_16x16x32_bf16 v[216:219], a[180:183], a[52:55], v[216:219]
    s_waitcnt vmcnt(33)
    v_mfma_f32_16x16x32_bf16 v[216:219], a[184:187], a[56:59], v[216:219]
    s_waitcnt vmcnt(32)
    v_mfma_f32_16x16x32_bf16 v[216:219], a[188:191], a[60:63], v[216:219]
    s_waitcnt vmcnt(31)
    v_mfma_f32_16x16x32_bf16 v[216:219], a[192:195], a[64:67], v[216:219]
    s_waitcnt vmcnt(30)
    v_mfma_f32_16x16x32_bf16 v[216:219], a[196:199], a[68:71], v[216:219]
    s_waitcnt vmcnt(29)
    v_mfma_f32_16x16x32_bf16 v[216:219], a[200:203], a[72:75], v[216:219]
    s_waitcnt vmcnt(28)
    v_mfma_f32_16x16x32_bf16 v[216:219], a[204:207], a[76:79], v[216:219]
    s_waitcnt vmcnt(27)
    v_mfma_f32_16x16x32_bf16 v[216:219], a[208:211], a[80:83], v[216:219]
    s_waitcnt vmcnt(26)
    v_mfma_f32_16x16x32_bf16 v[216:219], a[212:215], a[84:87], v[216:219]
    s_waitcnt vmcnt(25)
    v_mfma_f32_16x16x32_bf16 v[216:219], a[216:219], a[88:91], v[216:219]
    s_waitcnt vmcnt(24)
    v_mfma_f32_16x16x32_bf16 v[216:219], a[220:223], a[92:95], v[216:219]
    s_waitcnt vmcnt(23)
    v_mfma_f32_16x16x32_bf16 v[216:219], a[224:227], a[96:99], v[216:219]
    s_waitcnt vmcnt(22)
    v_mfma_f32_16x16x32_bf16 v[216:219], a[228:231], a[100:103], v[216:219]
    s_waitcnt vmcnt(21)
    v_mfma_f32_16x16x32_bf16 v[216:219], a[232:235], a[104:107], v[216:219]
    s_waitcnt vmcnt(20)
    v_mfma_f32_16x16x32_bf16 v[216:219], a[236:239], a[108:111], v[216:219]
    s_waitcnt vmcnt(19)
    v_mfma_f32_16x16x32_bf16 v[216:219], a[240:243], a[112:115], v[216:219]
    s_waitcnt vmcnt(18)
    v_mfma_f32_16x16x32_bf16 v[216:219], a[244:247], a[116:119], v[216:219]
    s_waitcnt vmcnt(17)
    v_mfma_f32_16x16x32_bf16 v[216:219], a[248:251], a[120:123], v[216:219]
    s_waitcnt vmcnt(16)
    v_mfma_f32_16x16x32_bf16 v[216:219], a[252:255], a[124:127], v[216:219]
    s_lshl_b32 s4, s61, 12
    v_add_u32 v6, s4, v5
    buffer_load_dwordx4 v[184:187], v2, s[36:39], s4 offen offset:0
    buffer_load_dwordx4 v[188:191], v2, s[36:39], s4 offen offset:1024
    buffer_load_dwordx4 v[192:195], v2, s[36:39], s4 offen offset:2048
    buffer_load_dwordx4 v[196:199], v2, s[36:39], s4 offen offset:3072
    buffer_load_dword v200, v6, s[36:39], 0 offen
    buffer_load_dword v201, v2, s[36:39], s4 offen offset:1020
    buffer_load_dword v202, v2, s[36:39], s4 offen offset:2044
    buffer_load_dword v203, v2, s[36:39], s4 offen offset:3068
    v_cvt_pk_bf16_f32 v216, v216, v216
    v_lshlrev_b32 v216, 16, v216
    v_mul_f32 v216, 0xbfb8aa3b, v216
    v_exp_f32 v216, v216
    s_lshl_b32 s4, s97, 7
    v_add_f32 v216, 1.0, v216
    v_rcp_f32 v216, v216
    s_lshl_b32 s5, s24, 5
    v_cvt_pk_bf16_f32 v216, v216, v216
    v_lshlrev_b32 v216, 16, v216
    s_add_u32 s4, s4, s5
    s_add_u32 s4, s4, 121634816
    v_lshlrev_b32 v15, 2, v1
    s_mov_b64 exec, 0xff
    buffer_store_dword v216, v15, s[8:11], s4 offen sc1
    s_mov_b64 exec, -1
    v_mov_b32 v220, 0
    v_mov_b32 v221, 0
    v_mov_b32 v222, 0
    v_mov_b32 v223, 0
    s_mul_i32 s4, s24, 7680
    v_add_u32 v15, s4, v2
    ds_write_b128 v15, v[220:223] offset:0
    ds_write_b128 v15, v[220:223] offset:1024
    ds_write_b128 v15, v[220:223] offset:1536
    v_add_u32 v15, 30720, v15
    ds_write_b128 v15, v[220:223] offset:0
    ds_write_b128 v15, v[220:223] offset:1024
    ds_write_b128 v15, v[220:223] offset:1536
    v_add_u32 v15, 30720, v15
    ds_write_b128 v15, v[220:223] offset:0
    ds_write_b128 v15, v[220:223] offset:1024
    ds_write_b128 v15, v[220:223] offset:1536
    v_add_u32 v15, 30720, v15
    ds_write_b128 v15, v[220:223] offset:0
    ds_write_b128 v15, v[220:223] offset:1024
    ds_write_b128 v15, v[220:223] offset:1536
    v_add_u32 v15, 30720, v15
    s_mov_b64 exec, 0xf
    ds_write_b128 v9, v[220:223]
    ds_write_b128 v9, v[220:223] offset:4160
    s_mov_b64 exec, -1
    s_mul_i32 s4, s24, 640
    s_add_u32 s4, s4, 2560
    v_bfe_u32 v254, v1, 0, 1
    v_mul_u32_u24 v12, 61440, v254
    v_bfe_u32 v254, v1, 3, 3
    v_mul_u32_u24 v254, 80, v254
    v_add_u32 v12, v12, v254
    v_bfe_u32 v254, v1, 1, 2
    v_mul_u32_u24 v254, 16, v254
    v_add_u32 v12, v12, v254
    v_add_u32 v12, s4, v12
    s_lshl_b32 s4, s97, 7
    v_bfe_u32 v254, v1, 0, 1
    v_mul_u32_u24 v13, 64, v254
    v_add_u32 v13, s4, v13
    s_and_b32 s4, s97, 3
    s_lshl1_add_u32 s4, s4, s24
    s_and_b32 s5, s24, 2
    s_sub_u32 s4, s4, s5
    v_xor_b32 v13, s4, v1
    v_bfe_u32 v14, v13, 2, 1
    v_and_b32 v13, 3, v13
    v_lshlrev_b32 v13, 4, v13
    v_mul_u32_u24 v14, 80, v14
    v_add_u32 v13, v13, v14
    s_mul_i32 s5, s5, 1280
    s_and_b32 s4, s24, 1
    s_mul_i32 s4, s4, 61440
    s_add_u32 s4, s4, s5
    s_add_u32 s4, s4, 2560
    v_bfe_u32 v254, v1, 3, 3
    v_mul_u32_u24 v12, 7680, v254
    v_add_u32 v12, s4, v12
    v_add_u32 v12, v13, v12
    s_waitcnt vmcnt(0)
    ds_write_b128 v12, v[32:35] offset:0
    ds_write_b128 v12, v[36:39] offset:160
    ds_write_b128 v12, v[40:43] offset:320
    ds_write_b128 v12, v[44:47] offset:480
    ds_write_b128 v12, v[48:51] offset:640
    ds_write_b128 v12, v[52:55] offset:800
    ds_write_b128 v12, v[56:59] offset:960
    ds_write_b128 v12, v[60:63] offset:1120
    ds_write_b128 v12, v[64:67] offset:1280
    ds_write_b128 v12, v[68:71] offset:1440
    ds_write_b128 v12, v[72:75] offset:1600
    ds_write_b128 v12, v[76:79] offset:1760
    ds_write_b128 v12, v[80:83] offset:1920
    ds_write_b128 v12, v[84:87] offset:2080
    ds_write_b128 v12, v[88:91] offset:2240
    ds_write_b128 v12, v[92:95] offset:2400
    s_waitcnt vmcnt(0)
    s_waitcnt lgkmcnt(0)
    s_barrier
    s_mov_b32 s64, 0
    s_cmp_lg_u32 s24, 0
    s_cbranch_scc1 .sg_412
    s_mov_b64 exec, 1
    v_mov_b32 v4, 1
    v_mov_b32 v3, 0
    buffer_atomic_add v4, v3, s[20:23], 0 offen offset:192 sc1
    s_mov_b64 exec, -1
.sg_412:
.chan_410:
    s_lshr_b32 s4, s61, 1
    s_lshl_b32 s4, s4, 2
    s_load_dword s65, s[50:51], s4
    s_lshl_b32 s7, s61, 12
    s_add_u32 s7, s7, 130023424
    v_writelane_b32 v200, 0, 0
    ds_write_b128 v9, v[184:187] offset:64
    v_alignbit_b32 v204, v184, v200, 16
    v_alignbit_b32 v205, v185, v184, 16
    v_alignbit_b32 v206, v186, v185, 16
    v_alignbit_b32 v207, v187, v186, 16
    ds_write_b128 v9, v[204:207] offset:4224
    ds_write_b128 v9, v[188:191] offset:1088
    v_alignbit_b32 v208, v188, v201, 16
    v_alignbit_b32 v209, v189, v188, 16
    v_alignbit_b32 v210, v190, v189, 16
    v_alignbit_b32 v211, v191, v190, 16
    ds_write_b128 v9, v[208:211] offset:5248
    ds_write_b128 v9, v[192:195] offset:2112
    v_alignbit_b32 v212, v192, v202, 16
    v_alignbit_b32 v213, v193, v192, 16
    v_alignbit_b32 v214, v194, v193, 16
    v_alignbit_b32 v215, v195, v194, 16
    ds_write_b128 v9, v[212:215] offset:6272
    ds_write_b128 v9, v[196:199] offset:3136
    v_alignbit_b32 v216, v196, v203, 16
    v_alignbit_b32 v217, v197, v196, 16
    v_alignbit_b32 v218, v198, v197, 16
    v_alignbit_b32 v219, v199, v198, 16
    ds_write_b128 v9, v[216:219] offset:7296
    s_and_b32 s4, s61, 1
    s_lshl_b32 s4, s4, 4
    s_waitcnt lgkmcnt(0)
    s_lshr_b32 s65, s65, s4
    s_pack_ll_b32_b16 s65, s65, s65
    s_add_u32 s61, s61, 4
    s_cmp_eq_u32 s64, 3
    s_cbranch_scc1 .chan_410_ns
    s_lshl_b32 s4, s61, 12
    v_add_u32 v6, s4, v5
    buffer_load_dwordx4 v[184:187], v2, s[36:39], s4 offen offset:0
    buffer_load_dwordx4 v[188:191], v2, s[36:39], s4 offen offset:1024
    buffer_load_dwordx4 v[192:195], v2, s[36:39], s4 offen offset:2048
    buffer_load_dwordx4 v[196:199], v2, s[36:39], s4 offen offset:3072
    buffer_load_dword v200, v6, s[36:39], 0 offen
    buffer_load_dword v201, v2, s[36:39], s4 offen offset:1020
    buffer_load_dword v202, v2, s[36:39], s4 offen offset:2044
    buffer_load_dword v203, v2, s[36:39], s4 offen offset:3068
.chan_410_ns:
    v_and_b32 v16, s65, v24
    v_and_b32 v17, s65, v25
    v_and_b32 v18, s65, v26
    v_and_b32 v19, s65, v27
    v_and_b32 v20, s65, v28
    v_and_b32 v21, s65, v29
    v_and_b32 v22, s65, v30
    v_and_b32 v23, s65, v31
    v_mov_b32 v14, v10
    ds_read2_b32 a[32:33], v14 offset0:0 offset1:1
    ds_read2_b32 a[34:35], v14 offset0:2 offset1:3
    ds_read_b128 a[56:59], v11 offset:7632
    ds_read_b128 a[60:63], v11 offset:5072
    ds_read2_b32 a[36:37], v14 offset0:8 offset1:9
    ds_read2_b32 a[38:39], v14 offset0:10 offset1:11
    ds_read_b128 a[64:67], v11 offset:7600
    ds_read_b128 a[68:71], v11 offset:5040
    ds_read2_b32 a[40:41], v14 offset0:16 offset1:17
    ds_read2_b32 a[42:43], v14 offset0:18 offset1:19
    ds_read_b128 a[72:75], v11 offset:7552
    ds_read_b128 a[76:79], v11 offset:4992
    s_waitcnt lgkmcnt(9)
    v_mfma_f32_32x32x16_bf16 a[16:31], a[32:35], a[56:59], 0
    v_mfma_f32_32x32x16_bf16 a[16:31], v[20:23], a[56:59], a[16:31]
    ds_read2_b32 a[44:45], v14 offset0:24 offset1:25
    ds_read2_b32 a[46:47], v14 offset0:26 offset1:27
    s_waitcnt lgkmcnt(10)
    v_mfma_f32_32x32x16_bf16 a[0:15], a[32:35], a[60:63], 0
    v_mfma_f32_32x32x16_bf16 a[0:15], v[20:23], a[60:63], a[0:15]
    ds_read_b128 a[80:83], v11 offset:7520
    ds_read_b128 a[84:87], v11 offset:4960
    s_waitcnt lgkmcnt(9)
    v_mfma_f32_32x32x16_bf16 a[16:31], a[36:39], a[64:67], a[16:31]
    v_mfma_f32_32x32x16_bf16 a[16:31], v[16:19], a[64:67], a[16:31]
    ds_read2_b32 a[48:49], v14 offset0:32 offset1:33
    ds_read2_b32 a[50:51], v14 offset0:34 offset1:35
    s_waitcnt lgkmcnt(10)
    v_mfma_f32_32x32x16_bf16 a[0:15], a[36:39], a[68:71], a[0:15]
    v_mfma_f32_32x32x16_bf16 a[0:15], v[16:19], a[68:71], a[0:15]
    ds_read_b128 a[56:59], v11 offset:7472
    ds_read_b128 a[60:63], v11 offset:4912
    s_waitcnt lgkmcnt(9)
    v_mfma_f32_32x32x16_bf16 a[16:31], a[40:43], a[72:75], a[16:31]
    ds_read2_b32 a[52:53], v14 offset0:40 offset1:41
    ds_read2_b32 a[54:55], v14 offset0:42 offset1:43
    s_waitcnt lgkmcnt(10)
    v_mfma_f32_32x32x16_bf16 a[0:15], a[40:43], a[76:79], a[0:15]
    ds_read_b128 a[64:67], v11 offset:7440
    ds_read_b128 a[68:71], v11 offset:4880
    s_waitcnt lgkmcnt(9)
    v_mfma_f32_32x32x16_bf16 a[16:31], a[44:47], a[80:83], a[16:31]
    ds_read2_b32 a[32:33], v14 offset0:48 offset1:49
    ds_read2_b32 a[34:35], v14 offset0:50 offset1:51
    s_waitcnt lgkmcnt(10)
    v_mfma_f32_32x32x16_bf16 a[0:15], a[44:47], a[84:87], a[0:15]
    ds_read_b128 a[72:75], v11 offset:7392
    ds_read_b128 a[76:79], v11 offset:4832
    s_waitcnt lgkmcnt(9)
    v_mfma_f32_32x32x16_bf16 a[16:31], a[48:51], a[56:59], a[16:31]
    ds_read2_b32 a[36:37], v14 offset0:56 offset1:57
    ds_read2_b32 a[38:39], v14 offset0:58 offset1:59
    s_waitcnt lgkmcnt(10)
    v_mfma_f32_32x32x16_bf16 a[0:15], a[48:51], a[60:63], a[0:15]
    ds_read_b128 a[80:83], v11 offset:7360
    ds_read_b128 a[84:87], v11 offset:4800
    s_waitcnt lgkmcnt(9)
    v_mfma_f32_32x32x16_bf16 a[16:31], a[52:55], a[64:67], a[16:31]
    ds_read2_b32 a[40:41], v14 offset0:64 offset1:65
    ds_read2_b32 a[42:43], v14 offset0:66 offset1:67
    s_waitcnt lgkmcnt(10)
    v_mfma_f32_32x32x16_bf16 a[0:15], a[52:55], a[68:71], a[0:15]
    ds_read_b128 a[56:59], v11 offset:7312
    ds_read_b128 a[60:63], v11 offset:4752
    s_waitcnt lgkmcnt(9)
    v_mfma_f32_32x32x16_bf16 a[16:31], a[32:35], a[72:75], a[16:31]
    ds_read2_b32 a[44:45], v14 offset0:72 offset1:73
    ds_read2_b32 a[46:47], v14 offset0:74 offset1:75
    s_waitcnt lgkmcnt(10)
    v_mfma_f32_32x32x16_bf16 a[0:15], a[32:35], a[76:79], a[0:15]
    ds_read_b128 a[64:67], v11 offset:7280
    ds_read_b128 a[68:71], v11 offset:4720
    s_waitcnt lgkmcnt(9)
    v_mfma_f32_32x32x16_bf16 a[16:31], a[36:39], a[80:83], a[16:31]
    ds_read2_b32 a[48:49], v14 offset0:80 offset1:81
    ds_read2_b32 a[50:51], v14 offset0:82 offset1:83
    s_waitcnt lgkmcnt(10)
    v_mfma_f32_32x32x16_bf16 a[0:15], a[36:39], a[84:87], a[0:15]
    ds_read_b128 a[72:75], v11 offset:7232
    ds_read_b128 a[76:79], v11 offset:4672
    s_waitcnt lgkmcnt(9)
    v_mfma_f32_32x32x16_bf16 a[16:31], a[40:43], a[56:59], a[16:31]
    ds_read2_b32 a[52:53], v14 offset0:88 offset1:89
    ds_read2_b32 a[54:55], v14 offset0:90 offset1:91
    s_waitcnt lgkmcnt(10)
    v_mfma_f32_32x32x16_bf16 a[0:15], a[40:43], a[60:63], a[0:15]
    ds_read_b128 a[80:83], v11 offset:7200
    ds_read_b128 a[84:87], v11 offset:4640
    s_waitcnt lgkmcnt(9)
    v_mfma_f32_32x32x16_bf16 a[16:31], a[44:47], a[64:67], a[16:31]
    ds_read2_b32 a[32:33], v14 offset0:96 offset1:97
    ds_read2_b32 a[34:35], v14 offset0:98 offset1:99
    s_waitcnt lgkmcnt(10)
    v_mfma_f32_32x32x16_bf16 a[0:15], a[44:47], a[68:71], a[0:15]
    ds_read_b128 a[56:59], v11 offset:7152
    ds_read_b128 a[60:63], v11 offset:4592
    s_waitcnt lgkmcnt(9)
    v_mfma_f32_32x32x16_bf16 a[16:31], a[48:51], a[72:75], a[16:31]
    ds_read2_b32 a[36:37], v14 offset0:104 offset1:105
    ds_read2_b32 a[38:39], v14 offset0:106 offset1:107
    s_waitcnt lgkmcnt(10)
    v_mfma_f32_32x32x16_bf16 a[0:15], a[48:51], a[76:79], a[0:15]
    ds_read_b128 a[64:67], v11 offset:7120
    ds_read_b128 a[68:71], v11 offset:4560
    s_waitcnt lgkmcnt(9)
    v_mfma_f32_32x32x16_bf16 a[16:31], a[52:55], a[80:83], a[16:31]
    ds_read2_b32 a[40:41], v14 offset0:112 offset1:113
    ds_read2_b32 a[42:43], v14 offset0:114 offset1:115
    s_waitcnt lgkmcnt(10)
    v_mfma_f32_32x32x16_bf16 a[0:15], a[52:55], a[84:87], a[0:15]
    ds_read_b128 a[72:75], v11 offset:7072
    ds_read_b128 a[76:79], v11 offset:4512
    s_waitcnt lgkmcnt(9)
    v_mfma_f32_32x32x16_bf16 a[16:31], a[32:35], a[56:59], a[16:31]
    ds_read2_b32 a[44:45], v14 offset0:120 offset1:121
    ds_read2_b32 a[46:47], v14 offset0:122 offset1:123
    s_waitcnt lgkmcnt(10)
    v_mfma_f32_32x32x16_bf16 a[0:15], a[32:35], a[60:63], a[0:15]
    ds_read_b128 a[80:83], v11 offset:7040
    ds_read_b128 a[84:87], v11 offset:4480
    s_waitcnt lgkmcnt(9)
    v_mfma_f32_32x32x16_bf16 a[16:31], a[36:39], a[64:67], a[16:31]
    ds_read2_b32 a[48:49], v14 offset0:128 offset1:129
    ds_read2_b32 a[50:51], v14 offset0:130 offset1:131
    s_waitcnt lgkmcnt(10)
    v_mfma_f32_32x32x16_bf16 a[0:15], a[36:39], a[68:71], a[0:15]
    ds_read_b128 a[56:59], v11 offset:6992
    ds_read_b128 a[60:63], v11 offset:4432
    s_waitcnt lgkmcnt(9)
    v_mfma_f32_32x32x16_bf16 a[16:31], a[40:43], a[72:75], a[16:31]
    ds_read2_b32 a[52:53], v14 offset0:136 offset1:137
    ds_read2_b32 a[54:55], v14 offset0:138 offset1:139
    s_waitcnt lgkmcnt(10)
    v_mfma_f32_32x32x16_bf16 a[0:15], a[40:43], a[76:79], a[0:15]
    ds_read_b128 a[64:67], v11 offset:6960
    ds_read_b128 a[68:71], v11 offset:4400
    s_waitcnt lgkmcnt(9)
    v_mfma_f32_32x32x16_bf16 a[16:31], a[44:47], a[80:83], a[16:31]
    ds_read2_b32 a[32:33], v14 offset0:144 offset1:145
    ds_read2_b32 a[34:35], v14 offset0:146 offset1:147
    s_waitcnt lgkmcnt(10)
    v_mfma_f32_32x32x16_bf16 a[0:15], a[44:47], a[84:87], a[0:15]
    ds_read_b128 a[72:75], v11 offset:6912
    ds_read_b128 a[76:79], v11 offset:4352
    s_waitcnt lgkmcnt(9)
    v_mfma_f32_32x32x16_bf16 a[16:31], a[48:51], a[56:59], a[16:31]
    ds_read2_b32 a[36:37], v14 offset0:152 offset1:153
    ds_read2_b32 a[38:39], v14 offset0:154 offset1:155
    s_waitcnt lgkmcnt(10)
    v_mfma_f32_32x32x16_bf16 a[0:15], a[48:51], a[60:63], a[0:15]
    ds_read_b128 a[80:83], v11 offset:6880
    ds_read_b128 a[84:87], v11 offset:4320
    s_waitcnt lgkmcnt(9)
    v_mfma_f32_32x32x16_bf16 a[16:31], a[52:55], a[64:67], a[16:31]
    ds_read2_b32 a[40:41], v14 offset0:160 offset1:161
    ds_read2_b32 a[42:43], v14 offset0:162 offset1:163
    s_waitcnt lgkmcnt(10)
    v_mfma_f32_32x32x16_bf16 a[0:15], a[52:55], a[68:71], a[0:15]
    ds_read_b128 a[56:59], v11 offset:6832
    ds_read_b128 a[60:63], v11 offset:4272
    s_waitcnt lgkmcnt(9)
    v_mfma_f32_32x32x16_bf16 a[16:31], a[32:35], a[72:75], a[16:31]
    ds_read2_b32 a[44:45], v14 offset0:168 offset1:169
    ds_read2_b32 a[46:47], v14 offset0:170 offset1:171
    s_waitcnt lgkmcnt(10)
    v_mfma_f32_32x32x16_bf16 a[0:15], a[32:35], a[76:79], a[0:15]
    ds_read_b128 a[64:67], v11 offset:6800
    ds_read_b128 a[68:71], v11 offset:4240
    s_waitcnt lgkmcnt(9)
    v_mfma_f32_32x32x16_bf16 a[16:31], a[36:39], a[80:83], a[16:31]
    ds_read2_b32 a[48:49], v14 offset0:176 offset1:177
    ds_read2_b32 a[50:51], v14 offset0:178 offset1:179
    s_waitcnt lgkmcnt(10)
    v_mfma_f32_32x32x16_bf16 a[0:15], a[36:39], a[84:87], a[0:15]
    ds_read_b128 a[72:75], v11 offset:6752
    ds_read_b128 a[76:79], v11 offset:4192
    s_waitcnt lgkmcnt(9)
    v_mfma_f32_32x32x16_bf16 a[16:31], a[40:43], a[56:59], a[16:31]
    ds_read2_b32 a[52:53], v14 offset0:184 offset1:185
    ds_read2_b32 a[54:55], v14 offset0:186 offset1:187
    s_waitcnt lgkmcnt(10)
    v_mfma_f32_32x32x16_bf16 a[0:15], a[40:43], a[60:63], a[0:15]
    ds_read_b128 a[80:83], v11 offset:6720
    ds_read_b128 a[84:87], v11 offset:4160
    s_waitcnt lgkmcnt(9)
    v_mfma_f32_32x32x16_bf16 a[16:31], a[44:47], a[64:67], a[16:31]
    ds_read2_b32 a[32:33], v14 offset0:192 offset1:193
    ds_read2_b32 a[34:35], v14 offset0:194 offset1:195
    s_waitcnt lgkmcnt(10)
    v_mfma_f32_32x32x16_bf16 a[0:15], a[44:47], a[68:71], a[0:15]
    ds_read_b128 a[56:59], v11 offset:6672
    ds_read_b128 a[60:63], v11 offset:4112
    s_waitcnt lgkmcnt(9)
    v_mfma_f32_32x32x16_bf16 a[16:31], a[48:51], a[72:75], a[16:31]
    ds_read2_b32 a[36:37], v14 offset0:200 offset1:201
    ds_read2_b32 a[38:39], v14 offset0:202 offset1:203
    s_waitcnt lgkmcnt(10)
    v_mfma_f32_32x32x16_bf16 a[0:15], a[48:51], a[76:79], a[0:15]
    ds_read_b128 a[64:67], v11 offset:6640
    ds_read_b128 a[68:71], v11 offset:4080
    s_waitcnt lgkmcnt(9)
    v_mfma_f32_32x32x16_bf16 a[16:31], a[52:55], a[80:83], a[16:31]
    ds_read2_b32 a[40:41], v14 offset0:208 offset1:209
    ds_read2_b32 a[42:43], v14 offset0:210 offset1:211
    s_waitcnt lgkmcnt(10)
    v_mfma_f32_32x32x16_bf16 a[0:15], a[52:55], a[84:87], a[0:15]
    ds_read_b128 a[72:75], v11 offset:6592
    ds_read_b128 a[76:79], v11 offset:4032
    s_waitcnt lgkmcnt(9)
    v_mfma_f32_32x32x16_bf16 a[16:31], a[32:35], a[56:59], a[16:31]
    ds_read2_b32 a[44:45], v14 offset0:216 offset1:217
    ds_read2_b32 a[46:47], v14 offset0:218 offset1:219
    s_waitcnt lgkmcnt(10)
    v_mfma_f32_32x32x16_bf16 a[0:15], a[32:35], a[60:63], a[0:15]
    ds_read_b128 a[80:83], v11 offset:6560
    ds_read_b128 a[84:87], v11 offset:4000
    s_waitcnt lgkmcnt(9)
    v_mfma_f32_32x32x16_bf16 a[16:31], a[36:39], a[64:67], a[16:31]
    ds_read2_b32 a[48:49], v14 offset0:224 offset1:225
    ds_read2_b32 a[50:51], v14 offset0:226 offset1:227
    s_waitcnt lgkmcnt(10)
    v_mfma_f32_32x32x16_bf16 a[0:15], a[36:39], a[68:71], a[0:15]
    ds_read_b128 a[56:59], v11 offset:6512
    ds_read_b128 a[60:63], v11 offset:3952
    s_waitcnt lgkmcnt(9)
    v_mfma_f32_32x32x16_bf16 a[16:31], a[40:43], a[72:75], a[16:31]
    ds_read2_b32 a[52:53], v14 offset0:232 offset1:233
    ds_read2_b32 a[54:55], v14 offset0:234 offset1:235
    s_waitcnt lgkmcnt(10)
    v_mfma_f32_32x32x16_bf16 a[0:15], a[40:43], a[76:79], a[0:15]
    ds_read_b128 a[64:67], v11 offset:6480
    ds_read_b128 a[68:71], v11 offset:3920
    s_waitcnt lgkmcnt(9)
    v_mfma_f32_32x32x16_bf16 a[16:31], a[44:47], a[80:83], a[16:31]
    ds_read2_b32 a[32:33], v14 offset0:240 offset1:241
    ds_read2_b32 a[34:35], v14 offset0:242 offset1:243
    s_waitcnt lgkmcnt(10)
    v_mfma_f32_32x32x16_bf16 a[0:15], a[44:47], a[84:87], a[0:15]
    ds_read_b128 a[72:75], v11 offset:6432
    ds_read_b128 a[76:79], v11 offset:3872
    s_waitcnt lgkmcnt(9)
    v_mfma_f32_32x32x16_bf16 a[16:31], a[48:51], a[56:59], a[16:31]
    ds_read2_b32 a[36:37], v14 offset0:248 offset1:249
    ds_read2_b32 a[38:39], v14 offset0:250 offset1:251
    v_add_u32 v14, 1024, v14
    s_waitcnt lgkmcnt(10)
    v_mfma_f32_32x32x16_bf16 a[0:15], a[48:51], a[60:63], a[0:15]
    ds_read_b128 a[80:83], v11 offset:6400
    ds_read_b128 a[84:87], v11 offset:3840
    s_waitcnt lgkmcnt(9)
    v_mfma_f32_32x32x16_bf16 a[16:31], a[52:55], a[64:67], a[16:31]
    ds_read2_b32 a[40:41], v14 offset0:0 offset1:1
    ds_read2_b32 a[42:43], v14 offset0:2 offset1:3
    s_waitcnt lgkmcnt(10)
    v_mfma_f32_32x32x16_bf16 a[0:15], a[52:55], a[68:71], a[0:15]
    ds_read_b128 a[56:59], v11 offset:6352
    ds_read_b128 a[60:63], v11 offset:3792
    s_waitcnt lgkmcnt(9)
    v_mfma_f32_32x32x16_bf16 a[16:31], a[32:35], a[72:75], a[16:31]
    ds_read2_b32 a[44:45], v14 offset0:8 offset1:9
    ds_read2_b32 a[46:47], v14 offset0:10 offset1:11
    s_waitcnt lgkmcnt(10)
    v_mfma_f32_32x32x16_bf16 a[0:15], a[32:35], a[76:79], a[0:15]
    ds_read_b128 a[64:67], v11 offset:6320
    ds_read_b128 a[68:71], v11 offset:3760
    s_waitcnt lgkmcnt(9)
    v_mfma_f32_32x32x16_bf16 a[16:31], a[36:39], a[80:83], a[16:31]
    ds_read2_b32 a[48:49], v14 offset0:16 offset1:17
    ds_read2_b32 a[50:51], v14 offset0:18 offset1:19
    s_waitcnt lgkmcnt(10)
    v_mfma_f32_32x32x16_bf16 a[0:15], a[36:39], a[84:87], a[0:15]
    ds_read_b128 a[72:75], v11 offset:6272
    ds_read_b128 a[76:79], v11 offset:3712
    s_waitcnt lgkmcnt(9)
    v_mfma_f32_32x32x16_bf16 a[16:31], a[40:43], a[56:59], a[16:31]
    ds_read2_b32 a[52:53], v14 offset0:24 offset1:25
    ds_read2_b32 a[54:55], v14 offset0:26 offset1:27
    s_waitcnt lgkmcnt(10)
    v_mfma_f32_32x32x16_bf16 a[0:15], a[40:43], a[60:63], a[0:15]
    ds_read_b128 a[80:83], v11 offset:6240
    ds_read_b128 a[84:87], v11 offset:3680
    s_waitcnt lgkmcnt(9)
    v_mfma_f32_32x32x16_bf16 a[16:31], a[44:47], a[64:67], a[16:31]
    ds_read2_b32 a[32:33], v14 offset0:32 offset1:33
    ds_read2_b32 a[34:35], v14 offset0:34 offset1:35
    s_waitcnt lgkmcnt(10)
    v_mfma_f32_32x32x16_bf16 a[0:15], a[44:47], a[68:71], a[0:15]
    ds_read_b128 a[56:59], v11 offset:6192
    ds_read_b128 a[60:63], v11 offset:3632
    s_waitcnt lgkmcnt(9)
    v_mfma_f32_32x32x16_bf16 a[16:31], a[48:51], a[72:75], a[16:31]
    ds_read2_b32 a[36:37], v14 offset0:40 offset1:41
    ds_read2_b32 a[38:39], v14 offset0:42 offset1:43
    s_waitcnt lgkmcnt(10)
    v_mfma_f32_32x32x16_bf16 a[0:15], a[48:51], a[76:79], a[0:15]
    ds_read_b128 a[64:67], v11 offset:6160
    ds_read_b128 a[68:71], v11 offset:3600
    s_waitcnt lgkmcnt(9)
    v_mfma_f32_32x32x16_bf16 a[16:31], a[52:55], a[80:83], a[16:31]
    ds_read2_b32 a[40:41], v14 offset0:48 offset1:49
    ds_read2_b32 a[42:43], v14 offset0:50 offset1:51
    s_waitcnt lgkmcnt(10)
    v_mfma_f32_32x32x16_bf16 a[0:15], a[52:55], a[84:87], a[0:15]
    ds_read_b128 a[72:75], v11 offset:6112
    ds_read_b128 a[76:79], v11 offset:3552
    s_waitcnt lgkmcnt(9)
    v_mfma_f32_32x32x16_bf16 a[16:31], a[32:35], a[56:59], a[16:31]
    ds_read2_b32 a[44:45], v14 offset0:56 offset1:57
    ds_read2_b32 a[46:47], v14 offset0:58 offset1:59
    s_waitcnt lgkmcnt(10)
    v_mfma_f32_32x32x16_bf16 a[0:15], a[32:35], a[60:63], a[0:15]
    ds_read_b128 a[80:83], v11 offset:6080
    ds_read_b128 a[84:87], v11 offset:3520
    s_waitcnt lgkmcnt(9)
    v_mfma_f32_32x32x16_bf16 a[16:31], a[36:39], a[64:67], a[16:31]
    ds_read2_b32 a[48:49], v14 offset0:64 offset1:65
    ds_read2_b32 a[50:51], v14 offset0:66 offset1:67
    s_waitcnt lgkmcnt(10)
    v_mfma_f32_32x32x16_bf16 a[0:15], a[36:39], a[68:71], a[0:15]
    ds_read_b128 a[56:59], v11 offset:6032
    ds_read_b128 a[60:63], v11 offset:3472
    s_waitcnt lgkmcnt(9)
    v_mfma_f32_32x32x16_bf16 a[16:31], a[40:43], a[72:75], a[16:31]
    ds_read2_b32 a[52:53], v14 offset0:72 offset1:73
    ds_read2_b32 a[54:55], v14 offset0:74 offset1:75
    s_waitcnt lgkmcnt(10)
    v_mfma_f32_32x32x16_bf16 a[0:15], a[40:43], a[76:79], a[0:15]
    ds_read_b128 a[64:67], v11 offset:6000
    ds_read_b128 a[68:71], v11 offset:3440
    s_waitcnt lgkmcnt(9)
    v_mfma_f32_32x32x16_bf16 a[16:31], a[44:47], a[80:83], a[16:31]
    ds_read2_b32 a[32:33], v14 offset0:80 offset1:81
    ds_read2_b32 a[34:35], v14 offset0:82 offset1:83
    s_waitcnt lgkmcnt(10)
    v_mfma_f32_32x32x16_bf16 a[0:15], a[44:47], a[84:87], a[0:15]
    ds_read_b128 a[72:75], v11 offset:5952
    ds_read_b128 a[76:79], v11 offset:3392
    s_waitcnt lgkmcnt(9)
    v_mfma_f32_32x32x16_bf16 a[16:31], a[48:51], a[56:59], a[16:31]
    ds_read2_b32 a[36:37], v14 offset0:88 offset1:89
    ds_read2_b32 a[38:39], v14 offset0:90 offset1:91
    s_waitcnt lgkmcnt(10)
    v_mfma_f32_32x32x16_bf16 a[0:15], a[48:51], a[60:63], a[0:15]
    ds_read_b128 a[80:83], v11 offset:5920
    ds_read_b128 a[84:87], v11 offset:3360
    s_waitcnt lgkmcnt(9)
    v_mfma_f32_32x32x16_bf16 a[16:31], a[52:55], a[64:67], a[16:31]
    ds_read2_b32 a[40:41], v14 offset0:96 offset1:97
    ds_read2_b32 a[42:43], v14 offset0:98 offset1:99
    s_waitcnt lgkmcnt(10)
    v_mfma_f32_32x32x16_bf16 a[0:15], a[52:55], a[68:71], a[0:15]
    ds_read_b128 a[56:59], v11 offset:5872
    ds_read_b128 a[60:63], v11 offset:3312
    s_waitcnt lgkmcnt(9)
    v_mfma_f32_32x32x16_bf16 a[16:31], a[32:35], a[72:75], a[16:31]
    ds_read2_b32 a[44:45], v14 offset0:104 offset1:105
    ds_read2_b32 a[46:47], v14 offset0:106 offset1:107
    s_waitcnt lgkmcnt(10)
    v_mfma_f32_32x32x16_bf16 a[0:15], a[32:35], a[76:79], a[0:15]
    ds_read_b128 a[64:67], v11 offset:5840
    ds_read_b128 a[68:71], v11 offset:3280
    s_waitcnt lgkmcnt(9)
    v_mfma_f32_32x32x16_bf16 a[16:31], a[36:39], a[80:83], a[16:31]
    ds_read2_b32 a[48:49], v14 offset0:112 offset1:113
    ds_read2_b32 a[50:51], v14 offset0:114 offset1:115
    s_waitcnt lgkmcnt(10)
    v_mfma_f32_32x32x16_bf16 a[0:15], a[36:39], a[84:87], a[0:15]
    ds_read_b128 a[72:75], v11 offset:5792
    ds_read_b128 a[76:79], v11 offset:3232
    s_waitcnt lgkmcnt(9)
    v_mfma_f32_32x32x16_bf16 a[16:31], a[40:43], a[56:59], a[16:31]
    ds_read2_b32 a[52:53], v14 offset0:120 offset1:121
    ds_read2_b32 a[54:55], v14 offset0:122 offset1:123
    s_waitcnt lgkmcnt(10)
    v_mfma_f32_32x32x16_bf16 a[0:15], a[40:43], a[60:63], a[0:15]
    ds_read_b128 a[80:83], v11 offset:5760
    ds_read_b128 a[84:87], v11 offset:3200
    s_waitcnt lgkmcnt(9)
    v_mfma_f32_32x32x16_bf16 a[16:31], a[44:47], a[64:67], a[16:31]
    ds_read2_b32 a[32:33], v14 offset0:128 offset1:129
    ds_read2_b32 a[34:35], v14 offset0:130 offset1:131
    s_waitcnt lgkmcnt(10)
    v_mfma_f32_32x32x16_bf16 a[0:15], a[44:47], a[68:71], a[0:15]
    ds_read_b128 a[56:59], v11 offset:5712
    ds_read_b128 a[60:63], v11 offset:3152
    s_waitcnt lgkmcnt(9)
    v_mfma_f32_32x32x16_bf16 a[16:31], a[48:51], a[72:75], a[16:31]
    ds_read2_b32 a[36:37], v14 offset0:136 offset1:137
    ds_read2_b32 a[38:39], v14 offset0:138 offset1:139
    s_waitcnt lgkmcnt(10)
    v_mfma_f32_32x32x16_bf16 a[0:15], a[48:51], a[76:79], a[0:15]
    ds_read_b128 a[64:67], v11 offset:5680
    ds_read_b128 a[68:71], v11 offset:3120
    s_waitcnt lgkmcnt(9)
    v_mfma_f32_32x32x16_bf16 a[16:31], a[52:55], a[80:83], a[16:31]
    ds_read2_b32 a[40:41], v14 offset0:144 offset1:145
    ds_read2_b32 a[42:43], v14 offset0:146 offset1:147
    s_waitcnt lgkmcnt(10)
    v_mfma_f32_32x32x16_bf16 a[0:15], a[52:55], a[84:87], a[0:15]
    ds_read_b128 a[72:75], v11 offset:5632
    ds_read_b128 a[76:79], v11 offset:3072
    s_waitcnt lgkmcnt(9)
    v_mfma_f32_32x32x16_bf16 a[16:31], a[32:35], a[56:59], a[16:31]
    ds_read2_b32 a[44:45], v14 offset0:152 offset1:153
    ds_read2_b32 a[46:47], v14 offset0:154 offset1:155
    s_waitcnt lgkmcnt(10)
    v_mfma_f32_32x32x16_bf16 a[0:15], a[32:35], a[60:63], a[0:15]
    ds_read_b128 a[80:83], v11 offset:5600
    ds_read_b128 a[84:87], v11 offset:3040
    s_waitcnt lgkmcnt(9)
    v_mfma_f32_32x32x16_bf16 a[16:31], a[36:39], a[64:67], a[16:31]
    ds_read2_b32 a[48:49], v14 offset0:160 offset1:161
    ds_read2_b32 a[50:51], v14 offset0:162 offset1:163
    s_waitcnt lgkmcnt(10)
    v_mfma_f32_32x32x16_bf16 a[0:15], a[36:39], a[68:71], a[0:15]
    ds_read_b128 a[56:59], v11 offset:5552
    ds_read_b128 a[60:63], v11 offset:2992
    s_waitcnt lgkmcnt(9)
    v_mfma_f32_32x32x16_bf16 a[16:31], a[40:43], a[72:75], a[16:31]
    ds_read2_b32 a[52:53], v14 offset0:168 offset1:169
    ds_read2_b32 a[54:55], v14 offset0:170 offset1:171
    s_waitcnt lgkmcnt(10)
    v_mfma_f32_32x32x16_bf16 a[0:15], a[40:43], a[76:79], a[0:15]
    ds_read_b128 a[64:67], v11 offset:5520
    ds_read_b128 a[68:71], v11 offset:2960
    s_waitcnt lgkmcnt(9)
    v_mfma_f32_32x32x16_bf16 a[16:31], a[44:47], a[80:83], a[16:31]
    ds_read2_b32 a[32:33], v14 offset0:176 offset1:177
    ds_read2_b32 a[34:35], v14 offset0:178 offset1:179
    s_waitcnt lgkmcnt(10)
    v_mfma_f32_32x32x16_bf16 a[0:15], a[44:47], a[84:87], a[0:15]
    ds_read_b128 a[72:75], v11 offset:5472
    ds_read_b128 a[76:79], v11 offset:2912
    s_waitcnt lgkmcnt(9)
    v_mfma_f32_32x32x16_bf16 a[16:31], a[48:51], a[56:59], a[16:31]
    ds_read2_b32 a[36:37], v14 offset0:184 offset1:185
    ds_read2_b32 a[38:39], v14 offset0:186 offset1:187
    s_waitcnt lgkmcnt(10)
    v_mfma_f32_32x32x16_bf16 a[0:15], a[48:51], a[60:63], a[0:15]
    ds_read_b128 a[80:83], v11 offset:5440
    ds_read_b128 a[84:87], v11 offset:2880
    s_waitcnt lgkmcnt(9)
    v_mfma_f32_32x32x16_bf16 a[16:31], a[52:55], a[64:67], a[16:31]
    ds_read2_b32 a[40:41], v14 offset0:192 offset1:193
    ds_read2_b32 a[42:43], v14 offset0:194 offset1:195
    s_waitcnt lgkmcnt(10)
    v_mfma_f32_32x32x16_bf16 a[0:15], a[52:55], a[68:71], a[0:15]
    ds_read_b128 a[56:59], v11 offset:5392
    ds_read_b128 a[60:63], v11 offset:2832
    s_waitcnt lgkmcnt(9)
    v_mfma_f32_32x32x16_bf16 a[16:31], a[32:35], a[72:75], a[16:31]
    ds_read2_b32 a[44:45], v14 offset0:200 offset1:201
    ds_read2_b32 a[46:47], v14 offset0:202 offset1:203
    s_waitcnt lgkmcnt(10)
    v_mfma_f32_32x32x16_bf16 a[0:15], a[32:35], a[76:79], a[0:15]
    ds_read_b128 a[64:67], v11 offset:5360
    ds_read_b128 a[68:71], v11 offset:2800
    s_waitcnt lgkmcnt(9)
    v_mfma_f32_32x32x16_bf16 a[16:31], a[36:39], a[80:83], a[16:31]
    ds_read2_b32 a[48:49], v14 offset0:208 offset1:209
    ds_read2_b32 a[50:51], v14 offset0:210 offset1:211
    s_waitcnt lgkmcnt(10)
    v_mfma_f32_32x32x16_bf16 a[0:15], a[36:39], a[84:87], a[0:15]
    ds_read_b128 a[72:75], v11 offset:5312
    ds_read_b128 a[76:79], v11 offset:2752
    s_waitcnt lgkmcnt(9)
    v_mfma_f32_32x32x16_bf16 a[16:31], a[40:43], a[56:59], a[16:31]
    ds_read2_b32 a[52:53], v14 offset0:216 offset1:217
    ds_read2_b32 a[54:55], v14 offset0:218 offset1:219
    s_waitcnt lgkmcnt(10)
    v_mfma_f32_32x32x16_bf16 a[0:15], a[40:43], a[60:63], a[0:15]
    ds_read_b128 a[80:83], v11 offset:5280
    ds_read_b128 a[84:87], v11 offset:2720
    s_waitcnt lgkmcnt(9)
    v_mfma_f32_32x32x16_bf16 a[16:31], a[44:47], a[64:67], a[16:31]
    ds_read2_b32 a[32:33], v14 offset0:224 offset1:225
    ds_read2_b32 a[34:35], v14 offset0:226 offset1:227
    s_waitcnt lgkmcnt(10)
    v_mfma_f32_32x32x16_bf16 a[0:15], a[44:47], a[68:71], a[0:15]
    ds_read_b128 a[56:59], v11 offset:5232
    ds_read_b128 a[60:63], v11 offset:2672
    s_waitcnt lgkmcnt(9)
    v_mfma_f32_32x32x16_bf16 a[16:31], a[48:51], a[72:75], a[16:31]
    ds_read2_b32 a[36:37], v14 offset0:232 offset1:233
    ds_read2_b32 a[38:39], v14 offset0:234 offset1:235
    s_waitcnt lgkmcnt(10)
    v_mfma_f32_32x32x16_bf16 a[0:15], a[48:51], a[76:79], a[0:15]
    ds_read_b128 a[64:67], v11 offset:5200
    ds_read_b128 a[68:71], v11 offset:2640
    s_waitcnt lgkmcnt(9)
    v_mfma_f32_32x32x16_bf16 a[16:31], a[52:55], a[80:83], a[16:31]
    ds_read2_b32 a[40:41], v14 offset0:240 offset1:241
    ds_read2_b32 a[42:43], v14 offset0:242 offset1:243
    s_waitcnt lgkmcnt(10)
    v_mfma_f32_32x32x16_bf16 a[0:15], a[52:55], a[84:87], a[0:15]
    ds_read_b128 a[72:75], v11 offset:5152
    ds_read_b128 a[76:79], v11 offset:2592
    s_waitcnt lgkmcnt(9)
    v_mfma_f32_32x32x16_bf16 a[16:31], a[32:35], a[56:59], a[16:31]
    ds_read2_b32 a[44:45], v14 offset0:248 offset1:249
    ds_read2_b32 a[46:47], v14 offset0:250 offset1:251
    v_add_u32 v14, 1024, v14
    s_waitcnt lgkmcnt(10)
    v_mfma_f32_32x32x16_bf16 a[0:15], a[32:35], a[60:63], a[0:15]
    ds_read_b128 a[80:83], v11 offset:5120
    ds_read_b128 a[84:87], v11 offset:2560
    s_waitcnt lgkmcnt(9)
    v_mfma_f32_32x32x16_bf16 a[16:31], a[36:39], a[64:67], a[16:31]
    ds_read2_b32 a[48:49], v14 offset0:0 offset1:1
    ds_read2_b32 a[50:51], v14 offset0:2 offset1:3
    s_waitcnt lgkmcnt(10)
    v_mfma_f32_32x32x16_bf16 a[0:15], a[36:39], a[68:71], a[0:15]
    ds_read_b128 a[56:59], v11 offset:5072
    ds_read2_b32 a[52:53], v14 offset0:8 offset1:9
    ds_read2_b32 a[54:55], v14 offset0:10 offset1:11
    s_waitcnt lgkmcnt(10)
    v_mfma_f32_32x32x16_bf16 a[16:31], a[40:43], a[72:75], a[16:31]
    ds_read_b128 a[60:63], v11 offset:5040
    s_waitcnt lgkmcnt(10)
    v_mfma_f32_32x32x16_bf16 a[0:15], a[40:43], a[76:79], a[0:15]
    ds_read2_b32 a[32:33], v14 offset0:16 offset1:17
    ds_read2_b32 a[34:35], v14 offset0:18 offset1:19
    ds_read_b128 a[64:67], v11 offset:4992
    s_waitcnt lgkmcnt(10)
    v_mfma_f32_32x32x16_bf16 a[16:31], a[44:47], a[80:83], a[16:31]
    ds_read2_b32 a[36:37], v14 offset0:24 offset1:25
    ds_read2_b32 a[38:39], v14 offset0:26 offset1:27
    s_waitcnt lgkmcnt(11)
    v_mfma_f32_32x32x16_bf16 a[0:15], a[44:47], a[84:87], a[0:15]
    ds_read_b128 a[68:71], v11 offset:4960
    ds_read2_b32 a[40:41], v14 offset0:32 offset1:33
    ds_read2_b32 a[42:43], v14 offset0:34 offset1:35
    s_waitcnt lgkmcnt(11)
    v_mfma_f32_32x32x16_bf16 a[16:31], a[48:51], a[56:59], a[16:31]
    ds_read_b128 a[72:75], v11 offset:4912
    ds_read2_b32 a[44:45], v14 offset0:40 offset1:41
    ds_read2_b32 a[46:47], v14 offset0:42 offset1:43
    s_waitcnt lgkmcnt(11)
    v_mfma_f32_32x32x16_bf16 a[16:31], a[52:55], a[60:63], a[16:31]
    ds_read_b128 a[76:79], v11 offset:4880
    ds_read2_b32 a[48:49], v14 offset0:48 offset1:49
    ds_read2_b32 a[50:51], v14 offset0:50 offset1:51
    s_waitcnt lgkmcnt(11)
    v_mfma_f32_32x32x16_bf16 a[16:31], a[32:35], a[64:67], a[16:31]
    ds_read_b128 a[80:83], v11 offset:4832
    ds_read2_b32 a[52:53], v14 offset0:56 offset1:57
    ds_read2_b32 a[54:55], v14 offset0:58 offset1:59
    s_waitcnt lgkmcnt(11)
    v_mfma_f32_32x32x16_bf16 a[16:31], a[36:39], a[68:71], a[16:31]
    ds_read_b128 a[84:87], v11 offset:4800
    ds_read2_b32 a[32:33], v14 offset0:64 offset1:65
    ds_read2_b32 a[34:35], v14 offset0:66 offset1:67
    s_waitcnt lgkmcnt(11)
    v_mfma_f32_32x32x16_bf16 a[16:31], a[40:43], a[72:75], a[16:31]
    ds_read_b128 a[56:59], v11 offset:4752
    ds_read2_b32 a[36:37], v14 offset0:72 offset1:73
    ds_read2_b32 a[38:39], v14 offset0:74 offset1:75
    s_waitcnt lgkmcnt(11)
    v_mfma_f32_32x32x16_bf16 a[16:31], a[44:47], a[76:79], a[16:31]
    ds_read_b128 a[60:63], v11 offset:4720
    ds_read2_b32 a[40:41], v14 offset0:80 offset1:81
    ds_read2_b32 a[42:43], v14 offset0:82 offset1:83
    s_waitcnt lgkmcnt(11)
    v_mfma_f32_32x32x16_bf16 a[16:31], a[48:51], a[80:83], a[16:31]
    ds_read_b128 a[64:67], v11 offset:4672
    ds_read2_b32 a[44:45], v14 offset0:88 offset1:89
    ds_read2_b32 a[46:47], v14 offset0:90 offset1:91
    s_waitcnt lgkmcnt(11)
    v_mfma_f32_32x32x16_bf16 a[16:31], a[52:55], a[84:87], a[16:31]
    ds_read_b128 a[68:71], v11 offset:4640
    ds_read2_b32 a[48:49], v14 offset0:96 offset1:97
    ds_read2_b32 a[50:51], v14 offset0:98 offset1:99
    s_waitcnt lgkmcnt(11)
    v_mfma_f32_32x32x16_bf16 a[16:31], a[32:35], a[56:59], a[16:31]
    ds_read_b128 a[72:75], v11 offset:4592
    ds_read2_b32 a[52:53], v14 offset0:104 offset1:105
    ds_read2_b32 a[54:55], v14 offset0:106 offset1:107
    s_waitcnt lgkmcnt(11)
    v_mfma_f32_32x32x16_bf16 a[16:31], a[36:39], a[60:63], a[16:31]
    ds_read_b128 a[76:79], v11 offset:4560
    ds_read2_b32 a[32:33], v14 offset0:112 offset1:113
    ds_read2_b32 a[34:35], v14 offset0:114 offset1:115
    s_waitcnt lgkmcnt(11)
    v_mfma_f32_32x32x16_bf16 a[16:31], a[40:43], a[64:67], a[16:31]
    ds_read_b128 a[80:83], v11 offset:4512
    ds_read2_b32 a[36:37], v14 offset0:120 offset1:121
    ds_read2_b32 a[38:39], v14 offset0:122 offset1:123
    s_waitcnt lgkmcnt(11)
    v_mfma_f32_32x32x16_bf16 a[16:31], a[44:47], a[68:71], a[16:31]
    ds_read_b128 a[84:87], v11 offset:4480
    ds_read2_b32 a[40:41], v14 offset0:128 offset1:129
    ds_read2_b32 a[42:43], v14 offset0:130 offset1:131
    s_waitcnt lgkmcnt(11)
    v_mfma_f32_32x32x16_bf16 a[16:31], a[48:51], a[72:75], a[16:31]
    ds_read_b128 a[56:59], v11 offset:4432
    ds_read2_b32 a[44:45], v14 offset0:136 offset1:137
    ds_read2_b32 a[46:47], v14 offset0:138 offset1:139
    s_waitcnt lgkmcnt(11)
    v_mfma_f32_32x32x16_bf16 a[16:31], a[52:55], a[76:79], a[16:31]
    ds_read_b128 a[60:63], v11 offset:4400
    ds_read2_b32 a[48:49], v14 offset0:144 offset1:145
    ds_read2_b32 a[50:51], v14 offset0:146 offset1:147
    s_waitcnt lgkmcnt(11)
    v_mfma_f32_32x32x16_bf16 a[16:31], a[32:35], a[80:83], a[16:31]
    ds_read_b128 a[64:67], v11 offset:4352
    ds_read2_b32 a[52:53], v14 offset0:152 offset1:153
    ds_read2_b32 a[54:55], v14 offset0:154 offset1:155
    s_waitcnt lgkmcnt(11)
    v_mfma_f32_32x32x16_bf16 a[16:31], a[36:39], a[84:87], a[16:31]
    ds_read_b128 a[68:71], v11 offset:4320
    ds_read2_b32 a[32:33], v14 offset0:160 offset1:161
    ds_read2_b32 a[34:35], v14 offset0:162 offset1:163
    s_waitcnt lgkmcnt(11)
    v_mfma_f32_32x32x16_bf16 a[16:31], a[40:43], a[56:59], a[16:31]
    ds_read_b128 a[72:75], v11 offset:4272
    ds_read2_b32 a[36:37], v14 offset0:168 offset1:169
    ds_read2_b32 a[38:39], v14 offset0:170 offset1:171
    s_waitcnt lgkmcnt(11)
    v_mfma_f32_32x32x16_bf16 a[16:31], a[44:47], a[60:63], a[16:31]
    ds_read_b128 a[76:79], v11 offset:4240
    ds_read2_b32 a[40:41], v14 offset0:176 offset1:177
    ds_read2_b32 a[42:43], v14 offset0:178 offset1:179
    s_waitcnt lgkmcnt(11)
    v_mfma_f32_32x32x16_bf16 a[16:31], a[48:51], a[64:67], a[16:31]
    ds_read_b128 a[80:83], v11 offset:4192
    ds_read2_b32 a[44:45], v14 offset0:184 offset1:185
    ds_read2_b32 a[46:47], v14 offset0:186 offset1:187
    s_waitcnt lgkmcnt(11)
    v_mfma_f32_32x32x16_bf16 a[16:31], a[52:55], a[68:71], a[16:31]
    ds_read_b128 a[84:87], v11 offset:4160
    ds_read2_b32 a[48:49], v14 offset0:192 offset1:193
    ds_read2_b32 a[50:51], v14 offset0:194 offset1:195
    s_waitcnt lgkmcnt(11)
    v_mfma_f32_32x32x16_bf16 a[16:31], a[32:35], a[72:75], a[16:31]
    ds_read_b128 a[56:59], v11 offset:4112
    ds_read2_b32 a[52:53], v14 offset0:200 offset1:201
    ds_read2_b32 a[54:55], v14 offset0:202 offset1:203
    s_waitcnt lgkmcnt(11)
    v_mfma_f32_32x32x16_bf16 a[16:31], a[36:39], a[76:79], a[16:31]
    ds_read_b128 a[60:63], v11 offset:4080
    ds_read2_b32 a[32:33], v14 offset0:208 offset1:209
    ds_read2_b32 a[34:35], v14 offset0:210 offset1:211
    s_waitcnt lgkmcnt(11)
    v_mfma_f32_32x32x16_bf16 a[16:31], a[40:43], a[80:83], a[16:31]
    ds_read_b128 a[64:67], v11 offset:4032
    ds_read2_b32 a[36:37], v14 offset0:216 offset1:217
    ds_read2_b32 a[38:39], v14 offset0:218 offset1:219
    s_waitcnt lgkmcnt(11)
    v_mfma_f32_32x32x16_bf16 a[16:31], a[44:47], a[84:87], a[16:31]
    ds_read_b128 a[68:71], v11 offset:4000
    ds_read2_b32 a[40:41], v14 offset0:224 offset1:225
    ds_read2_b32 a[42:43], v14 offset0:226 offset1:227
    s_waitcnt lgkmcnt(11)
    v_mfma_f32_32x32x16_bf16 a[16:31], a[48:51], a[56:59], a[16:31]
    ds_read_b128 a[72:75], v11 offset:3952
    ds_read2_b32 a[44:45], v14 offset0:232 offset1:233
    ds_read2_b32 a[46:47], v14 offset0:234 offset1:235
    s_waitcnt lgkmcnt(11)
    v_mfma_f32_32x32x16_bf16 a[16:31], a[52:55], a[60:63], a[16:31]
    ds_read_b128 a[76:79], v11 offset:3920
    ds_read2_b32 a[48:49], v14 offset0:240 offset1:241
    ds_read2_b32 a[50:51], v14 offset0:242 offset1:243
    s_waitcnt lgkmcnt(11)
    v_mfma_f32_32x32x16_bf16 a[16:31], a[32:35], a[64:67], a[16:31]
    ds_read_b128 a[80:83], v11 offset:3872
    ds_read2_b32 a[52:53], v14 offset0:248 offset1:249
    ds_read2_b32 a[54:55], v14 offset0:250 offset1:251
    v_add_u32 v14, 1024, v14
    s_waitcnt lgkmcnt(11)
    v_mfma_f32_32x32x16_bf16 a[16:31], a[36:39], a[68:71], a[16:31]
    ds_read_b128 a[84:87], v11 offset:3840
    ds_read2_b32 a[32:33], v14 offset0:0 offset1:1
    ds_read2_b32 a[34:35], v14 offset0:2 offset1:3
    s_waitcnt lgkmcnt(11)
    v_mfma_f32_32x32x16_bf16 a[16:31], a[40:43], a[72:75], a[16:31]
    ds_read_b128 a[56:59], v11 offset:3792
    ds_read2_b32 a[36:37], v14 offset0:8 offset1:9
    ds_read2_b32 a[38:39], v14 offset0:10 offset1:11
    s_waitcnt lgkmcnt(11)
    v_mfma_f32_32x32x16_bf16 a[16:31], a[44:47], a[76:79], a[16:31]
    ds_read_b128 a[60:63], v11 offset:3760
    ds_read2_b32 a[40:41], v14 offset0:16 offset1:17
    ds_read2_b32 a[42:43], v14 offset0:18 offset1:19
    s_waitcnt lgkmcnt(11)
    v_mfma_f32_32x32x16_bf16 a[16:31], a[48:51], a[80:83], a[16:31]
    ds_read_b128 a[64:67], v11 offset:3712
    ds_read2_b32 a[44:45], v14 offset0:24 offset1:25
    ds_read2_b32 a[46:47], v14 offset0:26 offset1:27
    s_waitcnt lgkmcnt(11)
    v_mfma_f32_32x32x16_bf16 a[16:31], a[52:55], a[84:87], a[16:31]
    ds_read_b128 a[68:71], v11 offset:3680
    ds_read2_b32 a[48:49], v14 offset0:32 offset1:33
    ds_read2_b32 a[50:51], v14 offset0:34 offset1:35
    s_waitcnt lgkmcnt(11)
    v_mfma_f32_32x32x16_bf16 a[16:31], a[32:35], a[56:59], a[16:31]
    ds_read_b128 a[72:75], v11 offset:3632
    ds_read2_b32 a[52:53], v14 offset0:40 offset1:41
    ds_read2_b32 a[54:55], v14 offset0:42 offset1:43
    s_waitcnt lgkmcnt(11)
    v_mfma_f32_32x32x16_bf16 a[16:31], a[36:39], a[60:63], a[16:31]
    ds_read_b128 a[76:79], v11 offset:3600
    ds_read2_b32 a[32:33], v14 offset0:48 offset1:49
    ds_read2_b32 a[34:35], v14 offset0:50 offset1:51
    s_waitcnt lgkmcnt(11)
    v_mfma_f32_32x32x16_bf16 a[16:31], a[40:43], a[64:67], a[16:31]
    ds_read_b128 a[80:83], v11 offset:3552
    ds_read2_b32 a[36:37], v14 offset0:56 offset1:57
    ds_read2_b32 a[38:39], v14 offset0:58 offset1:59
    s_waitcnt lgkmcnt(11)
    v_mfma_f32_32x32x16_bf16 a[16:31], a[44:47], a[68:71], a[16:31]
    ds_read_b128 a[84:87], v11 offset:3520
    ds_read2_b32 a[40:41], v14 offset0:64 offset1:65
    ds_read2_b32 a[42:43], v14 offset0:66 offset1:67
    s_waitcnt lgkmcnt(11)
    v_mfma_f32_32x32x16_bf16 a[16:31], a[48:51], a[72:75], a[16:31]
    ds_read_b128 a[56:59], v11 offset:3472
    ds_read2_b32 a[44:45], v14 offset0:72 offset1:73
    ds_read2_b32 a[46:47], v14 offset0:74 offset1:75
    s_waitcnt lgkmcnt(11)
    v_mfma_f32_32x32x16_bf16 a[16:31], a[52:55], a[76:79], a[16:31]
    ds_read_b128 a[60:63], v11 offset:3440
    ds_read2_b32 a[48:49], v14 offset0:80 offset1:81
    ds_read2_b32 a[50:51], v14 offset0:82 offset1:83
    s_waitcnt lgkmcnt(11)
    v_mfma_f32_32x32x16_bf16 a[16:31], a[32:35], a[80:83], a[16:31]
    ds_read_b128 a[64:67], v11 offset:3392
    ds_read2_b32 a[52:53], v14 offset0:88 offset1:89
    ds_read2_b32 a[54:55], v14 offset0:90 offset1:91
    s_waitcnt lgkmcnt(11)
    v_mfma_f32_32x32x16_bf16 a[16:31], a[36:39], a[84:87], a[16:31]
    ds_read_b128 a[68:71], v11 offset:3360
    ds_read2_b32 a[32:33], v14 offset0:96 offset1:97
    ds_read2_b32 a[34:35], v14 offset0:98 offset1:99
    s_waitcnt lgkmcnt(11)
    v_mfma_f32_32x32x16_bf16 a[16:31], a[40:43], a[56:59], a[16:31]
    ds_read_b128 a[72:75], v11 offset:3312
    ds_read2_b32 a[36:37], v14 offset0:104 offset1:105
    ds_read2_b32 a[38:39], v14 offset0:106 offset1:107
    s_waitcnt lgkmcnt(11)
    v_mfma_f32_32x32x16_bf16 a[16:31], a[44:47], a[60:63], a[16:31]
    ds_read_b128 a[76:79], v11 offset:3280
    ds_read2_b32 a[40:41], v14 offset0:112 offset1:113
    ds_read2_b32 a[42:43], v14 offset0:114 offset1:115
    s_waitcnt lgkmcnt(11)
    v_mfma_f32_32x32x16_bf16 a[16:31], a[48:51], a[64:67], a[16:31]
    ds_read_b128 a[80:83], v11 offset:3232
    ds_read2_b32 a[44:45], v14 offset0:120 offset1:121
    ds_read2_b32 a[46:47], v14 offset0:122 offset1:123
    s_waitcnt lgkmcnt(11)
    v_mfma_f32_32x32x16_bf16 a[16:31], a[52:55], a[68:71], a[16:31]
    ds_read_b128 a[84:87], v11 offset:3200
    ds_read2_b32 a[48:49], v14 offset0:128 offset1:129
    ds_read2_b32 a[50:51], v14 offset0:130 offset1:131
    s_waitcnt lgkmcnt(11)
    v_mfma_f32_32x32x16_bf16 a[16:31], a[32:35], a[72:75], a[16:31]
    ds_read_b128 a[56:59], v11 offset:3152
    ds_read2_b32 a[52:53], v14 offset0:136 offset1:137
    ds_read2_b32 a[54:55], v14 offset0:138 offset1:139
    s_waitcnt lgkmcnt(11)
    v_mfma_f32_32x32x16_bf16 a[16:31], a[36:39], a[76:79], a[16:31]
    ds_read_b128 a[60:63], v11 offset:3120
    ds_read2_b32 a[32:33], v14 offset0:144 offset1:145
    ds_read2_b32 a[34:35], v14 offset0:146 offset1:147
    s_waitcnt lgkmcnt(11)
    v_mfma_f32_32x32x16_bf16 a[16:31], a[40:43], a[80:83], a[16:31]
    ds_read_b128 a[64:67], v11 offset:3072
    ds_read2_b32 a[36:37], v14 offset0:152 offset1:153
    ds_read2_b32 a[38:39], v14 offset0:154 offset1:155
    s_waitcnt lgkmcnt(11)
    v_mfma_f32_32x32x16_bf16 a[16:31], a[44:47], a[84:87], a[16:31]
    ds_read_b128 a[68:71], v11 offset:3040
    ds_read2_b32 a[40:41], v14 offset0:160 offset1:161
    ds_read2_b32 a[42:43], v14 offset0:162 offset1:163
    s_waitcnt lgkmcnt(11)
    v_mfma_f32_32x32x16_bf16 a[16:31], a[48:51], a[56:59], a[16:31]
    ds_read_b128 a[72:75], v11 offset:2992
    ds_read2_b32 a[44:45], v14 offset0:168 offset1:169
    ds_read2_b32 a[46:47], v14 offset0:170 offset1:171
    s_waitcnt lgkmcnt(11)
    v_mfma_f32_32x32x16_bf16 a[16:31], a[52:55], a[60:63], a[16:31]
    ds_read_b128 a[76:79], v11 offset:2960
    ds_read2_b32 a[48:49], v14 offset0:176 offset1:177
    ds_read2_b32 a[50:51], v14 offset0:178 offset1:179
    s_waitcnt lgkmcnt(11)
    v_mfma_f32_32x32x16_bf16 a[16:31], a[32:35], a[64:67], a[16:31]
    ds_read_b128 a[80:83], v11 offset:2912
    ds_read2_b32 a[52:53], v14 offset0:184 offset1:185
    ds_read2_b32 a[54:55], v14 offset0:186 offset1:187
    s_waitcnt lgkmcnt(11)
    v_mfma_f32_32x32x16_bf16 a[16:31], a[36:39], a[68:71], a[16:31]
    ds_read_b128 a[84:87], v11 offset:2880
    ds_read2_b32 a[32:33], v14 offset0:192 offset1:193
    ds_read2_b32 a[34:35], v14 offset0:194 offset1:195
    s_waitcnt lgkmcnt(11)
    v_mfma_f32_32x32x16_bf16 a[16:31], a[40:43], a[72:75], a[16:31]
    ds_read_b128 a[56:59], v11 offset:2832
    ds_read2_b32 a[36:37], v14 offset0:200 offset1:201
    ds_read2_b32 a[38:39], v14 offset0:202 offset1:203
    s_waitcnt lgkmcnt(11)
    v_mfma_f32_32x32x16_bf16 a[16:31], a[44:47], a[76:79], a[16:31]
    ds_read_b128 a[60:63], v11 offset:2800
    ds_read2_b32 a[40:41], v14 offset0:208 offset1:209
    ds_read2_b32 a[42:43], v14 offset0:210 offset1:211
    s_waitcnt lgkmcnt(11)
    v_mfma_f32_32x32x16_bf16 a[16:31], a[48:51], a[80:83], a[16:31]
    ds_read_b128 a[64:67], v11 offset:2752
    ds_read2_b32 a[44:45], v14 offset0:216 offset1:217
    ds_read2_b32 a[46:47], v14 offset0:218 offset1:219
    s_waitcnt lgkmcnt(11)
    v_mfma_f32_32x32x16_bf16 a[16:31], a[52:55], a[84:87], a[16:31]
    ds_read_b128 a[68:71], v11 offset:2720
    ds_read2_b32 a[48:49], v14 offset0:224 offset1:225
    ds_read2_b32 a[50:51], v14 offset0:226 offset1:227
    s_waitcnt lgkmcnt(11)
    v_mfma_f32_32x32x16_bf16 a[16:31], a[32:35], a[56:59], a[16:31]
    ds_read_b128 a[72:75], v11 offset:2672
    ds_read2_b32 a[52:53], v14 offset0:232 offset1:233
    ds_read2_b32 a[54:55], v14 offset0:234 offset1:235
    s_waitcnt lgkmcnt(11)
    v_mfma_f32_32x32x16_bf16 a[16:31], a[36:39], a[60:63], a[16:31]
    ds_read_b128 a[76:79], v11 offset:2640
    ds_read2_b32 a[32:33], v14 offset0:240 offset1:241
    ds_read2_b32 a[34:35], v14 offset0:242 offset1:243
    s_waitcnt lgkmcnt(11)
    v_mfma_f32_32x32x16_bf16 a[16:31], a[40:43], a[64:67], a[16:31]
    ds_read_b128 a[80:83], v11 offset:2592
    ds_read2_b32 a[36:37], v14 offset0:248 offset1:249
    ds_read2_b32 a[38:39], v14 offset0:250 offset1:251
    v_add_u32 v14, 1024, v14
    s_waitcnt lgkmcnt(11)
    v_mfma_f32_32x32x16_bf16 a[16:31], a[44:47], a[68:71], a[16:31]
    ds_read_b128 a[84:87], v11 offset:2560
    s_waitcnt lgkmcnt(9)
    v_mfma_f32_32x32x16_bf16 a[16:31], a[48:51], a[72:75], a[16:31]
    s_waitcnt lgkmcnt(6)
    v_mfma_f32_32x32x16_bf16 a[16:31], a[52:55], a[76:79], a[16:31]
    s_waitcnt lgkmcnt(3)
    v_mfma_f32_32x32x16_bf16 a[16:31], a[32:35], a[80:83], a[16:31]
    s_waitcnt lgkmcnt(0)
    v_mfma_f32_32x32x16_bf16 a[16:31], a[36:39], a[84:87], a[16:31]
    v_accvgpr_read_b32 v220, a0
    v_accvgpr_read_b32 v221, a1
    v_accvgpr_read_b32 v222, a2
    v_accvgpr_read_b32 v223, a3
    v_accvgpr_read_b32 v224, a4
    v_accvgpr_read_b32 v225, a5
    v_accvgpr_read_b32 v226, a6
    v_accvgpr_read_b32 v227, a7
    v_accvgpr_read_b32 v228, a8
    v_accvgpr_read_b32 v229, a9
    v_accvgpr_read_b32 v230, a10
    v_accvgpr_read_b32 v231, a11
    v_accvgpr_read_b32 v232, a12
    v_accvgpr_read_b32 v233, a13
    v_accvgpr_read_b32 v234, a14
    v_accvgpr_read_b32 v235, a15
    v_cvt_pk_bf16_f32 v236, v220, v221
    v_cvt_pk_bf16_f32 v237, v222, v223
    v_cvt_pk_bf16_f32 v238, v224, v225
    v_cvt_pk_bf16_f32 v239, v226, v227
    v_cvt_pk_bf16_f32 v240, v228, v229
    v_cvt_pk_bf16_f32 v241, v230, v231
    v_cvt_pk_bf16_f32 v242, v232, v233
    v_cvt_pk_bf16_f32 v243, v234, v235
    s_nop 0
    v_permlane32_swap_b32 v236, v238
    v_permlane32_swap_b32 v237, v239
    v_permlane32_swap_b32 v240, v242
    v_permlane32_swap_b32 v241, v243
    buffer_store_dwordx4 v[236:239], v2, s[8:11], s7 offen offset:0 sc1
    buffer_store_dwordx4 v[240:243], v2, s[8:11], s7 offen offset:1024 sc1
    v_accvgpr_read_b32 v220, a16
    v_accvgpr_read_b32 v221, a17
    v_accvgpr_read_b32 v222, a18
    v_accvgpr_read_b32 v223, a19
    v_accvgpr_read_b32 v224, a20
    v_accvgpr_read_b32 v225, a21
    v_accvgpr_read_b32 v226, a22
    v_accvgpr_read_b32 v227, a23
    v_accvgpr_read_b32 v228, a24
    v_accvgpr_read_b32 v229, a25
    v_accvgpr_read_b32 v230, a26
    v_accvgpr_read_b32 v231, a27
    v_accvgpr_read_b32 v232, a28
    v_accvgpr_read_b32 v233, a29
    v_accvgpr_read_b32 v234, a30
    v_accvgpr_read_b32 v235, a31
    v_cvt_pk_bf16_f32 v236, v220, v221
    v_cvt_pk_bf16_f32 v237, v222, v223
    v_cvt_pk_bf16_f32 v238, v224, v225
    v_cvt_pk_bf16_f32 v239, v226, v227
    v_cvt_pk_bf16_f32 v240, v228, v229
    v_cvt_pk_bf16_f32 v241, v230, v231
    v_cvt_pk_bf16_f32 v242, v232, v233
    v_cvt_pk_bf16_f32 v243, v234, v235
    s_nop 0
    v_permlane32_swap_b32 v236, v238
    v_permlane32_swap_b32 v237, v239
    v_permlane32_swap_b32 v240, v242
    v_permlane32_swap_b32 v241, v243
    buffer_store_dwordx4 v[236:239], v2, s[8:11], s7 offen offset:2048 sc1
    buffer_store_dwordx4 v[240:243], v2, s[8:11], s7 offen offset:3072 sc1
    v_add_u32 v11, 30720, v11
    s_add_u32 s64, s64, 1
    s_cmp_lt_u32 s64, 4
    s_waitcnt vmcnt(4)
    s_cbranch_scc1 .chan_410
    s_waitcnt vmcnt(0)
    s_barrier
    v_mov_b32 v4, 1
    v_mov_b32 v5, 0
    s_mov_b64 exec, 1
    buffer_store_dword v4, v5, s[8:11], s94 offen offset:4 sc1
    s_mov_b64 exec, -1
    s_branch .fin_413
.qa_402:
    s_and_b32 s34, s24, 1
    s_lshr_b32 s35, s24, 1
    s_lshl_b32 s4, s35, 10
    s_add_u32 s4, s4, 2048
    v_lshlrev_b32 v2, 4, v1
    s_lshl_b32 s5, s24, 10
    s_add_u32 s5, s5, 131072
    v_add_u32 v24, s5, v2
    s_lshl_b32 s5, s34, 12
    s_add_u32 s5, s5, 131072
    v_add_u32 v25, s5, v2
    v_add_u32 v31, 139264, v2
    s_lshl_b32 s5, s35, 12
    v_add_u32 v5, s5, v31
    s_lshl_b32 s43, s24, 11
    v_bfe_u32 v254, v1, 4, 2
    v_mul_u32_u24 v3, 128, v254
    v_bfe_u32 v254, v1, 2, 2
    v_mul_u32_u24 v254, 32, v254
    v_add_u32 v3, v3, v254
    v_bfe_u32 v254, v1, 0, 1
    v_mul_u32_u24 v254, 16, v254
    v_add_u32 v3, v3, v254
    v_add_u32 v3, 155648, v3
    v_bfe_u32 v254, v1, 2, 2
    v_mul_u32_u24 v6, 128, v254
    v_bfe_u32 v254, v1, 0, 2
    v_mul_u32_u24 v254, 16, v254
    v_add_u32 v6, v6, v254
    v_bfe_u32 v254, v1, 4, 2
    v_mul_u32_u24 v254, 4, v254
    v_add_u32 v6, v6, v254
    v_add_u32 v6, 155648, v6
    v_add_u32 v6, s4, v6
    s_lshl_b32 s4, s99, 9
    s_add_u32 s4, s4, 92274688
    v_bfe_u32 v254, v1, 0, 2
    v_mul_u32_u24 v7, 128, v254
    v_add_u32 v7, s4, v7
    v_mov_b32 v232, 0
    v_mov_b32 v233, 0
    v_mov_b32 v234, 0
    v_mov_b32 v235, 0
    v_mov_b32 v236, 0
    v_mov_b32 v237, 0
    v_mov_b32 v238, 0
    v_mov_b32 v239, 0
    v_mov_b32 v240, 0
    v_mov_b32 v241, 0
    v_mov_b32 v40, 0
    v_mov_b32 v44, 0x3f803f80
    v_mov_b32 v41, 0
    v_mov_b32 v45, 0x3f803f80
    v_mov_b32 v42, 0
    v_mov_b32 v46, 0x3f803f80
    v_mov_b32 v43, 0
    v_mov_b32 v47, 0x3f803f80
    s_lshl_b32 s4, s34, 4
    v_and_b32 v48, 15, v1
    v_add_u32 v48, s4, v48
    v_lshrrev_b32 v49, 4, v1
    v_lshlrev_b32 v49, 2, v49
    v_mov_b32 v51, 0xff800000
    v_add_u32 v50, 0, v49
    v_cmp_le_u32 vcc, v50, v48
    s_nop 1
    v_cndmask_b32 v32, v51, v40, vcc
    v_add_u32 v50, 1, v49
    v_cmp_le_u32 vcc, v50, v48
    s_nop 1
    v_cndmask_b32 v33, v51, v40, vcc
    v_add_u32 v50, 2, v49
    v_cmp_le_u32 vcc, v50, v48
    s_nop 1
    v_cndmask_b32 v34, v51, v40, vcc
    v_add_u32 v50, 3, v49
    v_cmp_le_u32 vcc, v50, v48
    s_nop 1
    v_cndmask_b32 v35, v51, v40, vcc
    v_add_u32 v50, 16, v49
    v_cmp_le_u32 vcc, v50, v48
    s_nop 1
    v_cndmask_b32 v36, v51, v40, vcc
    v_add_u32 v50, 17, v49
    v_cmp_le_u32 vcc, v50, v48
    s_nop 1
    v_cndmask_b32 v37, v51, v40, vcc
    v_add_u32 v50, 18, v49
    v_cmp_le_u32 vcc, v50, v48
    s_nop 1
    v_cndmask_b32 v38, v51, v40, vcc
    v_add_u32 v50, 19, v49
    v_cmp_le_u32 vcc, v50, v48
    s_nop 1
    v_cndmask_b32 v39, v51, v40, vcc
    s_lshl_b32 s4, s99, 7
    s_lshl_b32 s5, s24, 2
    s_add_u32 s4, s4, s5
    s_add_u32 s94, s4, 92340224
    s_mov_b32 s46, 16384
    s_mov_b32 s47, 32768
    s_mov_b32 s30, -1
    s_mov_b32 s32, 0
    s_mov_b32 s33, 0
    s_mov_b32 s42, 0
    s_mov_b32 s53, 75497472
    s_mov_b32 s45, 0x3e0293ee
    s_lshl_b32 s36, s99, 13
    s_add_u32 s36, s36, s43
    s_add_u32 s36, s36, 16777216
    s_add_u32 s43, s43, 139264
    s_sub_u32 s37, s36, 0x40000
    v_and_b32 v255, 15, v1
    v_bfe_u32 v254, v1, 4, 1
    v_lshlrev_b32 v255, 7, v255
    v_lshl_add_u32 v255, v254, 24, v255
    s_lshl_b32 s39, s99, 12
    s_lshl_b32 s4, s34, 12
    s_lshl_b32 s40, s99, 13
    s_add_u32 s40, s40, s4
    s_lshl_b32 s4, s35, 11
    s_add_u32 s40, s40, s4
    s_add_u32 s40, s40, 16777216
    s_add_u32 s39, s39, 67108864
    s_lshl_b32 s52, s24, 10
    s_add_u32 s39, s39, s52
    s_add_u32 s52, s52, 155648
    s_mov_b32 s31, 1
    s_sub_u32 s48, s39, 0x20000
    s_mov_b32 s49, s37
    s_mov_b32 vcc_lo, s27
    s_mov_b32 vcc_hi, 0
    s_cmp_gt_u32 s32, 0
    s_cbranch_scc1 .ndd_429
    s_mov_b32 s62, 0
.nd_428:
    buffer_load_dword v29, v7, s[8:11], s46 offen sc1
    buffer_load_dword v30, v7, s[8:11], s47 offen sc1
    s_add_u32 s62, s62, 1
    s_cmp_gt_u32 s62, 0x200000
    s_cbranch_scc1 .mg_end_1
    s_waitcnt vmcnt(0)
    v_min_u32 v29, v29, v30
    s_nop 1
    v_min_u32_dpp v29, v29, v29 quad_perm:[1,0,3,2] row_mask:0xf bank_mask:0xf
    s_nop 1
    v_min_u32_dpp v29, v29, v29 quad_perm:[2,3,0,1] row_mask:0xf bank_mask:0xf
    s_nop 1
    v_readfirstlane_b32 s32, v29
    s_lshl_b32 s55, s32, 18
    s_add_u32 s55, s55, s37
    s_cmp_gt_u32 s32, 0
    s_cbranch_scc1 .ndd_429
    s_sleep 2
    s_branch .nd_428
.ndd_429:
    s_waitcnt lgkmcnt(0)
    s_mov_b32 s14, 3801088
.p2align 6
.ql_430:
    s_waitcnt lgkmcnt(8)
    v_mfma_f32_16x16x32_bf16 v[192:195], a[0:3], v[64:67], 0
    buffer_load_dwordx4 v19, s[12:15], s29 offen offset:2048 lds
    v_mfma_f32_16x16x32_bf16 v[196:199], a[4:7], v[64:67], 0
    ds_read_b128 v[112:115], v10 offset:256
    ds_read_b128 v[116:119], v10 offset:33024
    v_mfma_f32_16x16x32_bf16 v[200:203], a[0:3], v[68:71], 0
    ds_read_b128 v[120:123], v11 offset:256
    ds_read_b128 v[124:127], v11 offset:33024
    v_mfma_f32_16x16x32_bf16 v[204:207], a[4:7], v[68:71], 0
    ds_read_b128 v[64:67], v8 offset:512
    ds_read_b128 v[68:71], v8 offset:33280
    v_mfma_f32_16x16x32_bf16 v[192:195], a[8:11], v[72:75], v[192:195]
    buffer_load_dwordx4 v19, s[12:15], s29 offen offset:3072 lds
    v_mfma_f32_16x16x32_bf16 v[196:199], a[12:15], v[72:75], v[196:199]
    v_cvt_pk_bf16_f32 v224, v208, v209
    v_cvt_pk_bf16_f32 v225, v210, v211
    v_mfma_f32_16x16x32_bf16 v[200:203], a[8:11], v[76:79], v[200:203]
    v_cvt_pk_bf16_f32 v226, v212, v213
    v_cvt_pk_bf16_f32 v227, v214, v215
    v_mfma_f32_16x16x32_bf16 v[204:207], a[12:15], v[76:79], v[204:207]
    ds_write_b128 v24, v[224:227] offset:0
    s_waitcnt lgkmcnt(11)
    v_mfma_f32_16x16x32_bf16 v[192:195], a[16:19], v[80:83], v[192:195]
    s_add_u32 m0, s6, 73728
    v_cvt_pk_bf16_f32 v228, v216, v217
    v_mfma_f32_16x16x32_bf16 v[196:199], a[20:23], v[80:83], v[196:199]
    buffer_load_dwordx4 v20, s[12:15], s29 offen offset:0 lds
    v_mfma_f32_16x16x32_bf16 v[200:203], a[16:19], v[84:87], v[200:203]
    v_cvt_pk_bf16_f32 v229, v218, v219
    v_cvt_pk_bf16_f32 v230, v220, v221
    v_mfma_f32_16x16x32_bf16 v[204:207], a[20:23], v[84:87], v[204:207]
    v_cvt_pk_bf16_f32 v231, v222, v223
    ds_write_b128 v24, v[228:231] offset:4096
    v_mfma_f32_16x16x32_bf16 v[192:195], a[24:27], v[88:91], v[192:195]
    ds_read_b128 v[72:75], v9 offset:512
    ds_read_b128 v[76:79], v9 offset:33280
    v_mfma_f32_16x16x32_bf16 v[196:199], a[28:31], v[88:91], v[196:199]
    buffer_load_dwordx4 v20, s[12:15], s29 offen offset:1024 lds
    v_mfma_f32_16x16x32_bf16 v[200:203], a[24:27], v[92:95], v[200:203]
    ds_read_b128 v[80:83], v10 offset:512
    ds_read_b128 v[84:87], v10 offset:33280
    v_mfma_f32_16x16x32_bf16 v[204:207], a[28:31], v[92:95], v[204:207]
    ds_read_b128 v[88:91], v11 offset:512
    s_waitcnt lgkmcnt(13)
    v_mfma_f32_16x16x32_bf16 v[192:195], a[32:35], v[96:99], v[192:195]
    s_waitcnt vmcnt(13) lgkmcnt(5)
    s_barrier
    v_mfma_f32_16x16x32_bf16 v[196:199], a[36:39], v[96:99], v[196:199]
    buffer_load_dwordx4 v21, s[12:15], s29 offen offset:2048 lds
    v_mfma_f32_16x16x32_bf16 v[200:203], a[32:35], v[100:103], v[200:203]
    ds_read_b128 v[208:211], v25 offset:0
    ds_read_b128 v[128:131], v31 offset:0
    v_mfma_f32_16x16x32_bf16 v[204:207], a[36:39], v[100:103], v[204:207]
    ds_read_b128 v[144:147], v31 offset:4096
    ds_read_b128 v[212:215], v25 offset:1024
    v_mfma_f32_16x16x32_bf16 v[192:195], a[40:43], v[104:107], v[192:195]
    ds_read_b128 v[132:135], v31 offset:1024
    ds_read_b128 v[148:151], v31 offset:5120
    v_mfma_f32_16x16x32_bf16 v[196:199], a[44:47], v[104:107], v[196:199]
    buffer_load_dwordx4 v21, s[12:15], s29 offen offset:3072 lds
    v_mfma_f32_16x16x32_bf16 v[200:203], a[40:43], v[108:111], v[200:203]
    ds_read_b128 v[92:95], v11 offset:33280
    ds_read_b128 v[216:219], v25 offset:2048
    v_mfma_f32_16x16x32_bf16 v[204:207], a[44:47], v[108:111], v[204:207]
    ds_read_b128 v[136:139], v31 offset:2048
    ds_read_b128 v[152:155], v31 offset:6144
    v_mfma_f32_16x16x32_bf16 v[192:195], a[48:51], v[112:115], v[192:195]
    ds_read_b128 v[220:223], v25 offset:3072
    ds_read_b128 v[140:143], v31 offset:3072
    v_mfma_f32_16x16x32_bf16 v[196:199], a[52:55], v[112:115], v[196:199]
    s_add_u32 m0, s6, 77824
    s_waitcnt lgkmcnt(9)
    v_mfma_f32_16x16x32_bf16 v[48:51], v[128:131], v[208:211], v[32:35]
    buffer_load_dwordx4 v22, s[12:15], s29 offen offset:0 lds
    v_mfma_f32_16x16x32_bf16 v[52:55], v[144:147], v[208:211], v[36:39]
    ds_read_b128 v[156:159], v31 offset:7168
    s_waitcnt lgkmcnt(7)
    v_mfma_f32_16x16x32_bf16 v[48:51], v[132:135], v[212:215], v[48:51]
    ds_read_b128 v[160:163], v5 offset:8192
    ds_read_b128 v[164:167], v5 offset:9216
    v_mfma_f32_16x16x32_bf16 v[52:55], v[148:151], v[212:215], v[52:55]
    ds_read_b128 v[96:99], v8 offset:768
    s_waitcnt lgkmcnt(6)
    v_mfma_f32_16x16x32_bf16 v[48:51], v[136:139], v[216:219], v[48:51]
    buffer_load_dwordx4 v22, s[12:15], s29 offen offset:1024 lds
    v_mfma_f32_16x16x32_bf16 v[52:55], v[152:155], v[216:219], v[52:55]
    ds_read_b128 v[100:103], v8 offset:33536
    ds_read_b128 v[104:107], v9 offset:768
    v_mfma_f32_16x16x32_bf16 v[200:203], a[48:51], v[116:119], v[200:203]
    ds_read_b128 v[108:111], v9 offset:33536
    ds_read_b128 v[168:171], v5 offset:10240
    v_mfma_f32_16x16x32_bf16 v[204:207], a[52:55], v[116:119], v[204:207]
    ds_read_b128 v[172:175], v5 offset:11264
    s_waitcnt lgkmcnt(8)
    v_mfma_f32_16x16x32_bf16 v[48:51], v[140:143], v[220:223], v[48:51]
    buffer_load_dwordx4 v23, s[12:15], s29 offen offset:2048 lds
    v_mfma_f32_16x16x32_bf16 v[52:55], v[156:159], v[220:223], v[52:55]
    v_max_i32 v27, s30, v26
    ds_read_b128 v[112:115], v10 offset:768
    v_mfma_f32_16x16x32_bf16 v[192:195], a[56:59], v[120:123], v[192:195]
    s_waitcnt vmcnt(12)
    s_cbranch_vccnz .cp_436
    buffer_store_dword v27, v26, s[8:11], s94 offen
.cb_437:
    v_mfma_f32_16x16x32_bf16 v[196:199], a[60:63], v[120:123], v[196:199]
    ds_read_b128 v[116:119], v10 offset:33536
    ds_read_b128 v[120:123], v11 offset:768
    v_mfma_f32_16x16x32_bf16 v[200:203], a[56:59], v[124:127], v[200:203]
    buffer_load_dwordx4 v23, s[12:15], s29 offen offset:3072 lds
    v_mfma_f32_16x16x32_bf16 v[204:207], a[60:63], v[124:127], v[204:207]
    s_cmp_eq_u32 s31, 0
    s_cbranch_scc1 .cp_440
.cb_441:
    v_mfma_f32_16x16x32_bf16 v[192:195], a[64:67], v[64:67], v[192:195]
    s_waitcnt lgkmcnt(3)
    s_barrier
    v_mfma_f32_16x16x32_bf16 v[196:199], a[68:71], v[64:67], v[196:199]
    ds_read_b128 v[124:127], v11 offset:33536
    ds_read_b128 v[176:179], v3 offset:0
    v_mfma_f32_16x16x32_bf16 v[200:203], a[64:67], v[68:71], v[200:203]
    ds_read_b128 v[180:183], v3 offset:512
    ds_read_b128 v[184:187], v3 offset:1024
    v_mfma_f32_16x16x32_bf16 v[204:207], a[68:71], v[68:71], v[204:207]
    ds_read_b128 v[188:191], v3 offset:1536
    ds_read_b128 v[64:67], v8 offset:1024
    v_mfma_f32_16x16x32_bf16 v[192:195], a[72:75], v[72:75], v[192:195]
    ds_read_b128 v[68:71], v8 offset:33792
    v_max3_f32 v248, v48, v49, v50
    v_mfma_f32_16x16x32_bf16 v[196:199], a[76:79], v[72:75], v[196:199]
    ds_read_b128 v[72:75], v9 offset:1024
    v_max3_f32 v248, v248, v51, v52
    v_mfma_f32_16x16x32_bf16 v[200:203], a[72:75], v[76:79], v[200:203]
    v_max3_f32 v249, v53, v54, v55
    s_add_u32 m0, s52, 4096
    v_mfma_f32_16x16x32_bf16 v[204:207], a[76:79], v[76:79], v[204:207]
    ds_read_b128 v[76:79], v9 offset:33792
    s_add_u32 s48, s48, 0x20000
    v_mfma_f32_16x16x32_bf16 v[192:195], a[80:83], v[80:83], v[192:195]
    s_mov_b32 s31, 1
    buffer_load_dword v29, v28, s[12:15], s29 offen
    v_mfma_f32_16x16x32_bf16 v[196:199], a[84:87], v[80:83], v[196:199]
    s_cmp_gt_u32 s33, s42
    s_cbranch_scc0 .pp_442
    buffer_load_dwordx4 v2, s[8:11], s48 offen lds
.pb_443:
    s_waitcnt lgkmcnt(4)
    v_mfma_f32_16x16x32_bf16 v[56:59], v[176:179], v[208:211], 0
    ds_read_b128 v[80:83], v10 offset:1024
    s_add_u32 s29, s29, 0x10000
    v_mfma_f32_16x16x32_bf16 v[56:59], v[180:183], v[212:215], v[56:59]
    s_cmp_gt_u32 s32, s42
    s_cbranch_scc0 .cp_438
.cb_439:
    v_mfma_f32_16x16x32_bf16 v[56:59], v[184:187], v[216:219], v[56:59]
    ds_read_b32 v232, v6 offset:0
    ds_read_b32 v234, v6 offset:64
    v_mfma_f32_16x16x32_bf16 v[56:59], v[188:191], v[220:223], v[56:59]
    ds_read_b32 v236, v6 offset:512
    ds_read_b32 v238, v6 offset:576
    v_mfma_f32_16x16x32_bf16 v[200:203], a[80:83], v[84:87], v[200:203]
    s_mov_b32 m0, s43
    s_add_u32 s49, s49, 0x40000
    v_mfma_f32_16x16x32_bf16 v[204:207], a[84:87], v[84:87], v[204:207]
    ds_read_b128 v[84:87], v10 offset:33792
    v_mfma_f32_16x16x32_bf16 v[192:195], a[88:91], v[88:91], v[192:195]
    buffer_load_dwordx4 v2, s[8:11], s49 offen lds
    v_mfma_f32_16x16x32_bf16 v[196:199], a[92:95], v[88:91], v[196:199]
    ds_read_b128 v[88:91], v11 offset:1024
    v_max3_f32 v248, v248, v56, v57
    v_mfma_f32_16x16x32_bf16 v[200:203], a[88:91], v[92:95], v[200:203]
    v_max_f32 v30, v248, v249
    v_max_f32 v249, v248, v249
    v_mfma_f32_16x16x32_bf16 v[204:207], a[92:95], v[92:95], v[204:207]
    ds_read_b128 v[92:95], v11 offset:33792
    s_add_u32 s50, s49, 16777216
    v_mfma_f32_16x16x32_bf16 v[192:195], a[96:99], v[96:99], v[192:195]
    v_permlane16_swap_b32 v249, v30
    v_max_f32 v248, v249, v30
    v_mfma_f32_16x16x32_bf16 v[196:199], a[100:103], v[96:99], v[196:199]
    v_max_f32 v249, v249, v30
    ds_read_b128 v[96:99], v8 offset:1280
    v_mfma_f32_16x16x32_bf16 v[200:203], a[96:99], v[100:103], v[200:203]
    buffer_load_dwordx4 v2, s[8:11], s49 offen offset:1024 lds
    v_mfma_f32_16x16x32_bf16 v[204:207], a[100:103], v[100:103], v[204:207]
    v_permlane32_swap_b32 v248, v249
    v_max_f32 v248, v248, v249
    v_mfma_f32_16x16x32_bf16 v[192:195], a[104:107], v[104:107], v[192:195]
    v_mul_f32 v248, s45, v248
    ds_read_b128 v[100:103], v8 offset:34048
    v_mfma_f32_16x16x32_bf16 v[196:199], a[108:111], v[104:107], v[196:199]
    ds_read_b128 v[104:107], v9 offset:1280
    v_fma_f32 v60, v48, s45, -v248
    v_mfma_f32_16x16x32_bf16 v[200:203], a[104:107], v[108:111], v[200:203]
    v_fma_f32 v61, v49, s45, -v248
    v_fma_f32 v62, v50, s45, -v248
    v_mfma_f32_16x16x32_bf16 v[204:207], a[108:111], v[108:111], v[204:207]
    ds_read_b128 v[108:111], v9 offset:34048
    v_fma_f32 v63, v51, s45, -v248
    v_mfma_f32_16x16x32_bf16 v[192:195], a[112:115], v[112:115], v[192:195]
    v_fma_f32 v242, v52, s45, -v248
    v_fma_f32 v243, v53, s45, -v248
    v_mfma_f32_16x16x32_bf16 v[196:199], a[116:119], v[112:115], v[196:199]
    v_fma_f32 v244, v54, s45, -v248
    v_fma_f32 v245, v55, s45, -v248
    v_mfma_f32_16x16x32_bf16 v[200:203], a[112:115], v[116:119], v[200:203]
    v_fma_f32 v246, v56, s45, -v248
    v_fma_f32 v247, v57, s45, -v248
    v_mfma_f32_16x16x32_bf16 v[204:207], a[116:119], v[116:119], v[204:207]
    ds_read_b128 v[112:115], v10 offset:1280
    ds_read_b128 v[116:119], v10 offset:34048
    v_mfma_f32_16x16x32_bf16 v[192:195], a[120:123], v[120:123], v[192:195]
    s_add_u32 m0, s43, 8192
    s_add_u32 s5, s49, 0x40000
    v_mfma_f32_16x16x32_bf16 v[196:199], a[124:127], v[120:123], v[196:199]
    ds_read_b128 v[120:123], v11 offset:1280
    v_mfma_f32_16x16x32_bf16 v[200:203], a[120:123], v[124:127], v[200:203]
    buffer_load_dwordx4 v2, s[8:11], s50 offen lds
    v_mfma_f32_16x16x32_bf16 v[204:207], a[124:127], v[124:127], v[204:207]
    ds_read_b128 v[124:127], v11 offset:34048
    s_waitcnt lgkmcnt(15)
    v_mfma_f32_16x16x32_bf16 v[192:195], a[128:131], v[64:67], v[192:195]
    s_min_u32 s5, s5, s55
    v_mfma_f32_16x16x32_bf16 v[196:199], a[132:135], v[64:67], v[196:199]
    v_exp_f32 v60, v60
    v_mfma_f32_16x16x32_bf16 v[200:203], a[128:131], v[68:71], v[200:203]
    v_exp_f32 v61, v61
    v_mfma_f32_16x16x32_bf16 v[204:207], a[132:135], v[68:71], v[204:207]
    v_exp_f32 v62, v62
    v_mfma_f32_16x16x32_bf16 v[192:195], a[136:139], v[72:75], v[192:195]
    v_exp_f32 v63, v63
    v_mfma_f32_16x16x32_bf16 v[196:199], a[140:143], v[72:75], v[196:199]
    v_exp_f32 v242, v242
    v_mfma_f32_16x16x32_bf16 v[200:203], a[136:139], v[76:79], v[200:203]
    v_exp_f32 v243, v243
    v_mfma_f32_16x16x32_bf16 v[204:207], a[140:143], v[76:79], v[204:207]
    ds_read_b128 v[64:67], v8 offset:1536
    s_waitcnt lgkmcnt(9)
    v_mfma_f32_16x16x32_bf16 v[192:195], a[144:147], v[80:83], v[192:195]
    v_exp_f32 v244, v244
    v_mfma_f32_16x16x32_bf16 v[196:199], a[148:151], v[80:83], v[196:199]
    v_exp_f32 v245, v245
    v_mfma_f32_16x16x32_bf16 v[200:203], a[144:147], v[84:87], v[200:203]
    v_exp_f32 v246, v246
    v_mfma_f32_16x16x32_bf16 v[204:207], a[148:151], v[84:87], v[204:207]
    v_exp_f32 v247, v247
    v_mfma_f32_16x16x32_bf16 v[192:195], a[152:155], v[88:91], v[192:195]
    ds_read_b128 v[68:71], v8 offset:34304
    ds_read_b128 v[72:75], v9 offset:1536
    v_mfma_f32_16x16x32_bf16 v[196:199], a[156:159], v[88:91], v[196:199]
    ds_read_b128 v[76:79], v9 offset:34304
    v_cvt_pk_bf16_f32 v48, v60, v61
    v_mfma_f32_16x16x32_bf16 v[200:203], a[152:155], v[92:95], v[200:203]
    buffer_load_dwordx4 v2, s[8:11], s50 offen offset:1024 lds
    v_mfma_f32_16x16x32_bf16 v[204:207], a[156:159], v[92:95], v[204:207]
    v_cvt_pk_bf16_f32 v49, v62, v63
    s_waitcnt lgkmcnt(8)
    v_mfma_f32_16x16x32_bf16 v[192:195], a[160:163], v[96:99], v[192:195]
    v_cvt_pk_bf16_f32 v50, v242, v243
    v_cvt_pk_bf16_f32 v51, v244, v245
    v_mfma_f32_16x16x32_bf16 v[196:199], a[164:167], v[96:99], v[196:199]
    v_cvt_pk_bf16_f32 v40, v246, v247
    buffer_load_dword v29, v255, s[8:11], s5 offen
    v_mfma_f32_16x16x32_bf16 v[200:203], a[160:163], v[100:103], v[200:203]
    ds_read_b128 v[80:83], v10 offset:1536
    ds_read_b128 v[84:87], v10 offset:34304
    v_mfma_f32_16x16x32_bf16 v[52:55], v[44:47], v[48:51], 0
    ds_read_b128 v[88:91], v11 offset:1536
    ds_read_b128 v[92:95], v11 offset:34304
    v_mfma_f32_16x16x32_bf16 v[52:55], v[44:47], v[40:43], v[52:55]
    ds_read_b128 v[96:99], v8 offset:1792
    v_mfma_f32_16x16x32_bf16 v[208:211], v[160:163], v[48:51], 0
    v_mfma_f32_16x16x32_bf16 v[208:211], v[232:235], v[40:43], v[208:211]
    v_mfma_f32_16x16x32_bf16 v[212:215], v[164:167], v[48:51], 0
    v_mfma_f32_16x16x32_bf16 v[212:215], v[234:237], v[40:43], v[212:215]
    v_mfma_f32_16x16x32_bf16 v[216:219], v[168:171], v[48:51], 0
    v_mfma_f32_16x16x32_bf16 v[216:219], v[236:239], v[40:43], v[216:219]
    v_mfma_f32_16x16x32_bf16 v[220:223], v[172:175], v[48:51], 0
    v_mfma_f32_16x16x32_bf16 v[220:223], v[238:241], v[40:43], v[220:223]
    v_rcp_f32 v248, v52
    v_mfma_f32_16x16x32_bf16 v[204:207], a[164:167], v[100:103], v[204:207]
    ds_read_b128 v[100:103], v8 offset:34560
    v_mul_f32 v208, v248, v208
    v_mfma_f32_16x16x32_bf16 v[192:195], a[168:171], v[104:107], v[192:195]
    v_mul_f32 v209, v248, v209
    v_mul_f32 v210, v248, v210
    v_mfma_f32_16x16x32_bf16 v[196:199], a[172:175], v[104:107], v[196:199]
    ds_read_b128 v[104:107], v9 offset:1792
    v_mul_f32 v211, v248, v211
    v_mfma_f32_16x16x32_bf16 v[200:203], a[168:171], v[108:111], v[200:203]
    v_cvt_pk_bf16_f32 v224, v208, v209
    v_cvt_pk_bf16_f32 v225, v210, v211
    v_mfma_f32_16x16x32_bf16 v[204:207], a[172:175], v[108:111], v[204:207]
    ds_read_b128 v[108:111], v9 offset:34560
    s_waitcnt lgkmcnt(12)
    v_mfma_f32_16x16x32_bf16 v[192:195], a[176:179], v[112:115], v[192:195]
    v_mul_f32 v212, v248, v212
    v_mul_f32 v213, v248, v213
    v_mfma_f32_16x16x32_bf16 v[196:199], a[180:183], v[112:115], v[196:199]
    ds_read_b128 v[112:115], v10 offset:1792
    v_mul_f32 v214, v248, v214
    v_mfma_f32_16x16x32_bf16 v[200:203], a[176:179], v[116:119], v[200:203]
    v_mul_f32 v215, v248, v215
    v_cvt_pk_bf16_f32 v226, v212, v213
    v_mfma_f32_16x16x32_bf16 v[204:207], a[180:183], v[116:119], v[204:207]
    ds_read_b128 v[116:119], v10 offset:34560
    v_cvt_pk_bf16_f32 v227, v214, v215
    v_mfma_f32_16x16x32_bf16 v[192:195], a[184:187], v[120:123], v[192:195]
    v_mfma_f32_16x16x32_bf16 v[196:199], a[188:191], v[120:123], v[196:199]
    ds_read_b128 v[120:123], v11 offset:1792
    v_mfma_f32_16x16x32_bf16 v[200:203], a[184:187], v[124:127], v[200:203]
    v_mfma_f32_16x16x32_bf16 v[204:207], a[188:191], v[124:127], v[204:207]
    ds_read_b128 v[124:127], v11 offset:34560
    s_waitcnt lgkmcnt(12)
    v_mfma_f32_16x16x32_bf16 v[192:195], a[192:195], v[64:67], v[192:195]
    v_mfma_f32_16x16x32_bf16 v[196:199], a[196:199], v[64:67], v[196:199]
    v_mfma_f32_16x16x32_bf16 v[200:203], a[192:195], v[68:71], v[200:203]
    s_cmp_eq_u32 s31, 0
    s_cbranch_scc1 .cp_444
.cb_445:
    v_mfma_f32_16x16x32_bf16 v[204:207], a[196:199], v[68:71], v[204:207]
    s_cbranch_vccnz .cp_432
    buffer_store_dwordx4 v[224:227], v2, s[8:11], s53 offen offset:0
.cb_433:
    v_mfma_f32_16x16x32_bf16 v[192:195], a[200:203], v[72:75], v[192:195]
    s_waitcnt vmcnt(8) lgkmcnt(0)
    s_barrier
    v_mfma_f32_16x16x32_bf16 v[196:199], a[204:207], v[72:75], v[196:199]
    s_add_u32 m0, s6, 0
    ds_read_b128 v[64:67], v12 offset:0
    v_mfma_f32_16x16x32_bf16 v[200:203], a[200:203], v[76:79], v[200:203]
    buffer_load_dwordx4 v16, s[12:15], s29 offen offset:0 lds
    v_mfma_f32_16x16x32_bf16 v[204:207], a[204:207], v[76:79], v[204:207]
    ds_read_b128 v[68:71], v12 offset:32768
    ds_read_b128 v[72:75], v13 offset:0
    v_mfma_f32_16x16x32_bf16 v[192:195], a[208:211], v[80:83], v[192:195]
    ds_read_b128 v[76:79], v13 offset:32768
    v_mul_f32 v216, v248, v216
    v_mfma_f32_16x16x32_bf16 v[196:199], a[212:215], v[80:83], v[196:199]
    v_mul_f32 v217, v248, v217
    v_mul_f32 v218, v248, v218
    v_mfma_f32_16x16x32_bf16 v[200:203], a[208:211], v[84:87], v[200:203]
    buffer_load_dwordx4 v16, s[12:15], s29 offen offset:1024 lds
    v_mfma_f32_16x16x32_bf16 v[204:207], a[212:215], v[84:87], v[204:207]
    v_mul_f32 v219, v248, v219
    v_cvt_pk_bf16_f32 v228, v216, v217
    v_mfma_f32_16x16x32_bf16 v[192:195], a[216:219], v[88:91], v[192:195]
    v_cvt_pk_bf16_f32 v229, v218, v219
    v_mul_f32 v220, v248, v220
    v_mfma_f32_16x16x32_bf16 v[196:199], a[220:223], v[88:91], v[196:199]
    v_mul_f32 v221, v248, v221
    v_mul_f32 v222, v248, v222
    v_mfma_f32_16x16x32_bf16 v[200:203], a[216:219], v[92:95], v[200:203]
    buffer_load_dwordx4 v17, s[12:15], s29 offen offset:2048 lds
    v_mfma_f32_16x16x32_bf16 v[204:207], a[220:223], v[92:95], v[204:207]
    v_mul_f32 v223, v248, v223
    v_cvt_pk_bf16_f32 v230, v220, v221
    v_mfma_f32_16x16x32_bf16 v[192:195], a[224:227], v[96:99], v[192:195]
    v_cvt_pk_bf16_f32 v231, v222, v223
    ds_read_b128 v[80:83], v14 offset:0
    v_mfma_f32_16x16x32_bf16 v[196:199], a[228:231], v[96:99], v[196:199]
    s_cbranch_vccnz .cp_434
    buffer_store_dwordx4 v[228:231], v2, s[8:11], s53 offen offset:1024
.cb_435:
    v_mfma_f32_16x16x32_bf16 v[200:203], a[224:227], v[100:103], v[200:203]
    buffer_load_dwordx4 v17, s[12:15], s29 offen offset:3072 lds
    v_mfma_f32_16x16x32_bf16 v[204:207], a[228:231], v[100:103], v[204:207]
    ds_read_b128 v[84:87], v14 offset:32768
    ds_read_b128 v[88:91], v15 offset:0
    v_mfma_f32_16x16x32_bf16 v[192:195], a[232:235], v[104:107], v[192:195]
    ds_read_b128 v[92:95], v15 offset:32768
    ds_read_b128 v[96:99], v12 offset:256
    v_mfma_f32_16x16x32_bf16 v[196:199], a[236:239], v[104:107], v[196:199]
    ds_read_b128 v[100:103], v12 offset:33024
    ds_read_b128 v[104:107], v13 offset:256
    v_mfma_f32_16x16x32_bf16 v[200:203], a[232:235], v[108:111], v[200:203]
    s_add_u32 m0, s6, 4096
    s_mov_b32 s53, s40
    v_mfma_f32_16x16x32_bf16 v[204:207], a[236:239], v[108:111], v[204:207]
    buffer_load_dwordx4 v18, s[12:15], s29 offen offset:0 lds
    v_mfma_f32_16x16x32_bf16 v[192:195], a[240:243], v[112:115], v[192:195]
    ds_read_b128 v[108:111], v13 offset:33024
    s_add_u32 s40, s40, 0x40000
    v_mfma_f32_16x16x32_bf16 v[196:199], a[244:247], v[112:115], v[196:199]
    s_mov_b32 s30, s42
    s_add_u32 s42, s42, 1
    v_mfma_f32_16x16x32_bf16 v[200:203], a[240:243], v[116:119], v[200:203]
    v_mfma_f32_16x16x32_bf16 v[204:207], a[244:247], v[116:119], v[204:207]
    buffer_load_dwordx4 v18, s[12:15], s29 offen offset:1024 lds
    v_mfma_f32_16x16x32_bf16 v[192:195], a[248:251], v[120:123], v[192:195]
    v_mfma_f32_16x16x32_bf16 v[196:199], a[252:255], v[120:123], v[196:199]
    v_mfma_f32_16x16x32_bf16 v[200:203], a[248:251], v[124:127], v[200:203]
    v_mfma_f32_16x16x32_bf16 v[204:207], a[252:255], v[124:127], v[204:207]
    s_waitcnt lgkmcnt(8)
    v_mfma_f32_16x16x32_bf16 v[208:211], a[0:3], v[64:67], 0
    buffer_load_dwordx4 v19, s[12:15], s29 offen offset:2048 lds
    v_mfma_f32_16x16x32_bf16 v[212:215], a[4:7], v[64:67], 0
    ds_read_b128 v[112:115], v14 offset:256
    ds_read_b128 v[116:119], v14 offset:33024
    v_mfma_f32_16x16x32_bf16 v[216:219], a[0:3], v[68:71], 0
    ds_read_b128 v[120:123], v15 offset:256
    ds_read_b128 v[124:127], v15 offset:33024
    v_mfma_f32_16x16x32_bf16 v[220:223], a[4:7], v[68:71], 0
    ds_read_b128 v[64:67], v12 offset:512
    ds_read_b128 v[68:71], v12 offset:33280
    v_mfma_f32_16x16x32_bf16 v[208:211], a[8:11], v[72:75], v[208:211]
    buffer_load_dwordx4 v19, s[12:15], s29 offen offset:3072 lds
    v_mfma_f32_16x16x32_bf16 v[212:215], a[12:15], v[72:75], v[212:215]
    v_cvt_pk_bf16_f32 v224, v192, v193
    v_cvt_pk_bf16_f32 v225, v194, v195
    v_mfma_f32_16x16x32_bf16 v[216:219], a[8:11], v[76:79], v[216:219]
    v_cvt_pk_bf16_f32 v226, v196, v197
    v_cvt_pk_bf16_f32 v227, v198, v199
    v_mfma_f32_16x16x32_bf16 v[220:223], a[12:15], v[76:79], v[220:223]
    ds_write_b128 v24, v[224:227] offset:0
    s_waitcnt lgkmcnt(11)
    v_mfma_f32_16x16x32_bf16 v[208:211], a[16:19], v[80:83], v[208:211]
    s_add_u32 m0, s6, 8192
    v_cvt_pk_bf16_f32 v228, v200, v201
    v_mfma_f32_16x16x32_bf16 v[212:215], a[20:23], v[80:83], v[212:215]
    buffer_load_dwordx4 v20, s[12:15], s29 offen offset:0 lds
    v_mfma_f32_16x16x32_bf16 v[216:219], a[16:19], v[84:87], v[216:219]
    v_cvt_pk_bf16_f32 v229, v202, v203
    v_cvt_pk_bf16_f32 v230, v204, v205
    v_mfma_f32_16x16x32_bf16 v[220:223], a[20:23], v[84:87], v[220:223]
    v_cvt_pk_bf16_f32 v231, v206, v207
    ds_write_b128 v24, v[228:231] offset:4096
    v_mfma_f32_16x16x32_bf16 v[208:211], a[24:27], v[88:91], v[208:211]
    ds_read_b128 v[72:75], v13 offset:512
    ds_read_b128 v[76:79], v13 offset:33280
    v_mfma_f32_16x16x32_bf16 v[212:215], a[28:31], v[88:91], v[212:215]
    buffer_load_dwordx4 v20, s[12:15], s29 offen offset:1024 lds
    v_mfma_f32_16x16x32_bf16 v[216:219], a[24:27], v[92:95], v[216:219]
    ds_read_b128 v[80:83], v14 offset:512
    ds_read_b128 v[84:87], v14 offset:33280
    v_mfma_f32_16x16x32_bf16 v[220:223], a[28:31], v[92:95], v[220:223]
    ds_read_b128 v[88:91], v15 offset:512
    s_waitcnt lgkmcnt(13)
    v_mfma_f32_16x16x32_bf16 v[208:211], a[32:35], v[96:99], v[208:211]
    s_waitcnt vmcnt(13) lgkmcnt(5)
    s_barrier
    v_mfma_f32_16x16x32_bf16 v[212:215], a[36:39], v[96:99], v[212:215]
    buffer_load_dwordx4 v21, s[12:15], s29 offen offset:2048 lds
    v_mfma_f32_16x16x32_bf16 v[216:219], a[32:35], v[100:103], v[216:219]
    ds_read_b128 v[192:195], v25 offset:0
    ds_read_b128 v[128:131], v31 offset:0
    v_mfma_f32_16x16x32_bf16 v[220:223], a[36:39], v[100:103], v[220:223]
    ds_read_b128 v[144:147], v31 offset:4096
    ds_read_b128 v[196:199], v25 offset:1024
    v_mfma_f32_16x16x32_bf16 v[208:211], a[40:43], v[104:107], v[208:211]
    ds_read_b128 v[132:135], v31 offset:1024
    ds_read_b128 v[148:151], v31 offset:5120
    v_mfma_f32_16x16x32_bf16 v[212:215], a[44:47], v[104:107], v[212:215]
    buffer_load_dwordx4 v21, s[12:15], s29 offen offset:3072 lds
    v_mfma_f32_16x16x32_bf16 v[216:219], a[40:43], v[108:111], v[216:219]
    ds_read_b128 v[92:95], v15 offset:33280
    ds_read_b128 v[200:203], v25 offset:2048
    v_mfma_f32_16x16x32_bf16 v[220:223], a[44:47], v[108:111], v[220:223]
    ds_read_b128 v[136:139], v31 offset:2048
    ds_read_b128 v[152:155], v31 offset:6144
    v_mfma_f32_16x16x32_bf16 v[208:211], a[48:51], v[112:115], v[208:211]
    ds_read_b128 v[204:207], v25 offset:3072
    ds_read_b128 v[140:143], v31 offset:3072
    v_mfma_f32_16x16x32_bf16 v[212:215], a[52:55], v[112:115], v[212:215]
    s_add_u32 m0, s6, 12288
    s_waitcnt lgkmcnt(9)
    v_mfma_f32_16x16x32_bf16 v[48:51], v[128:131], v[192:195], v[32:35]
    buffer_load_dwordx4 v22, s[12:15], s29 offen offset:0 lds
    v_mfma_f32_16x16x32_bf16 v[52:55], v[144:147], v[192:195], v[36:39]
    ds_read_b128 v[156:159], v31 offset:7168
    s_waitcnt lgkmcnt(7)
    v_mfma_f32_16x16x32_bf16 v[48:51], v[132:135], v[196:199], v[48:51]
    ds_read_b128 v[160:163], v5 offset:8192
    ds_read_b128 v[164:167], v5 offset:9216
    v_mfma_f32_16x16x32_bf16 v[52:55], v[148:151], v[196:199], v[52:55]
    ds_read_b128 v[96:99], v12 offset:768
    s_waitcnt lgkmcnt(6)
    v_mfma_f32_16x16x32_bf16 v[48:51], v[136:139], v[200:203], v[48:51]
    buffer_load_dwordx4 v22, s[12:15], s29 offen offset:1024 lds
    v_mfma_f32_16x16x32_bf16 v[52:55], v[152:155], v[200:203], v[52:55]
    ds_read_b128 v[100:103], v12 offset:33536
    ds_read_b128 v[104:107], v13 offset:768
    v_mfma_f32_16x16x32_bf16 v[216:219], a[48:51], v[116:119], v[216:219]
    ds_read_b128 v[108:111], v13 offset:33536
    ds_read_b128 v[168:171], v5 offset:10240
    v_mfma_f32_16x16x32_bf16 v[220:223], a[52:55], v[116:119], v[220:223]
    ds_read_b128 v[172:175], v5 offset:11264
    s_waitcnt lgkmcnt(8)
    v_mfma_f32_16x16x32_bf16 v[48:51], v[140:143], v[204:207], v[48:51]
    buffer_load_dwordx4 v23, s[12:15], s29 offen offset:2048 lds
    v_mfma_f32_16x16x32_bf16 v[52:55], v[156:159], v[204:207], v[52:55]
    v_max_i32 v27, s30, v26
    ds_read_b128 v[112:115], v14 offset:768
    v_mfma_f32_16x16x32_bf16 v[208:211], a[56:59], v[120:123], v[208:211]
    s_waitcnt vmcnt(12)
    s_cbranch_vccnz .cp_450
    buffer_store_dword v27, v26, s[8:11], s94 offen
.cb_451:
    v_mfma_f32_16x16x32_bf16 v[212:215], a[60:63], v[120:123], v[212:215]
    ds_read_b128 v[116:119], v14 offset:33536
    ds_read_b128 v[120:123], v15 offset:768
    v_mfma_f32_16x16x32_bf16 v[216:219], a[56:59], v[124:127], v[216:219]
    buffer_load_dwordx4 v23, s[12:15], s29 offen offset:3072 lds
    v_mfma_f32_16x16x32_bf16 v[220:223], a[60:63], v[124:127], v[220:223]
    s_cmp_eq_u32 s31, 0
    s_cbranch_scc1 .cp_454
.cb_455:
    v_mfma_f32_16x16x32_bf16 v[208:211], a[64:67], v[64:67], v[208:211]
    s_waitcnt lgkmcnt(3)
    s_barrier
    v_mfma_f32_16x16x32_bf16 v[212:215], a[68:71], v[64:67], v[212:215]
    ds_read_b128 v[124:127], v15 offset:33536
    ds_read_b128 v[176:179], v3 offset:4096
    v_mfma_f32_16x16x32_bf16 v[216:219], a[64:67], v[68:71], v[216:219]
    ds_read_b128 v[180:183], v3 offset:4608
    ds_read_b128 v[184:187], v3 offset:5120
    v_mfma_f32_16x16x32_bf16 v[220:223], a[68:71], v[68:71], v[220:223]
    ds_read_b128 v[188:191], v3 offset:5632
    ds_read_b128 v[64:67], v12 offset:1024
    v_mfma_f32_16x16x32_bf16 v[208:211], a[72:75], v[72:75], v[208:211]
    ds_read_b128 v[68:71], v12 offset:33792
    v_max3_f32 v248, v48, v49, v50
    v_mfma_f32_16x16x32_bf16 v[212:215], a[76:79], v[72:75], v[212:215]
    ds_read_b128 v[72:75], v13 offset:1024
    v_max3_f32 v248, v248, v51, v52
    v_mfma_f32_16x16x32_bf16 v[216:219], a[72:75], v[76:79], v[216:219]
    v_max3_f32 v249, v53, v54, v55
    s_add_u32 m0, s52, 0
    v_mfma_f32_16x16x32_bf16 v[220:223], a[76:79], v[76:79], v[220:223]
    ds_read_b128 v[76:79], v13 offset:33792
    s_add_u32 s48, s48, 0x20000
    v_mfma_f32_16x16x32_bf16 v[208:211], a[80:83], v[80:83], v[208:211]
    s_mov_b32 s31, 1
    buffer_load_dword v29, v28, s[12:15], s29 offen
    v_mfma_f32_16x16x32_bf16 v[212:215], a[84:87], v[80:83], v[212:215]
    s_cmp_gt_u32 s33, s42
    s_cbranch_scc0 .pp_456
    buffer_load_dwordx4 v2, s[8:11], s48 offen lds
.pb_457:
    s_waitcnt lgkmcnt(4)
    v_mfma_f32_16x16x32_bf16 v[56:59], v[176:179], v[192:195], 0
    ds_read_b128 v[80:83], v14 offset:1024
    s_add_u32 s29, s29, 0x10000
    v_mfma_f32_16x16x32_bf16 v[56:59], v[180:183], v[196:199], v[56:59]
    s_cmp_gt_u32 s32, s42
    s_cbranch_scc0 .cp_452
.cb_453:
    v_mfma_f32_16x16x32_bf16 v[56:59], v[184:187], v[200:203], v[56:59]
    ds_read_b32 v232, v6 offset:4096
    ds_read_b32 v234, v6 offset:4160
    v_mfma_f32_16x16x32_bf16 v[56:59], v[188:191], v[204:207], v[56:59]
    ds_read_b32 v236, v6 offset:4608
    ds_read_b32 v238, v6 offset:4672
    v_mfma_f32_16x16x32_bf16 v[216:219], a[80:83], v[84:87], v[216:219]
    s_mov_b32 m0, s43
    s_add_u32 s49, s49, 0x40000
    v_mfma_f32_16x16x32_bf16 v[220:223], a[84:87], v[84:87], v[220:223]
    ds_read_b128 v[84:87], v14 offset:33792
    v_mfma_f32_16x16x32_bf16 v[208:211], a[88:91], v[88:91], v[208:211]
    buffer_load_dwordx4 v2, s[8:11], s49 offen lds
    v_mfma_f32_16x16x32_bf16 v[212:215], a[92:95], v[88:91], v[212:215]
    ds_read_b128 v[88:91], v15 offset:1024
    v_max3_f32 v248, v248, v56, v57
    v_mfma_f32_16x16x32_bf16 v[216:219], a[88:91], v[92:95], v[216:219]
    v_max_f32 v30, v248, v249
    v_max_f32 v249, v248, v249
    v_mfma_f32_16x16x32_bf16 v[220:223], a[92:95], v[92:95], v[220:223]
    ds_read_b128 v[92:95], v15 offset:33792
    s_add_u32 s50, s49, 16777216
    v_mfma_f32_16x16x32_bf16 v[208:211], a[96:99], v[96:99], v[208:211]
    v_permlane16_swap_b32 v249, v30
    v_max_f32 v248, v249, v30
    v_mfma_f32_16x16x32_bf16 v[212:215], a[100:103], v[96:99], v[212:215]
    v_max_f32 v249, v249, v30
    ds_read_b128 v[96:99], v12 offset:1280
    v_mfma_f32_16x16x32_bf16 v[216:219], a[96:99], v[100:103], v[216:219]
    buffer_load_dwordx4 v2, s[8:11], s49 offen offset:1024 lds
    v_mfma_f32_16x16x32_bf16 v[220:223], a[100:103], v[100:103], v[220:223]
    v_permlane32_swap_b32 v248, v249
    v_max_f32 v248, v248, v249
    v_mfma_f32_16x16x32_bf16 v[208:211], a[104:107], v[104:107], v[208:211]
    v_mul_f32 v248, s45, v248
    ds_read_b128 v[100:103], v12 offset:34048
    v_mfma_f32_16x16x32_bf16 v[212:215], a[108:111], v[104:107], v[212:215]
    ds_read_b128 v[104:107], v13 offset:1280
    v_fma_f32 v60, v48, s45, -v248
    v_mfma_f32_16x16x32_bf16 v[216:219], a[104:107], v[108:111], v[216:219]
    v_fma_f32 v61, v49, s45, -v248
    v_fma_f32 v62, v50, s45, -v248
    v_mfma_f32_16x16x32_bf16 v[220:223], a[108:111], v[108:111], v[220:223]
    ds_read_b128 v[108:111], v13 offset:34048
    v_fma_f32 v63, v51, s45, -v248
    v_mfma_f32_16x16x32_bf16 v[208:211], a[112:115], v[112:115], v[208:211]
    v_fma_f32 v242, v52, s45, -v248
    v_fma_f32 v243, v53, s45, -v248
    v_mfma_f32_16x16x32_bf16 v[212:215], a[116:119], v[112:115], v[212:215]
    v_fma_f32 v244, v54, s45, -v248
    v_fma_f32 v245, v55, s45, -v248
    v_mfma_f32_16x16x32_bf16 v[216:219], a[112:115], v[116:119], v[216:219]
    v_fma_f32 v246, v56, s45, -v248
    v_fma_f32 v247, v57, s45, -v248
    v_mfma_f32_16x16x32_bf16 v[220:223], a[116:119], v[116:119], v[220:223]
    ds_read_b128 v[112:115], v14 offset:1280
    ds_read_b128 v[116:119], v14 offset:34048
    v_mfma_f32_16x16x32_bf16 v[208:211], a[120:123], v[120:123], v[208:211]
    s_add_u32 m0, s43, 8192
    s_add_u32 s5, s49, 0x40000
    v_mfma_f32_16x16x32_bf16 v[212:215], a[124:127], v[120:123], v[212:215]
    ds_read_b128 v[120:123], v15 offset:1280
    v_mfma_f32_16x16x32_bf16 v[216:219], a[120:123], v[124:127], v[216:219]
    buffer_load_dwordx4 v2, s[8:11], s50 offen lds
    v_mfma_f32_16x16x32_bf16 v[220:223], a[124:127], v[124:127], v[220:223]
    ds_read_b128 v[124:127], v15 offset:34048
    s_waitcnt lgkmcnt(15)
    v_mfma_f32_16x16x32_bf16 v[208:211], a[128:131], v[64:67], v[208:211]
    s_min_u32 s5, s5, s55
    v_mfma_f32_16x16x32_bf16 v[212:215], a[132:135], v[64:67], v[212:215]
    v_exp_f32 v60, v60
    v_mfma_f32_16x16x32_bf16 v[216:219], a[128:131], v[68:71], v[216:219]
    v_exp_f32 v61, v61
    v_mfma_f32_16x16x32_bf16 v[220:223], a[132:135], v[68:71], v[220:223]
    v_exp_f32 v62, v62
    v_mfma_f32_16x16x32_bf16 v[208:211], a[136:139], v[72:75], v[208:211]
    v_exp_f32 v63, v63
    v_mfma_f32_16x16x32_bf16 v[212:215], a[140:143], v[72:75], v[212:215]
    v_exp_f32 v242, v242
    v_mfma_f32_16x16x32_bf16 v[216:219], a[136:139], v[76:79], v[216:219]
    v_exp_f32 v243, v243
    v_mfma_f32_16x16x32_bf16 v[220:223], a[140:143], v[76:79], v[220:223]
    ds_read_b128 v[64:67], v12 offset:1536
    s_waitcnt lgkmcnt(9)
    v_mfma_f32_16x16x32_bf16 v[208:211], a[144:147], v[80:83], v[208:211]
    v_exp_f32 v244, v244
    v_mfma_f32_16x16x32_bf16 v[212:215], a[148:151], v[80:83], v[212:215]
    v_exp_f32 v245, v245
    v_mfma_f32_16x16x32_bf16 v[216:219], a[144:147], v[84:87], v[216:219]
    v_exp_f32 v246, v246
    v_mfma_f32_16x16x32_bf16 v[220:223], a[148:151], v[84:87], v[220:223]
    v_exp_f32 v247, v247
    v_mfma_f32_16x16x32_bf16 v[208:211], a[152:155], v[88:91], v[208:211]
    ds_read_b128 v[68:71], v12 offset:34304
    ds_read_b128 v[72:75], v13 offset:1536
    v_mfma_f32_16x16x32_bf16 v[212:215], a[156:159], v[88:91], v[212:215]
    ds_read_b128 v[76:79], v13 offset:34304
    v_cvt_pk_bf16_f32 v48, v60, v61
    v_mfma_f32_16x16x32_bf16 v[216:219], a[152:155], v[92:95], v[216:219]
    buffer_load_dwordx4 v2, s[8:11], s50 offen offset:1024 lds
    v_mfma_f32_16x16x32_bf16 v[220:223], a[156:159], v[92:95], v[220:223]
    v_cvt_pk_bf16_f32 v49, v62, v63
    s_waitcnt lgkmcnt(8)
    v_mfma_f32_16x16x32_bf16 v[208:211], a[160:163], v[96:99], v[208:211]
    v_cvt_pk_bf16_f32 v50, v242, v243
    v_cvt_pk_bf16_f32 v51, v244, v245
    v_mfma_f32_16x16x32_bf16 v[212:215], a[164:167], v[96:99], v[212:215]
    v_cvt_pk_bf16_f32 v40, v246, v247
    buffer_load_dword v29, v255, s[8:11], s5 offen
    v_mfma_f32_16x16x32_bf16 v[216:219], a[160:163], v[100:103], v[216:219]
    ds_read_b128 v[80:83], v14 offset:1536
    ds_read_b128 v[84:87], v14 offset:34304
    v_mfma_f32_16x16x32_bf16 v[52:55], v[44:47], v[48:51], 0
    ds_read_b128 v[88:91], v15 offset:1536
    ds_read_b128 v[92:95], v15 offset:34304
    v_mfma_f32_16x16x32_bf16 v[52:55], v[44:47], v[40:43], v[52:55]
    ds_read_b128 v[96:99], v12 offset:1792
    v_mfma_f32_16x16x32_bf16 v[192:195], v[160:163], v[48:51], 0
    v_mfma_f32_16x16x32_bf16 v[192:195], v[232:235], v[40:43], v[192:195]
    v_mfma_f32_16x16x32_bf16 v[196:199], v[164:167], v[48:51], 0
    v_mfma_f32_16x16x32_bf16 v[196:199], v[234:237], v[40:43], v[196:199]
    v_mfma_f32_16x16x32_bf16 v[200:203], v[168:171], v[48:51], 0
    v_mfma_f32_16x16x32_bf16 v[200:203], v[236:239], v[40:43], v[200:203]
    v_mfma_f32_16x16x32_bf16 v[204:207], v[172:175], v[48:51], 0
    v_mfma_f32_16x16x32_bf16 v[204:207], v[238:241], v[40:43], v[204:207]
    v_rcp_f32 v248, v52
    v_mfma_f32_16x16x32_bf16 v[220:223], a[164:167], v[100:103], v[220:223]
    ds_read_b128 v[100:103], v12 offset:34560
    v_mul_f32 v192, v248, v192
    v_mfma_f32_16x16x32_bf16 v[208:211], a[168:171], v[104:107], v[208:211]
    v_mul_f32 v193, v248, v193
    v_mul_f32 v194, v248, v194
    v_mfma_f32_16x16x32_bf16 v[212:215], a[172:175], v[104:107], v[212:215]
    ds_read_b128 v[104:107], v13 offset:1792
    v_mul_f32 v195, v248, v195
    v_mfma_f32_16x16x32_bf16 v[216:219], a[168:171], v[108:111], v[216:219]
    v_cvt_pk_bf16_f32 v224, v192, v193
    v_cvt_pk_bf16_f32 v225, v194, v195
    v_mfma_f32_16x16x32_bf16 v[220:223], a[172:175], v[108:111], v[220:223]
    ds_read_b128 v[108:111], v13 offset:34560
    s_waitcnt lgkmcnt(12)
    v_mfma_f32_16x16x32_bf16 v[208:211], a[176:179], v[112:115], v[208:211]
    v_mul_f32 v196, v248, v196
    v_mul_f32 v197, v248, v197
    v_mfma_f32_16x16x32_bf16 v[212:215], a[180:183], v[112:115], v[212:215]
    ds_read_b128 v[112:115], v14 offset:1792
    v_mul_f32 v198, v248, v198
    v_mfma_f32_16x16x32_bf16 v[216:219], a[176:179], v[116:119], v[216:219]
    v_mul_f32 v199, v248, v199
    v_cvt_pk_bf16_f32 v226, v196, v197
    v_mfma_f32_16x16x32_bf16 v[220:223], a[180:183], v[116:119], v[220:223]
    ds_read_b128 v[116:119], v14 offset:34560
    v_cvt_pk_bf16_f32 v227, v198, v199
    v_mfma_f32_16x16x32_bf16 v[208:211], a[184:187], v[120:123], v[208:211]
    v_mfma_f32_16x16x32_bf16 v[212:215], a[188:191], v[120:123], v[212:215]
    ds_read_b128 v[120:123], v15 offset:1792
    v_mfma_f32_16x16x32_bf16 v[216:219], a[184:187], v[124:127], v[216:219]
    v_mfma_f32_16x16x32_bf16 v[220:223], a[188:191], v[124:127], v[220:223]
    ds_read_b128 v[124:127], v15 offset:34560
    s_waitcnt lgkmcnt(12)
    v_mfma_f32_16x16x32_bf16 v[208:211], a[192:195], v[64:67], v[208:211]
    v_mfma_f32_16x16x32_bf16 v[212:215], a[196:199], v[64:67], v[212:215]
    v_mfma_f32_16x16x32_bf16 v[216:219], a[192:195], v[68:71], v[216:219]
    s_cmp_eq_u32 s31, 0
    s_cbranch_scc1 .cp_458
.cb_459:
    v_mfma_f32_16x16x32_bf16 v[220:223], a[196:199], v[68:71], v[220:223]
    s_cbranch_vccnz .cp_446
    buffer_store_dwordx4 v[224:227], v2, s[8:11], s53 offen offset:0
.cb_447:
    v_mfma_f32_16x16x32_bf16 v[208:211], a[200:203], v[72:75], v[208:211]
    s_waitcnt vmcnt(8) lgkmcnt(0)
    s_barrier
    v_mfma_f32_16x16x32_bf16 v[212:215], a[204:207], v[72:75], v[212:215]
    s_add_u32 m0, s6, 65536
    ds_read_b128 v[64:67], v8 offset:0
    v_mfma_f32_16x16x32_bf16 v[216:219], a[200:203], v[76:79], v[216:219]
    buffer_load_dwordx4 v16, s[12:15], s29 offen offset:0 lds
    v_mfma_f32_16x16x32_bf16 v[220:223], a[204:207], v[76:79], v[220:223]
    ds_read_b128 v[68:71], v8 offset:32768
    ds_read_b128 v[72:75], v9 offset:0
    v_mfma_f32_16x16x32_bf16 v[208:211], a[208:211], v[80:83], v[208:211]
    ds_read_b128 v[76:79], v9 offset:32768
    v_mul_f32 v200, v248, v200
    v_mfma_f32_16x16x32_bf16 v[212:215], a[212:215], v[80:83], v[212:215]
    v_mul_f32 v201, v248, v201
    v_mul_f32 v202, v248, v202
    v_mfma_f32_16x16x32_bf16 v[216:219], a[208:211], v[84:87], v[216:219]
    buffer_load_dwordx4 v16, s[12:15], s29 offen offset:1024 lds
    v_mfma_f32_16x16x32_bf16 v[220:223], a[212:215], v[84:87], v[220:223]
    v_mul_f32 v203, v248, v203
    v_cvt_pk_bf16_f32 v228, v200, v201
    v_mfma_f32_16x16x32_bf16 v[208:211], a[216:219], v[88:91], v[208:211]
    v_cvt_pk_bf16_f32 v229, v202, v203
    v_mul_f32 v204, v248, v204
    v_mfma_f32_16x16x32_bf16 v[212:215], a[220:223], v[88:91], v[212:215]
    v_mul_f32 v205, v248, v205
    v_mul_f32 v206, v248, v206
    v_mfma_f32_16x16x32_bf16 v[216:219], a[216:219], v[92:95], v[216:219]
    buffer_load_dwordx4 v17, s[12:15], s29 offen offset:2048 lds
    v_mfma_f32_16x16x32_bf16 v[220:223], a[220:223], v[92:95], v[220:223]
    v_mul_f32 v207, v248, v207
    v_cvt_pk_bf16_f32 v230, v204, v205
    v_mfma_f32_16x16x32_bf16 v[208:211], a[224:227], v[96:99], v[208:211]
    v_cvt_pk_bf16_f32 v231, v206, v207
    ds_read_b128 v[80:83], v10 offset:0
    v_mfma_f32_16x16x32_bf16 v[212:215], a[228:231], v[96:99], v[212:215]
    s_cbranch_vccnz .cp_448
    buffer_store_dwordx4 v[228:231], v2, s[8:11], s53 offen offset:1024
.cb_449:
    v_mfma_f32_16x16x32_bf16 v[216:219], a[224:227], v[100:103], v[216:219]
    buffer_load_dwordx4 v17, s[12:15], s29 offen offset:3072 lds
    v_mfma_f32_16x16x32_bf16 v[220:223], a[228:231], v[100:103], v[220:223]
    ds_read_b128 v[84:87], v10 offset:32768
    ds_read_b128 v[88:91], v11 offset:0
    v_mfma_f32_16x16x32_bf16 v[208:211], a[232:235], v[104:107], v[208:211]
    ds_read_b128 v[92:95], v11 offset:32768
    ds_read_b128 v[96:99], v8 offset:256
    v_mfma_f32_16x16x32_bf16 v[212:215], a[236:239], v[104:107], v[212:215]
    ds_read_b128 v[100:103], v8 offset:33024
    ds_read_b128 v[104:107], v9 offset:256
    v_mfma_f32_16x16x32_bf16 v[216:219], a[232:235], v[108:111], v[216:219]
    s_add_u32 m0, s6, 69632
    s_mov_b32 s53, s40
    v_mfma_f32_16x16x32_bf16 v[220:223], a[236:239], v[108:111], v[220:223]
    buffer_load_dwordx4 v18, s[12:15], s29 offen offset:0 lds
    v_mfma_f32_16x16x32_bf16 v[208:211], a[240:243], v[112:115], v[208:211]
    ds_read_b128 v[108:111], v9 offset:33024
    s_add_u32 s40, s40, 0x40000
    v_mfma_f32_16x16x32_bf16 v[212:215], a[244:247], v[112:115], v[212:215]
    s_mov_b32 s30, s42
    s_add_u32 s42, s42, 1
    v_mfma_f32_16x16x32_bf16 v[216:219], a[240:243], v[116:119], v[216:219]
    v_mfma_f32_16x16x32_bf16 v[220:223], a[244:247], v[116:119], v[220:223]
    buffer_load_dwordx4 v18, s[12:15], s29 offen offset:1024 lds
    v_mfma_f32_16x16x32_bf16 v[208:211], a[248:251], v[120:123], v[208:211]
    v_mfma_f32_16x16x32_bf16 v[212:215], a[252:255], v[120:123], v[212:215]
    v_mfma_f32_16x16x32_bf16 v[216:219], a[248:251], v[124:127], v[216:219]
    v_mfma_f32_16x16x32_bf16 v[220:223], a[252:255], v[124:127], v[220:223]
    s_cmp_lg_u32 s42, 58
    s_cbranch_scc1 .ql_430
    s_nop 5
    v_cvt_pk_bf16_f32 v224, v208, v209
    v_cvt_pk_bf16_f32 v225, v210, v211
    v_cvt_pk_bf16_f32 v226, v212, v213
    v_cvt_pk_bf16_f32 v227, v214, v215
    v_cvt_pk_bf16_f32 v228, v216, v217
    v_cvt_pk_bf16_f32 v229, v218, v219
    v_cvt_pk_bf16_f32 v230, v220, v221
    v_cvt_pk_bf16_f32 v231, v222, v223
    ds_write_b128 v24, v[224:227] offset:0
    ds_write_b128 v24, v[228:231] offset:4096
    s_waitcnt vmcnt(0)
    v_max_i32 v27, s30, v26
    s_cbranch_vccnz .cp_460
    buffer_store_dword v27, v26, s[8:11], s94 offen
.cb_461:
    s_waitcnt lgkmcnt(0)
    s_barrier
    ds_read_b128 v[208:211], v25 offset:0
    ds_read_b128 v[128:131], v31 offset:0
    ds_read_b128 v[144:147], v31 offset:4096
    ds_read_b128 v[212:215], v25 offset:1024
    ds_read_b128 v[132:135], v31 offset:1024
    ds_read_b128 v[148:151], v31 offset:5120
    ds_read_b128 v[216:219], v25 offset:2048
    ds_read_b128 v[136:139], v31 offset:2048
    ds_read_b128 v[152:155], v31 offset:6144
    ds_read_b128 v[220:223], v25 offset:3072
    ds_read_b128 v[140:143], v31 offset:3072
    ds_read_b128 v[156:159], v31 offset:7168
    ds_read_b128 v[160:163], v5 offset:8192
    ds_read_b128 v[164:167], v5 offset:9216
    ds_read_b128 v[168:171], v5 offset:10240
    ds_read_b128 v[172:175], v5 offset:11264
    s_waitcnt lgkmcnt(4)
    v_mfma_f32_16x16x32_bf16 v[48:51], v[128:131], v[208:211], v[32:35]
    v_mfma_f32_16x16x32_bf16 v[52:55], v[144:147], v[208:211], v[36:39]
    v_mfma_f32_16x16x32_bf16 v[48:51], v[132:135], v[212:215], v[48:51]
    v_mfma_f32_16x16x32_bf16 v[52:55], v[148:151], v[212:215], v[52:55]
    v_mfma_f32_16x16x32_bf16 v[48:51], v[136:139], v[216:219], v[48:51]
    v_mfma_f32_16x16x32_bf16 v[52:55], v[152:155], v[216:219], v[52:55]
    v_mfma_f32_16x16x32_bf16 v[48:51], v[140:143], v[220:223], v[48:51]
    v_mfma_f32_16x16x32_bf16 v[52:55], v[156:159], v[220:223], v[52:55]
    s_cmp_eq_u32 s31, 0
    s_cbranch_scc1 .cp_470
.cb_471:
    s_waitcnt vmcnt(0)
    s_barrier
    ds_read_b128 v[176:179], v3 offset:0
    ds_read_b128 v[180:183], v3 offset:512
    ds_read_b128 v[184:187], v3 offset:1024
    ds_read_b128 v[188:191], v3 offset:1536
    ds_read_b32 v232, v6 offset:0
    ds_read_b32 v234, v6 offset:64
    ds_read_b32 v236, v6 offset:512
    ds_read_b32 v238, v6 offset:576
    v_max3_f32 v248, v48, v49, v50
    v_max3_f32 v248, v248, v51, v52
    v_max3_f32 v249, v53, v54, v55
    s_waitcnt lgkmcnt(4)
    v_mfma_f32_16x16x32_bf16 v[56:59], v[176:179], v[208:211], 0
    v_mfma_f32_16x16x32_bf16 v[56:59], v[180:183], v[212:215], v[56:59]
    v_mfma_f32_16x16x32_bf16 v[56:59], v[184:187], v[216:219], v[56:59]
    v_mfma_f32_16x16x32_bf16 v[56:59], v[188:191], v[220:223], v[56:59]
    s_nop 7
    v_max3_f32 v248, v248, v56, v57
    v_max_f32 v30, v248, v249
    v_max_f32 v249, v248, v249
    s_nop 1
    v_permlane16_swap_b32 v249, v30
    v_max_f32 v248, v249, v30
    v_max_f32 v249, v249, v30
    s_nop 1
    v_permlane32_swap_b32 v248, v249
    v_max_f32 v248, v248, v249
    v_mul_f32 v248, s45, v248
    v_fma_f32 v60, v48, s45, -v248
    v_fma_f32 v61, v49, s45, -v248
    v_fma_f32 v62, v50, s45, -v248
    v_fma_f32 v63, v51, s45, -v248
    v_fma_f32 v242, v52, s45, -v248
    v_fma_f32 v243, v53, s45, -v248
    v_fma_f32 v244, v54, s45, -v248
    v_fma_f32 v245, v55, s45, -v248
    v_fma_f32 v246, v56, s45, -v248
    v_fma_f32 v247, v57, s45, -v248
    v_exp_f32 v60, v60
    v_exp_f32 v61, v61
    v_exp_f32 v62, v62
    v_exp_f32 v63, v63
    v_exp_f32 v242, v242
    v_exp_f32 v243, v243
    v_exp_f32 v244, v244
    v_exp_f32 v245, v245
    v_exp_f32 v246, v246
    v_exp_f32 v247, v247
    v_cvt_pk_bf16_f32 v48, v60, v61
    v_cvt_pk_bf16_f32 v49, v62, v63
    v_cvt_pk_bf16_f32 v50, v242, v243
    v_cvt_pk_bf16_f32 v51, v244, v245
    v_cvt_pk_bf16_f32 v40, v246, v247
    s_waitcnt lgkmcnt(0)
    v_mfma_f32_16x16x32_bf16 v[52:55], v[44:47], v[48:51], 0
    v_mfma_f32_16x16x32_bf16 v[52:55], v[44:47], v[40:43], v[52:55]
    v_mfma_f32_16x16x32_bf16 v[208:211], v[160:163], v[48:51], 0
    v_mfma_f32_16x16x32_bf16 v[208:211], v[232:235], v[40:43], v[208:211]
    v_mfma_f32_16x16x32_bf16 v[212:215], v[164:167], v[48:51], 0
    v_mfma_f32_16x16x32_bf16 v[212:215], v[234:237], v[40:43], v[212:215]
    v_mfma_f32_16x16x32_bf16 v[216:219], v[168:171], v[48:51], 0
    v_mfma_f32_16x16x32_bf16 v[216:219], v[236:239], v[40:43], v[216:219]
    v_mfma_f32_16x16x32_bf16 v[220:223], v[172:175], v[48:51], 0
    v_mfma_f32_16x16x32_bf16 v[220:223], v[238:241], v[40:43], v[220:223]
    v_rcp_f32 v248, v52
    s_nop 0
    v_mul_f32 v208, v248, v208
    v_mul_f32 v209, v248, v209
    v_mul_f32 v210, v248, v210
    v_mul_f32 v211, v248, v211
    v_cvt_pk_bf16_f32 v224, v208, v209
    v_cvt_pk_bf16_f32 v225, v210, v211
    v_mul_f32 v212, v248, v212
    v_mul_f32 v213, v248, v213
    v_mul_f32 v214, v248, v214
    v_mul_f32 v215, v248, v215
    v_cvt_pk_bf16_f32 v226, v212, v213
    v_cvt_pk_bf16_f32 v227, v214, v215
    s_cbranch_vccnz .cp_466
    buffer_store_dwordx4 v[224:227], v2, s[8:11], s53 offen offset:0
.cb_467:
    v_mul_f32 v216, v248, v216
    v_mul_f32 v217, v248, v217
    v_mul_f32 v218, v248, v218
    v_mul_f32 v219, v248, v219
    v_cvt_pk_bf16_f32 v228, v216, v217
    v_cvt_pk_bf16_f32 v229, v218, v219
    v_mul_f32 v220, v248, v220
    v_mul_f32 v221, v248, v221
    v_mul_f32 v222, v248, v222
    v_mul_f32 v223, v248, v223
    v_cvt_pk_bf16_f32 v230, v220, v221
    v_cvt_pk_bf16_f32 v231, v222, v223
    s_cbranch_vccnz .cp_468
    buffer_store_dwordx4 v[228:231], v2, s[8:11], s53 offen offset:1024
.cb_469:
    s_add_u32 s30, s30, 1
    s_mov_b32 s53, s40
    s_waitcnt vmcnt(0)
    v_max_i32 v27, s30, v26
    s_cbranch_vccnz .cp_472
    buffer_store_dword v27, v26, s[8:11], s94 offen
.cb_473:
    s_cmp_gt_u32 s32, 63
    s_cbranch_scc1 .ndd_475
    s_mov_b32 s62, 0
.nd_474:
    buffer_load_dword v29, v7, s[8:11], s46 offen sc1
    buffer_load_dword v30, v7, s[8:11], s47 offen sc1
    s_add_u32 s62, s62, 1
    s_cmp_gt_u32 s62, 0x200000
    s_cbranch_scc1 .mg_end_1
    s_waitcnt vmcnt(0)
    v_min_u32 v29, v29, v30
    s_nop 1
    v_min_u32_dpp v29, v29, v29 quad_perm:[1,0,3,2] row_mask:0xf bank_mask:0xf
    s_nop 1
    v_min_u32_dpp v29, v29, v29 quad_perm:[2,3,0,1] row_mask:0xf bank_mask:0xf
    s_nop 1
    v_readfirstlane_b32 s32, v29
    s_lshl_b32 s55, s32, 18
    s_add_u32 s55, s55, s37
    s_cmp_gt_u32 s32, 63
    s_cbranch_scc1 .ndd_475
    s_sleep 2
    s_branch .nd_474
.ndd_475:
    s_barrier
    s_sub_u32 s4, s36, 16777216
    s_sub_u32 s5, s43, 139264
    s_add_u32 s49, s49, 0x40000
    s_add_u32 s50, s49, 16777216
    s_add_u32 m0, s5, 0
    s_nop 0
    buffer_load_dwordx4 v2, s[8:11], s4 offen lds
    buffer_load_dwordx4 v2, s[8:11], s4 offen offset:1024 lds
    s_add_u32 m0, s5, 8192
    s_nop 0
    buffer_load_dwordx4 v2, s[8:11], s49 offen lds
    buffer_load_dwordx4 v2, s[8:11], s49 offen offset:1024 lds
    s_add_u32 m0, s5, 16384
    s_nop 0
    buffer_load_dwordx4 v2, s[8:11], s50 offen lds
    buffer_load_dwordx4 v2, s[8:11], s50 offen offset:1024 lds
    s_add_u32 s4, s4, 0x40000
    s_add_u32 s49, s49, 0x40000
    s_add_u32 s50, s49, 16777216
    s_add_u32 m0, s5, 24576
    s_nop 0
    buffer_load_dwordx4 v2, s[8:11], s4 offen lds
    buffer_load_dwordx4 v2, s[8:11], s4 offen offset:1024 lds
    s_add_u32 m0, s5, 32768
    s_nop 0
    buffer_load_dwordx4 v2, s[8:11], s49 offen lds
    buffer_load_dwordx4 v2, s[8:11], s49 offen offset:1024 lds
    s_add_u32 m0, s5, 40960
    s_nop 0
    buffer_load_dwordx4 v2, s[8:11], s50 offen lds
    buffer_load_dwordx4 v2, s[8:11], s50 offen offset:1024 lds
    s_add_u32 s4, s4, 0x40000
    s_add_u32 s49, s49, 0x40000
    s_add_u32 s50, s49, 16777216
    s_add_u32 m0, s5, 49152
    s_nop 0
    buffer_load_dwordx4 v2, s[8:11], s4 offen lds
    buffer_load_dwordx4 v2, s[8:11], s4 offen offset:1024 lds
    s_add_u32 m0, s5, 57344
    s_nop 0
    buffer_load_dwordx4 v2, s[8:11], s49 offen lds
    buffer_load_dwordx4 v2, s[8:11], s49 offen offset:1024 lds
    s_add_u32 m0, s5, 65536
    s_nop 0
    buffer_load_dwordx4 v2, s[8:11], s50 offen lds
    buffer_load_dwordx4 v2, s[8:11], s50 offen offset:1024 lds
    s_add_u32 s4, s4, 0x40000
    s_add_u32 s49, s49, 0x40000
    s_add_u32 s50, s49, 16777216
    s_add_u32 m0, s5, 73728
    s_nop 0
    buffer_load_dwordx4 v2, s[8:11], s4 offen lds
    buffer_load_dwordx4 v2, s[8:11], s4 offen offset:1024 lds
    s_add_u32 m0, s5, 81920
    s_nop 0
    buffer_load_dwordx4 v2, s[8:11], s49 offen lds
    buffer_load_dwordx4 v2, s[8:11], s49 offen offset:1024 lds
    s_add_u32 m0, s5, 90112
    s_nop 0
    buffer_load_dwordx4 v2, s[8:11], s50 offen lds
    buffer_load_dwordx4 v2, s[8:11], s50 offen offset:1024 lds
    s_add_u32 s4, s4, 0x40000
    s_add_u32 s49, s49, 0x40000
    s_add_u32 s50, s49, 16777216
    s_add_u32 m0, s5, 98304
    s_nop 0
    buffer_load_dwordx4 v2, s[8:11], s4 offen lds
    buffer_load_dwordx4 v2, s[8:11], s4 offen offset:1024 lds
    s_add_u32 m0, s5, 106496
    s_nop 0
    buffer_load_dwordx4 v2, s[8:11], s49 offen lds
    buffer_load_dwordx4 v2, s[8:11], s49 offen offset:1024 lds
    s_add_u32 m0, s5, 114688
    s_nop 0
    buffer_load_dwordx4 v2, s[8:11], s50 offen lds
    buffer_load_dwordx4 v2, s[8:11], s50 offen offset:1024 lds
    s_add_u32 s4, s4, 0x40000
    s_add_u32 s49, s49, 0x40000
    s_add_u32 s50, s49, 16777216
    s_add_u32 m0, s5, 122880
    s_nop 0
    buffer_load_dwordx4 v2, s[8:11], s4 offen lds
    buffer_load_dwordx4 v2, s[8:11], s4 offen offset:1024 lds
    s_add_u32 m0, s5, 131072
    s_nop 0
    buffer_load_dwordx4 v2, s[8:11], s49 offen lds
    buffer_load_dwordx4 v2, s[8:11], s49 offen offset:1024 lds
    s_add_u32 m0, s5, 139264
    s_nop 0
    buffer_load_dwordx4 v2, s[8:11], s50 offen lds
    buffer_load_dwordx4 v2, s[8:11], s50 offen offset:1024 lds
    s_add_u32 s4, s4, 0x40000
    buffer_load_dword v4, v7, s[8:11], 0 offen sc1
    v_subrev_u32 v25, 131072, v25
    v_subrev_u32 v31, 131072, v31
    v_subrev_u32 v5, 131072, v5
    s_add_u32 s48, s48, 0x20000
    s_mov_b32 s31, 0
    s_add_u32 s40, s40, 0x40000
    s_waitcnt vmcnt(31)
    s_barrier
    ds_read_b128 v[192:195], v25 offset:0
    ds_read_b128 v[128:131], v31 offset:0
    ds_read_b128 v[144:147], v31 offset:4096
    ds_read_b128 v[196:199], v25 offset:1024
    ds_read_b128 v[132:135], v31 offset:1024
    ds_read_b128 v[148:151], v31 offset:5120
    ds_read_b128 v[200:203], v25 offset:2048
    ds_read_b128 v[136:139], v31 offset:2048
    ds_read_b128 v[152:155], v31 offset:6144
    ds_read_b128 v[204:207], v25 offset:3072
    ds_read_b128 v[140:143], v31 offset:3072
    ds_read_b128 v[156:159], v31 offset:7168
    ds_read_b128 v[160:163], v5 offset:8192
    ds_read_b128 v[164:167], v5 offset:9216
    ds_read_b128 v[168:171], v5 offset:10240
    ds_read_b128 v[172:175], v5 offset:11264
    s_waitcnt lgkmcnt(4)
    v_mfma_f32_16x16x32_bf16 v[48:51], v[128:131], v[192:195], v[32:35]
    v_mfma_f32_16x16x32_bf16 v[52:55], v[144:147], v[192:195], v[36:39]
    v_mfma_f32_16x16x32_bf16 v[48:51], v[132:135], v[196:199], v[48:51]
    v_mfma_f32_16x16x32_bf16 v[52:55], v[148:151], v[196:199], v[52:55]
    v_mfma_f32_16x16x32_bf16 v[48:51], v[136:139], v[200:203], v[48:51]
    v_mfma_f32_16x16x32_bf16 v[52:55], v[152:155], v[200:203], v[52:55]
    v_mfma_f32_16x16x32_bf16 v[48:51], v[140:143], v[204:207], v[48:51]
    v_mfma_f32_16x16x32_bf16 v[52:55], v[156:159], v[204:207], v[52:55]
    s_waitcnt vmcnt(0)
    v_min_u32_dpp v4, v4, v4 quad_perm:[1,0,3,2] row_mask:0xf bank_mask:0xf
    s_nop 1
    v_min_u32_dpp v4, v4, v4 quad_perm:[2,3,0,1] row_mask:0xf bank_mask:0xf
    s_nop 1
    v_readfirstlane_b32 s33, v4
    s_cmp_eq_u32 s31, 0
    s_cbranch_scc1 .cp_485
.cb_486:
    s_waitcnt vmcnt(0)
    s_barrier
    ds_read_b128 v[176:179], v3 offset:4096
    ds_read_b128 v[180:183], v3 offset:4608
    ds_read_b128 v[184:187], v3 offset:5120
    ds_read_b128 v[188:191], v3 offset:5632
    ds_read_b32 v232, v6 offset:4096
    ds_read_b32 v234, v6 offset:4160
    ds_read_b32 v236, v6 offset:4608
    ds_read_b32 v238, v6 offset:4672
    v_max3_f32 v248, v48, v49, v50
    v_max3_f32 v248, v248, v51, v52
    v_max3_f32 v249, v53, v54, v55
    s_waitcnt lgkmcnt(4)
    v_mfma_f32_16x16x32_bf16 v[56:59], v[176:179], v[192:195], 0
    v_mfma_f32_16x16x32_bf16 v[56:59], v[180:183], v[196:199], v[56:59]
    v_mfma_f32_16x16x32_bf16 v[56:59], v[184:187], v[200:203], v[56:59]
    v_mfma_f32_16x16x32_bf16 v[56:59], v[188:191], v[204:207], v[56:59]
    s_nop 7
    v_max3_f32 v248, v248, v56, v57
    v_max_f32 v30, v248, v249
    v_max_f32 v249, v248, v249
    s_nop 1
    v_permlane16_swap_b32 v249, v30
    v_max_f32 v248, v249, v30
    v_max_f32 v249, v249, v30
    s_nop 1
    v_permlane32_swap_b32 v248, v249
    v_max_f32 v248, v248, v249
    v_mul_f32 v248, s45, v248
    v_fma_f32 v60, v48, s45, -v248
    v_fma_f32 v61, v49, s45, -v248
    v_fma_f32 v62, v50, s45, -v248
    v_fma_f32 v63, v51, s45, -v248
    v_fma_f32 v242, v52, s45, -v248
    v_fma_f32 v243, v53, s45, -v248
    v_fma_f32 v244, v54, s45, -v248
    v_fma_f32 v245, v55, s45, -v248
    v_fma_f32 v246, v56, s45, -v248
    v_fma_f32 v247, v57, s45, -v248
    v_exp_f32 v60, v60
    v_exp_f32 v61, v61
    v_exp_f32 v62, v62
    v_exp_f32 v63, v63
    v_exp_f32 v242, v242
    v_exp_f32 v243, v243
    v_exp_f32 v244, v244
    v_exp_f32 v245, v245
    v_exp_f32 v246, v246
    v_exp_f32 v247, v247
    v_cvt_pk_bf16_f32 v48, v60, v61
    v_cvt_pk_bf16_f32 v49, v62, v63
    v_cvt_pk_bf16_f32 v50, v242, v243
    v_cvt_pk_bf16_f32 v51, v244, v245
    v_cvt_pk_bf16_f32 v40, v246, v247
    s_waitcnt lgkmcnt(0)
    v_mfma_f32_16x16x32_bf16 v[52:55], v[44:47], v[48:51], 0
    v_mfma_f32_16x16x32_bf16 v[52:55], v[44:47], v[40:43], v[52:55]
    v_mfma_f32_16x16x32_bf16 v[192:195], v[160:163], v[48:51], 0
    v_mfma_f32_16x16x32_bf16 v[192:195], v[232:235], v[40:43], v[192:195]
    v_mfma_f32_16x16x32_bf16 v[196:199], v[164:167], v[48:51], 0
    v_mfma_f32_16x16x32_bf16 v[196:199], v[234:237], v[40:43], v[196:199]
    v_mfma_f32_16x16x32_bf16 v[200:203], v[168:171], v[48:51], 0
    v_mfma_f32_16x16x32_bf16 v[200:203], v[236:239], v[40:43], v[200:203]
    v_mfma_f32_16x16x32_bf16 v[204:207], v[172:175], v[48:51], 0
    v_mfma_f32_16x16x32_bf16 v[204:207], v[238:241], v[40:43], v[204:207]
    v_rcp_f32 v248, v52
    s_nop 0
    v_mul_f32 v192, v248, v192
    v_mul_f32 v193, v248, v193
    v_mul_f32 v194, v248, v194
    v_mul_f32 v195, v248, v195
    v_cvt_pk_bf16_f32 v224, v192, v193
    v_cvt_pk_bf16_f32 v225, v194, v195
    v_mul_f32 v196, v248, v196
    v_mul_f32 v197, v248, v197
    v_mul_f32 v198, v248, v198
    v_mul_f32 v199, v248, v199
    v_cvt_pk_bf16_f32 v226, v196, v197
    v_cvt_pk_bf16_f32 v227, v198, v199
    s_cbranch_vccnz .cp_481
    buffer_store_dwordx4 v[224:227], v2, s[8:11], s53 offen offset:0
.cb_482:
    v_mul_f32 v200, v248, v200
    v_mul_f32 v201, v248, v201
    v_mul_f32 v202, v248, v202
    v_mul_f32 v203, v248, v203
    v_cvt_pk_bf16_f32 v228, v200, v201
    v_cvt_pk_bf16_f32 v229, v202, v203
    v_mul_f32 v204, v248, v204
    v_mul_f32 v205, v248, v205
    v_mul_f32 v206, v248, v206
    v_mul_f32 v207, v248, v207
    v_cvt_pk_bf16_f32 v230, v204, v205
    v_cvt_pk_bf16_f32 v231, v206, v207
    s_cbranch_vccnz .cp_483
    buffer_store_dwordx4 v[228:231], v2, s[8:11], s53 offen offset:1024
.cb_484:
    buffer_load_dword v4, v7, s[8:11], 0 offen sc1
    s_add_u32 s30, s30, 1
    s_mov_b32 s53, s40
    s_waitcnt vmcnt(1)
    v_max_i32 v27, s30, v26
    s_cbranch_vccnz .cp_487
    buffer_store_dword v27, v26, s[8:11], s94 offen
.cb_488:
    v_add_u32 v25, 24576, v25
    v_add_u32 v31, 24576, v31
    v_add_u32 v5, 24576, v5
    s_add_u32 s48, s48, 0x20000
    s_mov_b32 s31, 0
    s_add_u32 s40, s40, 0x40000
    ds_read_b128 v[208:211], v25 offset:0
    ds_read_b128 v[128:131], v31 offset:0
    ds_read_b128 v[144:147], v31 offset:4096
    ds_read_b128 v[212:215], v25 offset:1024
    ds_read_b128 v[132:135], v31 offset:1024
    ds_read_b128 v[148:151], v31 offset:5120
    ds_read_b128 v[216:219], v25 offset:2048
    ds_read_b128 v[136:139], v31 offset:2048
    ds_read_b128 v[152:155], v31 offset:6144
    ds_read_b128 v[220:223], v25 offset:3072
    ds_read_b128 v[140:143], v31 offset:3072
    ds_read_b128 v[156:159], v31 offset:7168
    ds_read_b128 v[160:163], v5 offset:8192
    ds_read_b128 v[164:167], v5 offset:9216
    ds_read_b128 v[168:171], v5 offset:10240
    ds_read_b128 v[172:175], v5 offset:11264
    s_waitcnt lgkmcnt(4)
    v_mfma_f32_16x16x32_bf16 v[48:51], v[128:131], v[208:211], v[32:35]
    v_mfma_f32_16x16x32_bf16 v[52:55], v[144:147], v[208:211], v[36:39]
    v_mfma_f32_16x16x32_bf16 v[48:51], v[132:135], v[212:215], v[48:51]
    v_mfma_f32_16x16x32_bf16 v[52:55], v[148:151], v[212:215], v[52:55]
    v_mfma_f32_16x16x32_bf16 v[48:51], v[136:139], v[216:219], v[48:51]
    v_mfma_f32_16x16x32_bf16 v[52:55], v[152:155], v[216:219], v[52:55]
    v_mfma_f32_16x16x32_bf16 v[48:51], v[140:143], v[220:223], v[48:51]
    v_mfma_f32_16x16x32_bf16 v[52:55], v[156:159], v[220:223], v[52:55]
    s_waitcnt vmcnt(1)
    v_min_u32_dpp v4, v4, v4 quad_perm:[1,0,3,2] row_mask:0xf bank_mask:0xf
    s_nop 1
    v_min_u32_dpp v4, v4, v4 quad_perm:[2,3,0,1] row_mask:0xf bank_mask:0xf
    s_nop 1
    v_readfirstlane_b32 s33, v4
    s_cmp_eq_u32 s31, 0
    s_cbranch_scc1 .cp_498
.cb_499:
    s_waitcnt vmcnt(0)
    s_barrier
    ds_read_b128 v[176:179], v3 offset:0
    ds_read_b128 v[180:183], v3 offset:512
    ds_read_b128 v[184:187], v3 offset:1024
    ds_read_b128 v[188:191], v3 offset:1536
    ds_read_b32 v232, v6 offset:0
    ds_read_b32 v234, v6 offset:64
    ds_read_b32 v236, v6 offset:512
    ds_read_b32 v238, v6 offset:576
    v_max3_f32 v248, v48, v49, v50
    v_max3_f32 v248, v248, v51, v52
    v_max3_f32 v249, v53, v54, v55
    s_waitcnt lgkmcnt(4)
    v_mfma_f32_16x16x32_bf16 v[56:59], v[176:179], v[208:211], 0
    v_mfma_f32_16x16x32_bf16 v[56:59], v[180:183], v[212:215], v[56:59]
    v_mfma_f32_16x16x32_bf16 v[56:59], v[184:187], v[216:219], v[56:59]
    v_mfma_f32_16x16x32_bf16 v[56:59], v[188:191], v[220:223], v[56:59]
    s_nop 7
    v_max3_f32 v248, v248, v56, v57
    v_max_f32 v30, v248, v249
    v_max_f32 v249, v248, v249
    s_nop 1
    v_permlane16_swap_b32 v249, v30
    v_max_f32 v248, v249, v30
    v_max_f32 v249, v249, v30
    s_nop 1
    v_permlane32_swap_b32 v248, v249
    v_max_f32 v248, v248, v249
    v_mul_f32 v248, s45, v248
    v_fma_f32 v60, v48, s45, -v248
    v_fma_f32 v61, v49, s45, -v248
    v_fma_f32 v62, v50, s45, -v248
    v_fma_f32 v63, v51, s45, -v248
    v_fma_f32 v242, v52, s45, -v248
    v_fma_f32 v243, v53, s45, -v248
    v_fma_f32 v244, v54, s45, -v248
    v_fma_f32 v245, v55, s45, -v248
    v_fma_f32 v246, v56, s45, -v248
    v_fma_f32 v247, v57, s45, -v248
    v_exp_f32 v60, v60
    v_exp_f32 v61, v61
    v_exp_f32 v62, v62
    v_exp_f32 v63, v63
    v_exp_f32 v242, v242
    v_exp_f32 v243, v243
    v_exp_f32 v244, v244
    v_exp_f32 v245, v245
    v_exp_f32 v246, v246
    v_exp_f32 v247, v247
    v_cvt_pk_bf16_f32 v48, v60, v61
    v_cvt_pk_bf16_f32 v49, v62, v63
    v_cvt_pk_bf16_f32 v50, v242, v243
    v_cvt_pk_bf16_f32 v51, v244, v245
    v_cvt_pk_bf16_f32 v40, v246, v247
    s_waitcnt lgkmcnt(0)
    v_mfma_f32_16x16x32_bf16 v[52:55], v[44:47], v[48:51], 0
    v_mfma_f32_16x16x32_bf16 v[52:55], v[44:47], v[40:43], v[52:55]
    v_mfma_f32_16x16x32_bf16 v[208:211], v[160:163], v[48:51], 0
    v_mfma_f32_16x16x32_bf16 v[208:211], v[232:235], v[40:43], v[208:211]
    v_mfma_f32_16x16x32_bf16 v[212:215], v[164:167], v[48:51], 0
    v_mfma_f32_16x16x32_bf16 v[212:215], v[234:237], v[40:43], v[212:215]
    v_mfma_f32_16x16x32_bf16 v[216:219], v[168:171], v[48:51], 0
    v_mfma_f32_16x16x32_bf16 v[216:219], v[236:239], v[40:43], v[216:219]
    v_mfma_f32_16x16x32_bf16 v[220:223], v[172:175], v[48:51], 0
    v_mfma_f32_16x16x32_bf16 v[220:223], v[238:241], v[40:43], v[220:223]
    v_rcp_f32 v248, v52
    s_nop 0
    v_mul_f32 v208, v248, v208
    v_mul_f32 v209, v248, v209
    v_mul_f32 v210, v248, v210
    v_mul_f32 v211, v248, v211
    v_cvt_pk_bf16_f32 v224, v208, v209
    v_cvt_pk_bf16_f32 v225, v210, v211
    v_mul_f32 v212, v248, v212
    v_mul_f32 v213, v248, v213
    v_mul_f32 v214, v248, v214
    v_mul_f32 v215, v248, v215
    v_cvt_pk_bf16_f32 v226, v212, v213
    v_cvt_pk_bf16_f32 v227, v214, v215
    s_cbranch_vccnz .cp_494
    buffer_store_dwordx4 v[224:227], v2, s[8:11], s53 offen offset:0
.cb_495:
    v_mul_f32 v216, v248, v216
    v_mul_f32 v217, v248, v217
    v_mul_f32 v218, v248, v218
    v_mul_f32 v219, v248, v219
    v_cvt_pk_bf16_f32 v228, v216, v217
    v_cvt_pk_bf16_f32 v229, v218, v219
    v_mul_f32 v220, v248, v220
    v_mul_f32 v221, v248, v221
    v_mul_f32 v222, v248, v222
    v_mul_f32 v223, v248, v223
    v_cvt_pk_bf16_f32 v230, v220, v221
    v_cvt_pk_bf16_f32 v231, v222, v223
    s_cbranch_vccnz .cp_496
    buffer_store_dwordx4 v[228:231], v2, s[8:11], s53 offen offset:1024
.cb_497:
    buffer_load_dword v4, v7, s[8:11], 0 offen sc1
    s_add_u32 s30, s30, 1
    s_mov_b32 s53, s40
    s_waitcnt vmcnt(1)
    v_max_i32 v27, s30, v26
    s_cbranch_vccnz .cp_500
    buffer_store_dword v27, v26, s[8:11], s94 offen
.cb_501:
    v_add_u32 v25, 24576, v25
    v_add_u32 v31, 24576, v31
    v_add_u32 v5, 24576, v5
    s_add_u32 s48, s48, 0x20000
    s_mov_b32 s31, 0
    s_add_u32 s40, s40, 0x40000
    ds_read_b128 v[192:195], v25 offset:0
    ds_read_b128 v[128:131], v31 offset:0
    ds_read_b128 v[144:147], v31 offset:4096
    ds_read_b128 v[196:199], v25 offset:1024
    ds_read_b128 v[132:135], v31 offset:1024
    ds_read_b128 v[148:151], v31 offset:5120
    ds_read_b128 v[200:203], v25 offset:2048
    ds_read_b128 v[136:139], v31 offset:2048
    ds_read_b128 v[152:155], v31 offset:6144
    ds_read_b128 v[204:207], v25 offset:3072
    ds_read_b128 v[140:143], v31 offset:3072
    ds_read_b128 v[156:159], v31 offset:7168
    ds_read_b128 v[160:163], v5 offset:8192
    ds_read_b128 v[164:167], v5 offset:9216
    ds_read_b128 v[168:171], v5 offset:10240
    ds_read_b128 v[172:175], v5 offset:11264
    s_waitcnt lgkmcnt(4)
    v_mfma_f32_16x16x32_bf16 v[48:51], v[128:131], v[192:195], v[32:35]
    v_mfma_f32_16x16x32_bf16 v[52:55], v[144:147], v[192:195], v[36:39]
    v_mfma_f32_16x16x32_bf16 v[48:51], v[132:135], v[196:199], v[48:51]
    v_mfma_f32_16x16x32_bf16 v[52:55], v[148:151], v[196:199], v[52:55]
    v_mfma_f32_16x16x32_bf16 v[48:51], v[136:139], v[200:203], v[48:51]
    v_mfma_f32_16x16x32_bf16 v[52:55], v[152:155], v[200:203], v[52:55]
    v_mfma_f32_16x16x32_bf16 v[48:51], v[140:143], v[204:207], v[48:51]
    v_mfma_f32_16x16x32_bf16 v[52:55], v[156:159], v[204:207], v[52:55]
    s_waitcnt vmcnt(1)
    v_min_u32_dpp v4, v4, v4 quad_perm:[1,0,3,2] row_mask:0xf bank_mask:0xf
    s_nop 1
    v_min_u32_dpp v4, v4, v4 quad_perm:[2,3,0,1] row_mask:0xf bank_mask:0xf
    s_nop 1
    v_readfirstlane_b32 s33, v4
    s_cmp_eq_u32 s31, 0
    s_cbranch_scc1 .cp_511
.cb_512:
    s_waitcnt vmcnt(0)
    s_barrier
    ds_read_b128 v[176:179], v3 offset:4096
    ds_read_b128 v[180:183], v3 offset:4608
    ds_read_b128 v[184:187], v3 offset:5120
    ds_read_b128 v[188:191], v3 offset:5632
    ds_read_b32 v232, v6 offset:4096
    ds_read_b32 v234, v6 offset:4160
    ds_read_b32 v236, v6 offset:4608
    ds_read_b32 v238, v6 offset:4672
    v_max3_f32 v248, v48, v49, v50
    v_max3_f32 v248, v248, v51, v52
    v_max3_f32 v249, v53, v54, v55
    s_waitcnt lgkmcnt(4)
    v_mfma_f32_16x16x32_bf16 v[56:59], v[176:179], v[192:195], 0
    v_mfma_f32_16x16x32_bf16 v[56:59], v[180:183], v[196:199], v[56:59]
    v_mfma_f32_16x16x32_bf16 v[56:59], v[184:187], v[200:203], v[56:59]
    v_mfma_f32_16x16x32_bf16 v[56:59], v[188:191], v[204:207], v[56:59]
    s_nop 7
    v_max3_f32 v248, v248, v56, v57
    v_max_f32 v30, v248, v249
    v_max_f32 v249, v248, v249
    s_nop 1
    v_permlane16_swap_b32 v249, v30
    v_max_f32 v248, v249, v30
    v_max_f32 v249, v249, v30
    s_nop 1
    v_permlane32_swap_b32 v248, v249
    v_max_f32 v248, v248, v249
    v_mul_f32 v248, s45, v248
    v_fma_f32 v60, v48, s45, -v248
    v_fma_f32 v61, v49, s45, -v248
    v_fma_f32 v62, v50, s45, -v248
    v_fma_f32 v63, v51, s45, -v248
    v_fma_f32 v242, v52, s45, -v248
    v_fma_f32 v243, v53, s45, -v248
    v_fma_f32 v244, v54, s45, -v248
    v_fma_f32 v245, v55, s45, -v248
    v_fma_f32 v246, v56, s45, -v248
    v_fma_f32 v247, v57, s45, -v248
    v_exp_f32 v60, v60
    v_exp_f32 v61, v61
    v_exp_f32 v62, v62
    v_exp_f32 v63, v63
    v_exp_f32 v242, v242
    v_exp_f32 v243, v243
    v_exp_f32 v244, v244
    v_exp_f32 v245, v245
    v_exp_f32 v246, v246
    v_exp_f32 v247, v247
    v_cvt_pk_bf16_f32 v48, v60, v61
    v_cvt_pk_bf16_f32 v49, v62, v63
    v_cvt_pk_bf16_f32 v50, v242, v243
    v_cvt_pk_bf16_f32 v51, v244, v245
    v_cvt_pk_bf16_f32 v40, v246, v247
    s_waitcnt lgkmcnt(0)
    v_mfma_f32_16x16x32_bf16 v[52:55], v[44:47], v[48:51], 0
    v_mfma_f32_16x16x32_bf16 v[52:55], v[44:47], v[40:43], v[52:55]
    v_mfma_f32_16x16x32_bf16 v[192:195], v[160:163], v[48:51], 0
    v_mfma_f32_16x16x32_bf16 v[192:195], v[232:235], v[40:43], v[192:195]
    v_mfma_f32_16x16x32_bf16 v[196:199], v[164:167], v[48:51], 0
    v_mfma_f32_16x16x32_bf16 v[196:199], v[234:237], v[40:43], v[196:199]
    v_mfma_f32_16x16x32_bf16 v[200:203], v[168:171], v[48:51], 0
    v_mfma_f32_16x16x32_bf16 v[200:203], v[236:239], v[40:43], v[200:203]
    v_mfma_f32_16x16x32_bf16 v[204:207], v[172:175], v[48:51], 0
    v_mfma_f32_16x16x32_bf16 v[204:207], v[238:241], v[40:43], v[204:207]
    v_rcp_f32 v248, v52
    s_nop 0
    v_mul_f32 v192, v248, v192
    v_mul_f32 v193, v248, v193
    v_mul_f32 v194, v248, v194
    v_mul_f32 v195, v248, v195
    v_cvt_pk_bf16_f32 v224, v192, v193
    v_cvt_pk_bf16_f32 v225, v194, v195
    v_mul_f32 v196, v248, v196
    v_mul_f32 v197, v248, v197
    v_mul_f32 v198, v248, v198
    v_mul_f32 v199, v248, v199
    v_cvt_pk_bf16_f32 v226, v196, v197
    v_cvt_pk_bf16_f32 v227, v198, v199
    s_cbranch_vccnz .cp_507
    buffer_store_dwordx4 v[224:227], v2, s[8:11], s53 offen offset:0
.cb_508:
    v_mul_f32 v200, v248, v200
    v_mul_f32 v201, v248, v201
    v_mul_f32 v202, v248, v202
    v_mul_f32 v203, v248, v203
    v_cvt_pk_bf16_f32 v228, v200, v201
    v_cvt_pk_bf16_f32 v229, v202, v203
    v_mul_f32 v204, v248, v204
    v_mul_f32 v205, v248, v205
    v_mul_f32 v206, v248, v206
    v_mul_f32 v207, v248, v207
    v_cvt_pk_bf16_f32 v230, v204, v205
    v_cvt_pk_bf16_f32 v231, v206, v207
    s_cbranch_vccnz .cp_509
    buffer_store_dwordx4 v[228:231], v2, s[8:11], s53 offen offset:1024
.cb_510:
    buffer_load_dword v4, v7, s[8:11], 0 offen sc1
    s_add_u32 s30, s30, 1
    s_mov_b32 s53, s40
    s_waitcnt vmcnt(1)
    v_max_i32 v27, s30, v26
    s_cbranch_vccnz .cp_513
    buffer_store_dword v27, v26, s[8:11], s94 offen
.cb_514:
    v_add_u32 v25, 24576, v25
    v_add_u32 v31, 24576, v31
    v_add_u32 v5, 24576, v5
    s_add_u32 s48, s48, 0x20000
    s_mov_b32 s31, 0
    s_add_u32 s40, s40, 0x40000
    ds_read_b128 v[208:211], v25 offset:0
    ds_read_b128 v[128:131], v31 offset:0
    ds_read_b128 v[144:147], v31 offset:4096
    ds_read_b128 v[212:215], v25 offset:1024
    ds_read_b128 v[132:135], v31 offset:1024
    ds_read_b128 v[148:151], v31 offset:5120
    ds_read_b128 v[216:219], v25 offset:2048
    ds_read_b128 v[136:139], v31 offset:2048
    ds_read_b128 v[152:155], v31 offset:6144
    ds_read_b128 v[220:223], v25 offset:3072
    ds_read_b128 v[140:143], v31 offset:3072
    ds_read_b128 v[156:159], v31 offset:7168
    ds_read_b128 v[160:163], v5 offset:8192
    ds_read_b128 v[164:167], v5 offset:9216
    ds_read_b128 v[168:171], v5 offset:10240
    ds_read_b128 v[172:175], v5 offset:11264
    s_waitcnt lgkmcnt(4)
    v_mfma_f32_16x16x32_bf16 v[48:51], v[128:131], v[208:211], v[32:35]
    v_mfma_f32_16x16x32_bf16 v[52:55], v[144:147], v[208:211], v[36:39]
    v_mfma_f32_16x16x32_bf16 v[48:51], v[132:135], v[212:215], v[48:51]
    v_mfma_f32_16x16x32_bf16 v[52:55], v[148:151], v[212:215], v[52:55]
    v_mfma_f32_16x16x32_bf16 v[48:51], v[136:139], v[216:219], v[48:51]
    v_mfma_f32_16x16x32_bf16 v[52:55], v[152:155], v[216:219], v[52:55]
    v_mfma_f32_16x16x32_bf16 v[48:51], v[140:143], v[220:223], v[48:51]
    v_mfma_f32_16x16x32_bf16 v[52:55], v[156:159], v[220:223], v[52:55]
    s_waitcnt vmcnt(1)
    v_min_u32_dpp v4, v4, v4 quad_perm:[1,0,3,2] row_mask:0xf bank_mask:0xf
    s_nop 1
    v_min_u32_dpp v4, v4, v4 quad_perm:[2,3,0,1] row_mask:0xf bank_mask:0xf
    s_nop 1
    v_readfirstlane_b32 s33, v4
    s_cmp_eq_u32 s31, 0
    s_cbranch_scc1 .cp_524
.cb_525:
    s_waitcnt vmcnt(0)
    s_barrier
    ds_read_b128 v[176:179], v3 offset:0
    ds_read_b128 v[180:183], v3 offset:512
    ds_read_b128 v[184:187], v3 offset:1024
    ds_read_b128 v[188:191], v3 offset:1536
    ds_read_b32 v232, v6 offset:0
    ds_read_b32 v234, v6 offset:64
    ds_read_b32 v236, v6 offset:512
    ds_read_b32 v238, v6 offset:576
    v_max3_f32 v248, v48, v49, v50
    v_max3_f32 v248, v248, v51, v52
    v_max3_f32 v249, v53, v54, v55
    s_waitcnt lgkmcnt(4)
    v_mfma_f32_16x16x32_bf16 v[56:59], v[176:179], v[208:211], 0
    v_mfma_f32_16x16x32_bf16 v[56:59], v[180:183], v[212:215], v[56:59]
    v_mfma_f32_16x16x32_bf16 v[56:59], v[184:187], v[216:219], v[56:59]
    v_mfma_f32_16x16x32_bf16 v[56:59], v[188:191], v[220:223], v[56:59]
    s_nop 7
    v_max3_f32 v248, v248, v56, v57
    v_max_f32 v30, v248, v249
    v_max_f32 v249, v248, v249
    s_nop 1
    v_permlane16_swap_b32 v249, v30
    v_max_f32 v248, v249, v30
    v_max_f32 v249, v249, v30
    s_nop 1
    v_permlane32_swap_b32 v248, v249
    v_max_f32 v248, v248, v249
    v_mul_f32 v248, s45, v248
    v_fma_f32 v60, v48, s45, -v248
    v_fma_f32 v61, v49, s45, -v248
    v_fma_f32 v62, v50, s45, -v248
    v_fma_f32 v63, v51, s45, -v248
    v_fma_f32 v242, v52, s45, -v248
    v_fma_f32 v243, v53, s45, -v248
    v_fma_f32 v244, v54, s45, -v248
    v_fma_f32 v245, v55, s45, -v248
    v_fma_f32 v246, v56, s45, -v248
    v_fma_f32 v247, v57, s45, -v248
    v_exp_f32 v60, v60
    v_exp_f32 v61, v61
    v_exp_f32 v62, v62
    v_exp_f32 v63, v63
    v_exp_f32 v242, v242
    v_exp_f32 v243, v243
    v_exp_f32 v244, v244
    v_exp_f32 v245, v245
    v_exp_f32 v246, v246
    v_exp_f32 v247, v247
    v_cvt_pk_bf16_f32 v48, v60, v61
    v_cvt_pk_bf16_f32 v49, v62, v63
    v_cvt_pk_bf16_f32 v50, v242, v243
    v_cvt_pk_bf16_f32 v51, v244, v245
    v_cvt_pk_bf16_f32 v40, v246, v247
    s_waitcnt lgkmcnt(0)
    v_mfma_f32_16x16x32_bf16 v[52:55], v[44:47], v[48:51], 0
    v_mfma_f32_16x16x32_bf16 v[52:55], v[44:47], v[40:43], v[52:55]
    v_mfma_f32_16x16x32_bf16 v[208:211], v[160:163], v[48:51], 0
    v_mfma_f32_16x16x32_bf16 v[208:211], v[232:235], v[40:43], v[208:211]
    v_mfma_f32_16x16x32_bf16 v[212:215], v[164:167], v[48:51], 0
    v_mfma_f32_16x16x32_bf16 v[212:215], v[234:237], v[40:43], v[212:215]
    v_mfma_f32_16x16x32_bf16 v[216:219], v[168:171], v[48:51], 0
    v_mfma_f32_16x16x32_bf16 v[216:219], v[236:239], v[40:43], v[216:219]
    v_mfma_f32_16x16x32_bf16 v[220:223], v[172:175], v[48:51], 0
    v_mfma_f32_16x16x32_bf16 v[220:223], v[238:241], v[40:43], v[220:223]
    v_rcp_f32 v248, v52
    s_nop 0
    v_mul_f32 v208, v248, v208
    v_mul_f32 v209, v248, v209
    v_mul_f32 v210, v248, v210
    v_mul_f32 v211, v248, v211
    v_cvt_pk_bf16_f32 v224, v208, v209
    v_cvt_pk_bf16_f32 v225, v210, v211
    v_mul_f32 v212, v248, v212
    v_mul_f32 v213, v248, v213
    v_mul_f32 v214, v248, v214
    v_mul_f32 v215, v248, v215
    v_cvt_pk_bf16_f32 v226, v212, v213
    v_cvt_pk_bf16_f32 v227, v214, v215
    s_cbranch_vccnz .cp_520
    buffer_store_dwordx4 v[224:227], v2, s[8:11], s53 offen offset:0
.cb_521:
    v_mul_f32 v216, v248, v216
    v_mul_f32 v217, v248, v217
    v_mul_f32 v218, v248, v218
    v_mul_f32 v219, v248, v219
    v_cvt_pk_bf16_f32 v228, v216, v217
    v_cvt_pk_bf16_f32 v229, v218, v219
    v_mul_f32 v220, v248, v220
    v_mul_f32 v221, v248, v221
    v_mul_f32 v222, v248, v222
    v_mul_f32 v223, v248, v223
    v_cvt_pk_bf16_f32 v230, v220, v221
    v_cvt_pk_bf16_f32 v231, v222, v223
    s_cbranch_vccnz .cp_522
    buffer_store_dwordx4 v[228:231], v2, s[8:11], s53 offen offset:1024
.cb_523:
    buffer_load_dword v4, v7, s[8:11], 0 offen sc1
    s_add_u32 s30, s30, 1
    s_mov_b32 s53, s40
    s_waitcnt vmcnt(1)
    v_max_i32 v27, s30, v26
    s_cbranch_vccnz .cp_526
    buffer_store_dword v27, v26, s[8:11], s94 offen
.cb_527:
    v_add_u32 v25, 24576, v25
    v_add_u32 v31, 24576, v31
    v_add_u32 v5, 24576, v5
    s_add_u32 s48, s48, 0x20000
    s_mov_b32 s31, 0
    s_add_u32 s40, s40, 0x40000
    ds_read_b128 v[192:195], v25 offset:0
    ds_read_b128 v[128:131], v31 offset:0
    ds_read_b128 v[144:147], v31 offset:4096
    ds_read_b128 v[196:199], v25 offset:1024
    ds_read_b128 v[132:135], v31 offset:1024
    ds_read_b128 v[148:151], v31 offset:5120
    ds_read_b128 v[200:203], v25 offset:2048
    ds_read_b128 v[136:139], v31 offset:2048
    ds_read_b128 v[152:155], v31 offset:6144
    ds_read_b128 v[204:207], v25 offset:3072
    ds_read_b128 v[140:143], v31 offset:3072
    ds_read_b128 v[156:159], v31 offset:7168
    ds_read_b128 v[160:163], v5 offset:8192
    ds_read_b128 v[164:167], v5 offset:9216
    ds_read_b128 v[168:171], v5 offset:10240
    ds_read_b128 v[172:175], v5 offset:11264
    s_waitcnt lgkmcnt(4)
    v_mfma_f32_16x16x32_bf16 v[48:51], v[128:131], v[192:195], v[32:35]
    v_mfma_f32_16x16x32_bf16 v[52:55], v[144:147], v[192:195], v[36:39]
    v_mfma_f32_16x16x32_bf16 v[48:51], v[132:135], v[196:199], v[48:51]
    v_mfma_f32_16x16x32_bf16 v[52:55], v[148:151], v[196:199], v[52:55]
    v_mfma_f32_16x16x32_bf16 v[48:51], v[136:139], v[200:203], v[48:51]
    v_mfma_f32_16x16x32_bf16 v[52:55], v[152:155], v[200:203], v[52:55]
    v_mfma_f32_16x16x32_bf16 v[48:51], v[140:143], v[204:207], v[48:51]
    v_mfma_f32_16x16x32_bf16 v[52:55], v[156:159], v[204:207], v[52:55]
    s_waitcnt vmcnt(1)
    v_min_u32_dpp v4, v4, v4 quad_perm:[1,0,3,2] row_mask:0xf bank_mask:0xf
    s_nop 1
    v_min_u32_dpp v4, v4, v4 quad_perm:[2,3,0,1] row_mask:0xf bank_mask:0xf
    s_nop 1
    v_readfirstlane_b32 s33, v4
    s_cmp_eq_u32 s31, 0
    s_cbranch_scc1 .cp_537
.cb_538:
    s_waitcnt vmcnt(0)
    s_barrier
    ds_read_b128 v[176:179], v3 offset:4096
    ds_read_b128 v[180:183], v3 offset:4608
    ds_read_b128 v[184:187], v3 offset:5120
    ds_read_b128 v[188:191], v3 offset:5632
    ds_read_b32 v232, v6 offset:4096
    ds_read_b32 v234, v6 offset:4160
    ds_read_b32 v236, v6 offset:4608
    ds_read_b32 v238, v6 offset:4672
    v_max3_f32 v248, v48, v49, v50
    v_max3_f32 v248, v248, v51, v52
    v_max3_f32 v249, v53, v54, v55
    s_waitcnt lgkmcnt(4)
    v_mfma_f32_16x16x32_bf16 v[56:59], v[176:179], v[192:195], 0
    v_mfma_f32_16x16x32_bf16 v[56:59], v[180:183], v[196:199], v[56:59]
    v_mfma_f32_16x16x32_bf16 v[56:59], v[184:187], v[200:203], v[56:59]
    v_mfma_f32_16x16x32_bf16 v[56:59], v[188:191], v[204:207], v[56:59]
    s_nop 7
    v_max3_f32 v248, v248, v56, v57
    v_max_f32 v30, v248, v249
    v_max_f32 v249, v248, v249
    s_nop 1
    v_permlane16_swap_b32 v249, v30
    v_max_f32 v248, v249, v30
    v_max_f32 v249, v249, v30
    s_nop 1
    v_permlane32_swap_b32 v248, v249
    v_max_f32 v248, v248, v249
    v_mul_f32 v248, s45, v248
    v_fma_f32 v60, v48, s45, -v248
    v_fma_f32 v61, v49, s45, -v248
    v_fma_f32 v62, v50, s45, -v248
    v_fma_f32 v63, v51, s45, -v248
    v_fma_f32 v242, v52, s45, -v248
    v_fma_f32 v243, v53, s45, -v248
    v_fma_f32 v244, v54, s45, -v248
    v_fma_f32 v245, v55, s45, -v248
    v_fma_f32 v246, v56, s45, -v248
    v_fma_f32 v247, v57, s45, -v248
    v_exp_f32 v60, v60
    v_exp_f32 v61, v61
    v_exp_f32 v62, v62
    v_exp_f32 v63, v63
    v_exp_f32 v242, v242
    v_exp_f32 v243, v243
    v_exp_f32 v244, v244
    v_exp_f32 v245, v245
    v_exp_f32 v246, v246
    v_exp_f32 v247, v247
    v_cvt_pk_bf16_f32 v48, v60, v61
    v_cvt_pk_bf16_f32 v49, v62, v63
    v_cvt_pk_bf16_f32 v50, v242, v243
    v_cvt_pk_bf16_f32 v51, v244, v245
    v_cvt_pk_bf16_f32 v40, v246, v247
    s_waitcnt lgkmcnt(0)
    v_mfma_f32_16x16x32_bf16 v[52:55], v[44:47], v[48:51], 0
    v_mfma_f32_16x16x32_bf16 v[52:55], v[44:47], v[40:43], v[52:55]
    v_mfma_f32_16x16x32_bf16 v[192:195], v[160:163], v[48:51], 0
    v_mfma_f32_16x16x32_bf16 v[192:195], v[232:235], v[40:43], v[192:195]
    v_mfma_f32_16x16x32_bf16 v[196:199], v[164:167], v[48:51], 0
    v_mfma_f32_16x16x32_bf16 v[196:199], v[234:237], v[40:43], v[196:199]
    v_mfma_f32_16x16x32_bf16 v[200:203], v[168:171], v[48:51], 0
    v_mfma_f32_16x16x32_bf16 v[200:203], v[236:239], v[40:43], v[200:203]
    v_mfma_f32_16x16x32_bf16 v[204:207], v[172:175], v[48:51], 0
    v_mfma_f32_16x16x32_bf16 v[204:207], v[238:241], v[40:43], v[204:207]
    v_rcp_f32 v248, v52
    s_nop 0
    v_mul_f32 v192, v248, v192
    v_mul_f32 v193, v248, v193
    v_mul_f32 v194, v248, v194
    v_mul_f32 v195, v248, v195
    v_cvt_pk_bf16_f32 v224, v192, v193
    v_cvt_pk_bf16_f32 v225, v194, v195
    v_mul_f32 v196, v248, v196
    v_mul_f32 v197, v248, v197
    v_mul_f32 v198, v248, v198
    v_mul_f32 v199, v248, v199
    v_cvt_pk_bf16_f32 v226, v196, v197
    v_cvt_pk_bf16_f32 v227, v198, v199
    s_cbranch_vccnz .cp_533
    buffer_store_dwordx4 v[224:227], v2, s[8:11], s53 offen offset:0
.cb_534:
    v_mul_f32 v200, v248, v200
    v_mul_f32 v201, v248, v201
    v_mul_f32 v202, v248, v202
    v_mul_f32 v203, v248, v203
    v_cvt_pk_bf16_f32 v228, v200, v201
    v_cvt_pk_bf16_f32 v229, v202, v203
    v_mul_f32 v204, v248, v204
    v_mul_f32 v205, v248, v205
    v_mul_f32 v206, v248, v206
    v_mul_f32 v207, v248, v207
    v_cvt_pk_bf16_f32 v230, v204, v205
    v_cvt_pk_bf16_f32 v231, v206, v207
    s_cbranch_vccnz .cp_535
    buffer_store_dwordx4 v[228:231], v2, s[8:11], s53 offen offset:1024
.cb_536:
    buffer_load_dword v4, v7, s[8:11], 0 offen sc1
    s_add_u32 s30, s30, 1
    s_mov_b32 s53, s40
    s_waitcnt vmcnt(1)
    v_max_i32 v27, s30, v26
    s_cbranch_vccnz .cp_539
    buffer_store_dword v27, v26, s[8:11], s94 offen
.cb_540:
    v_add_u32 v25, 24576, v25
    v_add_u32 v31, 24576, v31
    v_add_u32 v5, 24576, v5
    s_add_u32 s48, s48, 0x20000
    s_mov_b32 s31, 0
    s_add_u32 s40, s40, 0x40000
    ds_read_b128 v[208:211], v25 offset:0
    ds_read_b128 v[128:131], v31 offset:0
    ds_read_b128 v[144:147], v31 offset:4096
    ds_read_b128 v[212:215], v25 offset:1024
    ds_read_b128 v[132:135], v31 offset:1024
    ds_read_b128 v[148:151], v31 offset:5120
    ds_read_b128 v[216:219], v25 offset:2048
    ds_read_b128 v[136:139], v31 offset:2048
    ds_read_b128 v[152:155], v31 offset:6144
    ds_read_b128 v[220:223], v25 offset:3072
    ds_read_b128 v[140:143], v31 offset:3072
    ds_read_b128 v[156:159], v31 offset:7168
    ds_read_b128 v[160:163], v5 offset:8192
    ds_read_b128 v[164:167], v5 offset:9216
    ds_read_b128 v[168:171], v5 offset:10240
    ds_read_b128 v[172:175], v5 offset:11264
    s_waitcnt lgkmcnt(4)
    v_mfma_f32_16x16x32_bf16 v[48:51], v[128:131], v[208:211], v[32:35]
    v_mfma_f32_16x16x32_bf16 v[52:55], v[144:147], v[208:211], v[36:39]
    v_mfma_f32_16x16x32_bf16 v[48:51], v[132:135], v[212:215], v[48:51]
    v_mfma_f32_16x16x32_bf16 v[52:55], v[148:151], v[212:215], v[52:55]
    v_mfma_f32_16x16x32_bf16 v[48:51], v[136:139], v[216:219], v[48:51]
    v_mfma_f32_16x16x32_bf16 v[52:55], v[152:155], v[216:219], v[52:55]
    v_mfma_f32_16x16x32_bf16 v[48:51], v[140:143], v[220:223], v[48:51]
    v_mfma_f32_16x16x32_bf16 v[52:55], v[156:159], v[220:223], v[52:55]
    s_waitcnt vmcnt(1)
    v_min_u32_dpp v4, v4, v4 quad_perm:[1,0,3,2] row_mask:0xf bank_mask:0xf
    s_nop 1
    v_min_u32_dpp v4, v4, v4 quad_perm:[2,3,0,1] row_mask:0xf bank_mask:0xf
    s_nop 1
    v_readfirstlane_b32 s33, v4
    s_cmp_eq_u32 s31, 0
    s_cbranch_scc1 .cp_550
.cb_551:
    s_waitcnt vmcnt(0)
    s_barrier
    ds_read_b128 v[176:179], v3 offset:0
    ds_read_b128 v[180:183], v3 offset:512
    ds_read_b128 v[184:187], v3 offset:1024
    ds_read_b128 v[188:191], v3 offset:1536
    ds_read_b32 v232, v6 offset:0
    ds_read_b32 v234, v6 offset:64
    ds_read_b32 v236, v6 offset:512
    ds_read_b32 v238, v6 offset:576
    v_max3_f32 v248, v48, v49, v50
    v_max3_f32 v248, v248, v51, v52
    v_max3_f32 v249, v53, v54, v55
    s_waitcnt lgkmcnt(4)
    v_mfma_f32_16x16x32_bf16 v[56:59], v[176:179], v[208:211], 0
    v_mfma_f32_16x16x32_bf16 v[56:59], v[180:183], v[212:215], v[56:59]
    v_mfma_f32_16x16x32_bf16 v[56:59], v[184:187], v[216:219], v[56:59]
    v_mfma_f32_16x16x32_bf16 v[56:59], v[188:191], v[220:223], v[56:59]
    s_nop 7
    v_max3_f32 v248, v248, v56, v57
    v_max_f32 v30, v248, v249
    v_max_f32 v249, v248, v249
    s_nop 1
    v_permlane16_swap_b32 v249, v30
    v_max_f32 v248, v249, v30
    v_max_f32 v249, v249, v30
    s_nop 1
    v_permlane32_swap_b32 v248, v249
    v_max_f32 v248, v248, v249
    v_mul_f32 v248, s45, v248
    v_fma_f32 v60, v48, s45, -v248
    v_fma_f32 v61, v49, s45, -v248
    v_fma_f32 v62, v50, s45, -v248
    v_fma_f32 v63, v51, s45, -v248
    v_fma_f32 v242, v52, s45, -v248
    v_fma_f32 v243, v53, s45, -v248
    v_fma_f32 v244, v54, s45, -v248
    v_fma_f32 v245, v55, s45, -v248
    v_fma_f32 v246, v56, s45, -v248
    v_fma_f32 v247, v57, s45, -v248
    v_exp_f32 v60, v60
    v_exp_f32 v61, v61
    v_exp_f32 v62, v62
    v_exp_f32 v63, v63
    v_exp_f32 v242, v242
    v_exp_f32 v243, v243
    v_exp_f32 v244, v244
    v_exp_f32 v245, v245
    v_exp_f32 v246, v246
    v_exp_f32 v247, v247
    v_cvt_pk_bf16_f32 v48, v60, v61
    v_cvt_pk_bf16_f32 v49, v62, v63
    v_cvt_pk_bf16_f32 v50, v242, v243
    v_cvt_pk_bf16_f32 v51, v244, v245
    v_cvt_pk_bf16_f32 v40, v246, v247
    s_waitcnt lgkmcnt(0)
    v_mfma_f32_16x16x32_bf16 v[52:55], v[44:47], v[48:51], 0
    v_mfma_f32_16x16x32_bf16 v[52:55], v[44:47], v[40:43], v[52:55]
    v_mfma_f32_16x16x32_bf16 v[208:211], v[160:163], v[48:51], 0
    v_mfma_f32_16x16x32_bf16 v[208:211], v[232:235], v[40:43], v[208:211]
    v_mfma_f32_16x16x32_bf16 v[212:215], v[164:167], v[48:51], 0
    v_mfma_f32_16x16x32_bf16 v[212:215], v[234:237], v[40:43], v[212:215]
    v_mfma_f32_16x16x32_bf16 v[216:219], v[168:171], v[48:51], 0
    v_mfma_f32_16x16x32_bf16 v[216:219], v[236:239], v[40:43], v[216:219]
    v_mfma_f32_16x16x32_bf16 v[220:223], v[172:175], v[48:51], 0
    v_mfma_f32_16x16x32_bf16 v[220:223], v[238:241], v[40:43], v[220:223]
    v_rcp_f32 v248, v52
    s_nop 0
    v_mul_f32 v208, v248, v208
    v_mul_f32 v209, v248, v209
    v_mul_f32 v210, v248, v210
    v_mul_f32 v211, v248, v211
    v_cvt_pk_bf16_f32 v224, v208, v209
    v_cvt_pk_bf16_f32 v225, v210, v211
    v_mul_f32 v212, v248, v212
    v_mul_f32 v213, v248, v213
    v_mul_f32 v214, v248, v214
    v_mul_f32 v215, v248, v215
    v_cvt_pk_bf16_f32 v226, v212, v213
    v_cvt_pk_bf16_f32 v227, v214, v215
    s_cbranch_vccnz .cp_546
    buffer_store_dwordx4 v[224:227], v2, s[8:11], s53 offen offset:0
.cb_547:
    v_mul_f32 v216, v248, v216
    v_mul_f32 v217, v248, v217
    v_mul_f32 v218, v248, v218
    v_mul_f32 v219, v248, v219
    v_cvt_pk_bf16_f32 v228, v216, v217
    v_cvt_pk_bf16_f32 v229, v218, v219
    v_mul_f32 v220, v248, v220
    v_mul_f32 v221, v248, v221
    v_mul_f32 v222, v248, v222
    v_mul_f32 v223, v248, v223
    v_cvt_pk_bf16_f32 v230, v220, v221
    v_cvt_pk_bf16_f32 v231, v222, v223
    s_cbranch_vccnz .cp_548
    buffer_store_dwordx4 v[228:231], v2, s[8:11], s53 offen offset:1024
.cb_549:
    s_add_u32 s30, s30, 1
    s_mov_b32 s53, s40
    s_waitcnt vmcnt(0)
    v_max_i32 v27, s30, v26
    s_cbranch_vccnz .cp_552
    buffer_store_dword v27, v26, s[8:11], s94 offen
.cb_553:
    s_endpgm
.cp_432:
    buffer_store_dwordx4 v[224:227], v2, s[8:11], s53 offen offset:0 sc1
    s_branch .cb_433
.cp_434:
    buffer_store_dwordx4 v[228:231], v2, s[8:11], s53 offen offset:1024 sc1
    s_branch .cb_435
.cp_436:
    buffer_store_dword v27, v26, s[8:11], s94 offen sc1
    s_branch .cb_437
.cp_438:
    s_cmp_gt_u32 s32, s42
    s_cbranch_scc1 .ndd_555
    s_mov_b32 s62, 0
.nd_554:
    buffer_load_dword v29, v7, s[8:11], s46 offen sc1
    buffer_load_dword v30, v7, s[8:11], s47 offen sc1
    s_add_u32 s62, s62, 1
    s_cmp_gt_u32 s62, 0x200000
    s_cbranch_scc1 .mg_end_1
    s_waitcnt vmcnt(0)
    v_min_u32 v29, v29, v30
    s_nop 1
    v_min_u32_dpp v29, v29, v29 quad_perm:[1,0,3,2] row_mask:0xf bank_mask:0xf
    s_nop 1
    v_min_u32_dpp v29, v29, v29 quad_perm:[2,3,0,1] row_mask:0xf bank_mask:0xf
    s_nop 1
    v_readfirstlane_b32 s32, v29
    s_lshl_b32 s55, s32, 18
    s_add_u32 s55, s55, s37
    s_cmp_gt_u32 s32, s42
    s_cbranch_scc1 .ndd_555
    s_sleep 2
    s_branch .nd_554
.ndd_555:
    s_branch .cb_439
.cp_440:
    s_cmp_gt_u32 s33, s30
    s_cbranch_scc1 .ndd_557
    s_mov_b32 s62, 0
.nd_556:
    buffer_load_dword v4, v7, s[8:11], 0 offen sc1
    s_add_u32 s62, s62, 1
    s_cmp_gt_u32 s62, 0x200000
    s_cbranch_scc1 .mg_end_1
    s_waitcnt vmcnt(0)
    v_min_u32_dpp v4, v4, v4 quad_perm:[1,0,3,2] row_mask:0xf bank_mask:0xf
    s_nop 1
    v_min_u32_dpp v4, v4, v4 quad_perm:[2,3,0,1] row_mask:0xf bank_mask:0xf
    s_nop 1
    v_readfirstlane_b32 s33, v4
    s_cmp_gt_u32 s33, s30
    s_cbranch_scc1 .ndd_557
    s_sleep 2
    s_branch .nd_556
.ndd_557:
    s_add_u32 m0, s52, 0
    s_nop 0
    buffer_load_dwordx4 v2, s[8:11], s48 offen lds
    s_waitcnt vmcnt(0)
    s_branch .cb_441
.pp_442:
    buffer_load_dword v4, v7, s[8:11], 0 offen sc1
    s_mov_b32 s31, 0
    s_branch .pb_443
.cp_444:
    s_waitcnt vmcnt(1)
    v_min_u32_dpp v4, v4, v4 quad_perm:[1,0,3,2] row_mask:0xf bank_mask:0xf
    s_nop 1
    v_min_u32_dpp v4, v4, v4 quad_perm:[2,3,0,1] row_mask:0xf bank_mask:0xf
    s_nop 1
    v_readfirstlane_b32 s33, v4
    s_cmp_gt_u32 s33, s42
    s_cbranch_scc0 .cb_445
    s_mov_b32 s31, 1
    s_add_u32 m0, s52, 4096
    s_nop 0
    buffer_load_dwordx4 v2, s[8:11], s48 offen lds
    s_branch .cb_445
.cp_446:
    buffer_store_dwordx4 v[224:227], v2, s[8:11], s53 offen offset:0 sc1
    s_branch .cb_447
.cp_448:
    buffer_store_dwordx4 v[228:231], v2, s[8:11], s53 offen offset:1024 sc1
    s_branch .cb_449
.cp_450:
    buffer_store_dword v27, v26, s[8:11], s94 offen sc1
    s_branch .cb_451
.cp_452:
    s_cmp_gt_u32 s32, s42
    s_cbranch_scc1 .ndd_559
    s_mov_b32 s62, 0
.nd_558:
    buffer_load_dword v29, v7, s[8:11], s46 offen sc1
    buffer_load_dword v30, v7, s[8:11], s47 offen sc1
    s_add_u32 s62, s62, 1
    s_cmp_gt_u32 s62, 0x200000
    s_cbranch_scc1 .mg_end_1
    s_waitcnt vmcnt(0)
    v_min_u32 v29, v29, v30
    s_nop 1
    v_min_u32_dpp v29, v29, v29 quad_perm:[1,0,3,2] row_mask:0xf bank_mask:0xf
    s_nop 1
    v_min_u32_dpp v29, v29, v29 quad_perm:[2,3,0,1] row_mask:0xf bank_mask:0xf
    s_nop 1
    v_readfirstlane_b32 s32, v29
    s_lshl_b32 s55, s32, 18
    s_add_u32 s55, s55, s37
    s_cmp_gt_u32 s32, s42
    s_cbranch_scc1 .ndd_559
    s_sleep 2
    s_branch .nd_558
.ndd_559:
    s_branch .cb_453
.cp_454:
    s_cmp_gt_u32 s33, s30
    s_cbranch_scc1 .ndd_561
    s_mov_b32 s62, 0
.nd_560:
    buffer_load_dword v4, v7, s[8:11], 0 offen sc1
    s_add_u32 s62, s62, 1
    s_cmp_gt_u32 s62, 0x200000
    s_cbranch_scc1 .mg_end_1
    s_waitcnt vmcnt(0)
    v_min_u32_dpp v4, v4, v4 quad_perm:[1,0,3,2] row_mask:0xf bank_mask:0xf
    s_nop 1
    v_min_u32_dpp v4, v4, v4 quad_perm:[2,3,0,1] row_mask:0xf bank_mask:0xf
    s_nop 1
    v_readfirstlane_b32 s33, v4
    s_cmp_gt_u32 s33, s30
    s_cbranch_scc1 .ndd_561
    s_sleep 2
    s_branch .nd_560
.ndd_561:
    s_add_u32 m0, s52, 4096
    s_nop 0
    buffer_load_dwordx4 v2, s[8:11], s48 offen lds
    s_waitcnt vmcnt(0)
    s_branch .cb_455
.pp_456:
    buffer_load_dword v4, v7, s[8:11], 0 offen sc1
    s_mov_b32 s31, 0
    s_branch .pb_457
.cp_458:
    s_waitcnt vmcnt(1)
    v_min_u32_dpp v4, v4, v4 quad_perm:[1,0,3,2] row_mask:0xf bank_mask:0xf
    s_nop 1
    v_min_u32_dpp v4, v4, v4 quad_perm:[2,3,0,1] row_mask:0xf bank_mask:0xf
    s_nop 1
    v_readfirstlane_b32 s33, v4
    s_cmp_gt_u32 s33, s42
    s_cbranch_scc0 .cb_459
    s_mov_b32 s31, 1
    s_add_u32 m0, s52, 0
    s_nop 0
    buffer_load_dwordx4 v2, s[8:11], s48 offen lds
    s_branch .cb_459
.cp_460:
    buffer_store_dword v27, v26, s[8:11], s94 offen sc1
    s_branch .cb_461
.cp_466:
    buffer_store_dwordx4 v[224:227], v2, s[8:11], s53 offen offset:0 sc1
    s_branch .cb_467
.cp_468:
    buffer_store_dwordx4 v[228:231], v2, s[8:11], s53 offen offset:1024 sc1
    s_branch .cb_469
.cp_470:
    s_cmp_gt_u32 s33, s30
    s_cbranch_scc1 .ndd_563
    s_mov_b32 s62, 0
.nd_562:
    buffer_load_dword v4, v7, s[8:11], 0 offen sc1
    s_add_u32 s62, s62, 1
    s_cmp_gt_u32 s62, 0x200000
    s_cbranch_scc1 .mg_end_1
    s_waitcnt vmcnt(0)
    v_min_u32_dpp v4, v4, v4 quad_perm:[1,0,3,2] row_mask:0xf bank_mask:0xf
    s_nop 1
    v_min_u32_dpp v4, v4, v4 quad_perm:[2,3,0,1] row_mask:0xf bank_mask:0xf
    s_nop 1
    v_readfirstlane_b32 s33, v4
    s_cmp_gt_u32 s33, s30
    s_cbranch_scc1 .ndd_563
    s_sleep 2
    s_branch .nd_562
.ndd_563:
    s_add_u32 m0, s52, 0
    s_nop 0
    buffer_load_dwordx4 v2, s[8:11], s48 offen lds
    s_waitcnt vmcnt(0)
    s_branch .cb_471
.cp_472:
    buffer_store_dword v27, v26, s[8:11], s94 offen sc1
    s_branch .cb_473
.cp_481:
    buffer_store_dwordx4 v[224:227], v2, s[8:11], s53 offen offset:0 sc1
    s_branch .cb_482
.cp_483:
    buffer_store_dwordx4 v[228:231], v2, s[8:11], s53 offen offset:1024 sc1
    s_branch .cb_484
.cp_485:
    s_cmp_gt_u32 s33, s30
    s_cbranch_scc1 .ndd_565
    s_mov_b32 s62, 0
.nd_564:
    buffer_load_dword v4, v7, s[8:11], 0 offen sc1
    s_add_u32 s62, s62, 1
    s_cmp_gt_u32 s62, 0x200000
    s_cbranch_scc1 .mg_end_1
    s_waitcnt vmcnt(0)
    v_min_u32_dpp v4, v4, v4 quad_perm:[1,0,3,2] row_mask:0xf bank_mask:0xf
    s_nop 1
    v_min_u32_dpp v4, v4, v4 quad_perm:[2,3,0,1] row_mask:0xf bank_mask:0xf
    s_nop 1
    v_readfirstlane_b32 s33, v4
    s_cmp_gt_u32 s33, s30
    s_cbranch_scc1 .ndd_565
    s_sleep 2
    s_branch .nd_564
.ndd_565:
    s_add_u32 m0, s52, 4096
    s_nop 0
    buffer_load_dwordx4 v2, s[8:11], s48 offen lds
    s_waitcnt vmcnt(0)
    s_branch .cb_486
.cp_487:
    buffer_store_dword v27, v26, s[8:11], s94 offen sc1
    s_branch .cb_488
.cp_494:
    buffer_store_dwordx4 v[224:227], v2, s[8:11], s53 offen offset:0 sc1
    s_branch .cb_495
.cp_496:
    buffer_store_dwordx4 v[228:231], v2, s[8:11], s53 offen offset:1024 sc1
    s_branch .cb_497
.cp_498:
    s_cmp_gt_u32 s33, s30
    s_cbranch_scc1 .ndd_567
    s_mov_b32 s62, 0
.nd_566:
    buffer_load_dword v4, v7, s[8:11], 0 offen sc1
    s_add_u32 s62, s62, 1
    s_cmp_gt_u32 s62, 0x200000
    s_cbranch_scc1 .mg_end_1
    s_waitcnt vmcnt(0)
    v_min_u32_dpp v4, v4, v4 quad_perm:[1,0,3,2] row_mask:0xf bank_mask:0xf
    s_nop 1
    v_min_u32_dpp v4, v4, v4 quad_perm:[2,3,0,1] row_mask:0xf bank_mask:0xf
    s_nop 1
    v_readfirstlane_b32 s33, v4
    s_cmp_gt_u32 s33, s30
    s_cbranch_scc1 .ndd_567
    s_sleep 2
    s_branch .nd_566
.ndd_567:
    s_add_u32 m0, s52, 0
    s_nop 0
    buffer_load_dwordx4 v2, s[8:11], s48 offen lds
    s_waitcnt vmcnt(0)
    s_branch .cb_499
.cp_500:
    buffer_store_dword v27, v26, s[8:11], s94 offen sc1
    s_branch .cb_501
.cp_507:
    buffer_store_dwordx4 v[224:227], v2, s[8:11], s53 offen offset:0 sc1
    s_branch .cb_508
.cp_509:
    buffer_store_dwordx4 v[228:231], v2, s[8:11], s53 offen offset:1024 sc1
    s_branch .cb_510
.cp_511:
    s_cmp_gt_u32 s33, s30
    s_cbranch_scc1 .ndd_569
    s_mov_b32 s62, 0
.nd_568:
    buffer_load_dword v4, v7, s[8:11], 0 offen sc1
    s_add_u32 s62, s62, 1
    s_cmp_gt_u32 s62, 0x200000
    s_cbranch_scc1 .mg_end_1
    s_waitcnt vmcnt(0)
    v_min_u32_dpp v4, v4, v4 quad_perm:[1,0,3,2] row_mask:0xf bank_mask:0xf
    s_nop 1
    v_min_u32_dpp v4, v4, v4 quad_perm:[2,3,0,1] row_mask:0xf bank_mask:0xf
    s_nop 1
    v_readfirstlane_b32 s33, v4
    s_cmp_gt_u32 s33, s30
    s_cbranch_scc1 .ndd_569
    s_sleep 2
    s_branch .nd_568
.ndd_569:
    s_add_u32 m0, s52, 4096
    s_nop 0
    buffer_load_dwordx4 v2, s[8:11], s48 offen lds
    s_waitcnt vmcnt(0)
    s_branch .cb_512
.cp_513:
    buffer_store_dword v27, v26, s[8:11], s94 offen sc1
    s_branch .cb_514
.cp_520:
    buffer_store_dwordx4 v[224:227], v2, s[8:11], s53 offen offset:0 sc1
    s_branch .cb_521
.cp_522:
    buffer_store_dwordx4 v[228:231], v2, s[8:11], s53 offen offset:1024 sc1
    s_branch .cb_523
.cp_524:
    s_cmp_gt_u32 s33, s30
    s_cbranch_scc1 .ndd_571
    s_mov_b32 s62, 0
.nd_570:
    buffer_load_dword v4, v7, s[8:11], 0 offen sc1
    s_add_u32 s62, s62, 1
    s_cmp_gt_u32 s62, 0x200000
    s_cbranch_scc1 .mg_end_1
    s_waitcnt vmcnt(0)
    v_min_u32_dpp v4, v4, v4 quad_perm:[1,0,3,2] row_mask:0xf bank_mask:0xf
    s_nop 1
    v_min_u32_dpp v4, v4, v4 quad_perm:[2,3,0,1] row_mask:0xf bank_mask:0xf
    s_nop 1
    v_readfirstlane_b32 s33, v4
    s_cmp_gt_u32 s33, s30
    s_cbranch_scc1 .ndd_571
    s_sleep 2
    s_branch .nd_570
.ndd_571:
    s_add_u32 m0, s52, 0
    s_nop 0
    buffer_load_dwordx4 v2, s[8:11], s48 offen lds
    s_waitcnt vmcnt(0)
    s_branch .cb_525
.cp_526:
    buffer_store_dword v27, v26, s[8:11], s94 offen sc1
    s_branch .cb_527
.cp_533:
    buffer_store_dwordx4 v[224:227], v2, s[8:11], s53 offen offset:0 sc1
    s_branch .cb_534
.cp_535:
    buffer_store_dwordx4 v[228:231], v2, s[8:11], s53 offen offset:1024 sc1
    s_branch .cb_536
.cp_537:
    s_cmp_gt_u32 s33, s30
    s_cbranch_scc1 .ndd_573
    s_mov_b32 s62, 0
.nd_572:
    buffer_load_dword v4, v7, s[8:11], 0 offen sc1
    s_add_u32 s62, s62, 1
    s_cmp_gt_u32 s62, 0x200000
    s_cbranch_scc1 .mg_end_1
    s_waitcnt vmcnt(0)
    v_min_u32_dpp v4, v4, v4 quad_perm:[1,0,3,2] row_mask:0xf bank_mask:0xf
    s_nop 1
    v_min_u32_dpp v4, v4, v4 quad_perm:[2,3,0,1] row_mask:0xf bank_mask:0xf
    s_nop 1
    v_readfirstlane_b32 s33, v4
    s_cmp_gt_u32 s33, s30
    s_cbranch_scc1 .ndd_573
    s_sleep 2
    s_branch .nd_572
.ndd_573:
    s_add_u32 m0, s52, 4096
    s_nop 0
    buffer_load_dwordx4 v2, s[8:11], s48 offen lds
    s_waitcnt vmcnt(0)
    s_branch .cb_538
.cp_539:
    buffer_store_dword v27, v26, s[8:11], s94 offen sc1
    s_branch .cb_540
.cp_546:
    buffer_store_dwordx4 v[224:227], v2, s[8:11], s53 offen offset:0 sc1
    s_branch .cb_547
.cp_548:
    buffer_store_dwordx4 v[228:231], v2, s[8:11], s53 offen offset:1024 sc1
    s_branch .cb_549
.cp_550:
    s_cmp_gt_u32 s33, s30
    s_cbranch_scc1 .ndd_575
    s_mov_b32 s62, 0
.nd_574:
    buffer_load_dword v4, v7, s[8:11], 0 offen sc1
    s_add_u32 s62, s62, 1
    s_cmp_gt_u32 s62, 0x200000
    s_cbranch_scc1 .mg_end_1
    s_waitcnt vmcnt(0)
    v_min_u32_dpp v4, v4, v4 quad_perm:[1,0,3,2] row_mask:0xf bank_mask:0xf
    s_nop 1
    v_min_u32_dpp v4, v4, v4 quad_perm:[2,3,0,1] row_mask:0xf bank_mask:0xf
    s_nop 1
    v_readfirstlane_b32 s33, v4
    s_cmp_gt_u32 s33, s30
    s_cbranch_scc1 .ndd_575
    s_sleep 2
    s_branch .nd_574
.ndd_575:
    s_add_u32 m0, s52, 0
    s_nop 0
    buffer_load_dwordx4 v2, s[8:11], s48 offen lds
    s_waitcnt vmcnt(0)
    s_branch .cb_551
.cp_552:
    buffer_store_dword v27, v26, s[8:11], s94 offen sc1
    s_branch .cb_553
.ph2_386:
    s_load_dwordx2 s[42:43], s[0:1], 88
    s_lshr_b32 s34, s99, 3
    s_and_b32 s35, s99, 7
    s_lshl_b32 s4, s34, 21
    s_lshl_b32 s5, s35, 8
    s_add_u32 s4, s4, s5
    s_lshl_b32 s6, s24, 14
    s_mul_i32 s5, s24, 131072
    s_add_u32 s4, s4, s5
    v_bfe_u32 v2, v1, 4, 1
    v_lshlrev_b32 v2, 2, v2
    v_and_b32 v3, 7, v1
    v_xor_b32 v2, v2, v3
    v_lshlrev_b32 v2, 4, v2
    v_bfe_u32 v254, v1, 3, 2
    v_mul_u32_u24 v240, 2048, v254
    v_bfe_u32 v254, v1, 5, 1
    v_mul_u32_u24 v254, 128, v254
    v_add_u32 v240, v240, v254
    v_add_u32 v240, s4, v240
    v_add_u32 v240, v2, v240
    s_lshr_b32 s5, s24, 1
    s_lshl_b32 s5, s5, 9
    v_bfe_u32 v2, v1, 3, 1
    v_xor_b32 v2, s24, v2
    v_and_b32 v2, 1, v2
    v_lshlrev_b32 v2, 6, v2
    v_bfe_u32 v254, v1, 4, 2
    v_mul_u32_u24 v242, 2048, v254
    v_bfe_u32 v254, v1, 2, 2
    v_mul_u32_u24 v254, 128, v254
    v_add_u32 v242, v242, v254
    v_bfe_u32 v254, v1, 0, 2
    v_mul_u32_u24 v254, 16, v254
    v_add_u32 v242, v242, v254
    v_add_u32 v242, s5, v242
    v_add_u32 v242, v2, v242
    v_add_u32 v243, 0x10000, v242
    s_waitcnt lgkmcnt(0)
    s_mov_b32 s16, s42
    s_and_b32 s17, s43, 0xffff
    s_mov_b32 s18, 0x800000
    s_mov_b32 s19, 0x00020000
    s_add_u32 m0, s6, 0
    s_mov_b32 s5, 0
    buffer_load_dwordx4 v240, s[16:19], s5 offen nt lds
    s_add_u32 m0, s6, 1024
    s_mov_b32 s5, 8192
    buffer_load_dwordx4 v240, s[16:19], s5 offen nt lds
    s_add_u32 m0, s6, 2048
    s_mov_b32 s5, 16384
    buffer_load_dwordx4 v240, s[16:19], s5 offen nt lds
    s_add_u32 m0, s6, 3072
    s_mov_b32 s5, 24576
    buffer_load_dwordx4 v240, s[16:19], s5 offen nt lds
    s_add_u32 m0, s6, 4096
    s_mov_b32 s5, 32768
    buffer_load_dwordx4 v240, s[16:19], s5 offen nt lds
    s_add_u32 m0, s6, 5120
    s_mov_b32 s5, 40960
    buffer_load_dwordx4 v240, s[16:19], s5 offen nt lds
    s_add_u32 m0, s6, 6144
    s_mov_b32 s5, 49152
    buffer_load_dwordx4 v240, s[16:19], s5 offen nt lds
    s_add_u32 m0, s6, 7168
    s_mov_b32 s5, 57344
    buffer_load_dwordx4 v240, s[16:19], s5 offen nt lds
    s_add_u32 m0, s6, 8192
    s_mov_b32 s5, 65536
    buffer_load_dwordx4 v240, s[16:19], s5 offen nt lds
    s_add_u32 m0, s6, 9216
    s_mov_b32 s5, 73728
    buffer_load_dwordx4 v240, s[16:19], s5 offen nt lds
    s_add_u32 m0, s6, 10240
    s_mov_b32 s5, 81920
    buffer_load_dwordx4 v240, s[16:19], s5 offen nt lds
    s_add_u32 m0, s6, 11264
    s_mov_b32 s5, 90112
    buffer_load_dwordx4 v240, s[16:19], s5 offen nt lds
    s_add_u32 m0, s6, 12288
    s_mov_b32 s5, 98304
    buffer_load_dwordx4 v240, s[16:19], s5 offen nt lds
    s_add_u32 m0, s6, 13312
    s_mov_b32 s5, 106496
    buffer_load_dwordx4 v240, s[16:19], s5 offen nt lds
    s_add_u32 m0, s6, 14336
    s_mov_b32 s5, 114688
    buffer_load_dwordx4 v240, s[16:19], s5 offen nt lds
    s_add_u32 m0, s6, 15360
    s_mov_b32 s5, 122880
    buffer_load_dwordx4 v240, s[16:19], s5 offen nt lds
    s_add_u32 m0, s6, 65536
    s_mov_b32 s5, 524288
    buffer_load_dwordx4 v240, s[16:19], s5 offen nt lds
    s_add_u32 m0, s6, 66560
    s_mov_b32 s5, 532480
    buffer_load_dwordx4 v240, s[16:19], s5 offen nt lds
    s_add_u32 m0, s6, 67584
    s_mov_b32 s5, 540672
    buffer_load_dwordx4 v240, s[16:19], s5 offen nt lds
    s_add_u32 m0, s6, 68608
    s_mov_b32 s5, 548864
    buffer_load_dwordx4 v240, s[16:19], s5 offen nt lds
    s_add_u32 m0, s6, 69632
    s_mov_b32 s5, 557056
    buffer_load_dwordx4 v240, s[16:19], s5 offen nt lds
    s_add_u32 m0, s6, 70656
    s_mov_b32 s5, 565248
    buffer_load_dwordx4 v240, s[16:19], s5 offen nt lds
    s_add_u32 m0, s6, 71680
    s_mov_b32 s5, 573440
    buffer_load_dwordx4 v240, s[16:19], s5 offen nt lds
    s_add_u32 m0, s6, 72704
    s_mov_b32 s5, 581632
    buffer_load_dwordx4 v240, s[16:19], s5 offen nt lds
    s_add_u32 m0, s6, 73728
    s_mov_b32 s5, 589824
    buffer_load_dwordx4 v240, s[16:19], s5 offen nt lds
    s_add_u32 m0, s6, 74752
    s_mov_b32 s5, 598016
    buffer_load_dwordx4 v240, s[16:19], s5 offen nt lds
    s_add_u32 m0, s6, 75776
    s_mov_b32 s5, 606208
    buffer_load_dwordx4 v240, s[16:19], s5 offen nt lds
    s_add_u32 m0, s6, 76800
    s_mov_b32 s5, 614400
    buffer_load_dwordx4 v240, s[16:19], s5 offen nt lds
    s_add_u32 m0, s6, 77824
    s_mov_b32 s5, 622592
    buffer_load_dwordx4 v240, s[16:19], s5 offen nt lds
    s_add_u32 m0, s6, 78848
    s_mov_b32 s5, 630784
    buffer_load_dwordx4 v240, s[16:19], s5 offen nt lds
    s_add_u32 m0, s6, 79872
    s_mov_b32 s5, 638976
    buffer_load_dwordx4 v240, s[16:19], s5 offen nt lds
    s_add_u32 m0, s6, 80896
    s_mov_b32 s5, 647168
    buffer_load_dwordx4 v240, s[16:19], s5 offen nt lds
    v_lshlrev_b32 v2, 4, v1
    v_mov_b32 v8, v2
    s_lshl_b32 s36, s24, 12
    s_lshl_b32 s4, s34, 16
    s_add_u32 s4, s4, s36
    v_add_u32 v9, s4, v2
    s_lshl_b32 s4, s34, 10
    s_add_u32 s4, s4, 92340224
    v_bfe_u32 v254, v1, 0, 3
    v_mul_u32_u24 v7, 128, v254
    v_add_u32 v7, s4, v7
    s_lshl_b32 s4, s35, 2
    s_add_u32 s4, s4, s24
    s_lshl_b32 s5, s4, 9
    s_lshl_b32 s94, s34, 7
    s_add_u32 s94, s94, s5
    s_add_u32 s94, s94, 92323840
    s_lshl_b32 s38, s4, 1
    s_and_b32 s5, s34, 1
    s_or_b32 s38, s38, s5
    s_lshl_b32 s4, s35, 22
    s_lshl_b32 s37, s34, 20
    s_add_u32 s37, s37, s4
    s_lshl_b32 s4, s24, 18
    s_add_u32 s37, s37, s4
    s_add_u32 s37, s37, 150994944
    s_mov_b32 s29, 16777216
    s_mov_b32 s28, 0
    s_mov_b32 s33, 0
    s_mov_b32 s39, 0
    v_mov_b32 v26, 0
    s_waitcnt vmcnt(16)
    s_barrier
    ds_read_b64_tr_b16 a[0:1], v242 offset:0
    ds_read_b64_tr_b16 a[2:3], v242 offset:1024
    ds_read_b64_tr_b16 a[4:5], v242 offset:8
    ds_read_b64_tr_b16 a[6:7], v242 offset:1032
    ds_read_b64_tr_b16 a[8:9], v242 offset:8192
    ds_read_b64_tr_b16 a[10:11], v242 offset:9216
    ds_read_b64_tr_b16 a[12:13], v242 offset:8200
    ds_read_b64_tr_b16 a[14:15], v242 offset:9224
    ds_read_b64_tr_b16 a[16:17], v242 offset:16384
    ds_read_b64_tr_b16 a[18:19], v242 offset:17408
    ds_read_b64_tr_b16 a[20:21], v242 offset:16392
    ds_read_b64_tr_b16 a[22:23], v242 offset:17416
    ds_read_b64_tr_b16 a[24:25], v242 offset:24576
    ds_read_b64_tr_b16 a[26:27], v242 offset:25600
    ds_read_b64_tr_b16 a[28:29], v242 offset:24584
    ds_read_b64_tr_b16 a[30:31], v242 offset:25608
    ds_read_b64_tr_b16 a[32:33], v242 offset:32768
    ds_read_b64_tr_b16 a[34:35], v242 offset:33792
    ds_read_b64_tr_b16 a[36:37], v242 offset:32776
    ds_read_b64_tr_b16 a[38:39], v242 offset:33800
    ds_read_b64_tr_b16 a[40:41], v242 offset:40960
    ds_read_b64_tr_b16 a[42:43], v242 offset:41984
    ds_read_b64_tr_b16 a[44:45], v242 offset:40968
    ds_read_b64_tr_b16 a[46:47], v242 offset:41992
    ds_read_b64_tr_b16 a[48:49], v242 offset:49152
    ds_read_b64_tr_b16 a[50:51], v242 offset:50176
    ds_read_b64_tr_b16 a[52:53], v242 offset:49160
    ds_read_b64_tr_b16 a[54:55], v242 offset:50184
    ds_read_b64_tr_b16 a[56:57], v242 offset:57344
    ds_read_b64_tr_b16 a[58:59], v242 offset:58368
    ds_read_b64_tr_b16 a[60:61], v242 offset:57352
    ds_read_b64_tr_b16 a[62:63], v242 offset:58376
    s_waitcnt lgkmcnt(0)
    s_barrier
    s_add_u32 m0, s6, 0
    s_mov_b32 s5, 1048576
    buffer_load_dwordx4 v240, s[16:19], s5 offen nt lds
    s_add_u32 m0, s6, 1024
    s_mov_b32 s5, 1056768
    buffer_load_dwordx4 v240, s[16:19], s5 offen nt lds
    s_add_u32 m0, s6, 2048
    s_mov_b32 s5, 1064960
    buffer_load_dwordx4 v240, s[16:19], s5 offen nt lds
    s_add_u32 m0, s6, 3072
    s_mov_b32 s5, 1073152
    buffer_load_dwordx4 v240, s[16:19], s5 offen nt lds
    s_add_u32 m0, s6, 4096
    s_mov_b32 s5, 1081344
    buffer_load_dwordx4 v240, s[16:19], s5 offen nt lds
    s_add_u32 m0, s6, 5120
    s_mov_b32 s5, 1089536
    buffer_load_dwordx4 v240, s[16:19], s5 offen nt lds
    s_add_u32 m0, s6, 6144
    s_mov_b32 s5, 1097728
    buffer_load_dwordx4 v240, s[16:19], s5 offen nt lds
    s_add_u32 m0, s6, 7168
    s_mov_b32 s5, 1105920
    buffer_load_dwordx4 v240, s[16:19], s5 offen nt lds
    s_add_u32 m0, s6, 8192
    s_mov_b32 s5, 1114112
    buffer_load_dwordx4 v240, s[16:19], s5 offen nt lds
    s_add_u32 m0, s6, 9216
    s_mov_b32 s5, 1122304
    buffer_load_dwordx4 v240, s[16:19], s5 offen nt lds
    s_add_u32 m0, s6, 10240
    s_mov_b32 s5, 1130496
    buffer_load_dwordx4 v240, s[16:19], s5 offen nt lds
    s_add_u32 m0, s6, 11264
    s_mov_b32 s5, 1138688
    buffer_load_dwordx4 v240, s[16:19], s5 offen nt lds
    s_add_u32 m0, s6, 12288
    s_mov_b32 s5, 1146880
    buffer_load_dwordx4 v240, s[16:19], s5 offen nt lds
    s_add_u32 m0, s6, 13312
    s_mov_b32 s5, 1155072
    buffer_load_dwordx4 v240, s[16:19], s5 offen nt lds
    s_add_u32 m0, s6, 14336
    s_mov_b32 s5, 1163264
    buffer_load_dwordx4 v240, s[16:19], s5 offen nt lds
    s_add_u32 m0, s6, 15360
    s_mov_b32 s5, 1171456
    buffer_load_dwordx4 v240, s[16:19], s5 offen nt lds
    s_waitcnt vmcnt(16)
    s_barrier
    ds_read_b64_tr_b16 a[64:65], v243 offset:0
    ds_read_b64_tr_b16 a[66:67], v243 offset:1024
    ds_read_b64_tr_b16 a[68:69], v243 offset:8
    ds_read_b64_tr_b16 a[70:71], v243 offset:1032
    ds_read_b64_tr_b16 a[72:73], v243 offset:8192
    ds_read_b64_tr_b16 a[74:75], v243 offset:9216
    ds_read_b64_tr_b16 a[76:77], v243 offset:8200
    ds_read_b64_tr_b16 a[78:79], v243 offset:9224
    ds_read_b64_tr_b16 a[80:81], v243 offset:16384
    ds_read_b64_tr_b16 a[82:83], v243 offset:17408
    ds_read_b64_tr_b16 a[84:85], v243 offset:16392
    ds_read_b64_tr_b16 a[86:87], v243 offset:17416
    ds_read_b64_tr_b16 a[88:89], v243 offset:24576
    ds_read_b64_tr_b16 a[90:91], v243 offset:25600
    ds_read_b64_tr_b16 a[92:93], v243 offset:24584
    ds_read_b64_tr_b16 a[94:95], v243 offset:25608
    ds_read_b64_tr_b16 a[96:97], v243 offset:32768
    ds_read_b64_tr_b16 a[98:99], v243 offset:33792
    ds_read_b64_tr_b16 a[100:101], v243 offset:32776
    ds_read_b64_tr_b16 a[102:103], v243 offset:33800
    ds_read_b64_tr_b16 a[104:105], v243 offset:40960
    ds_read_b64_tr_b16 a[106:107], v243 offset:41984
    ds_read_b64_tr_b16 a[108:109], v243 offset:40968
    ds_read_b64_tr_b16 a[110:111], v243 offset:41992
    ds_read_b64_tr_b16 a[112:113], v243 offset:49152
    ds_read_b64_tr_b16 a[114:115], v243 offset:50176
    ds_read_b64_tr_b16 a[116:117], v243 offset:49160
    ds_read_b64_tr_b16 a[118:119], v243 offset:50184
    ds_read_b64_tr_b16 a[120:121], v243 offset:57344
    ds_read_b64_tr_b16 a[122:123], v243 offset:58368
    ds_read_b64_tr_b16 a[124:125], v243 offset:57352
    ds_read_b64_tr_b16 a[126:127], v243 offset:58376
    s_waitcnt lgkmcnt(0)
    s_barrier
    s_add_u32 m0, s6, 65536
    s_mov_b32 s5, 1572864
    buffer_load_dwordx4 v240, s[16:19], s5 offen nt lds
    s_add_u32 m0, s6, 66560
    s_mov_b32 s5, 1581056
    buffer_load_dwordx4 v240, s[16:19], s5 offen nt lds
    s_add_u32 m0, s6, 67584
    s_mov_b32 s5, 1589248
    buffer_load_dwordx4 v240, s[16:19], s5 offen nt lds
    s_add_u32 m0, s6, 68608
    s_mov_b32 s5, 1597440
    buffer_load_dwordx4 v240, s[16:19], s5 offen nt lds
    s_add_u32 m0, s6, 69632
    s_mov_b32 s5, 1605632
    buffer_load_dwordx4 v240, s[16:19], s5 offen nt lds
    s_add_u32 m0, s6, 70656
    s_mov_b32 s5, 1613824
    buffer_load_dwordx4 v240, s[16:19], s5 offen nt lds
    s_add_u32 m0, s6, 71680
    s_mov_b32 s5, 1622016
    buffer_load_dwordx4 v240, s[16:19], s5 offen nt lds
    s_add_u32 m0, s6, 72704
    s_mov_b32 s5, 1630208
    buffer_load_dwordx4 v240, s[16:19], s5 offen nt lds
    s_add_u32 m0, s6, 73728
    s_mov_b32 s5, 1638400
    buffer_load_dwordx4 v240, s[16:19], s5 offen nt lds
    s_add_u32 m0, s6, 74752
    s_mov_b32 s5, 1646592
    buffer_load_dwordx4 v240, s[16:19], s5 offen nt lds
    s_add_u32 m0, s6, 75776
    s_mov_b32 s5, 1654784
    buffer_load_dwordx4 v240, s[16:19], s5 offen nt lds
    s_add_u32 m0, s6, 76800
    s_mov_b32 s5, 1662976
    buffer_load_dwordx4 v240, s[16:19], s5 offen nt lds
    s_add_u32 m0, s6, 77824
    s_mov_b32 s5, 1671168
    buffer_load_dwordx4 v240, s[16:19], s5 offen nt lds
    s_add_u32 m0, s6, 78848
    s_mov_b32 s5, 1679360
    buffer_load_dwordx4 v240, s[16:19], s5 offen nt lds
    s_add_u32 m0, s6, 79872
    s_mov_b32 s5, 1687552
    buffer_load_dwordx4 v240, s[16:19], s5 offen nt lds
    s_add_u32 m0, s6, 80896
    s_mov_b32 s5, 1695744
    buffer_load_dwordx4 v240, s[16:19], s5 offen nt lds
    s_waitcnt vmcnt(16)
    s_load_dwordx4 s[56:59], s[0:1], 8
    s_load_dwordx2 s[60:61], s[0:1], 24
    s_lshl_b32 s4, s99, 17
    s_lshl_b32 s5, s24, 9
    s_add_u32 s4, s4, s5
    v_bfe_u32 v254, v1, 5, 1
    v_mul_u32_u24 v10, 65536, v254
    v_bfe_u32 v254, v1, 0, 5
    v_mul_u32_u24 v254, 16, v254
    v_add_u32 v10, v10, v254
    v_add_u32 v10, s4, v10
    s_lshl_b32 s4, s24, 11
    v_bfe_u32 v254, v1, 0, 5
    v_mul_u32_u24 v11, 64, v254
    v_add_u32 v11, s4, v11
    s_waitcnt lgkmcnt(0)
    s_mov_b32 s44, s56
    s_and_b32 s45, s57, 0xffff
    s_mov_b32 s46, 0x400000
    s_mov_b32 s47, 0x00020000
    s_mov_b32 s48, s58
    s_and_b32 s49, s59, 0xffff
    s_mov_b32 s50, 0x400000
    s_mov_b32 s51, 0x00020000
    s_mov_b32 s52, s60
    s_and_b32 s53, s61, 0xffff
    s_mov_b32 s54, 0x2000
    s_mov_b32 s55, 0x00020000
    buffer_load_dwordx4 v[216:219], v11, s[52:55], 0 offen offset:0
    buffer_load_dwordx4 v[220:223], v11, s[52:55], 0 offen offset:16
    buffer_load_dwordx4 v[224:227], v11, s[52:55], 0 offen offset:32
    buffer_load_dwordx4 v[228:231], v11, s[52:55], 0 offen offset:48
    v_subrev_u32 v11, 6144, v10
    buffer_load_dwordx4 v[32:35], v11, s[44:47], 0 offen nt
    v_subrev_u32 v11, 4096, v10
    buffer_load_dwordx4 v[36:39], v11, s[44:47], 0 offen nt
    v_subrev_u32 v11, 2048, v10
    buffer_load_dwordx4 v[40:43], v11, s[44:47], 0 offen nt
    s_mov_b32 s4, 0
    buffer_load_dwordx4 v[44:47], v10, s[44:47], s4 offen offset:0 nt
    buffer_load_dwordx4 v[76:79], v10, s[48:51], s4 offen offset:0 nt
    buffer_load_dwordx4 v[48:51], v10, s[44:47], s4 offen offset:2048 nt
    buffer_load_dwordx4 v[80:83], v10, s[48:51], s4 offen offset:2048 nt
    s_mov_b32 s4, 4096
    buffer_load_dwordx4 v[52:55], v10, s[44:47], s4 offen offset:0 nt
    buffer_load_dwordx4 v[84:87], v10, s[48:51], s4 offen offset:0 nt
    buffer_load_dwordx4 v[56:59], v10, s[44:47], s4 offen offset:2048 nt
    buffer_load_dwordx4 v[88:91], v10, s[48:51], s4 offen offset:2048 nt
    s_mov_b32 s4, 8192
    buffer_load_dwordx4 v[60:63], v10, s[44:47], s4 offen offset:0 nt
    buffer_load_dwordx4 v[92:95], v10, s[48:51], s4 offen offset:0 nt
    buffer_load_dwordx4 v[64:67], v10, s[44:47], s4 offen offset:2048 nt
    buffer_load_dwordx4 v[96:99], v10, s[48:51], s4 offen offset:2048 nt
    s_mov_b32 s4, 12288
    buffer_load_dwordx4 v[68:71], v10, s[44:47], s4 offen offset:0 nt
    buffer_load_dwordx4 v[100:103], v10, s[48:51], s4 offen offset:0 nt
    buffer_load_dwordx4 v[72:75], v10, s[44:47], s4 offen offset:2048 nt
    buffer_load_dwordx4 v[104:107], v10, s[48:51], s4 offen offset:2048 nt
    v_add_u32 v10, 16384, v10
    v_subrev_u32 v11, 6144, v10
    buffer_load_dwordx4 v[108:111], v11, s[44:47], 0 offen nt
    v_subrev_u32 v11, 4096, v10
    buffer_load_dwordx4 v[112:115], v11, s[44:47], 0 offen nt
    v_subrev_u32 v11, 2048, v10
    buffer_load_dwordx4 v[116:119], v11, s[44:47], 0 offen nt
    s_mov_b32 s4, 0
    buffer_load_dwordx4 v[120:123], v10, s[44:47], s4 offen offset:0 nt
    buffer_load_dwordx4 v[152:155], v10, s[48:51], s4 offen offset:0 nt
    buffer_load_dwordx4 v[124:127], v10, s[44:47], s4 offen offset:2048 nt
    buffer_load_dwordx4 v[156:159], v10, s[48:51], s4 offen offset:2048 nt
    s_mov_b32 s4, 4096
    buffer_load_dwordx4 v[128:131], v10, s[44:47], s4 offen offset:0 nt
    buffer_load_dwordx4 v[160:163], v10, s[48:51], s4 offen offset:0 nt
    buffer_load_dwordx4 v[132:135], v10, s[44:47], s4 offen offset:2048 nt
    buffer_load_dwordx4 v[164:167], v10, s[48:51], s4 offen offset:2048 nt
    s_mov_b32 s4, 8192
    buffer_load_dwordx4 v[136:139], v10, s[44:47], s4 offen offset:0 nt
    buffer_load_dwordx4 v[168:171], v10, s[48:51], s4 offen offset:0 nt
    buffer_load_dwordx4 v[140:143], v10, s[44:47], s4 offen offset:2048 nt
    buffer_load_dwordx4 v[172:175], v10, s[48:51], s4 offen offset:2048 nt
    s_mov_b32 s4, 12288
    buffer_load_dwordx4 v[144:147], v10, s[44:47], s4 offen offset:0 nt
    buffer_load_dwordx4 v[176:179], v10, s[48:51], s4 offen offset:0 nt
    buffer_load_dwordx4 v[148:151], v10, s[44:47], s4 offen offset:2048 nt
    buffer_load_dwordx4 v[180:183], v10, s[48:51], s4 offen offset:2048 nt
    v_add_u32 v10, 16384, v10
    s_barrier
    ds_read_b64_tr_b16 a[128:129], v242 offset:0
    ds_read_b64_tr_b16 a[130:131], v242 offset:1024
    ds_read_b64_tr_b16 a[132:133], v242 offset:8
    ds_read_b64_tr_b16 a[134:135], v242 offset:1032
    ds_read_b64_tr_b16 a[136:137], v242 offset:8192
    ds_read_b64_tr_b16 a[138:139], v242 offset:9216
    ds_read_b64_tr_b16 a[140:141], v242 offset:8200
    ds_read_b64_tr_b16 a[142:143], v242 offset:9224
    ds_read_b64_tr_b16 a[144:145], v242 offset:16384
    ds_read_b64_tr_b16 a[146:147], v242 offset:17408
    ds_read_b64_tr_b16 a[148:149], v242 offset:16392
    ds_read_b64_tr_b16 a[150:151], v242 offset:17416
    ds_read_b64_tr_b16 a[152:153], v242 offset:24576
    ds_read_b64_tr_b16 a[154:155], v242 offset:25600
    ds_read_b64_tr_b16 a[156:157], v242 offset:24584
    ds_read_b64_tr_b16 a[158:159], v242 offset:25608
    ds_read_b64_tr_b16 a[160:161], v242 offset:32768
    ds_read_b64_tr_b16 a[162:163], v242 offset:33792
    ds_read_b64_tr_b16 a[164:165], v242 offset:32776
    ds_read_b64_tr_b16 a[166:167], v242 offset:33800
    ds_read_b64_tr_b16 a[168:169], v242 offset:40960
    ds_read_b64_tr_b16 a[170:171], v242 offset:41984
    ds_read_b64_tr_b16 a[172:173], v242 offset:40968
    ds_read_b64_tr_b16 a[174:175], v242 offset:41992
    ds_read_b64_tr_b16 a[176:177], v242 offset:49152
    ds_read_b64_tr_b16 a[178:179], v242 offset:50176
    ds_read_b64_tr_b16 a[180:181], v242 offset:49160
    ds_read_b64_tr_b16 a[182:183], v242 offset:50184
    ds_read_b64_tr_b16 a[184:185], v242 offset:57344
    ds_read_b64_tr_b16 a[186:187], v242 offset:58368
    ds_read_b64_tr_b16 a[188:189], v242 offset:57352
    ds_read_b64_tr_b16 a[190:191], v242 offset:58376
    s_waitcnt lgkmcnt(0)
    s_barrier
    s_waitcnt vmcnt(42)
    s_barrier
    ds_read_b64_tr_b16 a[192:193], v243 offset:0
    ds_read_b64_tr_b16 a[194:195], v243 offset:1024
    ds_read_b64_tr_b16 a[196:197], v243 offset:8
    ds_read_b64_tr_b16 a[198:199], v243 offset:1032
    ds_read_b64_tr_b16 a[200:201], v243 offset:8192
    ds_read_b64_tr_b16 a[202:203], v243 offset:9216
    ds_read_b64_tr_b16 a[204:205], v243 offset:8200
    ds_read_b64_tr_b16 a[206:207], v243 offset:9224
    ds_read_b64_tr_b16 a[208:209], v243 offset:16384
    ds_read_b64_tr_b16 a[210:211], v243 offset:17408
    ds_read_b64_tr_b16 a[212:213], v243 offset:16392
    ds_read_b64_tr_b16 a[214:215], v243 offset:17416
    ds_read_b64_tr_b16 a[216:217], v243 offset:24576
    ds_read_b64_tr_b16 a[218:219], v243 offset:25600
    ds_read_b64_tr_b16 a[220:221], v243 offset:24584
    ds_read_b64_tr_b16 a[222:223], v243 offset:25608
    ds_read_b64_tr_b16 a[224:225], v243 offset:32768
    ds_read_b64_tr_b16 a[226:227], v243 offset:33792
    ds_read_b64_tr_b16 a[228:229], v243 offset:32776
    ds_read_b64_tr_b16 a[230:231], v243 offset:33800
    ds_read_b64_tr_b16 a[232:233], v243 offset:40960
    ds_read_b64_tr_b16 a[234:235], v243 offset:41984
    ds_read_b64_tr_b16 a[236:237], v243 offset:40968
    ds_read_b64_tr_b16 a[238:239], v243 offset:41992
    ds_read_b64_tr_b16 a[240:241], v243 offset:49152
    ds_read_b64_tr_b16 a[242:243], v243 offset:50176
    ds_read_b64_tr_b16 a[244:245], v243 offset:49160
    ds_read_b64_tr_b16 a[246:247], v243 offset:50184
    ds_read_b64_tr_b16 a[248:249], v243 offset:57344
    ds_read_b64_tr_b16 a[250:251], v243 offset:58368
    ds_read_b64_tr_b16 a[252:253], v243 offset:57352
    ds_read_b64_tr_b16 a[254:255], v243 offset:58376
    s_waitcnt lgkmcnt(0)
    s_barrier
    s_lshl_b32 s5, s24, 15
    v_bfe_u32 v254, v1, 0, 3
    v_mul_u32_u24 v12, 16, v254
    v_bfe_u32 v254, v1, 5, 1
    v_mul_u32_u24 v13, 64, v254
    v_xor_b32 v12, v12, v13
    v_bfe_u32 v254, v1, 0, 5
    v_mul_u32_u24 v13, 1024, v254
    v_add_u32 v13, s5, v13
    v_add_u32 v13, v12, v13
    s_waitcnt vmcnt(38)
    v_lshlrev_b32 v184, 16, v216
    v_lshlrev_b32 v185, 16, v218
    v_and_b32 v186, 0xffff0000, v216
    v_and_b32 v187, 0xffff0000, v218
    v_lshlrev_b32 v188, 16, v217
    v_lshlrev_b32 v189, 16, v219
    v_and_b32 v190, 0xffff0000, v217
    v_and_b32 v191, 0xffff0000, v219
    v_lshlrev_b32 v192, 16, v220
    v_lshlrev_b32 v193, 16, v222
    v_and_b32 v194, 0xffff0000, v220
    v_and_b32 v195, 0xffff0000, v222
    v_lshlrev_b32 v196, 16, v221
    v_lshlrev_b32 v197, 16, v223
    v_and_b32 v198, 0xffff0000, v221
    v_and_b32 v199, 0xffff0000, v223
    v_lshlrev_b32 v200, 16, v224
    v_lshlrev_b32 v201, 16, v226
    v_and_b32 v202, 0xffff0000, v224
    v_and_b32 v203, 0xffff0000, v226
    v_lshlrev_b32 v204, 16, v225
    v_lshlrev_b32 v205, 16, v227
    v_and_b32 v206, 0xffff0000, v225
    v_and_b32 v207, 0xffff0000, v227
    v_lshlrev_b32 v208, 16, v228
    v_lshlrev_b32 v209, 16, v230
    v_and_b32 v210, 0xffff0000, v228
    v_and_b32 v211, 0xffff0000, v230
    v_lshlrev_b32 v212, 16, v229
    v_lshlrev_b32 v213, 16, v231
    v_and_b32 v214, 0xffff0000, v229
    v_and_b32 v215, 0xffff0000, v231
    v_xor_b32 v12, 0, v13
    s_waitcnt vmcnt(19)
    v_lshlrev_b32 v216, 16, v32
    v_and_b32 v217, 0xffff0000, v32
    v_lshlrev_b32 v218, 16, v36
    v_and_b32 v219, 0xffff0000, v36
    v_lshlrev_b32 v220, 16, v40
    v_and_b32 v221, 0xffff0000, v40
    v_lshlrev_b32 v222, 16, v44
    v_and_b32 v223, 0xffff0000, v44
    v_lshlrev_b32 v224, 16, v48
    v_and_b32 v225, 0xffff0000, v48
    v_lshlrev_b32 v226, 16, v52
    v_and_b32 v227, 0xffff0000, v52
    v_lshlrev_b32 v228, 16, v56
    v_and_b32 v229, 0xffff0000, v56
    v_lshlrev_b32 v230, 16, v60
    v_and_b32 v231, 0xffff0000, v60
    v_lshlrev_b32 v232, 16, v64
    v_and_b32 v233, 0xffff0000, v64
    v_lshlrev_b32 v234, 16, v68
    v_and_b32 v235, 0xffff0000, v68
    v_lshlrev_b32 v236, 16, v72
    v_and_b32 v237, 0xffff0000, v72
    v_pk_mul_f32 v[216:217], v[216:217], v[190:191]
    v_lshlrev_b32 v238, 16, v76
    v_pk_fma_f32 v[216:217], v[218:219], v[188:189], v[216:217]
    v_and_b32 v239, 0xffff0000, v76
    v_pk_fma_f32 v[216:217], v[220:221], v[186:187], v[216:217]
    v_pk_fma_f32 v[216:217], v[222:223], v[184:185], v[216:217]
    v_pk_mul_f32 v[216:217], v[216:217], v[238:239]
    v_pk_mul_f32 v[218:219], v[218:219], v[190:191]
    v_lshlrev_b32 v240, 16, v80
    v_pk_fma_f32 v[218:219], v[220:221], v[188:189], v[218:219]
    v_and_b32 v241, 0xffff0000, v80
    v_pk_fma_f32 v[218:219], v[222:223], v[186:187], v[218:219]
    v_pk_fma_f32 v[218:219], v[224:225], v[184:185], v[218:219]
    v_pk_mul_f32 v[218:219], v[218:219], v[240:241]
    v_pk_mul_f32 v[220:221], v[220:221], v[190:191]
    v_lshlrev_b32 v238, 16, v84
    v_pk_fma_f32 v[220:221], v[222:223], v[188:189], v[220:221]
    v_and_b32 v239, 0xffff0000, v84
    v_pk_fma_f32 v[220:221], v[224:225], v[186:187], v[220:221]
    v_pk_fma_f32 v[220:221], v[226:227], v[184:185], v[220:221]
    v_pk_mul_f32 v[220:221], v[220:221], v[238:239]
    v_pk_mul_f32 v[222:223], v[222:223], v[190:191]
    v_lshlrev_b32 v240, 16, v88
    v_pk_fma_f32 v[222:223], v[224:225], v[188:189], v[222:223]
    v_and_b32 v241, 0xffff0000, v88
    v_pk_fma_f32 v[222:223], v[226:227], v[186:187], v[222:223]
    v_pk_fma_f32 v[222:223], v[228:229], v[184:185], v[222:223]
    v_pk_mul_f32 v[222:223], v[222:223], v[240:241]
    v_pk_mul_f32 v[224:225], v[224:225], v[190:191]
    v_lshlrev_b32 v238, 16, v92
    v_pk_fma_f32 v[224:225], v[226:227], v[188:189], v[224:225]
    v_and_b32 v239, 0xffff0000, v92
    v_pk_fma_f32 v[224:225], v[228:229], v[186:187], v[224:225]
    v_pk_fma_f32 v[224:225], v[230:231], v[184:185], v[224:225]
    v_pk_mul_f32 v[224:225], v[224:225], v[238:239]
    v_pk_mul_f32 v[226:227], v[226:227], v[190:191]
    v_lshlrev_b32 v240, 16, v96
    v_pk_fma_f32 v[226:227], v[228:229], v[188:189], v[226:227]
    v_and_b32 v241, 0xffff0000, v96
    v_pk_fma_f32 v[226:227], v[230:231], v[186:187], v[226:227]
    v_pk_fma_f32 v[226:227], v[232:233], v[184:185], v[226:227]
    v_pk_mul_f32 v[226:227], v[226:227], v[240:241]
    v_pk_mul_f32 v[228:229], v[228:229], v[190:191]
    v_lshlrev_b32 v238, 16, v100
    v_pk_fma_f32 v[228:229], v[230:231], v[188:189], v[228:229]
    v_and_b32 v239, 0xffff0000, v100
    v_pk_fma_f32 v[228:229], v[232:233], v[186:187], v[228:229]
    v_pk_fma_f32 v[228:229], v[234:235], v[184:185], v[228:229]
    v_pk_mul_f32 v[228:229], v[228:229], v[238:239]
    v_pk_mul_f32 v[230:231], v[230:231], v[190:191]
    v_lshlrev_b32 v240, 16, v104
    v_pk_fma_f32 v[230:231], v[232:233], v[188:189], v[230:231]
    v_and_b32 v241, 0xffff0000, v104
    v_pk_fma_f32 v[230:231], v[234:235], v[186:187], v[230:231]
    v_pk_fma_f32 v[230:231], v[236:237], v[184:185], v[230:231]
    v_pk_mul_f32 v[230:231], v[230:231], v[240:241]
    v_cvt_pk_bf16_f32 v242, v230, v228
    v_cvt_pk_bf16_f32 v243, v226, v224
    v_cvt_pk_bf16_f32 v244, v222, v220
    v_cvt_pk_bf16_f32 v245, v218, v216
    ds_write_b128 v12, v[242:245] offset:0
    v_cvt_pk_bf16_f32 v246, v231, v229
    v_cvt_pk_bf16_f32 v247, v227, v225
    v_cvt_pk_bf16_f32 v248, v223, v221
    v_cvt_pk_bf16_f32 v249, v219, v217
    ds_write_b128 v12, v[246:249] offset:128
    v_lshlrev_b32 v216, 16, v33
    v_and_b32 v217, 0xffff0000, v33
    v_lshlrev_b32 v218, 16, v37
    v_and_b32 v219, 0xffff0000, v37
    v_lshlrev_b32 v220, 16, v41
    v_and_b32 v221, 0xffff0000, v41
    v_lshlrev_b32 v222, 16, v45
    v_and_b32 v223, 0xffff0000, v45
    v_lshlrev_b32 v224, 16, v49
    v_and_b32 v225, 0xffff0000, v49
    v_lshlrev_b32 v226, 16, v53
    v_and_b32 v227, 0xffff0000, v53
    v_lshlrev_b32 v228, 16, v57
    v_and_b32 v229, 0xffff0000, v57
    v_lshlrev_b32 v230, 16, v61
    v_and_b32 v231, 0xffff0000, v61
    v_lshlrev_b32 v232, 16, v65
    v_and_b32 v233, 0xffff0000, v65
    v_lshlrev_b32 v234, 16, v69
    v_and_b32 v235, 0xffff0000, v69
    v_lshlrev_b32 v236, 16, v73
    v_and_b32 v237, 0xffff0000, v73
    v_pk_mul_f32 v[216:217], v[216:217], v[198:199]
    v_lshlrev_b32 v238, 16, v77
    v_pk_fma_f32 v[216:217], v[218:219], v[196:197], v[216:217]
    v_and_b32 v239, 0xffff0000, v77
    v_pk_fma_f32 v[216:217], v[220:221], v[194:195], v[216:217]
    v_pk_fma_f32 v[216:217], v[222:223], v[192:193], v[216:217]
    v_pk_mul_f32 v[216:217], v[216:217], v[238:239]
    v_pk_mul_f32 v[218:219], v[218:219], v[198:199]
    v_lshlrev_b32 v240, 16, v81
    v_pk_fma_f32 v[218:219], v[220:221], v[196:197], v[218:219]
    v_and_b32 v241, 0xffff0000, v81
    v_pk_fma_f32 v[218:219], v[222:223], v[194:195], v[218:219]
    v_pk_fma_f32 v[218:219], v[224:225], v[192:193], v[218:219]
    v_pk_mul_f32 v[218:219], v[218:219], v[240:241]
    v_pk_mul_f32 v[220:221], v[220:221], v[198:199]
    v_lshlrev_b32 v238, 16, v85
    v_pk_fma_f32 v[220:221], v[222:223], v[196:197], v[220:221]
    v_and_b32 v239, 0xffff0000, v85
    v_pk_fma_f32 v[220:221], v[224:225], v[194:195], v[220:221]
    v_pk_fma_f32 v[220:221], v[226:227], v[192:193], v[220:221]
    v_pk_mul_f32 v[220:221], v[220:221], v[238:239]
    v_pk_mul_f32 v[222:223], v[222:223], v[198:199]
    v_lshlrev_b32 v240, 16, v89
    v_pk_fma_f32 v[222:223], v[224:225], v[196:197], v[222:223]
    v_and_b32 v241, 0xffff0000, v89
    v_pk_fma_f32 v[222:223], v[226:227], v[194:195], v[222:223]
    v_pk_fma_f32 v[222:223], v[228:229], v[192:193], v[222:223]
    v_pk_mul_f32 v[222:223], v[222:223], v[240:241]
    v_pk_mul_f32 v[224:225], v[224:225], v[198:199]
    v_lshlrev_b32 v238, 16, v93
    v_pk_fma_f32 v[224:225], v[226:227], v[196:197], v[224:225]
    v_and_b32 v239, 0xffff0000, v93
    v_pk_fma_f32 v[224:225], v[228:229], v[194:195], v[224:225]
    v_pk_fma_f32 v[224:225], v[230:231], v[192:193], v[224:225]
    v_pk_mul_f32 v[224:225], v[224:225], v[238:239]
    v_pk_mul_f32 v[226:227], v[226:227], v[198:199]
    v_lshlrev_b32 v240, 16, v97
    v_pk_fma_f32 v[226:227], v[228:229], v[196:197], v[226:227]
    v_and_b32 v241, 0xffff0000, v97
    v_pk_fma_f32 v[226:227], v[230:231], v[194:195], v[226:227]
    v_pk_fma_f32 v[226:227], v[232:233], v[192:193], v[226:227]
    v_pk_mul_f32 v[226:227], v[226:227], v[240:241]
    v_pk_mul_f32 v[228:229], v[228:229], v[198:199]
    v_lshlrev_b32 v238, 16, v101
    v_pk_fma_f32 v[228:229], v[230:231], v[196:197], v[228:229]
    v_and_b32 v239, 0xffff0000, v101
    v_pk_fma_f32 v[228:229], v[232:233], v[194:195], v[228:229]
    v_pk_fma_f32 v[228:229], v[234:235], v[192:193], v[228:229]
    v_pk_mul_f32 v[228:229], v[228:229], v[238:239]
    v_pk_mul_f32 v[230:231], v[230:231], v[198:199]
    v_lshlrev_b32 v240, 16, v105
    v_pk_fma_f32 v[230:231], v[232:233], v[196:197], v[230:231]
    v_and_b32 v241, 0xffff0000, v105
    v_pk_fma_f32 v[230:231], v[234:235], v[194:195], v[230:231]
    v_pk_fma_f32 v[230:231], v[236:237], v[192:193], v[230:231]
    v_pk_mul_f32 v[230:231], v[230:231], v[240:241]
    v_cvt_pk_bf16_f32 v242, v230, v228
    v_cvt_pk_bf16_f32 v243, v226, v224
    v_cvt_pk_bf16_f32 v244, v222, v220
    v_cvt_pk_bf16_f32 v245, v218, v216
    ds_write_b128 v12, v[242:245] offset:256
    v_cvt_pk_bf16_f32 v246, v231, v229
    v_cvt_pk_bf16_f32 v247, v227, v225
    v_cvt_pk_bf16_f32 v248, v223, v221
    v_cvt_pk_bf16_f32 v249, v219, v217
    ds_write_b128 v12, v[246:249] offset:384
    v_lshlrev_b32 v216, 16, v34
    v_and_b32 v217, 0xffff0000, v34
    v_lshlrev_b32 v218, 16, v38
    v_and_b32 v219, 0xffff0000, v38
    v_lshlrev_b32 v220, 16, v42
    v_and_b32 v221, 0xffff0000, v42
    v_lshlrev_b32 v222, 16, v46
    v_and_b32 v223, 0xffff0000, v46
    v_lshlrev_b32 v224, 16, v50
    v_and_b32 v225, 0xffff0000, v50
    v_lshlrev_b32 v226, 16, v54
    v_and_b32 v227, 0xffff0000, v54
    v_lshlrev_b32 v228, 16, v58
    v_and_b32 v229, 0xffff0000, v58
    v_lshlrev_b32 v230, 16, v62
    v_and_b32 v231, 0xffff0000, v62
    v_lshlrev_b32 v232, 16, v66
    v_and_b32 v233, 0xffff0000, v66
    v_lshlrev_b32 v234, 16, v70
    v_and_b32 v235, 0xffff0000, v70
    v_lshlrev_b32 v236, 16, v74
    v_and_b32 v237, 0xffff0000, v74
    v_pk_mul_f32 v[216:217], v[216:217], v[206:207]
    v_lshlrev_b32 v238, 16, v78
    v_pk_fma_f32 v[216:217], v[218:219], v[204:205], v[216:217]
    v_and_b32 v239, 0xffff0000, v78
    v_pk_fma_f32 v[216:217], v[220:221], v[202:203], v[216:217]
    v_pk_fma_f32 v[216:217], v[222:223], v[200:201], v[216:217]
    v_pk_mul_f32 v[216:217], v[216:217], v[238:239]
    v_pk_mul_f32 v[218:219], v[218:219], v[206:207]
    v_lshlrev_b32 v240, 16, v82
    v_pk_fma_f32 v[218:219], v[220:221], v[204:205], v[218:219]
    v_and_b32 v241, 0xffff0000, v82
    v_pk_fma_f32 v[218:219], v[222:223], v[202:203], v[218:219]
    v_pk_fma_f32 v[218:219], v[224:225], v[200:201], v[218:219]
    v_pk_mul_f32 v[218:219], v[218:219], v[240:241]
    v_pk_mul_f32 v[220:221], v[220:221], v[206:207]
    v_lshlrev_b32 v238, 16, v86
    v_pk_fma_f32 v[220:221], v[222:223], v[204:205], v[220:221]
    v_and_b32 v239, 0xffff0000, v86
    v_pk_fma_f32 v[220:221], v[224:225], v[202:203], v[220:221]
    v_pk_fma_f32 v[220:221], v[226:227], v[200:201], v[220:221]
    v_pk_mul_f32 v[220:221], v[220:221], v[238:239]
    v_pk_mul_f32 v[222:223], v[222:223], v[206:207]
    v_lshlrev_b32 v240, 16, v90
    v_pk_fma_f32 v[222:223], v[224:225], v[204:205], v[222:223]
    v_and_b32 v241, 0xffff0000, v90
    v_pk_fma_f32 v[222:223], v[226:227], v[202:203], v[222:223]
    v_pk_fma_f32 v[222:223], v[228:229], v[200:201], v[222:223]
    v_pk_mul_f32 v[222:223], v[222:223], v[240:241]
    v_pk_mul_f32 v[224:225], v[224:225], v[206:207]
    v_lshlrev_b32 v238, 16, v94
    v_pk_fma_f32 v[224:225], v[226:227], v[204:205], v[224:225]
    v_and_b32 v239, 0xffff0000, v94
    v_pk_fma_f32 v[224:225], v[228:229], v[202:203], v[224:225]
    v_pk_fma_f32 v[224:225], v[230:231], v[200:201], v[224:225]
    v_pk_mul_f32 v[224:225], v[224:225], v[238:239]
    v_pk_mul_f32 v[226:227], v[226:227], v[206:207]
    v_lshlrev_b32 v240, 16, v98
    v_pk_fma_f32 v[226:227], v[228:229], v[204:205], v[226:227]
    v_and_b32 v241, 0xffff0000, v98
    v_pk_fma_f32 v[226:227], v[230:231], v[202:203], v[226:227]
    v_pk_fma_f32 v[226:227], v[232:233], v[200:201], v[226:227]
    v_pk_mul_f32 v[226:227], v[226:227], v[240:241]
    v_pk_mul_f32 v[228:229], v[228:229], v[206:207]
    v_lshlrev_b32 v238, 16, v102
    v_pk_fma_f32 v[228:229], v[230:231], v[204:205], v[228:229]
    v_and_b32 v239, 0xffff0000, v102
    v_pk_fma_f32 v[228:229], v[232:233], v[202:203], v[228:229]
    v_pk_fma_f32 v[228:229], v[234:235], v[200:201], v[228:229]
    v_pk_mul_f32 v[228:229], v[228:229], v[238:239]
    v_pk_mul_f32 v[230:231], v[230:231], v[206:207]
    v_lshlrev_b32 v240, 16, v106
    v_pk_fma_f32 v[230:231], v[232:233], v[204:205], v[230:231]
    v_and_b32 v241, 0xffff0000, v106
    v_pk_fma_f32 v[230:231], v[234:235], v[202:203], v[230:231]
    v_pk_fma_f32 v[230:231], v[236:237], v[200:201], v[230:231]
    v_pk_mul_f32 v[230:231], v[230:231], v[240:241]
    v_cvt_pk_bf16_f32 v242, v230, v228
    v_cvt_pk_bf16_f32 v243, v226, v224
    v_cvt_pk_bf16_f32 v244, v222, v220
    v_cvt_pk_bf16_f32 v245, v218, v216
    ds_write_b128 v12, v[242:245] offset:512
    v_cvt_pk_bf16_f32 v246, v231, v229
    v_cvt_pk_bf16_f32 v247, v227, v225
    v_cvt_pk_bf16_f32 v248, v223, v221
    v_cvt_pk_bf16_f32 v249, v219, v217
    ds_write_b128 v12, v[246:249] offset:640
    v_lshlrev_b32 v216, 16, v35
    v_and_b32 v217, 0xffff0000, v35
    v_lshlrev_b32 v218, 16, v39
    v_and_b32 v219, 0xffff0000, v39
    v_lshlrev_b32 v220, 16, v43
    v_and_b32 v221, 0xffff0000, v43
    v_lshlrev_b32 v222, 16, v47
    v_and_b32 v223, 0xffff0000, v47
    v_lshlrev_b32 v224, 16, v51
    v_and_b32 v225, 0xffff0000, v51
    v_lshlrev_b32 v226, 16, v55
    v_and_b32 v227, 0xffff0000, v55
    v_lshlrev_b32 v228, 16, v59
    v_and_b32 v229, 0xffff0000, v59
    v_lshlrev_b32 v230, 16, v63
    v_and_b32 v231, 0xffff0000, v63
    v_lshlrev_b32 v232, 16, v67
    v_and_b32 v233, 0xffff0000, v67
    v_lshlrev_b32 v234, 16, v71
    v_and_b32 v235, 0xffff0000, v71
    v_lshlrev_b32 v236, 16, v75
    v_and_b32 v237, 0xffff0000, v75
    v_pk_mul_f32 v[216:217], v[216:217], v[214:215]
    v_lshlrev_b32 v238, 16, v79
    v_pk_fma_f32 v[216:217], v[218:219], v[212:213], v[216:217]
    v_and_b32 v239, 0xffff0000, v79
    v_pk_fma_f32 v[216:217], v[220:221], v[210:211], v[216:217]
    v_pk_fma_f32 v[216:217], v[222:223], v[208:209], v[216:217]
    v_pk_mul_f32 v[216:217], v[216:217], v[238:239]
    v_pk_mul_f32 v[218:219], v[218:219], v[214:215]
    v_lshlrev_b32 v240, 16, v83
    v_pk_fma_f32 v[218:219], v[220:221], v[212:213], v[218:219]
    v_and_b32 v241, 0xffff0000, v83
    v_pk_fma_f32 v[218:219], v[222:223], v[210:211], v[218:219]
    v_pk_fma_f32 v[218:219], v[224:225], v[208:209], v[218:219]
    v_pk_mul_f32 v[218:219], v[218:219], v[240:241]
    v_pk_mul_f32 v[220:221], v[220:221], v[214:215]
    v_lshlrev_b32 v238, 16, v87
    v_pk_fma_f32 v[220:221], v[222:223], v[212:213], v[220:221]
    v_and_b32 v239, 0xffff0000, v87
    v_pk_fma_f32 v[220:221], v[224:225], v[210:211], v[220:221]
    v_pk_fma_f32 v[220:221], v[226:227], v[208:209], v[220:221]
    v_pk_mul_f32 v[220:221], v[220:221], v[238:239]
    v_pk_mul_f32 v[222:223], v[222:223], v[214:215]
    v_lshlrev_b32 v240, 16, v91
    v_pk_fma_f32 v[222:223], v[224:225], v[212:213], v[222:223]
    v_and_b32 v241, 0xffff0000, v91
    v_pk_fma_f32 v[222:223], v[226:227], v[210:211], v[222:223]
    v_pk_fma_f32 v[222:223], v[228:229], v[208:209], v[222:223]
    v_pk_mul_f32 v[222:223], v[222:223], v[240:241]
    v_pk_mul_f32 v[224:225], v[224:225], v[214:215]
    v_lshlrev_b32 v238, 16, v95
    v_pk_fma_f32 v[224:225], v[226:227], v[212:213], v[224:225]
    v_and_b32 v239, 0xffff0000, v95
    v_pk_fma_f32 v[224:225], v[228:229], v[210:211], v[224:225]
    v_pk_fma_f32 v[224:225], v[230:231], v[208:209], v[224:225]
    v_pk_mul_f32 v[224:225], v[224:225], v[238:239]
    v_pk_mul_f32 v[226:227], v[226:227], v[214:215]
    v_lshlrev_b32 v240, 16, v99
    v_pk_fma_f32 v[226:227], v[228:229], v[212:213], v[226:227]
    v_and_b32 v241, 0xffff0000, v99
    v_pk_fma_f32 v[226:227], v[230:231], v[210:211], v[226:227]
    v_pk_fma_f32 v[226:227], v[232:233], v[208:209], v[226:227]
    v_pk_mul_f32 v[226:227], v[226:227], v[240:241]
    v_pk_mul_f32 v[228:229], v[228:229], v[214:215]
    v_lshlrev_b32 v238, 16, v103
    v_pk_fma_f32 v[228:229], v[230:231], v[212:213], v[228:229]
    v_and_b32 v239, 0xffff0000, v103
    v_pk_fma_f32 v[228:229], v[232:233], v[210:211], v[228:229]
    v_pk_fma_f32 v[228:229], v[234:235], v[208:209], v[228:229]
    v_pk_mul_f32 v[228:229], v[228:229], v[238:239]
    v_pk_mul_f32 v[230:231], v[230:231], v[214:215]
    v_lshlrev_b32 v240, 16, v107
    v_pk_fma_f32 v[230:231], v[232:233], v[212:213], v[230:231]
    v_and_b32 v241, 0xffff0000, v107
    v_pk_fma_f32 v[230:231], v[234:235], v[210:211], v[230:231]
    v_pk_fma_f32 v[230:231], v[236:237], v[208:209], v[230:231]
    v_pk_mul_f32 v[230:231], v[230:231], v[240:241]
    v_cvt_pk_bf16_f32 v242, v230, v228
    v_cvt_pk_bf16_f32 v243, v226, v224
    v_cvt_pk_bf16_f32 v244, v222, v220
    v_cvt_pk_bf16_f32 v245, v218, v216
    ds_write_b128 v12, v[242:245] offset:768
    v_cvt_pk_bf16_f32 v246, v231, v229
    v_cvt_pk_bf16_f32 v247, v227, v225
    v_cvt_pk_bf16_f32 v248, v223, v221
    v_cvt_pk_bf16_f32 v249, v219, v217
    ds_write_b128 v12, v[246:249] offset:896
    v_subrev_u32 v11, 6144, v10
    buffer_load_dwordx4 v[32:35], v11, s[44:47], 0 offen nt
    v_subrev_u32 v11, 4096, v10
    buffer_load_dwordx4 v[36:39], v11, s[44:47], 0 offen nt
    v_subrev_u32 v11, 2048, v10
    buffer_load_dwordx4 v[40:43], v11, s[44:47], 0 offen nt
    s_mov_b32 s4, 0
    buffer_load_dwordx4 v[44:47], v10, s[44:47], s4 offen offset:0 nt
    buffer_load_dwordx4 v[76:79], v10, s[48:51], s4 offen offset:0 nt
    buffer_load_dwordx4 v[48:51], v10, s[44:47], s4 offen offset:2048 nt
    buffer_load_dwordx4 v[80:83], v10, s[48:51], s4 offen offset:2048 nt
    s_mov_b32 s4, 4096
    buffer_load_dwordx4 v[52:55], v10, s[44:47], s4 offen offset:0 nt
    buffer_load_dwordx4 v[84:87], v10, s[48:51], s4 offen offset:0 nt
    buffer_load_dwordx4 v[56:59], v10, s[44:47], s4 offen offset:2048 nt
    buffer_load_dwordx4 v[88:91], v10, s[48:51], s4 offen offset:2048 nt
    s_mov_b32 s4, 8192
    buffer_load_dwordx4 v[60:63], v10, s[44:47], s4 offen offset:0 nt
    buffer_load_dwordx4 v[92:95], v10, s[48:51], s4 offen offset:0 nt
    buffer_load_dwordx4 v[64:67], v10, s[44:47], s4 offen offset:2048 nt
    buffer_load_dwordx4 v[96:99], v10, s[48:51], s4 offen offset:2048 nt
    s_mov_b32 s4, 12288
    buffer_load_dwordx4 v[68:71], v10, s[44:47], s4 offen offset:0 nt
    buffer_load_dwordx4 v[100:103], v10, s[48:51], s4 offen offset:0 nt
    buffer_load_dwordx4 v[72:75], v10, s[44:47], s4 offen offset:2048 nt
    buffer_load_dwordx4 v[104:107], v10, s[48:51], s4 offen offset:2048 nt
    v_add_u32 v10, 16384, v10
    v_xor_b32 v12, 16, v13
    s_waitcnt vmcnt(19)
    v_lshlrev_b32 v216, 16, v108
    v_and_b32 v217, 0xffff0000, v108
    v_lshlrev_b32 v218, 16, v112
    v_and_b32 v219, 0xffff0000, v112
    v_lshlrev_b32 v220, 16, v116
    v_and_b32 v221, 0xffff0000, v116
    v_lshlrev_b32 v222, 16, v120
    v_and_b32 v223, 0xffff0000, v120
    v_lshlrev_b32 v224, 16, v124
    v_and_b32 v225, 0xffff0000, v124
    v_lshlrev_b32 v226, 16, v128
    v_and_b32 v227, 0xffff0000, v128
    v_lshlrev_b32 v228, 16, v132
    v_and_b32 v229, 0xffff0000, v132
    v_lshlrev_b32 v230, 16, v136
    v_and_b32 v231, 0xffff0000, v136
    v_lshlrev_b32 v232, 16, v140
    v_and_b32 v233, 0xffff0000, v140
    v_lshlrev_b32 v234, 16, v144
    v_and_b32 v235, 0xffff0000, v144
    v_lshlrev_b32 v236, 16, v148
    v_and_b32 v237, 0xffff0000, v148
    v_pk_mul_f32 v[216:217], v[216:217], v[190:191]
    v_lshlrev_b32 v238, 16, v152
    v_pk_fma_f32 v[216:217], v[218:219], v[188:189], v[216:217]
    v_and_b32 v239, 0xffff0000, v152
    v_pk_fma_f32 v[216:217], v[220:221], v[186:187], v[216:217]
    v_pk_fma_f32 v[216:217], v[222:223], v[184:185], v[216:217]
    v_pk_mul_f32 v[216:217], v[216:217], v[238:239]
    v_pk_mul_f32 v[218:219], v[218:219], v[190:191]
    v_lshlrev_b32 v240, 16, v156
    v_pk_fma_f32 v[218:219], v[220:221], v[188:189], v[218:219]
    v_and_b32 v241, 0xffff0000, v156
    v_pk_fma_f32 v[218:219], v[222:223], v[186:187], v[218:219]
    v_pk_fma_f32 v[218:219], v[224:225], v[184:185], v[218:219]
    v_pk_mul_f32 v[218:219], v[218:219], v[240:241]
    v_pk_mul_f32 v[220:221], v[220:221], v[190:191]
    v_lshlrev_b32 v238, 16, v160
    v_pk_fma_f32 v[220:221], v[222:223], v[188:189], v[220:221]
    v_and_b32 v239, 0xffff0000, v160
    v_pk_fma_f32 v[220:221], v[224:225], v[186:187], v[220:221]
    v_pk_fma_f32 v[220:221], v[226:227], v[184:185], v[220:221]
    v_pk_mul_f32 v[220:221], v[220:221], v[238:239]
    v_pk_mul_f32 v[222:223], v[222:223], v[190:191]
    v_lshlrev_b32 v240, 16, v164
    v_pk_fma_f32 v[222:223], v[224:225], v[188:189], v[222:223]
    v_and_b32 v241, 0xffff0000, v164
    v_pk_fma_f32 v[222:223], v[226:227], v[186:187], v[222:223]
    v_pk_fma_f32 v[222:223], v[228:229], v[184:185], v[222:223]
    v_pk_mul_f32 v[222:223], v[222:223], v[240:241]
    v_pk_mul_f32 v[224:225], v[224:225], v[190:191]
    v_lshlrev_b32 v238, 16, v168
    v_pk_fma_f32 v[224:225], v[226:227], v[188:189], v[224:225]
    v_and_b32 v239, 0xffff0000, v168
    v_pk_fma_f32 v[224:225], v[228:229], v[186:187], v[224:225]
    v_pk_fma_f32 v[224:225], v[230:231], v[184:185], v[224:225]
    v_pk_mul_f32 v[224:225], v[224:225], v[238:239]
    v_pk_mul_f32 v[226:227], v[226:227], v[190:191]
    v_lshlrev_b32 v240, 16, v172
    v_pk_fma_f32 v[226:227], v[228:229], v[188:189], v[226:227]
    v_and_b32 v241, 0xffff0000, v172
    v_pk_fma_f32 v[226:227], v[230:231], v[186:187], v[226:227]
    v_pk_fma_f32 v[226:227], v[232:233], v[184:185], v[226:227]
    v_pk_mul_f32 v[226:227], v[226:227], v[240:241]
    v_pk_mul_f32 v[228:229], v[228:229], v[190:191]
    v_lshlrev_b32 v238, 16, v176
    v_pk_fma_f32 v[228:229], v[230:231], v[188:189], v[228:229]
    v_and_b32 v239, 0xffff0000, v176
    v_pk_fma_f32 v[228:229], v[232:233], v[186:187], v[228:229]
    v_pk_fma_f32 v[228:229], v[234:235], v[184:185], v[228:229]
    v_pk_mul_f32 v[228:229], v[228:229], v[238:239]
    v_pk_mul_f32 v[230:231], v[230:231], v[190:191]
    v_lshlrev_b32 v240, 16, v180
    v_pk_fma_f32 v[230:231], v[232:233], v[188:189], v[230:231]
    v_and_b32 v241, 0xffff0000, v180
    v_pk_fma_f32 v[230:231], v[234:235], v[186:187], v[230:231]
    v_pk_fma_f32 v[230:231], v[236:237], v[184:185], v[230:231]
    v_pk_mul_f32 v[230:231], v[230:231], v[240:241]
    v_cvt_pk_bf16_f32 v242, v230, v228
    v_cvt_pk_bf16_f32 v243, v226, v224
    v_cvt_pk_bf16_f32 v244, v222, v220
    v_cvt_pk_bf16_f32 v245, v218, v216
    ds_write_b128 v12, v[242:245] offset:0
    v_cvt_pk_bf16_f32 v246, v231, v229
    v_cvt_pk_bf16_f32 v247, v227, v225
    v_cvt_pk_bf16_f32 v248, v223, v221
    v_cvt_pk_bf16_f32 v249, v219, v217
    ds_write_b128 v12, v[246:249] offset:128
    v_lshlrev_b32 v216, 16, v109
    v_and_b32 v217, 0xffff0000, v109
    v_lshlrev_b32 v218, 16, v113
    v_and_b32 v219, 0xffff0000, v113
    v_lshlrev_b32 v220, 16, v117
    v_and_b32 v221, 0xffff0000, v117
    v_lshlrev_b32 v222, 16, v121
    v_and_b32 v223, 0xffff0000, v121
    v_lshlrev_b32 v224, 16, v125
    v_and_b32 v225, 0xffff0000, v125
    v_lshlrev_b32 v226, 16, v129
    v_and_b32 v227, 0xffff0000, v129
    v_lshlrev_b32 v228, 16, v133
    v_and_b32 v229, 0xffff0000, v133
    v_lshlrev_b32 v230, 16, v137
    v_and_b32 v231, 0xffff0000, v137
    v_lshlrev_b32 v232, 16, v141
    v_and_b32 v233, 0xffff0000, v141
    v_lshlrev_b32 v234, 16, v145
    v_and_b32 v235, 0xffff0000, v145
    v_lshlrev_b32 v236, 16, v149
    v_and_b32 v237, 0xffff0000, v149
    v_pk_mul_f32 v[216:217], v[216:217], v[198:199]
    v_lshlrev_b32 v238, 16, v153
    v_pk_fma_f32 v[216:217], v[218:219], v[196:197], v[216:217]
    v_and_b32 v239, 0xffff0000, v153
    v_pk_fma_f32 v[216:217], v[220:221], v[194:195], v[216:217]
    v_pk_fma_f32 v[216:217], v[222:223], v[192:193], v[216:217]
    v_pk_mul_f32 v[216:217], v[216:217], v[238:239]
    v_pk_mul_f32 v[218:219], v[218:219], v[198:199]
    v_lshlrev_b32 v240, 16, v157
    v_pk_fma_f32 v[218:219], v[220:221], v[196:197], v[218:219]
    v_and_b32 v241, 0xffff0000, v157
    v_pk_fma_f32 v[218:219], v[222:223], v[194:195], v[218:219]
    v_pk_fma_f32 v[218:219], v[224:225], v[192:193], v[218:219]
    v_pk_mul_f32 v[218:219], v[218:219], v[240:241]
    v_pk_mul_f32 v[220:221], v[220:221], v[198:199]
    v_lshlrev_b32 v238, 16, v161
    v_pk_fma_f32 v[220:221], v[222:223], v[196:197], v[220:221]
    v_and_b32 v239, 0xffff0000, v161
    v_pk_fma_f32 v[220:221], v[224:225], v[194:195], v[220:221]
    v_pk_fma_f32 v[220:221], v[226:227], v[192:193], v[220:221]
    v_pk_mul_f32 v[220:221], v[220:221], v[238:239]
    v_pk_mul_f32 v[222:223], v[222:223], v[198:199]
    v_lshlrev_b32 v240, 16, v165
    v_pk_fma_f32 v[222:223], v[224:225], v[196:197], v[222:223]
    v_and_b32 v241, 0xffff0000, v165
    v_pk_fma_f32 v[222:223], v[226:227], v[194:195], v[222:223]
    v_pk_fma_f32 v[222:223], v[228:229], v[192:193], v[222:223]
    v_pk_mul_f32 v[222:223], v[222:223], v[240:241]
    v_pk_mul_f32 v[224:225], v[224:225], v[198:199]
    v_lshlrev_b32 v238, 16, v169
    v_pk_fma_f32 v[224:225], v[226:227], v[196:197], v[224:225]
    v_and_b32 v239, 0xffff0000, v169
    v_pk_fma_f32 v[224:225], v[228:229], v[194:195], v[224:225]
    v_pk_fma_f32 v[224:225], v[230:231], v[192:193], v[224:225]
    v_pk_mul_f32 v[224:225], v[224:225], v[238:239]
    v_pk_mul_f32 v[226:227], v[226:227], v[198:199]
    v_lshlrev_b32 v240, 16, v173
    v_pk_fma_f32 v[226:227], v[228:229], v[196:197], v[226:227]
    v_and_b32 v241, 0xffff0000, v173
    v_pk_fma_f32 v[226:227], v[230:231], v[194:195], v[226:227]
    v_pk_fma_f32 v[226:227], v[232:233], v[192:193], v[226:227]
    v_pk_mul_f32 v[226:227], v[226:227], v[240:241]
    v_pk_mul_f32 v[228:229], v[228:229], v[198:199]
    v_lshlrev_b32 v238, 16, v177
    v_pk_fma_f32 v[228:229], v[230:231], v[196:197], v[228:229]
    v_and_b32 v239, 0xffff0000, v177
    v_pk_fma_f32 v[228:229], v[232:233], v[194:195], v[228:229]
    v_pk_fma_f32 v[228:229], v[234:235], v[192:193], v[228:229]
    v_pk_mul_f32 v[228:229], v[228:229], v[238:239]
    v_pk_mul_f32 v[230:231], v[230:231], v[198:199]
    v_lshlrev_b32 v240, 16, v181
    v_pk_fma_f32 v[230:231], v[232:233], v[196:197], v[230:231]
    v_and_b32 v241, 0xffff0000, v181
    v_pk_fma_f32 v[230:231], v[234:235], v[194:195], v[230:231]
    v_pk_fma_f32 v[230:231], v[236:237], v[192:193], v[230:231]
    v_pk_mul_f32 v[230:231], v[230:231], v[240:241]
    v_cvt_pk_bf16_f32 v242, v230, v228
    v_cvt_pk_bf16_f32 v243, v226, v224
    v_cvt_pk_bf16_f32 v244, v222, v220
    v_cvt_pk_bf16_f32 v245, v218, v216
    ds_write_b128 v12, v[242:245] offset:256
    v_cvt_pk_bf16_f32 v246, v231, v229
    v_cvt_pk_bf16_f32 v247, v227, v225
    v_cvt_pk_bf16_f32 v248, v223, v221
    v_cvt_pk_bf16_f32 v249, v219, v217
    ds_write_b128 v12, v[246:249] offset:384
    v_lshlrev_b32 v216, 16, v110
    v_and_b32 v217, 0xffff0000, v110
    v_lshlrev_b32 v218, 16, v114
    v_and_b32 v219, 0xffff0000, v114
    v_lshlrev_b32 v220, 16, v118
    v_and_b32 v221, 0xffff0000, v118
    v_lshlrev_b32 v222, 16, v122
    v_and_b32 v223, 0xffff0000, v122
    v_lshlrev_b32 v224, 16, v126
    v_and_b32 v225, 0xffff0000, v126
    v_lshlrev_b32 v226, 16, v130
    v_and_b32 v227, 0xffff0000, v130
    v_lshlrev_b32 v228, 16, v134
    v_and_b32 v229, 0xffff0000, v134
    v_lshlrev_b32 v230, 16, v138
    v_and_b32 v231, 0xffff0000, v138
    v_lshlrev_b32 v232, 16, v142
    v_and_b32 v233, 0xffff0000, v142
    v_lshlrev_b32 v234, 16, v146
    v_and_b32 v235, 0xffff0000, v146
    v_lshlrev_b32 v236, 16, v150
    v_and_b32 v237, 0xffff0000, v150
    v_pk_mul_f32 v[216:217], v[216:217], v[206:207]
    v_lshlrev_b32 v238, 16, v154
    v_pk_fma_f32 v[216:217], v[218:219], v[204:205], v[216:217]
    v_and_b32 v239, 0xffff0000, v154
    v_pk_fma_f32 v[216:217], v[220:221], v[202:203], v[216:217]
    v_pk_fma_f32 v[216:217], v[222:223], v[200:201], v[216:217]
    v_pk_mul_f32 v[216:217], v[216:217], v[238:239]
    v_pk_mul_f32 v[218:219], v[218:219], v[206:207]
    v_lshlrev_b32 v240, 16, v158
    v_pk_fma_f32 v[218:219], v[220:221], v[204:205], v[218:219]
    v_and_b32 v241, 0xffff0000, v158
    v_pk_fma_f32 v[218:219], v[222:223], v[202:203], v[218:219]
    v_pk_fma_f32 v[218:219], v[224:225], v[200:201], v[218:219]
    v_pk_mul_f32 v[218:219], v[218:219], v[240:241]
    v_pk_mul_f32 v[220:221], v[220:221], v[206:207]
    v_lshlrev_b32 v238, 16, v162
    v_pk_fma_f32 v[220:221], v[222:223], v[204:205], v[220:221]
    v_and_b32 v239, 0xffff0000, v162
    v_pk_fma_f32 v[220:221], v[224:225], v[202:203], v[220:221]
    v_pk_fma_f32 v[220:221], v[226:227], v[200:201], v[220:221]
    v_pk_mul_f32 v[220:221], v[220:221], v[238:239]
    v_pk_mul_f32 v[222:223], v[222:223], v[206:207]
    v_lshlrev_b32 v240, 16, v166
    v_pk_fma_f32 v[222:223], v[224:225], v[204:205], v[222:223]
    v_and_b32 v241, 0xffff0000, v166
    v_pk_fma_f32 v[222:223], v[226:227], v[202:203], v[222:223]
    v_pk_fma_f32 v[222:223], v[228:229], v[200:201], v[222:223]
    v_pk_mul_f32 v[222:223], v[222:223], v[240:241]
    v_pk_mul_f32 v[224:225], v[224:225], v[206:207]
    v_lshlrev_b32 v238, 16, v170
    v_pk_fma_f32 v[224:225], v[226:227], v[204:205], v[224:225]
    v_and_b32 v239, 0xffff0000, v170
    v_pk_fma_f32 v[224:225], v[228:229], v[202:203], v[224:225]
    v_pk_fma_f32 v[224:225], v[230:231], v[200:201], v[224:225]
    v_pk_mul_f32 v[224:225], v[224:225], v[238:239]
    v_pk_mul_f32 v[226:227], v[226:227], v[206:207]
    v_lshlrev_b32 v240, 16, v174
    v_pk_fma_f32 v[226:227], v[228:229], v[204:205], v[226:227]
    v_and_b32 v241, 0xffff0000, v174
    v_pk_fma_f32 v[226:227], v[230:231], v[202:203], v[226:227]
    v_pk_fma_f32 v[226:227], v[232:233], v[200:201], v[226:227]
    v_pk_mul_f32 v[226:227], v[226:227], v[240:241]
    v_pk_mul_f32 v[228:229], v[228:229], v[206:207]
    v_lshlrev_b32 v238, 16, v178
    v_pk_fma_f32 v[228:229], v[230:231], v[204:205], v[228:229]
    v_and_b32 v239, 0xffff0000, v178
    v_pk_fma_f32 v[228:229], v[232:233], v[202:203], v[228:229]
    v_pk_fma_f32 v[228:229], v[234:235], v[200:201], v[228:229]
    v_pk_mul_f32 v[228:229], v[228:229], v[238:239]
    v_pk_mul_f32 v[230:231], v[230:231], v[206:207]
    v_lshlrev_b32 v240, 16, v182
    v_pk_fma_f32 v[230:231], v[232:233], v[204:205], v[230:231]
    v_and_b32 v241, 0xffff0000, v182
    v_pk_fma_f32 v[230:231], v[234:235], v[202:203], v[230:231]
    v_pk_fma_f32 v[230:231], v[236:237], v[200:201], v[230:231]
    v_pk_mul_f32 v[230:231], v[230:231], v[240:241]
    v_cvt_pk_bf16_f32 v242, v230, v228
    v_cvt_pk_bf16_f32 v243, v226, v224
    v_cvt_pk_bf16_f32 v244, v222, v220
    v_cvt_pk_bf16_f32 v245, v218, v216
    ds_write_b128 v12, v[242:245] offset:512
    v_cvt_pk_bf16_f32 v246, v231, v229
    v_cvt_pk_bf16_f32 v247, v227, v225
    v_cvt_pk_bf16_f32 v248, v223, v221
    v_cvt_pk_bf16_f32 v249, v219, v217
    ds_write_b128 v12, v[246:249] offset:640
    v_lshlrev_b32 v216, 16, v111
    v_and_b32 v217, 0xffff0000, v111
    v_lshlrev_b32 v218, 16, v115
    v_and_b32 v219, 0xffff0000, v115
    v_lshlrev_b32 v220, 16, v119
    v_and_b32 v221, 0xffff0000, v119
    v_lshlrev_b32 v222, 16, v123
    v_and_b32 v223, 0xffff0000, v123
    v_lshlrev_b32 v224, 16, v127
    v_and_b32 v225, 0xffff0000, v127
    v_lshlrev_b32 v226, 16, v131
    v_and_b32 v227, 0xffff0000, v131
    v_lshlrev_b32 v228, 16, v135
    v_and_b32 v229, 0xffff0000, v135
    v_lshlrev_b32 v230, 16, v139
    v_and_b32 v231, 0xffff0000, v139
    v_lshlrev_b32 v232, 16, v143
    v_and_b32 v233, 0xffff0000, v143
    v_lshlrev_b32 v234, 16, v147
    v_and_b32 v235, 0xffff0000, v147
    v_lshlrev_b32 v236, 16, v151
    v_and_b32 v237, 0xffff0000, v151
    v_pk_mul_f32 v[216:217], v[216:217], v[214:215]
    v_lshlrev_b32 v238, 16, v155
    v_pk_fma_f32 v[216:217], v[218:219], v[212:213], v[216:217]
    v_and_b32 v239, 0xffff0000, v155
    v_pk_fma_f32 v[216:217], v[220:221], v[210:211], v[216:217]
    v_pk_fma_f32 v[216:217], v[222:223], v[208:209], v[216:217]
    v_pk_mul_f32 v[216:217], v[216:217], v[238:239]
    v_pk_mul_f32 v[218:219], v[218:219], v[214:215]
    v_lshlrev_b32 v240, 16, v159
    v_pk_fma_f32 v[218:219], v[220:221], v[212:213], v[218:219]
    v_and_b32 v241, 0xffff0000, v159
    v_pk_fma_f32 v[218:219], v[222:223], v[210:211], v[218:219]
    v_pk_fma_f32 v[218:219], v[224:225], v[208:209], v[218:219]
    v_pk_mul_f32 v[218:219], v[218:219], v[240:241]
    v_pk_mul_f32 v[220:221], v[220:221], v[214:215]
    v_lshlrev_b32 v238, 16, v163
    v_pk_fma_f32 v[220:221], v[222:223], v[212:213], v[220:221]
    v_and_b32 v239, 0xffff0000, v163
    v_pk_fma_f32 v[220:221], v[224:225], v[210:211], v[220:221]
    v_pk_fma_f32 v[220:221], v[226:227], v[208:209], v[220:221]
    v_pk_mul_f32 v[220:221], v[220:221], v[238:239]
    v_pk_mul_f32 v[222:223], v[222:223], v[214:215]
    v_lshlrev_b32 v240, 16, v167
    v_pk_fma_f32 v[222:223], v[224:225], v[212:213], v[222:223]
    v_and_b32 v241, 0xffff0000, v167
    v_pk_fma_f32 v[222:223], v[226:227], v[210:211], v[222:223]
    v_pk_fma_f32 v[222:223], v[228:229], v[208:209], v[222:223]
    v_pk_mul_f32 v[222:223], v[222:223], v[240:241]
    v_pk_mul_f32 v[224:225], v[224:225], v[214:215]
    v_lshlrev_b32 v238, 16, v171
    v_pk_fma_f32 v[224:225], v[226:227], v[212:213], v[224:225]
    v_and_b32 v239, 0xffff0000, v171
    v_pk_fma_f32 v[224:225], v[228:229], v[210:211], v[224:225]
    v_pk_fma_f32 v[224:225], v[230:231], v[208:209], v[224:225]
    v_pk_mul_f32 v[224:225], v[224:225], v[238:239]
    v_pk_mul_f32 v[226:227], v[226:227], v[214:215]
    v_lshlrev_b32 v240, 16, v175
    v_pk_fma_f32 v[226:227], v[228:229], v[212:213], v[226:227]
    v_and_b32 v241, 0xffff0000, v175
    v_pk_fma_f32 v[226:227], v[230:231], v[210:211], v[226:227]
    v_pk_fma_f32 v[226:227], v[232:233], v[208:209], v[226:227]
    v_pk_mul_f32 v[226:227], v[226:227], v[240:241]
    v_pk_mul_f32 v[228:229], v[228:229], v[214:215]
    v_lshlrev_b32 v238, 16, v179
    v_pk_fma_f32 v[228:229], v[230:231], v[212:213], v[228:229]
    v_and_b32 v239, 0xffff0000, v179
    v_pk_fma_f32 v[228:229], v[232:233], v[210:211], v[228:229]
    v_pk_fma_f32 v[228:229], v[234:235], v[208:209], v[228:229]
    v_pk_mul_f32 v[228:229], v[228:229], v[238:239]
    v_pk_mul_f32 v[230:231], v[230:231], v[214:215]
    v_lshlrev_b32 v240, 16, v183
    v_pk_fma_f32 v[230:231], v[232:233], v[212:213], v[230:231]
    v_and_b32 v241, 0xffff0000, v183
    v_pk_fma_f32 v[230:231], v[234:235], v[210:211], v[230:231]
    v_pk_fma_f32 v[230:231], v[236:237], v[208:209], v[230:231]
    v_pk_mul_f32 v[230:231], v[230:231], v[240:241]
    v_cvt_pk_bf16_f32 v242, v230, v228
    v_cvt_pk_bf16_f32 v243, v226, v224
    v_cvt_pk_bf16_f32 v244, v222, v220
    v_cvt_pk_bf16_f32 v245, v218, v216
    ds_write_b128 v12, v[242:245] offset:768
    v_cvt_pk_bf16_f32 v246, v231, v229
    v_cvt_pk_bf16_f32 v247, v227, v225
    v_cvt_pk_bf16_f32 v248, v223, v221
    v_cvt_pk_bf16_f32 v249, v219, v217
    ds_write_b128 v12, v[246:249] offset:896
    v_subrev_u32 v11, 6144, v10
    buffer_load_dwordx4 v[108:111], v11, s[44:47], 0 offen nt
    v_subrev_u32 v11, 4096, v10
    buffer_load_dwordx4 v[112:115], v11, s[44:47], 0 offen nt
    v_subrev_u32 v11, 2048, v10
    buffer_load_dwordx4 v[116:119], v11, s[44:47], 0 offen nt
    s_mov_b32 s4, 0
    buffer_load_dwordx4 v[120:123], v10, s[44:47], s4 offen offset:0 nt
    buffer_load_dwordx4 v[152:155], v10, s[48:51], s4 offen offset:0 nt
    buffer_load_dwordx4 v[124:127], v10, s[44:47], s4 offen offset:2048 nt
    buffer_load_dwordx4 v[156:159], v10, s[48:51], s4 offen offset:2048 nt
    s_mov_b32 s4, 4096
    buffer_load_dwordx4 v[128:131], v10, s[44:47], s4 offen offset:0 nt
    buffer_load_dwordx4 v[160:163], v10, s[48:51], s4 offen offset:0 nt
    buffer_load_dwordx4 v[132:135], v10, s[44:47], s4 offen offset:2048 nt
    buffer_load_dwordx4 v[164:167], v10, s[48:51], s4 offen offset:2048 nt
    s_mov_b32 s4, 8192
    buffer_load_dwordx4 v[136:139], v10, s[44:47], s4 offen offset:0 nt
    buffer_load_dwordx4 v[168:171], v10, s[48:51], s4 offen offset:0 nt
    buffer_load_dwordx4 v[140:143], v10, s[44:47], s4 offen offset:2048 nt
    buffer_load_dwordx4 v[172:175], v10, s[48:51], s4 offen offset:2048 nt
    s_mov_b32 s4, 12288
    buffer_load_dwordx4 v[144:147], v10, s[44:47], s4 offen offset:0 nt
    buffer_load_dwordx4 v[176:179], v10, s[48:51], s4 offen offset:0 nt
    buffer_load_dwordx4 v[148:151], v10, s[44:47], s4 offen offset:2048 nt
    buffer_load_dwordx4 v[180:183], v10, s[48:51], s4 offen offset:2048 nt
    v_add_u32 v10, 16384, v10
    v_xor_b32 v12, 32, v13
    s_waitcnt vmcnt(19)
    v_lshlrev_b32 v216, 16, v32
    v_and_b32 v217, 0xffff0000, v32
    v_lshlrev_b32 v218, 16, v36
    v_and_b32 v219, 0xffff0000, v36
    v_lshlrev_b32 v220, 16, v40
    v_and_b32 v221, 0xffff0000, v40
    v_lshlrev_b32 v222, 16, v44
    v_and_b32 v223, 0xffff0000, v44
    v_lshlrev_b32 v224, 16, v48
    v_and_b32 v225, 0xffff0000, v48
    v_lshlrev_b32 v226, 16, v52
    v_and_b32 v227, 0xffff0000, v52
    v_lshlrev_b32 v228, 16, v56
    v_and_b32 v229, 0xffff0000, v56
    v_lshlrev_b32 v230, 16, v60
    v_and_b32 v231, 0xffff0000, v60
    v_lshlrev_b32 v232, 16, v64
    v_and_b32 v233, 0xffff0000, v64
    v_lshlrev_b32 v234, 16, v68
    v_and_b32 v235, 0xffff0000, v68
    v_lshlrev_b32 v236, 16, v72
    v_and_b32 v237, 0xffff0000, v72
    v_pk_mul_f32 v[216:217], v[216:217], v[190:191]
    v_lshlrev_b32 v238, 16, v76
    v_pk_fma_f32 v[216:217], v[218:219], v[188:189], v[216:217]
    v_and_b32 v239, 0xffff0000, v76
    v_pk_fma_f32 v[216:217], v[220:221], v[186:187], v[216:217]
    v_pk_fma_f32 v[216:217], v[222:223], v[184:185], v[216:217]
    v_pk_mul_f32 v[216:217], v[216:217], v[238:239]
    v_pk_mul_f32 v[218:219], v[218:219], v[190:191]
    v_lshlrev_b32 v240, 16, v80
    v_pk_fma_f32 v[218:219], v[220:221], v[188:189], v[218:219]
    v_and_b32 v241, 0xffff0000, v80
    v_pk_fma_f32 v[218:219], v[222:223], v[186:187], v[218:219]
    v_pk_fma_f32 v[218:219], v[224:225], v[184:185], v[218:219]
    v_pk_mul_f32 v[218:219], v[218:219], v[240:241]
    v_pk_mul_f32 v[220:221], v[220:221], v[190:191]
    v_lshlrev_b32 v238, 16, v84
    v_pk_fma_f32 v[220:221], v[222:223], v[188:189], v[220:221]
    v_and_b32 v239, 0xffff0000, v84
    v_pk_fma_f32 v[220:221], v[224:225], v[186:187], v[220:221]
    v_pk_fma_f32 v[220:221], v[226:227], v[184:185], v[220:221]
    v_pk_mul_f32 v[220:221], v[220:221], v[238:239]
    v_pk_mul_f32 v[222:223], v[222:223], v[190:191]
    v_lshlrev_b32 v240, 16, v88
    v_pk_fma_f32 v[222:223], v[224:225], v[188:189], v[222:223]
    v_and_b32 v241, 0xffff0000, v88
    v_pk_fma_f32 v[222:223], v[226:227], v[186:187], v[222:223]
    v_pk_fma_f32 v[222:223], v[228:229], v[184:185], v[222:223]
    v_pk_mul_f32 v[222:223], v[222:223], v[240:241]
    v_pk_mul_f32 v[224:225], v[224:225], v[190:191]
    v_lshlrev_b32 v238, 16, v92
    v_pk_fma_f32 v[224:225], v[226:227], v[188:189], v[224:225]
    v_and_b32 v239, 0xffff0000, v92
    v_pk_fma_f32 v[224:225], v[228:229], v[186:187], v[224:225]
    v_pk_fma_f32 v[224:225], v[230:231], v[184:185], v[224:225]
    v_pk_mul_f32 v[224:225], v[224:225], v[238:239]
    v_pk_mul_f32 v[226:227], v[226:227], v[190:191]
    v_lshlrev_b32 v240, 16, v96
    v_pk_fma_f32 v[226:227], v[228:229], v[188:189], v[226:227]
    v_and_b32 v241, 0xffff0000, v96
    v_pk_fma_f32 v[226:227], v[230:231], v[186:187], v[226:227]
    v_pk_fma_f32 v[226:227], v[232:233], v[184:185], v[226:227]
    v_pk_mul_f32 v[226:227], v[226:227], v[240:241]
    v_pk_mul_f32 v[228:229], v[228:229], v[190:191]
    v_lshlrev_b32 v238, 16, v100
    v_pk_fma_f32 v[228:229], v[230:231], v[188:189], v[228:229]
    v_and_b32 v239, 0xffff0000, v100
    v_pk_fma_f32 v[228:229], v[232:233], v[186:187], v[228:229]
    v_pk_fma_f32 v[228:229], v[234:235], v[184:185], v[228:229]
    v_pk_mul_f32 v[228:229], v[228:229], v[238:239]
    v_pk_mul_f32 v[230:231], v[230:231], v[190:191]
    v_lshlrev_b32 v240, 16, v104
    v_pk_fma_f32 v[230:231], v[232:233], v[188:189], v[230:231]
    v_and_b32 v241, 0xffff0000, v104
    v_pk_fma_f32 v[230:231], v[234:235], v[186:187], v[230:231]
    v_pk_fma_f32 v[230:231], v[236:237], v[184:185], v[230:231]
    v_pk_mul_f32 v[230:231], v[230:231], v[240:241]
    v_cvt_pk_bf16_f32 v242, v230, v228
    v_cvt_pk_bf16_f32 v243, v226, v224
    v_cvt_pk_bf16_f32 v244, v222, v220
    v_cvt_pk_bf16_f32 v245, v218, v216
    ds_write_b128 v12, v[242:245] offset:0
    v_cvt_pk_bf16_f32 v246, v231, v229
    v_cvt_pk_bf16_f32 v247, v227, v225
    v_cvt_pk_bf16_f32 v248, v223, v221
    v_cvt_pk_bf16_f32 v249, v219, v217
    ds_write_b128 v12, v[246:249] offset:128
    v_lshlrev_b32 v216, 16, v33
    v_and_b32 v217, 0xffff0000, v33
    v_lshlrev_b32 v218, 16, v37
    v_and_b32 v219, 0xffff0000, v37
    v_lshlrev_b32 v220, 16, v41
    v_and_b32 v221, 0xffff0000, v41
    v_lshlrev_b32 v222, 16, v45
    v_and_b32 v223, 0xffff0000, v45
    v_lshlrev_b32 v224, 16, v49
    v_and_b32 v225, 0xffff0000, v49
    v_lshlrev_b32 v226, 16, v53
    v_and_b32 v227, 0xffff0000, v53
    v_lshlrev_b32 v228, 16, v57
    v_and_b32 v229, 0xffff0000, v57
    v_lshlrev_b32 v230, 16, v61
    v_and_b32 v231, 0xffff0000, v61
    v_lshlrev_b32 v232, 16, v65
    v_and_b32 v233, 0xffff0000, v65
    v_lshlrev_b32 v234, 16, v69
    v_and_b32 v235, 0xffff0000, v69
    v_lshlrev_b32 v236, 16, v73
    v_and_b32 v237, 0xffff0000, v73
    v_pk_mul_f32 v[216:217], v[216:217], v[198:199]
    v_lshlrev_b32 v238, 16, v77
    v_pk_fma_f32 v[216:217], v[218:219], v[196:197], v[216:217]
    v_and_b32 v239, 0xffff0000, v77
    v_pk_fma_f32 v[216:217], v[220:221], v[194:195], v[216:217]
    v_pk_fma_f32 v[216:217], v[222:223], v[192:193], v[216:217]
    v_pk_mul_f32 v[216:217], v[216:217], v[238:239]
    v_pk_mul_f32 v[218:219], v[218:219], v[198:199]
    v_lshlrev_b32 v240, 16, v81
    v_pk_fma_f32 v[218:219], v[220:221], v[196:197], v[218:219]
    v_and_b32 v241, 0xffff0000, v81
    v_pk_fma_f32 v[218:219], v[222:223], v[194:195], v[218:219]
    v_pk_fma_f32 v[218:219], v[224:225], v[192:193], v[218:219]
    v_pk_mul_f32 v[218:219], v[218:219], v[240:241]
    v_pk_mul_f32 v[220:221], v[220:221], v[198:199]
    v_lshlrev_b32 v238, 16, v85
    v_pk_fma_f32 v[220:221], v[222:223], v[196:197], v[220:221]
    v_and_b32 v239, 0xffff0000, v85
    v_pk_fma_f32 v[220:221], v[224:225], v[194:195], v[220:221]
    v_pk_fma_f32 v[220:221], v[226:227], v[192:193], v[220:221]
    v_pk_mul_f32 v[220:221], v[220:221], v[238:239]
    v_pk_mul_f32 v[222:223], v[222:223], v[198:199]
    v_lshlrev_b32 v240, 16, v89
    v_pk_fma_f32 v[222:223], v[224:225], v[196:197], v[222:223]
    v_and_b32 v241, 0xffff0000, v89
    v_pk_fma_f32 v[222:223], v[226:227], v[194:195], v[222:223]
    v_pk_fma_f32 v[222:223], v[228:229], v[192:193], v[222:223]
    v_pk_mul_f32 v[222:223], v[222:223], v[240:241]
    v_pk_mul_f32 v[224:225], v[224:225], v[198:199]
    v_lshlrev_b32 v238, 16, v93
    v_pk_fma_f32 v[224:225], v[226:227], v[196:197], v[224:225]
    v_and_b32 v239, 0xffff0000, v93
    v_pk_fma_f32 v[224:225], v[228:229], v[194:195], v[224:225]
    v_pk_fma_f32 v[224:225], v[230:231], v[192:193], v[224:225]
    v_pk_mul_f32 v[224:225], v[224:225], v[238:239]
    v_pk_mul_f32 v[226:227], v[226:227], v[198:199]
    v_lshlrev_b32 v240, 16, v97
    v_pk_fma_f32 v[226:227], v[228:229], v[196:197], v[226:227]
    v_and_b32 v241, 0xffff0000, v97
    v_pk_fma_f32 v[226:227], v[230:231], v[194:195], v[226:227]
    v_pk_fma_f32 v[226:227], v[232:233], v[192:193], v[226:227]
    v_pk_mul_f32 v[226:227], v[226:227], v[240:241]
    v_pk_mul_f32 v[228:229], v[228:229], v[198:199]
    v_lshlrev_b32 v238, 16, v101
    v_pk_fma_f32 v[228:229], v[230:231], v[196:197], v[228:229]
    v_and_b32 v239, 0xffff0000, v101
    v_pk_fma_f32 v[228:229], v[232:233], v[194:195], v[228:229]
    v_pk_fma_f32 v[228:229], v[234:235], v[192:193], v[228:229]
    v_pk_mul_f32 v[228:229], v[228:229], v[238:239]
    v_pk_mul_f32 v[230:231], v[230:231], v[198:199]
    v_lshlrev_b32 v240, 16, v105
    v_pk_fma_f32 v[230:231], v[232:233], v[196:197], v[230:231]
    v_and_b32 v241, 0xffff0000, v105
    v_pk_fma_f32 v[230:231], v[234:235], v[194:195], v[230:231]
    v_pk_fma_f32 v[230:231], v[236:237], v[192:193], v[230:231]
    v_pk_mul_f32 v[230:231], v[230:231], v[240:241]
    v_cvt_pk_bf16_f32 v242, v230, v228
    v_cvt_pk_bf16_f32 v243, v226, v224
    v_cvt_pk_bf16_f32 v244, v222, v220
    v_cvt_pk_bf16_f32 v245, v218, v216
    ds_write_b128 v12, v[242:245] offset:256
    v_cvt_pk_bf16_f32 v246, v231, v229
    v_cvt_pk_bf16_f32 v247, v227, v225
    v_cvt_pk_bf16_f32 v248, v223, v221
    v_cvt_pk_bf16_f32 v249, v219, v217
    ds_write_b128 v12, v[246:249] offset:384
    v_lshlrev_b32 v216, 16, v34
    v_and_b32 v217, 0xffff0000, v34
    v_lshlrev_b32 v218, 16, v38
    v_and_b32 v219, 0xffff0000, v38
    v_lshlrev_b32 v220, 16, v42
    v_and_b32 v221, 0xffff0000, v42
    v_lshlrev_b32 v222, 16, v46
    v_and_b32 v223, 0xffff0000, v46
    v_lshlrev_b32 v224, 16, v50
    v_and_b32 v225, 0xffff0000, v50
    v_lshlrev_b32 v226, 16, v54
    v_and_b32 v227, 0xffff0000, v54
    v_lshlrev_b32 v228, 16, v58
    v_and_b32 v229, 0xffff0000, v58
    v_lshlrev_b32 v230, 16, v62
    v_and_b32 v231, 0xffff0000, v62
    v_lshlrev_b32 v232, 16, v66
    v_and_b32 v233, 0xffff0000, v66
    v_lshlrev_b32 v234, 16, v70
    v_and_b32 v235, 0xffff0000, v70
    v_lshlrev_b32 v236, 16, v74
    v_and_b32 v237, 0xffff0000, v74
    v_pk_mul_f32 v[216:217], v[216:217], v[206:207]
    v_lshlrev_b32 v238, 16, v78
    v_pk_fma_f32 v[216:217], v[218:219], v[204:205], v[216:217]
    v_and_b32 v239, 0xffff0000, v78
    v_pk_fma_f32 v[216:217], v[220:221], v[202:203], v[216:217]
    v_pk_fma_f32 v[216:217], v[222:223], v[200:201], v[216:217]
    v_pk_mul_f32 v[216:217], v[216:217], v[238:239]
    v_pk_mul_f32 v[218:219], v[218:219], v[206:207]
    v_lshlrev_b32 v240, 16, v82
    v_pk_fma_f32 v[218:219], v[220:221], v[204:205], v[218:219]
    v_and_b32 v241, 0xffff0000, v82
    v_pk_fma_f32 v[218:219], v[222:223], v[202:203], v[218:219]
    v_pk_fma_f32 v[218:219], v[224:225], v[200:201], v[218:219]
    v_pk_mul_f32 v[218:219], v[218:219], v[240:241]
    v_pk_mul_f32 v[220:221], v[220:221], v[206:207]
    v_lshlrev_b32 v238, 16, v86
    v_pk_fma_f32 v[220:221], v[222:223], v[204:205], v[220:221]
    v_and_b32 v239, 0xffff0000, v86
    v_pk_fma_f32 v[220:221], v[224:225], v[202:203], v[220:221]
    v_pk_fma_f32 v[220:221], v[226:227], v[200:201], v[220:221]
    v_pk_mul_f32 v[220:221], v[220:221], v[238:239]
    v_pk_mul_f32 v[222:223], v[222:223], v[206:207]
    v_lshlrev_b32 v240, 16, v90
    v_pk_fma_f32 v[222:223], v[224:225], v[204:205], v[222:223]
    v_and_b32 v241, 0xffff0000, v90
    v_pk_fma_f32 v[222:223], v[226:227], v[202:203], v[222:223]
    v_pk_fma_f32 v[222:223], v[228:229], v[200:201], v[222:223]
    v_pk_mul_f32 v[222:223], v[222:223], v[240:241]
    v_pk_mul_f32 v[224:225], v[224:225], v[206:207]
    v_lshlrev_b32 v238, 16, v94
    v_pk_fma_f32 v[224:225], v[226:227], v[204:205], v[224:225]
    v_and_b32 v239, 0xffff0000, v94
    v_pk_fma_f32 v[224:225], v[228:229], v[202:203], v[224:225]
    v_pk_fma_f32 v[224:225], v[230:231], v[200:201], v[224:225]
    v_pk_mul_f32 v[224:225], v[224:225], v[238:239]
    v_pk_mul_f32 v[226:227], v[226:227], v[206:207]
    v_lshlrev_b32 v240, 16, v98
    v_pk_fma_f32 v[226:227], v[228:229], v[204:205], v[226:227]
    v_and_b32 v241, 0xffff0000, v98
    v_pk_fma_f32 v[226:227], v[230:231], v[202:203], v[226:227]
    v_pk_fma_f32 v[226:227], v[232:233], v[200:201], v[226:227]
    v_pk_mul_f32 v[226:227], v[226:227], v[240:241]
    v_pk_mul_f32 v[228:229], v[228:229], v[206:207]
    v_lshlrev_b32 v238, 16, v102
    v_pk_fma_f32 v[228:229], v[230:231], v[204:205], v[228:229]
    v_and_b32 v239, 0xffff0000, v102
    v_pk_fma_f32 v[228:229], v[232:233], v[202:203], v[228:229]
    v_pk_fma_f32 v[228:229], v[234:235], v[200:201], v[228:229]
    v_pk_mul_f32 v[228:229], v[228:229], v[238:239]
    v_pk_mul_f32 v[230:231], v[230:231], v[206:207]
    v_lshlrev_b32 v240, 16, v106
    v_pk_fma_f32 v[230:231], v[232:233], v[204:205], v[230:231]
    v_and_b32 v241, 0xffff0000, v106
    v_pk_fma_f32 v[230:231], v[234:235], v[202:203], v[230:231]
    v_pk_fma_f32 v[230:231], v[236:237], v[200:201], v[230:231]
    v_pk_mul_f32 v[230:231], v[230:231], v[240:241]
    v_cvt_pk_bf16_f32 v242, v230, v228
    v_cvt_pk_bf16_f32 v243, v226, v224
    v_cvt_pk_bf16_f32 v244, v222, v220
    v_cvt_pk_bf16_f32 v245, v218, v216
    ds_write_b128 v12, v[242:245] offset:512
    v_cvt_pk_bf16_f32 v246, v231, v229
    v_cvt_pk_bf16_f32 v247, v227, v225
    v_cvt_pk_bf16_f32 v248, v223, v221
    v_cvt_pk_bf16_f32 v249, v219, v217
    ds_write_b128 v12, v[246:249] offset:640
    v_lshlrev_b32 v216, 16, v35
    v_and_b32 v217, 0xffff0000, v35
    v_lshlrev_b32 v218, 16, v39
    v_and_b32 v219, 0xffff0000, v39
    v_lshlrev_b32 v220, 16, v43
    v_and_b32 v221, 0xffff0000, v43
    v_lshlrev_b32 v222, 16, v47
    v_and_b32 v223, 0xffff0000, v47
    v_lshlrev_b32 v224, 16, v51
    v_and_b32 v225, 0xffff0000, v51
    v_lshlrev_b32 v226, 16, v55
    v_and_b32 v227, 0xffff0000, v55
    v_lshlrev_b32 v228, 16, v59
    v_and_b32 v229, 0xffff0000, v59
    v_lshlrev_b32 v230, 16, v63
    v_and_b32 v231, 0xffff0000, v63
    v_lshlrev_b32 v232, 16, v67
    v_and_b32 v233, 0xffff0000, v67
    v_lshlrev_b32 v234, 16, v71
    v_and_b32 v235, 0xffff0000, v71
    v_lshlrev_b32 v236, 16, v75
    v_and_b32 v237, 0xffff0000, v75
    v_pk_mul_f32 v[216:217], v[216:217], v[214:215]
    v_lshlrev_b32 v238, 16, v79
    v_pk_fma_f32 v[216:217], v[218:219], v[212:213], v[216:217]
    v_and_b32 v239, 0xffff0000, v79
    v_pk_fma_f32 v[216:217], v[220:221], v[210:211], v[216:217]
    v_pk_fma_f32 v[216:217], v[222:223], v[208:209], v[216:217]
    v_pk_mul_f32 v[216:217], v[216:217], v[238:239]
    v_pk_mul_f32 v[218:219], v[218:219], v[214:215]
    v_lshlrev_b32 v240, 16, v83
    v_pk_fma_f32 v[218:219], v[220:221], v[212:213], v[218:219]
    v_and_b32 v241, 0xffff0000, v83
    v_pk_fma_f32 v[218:219], v[222:223], v[210:211], v[218:219]
    v_pk_fma_f32 v[218:219], v[224:225], v[208:209], v[218:219]
    v_pk_mul_f32 v[218:219], v[218:219], v[240:241]
    v_pk_mul_f32 v[220:221], v[220:221], v[214:215]
    v_lshlrev_b32 v238, 16, v87
    v_pk_fma_f32 v[220:221], v[222:223], v[212:213], v[220:221]
    v_and_b32 v239, 0xffff0000, v87
    v_pk_fma_f32 v[220:221], v[224:225], v[210:211], v[220:221]
    v_pk_fma_f32 v[220:221], v[226:227], v[208:209], v[220:221]
    v_pk_mul_f32 v[220:221], v[220:221], v[238:239]
    v_pk_mul_f32 v[222:223], v[222:223], v[214:215]
    v_lshlrev_b32 v240, 16, v91
    v_pk_fma_f32 v[222:223], v[224:225], v[212:213], v[222:223]
    v_and_b32 v241, 0xffff0000, v91
    v_pk_fma_f32 v[222:223], v[226:227], v[210:211], v[222:223]
    v_pk_fma_f32 v[222:223], v[228:229], v[208:209], v[222:223]
    v_pk_mul_f32 v[222:223], v[222:223], v[240:241]
    v_pk_mul_f32 v[224:225], v[224:225], v[214:215]
    v_lshlrev_b32 v238, 16, v95
    v_pk_fma_f32 v[224:225], v[226:227], v[212:213], v[224:225]
    v_and_b32 v239, 0xffff0000, v95
    v_pk_fma_f32 v[224:225], v[228:229], v[210:211], v[224:225]
    v_pk_fma_f32 v[224:225], v[230:231], v[208:209], v[224:225]
    v_pk_mul_f32 v[224:225], v[224:225], v[238:239]
    v_pk_mul_f32 v[226:227], v[226:227], v[214:215]
    v_lshlrev_b32 v240, 16, v99
    v_pk_fma_f32 v[226:227], v[228:229], v[212:213], v[226:227]
    v_and_b32 v241, 0xffff0000, v99
    v_pk_fma_f32 v[226:227], v[230:231], v[210:211], v[226:227]
    v_pk_fma_f32 v[226:227], v[232:233], v[208:209], v[226:227]
    v_pk_mul_f32 v[226:227], v[226:227], v[240:241]
    v_pk_mul_f32 v[228:229], v[228:229], v[214:215]
    v_lshlrev_b32 v238, 16, v103
    v_pk_fma_f32 v[228:229], v[230:231], v[212:213], v[228:229]
    v_and_b32 v239, 0xffff0000, v103
    v_pk_fma_f32 v[228:229], v[232:233], v[210:211], v[228:229]
    v_pk_fma_f32 v[228:229], v[234:235], v[208:209], v[228:229]
    v_pk_mul_f32 v[228:229], v[228:229], v[238:239]
    v_pk_mul_f32 v[230:231], v[230:231], v[214:215]
    v_lshlrev_b32 v240, 16, v107
    v_pk_fma_f32 v[230:231], v[232:233], v[212:213], v[230:231]
    v_and_b32 v241, 0xffff0000, v107
    v_pk_fma_f32 v[230:231], v[234:235], v[210:211], v[230:231]
    v_pk_fma_f32 v[230:231], v[236:237], v[208:209], v[230:231]
    v_pk_mul_f32 v[230:231], v[230:231], v[240:241]
    v_cvt_pk_bf16_f32 v242, v230, v228
    v_cvt_pk_bf16_f32 v243, v226, v224
    v_cvt_pk_bf16_f32 v244, v222, v220
    v_cvt_pk_bf16_f32 v245, v218, v216
    ds_write_b128 v12, v[242:245] offset:768
    v_cvt_pk_bf16_f32 v246, v231, v229
    v_cvt_pk_bf16_f32 v247, v227, v225
    v_cvt_pk_bf16_f32 v248, v223, v221
    v_cvt_pk_bf16_f32 v249, v219, v217
    ds_write_b128 v12, v[246:249] offset:896
    v_xor_b32 v12, 48, v13
    s_waitcnt vmcnt(0)
    v_lshlrev_b32 v216, 16, v108
    v_and_b32 v217, 0xffff0000, v108
    v_lshlrev_b32 v218, 16, v112
    v_and_b32 v219, 0xffff0000, v112
    v_lshlrev_b32 v220, 16, v116
    v_and_b32 v221, 0xffff0000, v116
    v_lshlrev_b32 v222, 16, v120
    v_and_b32 v223, 0xffff0000, v120
    v_lshlrev_b32 v224, 16, v124
    v_and_b32 v225, 0xffff0000, v124
    v_lshlrev_b32 v226, 16, v128
    v_and_b32 v227, 0xffff0000, v128
    v_lshlrev_b32 v228, 16, v132
    v_and_b32 v229, 0xffff0000, v132
    v_lshlrev_b32 v230, 16, v136
    v_and_b32 v231, 0xffff0000, v136
    v_lshlrev_b32 v232, 16, v140
    v_and_b32 v233, 0xffff0000, v140
    v_lshlrev_b32 v234, 16, v144
    v_and_b32 v235, 0xffff0000, v144
    v_lshlrev_b32 v236, 16, v148
    v_and_b32 v237, 0xffff0000, v148
    v_pk_mul_f32 v[216:217], v[216:217], v[190:191]
    v_lshlrev_b32 v238, 16, v152
    v_pk_fma_f32 v[216:217], v[218:219], v[188:189], v[216:217]
    v_and_b32 v239, 0xffff0000, v152
    v_pk_fma_f32 v[216:217], v[220:221], v[186:187], v[216:217]
    v_pk_fma_f32 v[216:217], v[222:223], v[184:185], v[216:217]
    v_pk_mul_f32 v[216:217], v[216:217], v[238:239]
    v_pk_mul_f32 v[218:219], v[218:219], v[190:191]
    v_lshlrev_b32 v240, 16, v156
    v_pk_fma_f32 v[218:219], v[220:221], v[188:189], v[218:219]
    v_and_b32 v241, 0xffff0000, v156
    v_pk_fma_f32 v[218:219], v[222:223], v[186:187], v[218:219]
    v_pk_fma_f32 v[218:219], v[224:225], v[184:185], v[218:219]
    v_pk_mul_f32 v[218:219], v[218:219], v[240:241]
    v_pk_mul_f32 v[220:221], v[220:221], v[190:191]
    v_lshlrev_b32 v238, 16, v160
    v_pk_fma_f32 v[220:221], v[222:223], v[188:189], v[220:221]
    v_and_b32 v239, 0xffff0000, v160
    v_pk_fma_f32 v[220:221], v[224:225], v[186:187], v[220:221]
    v_pk_fma_f32 v[220:221], v[226:227], v[184:185], v[220:221]
    v_pk_mul_f32 v[220:221], v[220:221], v[238:239]
    v_pk_mul_f32 v[222:223], v[222:223], v[190:191]
    v_lshlrev_b32 v240, 16, v164
    v_pk_fma_f32 v[222:223], v[224:225], v[188:189], v[222:223]
    v_and_b32 v241, 0xffff0000, v164
    v_pk_fma_f32 v[222:223], v[226:227], v[186:187], v[222:223]
    v_pk_fma_f32 v[222:223], v[228:229], v[184:185], v[222:223]
    v_pk_mul_f32 v[222:223], v[222:223], v[240:241]
    v_pk_mul_f32 v[224:225], v[224:225], v[190:191]
    v_lshlrev_b32 v238, 16, v168
    v_pk_fma_f32 v[224:225], v[226:227], v[188:189], v[224:225]
    v_and_b32 v239, 0xffff0000, v168
    v_pk_fma_f32 v[224:225], v[228:229], v[186:187], v[224:225]
    v_pk_fma_f32 v[224:225], v[230:231], v[184:185], v[224:225]
    v_pk_mul_f32 v[224:225], v[224:225], v[238:239]
    v_pk_mul_f32 v[226:227], v[226:227], v[190:191]
    v_lshlrev_b32 v240, 16, v172
    v_pk_fma_f32 v[226:227], v[228:229], v[188:189], v[226:227]
    v_and_b32 v241, 0xffff0000, v172
    v_pk_fma_f32 v[226:227], v[230:231], v[186:187], v[226:227]
    v_pk_fma_f32 v[226:227], v[232:233], v[184:185], v[226:227]
    v_pk_mul_f32 v[226:227], v[226:227], v[240:241]
    v_pk_mul_f32 v[228:229], v[228:229], v[190:191]
    v_lshlrev_b32 v238, 16, v176
    v_pk_fma_f32 v[228:229], v[230:231], v[188:189], v[228:229]
    v_and_b32 v239, 0xffff0000, v176
    v_pk_fma_f32 v[228:229], v[232:233], v[186:187], v[228:229]
    v_pk_fma_f32 v[228:229], v[234:235], v[184:185], v[228:229]
    v_pk_mul_f32 v[228:229], v[228:229], v[238:239]
    v_pk_mul_f32 v[230:231], v[230:231], v[190:191]
    v_lshlrev_b32 v240, 16, v180
    v_pk_fma_f32 v[230:231], v[232:233], v[188:189], v[230:231]
    v_and_b32 v241, 0xffff0000, v180
    v_pk_fma_f32 v[230:231], v[234:235], v[186:187], v[230:231]
    v_pk_fma_f32 v[230:231], v[236:237], v[184:185], v[230:231]
    v_pk_mul_f32 v[230:231], v[230:231], v[240:241]
    v_cvt_pk_bf16_f32 v242, v230, v228
    v_cvt_pk_bf16_f32 v243, v226, v224
    v_cvt_pk_bf16_f32 v244, v222, v220
    v_cvt_pk_bf16_f32 v245, v218, v216
    ds_write_b128 v12, v[242:245] offset:0
    v_cvt_pk_bf16_f32 v246, v231, v229
    v_cvt_pk_bf16_f32 v247, v227, v225
    v_cvt_pk_bf16_f32 v248, v223, v221
    v_cvt_pk_bf16_f32 v249, v219, v217
    ds_write_b128 v12, v[246:249] offset:128
    v_lshlrev_b32 v216, 16, v109
    v_and_b32 v217, 0xffff0000, v109
    v_lshlrev_b32 v218, 16, v113
    v_and_b32 v219, 0xffff0000, v113
    v_lshlrev_b32 v220, 16, v117
    v_and_b32 v221, 0xffff0000, v117
    v_lshlrev_b32 v222, 16, v121
    v_and_b32 v223, 0xffff0000, v121
    v_lshlrev_b32 v224, 16, v125
    v_and_b32 v225, 0xffff0000, v125
    v_lshlrev_b32 v226, 16, v129
    v_and_b32 v227, 0xffff0000, v129
    v_lshlrev_b32 v228, 16, v133
    v_and_b32 v229, 0xffff0000, v133
    v_lshlrev_b32 v230, 16, v137
    v_and_b32 v231, 0xffff0000, v137
    v_lshlrev_b32 v232, 16, v141
    v_and_b32 v233, 0xffff0000, v141
    v_lshlrev_b32 v234, 16, v145
    v_and_b32 v235, 0xffff0000, v145
    v_lshlrev_b32 v236, 16, v149
    v_and_b32 v237, 0xffff0000, v149
    v_pk_mul_f32 v[216:217], v[216:217], v[198:199]
    v_lshlrev_b32 v238, 16, v153
    v_pk_fma_f32 v[216:217], v[218:219], v[196:197], v[216:217]
    v_and_b32 v239, 0xffff0000, v153
    v_pk_fma_f32 v[216:217], v[220:221], v[194:195], v[216:217]
    v_pk_fma_f32 v[216:217], v[222:223], v[192:193], v[216:217]
    v_pk_mul_f32 v[216:217], v[216:217], v[238:239]
    v_pk_mul_f32 v[218:219], v[218:219], v[198:199]
    v_lshlrev_b32 v240, 16, v157
    v_pk_fma_f32 v[218:219], v[220:221], v[196:197], v[218:219]
    v_and_b32 v241, 0xffff0000, v157
    v_pk_fma_f32 v[218:219], v[222:223], v[194:195], v[218:219]
    v_pk_fma_f32 v[218:219], v[224:225], v[192:193], v[218:219]
    v_pk_mul_f32 v[218:219], v[218:219], v[240:241]
    v_pk_mul_f32 v[220:221], v[220:221], v[198:199]
    v_lshlrev_b32 v238, 16, v161
    v_pk_fma_f32 v[220:221], v[222:223], v[196:197], v[220:221]
    v_and_b32 v239, 0xffff0000, v161
    v_pk_fma_f32 v[220:221], v[224:225], v[194:195], v[220:221]
    v_pk_fma_f32 v[220:221], v[226:227], v[192:193], v[220:221]
    v_pk_mul_f32 v[220:221], v[220:221], v[238:239]
    v_pk_mul_f32 v[222:223], v[222:223], v[198:199]
    v_lshlrev_b32 v240, 16, v165
    v_pk_fma_f32 v[222:223], v[224:225], v[196:197], v[222:223]
    v_and_b32 v241, 0xffff0000, v165
    v_pk_fma_f32 v[222:223], v[226:227], v[194:195], v[222:223]
    v_pk_fma_f32 v[222:223], v[228:229], v[192:193], v[222:223]
    v_pk_mul_f32 v[222:223], v[222:223], v[240:241]
    v_pk_mul_f32 v[224:225], v[224:225], v[198:199]
    v_lshlrev_b32 v238, 16, v169
    v_pk_fma_f32 v[224:225], v[226:227], v[196:197], v[224:225]
    v_and_b32 v239, 0xffff0000, v169
    v_pk_fma_f32 v[224:225], v[228:229], v[194:195], v[224:225]
    v_pk_fma_f32 v[224:225], v[230:231], v[192:193], v[224:225]
    v_pk_mul_f32 v[224:225], v[224:225], v[238:239]
    v_pk_mul_f32 v[226:227], v[226:227], v[198:199]
    v_lshlrev_b32 v240, 16, v173
    v_pk_fma_f32 v[226:227], v[228:229], v[196:197], v[226:227]
    v_and_b32 v241, 0xffff0000, v173
    v_pk_fma_f32 v[226:227], v[230:231], v[194:195], v[226:227]
    v_pk_fma_f32 v[226:227], v[232:233], v[192:193], v[226:227]
    v_pk_mul_f32 v[226:227], v[226:227], v[240:241]
    v_pk_mul_f32 v[228:229], v[228:229], v[198:199]
    v_lshlrev_b32 v238, 16, v177
    v_pk_fma_f32 v[228:229], v[230:231], v[196:197], v[228:229]
    v_and_b32 v239, 0xffff0000, v177
    v_pk_fma_f32 v[228:229], v[232:233], v[194:195], v[228:229]
    v_pk_fma_f32 v[228:229], v[234:235], v[192:193], v[228:229]
    v_pk_mul_f32 v[228:229], v[228:229], v[238:239]
    v_pk_mul_f32 v[230:231], v[230:231], v[198:199]
    v_lshlrev_b32 v240, 16, v181
    v_pk_fma_f32 v[230:231], v[232:233], v[196:197], v[230:231]
    v_and_b32 v241, 0xffff0000, v181
    v_pk_fma_f32 v[230:231], v[234:235], v[194:195], v[230:231]
    v_pk_fma_f32 v[230:231], v[236:237], v[192:193], v[230:231]
    v_pk_mul_f32 v[230:231], v[230:231], v[240:241]
    v_cvt_pk_bf16_f32 v242, v230, v228
    v_cvt_pk_bf16_f32 v243, v226, v224
    v_cvt_pk_bf16_f32 v244, v222, v220
    v_cvt_pk_bf16_f32 v245, v218, v216
    ds_write_b128 v12, v[242:245] offset:256
    v_cvt_pk_bf16_f32 v246, v231, v229
    v_cvt_pk_bf16_f32 v247, v227, v225
    v_cvt_pk_bf16_f32 v248, v223, v221
    v_cvt_pk_bf16_f32 v249, v219, v217
    ds_write_b128 v12, v[246:249] offset:384
    v_lshlrev_b32 v216, 16, v110
    v_and_b32 v217, 0xffff0000, v110
    v_lshlrev_b32 v218, 16, v114
    v_and_b32 v219, 0xffff0000, v114
    v_lshlrev_b32 v220, 16, v118
    v_and_b32 v221, 0xffff0000, v118
    v_lshlrev_b32 v222, 16, v122
    v_and_b32 v223, 0xffff0000, v122
    v_lshlrev_b32 v224, 16, v126
    v_and_b32 v225, 0xffff0000, v126
    v_lshlrev_b32 v226, 16, v130
    v_and_b32 v227, 0xffff0000, v130
    v_lshlrev_b32 v228, 16, v134
    v_and_b32 v229, 0xffff0000, v134
    v_lshlrev_b32 v230, 16, v138
    v_and_b32 v231, 0xffff0000, v138
    v_lshlrev_b32 v232, 16, v142
    v_and_b32 v233, 0xffff0000, v142
    v_lshlrev_b32 v234, 16, v146
    v_and_b32 v235, 0xffff0000, v146
    v_lshlrev_b32 v236, 16, v150
    v_and_b32 v237, 0xffff0000, v150
    v_pk_mul_f32 v[216:217], v[216:217], v[206:207]
    v_lshlrev_b32 v238, 16, v154
    v_pk_fma_f32 v[216:217], v[218:219], v[204:205], v[216:217]
    v_and_b32 v239, 0xffff0000, v154
    v_pk_fma_f32 v[216:217], v[220:221], v[202:203], v[216:217]
    v_pk_fma_f32 v[216:217], v[222:223], v[200:201], v[216:217]
    v_pk_mul_f32 v[216:217], v[216:217], v[238:239]
    v_pk_mul_f32 v[218:219], v[218:219], v[206:207]
    v_lshlrev_b32 v240, 16, v158
    v_pk_fma_f32 v[218:219], v[220:221], v[204:205], v[218:219]
    v_and_b32 v241, 0xffff0000, v158
    v_pk_fma_f32 v[218:219], v[222:223], v[202:203], v[218:219]
    v_pk_fma_f32 v[218:219], v[224:225], v[200:201], v[218:219]
    v_pk_mul_f32 v[218:219], v[218:219], v[240:241]
    v_pk_mul_f32 v[220:221], v[220:221], v[206:207]
    v_lshlrev_b32 v238, 16, v162
    v_pk_fma_f32 v[220:221], v[222:223], v[204:205], v[220:221]
    v_and_b32 v239, 0xffff0000, v162
    v_pk_fma_f32 v[220:221], v[224:225], v[202:203], v[220:221]
    v_pk_fma_f32 v[220:221], v[226:227], v[200:201], v[220:221]
    v_pk_mul_f32 v[220:221], v[220:221], v[238:239]
    v_pk_mul_f32 v[222:223], v[222:223], v[206:207]
    v_lshlrev_b32 v240, 16, v166
    v_pk_fma_f32 v[222:223], v[224:225], v[204:205], v[222:223]
    v_and_b32 v241, 0xffff0000, v166
    v_pk_fma_f32 v[222:223], v[226:227], v[202:203], v[222:223]
    v_pk_fma_f32 v[222:223], v[228:229], v[200:201], v[222:223]
    v_pk_mul_f32 v[222:223], v[222:223], v[240:241]
    v_pk_mul_f32 v[224:225], v[224:225], v[206:207]
    v_lshlrev_b32 v238, 16, v170
    v_pk_fma_f32 v[224:225], v[226:227], v[204:205], v[224:225]
    v_and_b32 v239, 0xffff0000, v170
    v_pk_fma_f32 v[224:225], v[228:229], v[202:203], v[224:225]
    v_pk_fma_f32 v[224:225], v[230:231], v[200:201], v[224:225]
    v_pk_mul_f32 v[224:225], v[224:225], v[238:239]
    v_pk_mul_f32 v[226:227], v[226:227], v[206:207]
    v_lshlrev_b32 v240, 16, v174
    v_pk_fma_f32 v[226:227], v[228:229], v[204:205], v[226:227]
    v_and_b32 v241, 0xffff0000, v174
    v_pk_fma_f32 v[226:227], v[230:231], v[202:203], v[226:227]
    v_pk_fma_f32 v[226:227], v[232:233], v[200:201], v[226:227]
    v_pk_mul_f32 v[226:227], v[226:227], v[240:241]
    v_pk_mul_f32 v[228:229], v[228:229], v[206:207]
    v_lshlrev_b32 v238, 16, v178
    v_pk_fma_f32 v[228:229], v[230:231], v[204:205], v[228:229]
    v_and_b32 v239, 0xffff0000, v178
    v_pk_fma_f32 v[228:229], v[232:233], v[202:203], v[228:229]
    v_pk_fma_f32 v[228:229], v[234:235], v[200:201], v[228:229]
    v_pk_mul_f32 v[228:229], v[228:229], v[238:239]
    v_pk_mul_f32 v[230:231], v[230:231], v[206:207]
    v_lshlrev_b32 v240, 16, v182
    v_pk_fma_f32 v[230:231], v[232:233], v[204:205], v[230:231]
    v_and_b32 v241, 0xffff0000, v182
    v_pk_fma_f32 v[230:231], v[234:235], v[202:203], v[230:231]
    v_pk_fma_f32 v[230:231], v[236:237], v[200:201], v[230:231]
    v_pk_mul_f32 v[230:231], v[230:231], v[240:241]
    v_cvt_pk_bf16_f32 v242, v230, v228
    v_cvt_pk_bf16_f32 v243, v226, v224
    v_cvt_pk_bf16_f32 v244, v222, v220
    v_cvt_pk_bf16_f32 v245, v218, v216
    ds_write_b128 v12, v[242:245] offset:512
    v_cvt_pk_bf16_f32 v246, v231, v229
    v_cvt_pk_bf16_f32 v247, v227, v225
    v_cvt_pk_bf16_f32 v248, v223, v221
    v_cvt_pk_bf16_f32 v249, v219, v217
    ds_write_b128 v12, v[246:249] offset:640
    v_lshlrev_b32 v216, 16, v111
    v_and_b32 v217, 0xffff0000, v111
    v_lshlrev_b32 v218, 16, v115
    v_and_b32 v219, 0xffff0000, v115
    v_lshlrev_b32 v220, 16, v119
    v_and_b32 v221, 0xffff0000, v119
    v_lshlrev_b32 v222, 16, v123
    v_and_b32 v223, 0xffff0000, v123
    v_lshlrev_b32 v224, 16, v127
    v_and_b32 v225, 0xffff0000, v127
    v_lshlrev_b32 v226, 16, v131
    v_and_b32 v227, 0xffff0000, v131
    v_lshlrev_b32 v228, 16, v135
    v_and_b32 v229, 0xffff0000, v135
    v_lshlrev_b32 v230, 16, v139
    v_and_b32 v231, 0xffff0000, v139
    v_lshlrev_b32 v232, 16, v143
    v_and_b32 v233, 0xffff0000, v143
    v_lshlrev_b32 v234, 16, v147
    v_and_b32 v235, 0xffff0000, v147
    v_lshlrev_b32 v236, 16, v151
    v_and_b32 v237, 0xffff0000, v151
    v_pk_mul_f32 v[216:217], v[216:217], v[214:215]
    v_lshlrev_b32 v238, 16, v155
    v_pk_fma_f32 v[216:217], v[218:219], v[212:213], v[216:217]
    v_and_b32 v239, 0xffff0000, v155
    v_pk_fma_f32 v[216:217], v[220:221], v[210:211], v[216:217]
    v_pk_fma_f32 v[216:217], v[222:223], v[208:209], v[216:217]
    v_pk_mul_f32 v[216:217], v[216:217], v[238:239]
    v_pk_mul_f32 v[218:219], v[218:219], v[214:215]
    v_lshlrev_b32 v240, 16, v159
    v_pk_fma_f32 v[218:219], v[220:221], v[212:213], v[218:219]
    v_and_b32 v241, 0xffff0000, v159
    v_pk_fma_f32 v[218:219], v[222:223], v[210:211], v[218:219]
    v_pk_fma_f32 v[218:219], v[224:225], v[208:209], v[218:219]
    v_pk_mul_f32 v[218:219], v[218:219], v[240:241]
    v_pk_mul_f32 v[220:221], v[220:221], v[214:215]
    v_lshlrev_b32 v238, 16, v163
    v_pk_fma_f32 v[220:221], v[222:223], v[212:213], v[220:221]
    v_and_b32 v239, 0xffff0000, v163
    v_pk_fma_f32 v[220:221], v[224:225], v[210:211], v[220:221]
    v_pk_fma_f32 v[220:221], v[226:227], v[208:209], v[220:221]
    v_pk_mul_f32 v[220:221], v[220:221], v[238:239]
    v_pk_mul_f32 v[222:223], v[222:223], v[214:215]
    v_lshlrev_b32 v240, 16, v167
    v_pk_fma_f32 v[222:223], v[224:225], v[212:213], v[222:223]
    v_and_b32 v241, 0xffff0000, v167
    v_pk_fma_f32 v[222:223], v[226:227], v[210:211], v[222:223]
    v_pk_fma_f32 v[222:223], v[228:229], v[208:209], v[222:223]
    v_pk_mul_f32 v[222:223], v[222:223], v[240:241]
    v_pk_mul_f32 v[224:225], v[224:225], v[214:215]
    v_lshlrev_b32 v238, 16, v171
    v_pk_fma_f32 v[224:225], v[226:227], v[212:213], v[224:225]
    v_and_b32 v239, 0xffff0000, v171
    v_pk_fma_f32 v[224:225], v[228:229], v[210:211], v[224:225]
    v_pk_fma_f32 v[224:225], v[230:231], v[208:209], v[224:225]
    v_pk_mul_f32 v[224:225], v[224:225], v[238:239]
    v_pk_mul_f32 v[226:227], v[226:227], v[214:215]
    v_lshlrev_b32 v240, 16, v175
    v_pk_fma_f32 v[226:227], v[228:229], v[212:213], v[226:227]
    v_and_b32 v241, 0xffff0000, v175
    v_pk_fma_f32 v[226:227], v[230:231], v[210:211], v[226:227]
    v_pk_fma_f32 v[226:227], v[232:233], v[208:209], v[226:227]
    v_pk_mul_f32 v[226:227], v[226:227], v[240:241]
    v_pk_mul_f32 v[228:229], v[228:229], v[214:215]
    v_lshlrev_b32 v238, 16, v179
    v_pk_fma_f32 v[228:229], v[230:231], v[212:213], v[228:229]
    v_and_b32 v239, 0xffff0000, v179
    v_pk_fma_f32 v[228:229], v[232:233], v[210:211], v[228:229]
    v_pk_fma_f32 v[228:229], v[234:235], v[208:209], v[228:229]
    v_pk_mul_f32 v[228:229], v[228:229], v[238:239]
    v_pk_mul_f32 v[230:231], v[230:231], v[214:215]
    v_lshlrev_b32 v240, 16, v183
    v_pk_fma_f32 v[230:231], v[232:233], v[212:213], v[230:231]
    v_and_b32 v241, 0xffff0000, v183
    v_pk_fma_f32 v[230:231], v[234:235], v[210:211], v[230:231]
    v_pk_fma_f32 v[230:231], v[236:237], v[208:209], v[230:231]
    v_pk_mul_f32 v[230:231], v[230:231], v[240:241]
    v_cvt_pk_bf16_f32 v242, v230, v228
    v_cvt_pk_bf16_f32 v243, v226, v224
    v_cvt_pk_bf16_f32 v244, v222, v220
    v_cvt_pk_bf16_f32 v245, v218, v216
    ds_write_b128 v12, v[242:245] offset:768
    v_cvt_pk_bf16_f32 v246, v231, v229
    v_cvt_pk_bf16_f32 v247, v227, v225
    v_cvt_pk_bf16_f32 v248, v223, v221
    v_cvt_pk_bf16_f32 v249, v219, v217
    ds_write_b128 v12, v[246:249] offset:896
    v_lshlrev_b32 v12, 4, v1
    v_add_u32 v13, s5, v12
    s_lshl_b32 s4, s24, 20
    s_lshl_b32 s5, s99, 11
    s_add_u32 s4, s4, s5
    s_add_u32 s4, s4, 125829120
    s_waitcnt lgkmcnt(0)
    ds_read_b128 v[32:35], v13 offset:0
    ds_read_b128 v[36:39], v13 offset:1024
    ds_read_b128 v[40:43], v13 offset:2048
    ds_read_b128 v[44:47], v13 offset:3072
    ds_read_b128 v[48:51], v13 offset:4096
    ds_read_b128 v[52:55], v13 offset:5120
    ds_read_b128 v[56:59], v13 offset:6144
    ds_read_b128 v[60:63], v13 offset:7168
    ds_read_b128 v[64:67], v13 offset:8192
    ds_read_b128 v[68:71], v13 offset:9216
    ds_read_b128 v[72:75], v13 offset:10240
    ds_read_b128 v[76:79], v13 offset:11264
    ds_read_b128 v[80:83], v13 offset:12288
    ds_read_b128 v[84:87], v13 offset:13312
    ds_read_b128 v[88:91], v13 offset:14336
    ds_read_b128 v[92:95], v13 offset:15360
    ds_read_b128 v[96:99], v13 offset:16384
    ds_read_b128 v[100:103], v13 offset:17408
    ds_read_b128 v[104:107], v13 offset:18432
    ds_read_b128 v[108:111], v13 offset:19456
    ds_read_b128 v[112:115], v13 offset:20480
    ds_read_b128 v[116:119], v13 offset:21504
    ds_read_b128 v[120:123], v13 offset:22528
    ds_read_b128 v[124:127], v13 offset:23552
    ds_read_b128 v[128:131], v13 offset:24576
    ds_read_b128 v[132:135], v13 offset:25600
    ds_read_b128 v[136:139], v13 offset:26624
    ds_read_b128 v[140:143], v13 offset:27648
    ds_read_b128 v[144:147], v13 offset:28672
    ds_read_b128 v[148:151], v13 offset:29696
    ds_read_b128 v[152:155], v13 offset:30720
    ds_read_b128 v[156:159], v13 offset:31744
    s_waitcnt lgkmcnt(15)
    buffer_store_dwordx4 v[32:35], v12, s[8:11], s4 offen offset:0 sc1
    buffer_store_dwordx4 v[36:39], v12, s[8:11], s4 offen offset:1024 sc1
    s_add_u32 s4, s4, 0x10000
    buffer_store_dwordx4 v[40:43], v12, s[8:11], s4 offen offset:0 sc1
    buffer_store_dwordx4 v[44:47], v12, s[8:11], s4 offen offset:1024 sc1
    s_add_u32 s4, s4, 0x10000
    buffer_store_dwordx4 v[48:51], v12, s[8:11], s4 offen offset:0 sc1
    buffer_store_dwordx4 v[52:55], v12, s[8:11], s4 offen offset:1024 sc1
    s_add_u32 s4, s4, 0x10000
    buffer_store_dwordx4 v[56:59], v12, s[8:11], s4 offen offset:0 sc1
    buffer_store_dwordx4 v[60:63], v12, s[8:11], s4 offen offset:1024 sc1
    s_add_u32 s4, s4, 0x10000
    buffer_store_dwordx4 v[64:67], v12, s[8:11], s4 offen offset:0 sc1
    buffer_store_dwordx4 v[68:71], v12, s[8:11], s4 offen offset:1024 sc1
    s_add_u32 s4, s4, 0x10000
    buffer_store_dwordx4 v[72:75], v12, s[8:11], s4 offen offset:0 sc1
    buffer_store_dwordx4 v[76:79], v12, s[8:11], s4 offen offset:1024 sc1
    s_add_u32 s4, s4, 0x10000
    buffer_store_dwordx4 v[80:83], v12, s[8:11], s4 offen offset:0 sc1
    buffer_store_dwordx4 v[84:87], v12, s[8:11], s4 offen offset:1024 sc1
    s_add_u32 s4, s4, 0x10000
    buffer_store_dwordx4 v[88:91], v12, s[8:11], s4 offen offset:0 sc1
    buffer_store_dwordx4 v[92:95], v12, s[8:11], s4 offen offset:1024 sc1
    s_add_u32 s4, s4, 0x10000
    s_waitcnt lgkmcnt(15)
    buffer_store_dwordx4 v[96:99], v12, s[8:11], s4 offen offset:0 sc1
    s_waitcnt lgkmcnt(14)
    buffer_store_dwordx4 v[100:103], v12, s[8:11], s4 offen offset:1024 sc1
    s_add_u32 s4, s4, 0x10000
    s_waitcnt lgkmcnt(13)
    buffer_store_dwordx4 v[104:107], v12, s[8:11], s4 offen offset:0 sc1
    s_waitcnt lgkmcnt(12)
    buffer_store_dwordx4 v[108:111], v12, s[8:11], s4 offen offset:1024 sc1
    s_add_u32 s4, s4, 0x10000
    s_waitcnt lgkmcnt(11)
    buffer_store_dwordx4 v[112:115], v12, s[8:11], s4 offen offset:0 sc1
    s_waitcnt lgkmcnt(10)
    buffer_store_dwordx4 v[116:119], v12, s[8:11], s4 offen offset:1024 sc1
    s_add_u32 s4, s4, 0x10000
    s_waitcnt lgkmcnt(9)
    buffer_store_dwordx4 v[120:123], v12, s[8:11], s4 offen offset:0 sc1
    s_waitcnt lgkmcnt(8)
    buffer_store_dwordx4 v[124:127], v12, s[8:11], s4 offen offset:1024 sc1
    s_add_u32 s4, s4, 0x10000
    s_waitcnt lgkmcnt(7)
    buffer_store_dwordx4 v[128:131], v12, s[8:11], s4 offen offset:0 sc1
    s_waitcnt lgkmcnt(6)
    buffer_store_dwordx4 v[132:135], v12, s[8:11], s4 offen offset:1024 sc1
    s_add_u32 s4, s4, 0x10000
    s_waitcnt lgkmcnt(5)
    buffer_store_dwordx4 v[136:139], v12, s[8:11], s4 offen offset:0 sc1
    s_waitcnt lgkmcnt(4)
    buffer_store_dwordx4 v[140:143], v12, s[8:11], s4 offen offset:1024 sc1
    s_add_u32 s4, s4, 0x10000
    s_waitcnt lgkmcnt(3)
    buffer_store_dwordx4 v[144:147], v12, s[8:11], s4 offen offset:0 sc1
    s_waitcnt lgkmcnt(2)
    buffer_store_dwordx4 v[148:151], v12, s[8:11], s4 offen offset:1024 sc1
    s_add_u32 s4, s4, 0x10000
    s_waitcnt lgkmcnt(1)
    buffer_store_dwordx4 v[152:155], v12, s[8:11], s4 offen offset:0 sc1
    s_waitcnt lgkmcnt(0)
    buffer_store_dwordx4 v[156:159], v12, s[8:11], s4 offen offset:1024 sc1
    s_add_u32 s4, s4, 0x10000
    s_lshl_b32 s4, s99, 7
    s_lshl_b32 s5, s24, 2
    s_add_u32 s4, s4, s5
    s_add_u32 s4, s4, 92344320
    v_mov_b32 v12, 1
    v_mov_b32 v13, 0
    s_waitcnt vmcnt(0)
    s_mov_b64 exec, 1
    buffer_store_dword v12, v13, s[8:11], s4 offen sc1
    s_mov_b64 exec, -1
    s_barrier
    s_lshl_b32 s30, s99, 14
    s_lshl_b32 s4, s24, 12
    s_add_u32 s30, s30, s4
    s_add_u32 s30, s30, 77070336
.cold_576:
    s_mov_b32 s62, 0
.gp_580:
    buffer_load_dwordx4 v[12:15], v7, s[8:11], 0 offen sc1
    s_add_u32 s62, s62, 1
    s_cmp_gt_u32 s62, 0x200000
    s_cbranch_scc1 .mg_end_1
    s_waitcnt vmcnt(0)
    v_min3_u32 v4, v12, v13, v14
    v_min_u32 v4, v4, v15
    s_nop 1
    v_min_u32_dpp v4, v4, v4 quad_perm:[1,0,3,2] row_mask:0xf bank_mask:0xf
    s_nop 1
    v_min_u32_dpp v4, v4, v4 quad_perm:[2,3,0,1] row_mask:0xf bank_mask:0xf
    s_nop 1
    v_min_u32_dpp v4, v4, v4 row_half_mirror row_mask:0xf bank_mask:0xf
    s_nop 1
    v_readfirstlane_b32 s33, v4
    s_cmp_gt_u32 s33, s28
    s_cbranch_scc1 .go_577
    s_sleep 1
    s_branch .gp_580
.go_577:
    s_add_u32 m0, s36, 0
    s_add_u32 s31, s29, 0
    buffer_load_dwordx4 v9, s[8:11], s31 offen offset:0 sc1 lds
    buffer_load_dwordx4 v9, s[8:11], s31 offen offset:1024 sc1 lds
    buffer_load_dwordx4 v9, s[8:11], s31 offen offset:2048 sc1 lds
    buffer_load_dwordx4 v9, s[8:11], s31 offen offset:3072 sc1 lds
    s_add_u32 m0, s36, 16384
    s_add_u32 s31, s29, 16384
    buffer_load_dwordx4 v9, s[8:11], s31 offen offset:0 sc1 lds
    buffer_load_dwordx4 v9, s[8:11], s31 offen offset:1024 sc1 lds
    buffer_load_dwordx4 v9, s[8:11], s31 offen offset:2048 sc1 lds
    buffer_load_dwordx4 v9, s[8:11], s31 offen offset:3072 sc1 lds
.body_578:
    s_waitcnt vmcnt(4)
    s_barrier
    ds_read_b128 v[64:67], v8 offset:0
    ds_read_b128 v[68:71], v8 offset:4096
    ds_read_b128 v[72:75], v8 offset:1024
    ds_read_b128 v[76:79], v8 offset:5120
    ds_read_b128 v[80:83], v8 offset:2048
    ds_read_b128 v[84:87], v8 offset:6144
    ds_read_b128 v[88:91], v8 offset:3072
    ds_read_b128 v[92:95], v8 offset:7168
    s_waitcnt lgkmcnt(6)
    v_mfma_f32_16x16x32_bf16 v[192:195], a[0:3], v[64:67], 0
    s_add_u32 m0, s36, 32768
    s_add_u32 s31, s29, 32768
    v_mfma_f32_16x16x32_bf16 v[196:199], a[4:7], v[64:67], 0
    buffer_load_dwordx4 v9, s[8:11], s31 offen offset:0 sc1 lds
    v_mfma_f32_16x16x32_bf16 v[200:203], a[0:3], v[68:71], 0
    ds_read_b128 v[96:99], v8 offset:8192
    ds_read_b128 v[100:103], v8 offset:12288
    v_mfma_f32_16x16x32_bf16 v[204:207], a[4:7], v[68:71], 0
    ds_read_b128 v[104:107], v8 offset:9216
    s_waitcnt lgkmcnt(7)
    v_mfma_f32_16x16x32_bf16 v[192:195], a[8:11], v[72:75], v[192:195]
    ds_read_b128 v[108:111], v8 offset:13312
    ds_read_b128 v[112:115], v8 offset:10240
    v_mfma_f32_16x16x32_bf16 v[196:199], a[12:15], v[72:75], v[196:199]
    buffer_load_dwordx4 v9, s[8:11], s31 offen offset:1024 sc1 lds
    v_mfma_f32_16x16x32_bf16 v[200:203], a[8:11], v[76:79], v[200:203]
    ds_read_b128 v[116:119], v8 offset:14336
    ds_read_b128 v[120:123], v8 offset:11264
    v_mfma_f32_16x16x32_bf16 v[204:207], a[12:15], v[76:79], v[204:207]
    ds_read_b128 v[124:127], v8 offset:15360
    s_waitcnt lgkmcnt(10)
    v_mfma_f32_16x16x32_bf16 v[192:195], a[16:19], v[80:83], v[192:195]
    buffer_load_dwordx4 v9, s[8:11], s31 offen offset:2048 sc1 lds
    v_mfma_f32_16x16x32_bf16 v[196:199], a[20:23], v[80:83], v[196:199]
    v_mfma_f32_16x16x32_bf16 v[200:203], a[16:19], v[84:87], v[200:203]
    v_mfma_f32_16x16x32_bf16 v[204:207], a[20:23], v[84:87], v[204:207]
    s_waitcnt lgkmcnt(8)
    v_mfma_f32_16x16x32_bf16 v[192:195], a[24:27], v[88:91], v[192:195]
    buffer_load_dwordx4 v9, s[8:11], s31 offen offset:3072 sc1 lds
    v_mfma_f32_16x16x32_bf16 v[196:199], a[28:31], v[88:91], v[196:199]
    v_mfma_f32_16x16x32_bf16 v[200:203], a[24:27], v[92:95], v[200:203]
    s_waitcnt vmcnt(4)
    s_barrier
    v_mfma_f32_16x16x32_bf16 v[204:207], a[28:31], v[92:95], v[204:207]
    ds_read_b128 v[128:131], v8 offset:16384
    s_waitcnt lgkmcnt(5)
    v_mfma_f32_16x16x32_bf16 v[192:195], a[32:35], v[96:99], v[192:195]
    s_add_u32 m0, s36, 49152
    s_add_u32 s31, s29, 49152
    v_mfma_f32_16x16x32_bf16 v[196:199], a[36:39], v[96:99], v[196:199]
    buffer_load_dwordx4 v9, s[8:11], s31 offen offset:0 sc1 lds
    v_mfma_f32_16x16x32_bf16 v[200:203], a[32:35], v[100:103], v[200:203]
    ds_read_b128 v[132:135], v8 offset:20480
    ds_read_b128 v[136:139], v8 offset:17408
    v_mfma_f32_16x16x32_bf16 v[204:207], a[36:39], v[100:103], v[204:207]
    ds_read_b128 v[140:143], v8 offset:21504
    ds_read_b128 v[144:147], v8 offset:18432
    v_mfma_f32_16x16x32_bf16 v[192:195], a[40:43], v[104:107], v[192:195]
    buffer_load_dwordx4 v9, s[8:11], s31 offen offset:1024 sc1 lds
    v_mfma_f32_16x16x32_bf16 v[196:199], a[44:47], v[104:107], v[196:199]
    ds_read_b128 v[148:151], v8 offset:22528
    ds_read_b128 v[152:155], v8 offset:19456
    v_mfma_f32_16x16x32_bf16 v[200:203], a[40:43], v[108:111], v[200:203]
    ds_read_b128 v[156:159], v8 offset:23552
    ds_read_b128 v[160:163], v8 offset:24576
    v_mfma_f32_16x16x32_bf16 v[204:207], a[44:47], v[108:111], v[204:207]
    ds_read_b128 v[164:167], v8 offset:28672
    s_waitcnt lgkmcnt(10)
    v_mfma_f32_16x16x32_bf16 v[192:195], a[48:51], v[112:115], v[192:195]
    buffer_load_dwordx4 v9, s[8:11], s31 offen offset:2048 sc1 lds
    v_mfma_f32_16x16x32_bf16 v[196:199], a[52:55], v[112:115], v[196:199]
    ds_read_b128 v[168:171], v8 offset:25600
    ds_read_b128 v[172:175], v8 offset:29696
    v_mfma_f32_16x16x32_bf16 v[200:203], a[48:51], v[116:119], v[200:203]
    ds_read_b128 v[176:179], v8 offset:26624
    ds_read_b128 v[180:183], v8 offset:30720
    v_mfma_f32_16x16x32_bf16 v[204:207], a[52:55], v[116:119], v[204:207]
    buffer_load_dwordx4 v9, s[8:11], s31 offen offset:3072 sc1 lds
    v_mfma_f32_16x16x32_bf16 v[192:195], a[56:59], v[120:123], v[192:195]
    ds_read_b128 v[184:187], v8 offset:27648
    ds_read_b128 v[188:191], v8 offset:31744
    v_mfma_f32_16x16x32_bf16 v[196:199], a[60:63], v[120:123], v[196:199]
    buffer_load_dwordx4 v[12:15], v7, s[8:11], 0 offen sc1
    s_xor_b32 s36, s36, 0x10000
    v_mfma_f32_16x16x32_bf16 v[200:203], a[56:59], v[124:127], v[200:203]
    s_add_u32 s29, s29, 0x40000
    v_mfma_f32_16x16x32_bf16 v[204:207], a[60:63], v[124:127], v[204:207]
    s_waitcnt lgkmcnt(12)
    v_mfma_f32_16x16x32_bf16 v[192:195], a[64:67], v[128:131], v[192:195]
    s_sub_u32 s4, s28, 1
    s_max_i32 s4, s4, 0
    v_mfma_f32_16x16x32_bf16 v[196:199], a[68:71], v[128:131], v[196:199]
    v_mov_b32 v27, s4
    v_mfma_f32_16x16x32_bf16 v[200:203], a[64:67], v[132:135], v[200:203]
    s_mov_b64 exec, 1
    buffer_store_dword v27, v26, s[8:11], s94 offen sc1
    s_mov_b64 exec, -1
    v_mfma_f32_16x16x32_bf16 v[204:207], a[68:71], v[132:135], v[204:207]
    v_mfma_f32_16x16x32_bf16 v[192:195], a[72:75], v[136:139], v[192:195]
    buffer_store_dwordx4 v[208:211], v2, s[8:11], s30 offen offset:0 sc1
    v_mfma_f32_16x16x32_bf16 v[196:199], a[76:79], v[136:139], v[196:199]
    v_mfma_f32_16x16x32_bf16 v[200:203], a[72:75], v[140:143], v[200:203]
    buffer_store_dwordx4 v[212:215], v2, s[8:11], s30 offen offset:1024 sc1
    v_mfma_f32_16x16x32_bf16 v[204:207], a[76:79], v[140:143], v[204:207]
    s_xor_b32 s30, s28, s38
    s_waitcnt lgkmcnt(8)
    v_mfma_f32_16x16x32_bf16 v[192:195], a[80:83], v[144:147], v[192:195]
    s_lshl_b32 s30, s30, 11
    s_add_u32 s30, s30, s37
    v_mfma_f32_16x16x32_bf16 v[196:199], a[84:87], v[144:147], v[196:199]
    s_add_u32 s28, s28, 1
    v_mfma_f32_16x16x32_bf16 v[200:203], a[80:83], v[148:151], v[200:203]
    v_mfma_f32_16x16x32_bf16 v[204:207], a[84:87], v[148:151], v[204:207]
    v_mfma_f32_16x16x32_bf16 v[192:195], a[88:91], v[152:155], v[192:195]
    v_mfma_f32_16x16x32_bf16 v[196:199], a[92:95], v[152:155], v[196:199]
    v_mfma_f32_16x16x32_bf16 v[200:203], a[88:91], v[156:159], v[200:203]
    v_mfma_f32_16x16x32_bf16 v[204:207], a[92:95], v[156:159], v[204:207]
    s_waitcnt lgkmcnt(4)
    v_mfma_f32_16x16x32_bf16 v[192:195], a[96:99], v[160:163], v[192:195]
    v_mfma_f32_16x16x32_bf16 v[196:199], a[100:103], v[160:163], v[196:199]
    v_mfma_f32_16x16x32_bf16 v[200:203], a[96:99], v[164:167], v[200:203]
    s_waitcnt vmcnt(3)
    s_barrier
    v_mfma_f32_16x16x32_bf16 v[204:207], a[100:103], v[164:167], v[204:207]
    ds_read_b128 v[64:67], v8 offset:32768
    ds_read_b128 v[68:71], v8 offset:36864
    v_mfma_f32_16x16x32_bf16 v[192:195], a[104:107], v[168:171], v[192:195]
    ds_read_b128 v[72:75], v8 offset:33792
    ds_read_b128 v[76:79], v8 offset:37888
    v_mfma_f32_16x16x32_bf16 v[196:199], a[108:111], v[168:171], v[196:199]
    ds_read_b128 v[80:83], v8 offset:34816
    ds_read_b128 v[84:87], v8 offset:38912
    v_mfma_f32_16x16x32_bf16 v[200:203], a[104:107], v[172:175], v[200:203]
    ds_read_b128 v[88:91], v8 offset:35840
    ds_read_b128 v[92:95], v8 offset:39936
    v_mfma_f32_16x16x32_bf16 v[204:207], a[108:111], v[172:175], v[204:207]
    ds_read_b128 v[96:99], v8 offset:40960
    s_waitcnt lgkmcnt(9)
    v_mfma_f32_16x16x32_bf16 v[192:195], a[112:115], v[176:179], v[192:195]
    v_min3_u32 v4, v12, v13, v14
    v_min_u32 v4, v4, v15
    v_mfma_f32_16x16x32_bf16 v[196:199], a[116:119], v[176:179], v[196:199]
    ds_read_b128 v[100:103], v8 offset:45056
    ds_read_b128 v[104:107], v8 offset:41984
    v_mfma_f32_16x16x32_bf16 v[200:203], a[112:115], v[180:183], v[200:203]
    v_min_u32_dpp v4, v4, v4 quad_perm:[1,0,3,2] row_mask:0xf bank_mask:0xf
    ds_read_b128 v[108:111], v8 offset:46080
    v_mfma_f32_16x16x32_bf16 v[204:207], a[116:119], v[180:183], v[204:207]
    ds_read_b128 v[112:115], v8 offset:43008
    ds_read_b128 v[116:119], v8 offset:47104
    v_mfma_f32_16x16x32_bf16 v[192:195], a[120:123], v[184:187], v[192:195]
    v_min_u32_dpp v4, v4, v4 quad_perm:[2,3,0,1] row_mask:0xf bank_mask:0xf
    ds_read_b128 v[120:123], v8 offset:44032
    v_mfma_f32_16x16x32_bf16 v[196:199], a[124:127], v[184:187], v[196:199]
    ds_read_b128 v[124:127], v8 offset:48128
    ds_read_b128 v[128:131], v8 offset:49152
    v_mfma_f32_16x16x32_bf16 v[200:203], a[120:123], v[188:191], v[200:203]
    v_min_u32_dpp v4, v4, v4 row_half_mirror row_mask:0xf bank_mask:0xf
    ds_read_b128 v[132:135], v8 offset:53248
    v_mfma_f32_16x16x32_bf16 v[204:207], a[124:127], v[188:191], v[204:207]
    ds_read_b128 v[136:139], v8 offset:50176
    s_waitcnt lgkmcnt(15)
    v_mfma_f32_16x16x32_bf16 v[192:195], a[128:131], v[64:67], v[192:195]
    v_readfirstlane_b32 s33, v4
    ds_read_b128 v[140:143], v8 offset:54272
    v_mfma_f32_16x16x32_bf16 v[196:199], a[132:135], v[64:67], v[196:199]
    s_cmp_gt_u32 s33, s28
    s_cbranch_scc1 .hot_579
    v_mfma_f32_16x16x32_bf16 v[200:203], a[128:131], v[68:71], v[200:203]
    ds_read_b128 v[144:147], v8 offset:51200
    ds_read_b128 v[148:151], v8 offset:55296
    v_mfma_f32_16x16x32_bf16 v[204:207], a[132:135], v[68:71], v[204:207]
    ds_read_b128 v[152:155], v8 offset:52224
    ds_read_b128 v[156:159], v8 offset:56320
    v_mfma_f32_16x16x32_bf16 v[192:195], a[136:139], v[72:75], v[192:195]
    ds_read_b128 v[160:163], v8 offset:57344
    ds_read_b128 v[164:167], v8 offset:61440
    v_mfma_f32_16x16x32_bf16 v[196:199], a[140:143], v[72:75], v[196:199]
    ds_read_b128 v[168:171], v8 offset:58368
    ds_read_b128 v[172:175], v8 offset:62464
    v_mfma_f32_16x16x32_bf16 v[200:203], a[136:139], v[76:79], v[200:203]
    ds_read_b128 v[176:179], v8 offset:59392
    ds_read_b128 v[180:183], v8 offset:63488
    v_mfma_f32_16x16x32_bf16 v[204:207], a[140:143], v[76:79], v[204:207]
    ds_read_b128 v[184:187], v8 offset:60416
    s_waitcnt lgkmcnt(15)
    v_mfma_f32_16x16x32_bf16 v[192:195], a[144:147], v[80:83], v[192:195]
    ds_read_b128 v[188:191], v8 offset:64512
    v_xor_b32 v8, 0x10000, v8
    v_mfma_f32_16x16x32_bf16 v[196:199], a[148:151], v[80:83], v[196:199]
    v_mfma_f32_16x16x32_bf16 v[200:203], a[144:147], v[84:87], v[200:203]
    v_mfma_f32_16x16x32_bf16 v[204:207], a[148:151], v[84:87], v[204:207]
    v_mfma_f32_16x16x32_bf16 v[192:195], a[152:155], v[88:91], v[192:195]
    v_mfma_f32_16x16x32_bf16 v[196:199], a[156:159], v[88:91], v[196:199]
    v_mfma_f32_16x16x32_bf16 v[200:203], a[152:155], v[92:95], v[200:203]
    v_mfma_f32_16x16x32_bf16 v[204:207], a[156:159], v[92:95], v[204:207]
    v_mfma_f32_16x16x32_bf16 v[192:195], a[160:163], v[96:99], v[192:195]
    v_mfma_f32_16x16x32_bf16 v[196:199], a[164:167], v[96:99], v[196:199]
    v_mfma_f32_16x16x32_bf16 v[200:203], a[160:163], v[100:103], v[200:203]
    v_mfma_f32_16x16x32_bf16 v[204:207], a[164:167], v[100:103], v[204:207]
    v_mfma_f32_16x16x32_bf16 v[192:195], a[168:171], v[104:107], v[192:195]
    v_mfma_f32_16x16x32_bf16 v[196:199], a[172:175], v[104:107], v[196:199]
    v_mfma_f32_16x16x32_bf16 v[200:203], a[168:171], v[108:111], v[200:203]
    v_mfma_f32_16x16x32_bf16 v[204:207], a[172:175], v[108:111], v[204:207]
    v_mfma_f32_16x16x32_bf16 v[192:195], a[176:179], v[112:115], v[192:195]
    v_mfma_f32_16x16x32_bf16 v[196:199], a[180:183], v[112:115], v[196:199]
    v_mfma_f32_16x16x32_bf16 v[200:203], a[176:179], v[116:119], v[200:203]
    v_mfma_f32_16x16x32_bf16 v[204:207], a[180:183], v[116:119], v[204:207]
    v_mfma_f32_16x16x32_bf16 v[192:195], a[184:187], v[120:123], v[192:195]
    buffer_load_dwordx4 v[12:15], v7, s[8:11], 0 offen sc1
    v_mfma_f32_16x16x32_bf16 v[196:199], a[188:191], v[120:123], v[196:199]
    v_mfma_f32_16x16x32_bf16 v[200:203], a[184:187], v[124:127], v[200:203]
    v_mfma_f32_16x16x32_bf16 v[204:207], a[188:191], v[124:127], v[204:207]
    s_waitcnt lgkmcnt(12)
    v_mfma_f32_16x16x32_bf16 v[192:195], a[192:195], v[128:131], v[192:195]
    v_mfma_f32_16x16x32_bf16 v[196:199], a[196:199], v[128:131], v[196:199]
    v_mfma_f32_16x16x32_bf16 v[200:203], a[192:195], v[132:135], v[200:203]
    v_mfma_f32_16x16x32_bf16 v[204:207], a[196:199], v[132:135], v[204:207]
    v_mfma_f32_16x16x32_bf16 v[192:195], a[200:203], v[136:139], v[192:195]
    v_mfma_f32_16x16x32_bf16 v[196:199], a[204:207], v[136:139], v[196:199]
    v_mfma_f32_16x16x32_bf16 v[200:203], a[200:203], v[140:143], v[200:203]
    v_mfma_f32_16x16x32_bf16 v[204:207], a[204:207], v[140:143], v[204:207]
    s_waitcnt lgkmcnt(8)
    v_mfma_f32_16x16x32_bf16 v[192:195], a[208:211], v[144:147], v[192:195]
    v_mfma_f32_16x16x32_bf16 v[196:199], a[212:215], v[144:147], v[196:199]
    v_mfma_f32_16x16x32_bf16 v[200:203], a[208:211], v[148:151], v[200:203]
    v_mfma_f32_16x16x32_bf16 v[204:207], a[212:215], v[148:151], v[204:207]
    v_mfma_f32_16x16x32_bf16 v[192:195], a[216:219], v[152:155], v[192:195]
    v_mfma_f32_16x16x32_bf16 v[196:199], a[220:223], v[152:155], v[196:199]
    v_mfma_f32_16x16x32_bf16 v[200:203], a[216:219], v[156:159], v[200:203]
    v_mfma_f32_16x16x32_bf16 v[204:207], a[220:223], v[156:159], v[204:207]
    s_waitcnt lgkmcnt(4)
    v_mfma_f32_16x16x32_bf16 v[192:195], a[224:227], v[160:163], v[192:195]
    v_mfma_f32_16x16x32_bf16 v[196:199], a[228:231], v[160:163], v[196:199]
    v_mfma_f32_16x16x32_bf16 v[200:203], a[224:227], v[164:167], v[200:203]
    v_mfma_f32_16x16x32_bf16 v[204:207], a[228:231], v[164:167], v[204:207]
    v_mfma_f32_16x16x32_bf16 v[192:195], a[232:235], v[168:171], v[192:195]
    v_mfma_f32_16x16x32_bf16 v[196:199], a[236:239], v[168:171], v[196:199]
    v_mfma_f32_16x16x32_bf16 v[200:203], a[232:235], v[172:175], v[200:203]
    s_waitcnt vmcnt(0)
    v_min3_u32 v4, v12, v13, v14
    v_min_u32 v4, v4, v15
    v_mfma_f32_16x16x32_bf16 v[204:207], a[236:239], v[172:175], v[204:207]
    s_waitcnt lgkmcnt(0)
    v_mfma_f32_16x16x32_bf16 v[192:195], a[240:243], v[176:179], v[192:195]
    v_min_u32_dpp v4, v4, v4 quad_perm:[1,0,3,2] row_mask:0xf bank_mask:0xf
    v_mfma_f32_16x16x32_bf16 v[196:199], a[244:247], v[176:179], v[196:199]
    v_mfma_f32_16x16x32_bf16 v[200:203], a[240:243], v[180:183], v[200:203]
    v_min_u32_dpp v4, v4, v4 quad_perm:[2,3,0,1] row_mask:0xf bank_mask:0xf
    v_mfma_f32_16x16x32_bf16 v[204:207], a[244:247], v[180:183], v[204:207]
    v_mfma_f32_16x16x32_bf16 v[192:195], a[248:251], v[184:187], v[192:195]
    v_min_u32_dpp v4, v4, v4 row_half_mirror row_mask:0xf bank_mask:0xf
    v_mfma_f32_16x16x32_bf16 v[196:199], a[252:255], v[184:187], v[196:199]
    v_mfma_f32_16x16x32_bf16 v[200:203], a[248:251], v[188:191], v[200:203]
    v_readfirstlane_b32 s33, v4
    v_mfma_f32_16x16x32_bf16 v[204:207], a[252:255], v[188:191], v[204:207]
    s_cmp_gt_u32 s33, s28
    s_cbranch_scc1 .gx_581
    s_cmp_ge_u32 s28, 64
    s_cbranch_scc1 .last_585
    s_mov_b32 s39, 1
    s_nop 2
    v_cvt_pk_bf16_f32 v208, v192, v193
    v_cvt_pk_bf16_f32 v209, v194, v195
    v_cvt_pk_bf16_f32 v210, v196, v197
    v_cvt_pk_bf16_f32 v211, v198, v199
    v_cvt_pk_bf16_f32 v212, v200, v201
    v_cvt_pk_bf16_f32 v213, v202, v203
    v_cvt_pk_bf16_f32 v214, v204, v205
    v_cvt_pk_bf16_f32 v215, v206, v207
    s_branch .cold_576
.last_585:
    s_nop 3
    v_cvt_pk_bf16_f32 v208, v192, v193
    v_cvt_pk_bf16_f32 v209, v194, v195
    v_cvt_pk_bf16_f32 v210, v196, v197
    v_cvt_pk_bf16_f32 v211, v198, v199
    v_cvt_pk_bf16_f32 v212, v200, v201
    v_cvt_pk_bf16_f32 v213, v202, v203
    v_cvt_pk_bf16_f32 v214, v204, v205
    v_cvt_pk_bf16_f32 v215, v206, v207
    buffer_store_dwordx4 v[208:211], v2, s[8:11], s30 offen offset:0 sc1
    buffer_store_dwordx4 v[212:215], v2, s[8:11], s30 offen offset:1024 sc1
    s_mov_b32 s39, 0
    s_waitcnt vmcnt(0)
    v_mov_b32 v27, s28
    s_mov_b64 exec, 1
    buffer_store_dword v27, v26, s[8:11], s94 offen sc1
    s_mov_b64 exec, -1
    s_cmp_lt_u32 s28, 64
    s_cbranch_scc1 .cold_576
    s_endpgm
.gx_581:
    s_add_u32 m0, s36, 0
    s_add_u32 s31, s29, 0
    buffer_load_dwordx4 v9, s[8:11], s31 offen offset:0 sc1 lds
    buffer_load_dwordx4 v9, s[8:11], s31 offen offset:1024 sc1 lds
    buffer_load_dwordx4 v9, s[8:11], s31 offen offset:2048 sc1 lds
    buffer_load_dwordx4 v9, s[8:11], s31 offen offset:3072 sc1 lds
    s_add_u32 m0, s36, 16384
    s_add_u32 s31, s29, 16384
    buffer_load_dwordx4 v9, s[8:11], s31 offen offset:0 sc1 lds
    buffer_load_dwordx4 v9, s[8:11], s31 offen offset:1024 sc1 lds
    buffer_load_dwordx4 v9, s[8:11], s31 offen offset:2048 sc1 lds
    buffer_load_dwordx4 v9, s[8:11], s31 offen offset:3072 sc1 lds
    s_branch .cpy_584
.hot_579:
    v_mfma_f32_16x16x32_bf16 v[200:203], a[128:131], v[68:71], v[200:203]
    s_add_u32 m0, s36, 0
    s_add_u32 s31, s29, 0
    v_mfma_f32_16x16x32_bf16 v[204:207], a[132:135], v[68:71], v[204:207]
    buffer_load_dwordx4 v9, s[8:11], s31 offen offset:0 sc1 lds
    v_mfma_f32_16x16x32_bf16 v[192:195], a[136:139], v[72:75], v[192:195]
    ds_read_b128 v[144:147], v8 offset:51200
    ds_read_b128 v[148:151], v8 offset:55296
    v_mfma_f32_16x16x32_bf16 v[196:199], a[140:143], v[72:75], v[196:199]
    ds_read_b128 v[152:155], v8 offset:52224
    ds_read_b128 v[156:159], v8 offset:56320
    v_mfma_f32_16x16x32_bf16 v[200:203], a[136:139], v[76:79], v[200:203]
    ds_read_b128 v[160:163], v8 offset:57344
    ds_read_b128 v[164:167], v8 offset:61440
    v_mfma_f32_16x16x32_bf16 v[204:207], a[140:143], v[76:79], v[204:207]
    ds_read_b128 v[168:171], v8 offset:58368
    s_waitcnt lgkmcnt(15)
    v_mfma_f32_16x16x32_bf16 v[192:195], a[144:147], v[80:83], v[192:195]
    buffer_load_dwordx4 v9, s[8:11], s31 offen offset:1024 sc1 lds
    v_mfma_f32_16x16x32_bf16 v[196:199], a[148:151], v[80:83], v[196:199]
    ds_read_b128 v[172:175], v8 offset:62464
    ds_read_b128 v[176:179], v8 offset:59392
    v_mfma_f32_16x16x32_bf16 v[200:203], a[144:147], v[84:87], v[200:203]
    ds_read_b128 v[180:183], v8 offset:63488
    ds_read_b128 v[184:187], v8 offset:60416
    v_mfma_f32_16x16x32_bf16 v[204:207], a[148:151], v[84:87], v[204:207]
    ds_read_b128 v[188:191], v8 offset:64512
    v_xor_b32 v8, 0x10000, v8
    v_mfma_f32_16x16x32_bf16 v[192:195], a[152:155], v[88:91], v[192:195]
    v_mfma_f32_16x16x32_bf16 v[196:199], a[156:159], v[88:91], v[196:199]
    buffer_load_dwordx4 v9, s[8:11], s31 offen offset:2048 sc1 lds
    v_mfma_f32_16x16x32_bf16 v[200:203], a[152:155], v[92:95], v[200:203]
    v_mfma_f32_16x16x32_bf16 v[204:207], a[156:159], v[92:95], v[204:207]
    v_mfma_f32_16x16x32_bf16 v[192:195], a[160:163], v[96:99], v[192:195]
    v_mfma_f32_16x16x32_bf16 v[196:199], a[164:167], v[96:99], v[196:199]
    v_mfma_f32_16x16x32_bf16 v[200:203], a[160:163], v[100:103], v[200:203]
    buffer_load_dwordx4 v9, s[8:11], s31 offen offset:3072 sc1 lds
    v_mfma_f32_16x16x32_bf16 v[204:207], a[164:167], v[100:103], v[204:207]
    v_mfma_f32_16x16x32_bf16 v[192:195], a[168:171], v[104:107], v[192:195]
    v_mfma_f32_16x16x32_bf16 v[196:199], a[172:175], v[104:107], v[196:199]
    v_mfma_f32_16x16x32_bf16 v[200:203], a[168:171], v[108:111], v[200:203]
    v_mfma_f32_16x16x32_bf16 v[204:207], a[172:175], v[108:111], v[204:207]
    s_waitcnt lgkmcnt(15)
    v_mfma_f32_16x16x32_bf16 v[192:195], a[176:179], v[112:115], v[192:195]
    s_add_u32 m0, s36, 16384
    s_add_u32 s31, s29, 16384
    v_mfma_f32_16x16x32_bf16 v[196:199], a[180:183], v[112:115], v[196:199]
    buffer_load_dwordx4 v9, s[8:11], s31 offen offset:0 sc1 lds
    v_mfma_f32_16x16x32_bf16 v[200:203], a[176:179], v[116:119], v[200:203]
    v_mfma_f32_16x16x32_bf16 v[204:207], a[180:183], v[116:119], v[204:207]
    v_mfma_f32_16x16x32_bf16 v[192:195], a[184:187], v[120:123], v[192:195]
    v_mfma_f32_16x16x32_bf16 v[196:199], a[188:191], v[120:123], v[196:199]
    v_mfma_f32_16x16x32_bf16 v[200:203], a[184:187], v[124:127], v[200:203]
    buffer_load_dwordx4 v9, s[8:11], s31 offen offset:1024 sc1 lds
    v_mfma_f32_16x16x32_bf16 v[204:207], a[188:191], v[124:127], v[204:207]
    s_waitcnt lgkmcnt(12)
    v_mfma_f32_16x16x32_bf16 v[192:195], a[192:195], v[128:131], v[192:195]
    v_mfma_f32_16x16x32_bf16 v[196:199], a[196:199], v[128:131], v[196:199]
    v_mfma_f32_16x16x32_bf16 v[200:203], a[192:195], v[132:135], v[200:203]
    v_mfma_f32_16x16x32_bf16 v[204:207], a[196:199], v[132:135], v[204:207]
    buffer_load_dwordx4 v9, s[8:11], s31 offen offset:2048 sc1 lds
    v_mfma_f32_16x16x32_bf16 v[192:195], a[200:203], v[136:139], v[192:195]
    v_mfma_f32_16x16x32_bf16 v[196:199], a[204:207], v[136:139], v[196:199]
    v_mfma_f32_16x16x32_bf16 v[200:203], a[200:203], v[140:143], v[200:203]
    v_mfma_f32_16x16x32_bf16 v[204:207], a[204:207], v[140:143], v[204:207]
    s_waitcnt lgkmcnt(8)
    v_mfma_f32_16x16x32_bf16 v[192:195], a[208:211], v[144:147], v[192:195]
    buffer_load_dwordx4 v9, s[8:11], s31 offen offset:3072 sc1 lds
    v_mfma_f32_16x16x32_bf16 v[196:199], a[212:215], v[144:147], v[196:199]
    v_mfma_f32_16x16x32_bf16 v[200:203], a[208:211], v[148:151], v[200:203]
    v_mfma_f32_16x16x32_bf16 v[204:207], a[212:215], v[148:151], v[204:207]
    v_mfma_f32_16x16x32_bf16 v[192:195], a[216:219], v[152:155], v[192:195]
    v_mfma_f32_16x16x32_bf16 v[196:199], a[220:223], v[152:155], v[196:199]
    v_mfma_f32_16x16x32_bf16 v[200:203], a[216:219], v[156:159], v[200:203]
    v_mfma_f32_16x16x32_bf16 v[204:207], a[220:223], v[156:159], v[204:207]
    s_waitcnt lgkmcnt(4)
    v_mfma_f32_16x16x32_bf16 v[192:195], a[224:227], v[160:163], v[192:195]
    v_mfma_f32_16x16x32_bf16 v[196:199], a[228:231], v[160:163], v[196:199]
    v_mfma_f32_16x16x32_bf16 v[200:203], a[224:227], v[164:167], v[200:203]
    v_mfma_f32_16x16x32_bf16 v[204:207], a[228:231], v[164:167], v[204:207]
    v_mfma_f32_16x16x32_bf16 v[192:195], a[232:235], v[168:171], v[192:195]
    v_mfma_f32_16x16x32_bf16 v[196:199], a[236:239], v[168:171], v[196:199]
    v_mfma_f32_16x16x32_bf16 v[200:203], a[232:235], v[172:175], v[200:203]
    v_mfma_f32_16x16x32_bf16 v[204:207], a[236:239], v[172:175], v[204:207]
    s_waitcnt lgkmcnt(0)
    v_mfma_f32_16x16x32_bf16 v[192:195], a[240:243], v[176:179], v[192:195]
    v_mfma_f32_16x16x32_bf16 v[196:199], a[244:247], v[176:179], v[196:199]
    v_mfma_f32_16x16x32_bf16 v[200:203], a[240:243], v[180:183], v[200:203]
    v_mfma_f32_16x16x32_bf16 v[204:207], a[244:247], v[180:183], v[204:207]
    v_mfma_f32_16x16x32_bf16 v[192:195], a[248:251], v[184:187], v[192:195]
    v_mfma_f32_16x16x32_bf16 v[196:199], a[252:255], v[184:187], v[196:199]
    v_mfma_f32_16x16x32_bf16 v[200:203], a[248:251], v[188:191], v[200:203]
    v_mfma_f32_16x16x32_bf16 v[204:207], a[252:255], v[188:191], v[204:207]
.cpy_584:
    s_mov_b32 s39, 1
    s_nop 2
    v_cvt_pk_bf16_f32 v208, v192, v193
    v_cvt_pk_bf16_f32 v209, v194, v195
    v_cvt_pk_bf16_f32 v210, v196, v197
    v_cvt_pk_bf16_f32 v211, v198, v199
    v_cvt_pk_bf16_f32 v212, v200, v201
    v_cvt_pk_bf16_f32 v213, v202, v203
    v_cvt_pk_bf16_f32 v214, v204, v205
    v_cvt_pk_bf16_f32 v215, v206, v207
    s_branch .body_578
.pd_582:
.fin_413:
    s_load_dwordx2 s[44:45], s[0:1], 112
    s_sub_u32 s34, s98, 1
    s_lshl_b32 s4, s34, 10
    s_lshr_b32 s5, s99, 2
    s_lshl_b32 s5, s5, 22
    s_add_u32 s4, s4, s5
    s_and_b32 s5, s99, 3
    s_lshl_b32 s5, s5, 18
    s_add_u32 s4, s4, s5
    s_lshl_b32 s38, s99, 1
    v_lshlrev_b32 v2, 4, v1
    v_add_u32 v2, s4, v2
    s_lshl_b32 s4, s34, 15
    s_lshl_b32 s5, s99, 6
    s_add_u32 s4, s4, s5
    v_bfe_u32 v254, v1, 0, 4
    v_mul_u32_u24 v13, 2048, v254
    v_bfe_u32 v254, v1, 4, 2
    v_mul_u32_u24 v254, 16, v254
    v_add_u32 v13, v13, v254
    v_add_u32 v13, s4, v13
    s_lshl_b32 s4, s99, 17
    s_lshl_b32 s5, s34, 10
    s_add_u32 s4, s4, s5
    v_bfe_u32 v254, v1, 4, 2
    v_mul_u32_u24 v14, 32768, v254
    v_bfe_u32 v254, v1, 3, 1
    v_mul_u32_u24 v254, 512, v254
    v_add_u32 v14, v14, v254
    v_bfe_u32 v254, v1, 0, 3
    v_mul_u32_u24 v254, 2, v254
    v_add_u32 v14, v14, v254
    v_add_u32 v14, s4, v14
    v_add_u32 v15, 4096, v14
    v_add_u32 v16, 8192, v14
    v_add_u32 v17, 12288, v14
    v_add_u32 v18, 16384, v14
    v_add_u32 v19, 20480, v14
    v_add_u32 v20, 24576, v14
    v_add_u32 v21, 28672, v14
    s_lshl_b32 s4, s34, 6
    v_bfe_u32 v254, v1, 0, 4
    v_mul_u32_u24 v22, 4, v254
    v_add_u32 v22, s4, v22
    s_lshl_b32 s4, s99, 9
    s_add_u32 s4, s4, 92323840
    v_bfe_u32 v254, v1, 0, 2
    v_mul_u32_u24 v7, 128, v254
    v_add_u32 v7, s4, v7
    s_mov_b32 s28, s24
    s_mov_b32 s33, 0
    s_waitcnt lgkmcnt(0)
    s_mov_b32 s84, s44
    s_and_b32 s85, s45, 0xffff
    s_mov_b32 s86, 0x400000
    s_mov_b32 s87, 0x00020000
    s_xor_b32 s5, s94, 49152
    s_mov_b32 s62, 0
.pw_586:
    buffer_load_dword v4, v5, s[8:11], s5 offen offset:4 sc1
    s_add_u32 s62, s62, 1
    s_cmp_gt_u32 s62, 0x200000
    s_cbranch_scc1 .mg_end_1
    s_waitcnt vmcnt(0)
    v_readfirstlane_b32 s4, v4
    s_cmp_lg_u32 s4, 0
    s_cbranch_scc1 .pw_587
    s_sleep 8
    s_branch .pw_586
.pw_587:
    s_mov_b32 s62, 0
    v_mov_b32 v5, 0
.wc_588:
    buffer_load_dword v4, v5, s[20:23], 0 offen offset:192 sc1
    s_add_u32 s62, s62, 1
    s_cmp_gt_u32 s62, 0x200000
    s_cbranch_scc1 .mg_end_1
    s_waitcnt vmcnt(0)
    v_readfirstlane_b32 s4, v4
    s_cmp_ge_u32 s4, 64
    s_cbranch_scc1 .wd_589
    s_sleep 64
    s_branch .wc_588
.wd_589:
.fl_590:
    s_lshl_b32 s57, s28, 16
    s_and_b32 s4, s28, 31
    s_lshl_b32 s4, s4, 4
    s_lshr_b32 s5, s28, 5
    s_lshl_b32 s5, s5, 11
    s_add_u32 s58, s4, s5
    s_add_u32 s58, s58, 130023424
    s_lshl_b32 s59, s28, 7
    s_add_u32 s59, s59, 121634816
    buffer_load_dwordx4 v[32:35], v13, s[12:15], s57 offen
    buffer_load_dword v44, v22, s[8:11], s59 offen
    buffer_load_ushort v36, v14, s[8:11], s58 offen
    buffer_load_ushort v37, v15, s[8:11], s58 offen
    buffer_load_ushort v38, v16, s[8:11], s58 offen
    buffer_load_ushort v39, v17, s[8:11], s58 offen
    buffer_load_ushort v40, v18, s[8:11], s58 offen
    buffer_load_ushort v41, v19, s[8:11], s58 offen
    buffer_load_ushort v42, v20, s[8:11], s58 offen
    buffer_load_ushort v43, v21, s[8:11], s58 offen
    s_xor_b32 s48, s28, s38
    s_lshl_b32 s48, s48, 11
    s_add_u32 s48, s48, 150994944
    s_xor_b32 s49, s48, 1050624
    s_add_u32 s50, s48, 0x200000
    s_add_u32 s51, s49, 0x200000
    s_cmp_gt_u32 s33, s28
    s_cbranch_scc1 .fd_592
    s_mov_b32 s62, 0
.fp_591:
    buffer_load_dword v4, v7, s[8:11], 0 offen sc1
    s_add_u32 s62, s62, 1
    s_cmp_gt_u32 s62, 0x200000
    s_cbranch_scc1 .mg_end_1
    s_waitcnt vmcnt(0)
    v_min_u32_dpp v4, v4, v4 quad_perm:[1,0,3,2] row_mask:0xf bank_mask:0xf
    s_nop 1
    v_min_u32_dpp v4, v4, v4 quad_perm:[2,3,0,1] row_mask:0xf bank_mask:0xf
    s_nop 1
    v_readfirstlane_b32 s33, v4
    s_cmp_gt_u32 s33, s28
    s_cbranch_scc1 .fd_592
    s_sleep 2
    s_add_u32 s4, s33, 1
    s_cmp_ge_u32 s4, s28
    s_cbranch_scc1 .fp_591
    s_sleep 12
    s_branch .fp_591
.fd_592:
    buffer_load_dwordx4 v[96:99], v2, s[8:11], s48 offen
    buffer_load_dwordx4 v[100:103], v2, s[8:11], s49 offen
    buffer_load_dwordx4 v[104:107], v2, s[8:11], s50 offen
    buffer_load_dwordx4 v[108:111], v2, s[8:11], s51 offen
    s_waitcnt vmcnt(4)
    v_lshlrev_b32 v48, 16, v32
    v_lshlrev_b32 v36, 16, v36
    v_and_b32 v49, 0xffff0000, v32
    v_lshlrev_b32 v37, 16, v37
    v_lshlrev_b32 v50, 16, v33
    v_lshlrev_b32 v38, 16, v38
    v_and_b32 v51, 0xffff0000, v33
    v_lshlrev_b32 v39, 16, v39
    v_lshlrev_b32 v52, 16, v34
    v_lshlrev_b32 v40, 16, v40
    v_and_b32 v53, 0xffff0000, v34
    v_lshlrev_b32 v41, 16, v41
    v_lshlrev_b32 v54, 16, v35
    v_lshlrev_b32 v42, 16, v42
    v_and_b32 v55, 0xffff0000, v35
    v_lshlrev_b32 v43, 16, v43
    v_mul_f32 v48, v48, v36
    v_mul_f32 v49, v49, v37
    v_mul_f32 v50, v50, v38
    v_mul_f32 v51, v51, v39
    v_mul_f32 v52, v52, v40
    v_mul_f32 v53, v53, v41
    v_mul_f32 v54, v54, v42
    v_mul_f32 v55, v55, v43
    v_mul_f32 v48, v48, v44
    v_mul_f32 v49, v49, v44
    v_mul_f32 v50, v50, v44
    v_mul_f32 v51, v51, v44
    v_mul_f32 v52, v52, v44
    v_mul_f32 v53, v53, v44
    v_mul_f32 v54, v54, v44
    v_mul_f32 v55, v55, v44
    v_sub_f32 v44, 1.0, v44
    s_waitcnt vmcnt(3)
    v_lshlrev_b32 v64, 16, v96
    v_and_b32 v65, 0xffff0000, v96
    v_lshlrev_b32 v66, 16, v97
    v_and_b32 v67, 0xffff0000, v97
    v_lshlrev_b32 v68, 16, v98
    v_and_b32 v69, 0xffff0000, v98
    v_lshlrev_b32 v70, 16, v99
    v_and_b32 v71, 0xffff0000, v99
    s_waitcnt vmcnt(2)
    v_lshlrev_b32 v72, 16, v100
    v_and_b32 v73, 0xffff0000, v100
    v_lshlrev_b32 v74, 16, v101
    v_and_b32 v75, 0xffff0000, v101
    v_lshlrev_b32 v76, 16, v102
    v_and_b32 v77, 0xffff0000, v102
    v_lshlrev_b32 v78, 16, v103
    v_and_b32 v79, 0xffff0000, v103
    v_pk_add_f32 v[64:65], v[64:65], v[72:73]
    v_pk_add_f32 v[66:67], v[66:67], v[74:75]
    v_pk_add_f32 v[68:69], v[68:69], v[76:77]
    v_pk_add_f32 v[70:71], v[70:71], v[78:79]
    s_waitcnt vmcnt(1)
    v_lshlrev_b32 v80, 16, v104
    v_and_b32 v81, 0xffff0000, v104
    v_lshlrev_b32 v82, 16, v105
    v_and_b32 v83, 0xffff0000, v105
    v_lshlrev_b32 v84, 16, v106
    v_and_b32 v85, 0xffff0000, v106
    v_lshlrev_b32 v86, 16, v107
    v_and_b32 v87, 0xffff0000, v107
    v_pk_add_f32 v[64:65], v[64:65], v[80:81]
    v_pk_add_f32 v[66:67], v[66:67], v[82:83]
    v_pk_add_f32 v[68:69], v[68:69], v[84:85]
    v_pk_add_f32 v[70:71], v[70:71], v[86:87]
    s_waitcnt vmcnt(0)
    v_lshlrev_b32 v88, 16, v108
    v_and_b32 v89, 0xffff0000, v108
    v_lshlrev_b32 v90, 16, v109
    v_and_b32 v91, 0xffff0000, v109
    v_lshlrev_b32 v92, 16, v110
    v_and_b32 v93, 0xffff0000, v110
    v_lshlrev_b32 v94, 16, v111
    v_and_b32 v95, 0xffff0000, v111
    v_pk_add_f32 v[64:65], v[64:65], v[88:89]
    v_pk_add_f32 v[66:67], v[66:67], v[90:91]
    v_pk_add_f32 v[68:69], v[68:69], v[92:93]
    v_pk_add_f32 v[70:71], v[70:71], v[94:95]
    v_fma_f32 v64, v64, v44, v48
    v_fma_f32 v65, v65, v44, v49
    v_fma_f32 v66, v66, v44, v50
    v_fma_f32 v67, v67, v44, v51
    v_fma_f32 v68, v68, v44, v52
    v_fma_f32 v69, v69, v44, v53
    v_fma_f32 v70, v70, v44, v54
    v_fma_f32 v71, v71, v44, v55
    v_cvt_pk_bf16_f32 v56, v64, v65
    v_cvt_pk_bf16_f32 v57, v66, v67
    v_cvt_pk_bf16_f32 v58, v68, v69
    v_cvt_pk_bf16_f32 v59, v70, v71
    buffer_store_dwordx4 v[56:59], v13, s[84:87], s57 offen
    s_add_u32 s28, s28, 4
    s_cmp_lt_u32 s28, 64
    s_cbranch_scc1 .fl_590
    s_endpgm
.mg_end_1:
    s_endpgm
.section .rodata,"a"
.p2align 6
.amdhsa_kernel mega_kernel
  .amdhsa_next_free_vgpr 512
  .amdhsa_next_free_sgpr 102
  .amdhsa_accum_offset 256
  .amdhsa_group_segment_fixed_size 0
  .amdhsa_kernarg_size 136
  .amdhsa_user_sgpr_count 2
  .amdhsa_user_sgpr_kernarg_segment_ptr 1
  .amdhsa_system_sgpr_workgroup_id_x 1
.end_amdhsa_kernel
```

```asm
; @launch kernel=mega_kernel grid=(256,1,1) block=(256,1,1) lds=163840
.amdgcn_target "amdgcn-amd-amdhsa--gfx950"
.text
.globl mega_kernel
.p2align 8
.type mega_kernel,@function
mega_kernel:
    s_cmp_ge_u32 s2, 256
    s_cbranch_scc1 .mg_end_1
    s_load_dwordx4 s[52:55], s[0:1], 120
    s_getreg_b32 s3, hwreg(HW_REG_XCC_ID)
    v_and_b32 v1, 63, v0
    v_lshrrev_b32 v4, 6, v0
    s_and_b32 s3, s3, 7
    v_readfirstlane_b32 s24, v4
    s_waitcnt lgkmcnt(0)
    s_mov_b32 s8, s54
    s_and_b32 s9, s55, 0xffff
    s_mov_b32 s10, 0x10000000
    s_mov_b32 s11, 0x00020000
    s_mov_b32 s20, s52
    s_and_b32 s21, s53, 0xffff
    s_mov_b32 s22, 0x100
    s_mov_b32 s23, 0x00020000
    s_mov_b32 s100, s54
    v_mov_b32 v7, 163832
    s_cmp_lg_u32 s24, 0
    s_cbranch_scc1 .noat_4
    s_mov_b64 exec, 1
    v_mov_b32 v5, 1
    s_lshl_b32 s4, s3, 3
    s_mov_b32 s6, 0x60402000
    s_mov_b32 s7, 0xe4e08480
    s_lshr_b64 s[6:7], s[6:7], s4
    s_and_b32 s4, s6, 0xff
    v_mov_b32 v6, s4
    buffer_atomic_add v5, v6, s[20:23], 0 offen sc0 sc1
    s_mov_b64 exec, -1
.noat_4:
    s_sub_u32 s101, 0, s100
    s_and_b32 s101, s101, 0x1fffff
    s_add_u32 s101, s101, 184549376
    s_lshl_b32 s4, s2, 2
    s_add_u32 s4, s4, s24
    s_lshl_b32 s5, s4, 11
    s_add_u32 s5, s5, s101
    v_lshlrev_b32 v8, 4, v1
    v_mov_b32 v20, -1
    v_mov_b32 v21, -1
    v_mov_b32 v22, -1
    v_mov_b32 v23, -1
    s_lshl_b32 s4, s4, 10
    s_add_u32 s4, s4, 83886080
    buffer_store_dwordx4 v[20:23], v8, s[8:11], s5 offen sc1
    buffer_store_dwordx4 v[20:23], v8, s[8:11], s5 offen offset:1024 sc1
    buffer_store_dwordx4 v[20:23], v8, s[8:11], s4 offen sc1
    s_cmp_eq_u32 s24, 2
    s_cselect_b32 s6, s2, -1
    s_cmp_ge_u32 s6, 128
    s_cbranch_scc1 .nr_7
    s_lshl_b32 s6, s6, 10
    s_add_u32 s6, s6, 84934656
    buffer_store_dwordx4 v[20:23], v8, s[8:11], s6 offen sc1
.nr_7:
    s_cmp_eq_u32 s24, 3
    s_cselect_b32 s6, s2, -1
    s_cmp_ge_u32 s6, 72
    s_cbranch_scc1 .nf_5
    v_mov_b32 v24, 0
    v_mov_b32 v25, 0
    v_mov_b32 v26, 0
    v_mov_b32 v27, 0
    s_lshl_b32 s6, s6, 10
    s_add_u32 s6, s6, 92274688
    buffer_store_dwordx4 v[24:27], v8, s[8:11], s6 offen sc1
.nf_5:
    s_cmp_lg_u32 s24, 0
    s_cbranch_scc1 .nw_6
    s_mov_b64 exec, 1
    s_waitcnt vmcnt(3)
    ds_write_b32 v7, v5
    s_waitcnt lgkmcnt(0)
    s_mov_b64 exec, -1
.nw_6:
    s_barrier
    ds_read_b32 v5, v7
    s_mov_b32 s25, s3
    s_mov_b32 s27, 0
    s_waitcnt lgkmcnt(0)
    v_readfirstlane_b32 s26, v5
    s_cmp_ge_u32 s26, 32
    s_cselect_b32 s3, 0x10001, 1
    s_and_b32 s26, s26, 31
.mg_role_3:
    s_cmp_ge_u32 s25, 4
    s_cbranch_scc1 .mg_bg_2
    s_load_dwordx8 s[84:91], s[0:1], 64
    s_load_dwordx2 s[40:41], s[0:1], 56
    v_and_b32 v1, 63, v0
    s_lshl_b32 s4, s25, 4
    s_andn2_b32 s5, 8, s26
    s_or_b32 s4, s4, s5
    s_cbranch_scc1 .nocal_8
    s_cmp_lg_u32 s24, 3
    s_cbranch_scc1 .calb_9
    s_lshr_b32 s4, s26, 1
    s_and_b32 s4, s4, 8
    s_and_b32 s5, s26, 7
    s_or_b32 s4, s4, s5
    s_lshl_b32 s5, s4, 21
    s_add_u32 s5, s5, s101
    s_mov_b64 exec, 1
    v_mov_b32 v4, -1
    v_mov_b32 v5, 0
    s_mov_b32 s7, 0xffff
    s_mov_b32 s6, 0xffff
    s_memtime s[72:73]
    s_waitcnt lgkmcnt(0)
    buffer_store_dword v4, v5, s[8:11], s5 offen sc1
    s_waitcnt vmcnt(0)
    s_memtime s[74:75]
    s_waitcnt lgkmcnt(0)
    s_sub_u32 s74, s74, s72
    s_min_u32 s7, s7, s74
    v_xor_b32 v5, 0x2000, v5
    s_memtime s[72:73]
    s_waitcnt lgkmcnt(0)
    buffer_store_dword v4, v5, s[8:11], s5 offen sc1
    s_waitcnt vmcnt(0)
    s_memtime s[74:75]
    s_waitcnt lgkmcnt(0)
    s_sub_u32 s74, s74, s72
    s_min_u32 s6, s6, s74
    v_xor_b32 v5, 0x2000, v5
    s_memtime s[72:73]
    s_waitcnt lgkmcnt(0)
    buffer_store_dword v4, v5, s[8:11], s5 offen sc1
    s_waitcnt vmcnt(0)
    s_memtime s[74:75]
    s_waitcnt lgkmcnt(0)
    s_sub_u32 s74, s74, s72
    s_min_u32 s7, s7, s74
    v_xor_b32 v5, 0x2000, v5
    s_memtime s[72:73]
    s_waitcnt lgkmcnt(0)
    buffer_store_dword v4, v5, s[8:11], s5 offen sc1
    s_waitcnt vmcnt(0)
    s_memtime s[74:75]
    s_waitcnt lgkmcnt(0)
    s_sub_u32 s74, s74, s72
    s_min_u32 s6, s6, s74
    v_xor_b32 v5, 0x2000, v5
    s_memtime s[72:73]
    s_waitcnt lgkmcnt(0)
    buffer_store_dword v4, v5, s[8:11], s5 offen sc1
    s_waitcnt vmcnt(0)
    s_memtime s[74:75]
    s_waitcnt lgkmcnt(0)
    s_sub_u32 s74, s74, s72
    s_min_u32 s7, s7, s74
    v_xor_b32 v5, 0x2000, v5
    s_cmp_lt_u32 s6, s7
    s_cselect_b32 s7, 2, 1
    v_mov_b32 v5, 0
    s_lshr_b32 s5, s4, 3
    s_and_b32 s4, s4, 7
    s_lshl_b32 s4, s4, 1
    s_or_b32 s4, s4, s5
    s_lshl_b32 s5, s4, 1
    s_add_u32 s5, s5, 160
    v_mov_b32 v4, s7
    buffer_store_short v4, v5, s[20:23], s5 offen sc1
    s_mov_b64 exec, -1
.calb_9:
    s_barrier
.nocal_8:
    s_lshl_b32 s4, s25, 11
    s_lshl_b32 s5, s26, 6
    s_add_u32 s4, s4, s5
    s_lshl_b32 s6, s24, 21
    s_add_u32 s4, s4, s6
    s_lshl_b32 s7, s25, 21
    s_lshl_b32 s6, s24, 19
    s_add_u32 s7, s7, s6
    s_add_u32 s7, s7, s5
    s_lshl_b32 s6, s24, 15
    v_bfe_u32 v4, v1, 4, 1
    v_lshlrev_b32 v4, 1, v4
    v_and_b32 v5, 3, v1
    v_xor_b32 v4, v4, v5
    v_lshlrev_b32 v4, 4, v4
    v_bfe_u32 v254, v1, 2, 1
    v_mul_u32_u24 v5, 1, v254
    v_bfe_u32 v254, v1, 3, 1
    v_mul_u32_u24 v254, 8, v254
    v_add_u32 v5, v5, v254
    v_bfe_u32 v254, v1, 4, 1
    v_mul_u32_u24 v254, 4, v254
    v_add_u32 v5, v5, v254
    v_bfe_u32 v254, v1, 5, 1
    v_mul_u32_u24 v254, 2, v254
    v_add_u32 v5, v5, v254
    v_lshlrev_b32 v6, 13, v5
    v_add_u32 v6, v6, v4
    v_add_u32 v240, s4, v6
    v_lshlrev_b32 v6, 11, v5
    v_add_u32 v6, v6, v4
    v_add_u32 v241, s7, v6
    v_xor_b32 v241, 256, v241
    v_bfe_u32 v254, v1, 2, 2
    v_mul_u32_u24 v242, 64, v254
    v_bfe_u32 v254, v1, 4, 1
    v_mul_u32_u24 v254, 288, v254
    v_add_u32 v242, v242, v254
    v_bfe_u32 v254, v1, 5, 1
    v_mul_u32_u24 v254, 1024, v254
    v_add_u32 v242, v242, v254
    v_bfe_u32 v254, v1, 0, 2
    v_mul_u32_u24 v254, 8, v254
    v_add_u32 v242, v242, v254
    v_add_u32 v242, s6, v242
    v_xor_b32 v243, 32, v242
    s_waitcnt lgkmcnt(0)
    s_mov_b32 s16, s84
    s_and_b32 s17, s85, 0xffff
    s_mov_b32 s18, 0x800000
    s_mov_b32 s19, 0x00020000
    v_xor_b32 v240, 128, v240
    s_and_b32 s4, s26, 1
    s_lshl_b32 s98, s4, 11
    s_lshl_b32 s99, s4, 18
    s_add_u32 s98, s98, s6
    s_xor_b32 m0, s98, 0
    s_xor_b32 s5, s99, 0
    buffer_load_dwordx4 v240, s[16:19], s5 offen nt lds
    s_xor_b32 m0, s98, 1024
    s_xor_b32 s5, s99, 131072
    buffer_load_dwordx4 v240, s[16:19], s5 offen nt lds
    s_xor_b32 m0, s98, 2048
    s_xor_b32 s5, s99, 262144
    buffer_load_dwordx4 v240, s[16:19], s5 offen nt lds
    s_xor_b32 m0, s98, 3072
    s_xor_b32 s5, s99, 393216
    buffer_load_dwordx4 v240, s[16:19], s5 offen nt lds
    s_xor_b32 m0, s98, 4096
    s_xor_b32 s5, s99, 524288
    buffer_load_dwordx4 v240, s[16:19], s5 offen nt lds
    s_xor_b32 m0, s98, 5120
    s_xor_b32 s5, s99, 655360
    buffer_load_dwordx4 v240, s[16:19], s5 offen nt lds
    s_xor_b32 m0, s98, 6144
    s_xor_b32 s5, s99, 786432
    buffer_load_dwordx4 v240, s[16:19], s5 offen nt lds
    s_xor_b32 m0, s98, 7168
    s_xor_b32 s5, s99, 917504
    buffer_load_dwordx4 v240, s[16:19], s5 offen nt lds
    s_xor_b32 m0, s98, 8192
    s_xor_b32 s5, s99, 1048576
    buffer_load_dwordx4 v240, s[16:19], s5 offen nt lds
    s_xor_b32 m0, s98, 9216
    s_xor_b32 s5, s99, 1179648
    buffer_load_dwordx4 v240, s[16:19], s5 offen nt lds
    s_xor_b32 m0, s98, 10240
    s_xor_b32 s5, s99, 1310720
    buffer_load_dwordx4 v240, s[16:19], s5 offen nt lds
    s_xor_b32 m0, s98, 11264
    s_xor_b32 s5, s99, 1441792
    buffer_load_dwordx4 v240, s[16:19], s5 offen nt lds
    s_xor_b32 m0, s98, 12288
    s_xor_b32 s5, s99, 1572864
    buffer_load_dwordx4 v240, s[16:19], s5 offen nt lds
    s_xor_b32 m0, s98, 13312
    s_xor_b32 s5, s99, 1703936
    buffer_load_dwordx4 v240, s[16:19], s5 offen nt lds
    s_xor_b32 m0, s98, 14336
    s_xor_b32 s5, s99, 1835008
    buffer_load_dwordx4 v240, s[16:19], s5 offen nt lds
    s_xor_b32 m0, s98, 15360
    s_xor_b32 s5, s99, 1966080
    buffer_load_dwordx4 v240, s[16:19], s5 offen nt lds
    s_waitcnt vmcnt(16)
    s_barrier
    s_cmp_lg_u32 s24, 1
    s_cbranch_scc1 .ns_10
    s_mov_b64 exec, 1
    v_mov_b32 v238, s3
    v_mov_b32 v239, 0
    buffer_atomic_add v238, v239, s[20:23], 0 offen offset:196 sc1
    s_mov_b64 exec, -1
.ns_10:
    s_mov_b32 s16, s86
    s_and_b32 s17, s87, 0xffff
    s_mov_b32 s18, 0x800000
    s_mov_b32 s19, 0x00020000
    v_xor_b32 v240, 0, v240
    s_and_b32 s4, s26, 1
    s_lshl_b32 s98, s4, 11
    s_lshl_b32 s99, s4, 18
    s_add_u32 s98, s98, s6
    s_xor_b32 m0, s98, 16384
    s_xor_b32 s5, s99, 0
    buffer_load_dwordx4 v240, s[16:19], s5 offen nt lds
    s_xor_b32 m0, s98, 17408
    s_xor_b32 s5, s99, 131072
    buffer_load_dwordx4 v240, s[16:19], s5 offen nt lds
    s_xor_b32 m0, s98, 18432
    s_xor_b32 s5, s99, 262144
    buffer_load_dwordx4 v240, s[16:19], s5 offen nt lds
    s_xor_b32 m0, s98, 19456
    s_xor_b32 s5, s99, 393216
    buffer_load_dwordx4 v240, s[16:19], s5 offen nt lds
    s_xor_b32 m0, s98, 20480
    s_xor_b32 s5, s99, 524288
    buffer_load_dwordx4 v240, s[16:19], s5 offen nt lds
    s_xor_b32 m0, s98, 21504
    s_xor_b32 s5, s99, 655360
    buffer_load_dwordx4 v240, s[16:19], s5 offen nt lds
    s_xor_b32 m0, s98, 22528
    s_xor_b32 s5, s99, 786432
    buffer_load_dwordx4 v240, s[16:19], s5 offen nt lds
    s_xor_b32 m0, s98, 23552
    s_xor_b32 s5, s99, 917504
    buffer_load_dwordx4 v240, s[16:19], s5 offen nt lds
    s_xor_b32 m0, s98, 24576
    s_xor_b32 s5, s99, 1048576
    buffer_load_dwordx4 v240, s[16:19], s5 offen nt lds
    s_xor_b32 m0, s98, 25600
    s_xor_b32 s5, s99, 1179648
    buffer_load_dwordx4 v240, s[16:19], s5 offen nt lds
    s_xor_b32 m0, s98, 26624
    s_xor_b32 s5, s99, 1310720
    buffer_load_dwordx4 v240, s[16:19], s5 offen nt lds
    s_xor_b32 m0, s98, 27648
    s_xor_b32 s5, s99, 1441792
    buffer_load_dwordx4 v240, s[16:19], s5 offen nt lds
    s_xor_b32 m0, s98, 28672
    s_xor_b32 s5, s99, 1572864
    buffer_load_dwordx4 v240, s[16:19], s5 offen nt lds
    s_xor_b32 m0, s98, 29696
    s_xor_b32 s5, s99, 1703936
    buffer_load_dwordx4 v240, s[16:19], s5 offen nt lds
    s_xor_b32 m0, s98, 30720
    s_xor_b32 s5, s99, 1835008
    buffer_load_dwordx4 v240, s[16:19], s5 offen nt lds
    s_xor_b32 m0, s98, 31744
    s_xor_b32 s5, s99, 1966080
    buffer_load_dwordx4 v240, s[16:19], s5 offen nt lds
    s_lshr_b32 s52, s26, 2
    s_and_b32 s53, s26, 3
    s_lshl_b32 s54, s25, 14
    s_lshl_b32 s55, s26, 9
    s_add_u32 s55, s55, s54
    s_lshl_b32 s56, s25, 3
    s_add_u32 s56, s56, s52
    s_lshl_b32 s57, s56, 12
    s_lshl_b32 s58, s53, 9
    s_add_u32 s58, s58, s57
    s_mov_b32 s48, 0x00ff00ff
    s_mov_b32 s49, 0x00ff00ff
    s_mov_b32 s50, 0xff00ff00
    s_mov_b32 s51, 0xff00ff00
    v_mov_b32 v2, 0x4444
    v_mov_b32 v4, 0xeeee
    s_lshl_b32 s4, s24, 12
    s_add_u32 s4, s4, s54
    s_mov_b32 vcc_lo, 0x33333333
    s_mov_b32 vcc_hi, 0x33333333
    v_cndmask_b32 v2, v4, v2, vcc
    v_bfe_u32 v254, v1, 0, 6
    v_mul_u32_u24 v3, 16, v254
    v_add_u32 v3, s4, v3
    v_add_u32 v4, 0x10000, v3
    s_mul_i32 s4, s24, 1152
    v_bfe_u32 v254, v1, 4, 1
    v_mul_u32_u24 v5, 576, v254
    v_bfe_u32 v254, v1, 5, 1
    v_mul_u32_u24 v254, 288, v254
    v_add_u32 v5, v5, v254
    v_bfe_u32 v254, v1, 0, 4
    v_mul_u32_u24 v254, 4, v254
    v_add_u32 v5, v5, v254
    v_add_u32 v5, s4, v5
    v_bfe_u32 v254, v1, 4, 1
    v_mul_u32_u24 v7, 576, v254
    v_bfe_u32 v254, v1, 5, 1
    v_mul_u32_u24 v254, 288, v254
    v_add_u32 v7, v7, v254
    v_bfe_u32 v254, v1, 0, 4
    v_mul_u32_u24 v254, 4, v254
    v_add_u32 v7, v7, v254
    v_add_u32 v7, 9472, v7
    v_add_u32 v7, s4, v7
    v_add_u32 v6, 4736, v5
    s_lshl_b32 s4, s24, 10
    v_bfe_u32 v254, v1, 0, 6
    v_mul_u32_u24 v8, 16, v254
    v_add_u32 v8, 14080, v8
    v_add_u32 v8, s4, v8
    s_and_b32 s4, s24, 1
    s_lshr_b32 s5, s24, 1
    s_lshl_b32 s59, s4, 6
    s_mul_i32 s60, s5, 4736
    s_add_u32 s59, s59, s60
    s_lshl_b32 s4, s4, 8
    s_add_u32 s60, s58, s4
    s_lshl_b32 s5, s5, 11
    s_add_u32 s61, s60, s5
    s_cmp_lt_u32 s24, 2
    s_cselect_b32 s5, 8, 1
    s_lshl_b32 s5, s5, 10
    s_xor_b32 s61, s61, s5
    v_bfe_u32 v254, v1, 2, 3
    v_mul_u32_u24 v9, 144, v254
    v_bfe_u32 v254, v1, 5, 1
    v_mul_u32_u24 v254, 32, v254
    v_add_u32 v9, v9, v254
    v_bfe_u32 v254, v1, 0, 2
    v_mul_u32_u24 v254, 8, v254
    v_add_u32 v9, v9, v254
    v_add_u32 v9, s59, v9
    v_bfe_u32 v254, v1, 0, 6
    v_mul_u32_u24 v10, 4, v254
    v_add_u32 v10, 131072, v10
    v_add_u32 v10, s61, v10
    v_bfe_u32 v254, v1, 0, 6
    v_mul_u32_u24 v11, 4, v254
    v_add_u32 v11, 18176, v11
    v_add_u32 v11, s4, v11
    s_lshl_b32 s4, s24, 2
    v_bfe_u32 v254, v1, 2, 1
    v_mul_u32_u24 v255, 1024, v254
    v_bfe_u32 v254, v1, 4, 1
    v_mul_u32_u24 v254, 512, v254
    v_add_u32 v255, v255, v254
    v_bfe_u32 v254, v1, 5, 1
    v_mul_u32_u24 v254, 256, v254
    v_add_u32 v255, v255, v254
    v_bfe_u32 v254, v1, 3, 1
    v_mul_u32_u24 v254, 64, v254
    v_add_u32 v255, v255, v254
    v_bfe_u32 v254, v1, 0, 2
    v_mul_u32_u24 v254, 16, v254
    v_add_u32 v255, v255, v254
    v_add_u32 v255, 20224, v255
    v_add_u32 v255, s4, v255
    v_mov_b32 v20, -1
    v_mov_b32 v21, -1
    v_mov_b32 v22, -1
    v_mov_b32 v23, -1
    v_mov_b32 v40, 0
    v_mov_b32 v41, 0
    v_mov_b32 v42, 0
    v_mov_b32 v43, 0
    v_mov_b32 v44, 0
    v_mov_b32 v45, 0
    v_mov_b32 v46, 0
    v_mov_b32 v47, 0
    v_mov_b32 v48, 0
    v_mov_b32 v49, 0
    v_mov_b32 v50, 0
    v_mov_b32 v51, 0
    v_mov_b32 v52, 0
    v_mov_b32 v53, 0
    v_mov_b32 v54, 0
    v_mov_b32 v55, 0
    v_mov_b32 v56, 0
    v_mov_b32 v57, 0
    v_mov_b32 v58, 0
    v_mov_b32 v59, 0
    v_mov_b32 v60, 0
    v_mov_b32 v61, 0
    v_mov_b32 v62, 0
    v_mov_b32 v63, 0
    v_mov_b32 v64, 0
    v_mov_b32 v65, 0
    v_mov_b32 v66, 0
    v_mov_b32 v67, 0
    v_mov_b32 v68, 0
    v_mov_b32 v69, 0
    v_mov_b32 v70, 0
    v_mov_b32 v71, 0
    v_bfe_u32 v254, v1, 0, 5
    v_mul_u32_u24 v244, 16, v254
    v_bfe_u32 v254, v1, 5, 1
    v_mul_u32_u24 v254, 2048, v254
    v_add_u32 v244, v244, v254
    v_add_u32 v244, 131072, v244
    v_add_u32 v244, s58, v244
    v_bfe_u32 v254, v1, 0, 5
    v_mul_u32_u24 v245, 16, v254
    v_bfe_u32 v254, v1, 5, 1
    v_mul_u32_u24 v254, 65536, v254
    v_add_u32 v245, v245, v254
    v_add_u32 v245, s55, v245
    s_lshl_b32 s4, s53, 10
    s_add_u32 s4, s4, s57
    v_bfe_u32 v254, v1, 0, 6
    v_mul_u32_u24 v246, 16, v254
    v_add_u32 v246, 131072, v246
    v_add_u32 v246, s4, v246
    v_subrev_u32 v237, 0x20000, v246
    v_lshrrev_b32 v237, 2, v237
    v_add_u32 v237, 262144, v237
    s_waitcnt vmcnt(16)
    ds_read_b64_tr_b16 a[0:1], v242 offset:0
    ds_read_b64_tr_b16 a[2:3], v242 offset:512
    ds_read_b64_tr_b16 a[4:5], v242 offset:2048
    ds_read_b64_tr_b16 a[6:7], v242 offset:2560
    ds_read_b64_tr_b16 a[8:9], v242 offset:4096
    ds_read_b64_tr_b16 a[10:11], v242 offset:4608
    ds_read_b64_tr_b16 a[12:13], v242 offset:6144
    ds_read_b64_tr_b16 a[14:15], v242 offset:6656
    ds_read_b64_tr_b16 a[16:17], v242 offset:8192
    ds_read_b64_tr_b16 a[18:19], v242 offset:8704
    ds_read_b64_tr_b16 a[20:21], v242 offset:10240
    ds_read_b64_tr_b16 a[22:23], v242 offset:10752
    ds_read_b64_tr_b16 a[24:25], v242 offset:12288
    ds_read_b64_tr_b16 a[26:27], v242 offset:12800
    ds_read_b64_tr_b16 a[28:29], v242 offset:14336
    ds_read_b64_tr_b16 a[30:31], v242 offset:14848
    ds_read_b64_tr_b16 a[32:33], v243 offset:0
    ds_read_b64_tr_b16 a[34:35], v243 offset:512
    ds_read_b64_tr_b16 a[36:37], v243 offset:2048
    ds_read_b64_tr_b16 a[38:39], v243 offset:2560
    ds_read_b64_tr_b16 a[40:41], v243 offset:4096
    ds_read_b64_tr_b16 a[42:43], v243 offset:4608
    ds_read_b64_tr_b16 a[44:45], v243 offset:6144
    ds_read_b64_tr_b16 a[46:47], v243 offset:6656
    ds_read_b64_tr_b16 a[48:49], v243 offset:8192
    ds_read_b64_tr_b16 a[50:51], v243 offset:8704
    ds_read_b64_tr_b16 a[52:53], v243 offset:10240
    ds_read_b64_tr_b16 a[54:55], v243 offset:10752
    ds_read_b64_tr_b16 a[56:57], v243 offset:12288
    ds_read_b64_tr_b16 a[58:59], v243 offset:12800
    ds_read_b64_tr_b16 a[60:61], v243 offset:14336
    ds_read_b64_tr_b16 a[62:63], v243 offset:14848
    s_waitcnt lgkmcnt(0)
    s_mov_b32 s16, s88
    s_and_b32 s17, s89, 0xffff
    s_mov_b32 s18, 0x800000
    s_mov_b32 s19, 0x00020000
    v_xor_b32 v240, 128, v240
    s_and_b32 s4, s26, 1
    s_lshl_b32 s98, s4, 11
    s_lshl_b32 s99, s4, 18
    s_add_u32 s98, s98, s6
    s_xor_b32 m0, s98, 0
    s_xor_b32 s5, s99, 0
    buffer_load_dwordx4 v240, s[16:19], s5 offen nt lds
    s_xor_b32 m0, s98, 1024
    s_xor_b32 s5, s99, 131072
    buffer_load_dwordx4 v240, s[16:19], s5 offen nt lds
    s_xor_b32 m0, s98, 2048
    s_xor_b32 s5, s99, 262144
    buffer_load_dwordx4 v240, s[16:19], s5 offen nt lds
    s_xor_b32 m0, s98, 3072
    s_xor_b32 s5, s99, 393216
    buffer_load_dwordx4 v240, s[16:19], s5 offen nt lds
    s_xor_b32 m0, s98, 4096
    s_xor_b32 s5, s99, 524288
    buffer_load_dwordx4 v240, s[16:19], s5 offen nt lds
    s_xor_b32 m0, s98, 5120
    s_xor_b32 s5, s99, 655360
    buffer_load_dwordx4 v240, s[16:19], s5 offen nt lds
    s_xor_b32 m0, s98, 6144
    s_xor_b32 s5, s99, 786432
    buffer_load_dwordx4 v240, s[16:19], s5 offen nt lds
    s_xor_b32 m0, s98, 7168
    s_xor_b32 s5, s99, 917504
    buffer_load_dwordx4 v240, s[16:19], s5 offen nt lds
    s_xor_b32 m0, s98, 8192
    s_xor_b32 s5, s99, 1048576
    buffer_load_dwordx4 v240, s[16:19], s5 offen nt lds
    s_xor_b32 m0, s98, 9216
    s_xor_b32 s5, s99, 1179648
    buffer_load_dwordx4 v240, s[16:19], s5 offen nt lds
    s_xor_b32 m0, s98, 10240
    s_xor_b32 s5, s99, 1310720
    buffer_load_dwordx4 v240, s[16:19], s5 offen nt lds
    s_xor_b32 m0, s98, 11264
    s_xor_b32 s5, s99, 1441792
    buffer_load_dwordx4 v240, s[16:19], s5 offen nt lds
    s_xor_b32 m0, s98, 12288
    s_xor_b32 s5, s99, 1572864
    buffer_load_dwordx4 v240, s[16:19], s5 offen nt lds
    s_xor_b32 m0, s98, 13312
    s_xor_b32 s5, s99, 1703936
    buffer_load_dwordx4 v240, s[16:19], s5 offen nt lds
    s_xor_b32 m0, s98, 14336
    s_xor_b32 s5, s99, 1835008
    buffer_load_dwordx4 v240, s[16:19], s5 offen nt lds
    s_xor_b32 m0, s98, 15360
    s_xor_b32 s5, s99, 1966080
    buffer_load_dwordx4 v240, s[16:19], s5 offen nt lds
    s_waitcnt vmcnt(16)
    ds_read_b64_tr_b16 a[64:65], v242 offset:16384
    ds_read_b64_tr_b16 a[66:67], v242 offset:16896
    ds_read_b64_tr_b16 a[68:69], v242 offset:18432
    ds_read_b64_tr_b16 a[70:71], v242 offset:18944
    ds_read_b64_tr_b16 a[72:73], v242 offset:20480
    ds_read_b64_tr_b16 a[74:75], v242 offset:20992
    ds_read_b64_tr_b16 a[76:77], v242 offset:22528
    ds_read_b64_tr_b16 a[78:79], v242 offset:23040
    ds_read_b64_tr_b16 a[80:81], v242 offset:24576
    ds_read_b64_tr_b16 a[82:83], v242 offset:25088
    ds_read_b64_tr_b16 a[84:85], v242 offset:26624
    ds_read_b64_tr_b16 a[86:87], v242 offset:27136
    ds_read_b64_tr_b16 a[88:89], v242 offset:28672
    ds_read_b64_tr_b16 a[90:91], v242 offset:29184
    ds_read_b64_tr_b16 a[92:93], v242 offset:30720
    ds_read_b64_tr_b16 a[94:95], v242 offset:31232
    ds_read_b64_tr_b16 a[96:97], v243 offset:16384
    ds_read_b64_tr_b16 a[98:99], v243 offset:16896
    ds_read_b64_tr_b16 a[100:101], v243 offset:18432
    ds_read_b64_tr_b16 a[102:103], v243 offset:18944
    ds_read_b64_tr_b16 a[104:105], v243 offset:20480
    ds_read_b64_tr_b16 a[106:107], v243 offset:20992
    ds_read_b64_tr_b16 a[108:109], v243 offset:22528
    ds_read_b64_tr_b16 a[110:111], v243 offset:23040
    ds_read_b64_tr_b16 a[112:113], v243 offset:24576
    ds_read_b64_tr_b16 a[114:115], v243 offset:25088
    ds_read_b64_tr_b16 a[116:117], v243 offset:26624
    ds_read_b64_tr_b16 a[118:119], v243 offset:27136
    ds_read_b64_tr_b16 a[120:121], v243 offset:28672
    ds_read_b64_tr_b16 a[122:123], v243 offset:29184
    ds_read_b64_tr_b16 a[124:125], v243 offset:30720
    ds_read_b64_tr_b16 a[126:127], v243 offset:31232
    s_waitcnt lgkmcnt(0)
    v_or_b32 v239, 32, v1
    v_lshlrev_b32 v239, 2, v239
    buffer_load_dword v238, v239, s[20:23], 0 offen sc1
    s_mov_b32 s12, s40
    s_and_b32 s13, s41, 0xffff
    s_mov_b32 s14, 0x4000
    s_mov_b32 s15, 0x00020000
    s_xor_b32 s4, s26, 4
    s_lshl_b32 s4, s4, 6
    v_bfe_u32 v254, v1, 1, 1
    v_mul_u32_u24 v247, 2048, v254
    v_bfe_u32 v254, v1, 5, 1
    v_mul_u32_u24 v254, 4096, v254
    v_add_u32 v247, v247, v254
    v_bfe_u32 v254, v1, 3, 1
    v_mul_u32_u24 v254, 8192, v254
    v_add_u32 v247, v247, v254
    v_bfe_u32 v254, v1, 4, 1
    v_mul_u32_u24 v254, 16, v254
    v_add_u32 v247, v247, v254
    v_bfe_u32 v254, v1, 2, 1
    v_mul_u32_u24 v254, 32, v254
    v_add_u32 v247, v247, v254
    v_bfe_u32 v254, v1, 0, 1
    v_mul_u32_u24 v254, 8, v254
    v_add_u32 v247, v247, v254
    buffer_load_dwordx2 v[248:249], v247, s[12:15], s4 offen
    s_mov_b32 s16, s90
    s_and_b32 s17, s91, 0xffff
    s_mov_b32 s18, 0x800000
    s_mov_b32 s19, 0x00020000
    s_and_b32 s4, s26, 1
    s_lshl_b32 s98, s4, 11
    s_lshl_b32 s99, s4, 16
    s_add_u32 s98, s98, s6
    s_xor_b32 m0, s98, 16384
    s_xor_b32 s5, s99, 0
    buffer_load_dwordx4 v241, s[16:19], s5 offen nt lds
    s_xor_b32 m0, s98, 17408
    s_xor_b32 s5, s99, 32768
    buffer_load_dwordx4 v241, s[16:19], s5 offen nt lds
    s_xor_b32 m0, s98, 18432
    s_xor_b32 s5, s99, 65536
    buffer_load_dwordx4 v241, s[16:19], s5 offen nt lds
    s_xor_b32 m0, s98, 19456
    s_xor_b32 s5, s99, 98304
    buffer_load_dwordx4 v241, s[16:19], s5 offen nt lds
    s_xor_b32 m0, s98, 20480
    s_xor_b32 s5, s99, 131072
    buffer_load_dwordx4 v241, s[16:19], s5 offen nt lds
    s_xor_b32 m0, s98, 21504
    s_xor_b32 s5, s99, 163840
    buffer_load_dwordx4 v241, s[16:19], s5 offen nt lds
    s_xor_b32 m0, s98, 22528
    s_xor_b32 s5, s99, 196608
    buffer_load_dwordx4 v241, s[16:19], s5 offen nt lds
    s_xor_b32 m0, s98, 23552
    s_xor_b32 s5, s99, 229376
    buffer_load_dwordx4 v241, s[16:19], s5 offen nt lds
    s_xor_b32 m0, s98, 24576
    s_xor_b32 s5, s99, 262144
    buffer_load_dwordx4 v241, s[16:19], s5 offen nt lds
    s_xor_b32 m0, s98, 25600
    s_xor_b32 s5, s99, 294912
    buffer_load_dwordx4 v241, s[16:19], s5 offen nt lds
    s_xor_b32 m0, s98, 26624
    s_xor_b32 s5, s99, 327680
    buffer_load_dwordx4 v241, s[16:19], s5 offen nt lds
    s_xor_b32 m0, s98, 27648
    s_xor_b32 s5, s99, 360448
    buffer_load_dwordx4 v241, s[16:19], s5 offen nt lds
    s_xor_b32 m0, s98, 28672
    s_xor_b32 s5, s99, 393216
    buffer_load_dwordx4 v241, s[16:19], s5 offen nt lds
    s_xor_b32 m0, s98, 29696
    s_xor_b32 s5, s99, 425984
    buffer_load_dwordx4 v241, s[16:19], s5 offen nt lds
    s_xor_b32 m0, s98, 30720
    s_xor_b32 s5, s99, 458752
    buffer_load_dwordx4 v241, s[16:19], s5 offen nt lds
    s_xor_b32 m0, s98, 31744
    s_xor_b32 s5, s99, 491520
    buffer_load_dwordx4 v241, s[16:19], s5 offen nt lds
    s_waitcnt vmcnt(16)
    s_cmp_lg_u32 s27, 0
    s_cbranch_scc1 .vd_12
    s_mov_b32 s62, 0
.vp_11:
    v_readlane_b32 s4, v238, 49
    s_and_b32 s5, s4, 0xffff
    s_cmp_ge_u32 s5, 256
    s_cbranch_scc1 .va_13
    s_add_u32 s62, s62, 1
    s_cmp_gt_u32 s62, 0x100000
    s_cbranch_scc1 .mg_end_1
    s_sleep 16
    buffer_load_dword v238, v239, s[20:23], 0 offen sc1
    s_waitcnt vmcnt(0)
    s_branch .vp_11
.va_13:
    s_lshr_b32 s4, s4, 16
    s_cbranch_scc0 .vd_12
    s_lshr_b32 s25, s2, 5
    s_and_b32 s26, s2, 31
    s_mov_b32 s27, 1
    s_waitcnt vmcnt(0) lgkmcnt(0)
    s_barrier
    s_branch .mg_role_3
.vd_12:
    ds_read_b64_tr_b16 a[128:129], v242 offset:0
    ds_read_b64_tr_b16 a[130:131], v242 offset:512
    ds_read_b64_tr_b16 a[132:133], v242 offset:2048
    ds_read_b64_tr_b16 a[134:135], v242 offset:2560
    ds_read_b64_tr_b16 a[136:137], v242 offset:4096
    ds_read_b64_tr_b16 a[138:139], v242 offset:4608
    ds_read_b64_tr_b16 a[140:141], v242 offset:6144
    ds_read_b64_tr_b16 a[142:143], v242 offset:6656
    ds_read_b64_tr_b16 a[144:145], v242 offset:8192
    ds_read_b64_tr_b16 a[146:147], v242 offset:8704
    ds_read_b64_tr_b16 a[148:149], v242 offset:10240
    ds_read_b64_tr_b16 a[150:151], v242 offset:10752
    ds_read_b64_tr_b16 a[152:153], v242 offset:12288
    ds_read_b64_tr_b16 a[154:155], v242 offset:12800
    ds_read_b64_tr_b16 a[156:157], v242 offset:14336
    ds_read_b64_tr_b16 a[158:159], v242 offset:14848
    ds_read_b64_tr_b16 a[160:161], v243 offset:0
    ds_read_b64_tr_b16 a[162:163], v243 offset:512
    ds_read_b64_tr_b16 a[164:165], v243 offset:2048
    ds_read_b64_tr_b16 a[166:167], v243 offset:2560
    ds_read_b64_tr_b16 a[168:169], v243 offset:4096
    ds_read_b64_tr_b16 a[170:171], v243 offset:4608
    ds_read_b64_tr_b16 a[172:173], v243 offset:6144
    ds_read_b64_tr_b16 a[174:175], v243 offset:6656
    ds_read_b64_tr_b16 a[176:177], v243 offset:8192
    ds_read_b64_tr_b16 a[178:179], v243 offset:8704
    ds_read_b64_tr_b16 a[180:181], v243 offset:10240
    ds_read_b64_tr_b16 a[182:183], v243 offset:10752
    ds_read_b64_tr_b16 a[184:185], v243 offset:12288
    ds_read_b64_tr_b16 a[186:187], v243 offset:12800
    ds_read_b64_tr_b16 a[188:189], v243 offset:14336
    ds_read_b64_tr_b16 a[190:191], v243 offset:14848
    s_waitcnt lgkmcnt(0)
    s_mov_b32 s63, 0
    s_cmp_lg_u32 s27, 0
    s_cbranch_scc1 .cd_15
    s_mov_b32 s62, 0
.cp_14:
    v_and_b32 v18, 0xffff, v238
    v_lshrrev_b32 v19, 16, v238
    v_min_u32 v17, v18, v19
    v_cmp_eq_u32 vcc, 0, v17
    s_and_b32 s4, vcc_hi, 65280
    s_cbranch_scc0 .cg_16
    s_add_u32 s62, s62, 1
    s_cmp_gt_u32 s62, 0x100000
    s_cbranch_scc1 .mg_end_1
    s_sleep 16
    buffer_load_dword v238, v239, s[20:23], 0 offen sc1
    s_waitcnt vmcnt(0)
    s_branch .cp_14
.cg_16:
    v_cmp_eq_u32 vcc, 2, v18
    s_bfe_u32 s63, vcc_hi, 524296
    v_cmp_eq_u32 vcc, 2, v19
    s_bfe_u32 s4, vcc_hi, 524296
    s_lshl_b32 s4, s4, 8
    s_or_b32 s63, s63, s4
    s_xor_b32 s4, s63, 0xaaaa
    s_bcnt1_i32_b32 s4, s4
    s_cmp_le_u32 s4, 3
    s_cselect_b32 s63, 0xaaaa, s63
    s_cmp_ge_u32 s4, 13
    s_cselect_b32 s63, 0x5555, s63
.cd_15:
    s_cmp_lg_u32 s27, 0
    s_cbranch_scc1 .slowv_17
    s_mov_b32 s28, 0
    s_mov_b32 s30, 83886080
    s_mov_b32 s31, 84180992
    s_mov_b32 s32, 84475904
    s_mov_b32 s33, 84770816
    s_mov_b32 s41, 66977792
    s_lshl_b32 s42, s56, 13
    s_lshl_b32 s4, s53, 11
    s_add_u32 s44, s42, s4
    s_add_u32 s44, s44, 33554432
    s_add_u32 s42, s42, 16777216
    s_xor_b32 s4, s53, 2
    s_lshl_b32 s4, s4, 10
    s_add_u32 s42, s42, s4
    s_add_u32 s43, s42, 4096
    s_add_u32 s96, s44, 524288
    s_sub_u32 s95, s96, 16777216
    s_mov_b32 s62, 0
    s_mov_b32 s45, 0x3e0293ee
    s_mov_b32 s46, 0
    s_and_b32 s4, s25, 1
    s_lshl_b32 s4, s4, 14
    s_lshr_b32 s5, s25, 1
    s_lshl_b32 s5, s5, 12
    s_or_b32 s4, s4, s5
    s_xor_b32 s47, s47, s4
    s_and_b32 s5, s26, 1
    s_lshl_b32 s5, s5, 11
    s_lshr_b32 s4, s26, 1
    s_lshl_b32 s4, s4, 15
    s_or_b32 s5, s5, s4
    s_bfe_u32 s4, s26, 0x10004
    s_lshl_b32 s4, s4, 11
    s_xor_b32 s5, s5, s4
    s_xor_b32 s34, s5, s47
    s_xor_b32 s35, s34, 0x84000
    s_xor_b32 s36, s34, 0x101000
    s_xor_b32 s37, s34, 0x185000
    s_and_b32 s4, s25, 1
    s_lshl_b32 s35, s4, 14
    s_lshr_b32 s4, s25, 1
    s_lshl_b32 s4, s4, 12
    s_or_b32 s35, s35, s4
    s_and_b32 s4, s26, 1
    s_lshl_b32 s4, s4, 11
    s_or_b32 s35, s35, s4
    s_lshr_b32 s4, s26, 1
    s_lshl_b32 s4, s4, 15
    s_or_b32 s35, s35, s4
    s_cmp_eq_u32 s24, 1
    s_cbranch_scc1 .w1_19
    s_cmp_eq_u32 s24, 2
    s_cbranch_scc1 .w2_20
    s_cmp_eq_u32 s24, 3
    s_cbranch_scc1 .w3_21
.w0_18:
    v_bfe_u32 v254, v1, 4, 1
    v_mul_u32_u24 v168, 1024, v254
    v_bfe_u32 v254, v1, 5, 1
    v_mul_u32_u24 v254, 128, v254
    v_add_u32 v168, v168, v254
    v_bfe_u32 v254, v1, 3, 1
    v_mul_u32_u24 v254, 64, v254
    v_add_u32 v168, v168, v254
    v_bfe_u32 v254, v1, 0, 2
    v_mul_u32_u24 v254, 16, v254
    v_add_u32 v168, v168, v254
    v_bfe_u32 v254, v1, 2, 1
    v_mul_u32_u24 v254, 8, v254
    v_add_u32 v168, v168, v254
    v_add_u32 v168, s101, v168
    v_bfe_u32 v254, v1, 0, 1
    v_mul_u32_u24 v9, 144, v254
    v_bfe_u32 v254, v1, 1, 1
    v_mul_u32_u24 v254, 576, v254
    v_add_u32 v9, v9, v254
    v_bfe_u32 v254, v1, 2, 1
    v_mul_u32_u24 v254, 288, v254
    v_add_u32 v9, v9, v254
    v_bfe_u32 v254, v1, 3, 1
    v_mul_u32_u24 v254, 1152, v254
    v_add_u32 v9, v9, v254
    v_bfe_u32 v254, v1, 4, 2
    v_mul_u32_u24 v254, 32, v254
    v_add_u32 v9, v9, v254
    s_lshl_b32 s4, s56, 10
    v_bfe_u32 v254, v1, 0, 6
    v_mul_u32_u24 v13, 16, v254
    v_add_u32 v13, 262144, v13
    v_add_u32 v13, s4, v13
    v_xor_b32 v156, 1024, v246
    v_xor_b32 v157, 2048, v246
    v_xor_b32 v158, 3072, v246
    v_bfe_u32 v254, v1, 0, 1
    v_mul_u32_u24 v14, 16, v254
    v_bfe_u32 v254, v1, 4, 1
    v_mul_u32_u24 v254, 32, v254
    v_add_u32 v14, v14, v254
    v_bfe_u32 v254, v1, 1, 2
    v_mul_u32_u24 v254, 64, v254
    v_add_u32 v14, v14, v254
    v_bfe_u32 v254, v1, 5, 1
    v_mul_u32_u24 v254, 256, v254
    v_add_u32 v14, v14, v254
    v_add_u32 v14, 65536, v14
    v_add_u32 v14, s55, v14
    v_bfe_u32 v254, v1, 0, 6
    v_mul_u32_u24 v15, 16, v254
    v_bfe_u32 v254, v1, 2, 2
    v_mul_u32_u24 v16, 128, v254
    v_bfe_u32 v254, v1, 0, 2
    v_mul_u32_u24 v254, 16, v254
    v_add_u32 v16, v16, v254
    v_bfe_u32 v254, v1, 4, 2
    v_mul_u32_u24 v254, 4, v254
    v_add_u32 v16, v16, v254
    v_add_u32 v16, 18688, v16
    v_mov_b32 v208, 0
    v_mov_b32 v209, 0
    v_mov_b32 v210, 0
    v_mov_b32 v211, 0
    v_mov_b32 v212, 0
    v_mov_b32 v213, 0
    v_mov_b32 v214, 0
    v_mov_b32 v215, 0
    v_mov_b32 v216, 0
    v_mov_b32 v217, 0
    v_mov_b32 v218, 0
    v_mov_b32 v219, 0
    s_mov_b64 s[50:51], s[48:49]
    v_mov_b32 v164, 0
    v_mov_b32 v165, 0
    v_mov_b32 v166, 0
    v_mov_b32 v167, 0
    v_mov_b32 v164, 0x3f803f80
    v_mov_b32 v200, s45
    v_mov_b32 v220, 0x3f803f80
    v_mov_b32 v201, s45
    v_mov_b32 v221, 0x3f803f80
    v_mov_b32 v202, s45
    v_mov_b32 v222, 0x3f803f80
    v_mov_b32 v203, s45
    v_mov_b32 v223, 0x3f803f80
    buffer_load_dwordx4 v[24:27], v246, s[8:11], s30 offen sc1
    buffer_load_dwordx4 v[28:31], v245, s[8:11], s30 offen sc1
    buffer_load_dword v32, v237, s[8:11], s30 offen sc1
    s_waitcnt vmcnt(0)
    ds_read_b64_tr_b16 a[192:193], v242 offset:16384
    ds_read_b64_tr_b16 a[194:195], v242 offset:16896
    ds_read_b64_tr_b16 a[196:197], v242 offset:18432
    ds_read_b64_tr_b16 a[198:199], v242 offset:18944
    ds_read_b64_tr_b16 a[200:201], v242 offset:20480
    ds_read_b64_tr_b16 a[202:203], v242 offset:20992
    ds_read_b64_tr_b16 a[204:205], v242 offset:22528
    ds_read_b64_tr_b16 a[206:207], v242 offset:23040
    ds_read_b64_tr_b16 a[208:209], v242 offset:24576
    ds_read_b64_tr_b16 a[210:211], v242 offset:25088
    ds_read_b64_tr_b16 a[212:213], v242 offset:26624
    ds_read_b64_tr_b16 a[214:215], v242 offset:27136
    ds_read_b64_tr_b16 a[216:217], v242 offset:28672
    ds_read_b64_tr_b16 a[218:219], v242 offset:29184
    ds_read_b64_tr_b16 a[220:221], v242 offset:30720
    ds_read_b64_tr_b16 a[222:223], v242 offset:31232
    ds_read_b64_tr_b16 a[224:225], v243 offset:16384
    ds_read_b64_tr_b16 a[226:227], v243 offset:16896
    ds_read_b64_tr_b16 a[228:229], v243 offset:18432
    ds_read_b64_tr_b16 a[230:231], v243 offset:18944
    ds_read_b64_tr_b16 a[232:233], v243 offset:20480
    ds_read_b64_tr_b16 a[234:235], v243 offset:20992
    ds_read_b64_tr_b16 a[236:237], v243 offset:22528
    ds_read_b64_tr_b16 a[238:239], v243 offset:23040
    ds_read_b64_tr_b16 a[240:241], v243 offset:24576
    ds_read_b64_tr_b16 a[242:243], v243 offset:25088
    ds_read_b64_tr_b16 a[244:245], v243 offset:26624
    ds_read_b64_tr_b16 a[246:247], v243 offset:27136
    ds_read_b64_tr_b16 a[248:249], v243 offset:28672
    ds_read_b64_tr_b16 a[250:251], v243 offset:29184
    ds_read_b64_tr_b16 a[252:253], v243 offset:30720
    ds_read_b64_tr_b16 a[254:255], v243 offset:31232
    s_waitcnt lgkmcnt(0)
    s_barrier
    buffer_load_dwordx4 v[104:107], v15, s[8:11], s42 offen offset:0
    buffer_load_dwordx4 v[120:123], v15, s[8:11], s43 offen offset:0
    buffer_load_dwordx4 v[136:139], v15, s[8:11], s44 offen offset:0
    buffer_load_dwordx4 v[140:143], v15, s[8:11], s44 offen offset:1024
    s_add_u32 s37, s28, 0
    s_bitcmp1_b32 s37, 0
    s_cselect_b32 s4, 0x84000, 0
    s_xor_b32 s34, s35, s4
    s_bitcmp1_b32 s37, 1
    s_cselect_b32 s4, 0x101000, 0
    s_xor_b32 s34, s34, s4
    s_lshr_b32 s37, s37, 2
    s_bitcmp1_b32 s63, s37
    s_cselect_b32 s4, 0x2000, 0
    s_xor_b32 s34, s34, s4
    s_lshl_b32 s37, s37, 21
    s_add_u32 s34, s34, s37
.p2align 6
.step_24:
    s_barrier
    s_setprio 3
    buffer_load_dwordx4 v[24:27], v3, s[8:11], s30 offen offset:0 sc1
    s_setprio 2
    buffer_load_dwordx4 v[28:31], v3, s[8:11], s30 offen offset:1024 sc1
    s_setprio 1
    buffer_load_dwordx4 v[32:35], v3, s[8:11], s30 offen offset:2048 sc1
    s_setprio 0
    buffer_load_dwordx4 v[36:39], v3, s[8:11], s30 offen offset:3072 sc1
    s_call_b64 s[98:99], .gm_22
    v_pk_add_f32 v[40:41], v[40:41], v[42:43]
    v_pk_add_f32 v[42:43], v[44:45], v[46:47]
    ds_write2_b32 v5, v40, v41 offset0:0 offset1:36
    ds_write2_b32 v5, v42, v43 offset0:16 offset1:52
    s_nop 1
    v_pk_add_f32 v[48:49], v[48:49], v[50:51]
    v_pk_add_f32 v[50:51], v[52:53], v[54:55]
    ds_write2_b32 v6, v48, v49 offset0:0 offset1:36
    ds_write2_b32 v6, v50, v51 offset0:16 offset1:52
    s_waitcnt lgkmcnt(2)
    s_barrier
    ds_read_b128 v[72:75], v9 offset:0
    ds_read_b128 v[76:79], v9 offset:2304
    ds_read_b128 v[80:83], v9 offset:16
    ds_read_b128 v[84:87], v9 offset:2320
    v_smfmac_f32_16x16x64_bf16 v[56:59], v[24:27], a[128:135], v2
    v_smfmac_f32_16x16x64_bf16 v[60:63], v[24:27], a[160:167], v2
    s_waitcnt lgkmcnt(4)
    s_barrier
    v_smfmac_f32_16x16x64_bf16 v[56:59], v[28:31], a[136:143], v2
    s_waitcnt lgkmcnt(2)
    v_pk_add_f32 v[72:73], v[72:73], v[76:77]
    v_pk_add_f32 v[74:75], v[74:75], v[78:79]
    v_cvt_pk_bf16_f32 v144, v72, v73
    v_cvt_pk_bf16_f32 v145, v74, v75
    s_waitcnt lgkmcnt(0)
    v_pk_add_f32 v[80:81], v[80:81], v[84:85]
    v_pk_add_f32 v[82:83], v[82:83], v[86:87]
    v_cvt_pk_bf16_f32 v146, v80, v81
    v_cvt_pk_bf16_f32 v147, v82, v83
    s_nop 1
    v_mfma_f32_16x16x32_bf16 v[192:195], v[104:107], v[144:147], 0
    v_mfma_f32_16x16x32_bf16 v[160:163], v[120:123], v[144:147], 0
    v_smfmac_f32_16x16x64_bf16 v[60:63], v[28:31], a[168:175], v2
    v_add_f32_dpp v151, v195, v195 row_ror:8 row_mask:0xf bank_mask:0x3
    v_add_f32_dpp v148, v192, v192 row_ror:8 row_mask:0xf bank_mask:0x3
    v_add_f32_dpp v149, v193, v193 row_ror:8 row_mask:0xf bank_mask:0x3
    v_add_f32_dpp v150, v194, v194 row_ror:8 row_mask:0xf bank_mask:0x3
    v_add_f32_dpp v151, v163, v163 row_ror:8 row_mask:0xf bank_mask:0xc
    v_add_f32_dpp v148, v160, v160 row_ror:8 row_mask:0xf bank_mask:0xc
    v_add_f32_dpp v149, v161, v161 row_ror:8 row_mask:0xf bank_mask:0xc
    v_add_f32_dpp v150, v162, v162 row_ror:8 row_mask:0xf bank_mask:0xc
    v_min_u32 v151, 0xfffffffe, v151
    buffer_store_dwordx4 v[148:151], v246, s[8:11], s30 offen
    v_smfmac_f32_16x16x64_bf16 v[56:59], v[32:35], a[144:151], v2
    v_smfmac_f32_16x16x64_bf16 v[60:63], v[32:35], a[176:183], v2
    v_smfmac_f32_16x16x64_bf16 v[56:59], v[36:39], a[152:159], v2
    v_smfmac_f32_16x16x64_bf16 v[60:63], v[36:39], a[184:191], v2
    v_mov_b32 v40, 0
    v_mov_b32 v41, 0
    v_mov_b32 v42, 0
    v_mov_b32 v43, 0
    v_mov_b32 v44, 0
    v_mov_b32 v45, 0
    v_mov_b32 v46, 0
    v_mov_b32 v47, 0
    v_pk_add_f32 v[56:57], v[56:57], v[58:59]
    v_pk_add_f32 v[58:59], v[60:61], v[62:63]
    v_cvt_pk_bf16_f32 v60, v56, v57
    v_cvt_pk_bf16_f32 v61, v58, v59
    ds_write2_b32 v255, v60, v61 offset0:0 offset1:32
    ds_write_b128 v8, v[56:59]
    s_cmp_eq_u32 s28, 63
    s_cbranch_scc1 .fin_25
    s_waitcnt lgkmcnt(0)
    buffer_load_dwordx4 v[176:179], v13, s[8:11], s30 offen sc1
    buffer_load_dwordx4 v[180:183], v156, s[8:11], s30 offen sc1
    buffer_load_dwordx4 v[184:187], v157, s[8:11], s30 offen sc1
    buffer_load_dwordx4 v[188:191], v158, s[8:11], s30 offen sc1
    s_waitcnt lgkmcnt(0)
    s_barrier
    ds_read_b128 v[212:215], v15 offset:20224
    ds_read_b128 v[216:219], v15 offset:21248
    v_mov_b32 v48, 0
    v_mov_b32 v49, 0
    v_mov_b32 v50, 0
    v_mov_b32 v51, 0
    v_mov_b32 v52, 0
    v_mov_b32 v53, 0
    v_mov_b32 v54, 0
    v_mov_b32 v55, 0
    v_mov_b32 v56, 0
    v_mov_b32 v57, 0
    v_mov_b32 v58, 0
    v_mov_b32 v59, 0
    v_mov_b32 v60, 0
    v_mov_b32 v61, 0
    v_mov_b32 v62, 0
    v_mov_b32 v63, 0
    buffer_load_dwordx4 v[72:75], v13, s[8:11], s30 offen sc1
    buffer_load_dwordx4 v[76:79], v156, s[8:11], s30 offen sc1
    buffer_load_dwordx4 v[80:83], v157, s[8:11], s30 offen sc1
    buffer_load_dwordx4 v[84:87], v158, s[8:11], s30 offen sc1
.mf_26:
    s_waitcnt vmcnt(7)
    v_max3_u32 v18, v176, v177, v178
    v_pk_add_f32 v[196:197], v[176:177], v[178:179]
    s_waitcnt vmcnt(6)
    v_max3_u32 v18, v18, v179, v183
    v_pk_add_f32 v[192:193], v[148:149], v[180:181]
    v_pk_add_f32 v[194:195], v[150:151], v[182:183]
    v_add_f32 v196, v196, v197
    s_waitcnt vmcnt(5)
    v_pk_add_f32 v[192:193], v[192:193], v[184:185]
    v_pk_add_f32 v[194:195], v[194:195], v[186:187]
    s_waitcnt vmcnt(4)
    v_max3_u32 v18, v18, v187, v191
    v_pk_add_f32 v[192:193], v[192:193], v[188:189]
    v_pk_add_f32 v[194:195], v[194:195], v[190:191]
    v_cmp_eq_u32 vcc, -1, v18
    v_max3_f32 v19, v192, v193, v196
    v_max3_f32 v19, v19, v194, v195
    s_cbranch_vccnz .re_27
.sj_28:
    s_nop 0
    v_max_f32_dpp v18, v19, v19 row_ror:8 row_mask:0xf bank_mask:0xf
    v_max_f32_dpp v17, v19, v19 row_ror:8 row_mask:0xf bank_mask:0xf
    s_nop 1
    v_permlane16_swap_b32 v18, v17
    v_max_f32 v19, v18, v17
    v_max_f32 v18, v18, v17
    s_nop 1
    v_permlane32_swap_b32 v18, v19
    v_max_f32 v18, v18, v19
    v_mul_f32 v18, s45, v18
    v_fma_f32 v244, v196, s45, -v18
    v_pk_fma_f32 v[240:241], v[192:193], v[200:201], v[18:19] op_sel_hi:[1,1,0] neg_lo:[0,0,1] neg_hi:[0,0,1]
    v_exp_f32 v244, v244
    v_pk_fma_f32 v[242:243], v[194:195], v[200:201], v[18:19] op_sel_hi:[1,1,0] neg_lo:[0,0,1] neg_hi:[0,0,1]
    v_exp_f32 v240, v240
    v_mov_b32_dpp v245, v244 row_ror:8 row_mask:0xf bank_mask:0xf
    v_cvt_pk_bf16_f32 v208, v244, v245
    v_cvt_pk_bf16_f32 v209, v244, v245
    v_pk_mov_b32 v[210:211], v[208:209], v[208:209] op_sel:[0,1]
    v_exp_f32 v241, v241
    s_waitcnt lgkmcnt(0)
    v_mfma_f32_16x16x32_bf16 v[228:231], v[212:215], v[208:211], 0
    v_exp_f32 v242, v242
    v_mfma_f32_16x16x32_bf16 v[224:227], v[164:167], v[208:211], 0
    v_exp_f32 v243, v243
    v_cvt_pk_bf16_f32 v204, v240, v241
    v_cvt_pk_bf16_f32 v205, v242, v243
    v_mfma_f32_16x16x32_bf16 v[232:235], v[216:219], v[208:211], 0
    v_mov_b32_dpp v206, v204 row_ror:8 row_mask:0xf bank_mask:0xf
    v_mov_b32_dpp v207, v205 row_ror:8 row_mask:0xf bank_mask:0xf
    s_nop 1
    v_mfma_f32_16x16x32_bf16 v[224:227], v[220:223], v[204:207], v[224:227]
    v_mfma_f32_16x16x32_bf16 v[228:231], v[136:139], v[204:207], v[228:231]
    v_mfma_f32_16x16x32_bf16 v[232:235], v[140:143], v[204:207], v[232:235]
    s_mov_b64 exec, s[50:51]
    v_rcp_f32 v18, v224
    s_nop 1
    v_mul_f32 v228, v18, v228
    v_mul_f32 v229, v18, v229
    v_mul_f32 v230, v18, v230
    v_mul_f32 v231, v18, v231
    v_pk_mul_f32 v[232:233], v[18:19], v[232:233] op_sel_hi:[0,1]
    v_pk_mul_f32 v[234:235], v[18:19], v[234:235] op_sel_hi:[0,1]
    v_cvt_pk_bf16_f32 v236, v228, v229
    v_cvt_pk_bf16_f32 v239, v234, v235
    v_cvt_pk_bf16_f32 v237, v230, v231
    v_cvt_pk_bf16_f32 v238, v232, v233
    v_min_u32 v239, 0xfffffffe, v239
    buffer_store_dwordx4 v[236:239], v14, s[8:11], s30 offen
    s_mov_b64 exec, -1
    s_add_u32 s37, s28, 0
    s_bitcmp1_b32 s37, 0
    s_cselect_b32 s4, 0x84000, 0
    s_xor_b32 s34, s35, s4
    s_bitcmp1_b32 s37, 1
    s_cselect_b32 s4, 0x101000, 0
    s_xor_b32 s34, s34, s4
    s_lshr_b32 s37, s37, 2
    s_bitcmp1_b32 s63, s37
    s_cselect_b32 s4, 0x2000, 0
    s_xor_b32 s34, s34, s4
    s_lshl_b32 s37, s37, 21
    s_add_u32 s34, s34, s37
    s_add_u32 s42, s42, 262144
    s_add_u32 s43, s43, 262144
    s_add_u32 s44, s44, 262144
    v_mov_b32 v64, 0
    v_mov_b32 v65, 0
    v_mov_b32 v66, 0
    v_mov_b32 v67, 0
    v_mov_b32 v68, 0
    v_mov_b32 v69, 0
    v_mov_b32 v70, 0
    v_mov_b32 v71, 0
    s_barrier
    s_setprio 3
    buffer_load_dwordx4 v[24:27], v4, s[8:11], s30 offen offset:0 sc1
    s_setprio 2
    buffer_load_dwordx4 v[28:31], v4, s[8:11], s30 offen offset:1024 sc1
    s_setprio 1
    buffer_load_dwordx4 v[32:35], v4, s[8:11], s30 offen offset:2048 sc1
    s_setprio 0
    buffer_load_dwordx4 v[36:39], v4, s[8:11], s30 offen offset:3072 sc1
    s_call_b64 s[98:99], .gm_23
    s_nop 4
    v_pk_add_f32 v[64:65], v[64:65], v[66:67]
    v_cvt_pk_bf16_f32 v66, v64, v65
    v_pk_add_f32 v[68:69], v[68:69], v[70:71]
    v_cvt_pk_bf16_f32 v67, v68, v69
    v_min_u32 v67, 0xfffffffe, v67
    buffer_store_dwordx2 v[66:67], v168, s[8:11], s34 offen sc1
    ds_write2_b32 v7, v64, v65 offset0:0 offset1:36
    ds_write2_b32 v7, v68, v69 offset0:16 offset1:52
    s_waitcnt lgkmcnt(0)
    s_barrier
    buffer_load_dwordx4 v[104:107], v15, s[8:11], s42 offen offset:0
    buffer_load_dwordx4 v[120:123], v15, s[8:11], s43 offen offset:0
    buffer_load_dwordx4 v[136:139], v15, s[8:11], s44 offen offset:0
    buffer_load_dwordx4 v[140:143], v15, s[8:11], s44 offen offset:1024
    s_mov_b32 s4, s30
    s_mov_b32 s30, s31
    s_mov_b32 s31, s32
    s_mov_b32 s32, s33
    s_mov_b32 s33, s4
    s_add_u32 s28, s28, 1
    s_mov_b32 s62, 0
    s_branch .step_24
.fin_25:
    s_waitcnt lgkmcnt(0)
    s_barrier
    s_barrier
    s_endpgm
.re_27:
    buffer_load_dwordx4 v[176:179], v13, s[8:11], s30 offen sc1
    buffer_load_dwordx4 v[180:183], v156, s[8:11], s30 offen sc1
    buffer_load_dwordx4 v[184:187], v157, s[8:11], s30 offen sc1
    buffer_load_dwordx4 v[188:191], v158, s[8:11], s30 offen sc1
    s_waitcnt vmcnt(7)
    v_max3_u32 v18, v72, v73, v74
    v_pk_add_f32 v[196:197], v[72:73], v[74:75]
    s_waitcnt vmcnt(6)
    v_max3_u32 v18, v18, v75, v79
    v_pk_add_f32 v[192:193], v[148:149], v[76:77]
    v_pk_add_f32 v[194:195], v[150:151], v[78:79]
    v_add_f32 v196, v196, v197
    s_waitcnt vmcnt(5)
    v_pk_add_f32 v[192:193], v[192:193], v[80:81]
    v_pk_add_f32 v[194:195], v[194:195], v[82:83]
    s_waitcnt vmcnt(4)
    v_max3_u32 v18, v18, v83, v87
    v_pk_add_f32 v[192:193], v[192:193], v[84:85]
    v_pk_add_f32 v[194:195], v[194:195], v[86:87]
    v_cmp_eq_u32 vcc, -1, v18
    v_max3_f32 v19, v192, v193, v196
    v_max3_f32 v19, v19, v194, v195
    s_cbranch_vccnz .re_29
    s_branch .sj_28
.re_29:
    buffer_load_dwordx4 v[72:75], v13, s[8:11], s30 offen sc1
    buffer_load_dwordx4 v[76:79], v156, s[8:11], s30 offen sc1
    buffer_load_dwordx4 v[80:83], v157, s[8:11], s30 offen sc1
    buffer_load_dwordx4 v[84:87], v158, s[8:11], s30 offen sc1
    s_add_u32 s62, s62, 1
    s_cmp_gt_u32 s62, 0x100000
    s_cbranch_scc1 .mg_end_1
    s_branch .mf_26
.w1_19:
    v_bfe_u32 v254, v1, 4, 1
    v_mul_u32_u24 v168, 1024, v254
    v_bfe_u32 v254, v1, 5, 1
    v_mul_u32_u24 v254, 128, v254
    v_add_u32 v168, v168, v254
    v_bfe_u32 v254, v1, 3, 1
    v_mul_u32_u24 v254, 64, v254
    v_add_u32 v168, v168, v254
    v_bfe_u32 v254, v1, 0, 2
    v_mul_u32_u24 v254, 16, v254
    v_add_u32 v168, v168, v254
    v_bfe_u32 v254, v1, 2, 1
    v_mul_u32_u24 v254, 8, v254
    v_add_u32 v168, v168, v254
    v_add_u32 v168, 256, v168
    v_add_u32 v168, s101, v168
    v_bfe_u32 v254, v1, 0, 1
    v_mul_u32_u24 v17, 2, v254
    v_bfe_u32 v254, v1, 2, 1
    v_mul_u32_u24 v254, 1, v254
    v_add_u32 v17, v17, v254
    v_bfe_u32 v254, v1, 3, 1
    v_mul_u32_u24 v254, 4, v254
    v_add_u32 v17, v17, v254
    v_bfe_u32 v254, v1, 1, 1
    v_mul_u32_u24 v18, 16, v254
    v_mov_b32 v19, 0x3f80
    v_lshlrev_b32 v18, v18, v19
    v_cmp_eq_u32 vcc, 0, v17
    s_nop 1
    v_cndmask_b32 v124, 0, v18, vcc
    v_cmp_eq_u32 vcc, 1, v17
    s_nop 1
    v_cndmask_b32 v125, 0, v18, vcc
    v_cmp_eq_u32 vcc, 2, v17
    s_nop 1
    v_cndmask_b32 v126, 0, v18, vcc
    v_cmp_eq_u32 vcc, 3, v17
    s_nop 1
    v_cndmask_b32 v127, 0, v18, vcc
    v_cmp_eq_u32 vcc, 4, v17
    s_nop 1
    v_cndmask_b32 v128, 0, v18, vcc
    v_cmp_eq_u32 vcc, 5, v17
    s_nop 1
    v_cndmask_b32 v129, 0, v18, vcc
    v_cmp_eq_u32 vcc, 6, v17
    s_nop 1
    v_cndmask_b32 v130, 0, v18, vcc
    v_cmp_eq_u32 vcc, 7, v17
    s_nop 1
    v_cndmask_b32 v131, 0, v18, vcc
    v_bfe_u32 v254, v1, 0, 1
    v_mul_u32_u24 v9, 144, v254
    v_bfe_u32 v254, v1, 1, 1
    v_mul_u32_u24 v254, 576, v254
    v_add_u32 v9, v9, v254
    v_bfe_u32 v254, v1, 2, 1
    v_mul_u32_u24 v254, 288, v254
    v_add_u32 v9, v9, v254
    v_bfe_u32 v254, v1, 3, 1
    v_mul_u32_u24 v254, 1152, v254
    v_add_u32 v9, v9, v254
    v_bfe_u32 v254, v1, 4, 2
    v_mul_u32_u24 v254, 32, v254
    v_add_u32 v9, v9, v254
    v_bfe_u32 v254, v1, 0, 1
    v_mul_u32_u24 v11, 144, v254
    v_bfe_u32 v254, v1, 2, 2
    v_mul_u32_u24 v254, 288, v254
    v_add_u32 v11, v11, v254
    v_bfe_u32 v254, v1, 1, 1
    v_mul_u32_u24 v254, 1152, v254
    v_add_u32 v11, v11, v254
    v_bfe_u32 v254, v1, 4, 2
    v_mul_u32_u24 v254, 32, v254
    v_add_u32 v11, v11, v254
    v_add_u32 v11, 4736, v11
    s_lshl_b32 s4, s56, 10
    s_lshl_b32 s5, s53, 2
    v_bfe_u32 v254, v1, 0, 6
    v_mul_u32_u24 v10, 16, v254
    v_add_u32 v10, 262144, v10
    v_add_u32 v10, s4, v10
    v_add_u32 v10, s5, v10
    v_bfe_u32 v254, v1, 1, 1
    v_mul_u32_u24 v12, 144, v254
    v_bfe_u32 v254, v1, 5, 1
    v_mul_u32_u24 v254, 288, v254
    v_add_u32 v12, v12, v254
    v_bfe_u32 v254, v1, 3, 1
    v_mul_u32_u24 v254, 576, v254
    v_add_u32 v12, v12, v254
    v_bfe_u32 v254, v1, 4, 1
    v_mul_u32_u24 v254, 32, v254
    v_add_u32 v12, v12, v254
    v_bfe_u32 v254, v1, 2, 1
    v_mul_u32_u24 v254, 64, v254
    v_add_u32 v12, v12, v254
    v_bfe_u32 v254, v1, 0, 1
    v_mul_u32_u24 v254, 16, v254
    v_add_u32 v12, v12, v254
    v_add_u32 v12, 9472, v12
    v_bfe_u32 v254, v1, 0, 6
    v_mul_u32_u24 v13, 16, v254
    v_add_u32 v13, s101, v13
    v_bfe_u32 v254, v1, 0, 2
    v_mul_u32_u24 v14, 8, v254
    v_bfe_u32 v254, v1, 4, 1
    v_mul_u32_u24 v254, 32, v254
    v_add_u32 v14, v14, v254
    v_bfe_u32 v254, v1, 3, 1
    v_mul_u32_u24 v254, 64, v254
    v_add_u32 v14, v14, v254
    v_bfe_u32 v254, v1, 5, 1
    v_mul_u32_u24 v254, 128, v254
    v_add_u32 v14, v14, v254
    v_bfe_u32 v254, v1, 2, 1
    v_mul_u32_u24 v254, 256, v254
    v_add_u32 v14, v14, v254
    v_add_u32 v14, s55, v14
    v_xor_b32 v14, 2048, v14
    v_min_u32 v249, 0xfffffffe, v249
    buffer_store_dwordx2 v[248:249], v14, s[8:11], s30 offen
    v_bfe_u32 v254, v1, 0, 6
    v_mul_u32_u24 v15, 16, v254
    s_add_u32 s42, s42, 262144
    s_add_u32 s43, s43, 262144
    s_add_u32 s44, s44, 262144
    buffer_load_dwordx4 v[24:27], v246, s[8:11], s31 offen sc1
    buffer_load_dwordx4 v[28:31], v245, s[8:11], s31 offen sc1
    buffer_load_dword v32, v237, s[8:11], s31 offen sc1
    s_waitcnt vmcnt(0)
    ds_read_b64_tr_b16 a[192:193], v242 offset:16384
    ds_read_b64_tr_b16 a[194:195], v242 offset:16896
    ds_read_b64_tr_b16 a[196:197], v242 offset:18432
    ds_read_b64_tr_b16 a[198:199], v242 offset:18944
    ds_read_b64_tr_b16 a[200:201], v242 offset:20480
    ds_read_b64_tr_b16 a[202:203], v242 offset:20992
    ds_read_b64_tr_b16 a[204:205], v242 offset:22528
    ds_read_b64_tr_b16 a[206:207], v242 offset:23040
    ds_read_b64_tr_b16 a[208:209], v242 offset:24576
    ds_read_b64_tr_b16 a[210:211], v242 offset:25088
    ds_read_b64_tr_b16 a[212:213], v242 offset:26624
    ds_read_b64_tr_b16 a[214:215], v242 offset:27136
    ds_read_b64_tr_b16 a[216:217], v242 offset:28672
    ds_read_b64_tr_b16 a[218:219], v242 offset:29184
    ds_read_b64_tr_b16 a[220:221], v242 offset:30720
    ds_read_b64_tr_b16 a[222:223], v242 offset:31232
    ds_read_b64_tr_b16 a[224:225], v243 offset:16384
    ds_read_b64_tr_b16 a[226:227], v243 offset:16896
    ds_read_b64_tr_b16 a[228:229], v243 offset:18432
    ds_read_b64_tr_b16 a[230:231], v243 offset:18944
    ds_read_b64_tr_b16 a[232:233], v243 offset:20480
    ds_read_b64_tr_b16 a[234:235], v243 offset:20992
    ds_read_b64_tr_b16 a[236:237], v243 offset:22528
    ds_read_b64_tr_b16 a[238:239], v243 offset:23040
    ds_read_b64_tr_b16 a[240:241], v243 offset:24576
    ds_read_b64_tr_b16 a[242:243], v243 offset:25088
    ds_read_b64_tr_b16 a[244:245], v243 offset:26624
    ds_read_b64_tr_b16 a[246:247], v243 offset:27136
    ds_read_b64_tr_b16 a[248:249], v243 offset:28672
    ds_read_b64_tr_b16 a[250:251], v243 offset:29184
    ds_read_b64_tr_b16 a[252:253], v243 offset:30720
    ds_read_b64_tr_b16 a[254:255], v243 offset:31232
    s_waitcnt lgkmcnt(0)
    s_barrier
    s_add_u32 s37, s28, 0
    s_bitcmp1_b32 s37, 0
    s_cselect_b32 s4, 0x84000, 0
    s_xor_b32 s34, s35, s4
    s_bitcmp1_b32 s37, 1
    s_cselect_b32 s4, 0x101000, 0
    s_xor_b32 s34, s34, s4
    s_lshr_b32 s37, s37, 2
    s_bitcmp1_b32 s63, s37
    s_cselect_b32 s4, 0x2000, 0
    s_xor_b32 s34, s34, s4
    s_lshl_b32 s37, s37, 21
    s_add_u32 s34, s34, s37
.p2align 6
.step_30:
    s_barrier
    s_setprio 3
    buffer_load_dwordx4 v[24:27], v3, s[8:11], s30 offen offset:0 sc1
    s_setprio 2
    buffer_load_dwordx4 v[28:31], v3, s[8:11], s30 offen offset:1024 sc1
    s_setprio 1
    buffer_load_dwordx4 v[32:35], v3, s[8:11], s30 offen offset:2048 sc1
    s_setprio 0
    buffer_load_dwordx4 v[36:39], v3, s[8:11], s30 offen offset:3072 sc1
    s_call_b64 s[98:99], .gm_22
    v_pk_add_f32 v[40:41], v[40:41], v[42:43]
    v_pk_add_f32 v[42:43], v[44:45], v[46:47]
    ds_write2_b32 v5, v40, v41 offset0:0 offset1:36
    ds_write2_b32 v5, v42, v43 offset0:16 offset1:52
    s_nop 1
    v_pk_add_f32 v[48:49], v[48:49], v[50:51]
    v_pk_add_f32 v[50:51], v[52:53], v[54:55]
    ds_write2_b32 v6, v48, v49 offset0:0 offset1:36
    ds_write2_b32 v6, v50, v51 offset0:16 offset1:52
    s_waitcnt lgkmcnt(2)
    s_barrier
    ds_read_b128 v[72:75], v9 offset:0
    ds_read_b128 v[76:79], v9 offset:2304
    ds_read_b128 v[80:83], v9 offset:16
    ds_read_b128 v[84:87], v9 offset:2320
    v_smfmac_f32_16x16x64_bf16 v[56:59], v[24:27], a[128:135], v2
    v_smfmac_f32_16x16x64_bf16 v[60:63], v[24:27], a[160:167], v2
    s_waitcnt lgkmcnt(4)
    s_barrier
    ds_read_b128 v[88:91], v11 offset:0
    ds_read_b128 v[92:95], v11 offset:2304
    ds_read_b128 v[96:99], v11 offset:16
    ds_read_b128 v[100:103], v11 offset:2320
    v_smfmac_f32_16x16x64_bf16 v[56:59], v[28:31], a[136:143], v2
    s_waitcnt lgkmcnt(6)
    v_pk_add_f32 v[72:73], v[72:73], v[76:77]
    v_pk_add_f32 v[74:75], v[74:75], v[78:79]
    v_cvt_pk_bf16_f32 v144, v72, v73
    v_cvt_pk_bf16_f32 v145, v74, v75
    s_waitcnt lgkmcnt(4)
    v_pk_add_f32 v[80:81], v[80:81], v[84:85]
    v_pk_add_f32 v[82:83], v[82:83], v[86:87]
    v_cvt_pk_bf16_f32 v146, v80, v81
    v_cvt_pk_bf16_f32 v147, v82, v83
    s_waitcnt lgkmcnt(2)
    v_pk_add_f32 v[88:89], v[88:89], v[92:93]
    v_pk_add_f32 v[90:91], v[90:91], v[94:95]
    v_cvt_pk_bf16_f32 v148, v88, v89
    v_cvt_pk_bf16_f32 v149, v90, v91
    s_waitcnt lgkmcnt(0)
    v_pk_add_f32 v[96:97], v[96:97], v[100:101]
    v_pk_add_f32 v[98:99], v[98:99], v[102:103]
    v_cvt_pk_bf16_f32 v150, v96, v97
    v_cvt_pk_bf16_f32 v151, v98, v99
    s_nop 1
    v_mfma_f32_16x16x32_bf16 v[196:199], v[148:151], v[144:147], 0
    v_smfmac_f32_16x16x64_bf16 v[60:63], v[28:31], a[168:175], v2
    v_smfmac_f32_16x16x64_bf16 v[56:59], v[32:35], a[144:151], v2
    v_pk_add_f32 v[196:197], v[196:197], v[198:199]
    s_nop 1
    v_add_f32_dpp v198, v196, v196 row_ror:8 row_mask:0xf bank_mask:0xf
    v_add_f32_dpp v199, v197, v197 row_ror:8 row_mask:0xf bank_mask:0xf
    v_cndmask_b32 v198, v199, v198, s[48:49]
    v_min_u32 v198, 0xfffffffe, v198
    buffer_store_dword v198, v10, s[8:11], s30 offen
    v_smfmac_f32_16x16x64_bf16 v[60:63], v[32:35], a[176:183], v2
    v_smfmac_f32_16x16x64_bf16 v[56:59], v[36:39], a[152:159], v2
    v_smfmac_f32_16x16x64_bf16 v[60:63], v[36:39], a[184:191], v2
    v_mov_b32 v40, 0
    v_mov_b32 v41, 0
    v_mov_b32 v42, 0
    v_mov_b32 v43, 0
    v_mov_b32 v44, 0
    v_mov_b32 v45, 0
    v_mov_b32 v46, 0
    v_mov_b32 v47, 0
    v_pk_add_f32 v[56:57], v[56:57], v[58:59]
    v_pk_add_f32 v[58:59], v[60:61], v[62:63]
    v_cvt_pk_bf16_f32 v60, v56, v57
    v_cvt_pk_bf16_f32 v61, v58, v59
    ds_write2_b32 v255, v60, v61 offset0:0 offset1:32
    ds_write_b128 v8, v[56:59]
    s_waitcnt lgkmcnt(0)
    s_barrier
    s_cmp_eq_u32 s28, 63
    s_cbranch_scc1 .fin_31
    s_barrier
    s_setprio 3
    buffer_load_dwordx4 v[24:27], v4, s[8:11], s30 offen offset:0 sc1
    s_setprio 2
    buffer_load_dwordx4 v[28:31], v4, s[8:11], s30 offen offset:1024 sc1
    s_setprio 1
    buffer_load_dwordx4 v[32:35], v4, s[8:11], s30 offen offset:2048 sc1
    s_setprio 0
    buffer_load_dwordx4 v[36:39], v4, s[8:11], s30 offen offset:3072 sc1
    s_call_b64 s[98:99], .gm_23
    s_nop 4
    v_pk_add_f32 v[64:65], v[64:65], v[66:67]
    v_cvt_pk_bf16_f32 v66, v64, v65
    v_pk_add_f32 v[68:69], v[68:69], v[70:71]
    v_cvt_pk_bf16_f32 v67, v68, v69
    v_min_u32 v67, 0xfffffffe, v67
    buffer_store_dwordx2 v[66:67], v168, s[8:11], s34 offen sc1
    ds_write2_b32 v7, v64, v65 offset0:0 offset1:36
    ds_write2_b32 v7, v68, v69 offset0:16 offset1:52
    s_waitcnt lgkmcnt(0)
    s_barrier
    ds_read_b128 v[72:75], v12 offset:0
    ds_read_b128 v[76:79], v12 offset:1152
    ds_read_b128 v[80:83], v12 offset:2304
    ds_read_b128 v[84:87], v12 offset:3456
    s_waitcnt lgkmcnt(2)
    v_pk_add_f32 v[72:73], v[72:73], v[76:77]
    v_pk_add_f32 v[74:75], v[74:75], v[78:79]
    s_waitcnt lgkmcnt(0)
    v_pk_add_f32 v[80:81], v[80:81], v[84:85]
    v_pk_add_f32 v[82:83], v[82:83], v[86:87]
    v_pk_add_f32 v[72:73], v[72:73], v[80:81]
    v_pk_add_f32 v[74:75], v[74:75], v[82:83]
    v_mov_b32 v64, 0
    v_mov_b32 v65, 0
    v_mov_b32 v66, 0
    v_mov_b32 v67, 0
    v_mov_b32 v68, 0
    v_mov_b32 v69, 0
    v_mov_b32 v70, 0
    v_mov_b32 v71, 0
    s_xor_b32 s38, s34, 0x4000
    s_xor_b32 s39, s34, 0x1000
    s_xor_b32 s40, s34, 0x5000
    s_add_u32 s37, s28, 1
    s_bitcmp1_b32 s37, 0
    s_cselect_b32 s4, 0x84000, 0
    s_xor_b32 s34, s35, s4
    s_bitcmp1_b32 s37, 1
    s_cselect_b32 s4, 0x101000, 0
    s_xor_b32 s34, s34, s4
    s_lshr_b32 s37, s37, 2
    s_bitcmp1_b32 s63, s37
    s_cselect_b32 s4, 0x2000, 0
    s_xor_b32 s34, s34, s4
    s_lshl_b32 s37, s37, 21
    s_add_u32 s34, s34, s37
    v_mov_b32 v48, 0
    v_mov_b32 v49, 0
    v_mov_b32 v50, 0
    v_mov_b32 v51, 0
    v_mov_b32 v52, 0
    v_mov_b32 v53, 0
    v_mov_b32 v54, 0
    v_mov_b32 v55, 0
    v_mov_b32 v56, 0
    v_mov_b32 v57, 0
    v_mov_b32 v58, 0
    v_mov_b32 v59, 0
    v_mov_b32 v60, 0
    v_mov_b32 v61, 0
    v_mov_b32 v62, 0
    v_mov_b32 v63, 0
.pl_32:
    buffer_load_dwordx4 v[76:79], v13, s[8:11], s38 offen offset:0 sc1
    buffer_load_dwordx4 v[80:83], v13, s[8:11], s38 offen offset:1024 sc1
    buffer_load_dwordx4 v[84:87], v13, s[8:11], s39 offen offset:0 sc1
    buffer_load_dwordx4 v[88:91], v13, s[8:11], s39 offen offset:1024 sc1
    buffer_load_dwordx4 v[92:95], v13, s[8:11], s40 offen offset:0 sc1
    buffer_load_dwordx4 v[96:99], v13, s[8:11], s40 offen offset:1024 sc1
.pk_35:
    s_waitcnt vmcnt(5)
    v_mfma_f32_16x16x32_bf16 v[108:111], v[76:79], v[124:127], v[72:75]
    v_max_u32 v18, v77, v79
    s_waitcnt vmcnt(4)
    v_mfma_f32_16x16x32_bf16 v[108:111], v[80:83], v[128:131], v[108:111]
    v_max3_u32 v18, v18, v81, v83
    v_cmp_eq_u32 vcc, -1, v18
    s_cbranch_vccnz .pf_36
.pk_37:
    s_waitcnt vmcnt(3)
    v_mfma_f32_16x16x32_bf16 v[112:115], v[84:87], v[124:127], v[108:111]
    v_max_u32 v18, v85, v87
    s_waitcnt vmcnt(2)
    v_mfma_f32_16x16x32_bf16 v[112:115], v[88:91], v[128:131], v[112:115]
    v_max3_u32 v18, v18, v89, v91
    v_cmp_eq_u32 vcc, -1, v18
    s_cbranch_vccnz .pf_38
.pk_39:
    s_waitcnt vmcnt(1)
    v_mfma_f32_16x16x32_bf16 v[100:103], v[92:95], v[124:127], v[112:115]
    v_max_u32 v18, v93, v95
    s_waitcnt vmcnt(0)
    v_mfma_f32_16x16x32_bf16 v[100:103], v[96:99], v[128:131], v[100:103]
    v_max3_u32 v18, v18, v97, v99
    v_cmp_eq_u32 vcc, -1, v18
    s_cbranch_vccnz .pf_40
.pd_34:
    s_nop 4
    v_cvt_pk_bf16_f32 v105, v102, v103
    v_cvt_pk_bf16_f32 v104, v100, v101
    v_min_u32 v105, 0xfffffffe, v105
    buffer_store_dwordx2 v[104:105], v14, s[8:11], s31 offen
    s_mov_b32 s4, s30
    s_mov_b32 s30, s31
    s_mov_b32 s31, s32
    s_mov_b32 s32, s33
    s_mov_b32 s33, s4
    s_add_u32 s28, s28, 1
    s_mov_b32 s62, 0
    s_branch .step_30
.fin_31:
    s_barrier
    s_waitcnt vmcnt(0)
    s_endpgm
.pf_36:
    buffer_load_dwordx4 v[76:79], v13, s[8:11], s38 offen offset:0 sc1
    buffer_load_dwordx4 v[80:83], v13, s[8:11], s38 offen offset:1024 sc1
    s_add_u32 s62, s62, 1
    s_cmp_gt_u32 s62, 0x100000
    s_cbranch_scc1 .mg_end_1
.pk_41:
    s_waitcnt vmcnt(5)
    v_mfma_f32_16x16x32_bf16 v[108:111], v[84:87], v[124:127], v[72:75]
    v_max_u32 v18, v85, v87
    s_waitcnt vmcnt(4)
    v_mfma_f32_16x16x32_bf16 v[108:111], v[88:91], v[128:131], v[108:111]
    v_max3_u32 v18, v18, v89, v91
    v_cmp_eq_u32 vcc, -1, v18
    s_cbranch_vccnz .pf_42
.pk_43:
    s_waitcnt vmcnt(3)
    v_mfma_f32_16x16x32_bf16 v[112:115], v[92:95], v[124:127], v[108:111]
    v_max_u32 v18, v93, v95
    s_waitcnt vmcnt(2)
    v_mfma_f32_16x16x32_bf16 v[112:115], v[96:99], v[128:131], v[112:115]
    v_max3_u32 v18, v18, v97, v99
    v_cmp_eq_u32 vcc, -1, v18
    s_cbranch_vccnz .pf_44
.pk_45:
    s_waitcnt vmcnt(1)
    v_mfma_f32_16x16x32_bf16 v[100:103], v[76:79], v[124:127], v[112:115]
    v_max_u32 v18, v77, v79
    s_waitcnt vmcnt(0)
    v_mfma_f32_16x16x32_bf16 v[100:103], v[80:83], v[128:131], v[100:103]
    v_max3_u32 v18, v18, v81, v83
    v_cmp_eq_u32 vcc, -1, v18
    s_cbranch_vccnz .pf_46
    s_branch .pd_34
.pf_38:
    buffer_load_dwordx4 v[84:87], v13, s[8:11], s39 offen offset:0 sc1
    buffer_load_dwordx4 v[88:91], v13, s[8:11], s39 offen offset:1024 sc1
    s_add_u32 s62, s62, 1
    s_cmp_gt_u32 s62, 0x100000
    s_cbranch_scc1 .mg_end_1
.pk_47:
    s_waitcnt vmcnt(3)
    v_mfma_f32_16x16x32_bf16 v[112:115], v[92:95], v[124:127], v[108:111]
    v_max_u32 v18, v93, v95
    s_waitcnt vmcnt(2)
    v_mfma_f32_16x16x32_bf16 v[112:115], v[96:99], v[128:131], v[112:115]
    v_max3_u32 v18, v18, v97, v99
    v_cmp_eq_u32 vcc, -1, v18
    s_cbranch_vccnz .pf_48
.pk_49:
    s_waitcnt vmcnt(1)
    v_mfma_f32_16x16x32_bf16 v[100:103], v[84:87], v[124:127], v[112:115]
    v_max_u32 v18, v85, v87
    s_waitcnt vmcnt(0)
    v_mfma_f32_16x16x32_bf16 v[100:103], v[88:91], v[128:131], v[100:103]
    v_max3_u32 v18, v18, v89, v91
    v_cmp_eq_u32 vcc, -1, v18
    s_cbranch_vccnz .pf_50
    s_branch .pd_34
.pf_40:
    buffer_load_dwordx4 v[92:95], v13, s[8:11], s40 offen offset:0 sc1
    buffer_load_dwordx4 v[96:99], v13, s[8:11], s40 offen offset:1024 sc1
    s_add_u32 s62, s62, 1
    s_cmp_gt_u32 s62, 0x100000
    s_cbranch_scc1 .mg_end_1
    s_branch .pk_39
.pf_42:
    buffer_load_dwordx4 v[84:87], v13, s[8:11], s39 offen offset:0 sc1
    buffer_load_dwordx4 v[88:91], v13, s[8:11], s39 offen offset:1024 sc1
    s_add_u32 s62, s62, 1
    s_cmp_gt_u32 s62, 0x100000
    s_cbranch_scc1 .mg_end_1
.pk_51:
    s_waitcnt vmcnt(5)
    v_mfma_f32_16x16x32_bf16 v[108:111], v[92:95], v[124:127], v[72:75]
    v_max_u32 v18, v93, v95
    s_waitcnt vmcnt(4)
    v_mfma_f32_16x16x32_bf16 v[108:111], v[96:99], v[128:131], v[108:111]
    v_max3_u32 v18, v18, v97, v99
    v_cmp_eq_u32 vcc, -1, v18
    s_cbranch_vccnz .pf_52
.pk_53:
    s_waitcnt vmcnt(3)
    v_mfma_f32_16x16x32_bf16 v[112:115], v[76:79], v[124:127], v[108:111]
    v_max_u32 v18, v77, v79
    s_waitcnt vmcnt(2)
    v_mfma_f32_16x16x32_bf16 v[112:115], v[80:83], v[128:131], v[112:115]
    v_max3_u32 v18, v18, v81, v83
    v_cmp_eq_u32 vcc, -1, v18
    s_cbranch_vccnz .pf_54
    s_branch .pk_49
.pf_44:
    buffer_load_dwordx4 v[92:95], v13, s[8:11], s40 offen offset:0 sc1
    buffer_load_dwordx4 v[96:99], v13, s[8:11], s40 offen offset:1024 sc1
    s_add_u32 s62, s62, 1
    s_cmp_gt_u32 s62, 0x100000
    s_cbranch_scc1 .mg_end_1
.pk_55:
    s_waitcnt vmcnt(3)
    v_mfma_f32_16x16x32_bf16 v[112:115], v[76:79], v[124:127], v[108:111]
    v_max_u32 v18, v77, v79
    s_waitcnt vmcnt(2)
    v_mfma_f32_16x16x32_bf16 v[112:115], v[80:83], v[128:131], v[112:115]
    v_max3_u32 v18, v18, v81, v83
    v_cmp_eq_u32 vcc, -1, v18
    s_cbranch_vccnz .pf_56
    s_branch .pk_39
.pf_46:
    buffer_load_dwordx4 v[76:79], v13, s[8:11], s38 offen offset:0 sc1
    buffer_load_dwordx4 v[80:83], v13, s[8:11], s38 offen offset:1024 sc1
    s_add_u32 s62, s62, 1
    s_cmp_gt_u32 s62, 0x100000
    s_cbranch_scc1 .mg_end_1
    s_branch .pk_45
.pf_48:
    buffer_load_dwordx4 v[92:95], v13, s[8:11], s40 offen offset:0 sc1
    buffer_load_dwordx4 v[96:99], v13, s[8:11], s40 offen offset:1024 sc1
    s_add_u32 s62, s62, 1
    s_cmp_gt_u32 s62, 0x100000
    s_cbranch_scc1 .mg_end_1
    s_branch .pk_37
.pf_50:
    buffer_load_dwordx4 v[84:87], v13, s[8:11], s39 offen offset:0 sc1
    buffer_load_dwordx4 v[88:91], v13, s[8:11], s39 offen offset:1024 sc1
    s_add_u32 s62, s62, 1
    s_cmp_gt_u32 s62, 0x100000
    s_cbranch_scc1 .mg_end_1
    s_branch .pk_49
.pf_52:
    buffer_load_dwordx4 v[92:95], v13, s[8:11], s40 offen offset:0 sc1
    buffer_load_dwordx4 v[96:99], v13, s[8:11], s40 offen offset:1024 sc1
    s_add_u32 s62, s62, 1
    s_cmp_gt_u32 s62, 0x100000
    s_cbranch_scc1 .mg_end_1
    s_branch .pk_35
.pf_54:
    buffer_load_dwordx4 v[76:79], v13, s[8:11], s38 offen offset:0 sc1
    buffer_load_dwordx4 v[80:83], v13, s[8:11], s38 offen offset:1024 sc1
    s_add_u32 s62, s62, 1
    s_cmp_gt_u32 s62, 0x100000
    s_cbranch_scc1 .mg_end_1
.pk_57:
    s_waitcnt vmcnt(3)
    v_mfma_f32_16x16x32_bf16 v[112:115], v[84:87], v[124:127], v[108:111]
    v_max_u32 v18, v85, v87
    s_waitcnt vmcnt(2)
    v_mfma_f32_16x16x32_bf16 v[112:115], v[88:91], v[128:131], v[112:115]
    v_max3_u32 v18, v18, v89, v91
    v_cmp_eq_u32 vcc, -1, v18
    s_cbranch_vccnz .pf_58
    s_branch .pk_45
.pf_56:
    buffer_load_dwordx4 v[76:79], v13, s[8:11], s38 offen offset:0 sc1
    buffer_load_dwordx4 v[80:83], v13, s[8:11], s38 offen offset:1024 sc1
    s_add_u32 s62, s62, 1
    s_cmp_gt_u32 s62, 0x100000
    s_cbranch_scc1 .mg_end_1
    s_branch .pk_43
.pf_58:
    buffer_load_dwordx4 v[84:87], v13, s[8:11], s39 offen offset:0 sc1
    buffer_load_dwordx4 v[88:91], v13, s[8:11], s39 offen offset:1024 sc1
    s_add_u32 s62, s62, 1
    s_cmp_gt_u32 s62, 0x100000
    s_cbranch_scc1 .mg_end_1
    s_branch .pk_53
.pr_33:
    s_add_u32 s62, s62, 1
    s_cmp_gt_u32 s62, 0x100000
    s_cbranch_scc1 .mg_end_1
    s_branch .pl_32
.w2_20:
    v_bfe_u32 v254, v1, 4, 1
    v_mul_u32_u24 v168, 1024, v254
    v_bfe_u32 v254, v1, 5, 1
    v_mul_u32_u24 v254, 128, v254
    v_add_u32 v168, v168, v254
    v_bfe_u32 v254, v1, 3, 1
    v_mul_u32_u24 v254, 64, v254
    v_add_u32 v168, v168, v254
    v_bfe_u32 v254, v1, 0, 2
    v_mul_u32_u24 v254, 16, v254
    v_add_u32 v168, v168, v254
    v_bfe_u32 v254, v1, 2, 1
    v_mul_u32_u24 v254, 8, v254
    v_add_u32 v168, v168, v254
    v_add_u32 v168, 512, v168
    v_add_u32 v168, s101, v168
    s_lshl_b32 s4, s56, 9
    s_lshl_b32 s5, s53, 7
    s_add_u32 s4, s4, s5
    s_add_u32 s4, s4, 92274688
    v_mov_b32 v14, s4
    v_bfe_u32 v254, v1, 0, 6
    v_mul_u32_u24 v12, 16, v254
    v_add_u32 v12, 18176, v12
    v_bfe_u32 v254, v1, 0, 6
    v_mul_u32_u24 v15, 16, v254
    s_add_u32 s42, s42, 262144
    s_add_u32 s43, s43, 262144
    s_add_u32 s44, s44, 262144
    s_mov_b32 exec_hi, 0
    v_xor_b32 v244, 1024, v244
    s_mov_b32 exec_hi, -1
    buffer_load_dwordx4 v[24:27], v246, s[8:11], s32 offen sc1
    buffer_load_dwordx4 v[28:31], v245, s[8:11], s32 offen sc1
    buffer_load_dword v32, v237, s[8:11], s32 offen sc1
    s_waitcnt vmcnt(0)
    ds_read_b64_tr_b16 a[192:193], v242 offset:16384
    ds_read_b64_tr_b16 a[194:195], v242 offset:16896
    ds_read_b64_tr_b16 a[196:197], v242 offset:18432
    ds_read_b64_tr_b16 a[198:199], v242 offset:18944
    ds_read_b64_tr_b16 a[200:201], v242 offset:20480
    ds_read_b64_tr_b16 a[202:203], v242 offset:20992
    ds_read_b64_tr_b16 a[204:205], v242 offset:22528
    ds_read_b64_tr_b16 a[206:207], v242 offset:23040
    ds_read_b64_tr_b16 a[208:209], v242 offset:24576
    ds_read_b64_tr_b16 a[210:211], v242 offset:25088
    ds_read_b64_tr_b16 a[212:213], v242 offset:26624
    ds_read_b64_tr_b16 a[214:215], v242 offset:27136
    ds_read_b64_tr_b16 a[216:217], v242 offset:28672
    ds_read_b64_tr_b16 a[218:219], v242 offset:29184
    ds_read_b64_tr_b16 a[220:221], v242 offset:30720
    ds_read_b64_tr_b16 a[222:223], v242 offset:31232
    ds_read_b64_tr_b16 a[224:225], v243 offset:16384
    ds_read_b64_tr_b16 a[226:227], v243 offset:16896
    ds_read_b64_tr_b16 a[228:229], v243 offset:18432
    ds_read_b64_tr_b16 a[230:231], v243 offset:18944
    ds_read_b64_tr_b16 a[232:233], v243 offset:20480
    ds_read_b64_tr_b16 a[234:235], v243 offset:20992
    ds_read_b64_tr_b16 a[236:237], v243 offset:22528
    ds_read_b64_tr_b16 a[238:239], v243 offset:23040
    ds_read_b64_tr_b16 a[240:241], v243 offset:24576
    ds_read_b64_tr_b16 a[242:243], v243 offset:25088
    ds_read_b64_tr_b16 a[244:245], v243 offset:26624
    ds_read_b64_tr_b16 a[246:247], v243 offset:27136
    ds_read_b64_tr_b16 a[248:249], v243 offset:28672
    ds_read_b64_tr_b16 a[250:251], v243 offset:29184
    ds_read_b64_tr_b16 a[252:253], v243 offset:30720
    ds_read_b64_tr_b16 a[254:255], v243 offset:31232
    s_waitcnt lgkmcnt(0)
    s_barrier
.p2align 6
.step_59:
    s_barrier
    s_setprio 3
    buffer_load_dwordx4 v[24:27], v3, s[8:11], s30 offen offset:0 sc1
    s_setprio 2
    buffer_load_dwordx4 v[28:31], v3, s[8:11], s30 offen offset:1024 sc1
    s_setprio 1
    buffer_load_dwordx4 v[32:35], v3, s[8:11], s30 offen offset:2048 sc1
    s_setprio 0
    buffer_load_dwordx4 v[36:39], v3, s[8:11], s30 offen offset:3072 sc1
    s_call_b64 s[98:99], .gm_22
    v_pk_add_f32 v[40:41], v[40:41], v[42:43]
    v_pk_add_f32 v[42:43], v[44:45], v[46:47]
    ds_write2_b32 v5, v40, v41 offset0:0 offset1:36
    ds_write2_b32 v5, v42, v43 offset0:16 offset1:52
    s_nop 1
    v_pk_add_f32 v[48:49], v[48:49], v[50:51]
    v_pk_add_f32 v[50:51], v[52:53], v[54:55]
    ds_write2_b32 v6, v48, v49 offset0:0 offset1:36
    ds_write2_b32 v6, v50, v51 offset0:16 offset1:52
    s_waitcnt lgkmcnt(2)
    s_barrier
    s_waitcnt lgkmcnt(0)
    s_barrier
    v_smfmac_f32_16x16x64_bf16 v[56:59], v[24:27], a[128:135], v2
    v_smfmac_f32_16x16x64_bf16 v[60:63], v[24:27], a[160:167], v2
    v_smfmac_f32_16x16x64_bf16 v[56:59], v[28:31], a[136:143], v2
    v_smfmac_f32_16x16x64_bf16 v[60:63], v[28:31], a[168:175], v2
    v_smfmac_f32_16x16x64_bf16 v[56:59], v[32:35], a[144:151], v2
    v_smfmac_f32_16x16x64_bf16 v[60:63], v[32:35], a[176:183], v2
    v_smfmac_f32_16x16x64_bf16 v[56:59], v[36:39], a[152:159], v2
    v_smfmac_f32_16x16x64_bf16 v[60:63], v[36:39], a[184:191], v2
    ds_read_b64 v[72:73], v9 offset:0
    ds_read_b64 v[74:75], v9 offset:1152
    ds_read_b64 v[76:77], v9 offset:2304
    ds_read_b64 v[78:79], v9 offset:3456
    s_waitcnt lgkmcnt(0)
    v_pk_add_f32 v[72:73], v[72:73], v[74:75]
    v_pk_add_f32 v[76:77], v[76:77], v[78:79]
    v_pk_add_f32 v[72:73], v[72:73], v[76:77]
    v_cvt_pk_bf16_f32 v72, v72, v73
    ds_write_b32 v11, v72
    v_mov_b32 v40, 0
    v_mov_b32 v41, 0
    v_mov_b32 v42, 0
    v_mov_b32 v43, 0
    v_mov_b32 v44, 0
    v_mov_b32 v45, 0
    v_mov_b32 v46, 0
    v_mov_b32 v47, 0
    v_pk_add_f32 v[56:57], v[56:57], v[58:59]
    v_pk_add_f32 v[58:59], v[60:61], v[62:63]
    v_cvt_pk_bf16_f32 v60, v56, v57
    v_cvt_pk_bf16_f32 v61, v58, v59
    ds_write2_b32 v255, v60, v61 offset0:0 offset1:32
    ds_write_b128 v8, v[56:59]
    s_waitcnt lgkmcnt(0)
    s_barrier
    s_cmp_eq_u32 s28, 63
    s_cbranch_scc1 .fin_60
    s_add_u32 s37, s28, 0
    s_bitcmp1_b32 s37, 0
    s_cselect_b32 s4, 0x84000, 0
    s_xor_b32 s34, s35, s4
    s_bitcmp1_b32 s37, 1
    s_cselect_b32 s4, 0x101000, 0
    s_xor_b32 s34, s34, s4
    s_lshr_b32 s37, s37, 2
    s_bitcmp1_b32 s63, s37
    s_cselect_b32 s4, 0x2000, 0
    s_xor_b32 s34, s34, s4
    s_lshl_b32 s37, s37, 21
    s_add_u32 s34, s34, s37
    s_waitcnt lgkmcnt(0)
    v_mov_b32 v48, 0
    v_mov_b32 v49, 0
    v_mov_b32 v50, 0
    v_mov_b32 v51, 0
    v_mov_b32 v52, 0
    v_mov_b32 v53, 0
    v_mov_b32 v54, 0
    v_mov_b32 v55, 0
    v_mov_b32 v56, 0
    v_mov_b32 v57, 0
    v_mov_b32 v58, 0
    v_mov_b32 v59, 0
    v_mov_b32 v60, 0
    v_mov_b32 v61, 0
    v_mov_b32 v62, 0
    v_mov_b32 v63, 0
    s_barrier
    ds_read_b128 v[72:75], v12
    s_setprio 3
    buffer_load_dwordx4 v[24:27], v4, s[8:11], s30 offen offset:0 sc1
    s_setprio 2
    buffer_load_dwordx4 v[28:31], v4, s[8:11], s30 offen offset:1024 sc1
    s_setprio 1
    buffer_load_dwordx4 v[32:35], v4, s[8:11], s30 offen offset:2048 sc1
    s_setprio 0
    buffer_load_dwordx4 v[36:39], v4, s[8:11], s30 offen offset:3072 sc1
    s_call_b64 s[98:99], .gm_23
    s_waitcnt lgkmcnt(0)
    buffer_store_dwordx4 v[72:75], v244, s[8:11], s41 offen sc1
    s_nop 3
    v_pk_add_f32 v[64:65], v[64:65], v[66:67]
    v_cvt_pk_bf16_f32 v66, v64, v65
    v_pk_add_f32 v[68:69], v[68:69], v[70:71]
    v_cvt_pk_bf16_f32 v67, v68, v69
    v_min_u32 v67, 0xfffffffe, v67
    buffer_store_dwordx2 v[66:67], v168, s[8:11], s34 offen sc1
    ds_write2_b32 v7, v64, v65 offset0:0 offset1:36
    ds_write2_b32 v7, v68, v69 offset0:16 offset1:52
    s_waitcnt lgkmcnt(0)
    s_barrier
    s_cmp_lt_u32 s28, 52
    s_cselect_b32 s4, 1, 0
    s_andn2_b32 s4, s4, s28
    s_cbranch_scc1 .nl_61
    v_mov_b32 v18, s28
    v_add_u32 v18, 1, v18
    s_mov_b64 exec, 1
    s_waitcnt vmcnt(0)
    buffer_store_dword v18, v14, s[8:11], 0 offen sc1
    s_mov_b64 exec, -1
.nl_61:
    v_mov_b32 v64, 0
    v_mov_b32 v65, 0
    v_mov_b32 v66, 0
    v_mov_b32 v67, 0
    v_mov_b32 v68, 0
    v_mov_b32 v69, 0
    v_mov_b32 v70, 0
    v_mov_b32 v71, 0
    s_mov_b32 s4, s30
    s_mov_b32 s30, s31
    s_mov_b32 s31, s32
    s_mov_b32 s32, s33
    s_mov_b32 s33, s4
    s_add_u32 s28, s28, 1
    s_mov_b32 s62, 0
    s_add_u32 s41, s41, 0x20000
    s_branch .step_59
.fin_60:
    s_barrier
    s_endpgm
.w3_21:
    v_bfe_u32 v254, v1, 4, 1
    v_mul_u32_u24 v168, 1024, v254
    v_bfe_u32 v254, v1, 5, 1
    v_mul_u32_u24 v254, 128, v254
    v_add_u32 v168, v168, v254
    v_bfe_u32 v254, v1, 3, 1
    v_mul_u32_u24 v254, 64, v254
    v_add_u32 v168, v168, v254
    v_bfe_u32 v254, v1, 0, 2
    v_mul_u32_u24 v254, 16, v254
    v_add_u32 v168, v168, v254
    v_bfe_u32 v254, v1, 2, 1
    v_mul_u32_u24 v254, 8, v254
    v_add_u32 v168, v168, v254
    v_add_u32 v168, 768, v168
    v_add_u32 v168, s101, v168
    v_bfe_u32 v254, v1, 3, 1
    v_mul_u32_u24 v12, 8, v254
    v_bfe_u32 v254, v1, 5, 1
    v_mul_u32_u24 v254, 256, v254
    v_add_u32 v12, v12, v254
    v_bfe_u32 v254, v1, 2, 1
    v_mul_u32_u24 v254, 128, v254
    v_add_u32 v12, v12, v254
    v_bfe_u32 v254, v1, 0, 2
    v_mul_u32_u24 v254, 16, v254
    v_add_u32 v12, v12, v254
    v_bfe_u32 v254, v1, 4, 1
    v_mul_u32_u24 v254, 512, v254
    v_add_u32 v12, v12, v254
    v_add_u32 v12, 14080, v12
    v_bfe_u32 v254, v1, 2, 2
    v_mul_u32_u24 v14, 128, v254
    v_bfe_u32 v254, v1, 0, 2
    v_mul_u32_u24 v254, 16, v254
    v_add_u32 v14, v14, v254
    v_bfe_u32 v254, v1, 4, 2
    v_mul_u32_u24 v254, 4, v254
    v_add_u32 v14, v14, v254
    v_add_u32 v14, 18688, v14
    v_bfe_u32 v254, v1, 0, 6
    v_mul_u32_u24 v15, 16, v254
    v_add_u32 v15, s101, v15
    v_bfe_u32 v254, v1, 2, 2
    v_mul_u32_u24 v16, 128, v254
    v_bfe_u32 v254, v1, 0, 2
    v_mul_u32_u24 v254, 16, v254
    v_add_u32 v16, v16, v254
    v_bfe_u32 v254, v1, 4, 2
    v_mul_u32_u24 v254, 4, v254
    v_add_u32 v16, v16, v254
    v_add_u32 v16, 135168, v16
    v_add_u32 v16, s58, v16
    s_lshl_b32 s4, s56, 9
    s_add_u32 s4, s4, 92291072
    v_bfe_u32 v254, v1, 0, 2
    v_mul_u32_u24 v13, 128, v254
    v_bfe_u32 v254, v1, 2, 1
    v_mul_u32_u24 v254, 16384, v254
    v_add_u32 v13, v13, v254
    v_add_u32 v13, s4, v13
    s_lshl_b32 s4, s56, 9
    s_lshl_b32 s5, s53, 7
    s_add_u32 s4, s4, s5
    s_add_u32 s4, s4, 92274688
    v_mov_b32 v174, s4
    v_bfe_u32 v254, v1, 0, 6
    v_mul_u32_u24 v175, 16, v254
    v_add_u32 v175, 18176, v175
    s_mov_b32 exec_hi, 0
    v_xor_b32 v244, 1024, v244
    s_mov_b32 exec_hi, -1
    buffer_load_dwordx4 v[24:27], v246, s[8:11], s33 offen sc1
    buffer_load_dwordx4 v[28:31], v245, s[8:11], s33 offen sc1
    buffer_load_dword v32, v237, s[8:11], s33 offen sc1
    s_waitcnt vmcnt(0)
    ds_read_b64_tr_b16 a[192:193], v242 offset:16384
    ds_read_b64_tr_b16 a[194:195], v242 offset:16896
    ds_read_b64_tr_b16 a[196:197], v242 offset:18432
    ds_read_b64_tr_b16 a[198:199], v242 offset:18944
    ds_read_b64_tr_b16 a[200:201], v242 offset:20480
    ds_read_b64_tr_b16 a[202:203], v242 offset:20992
    ds_read_b64_tr_b16 a[204:205], v242 offset:22528
    ds_read_b64_tr_b16 a[206:207], v242 offset:23040
    ds_read_b64_tr_b16 a[208:209], v242 offset:24576
    ds_read_b64_tr_b16 a[210:211], v242 offset:25088
    ds_read_b64_tr_b16 a[212:213], v242 offset:26624
    ds_read_b64_tr_b16 a[214:215], v242 offset:27136
    ds_read_b64_tr_b16 a[216:217], v242 offset:28672
    ds_read_b64_tr_b16 a[218:219], v242 offset:29184
    ds_read_b64_tr_b16 a[220:221], v242 offset:30720
    ds_read_b64_tr_b16 a[222:223], v242 offset:31232
    ds_read_b64_tr_b16 a[224:225], v243 offset:16384
    ds_read_b64_tr_b16 a[226:227], v243 offset:16896
    ds_read_b64_tr_b16 a[228:229], v243 offset:18432
    ds_read_b64_tr_b16 a[230:231], v243 offset:18944
    ds_read_b64_tr_b16 a[232:233], v243 offset:20480
    ds_read_b64_tr_b16 a[234:235], v243 offset:20992
    ds_read_b64_tr_b16 a[236:237], v243 offset:22528
    ds_read_b64_tr_b16 a[238:239], v243 offset:23040
    ds_read_b64_tr_b16 a[240:241], v243 offset:24576
    ds_read_b64_tr_b16 a[242:243], v243 offset:25088
    ds_read_b64_tr_b16 a[244:245], v243 offset:26624
    ds_read_b64_tr_b16 a[246:247], v243 offset:27136
    ds_read_b64_tr_b16 a[248:249], v243 offset:28672
    ds_read_b64_tr_b16 a[250:251], v243 offset:29184
    ds_read_b64_tr_b16 a[252:253], v243 offset:30720
    ds_read_b64_tr_b16 a[254:255], v243 offset:31232
    s_waitcnt lgkmcnt(0)
    s_cmp_ge_u32 s46, 1
    s_cbranch_scc1 .kvd_63
    s_mov_b32 s62, 0
.kv_62:
    buffer_load_dword v18, v13, s[8:11], 0 offen sc1
    s_add_u32 s62, s62, 1
    s_cmp_gt_u32 s62, 0x100000
    s_cbranch_scc1 .mg_end_1
    s_waitcnt vmcnt(0)
    v_min_u32_dpp v18, v18, v18 quad_perm:[1,0,3,2] row_mask:0xf bank_mask:0xf
    s_nop 1
    v_min_u32_dpp v18, v18, v18 quad_perm:[2,3,0,1] row_mask:0xf bank_mask:0xf
    s_nop 1
    v_min_u32_dpp v18, v18, v18 row_half_mirror row_mask:0xf bank_mask:0xf
    s_nop 0
    v_readfirstlane_b32 s46, v18
    s_cmp_lt_u32 s46, 1
    s_cbranch_scc1 .kv_62
.kvd_63:
    s_barrier
.p2align 6
.step_64:
    s_barrier
    s_setprio 3
    buffer_load_dwordx4 v[24:27], v3, s[8:11], s30 offen offset:0 sc1
    s_setprio 2
    buffer_load_dwordx4 v[28:31], v3, s[8:11], s30 offen offset:1024 sc1
    s_setprio 1
    buffer_load_dwordx4 v[32:35], v3, s[8:11], s30 offen offset:2048 sc1
    s_setprio 0
    buffer_load_dwordx4 v[36:39], v3, s[8:11], s30 offen offset:3072 sc1
    s_call_b64 s[98:99], .gm_22
    v_pk_add_f32 v[40:41], v[40:41], v[42:43]
    v_pk_add_f32 v[42:43], v[44:45], v[46:47]
    ds_write2_b32 v5, v40, v41 offset0:0 offset1:36
    ds_write2_b32 v5, v42, v43 offset0:16 offset1:52
    s_nop 1
    v_pk_add_f32 v[48:49], v[48:49], v[50:51]
    v_pk_add_f32 v[50:51], v[52:53], v[54:55]
    ds_write2_b32 v6, v48, v49 offset0:0 offset1:36
    ds_write2_b32 v6, v50, v51 offset0:16 offset1:52
    s_waitcnt lgkmcnt(2)
    s_barrier
    s_waitcnt lgkmcnt(0)
    s_barrier
    v_smfmac_f32_16x16x64_bf16 v[56:59], v[24:27], a[128:135], v2
    v_smfmac_f32_16x16x64_bf16 v[60:63], v[24:27], a[160:167], v2
    v_smfmac_f32_16x16x64_bf16 v[56:59], v[28:31], a[136:143], v2
    v_smfmac_f32_16x16x64_bf16 v[60:63], v[28:31], a[168:175], v2
    v_smfmac_f32_16x16x64_bf16 v[56:59], v[32:35], a[144:151], v2
    v_smfmac_f32_16x16x64_bf16 v[60:63], v[32:35], a[176:183], v2
    v_smfmac_f32_16x16x64_bf16 v[56:59], v[36:39], a[152:159], v2
    v_smfmac_f32_16x16x64_bf16 v[60:63], v[36:39], a[184:191], v2
    ds_read_b64 v[72:73], v9 offset:0
    ds_read_b64 v[74:75], v9 offset:1152
    ds_read_b64 v[76:77], v9 offset:2304
    ds_read_b64 v[78:79], v9 offset:3456
    s_waitcnt lgkmcnt(0)
    v_pk_add_f32 v[72:73], v[72:73], v[74:75]
    v_pk_add_f32 v[76:77], v[76:77], v[78:79]
    v_pk_add_f32 v[72:73], v[72:73], v[76:77]
    v_cvt_pk_bf16_f32 v72, v72, v73
    ds_write_b32 v11, v72
    v_mov_b32 v40, 0
    v_mov_b32 v41, 0
    v_mov_b32 v42, 0
    v_mov_b32 v43, 0
    v_mov_b32 v44, 0
    v_mov_b32 v45, 0
    v_mov_b32 v46, 0
    v_mov_b32 v47, 0
    v_pk_add_f32 v[56:57], v[56:57], v[58:59]
    v_pk_add_f32 v[58:59], v[60:61], v[62:63]
    v_cvt_pk_bf16_f32 v60, v56, v57
    v_cvt_pk_bf16_f32 v61, v58, v59
    ds_write2_b32 v255, v60, v61 offset0:0 offset1:32
    ds_write_b128 v8, v[56:59]
    s_waitcnt lgkmcnt(0)
    s_barrier
    ds_read_b64 v[72:73], v12 offset:0
    ds_read_b64 v[74:75], v12 offset:1024
    ds_read_b64 v[76:77], v12 offset:2048
    ds_read_b64 v[78:79], v12 offset:3072
    ds_read_b64 v[80:81], v12 offset:64
    ds_read_b64 v[82:83], v12 offset:1088
    ds_read_b64 v[84:85], v12 offset:2112
    ds_read_b64 v[86:87], v12 offset:3136
    s_waitcnt lgkmcnt(4)
    v_add_f32 v72, v72, v74
    v_add_f32 v73, v73, v75
    v_add_f32 v76, v76, v78
    v_add_f32 v77, v77, v79
    v_add_f32 v72, v72, v76
    v_add_f32 v73, v73, v77
    v_cvt_pk_bf16_f32 v72, v72, v73
    s_waitcnt lgkmcnt(0)
    v_add_f32 v80, v80, v82
    v_add_f32 v81, v81, v83
    v_add_f32 v84, v84, v86
    v_add_f32 v85, v85, v87
    v_add_f32 v80, v80, v84
    v_add_f32 v81, v81, v85
    v_cvt_pk_bf16_f32 v80, v80, v81
    ds_write_b32 v14, v72
    ds_write_b32 v14, v80 offset:64
    s_waitcnt lgkmcnt(0)
    s_cmp_ge_u32 s28, 62
    s_cbranch_scc1 .ke_66
.kb_67:
    s_cmp_eq_u32 s28, 63
    s_cbranch_scc1 .fin_65
    s_add_u32 s37, s28, 0
    s_bitcmp1_b32 s37, 0
    s_cselect_b32 s4, 0x84000, 0
    s_xor_b32 s34, s35, s4
    s_bitcmp1_b32 s37, 1
    s_cselect_b32 s4, 0x101000, 0
    s_xor_b32 s34, s34, s4
    s_lshr_b32 s37, s37, 2
    s_bitcmp1_b32 s63, s37
    s_cselect_b32 s4, 0x2000, 0
    s_xor_b32 s34, s34, s4
    s_lshl_b32 s37, s37, 21
    s_add_u32 s34, s34, s37
    buffer_store_dwordx4 v[20:23], v246, s[8:11], s32 offen
    buffer_store_dwordx4 v[20:23], v245, s[8:11], s32 offen
    buffer_store_dword v20, v237, s[8:11], s32 offen
    s_add_u32 s5, s28, 2
    s_cmp_ge_u32 s46, s5
    s_cbranch_scc1 .kvd_71
    s_mov_b32 s62, 0
.kv_70:
    buffer_load_dword v18, v13, s[8:11], 0 offen sc1
    s_add_u32 s62, s62, 1
    s_cmp_gt_u32 s62, 0x100000
    s_cbranch_scc1 .mg_end_1
    s_waitcnt vmcnt(0)
    v_min_u32_dpp v18, v18, v18 quad_perm:[1,0,3,2] row_mask:0xf bank_mask:0xf
    s_nop 1
    v_min_u32_dpp v18, v18, v18 quad_perm:[2,3,0,1] row_mask:0xf bank_mask:0xf
    s_nop 1
    v_min_u32_dpp v18, v18, v18 row_half_mirror row_mask:0xf bank_mask:0xf
    s_nop 0
    v_readfirstlane_b32 s46, v18
    s_cmp_lt_u32 s46, s5
    s_cbranch_scc1 .kv_70
.kvd_71:
    v_mov_b32 v48, 0
    v_mov_b32 v49, 0
    v_mov_b32 v50, 0
    v_mov_b32 v51, 0
    v_mov_b32 v52, 0
    v_mov_b32 v53, 0
    v_mov_b32 v54, 0
    v_mov_b32 v55, 0
    v_mov_b32 v56, 0
    v_mov_b32 v57, 0
    v_mov_b32 v58, 0
    v_mov_b32 v59, 0
    v_mov_b32 v60, 0
    v_mov_b32 v61, 0
    v_mov_b32 v62, 0
    v_mov_b32 v63, 0
    s_cmp_ge_u32 s28, 62
    s_cbranch_scc1 .kf_68
.kg_69:
    s_barrier
    s_setprio 3
    buffer_load_dwordx4 v[24:27], v4, s[8:11], s30 offen offset:0 sc1
    s_setprio 2
    buffer_load_dwordx4 v[28:31], v4, s[8:11], s30 offen offset:1024 sc1
    s_setprio 1
    buffer_load_dwordx4 v[32:35], v4, s[8:11], s30 offen offset:2048 sc1
    s_setprio 0
    buffer_load_dwordx4 v[36:39], v4, s[8:11], s30 offen offset:3072 sc1
    s_call_b64 s[98:99], .gm_23
    s_nop 4
    v_pk_add_f32 v[64:65], v[64:65], v[66:67]
    v_cvt_pk_bf16_f32 v66, v64, v65
    v_pk_add_f32 v[68:69], v[68:69], v[70:71]
    v_cvt_pk_bf16_f32 v67, v68, v69
    v_min_u32 v67, 0xfffffffe, v67
    buffer_store_dwordx2 v[66:67], v168, s[8:11], s34 offen sc1
    ds_write2_b32 v7, v64, v65 offset0:0 offset1:36
    ds_write2_b32 v7, v68, v69 offset0:16 offset1:52
    s_waitcnt lgkmcnt(0)
    s_barrier
    s_add_u32 s5, s28, 3
    s_min_u32 s5, s5, 64
    s_cmp_ge_u32 s46, s5
    s_cbranch_scc1 .kvd_73
    s_mov_b32 s62, 0
.kv_72:
    buffer_load_dword v18, v13, s[8:11], 0 offen sc1
    s_add_u32 s62, s62, 1
    s_cmp_gt_u32 s62, 0x100000
    s_cbranch_scc1 .mg_end_1
    s_waitcnt vmcnt(0)
    v_min_u32_dpp v18, v18, v18 quad_perm:[1,0,3,2] row_mask:0xf bank_mask:0xf
    s_nop 1
    v_min_u32_dpp v18, v18, v18 quad_perm:[2,3,0,1] row_mask:0xf bank_mask:0xf
    s_nop 1
    v_min_u32_dpp v18, v18, v18 row_half_mirror row_mask:0xf bank_mask:0xf
    s_nop 0
    v_readfirstlane_b32 s46, v18
.kvd_73:
    v_mov_b32 v64, 0
    v_mov_b32 v65, 0
    v_mov_b32 v66, 0
    v_mov_b32 v67, 0
    v_mov_b32 v68, 0
    v_mov_b32 v69, 0
    v_mov_b32 v70, 0
    v_mov_b32 v71, 0
    s_mov_b32 s4, s30
    s_mov_b32 s30, s31
    s_mov_b32 s31, s32
    s_mov_b32 s32, s33
    s_mov_b32 s33, s4
    s_add_u32 s28, s28, 1
    s_mov_b32 s62, 0
    s_add_u32 s41, s41, 0x20000
    s_branch .step_64
.fin_65:
    s_barrier
    s_add_u32 s4, s28, 1
    v_mov_b32 v18, s4
    s_mov_b64 exec, 1
    s_waitcnt vmcnt(0)
    buffer_store_dword v18, v174, s[8:11], 0 offen sc1
    s_mov_b64 exec, -1
    s_endpgm
.ke_66:
    ds_read_b128 v[72:75], v175
    s_waitcnt lgkmcnt(0)
    buffer_store_dwordx4 v[72:75], v244, s[8:11], s41 offen sc1
    s_branch .kb_67
.kf_68:
    s_add_u32 s4, s28, 1
    v_mov_b32 v18, s4
    s_mov_b64 exec, 1
    s_waitcnt vmcnt(0)
    buffer_store_dword v18, v174, s[8:11], 0 offen sc1
    s_mov_b64 exec, -1
    s_branch .kg_69
.p2align 6
.gm_22:
    s_waitcnt vmcnt(3)
    v_max_u32 v18, v25, v27
    v_cmp_eq_u32 vcc, -1, v18
    s_cbranch_vccnz .nk_74
.ok_75:
    v_smfmac_f32_16x16x64_bf16 v[40:43], v[24:27], a[0:7], v2
    v_smfmac_f32_16x16x64_bf16 v[44:47], v[24:27], a[32:39], v2
    s_waitcnt vmcnt(2)
    v_max_u32 v18, v29, v31
    v_cmp_eq_u32 vcc, -1, v18
    v_smfmac_f32_16x16x64_bf16 v[48:51], v[24:27], a[64:71], v2
    v_smfmac_f32_16x16x64_bf16 v[52:55], v[24:27], a[96:103], v2
    s_cbranch_vccnz .nk_76
.ok_77:
    v_smfmac_f32_16x16x64_bf16 v[40:43], v[28:31], a[8:15], v2
    v_smfmac_f32_16x16x64_bf16 v[44:47], v[28:31], a[40:47], v2
    s_waitcnt vmcnt(1)
    v_max_u32 v18, v33, v35
    v_cmp_eq_u32 vcc, -1, v18
    v_smfmac_f32_16x16x64_bf16 v[48:51], v[28:31], a[72:79], v2
    v_smfmac_f32_16x16x64_bf16 v[52:55], v[28:31], a[104:111], v2
    s_cbranch_vccnz .nk_78
.ok_79:
    v_smfmac_f32_16x16x64_bf16 v[40:43], v[32:35], a[16:23], v2
    v_smfmac_f32_16x16x64_bf16 v[44:47], v[32:35], a[48:55], v2
    s_waitcnt vmcnt(0)
    v_max_u32 v18, v37, v39
    v_cmp_eq_u32 vcc, -1, v18
    v_smfmac_f32_16x16x64_bf16 v[48:51], v[32:35], a[80:87], v2
    v_smfmac_f32_16x16x64_bf16 v[52:55], v[32:35], a[112:119], v2
    s_cbranch_vccnz .nk_80
.ok_81:
    v_smfmac_f32_16x16x64_bf16 v[40:43], v[36:39], a[24:31], v2
    v_smfmac_f32_16x16x64_bf16 v[44:47], v[36:39], a[56:63], v2
    v_smfmac_f32_16x16x64_bf16 v[48:51], v[36:39], a[88:95], v2
    v_smfmac_f32_16x16x64_bf16 v[52:55], v[36:39], a[120:127], v2
    s_setpc_b64 s[98:99]
.nk_74:
    buffer_load_dwordx4 v[24:27], v3, s[8:11], s30 offen offset:0 sc1
    s_add_u32 s62, s62, 1
    s_cmp_gt_u32 s62, 0x100000
    s_cbranch_scc1 .mg_end_1
    s_waitcnt vmcnt(3)
    v_max_u32 v18, v29, v31
    v_cmp_eq_u32 vcc, -1, v18
    s_cbranch_vccnz .nk_82
.ok_83:
    v_smfmac_f32_16x16x64_bf16 v[40:43], v[28:31], a[8:15], v2
    v_smfmac_f32_16x16x64_bf16 v[44:47], v[28:31], a[40:47], v2
    s_waitcnt vmcnt(2)
    v_max_u32 v18, v33, v35
    v_cmp_eq_u32 vcc, -1, v18
    v_smfmac_f32_16x16x64_bf16 v[48:51], v[28:31], a[72:79], v2
    v_smfmac_f32_16x16x64_bf16 v[52:55], v[28:31], a[104:111], v2
    s_cbranch_vccnz .nk_84
.ok_85:
    v_smfmac_f32_16x16x64_bf16 v[40:43], v[32:35], a[16:23], v2
    v_smfmac_f32_16x16x64_bf16 v[44:47], v[32:35], a[48:55], v2
    s_waitcnt vmcnt(1)
    v_max_u32 v18, v37, v39
    v_cmp_eq_u32 vcc, -1, v18
    v_smfmac_f32_16x16x64_bf16 v[48:51], v[32:35], a[80:87], v2
    v_smfmac_f32_16x16x64_bf16 v[52:55], v[32:35], a[112:119], v2
    s_cbranch_vccnz .nk_86
.ok_87:
    v_smfmac_f32_16x16x64_bf16 v[40:43], v[36:39], a[24:31], v2
    v_smfmac_f32_16x16x64_bf16 v[44:47], v[36:39], a[56:63], v2
    s_waitcnt vmcnt(0)
    v_max_u32 v18, v25, v27
    v_cmp_eq_u32 vcc, -1, v18
    v_smfmac_f32_16x16x64_bf16 v[48:51], v[36:39], a[88:95], v2
    v_smfmac_f32_16x16x64_bf16 v[52:55], v[36:39], a[120:127], v2
    s_cbranch_vccnz .nk_88
.ok_89:
    v_smfmac_f32_16x16x64_bf16 v[40:43], v[24:27], a[0:7], v2
    v_smfmac_f32_16x16x64_bf16 v[44:47], v[24:27], a[32:39], v2
    v_smfmac_f32_16x16x64_bf16 v[48:51], v[24:27], a[64:71], v2
    v_smfmac_f32_16x16x64_bf16 v[52:55], v[24:27], a[96:103], v2
    s_setpc_b64 s[98:99]
.nk_76:
    buffer_load_dwordx4 v[28:31], v3, s[8:11], s30 offen offset:1024 sc1
    s_add_u32 s62, s62, 1
    s_cmp_gt_u32 s62, 0x100000
    s_cbranch_scc1 .mg_end_1
    s_waitcnt vmcnt(2)
    v_max_u32 v18, v33, v35
    v_cmp_eq_u32 vcc, -1, v18
    s_cbranch_vccnz .nk_90
.ok_91:
    v_smfmac_f32_16x16x64_bf16 v[40:43], v[32:35], a[16:23], v2
    v_smfmac_f32_16x16x64_bf16 v[44:47], v[32:35], a[48:55], v2
    s_waitcnt vmcnt(1)
    v_max_u32 v18, v37, v39
    v_cmp_eq_u32 vcc, -1, v18
    v_smfmac_f32_16x16x64_bf16 v[48:51], v[32:35], a[80:87], v2
    v_smfmac_f32_16x16x64_bf16 v[52:55], v[32:35], a[112:119], v2
    s_cbranch_vccnz .nk_92
.ok_93:
    v_smfmac_f32_16x16x64_bf16 v[40:43], v[36:39], a[24:31], v2
    v_smfmac_f32_16x16x64_bf16 v[44:47], v[36:39], a[56:63], v2
    s_waitcnt vmcnt(0)
    v_max_u32 v18, v29, v31
    v_cmp_eq_u32 vcc, -1, v18
    v_smfmac_f32_16x16x64_bf16 v[48:51], v[36:39], a[88:95], v2
    v_smfmac_f32_16x16x64_bf16 v[52:55], v[36:39], a[120:127], v2
    s_cbranch_vccnz .nk_94
.ok_95:
    v_smfmac_f32_16x16x64_bf16 v[40:43], v[28:31], a[8:15], v2
    v_smfmac_f32_16x16x64_bf16 v[44:47], v[28:31], a[40:47], v2
    v_smfmac_f32_16x16x64_bf16 v[48:51], v[28:31], a[72:79], v2
    v_smfmac_f32_16x16x64_bf16 v[52:55], v[28:31], a[104:111], v2
    s_setpc_b64 s[98:99]
.nk_78:
    buffer_load_dwordx4 v[32:35], v3, s[8:11], s30 offen offset:2048 sc1
    s_add_u32 s62, s62, 1
    s_cmp_gt_u32 s62, 0x100000
    s_cbranch_scc1 .mg_end_1
    s_waitcnt vmcnt(1)
    v_max_u32 v18, v37, v39
    v_cmp_eq_u32 vcc, -1, v18
    s_cbranch_vccnz .nk_96
.ok_97:
    v_smfmac_f32_16x16x64_bf16 v[40:43], v[36:39], a[24:31], v2
    v_smfmac_f32_16x16x64_bf16 v[44:47], v[36:39], a[56:63], v2
    s_waitcnt vmcnt(0)
    v_max_u32 v18, v33, v35
    v_cmp_eq_u32 vcc, -1, v18
    v_smfmac_f32_16x16x64_bf16 v[48:51], v[36:39], a[88:95], v2
    v_smfmac_f32_16x16x64_bf16 v[52:55], v[36:39], a[120:127], v2
    s_cbranch_vccnz .nk_98
.ok_99:
    v_smfmac_f32_16x16x64_bf16 v[40:43], v[32:35], a[16:23], v2
    v_smfmac_f32_16x16x64_bf16 v[44:47], v[32:35], a[48:55], v2
    v_smfmac_f32_16x16x64_bf16 v[48:51], v[32:35], a[80:87], v2
    v_smfmac_f32_16x16x64_bf16 v[52:55], v[32:35], a[112:119], v2
    s_setpc_b64 s[98:99]
.nk_80:
    buffer_load_dwordx4 v[36:39], v3, s[8:11], s30 offen offset:3072 sc1
    s_add_u32 s62, s62, 1
    s_cmp_gt_u32 s62, 0x100000
    s_cbranch_scc1 .mg_end_1
    s_waitcnt vmcnt(0)
    v_max_u32 v18, v37, v39
    v_cmp_eq_u32 vcc, -1, v18
    s_cbranch_vccnz .nk_80
    s_branch .ok_81
.nk_82:
    buffer_load_dwordx4 v[28:31], v3, s[8:11], s30 offen offset:1024 sc1
    s_add_u32 s62, s62, 1
    s_cmp_gt_u32 s62, 0x100000
    s_cbranch_scc1 .mg_end_1
    s_waitcnt vmcnt(3)
    v_max_u32 v18, v33, v35
    v_cmp_eq_u32 vcc, -1, v18
    s_cbranch_vccnz .nk_100
.ok_101:
    v_smfmac_f32_16x16x64_bf16 v[40:43], v[32:35], a[16:23], v2
    v_smfmac_f32_16x16x64_bf16 v[44:47], v[32:35], a[48:55], v2
    s_waitcnt vmcnt(2)
    v_max_u32 v18, v37, v39
    v_cmp_eq_u32 vcc, -1, v18
    v_smfmac_f32_16x16x64_bf16 v[48:51], v[32:35], a[80:87], v2
    v_smfmac_f32_16x16x64_bf16 v[52:55], v[32:35], a[112:119], v2
    s_cbranch_vccnz .nk_102
.ok_103:
    v_smfmac_f32_16x16x64_bf16 v[40:43], v[36:39], a[24:31], v2
    v_smfmac_f32_16x16x64_bf16 v[44:47], v[36:39], a[56:63], v2
    s_waitcnt vmcnt(1)
    v_max_u32 v18, v25, v27
    v_cmp_eq_u32 vcc, -1, v18
    v_smfmac_f32_16x16x64_bf16 v[48:51], v[36:39], a[88:95], v2
    v_smfmac_f32_16x16x64_bf16 v[52:55], v[36:39], a[120:127], v2
    s_cbranch_vccnz .nk_104
.ok_105:
    v_smfmac_f32_16x16x64_bf16 v[40:43], v[24:27], a[0:7], v2
    v_smfmac_f32_16x16x64_bf16 v[44:47], v[24:27], a[32:39], v2
    s_waitcnt vmcnt(0)
    v_max_u32 v18, v29, v31
    v_cmp_eq_u32 vcc, -1, v18
    v_smfmac_f32_16x16x64_bf16 v[48:51], v[24:27], a[64:71], v2
    v_smfmac_f32_16x16x64_bf16 v[52:55], v[24:27], a[96:103], v2
    s_cbranch_vccnz .nk_94
    s_branch .ok_95
.nk_84:
    buffer_load_dwordx4 v[32:35], v3, s[8:11], s30 offen offset:2048 sc1
    s_add_u32 s62, s62, 1
    s_cmp_gt_u32 s62, 0x100000
    s_cbranch_scc1 .mg_end_1
    s_waitcnt vmcnt(2)
    v_max_u32 v18, v37, v39
    v_cmp_eq_u32 vcc, -1, v18
    s_cbranch_vccnz .nk_106
.ok_107:
    v_smfmac_f32_16x16x64_bf16 v[40:43], v[36:39], a[24:31], v2
    v_smfmac_f32_16x16x64_bf16 v[44:47], v[36:39], a[56:63], v2
    s_waitcnt vmcnt(1)
    v_max_u32 v18, v25, v27
    v_cmp_eq_u32 vcc, -1, v18
    v_smfmac_f32_16x16x64_bf16 v[48:51], v[36:39], a[88:95], v2
    v_smfmac_f32_16x16x64_bf16 v[52:55], v[36:39], a[120:127], v2
    s_cbranch_vccnz .nk_108
.ok_109:
    v_smfmac_f32_16x16x64_bf16 v[40:43], v[24:27], a[0:7], v2
    v_smfmac_f32_16x16x64_bf16 v[44:47], v[24:27], a[32:39], v2
    s_waitcnt vmcnt(0)
    v_max_u32 v18, v33, v35
    v_cmp_eq_u32 vcc, -1, v18
    v_smfmac_f32_16x16x64_bf16 v[48:51], v[24:27], a[64:71], v2
    v_smfmac_f32_16x16x64_bf16 v[52:55], v[24:27], a[96:103], v2
    s_cbranch_vccnz .nk_98
    s_branch .ok_99
.nk_86:
    buffer_load_dwordx4 v[36:39], v3, s[8:11], s30 offen offset:3072 sc1
    s_add_u32 s62, s62, 1
    s_cmp_gt_u32 s62, 0x100000
    s_cbranch_scc1 .mg_end_1
    s_waitcnt vmcnt(1)
    v_max_u32 v18, v25, v27
    v_cmp_eq_u32 vcc, -1, v18
    s_cbranch_vccnz .nk_110
.ok_111:
    v_smfmac_f32_16x16x64_bf16 v[40:43], v[24:27], a[0:7], v2
    v_smfmac_f32_16x16x64_bf16 v[44:47], v[24:27], a[32:39], v2
    s_waitcnt vmcnt(0)
    v_max_u32 v18, v37, v39
    v_cmp_eq_u32 vcc, -1, v18
    v_smfmac_f32_16x16x64_bf16 v[48:51], v[24:27], a[64:71], v2
    v_smfmac_f32_16x16x64_bf16 v[52:55], v[24:27], a[96:103], v2
    s_cbranch_vccnz .nk_80
    s_branch .ok_81
.nk_88:
    buffer_load_dwordx4 v[24:27], v3, s[8:11], s30 offen offset:0 sc1
    s_add_u32 s62, s62, 1
    s_cmp_gt_u32 s62, 0x100000
    s_cbranch_scc1 .mg_end_1
    s_waitcnt vmcnt(0)
    v_max_u32 v18, v25, v27
    v_cmp_eq_u32 vcc, -1, v18
    s_cbranch_vccnz .nk_88
    s_branch .ok_89
.nk_90:
    buffer_load_dwordx4 v[32:35], v3, s[8:11], s30 offen offset:2048 sc1
    s_add_u32 s62, s62, 1
    s_cmp_gt_u32 s62, 0x100000
    s_cbranch_scc1 .mg_end_1
    s_waitcnt vmcnt(2)
    v_max_u32 v18, v37, v39
    v_cmp_eq_u32 vcc, -1, v18
    s_cbranch_vccnz .nk_112
.ok_113:
    v_smfmac_f32_16x16x64_bf16 v[40:43], v[36:39], a[24:31], v2
    v_smfmac_f32_16x16x64_bf16 v[44:47], v[36:39], a[56:63], v2
    s_waitcnt vmcnt(1)
    v_max_u32 v18, v29, v31
    v_cmp_eq_u32 vcc, -1, v18
    v_smfmac_f32_16x16x64_bf16 v[48:51], v[36:39], a[88:95], v2
    v_smfmac_f32_16x16x64_bf16 v[52:55], v[36:39], a[120:127], v2
    s_cbranch_vccnz .nk_114
.ok_115:
    v_smfmac_f32_16x16x64_bf16 v[40:43], v[28:31], a[8:15], v2
    v_smfmac_f32_16x16x64_bf16 v[44:47], v[28:31], a[40:47], v2
    s_waitcnt vmcnt(0)
    v_max_u32 v18, v33, v35
    v_cmp_eq_u32 vcc, -1, v18
    v_smfmac_f32_16x16x64_bf16 v[48:51], v[28:31], a[72:79], v2
    v_smfmac_f32_16x16x64_bf16 v[52:55], v[28:31], a[104:111], v2
    s_cbranch_vccnz .nk_98
    s_branch .ok_99
.nk_92:
    buffer_load_dwordx4 v[36:39], v3, s[8:11], s30 offen offset:3072 sc1
    s_add_u32 s62, s62, 1
    s_cmp_gt_u32 s62, 0x100000
    s_cbranch_scc1 .mg_end_1
    s_waitcnt vmcnt(1)
    v_max_u32 v18, v29, v31
    v_cmp_eq_u32 vcc, -1, v18
    s_cbranch_vccnz .nk_116
.ok_117:
    v_smfmac_f32_16x16x64_bf16 v[40:43], v[28:31], a[8:15], v2
    v_smfmac_f32_16x16x64_bf16 v[44:47], v[28:31], a[40:47], v2
    s_waitcnt vmcnt(0)
    v_max_u32 v18, v37, v39
    v_cmp_eq_u32 vcc, -1, v18
    v_smfmac_f32_16x16x64_bf16 v[48:51], v[28:31], a[72:79], v2
    v_smfmac_f32_16x16x64_bf16 v[52:55], v[28:31], a[104:111], v2
    s_cbranch_vccnz .nk_80
    s_branch .ok_81
.nk_94:
    buffer_load_dwordx4 v[28:31], v3, s[8:11], s30 offen offset:1024 sc1
    s_add_u32 s62, s62, 1
    s_cmp_gt_u32 s62, 0x100000
    s_cbranch_scc1 .mg_end_1
    s_waitcnt vmcnt(0)
    v_max_u32 v18, v29, v31
    v_cmp_eq_u32 vcc, -1, v18
    s_cbranch_vccnz .nk_94
    s_branch .ok_95
.nk_96:
    buffer_load_dwordx4 v[36:39], v3, s[8:11], s30 offen offset:3072 sc1
    s_add_u32 s62, s62, 1
    s_cmp_gt_u32 s62, 0x100000
    s_cbranch_scc1 .mg_end_1
    s_waitcnt vmcnt(1)
    v_max_u32 v18, v33, v35
    v_cmp_eq_u32 vcc, -1, v18
    s_cbranch_vccnz .nk_78
    s_branch .ok_79
.nk_98:
    buffer_load_dwordx4 v[32:35], v3, s[8:11], s30 offen offset:2048 sc1
    s_add_u32 s62, s62, 1
    s_cmp_gt_u32 s62, 0x100000
    s_cbranch_scc1 .mg_end_1
    s_waitcnt vmcnt(0)
    v_max_u32 v18, v33, v35
    v_cmp_eq_u32 vcc, -1, v18
    s_cbranch_vccnz .nk_98
    s_branch .ok_99
.nk_100:
    buffer_load_dwordx4 v[32:35], v3, s[8:11], s30 offen offset:2048 sc1
    s_add_u32 s62, s62, 1
    s_cmp_gt_u32 s62, 0x100000
    s_cbranch_scc1 .mg_end_1
    s_waitcnt vmcnt(3)
    v_max_u32 v18, v37, v39
    v_cmp_eq_u32 vcc, -1, v18
    s_cbranch_vccnz .nk_118
.ok_119:
    v_smfmac_f32_16x16x64_bf16 v[40:43], v[36:39], a[24:31], v2
    v_smfmac_f32_16x16x64_bf16 v[44:47], v[36:39], a[56:63], v2
    s_waitcnt vmcnt(2)
    v_max_u32 v18, v25, v27
    v_cmp_eq_u32 vcc, -1, v18
    v_smfmac_f32_16x16x64_bf16 v[48:51], v[36:39], a[88:95], v2
    v_smfmac_f32_16x16x64_bf16 v[52:55], v[36:39], a[120:127], v2
    s_cbranch_vccnz .nk_120
.ok_121:
    v_smfmac_f32_16x16x64_bf16 v[40:43], v[24:27], a[0:7], v2
    v_smfmac_f32_16x16x64_bf16 v[44:47], v[24:27], a[32:39], v2
    s_waitcnt vmcnt(1)
    v_max_u32 v18, v29, v31
    v_cmp_eq_u32 vcc, -1, v18
    v_smfmac_f32_16x16x64_bf16 v[48:51], v[24:27], a[64:71], v2
    v_smfmac_f32_16x16x64_bf16 v[52:55], v[24:27], a[96:103], v2
    s_cbranch_vccnz .nk_114
    s_branch .ok_115
.nk_102:
    buffer_load_dwordx4 v[36:39], v3, s[8:11], s30 offen offset:3072 sc1
    s_add_u32 s62, s62, 1
    s_cmp_gt_u32 s62, 0x100000
    s_cbranch_scc1 .mg_end_1
    s_waitcnt vmcnt(2)
    v_max_u32 v18, v25, v27
    v_cmp_eq_u32 vcc, -1, v18
    s_cbranch_vccnz .nk_122
.ok_123:
    v_smfmac_f32_16x16x64_bf16 v[40:43], v[24:27], a[0:7], v2
    v_smfmac_f32_16x16x64_bf16 v[44:47], v[24:27], a[32:39], v2
    s_waitcnt vmcnt(1)
    v_max_u32 v18, v29, v31
    v_cmp_eq_u32 vcc, -1, v18
    v_smfmac_f32_16x16x64_bf16 v[48:51], v[24:27], a[64:71], v2
    v_smfmac_f32_16x16x64_bf16 v[52:55], v[24:27], a[96:103], v2
    s_cbranch_vccnz .nk_116
    s_branch .ok_117
.nk_104:
    buffer_load_dwordx4 v[24:27], v3, s[8:11], s30 offen offset:0 sc1
    s_add_u32 s62, s62, 1
    s_cmp_gt_u32 s62, 0x100000
    s_cbranch_scc1 .mg_end_1
    s_waitcnt vmcnt(1)
    v_max_u32 v18, v29, v31
    v_cmp_eq_u32 vcc, -1, v18
    s_cbranch_vccnz .nk_124
.ok_125:
    v_smfmac_f32_16x16x64_bf16 v[40:43], v[28:31], a[8:15], v2
    v_smfmac_f32_16x16x64_bf16 v[44:47], v[28:31], a[40:47], v2
    s_waitcnt vmcnt(0)
    v_max_u32 v18, v25, v27
    v_cmp_eq_u32 vcc, -1, v18
    v_smfmac_f32_16x16x64_bf16 v[48:51], v[28:31], a[72:79], v2
    v_smfmac_f32_16x16x64_bf16 v[52:55], v[28:31], a[104:111], v2
    s_cbranch_vccnz .nk_88
    s_branch .ok_89
.nk_106:
    buffer_load_dwordx4 v[36:39], v3, s[8:11], s30 offen offset:3072 sc1
    s_add_u32 s62, s62, 1
    s_cmp_gt_u32 s62, 0x100000
    s_cbranch_scc1 .mg_end_1
    s_waitcnt vmcnt(2)
    v_max_u32 v18, v25, v27
    v_cmp_eq_u32 vcc, -1, v18
    s_cbranch_vccnz .nk_126
.ok_127:
    v_smfmac_f32_16x16x64_bf16 v[40:43], v[24:27], a[0:7], v2
    v_smfmac_f32_16x16x64_bf16 v[44:47], v[24:27], a[32:39], v2
    s_waitcnt vmcnt(1)
    v_max_u32 v18, v33, v35
    v_cmp_eq_u32 vcc, -1, v18
    v_smfmac_f32_16x16x64_bf16 v[48:51], v[24:27], a[64:71], v2
    v_smfmac_f32_16x16x64_bf16 v[52:55], v[24:27], a[96:103], v2
    s_cbranch_vccnz .nk_78
    s_branch .ok_79
.nk_108:
    buffer_load_dwordx4 v[24:27], v3, s[8:11], s30 offen offset:0 sc1
    s_add_u32 s62, s62, 1
    s_cmp_gt_u32 s62, 0x100000
    s_cbranch_scc1 .mg_end_1
    s_waitcnt vmcnt(1)
    v_max_u32 v18, v33, v35
    v_cmp_eq_u32 vcc, -1, v18
    s_cbranch_vccnz .nk_128
.ok_129:
    v_smfmac_f32_16x16x64_bf16 v[40:43], v[32:35], a[16:23], v2
    v_smfmac_f32_16x16x64_bf16 v[44:47], v[32:35], a[48:55], v2
    s_waitcnt vmcnt(0)
    v_max_u32 v18, v25, v27
    v_cmp_eq_u32 vcc, -1, v18
    v_smfmac_f32_16x16x64_bf16 v[48:51], v[32:35], a[80:87], v2
    v_smfmac_f32_16x16x64_bf16 v[52:55], v[32:35], a[112:119], v2
    s_cbranch_vccnz .nk_88
    s_branch .ok_89
.nk_110:
    buffer_load_dwordx4 v[24:27], v3, s[8:11], s30 offen offset:0 sc1
    s_add_u32 s62, s62, 1
    s_cmp_gt_u32 s62, 0x100000
    s_cbranch_scc1 .mg_end_1
    s_waitcnt vmcnt(1)
    v_max_u32 v18, v37, v39
    v_cmp_eq_u32 vcc, -1, v18
    s_cbranch_vccnz .nk_86
    s_branch .ok_87
.nk_112:
    buffer_load_dwordx4 v[36:39], v3, s[8:11], s30 offen offset:3072 sc1
    s_add_u32 s62, s62, 1
    s_cmp_gt_u32 s62, 0x100000
    s_cbranch_scc1 .mg_end_1
    s_waitcnt vmcnt(2)
    v_max_u32 v18, v29, v31
    v_cmp_eq_u32 vcc, -1, v18
    s_cbranch_vccnz .nk_76
    s_branch .ok_77
.nk_114:
    buffer_load_dwordx4 v[28:31], v3, s[8:11], s30 offen offset:1024 sc1
    s_add_u32 s62, s62, 1
    s_cmp_gt_u32 s62, 0x100000
    s_cbranch_scc1 .mg_end_1
    s_waitcnt vmcnt(1)
    v_max_u32 v18, v33, v35
    v_cmp_eq_u32 vcc, -1, v18
    s_cbranch_vccnz .nk_130
.ok_131:
    v_smfmac_f32_16x16x64_bf16 v[40:43], v[32:35], a[16:23], v2
    v_smfmac_f32_16x16x64_bf16 v[44:47], v[32:35], a[48:55], v2
    s_waitcnt vmcnt(0)
    v_max_u32 v18, v29, v31
    v_cmp_eq_u32 vcc, -1, v18
    v_smfmac_f32_16x16x64_bf16 v[48:51], v[32:35], a[80:87], v2
    v_smfmac_f32_16x16x64_bf16 v[52:55], v[32:35], a[112:119], v2
    s_cbranch_vccnz .nk_94
    s_branch .ok_95
.nk_116:
    buffer_load_dwordx4 v[28:31], v3, s[8:11], s30 offen offset:1024 sc1
    s_add_u32 s62, s62, 1
    s_cmp_gt_u32 s62, 0x100000
    s_cbranch_scc1 .mg_end_1
    s_waitcnt vmcnt(1)
    v_max_u32 v18, v37, v39
    v_cmp_eq_u32 vcc, -1, v18
    s_cbranch_vccnz .nk_92
    s_branch .ok_93
.nk_118:
    buffer_load_dwordx4 v[36:39], v3, s[8:11], s30 offen offset:3072 sc1
    s_add_u32 s62, s62, 1
    s_cmp_gt_u32 s62, 0x100000
    s_cbranch_scc1 .mg_end_1
    s_waitcnt vmcnt(3)
    v_max_u32 v18, v25, v27
    v_cmp_eq_u32 vcc, -1, v18
    s_cbranch_vccnz .nk_74
    s_branch .ok_75
.nk_120:
    buffer_load_dwordx4 v[24:27], v3, s[8:11], s30 offen offset:0 sc1
    s_add_u32 s62, s62, 1
    s_cmp_gt_u32 s62, 0x100000
    s_cbranch_scc1 .mg_end_1
    s_waitcnt vmcnt(2)
    v_max_u32 v18, v29, v31
    v_cmp_eq_u32 vcc, -1, v18
    s_cbranch_vccnz .nk_132
.ok_133:
    v_smfmac_f32_16x16x64_bf16 v[40:43], v[28:31], a[8:15], v2
    v_smfmac_f32_16x16x64_bf16 v[44:47], v[28:31], a[40:47], v2
    s_waitcnt vmcnt(1)
    v_max_u32 v18, v33, v35
    v_cmp_eq_u32 vcc, -1, v18
    v_smfmac_f32_16x16x64_bf16 v[48:51], v[28:31], a[72:79], v2
    v_smfmac_f32_16x16x64_bf16 v[52:55], v[28:31], a[104:111], v2
    s_cbranch_vccnz .nk_128
    s_branch .ok_129
.nk_122:
    buffer_load_dwordx4 v[24:27], v3, s[8:11], s30 offen offset:0 sc1
    s_add_u32 s62, s62, 1
    s_cmp_gt_u32 s62, 0x100000
    s_cbranch_scc1 .mg_end_1
    s_waitcnt vmcnt(2)
    v_max_u32 v18, v29, v31
    v_cmp_eq_u32 vcc, -1, v18
    s_cbranch_vccnz .nk_134
.ok_135:
    v_smfmac_f32_16x16x64_bf16 v[40:43], v[28:31], a[8:15], v2
    v_smfmac_f32_16x16x64_bf16 v[44:47], v[28:31], a[40:47], v2
    s_waitcnt vmcnt(1)
    v_max_u32 v18, v37, v39
    v_cmp_eq_u32 vcc, -1, v18
    v_smfmac_f32_16x16x64_bf16 v[48:51], v[28:31], a[72:79], v2
    v_smfmac_f32_16x16x64_bf16 v[52:55], v[28:31], a[104:111], v2
    s_cbranch_vccnz .nk_86
    s_branch .ok_87
.nk_124:
    buffer_load_dwordx4 v[28:31], v3, s[8:11], s30 offen offset:1024 sc1
    s_add_u32 s62, s62, 1
    s_cmp_gt_u32 s62, 0x100000
    s_cbranch_scc1 .mg_end_1
    s_waitcnt vmcnt(1)
    v_max_u32 v18, v25, v27
    v_cmp_eq_u32 vcc, -1, v18
    s_cbranch_vccnz .nk_104
    s_branch .ok_105
.nk_126:
    buffer_load_dwordx4 v[24:27], v3, s[8:11], s30 offen offset:0 sc1
    s_add_u32 s62, s62, 1
    s_cmp_gt_u32 s62, 0x100000
    s_cbranch_scc1 .mg_end_1
    s_waitcnt vmcnt(2)
    v_max_u32 v18, v33, v35
    v_cmp_eq_u32 vcc, -1, v18
    s_cbranch_vccnz .nk_84
    s_branch .ok_85
.nk_128:
    buffer_load_dwordx4 v[32:35], v3, s[8:11], s30 offen offset:2048 sc1
    s_add_u32 s62, s62, 1
    s_cmp_gt_u32 s62, 0x100000
    s_cbranch_scc1 .mg_end_1
    s_waitcnt vmcnt(1)
    v_max_u32 v18, v25, v27
    v_cmp_eq_u32 vcc, -1, v18
    s_cbranch_vccnz .nk_108
    s_branch .ok_109
.nk_130:
    buffer_load_dwordx4 v[32:35], v3, s[8:11], s30 offen offset:2048 sc1
    s_add_u32 s62, s62, 1
    s_cmp_gt_u32 s62, 0x100000
    s_cbranch_scc1 .mg_end_1
    s_waitcnt vmcnt(1)
    v_max_u32 v18, v29, v31
    v_cmp_eq_u32 vcc, -1, v18
    s_cbranch_vccnz .nk_114
    s_branch .ok_115
.nk_132:
    buffer_load_dwordx4 v[28:31], v3, s[8:11], s30 offen offset:1024 sc1
    s_add_u32 s62, s62, 1
    s_cmp_gt_u32 s62, 0x100000
    s_cbranch_scc1 .mg_end_1
    s_waitcnt vmcnt(2)
    v_max_u32 v18, v33, v35
    v_cmp_eq_u32 vcc, -1, v18
    s_cbranch_vccnz .nk_136
.ok_137:
    v_smfmac_f32_16x16x64_bf16 v[40:43], v[32:35], a[16:23], v2
    v_smfmac_f32_16x16x64_bf16 v[44:47], v[32:35], a[48:55], v2
    s_waitcnt vmcnt(1)
    v_max_u32 v18, v25, v27
    v_cmp_eq_u32 vcc, -1, v18
    v_smfmac_f32_16x16x64_bf16 v[48:51], v[32:35], a[80:87], v2
    v_smfmac_f32_16x16x64_bf16 v[52:55], v[32:35], a[112:119], v2
    s_cbranch_vccnz .nk_104
    s_branch .ok_105
.nk_134:
    buffer_load_dwordx4 v[28:31], v3, s[8:11], s30 offen offset:1024 sc1
    s_add_u32 s62, s62, 1
    s_cmp_gt_u32 s62, 0x100000
    s_cbranch_scc1 .mg_end_1
    s_waitcnt vmcnt(2)
    v_max_u32 v18, v37, v39
    v_cmp_eq_u32 vcc, -1, v18
    s_cbranch_vccnz .nk_102
    s_branch .ok_103
.nk_136:
    buffer_load_dwordx4 v[32:35], v3, s[8:11], s30 offen offset:2048 sc1
    s_add_u32 s62, s62, 1
    s_cmp_gt_u32 s62, 0x100000
    s_cbranch_scc1 .mg_end_1
    s_waitcnt vmcnt(2)
    v_max_u32 v18, v25, v27
    v_cmp_eq_u32 vcc, -1, v18
    s_cbranch_vccnz .nk_120
    s_branch .ok_121
.p2align 6
.gm_23:
    s_waitcnt vmcnt(3)
    v_cmp_eq_u32 vcc, -1, v27
    s_cbranch_vccnz .nk_138
.ok_139:
    v_smfmac_f32_16x16x64_bf16 v[64:67], v[24:27], a[192:199], v2
    s_waitcnt vmcnt(2)
    v_cmp_eq_u32 vcc, -1, v31
    v_smfmac_f32_16x16x64_bf16 v[68:71], v[24:27], a[224:231], v2
    s_cbranch_vccnz .nk_140
.ok_141:
    v_smfmac_f32_16x16x64_bf16 v[64:67], v[28:31], a[200:207], v2
    s_waitcnt vmcnt(1)
    v_cmp_eq_u32 vcc, -1, v35
    v_smfmac_f32_16x16x64_bf16 v[68:71], v[28:31], a[232:239], v2
    s_cbranch_vccnz .nk_142
.ok_143:
    v_smfmac_f32_16x16x64_bf16 v[64:67], v[32:35], a[208:215], v2
    s_waitcnt vmcnt(0)
    v_cmp_eq_u32 vcc, -1, v39
    v_smfmac_f32_16x16x64_bf16 v[68:71], v[32:35], a[240:247], v2
    s_cbranch_vccnz .nk_144
.ok_145:
    v_smfmac_f32_16x16x64_bf16 v[64:67], v[36:39], a[216:223], v2
    v_smfmac_f32_16x16x64_bf16 v[68:71], v[36:39], a[248:255], v2
    s_setpc_b64 s[98:99]
.nk_138:
    buffer_load_dwordx4 v[24:27], v4, s[8:11], s30 offen offset:0 sc1
    s_add_u32 s62, s62, 1
    s_cmp_gt_u32 s62, 0x100000
    s_cbranch_scc1 .mg_end_1
    s_waitcnt vmcnt(3)
    v_cmp_eq_u32 vcc, -1, v31
    s_cbranch_vccnz .nk_146
.ok_147:
    v_smfmac_f32_16x16x64_bf16 v[64:67], v[28:31], a[200:207], v2
    s_waitcnt vmcnt(2)
    v_cmp_eq_u32 vcc, -1, v35
    v_smfmac_f32_16x16x64_bf16 v[68:71], v[28:31], a[232:239], v2
    s_cbranch_vccnz .nk_148
.ok_149:
    v_smfmac_f32_16x16x64_bf16 v[64:67], v[32:35], a[208:215], v2
    s_waitcnt vmcnt(1)
    v_cmp_eq_u32 vcc, -1, v39
    v_smfmac_f32_16x16x64_bf16 v[68:71], v[32:35], a[240:247], v2
    s_cbranch_vccnz .nk_150
.ok_151:
    v_smfmac_f32_16x16x64_bf16 v[64:67], v[36:39], a[216:223], v2
    s_waitcnt vmcnt(0)
    v_cmp_eq_u32 vcc, -1, v27
    v_smfmac_f32_16x16x64_bf16 v[68:71], v[36:39], a[248:255], v2
    s_cbranch_vccnz .nk_152
.ok_153:
    v_smfmac_f32_16x16x64_bf16 v[64:67], v[24:27], a[192:199], v2
    v_smfmac_f32_16x16x64_bf16 v[68:71], v[24:27], a[224:231], v2
    s_setpc_b64 s[98:99]
.nk_140:
    buffer_load_dwordx4 v[28:31], v4, s[8:11], s30 offen offset:1024 sc1
    s_add_u32 s62, s62, 1
    s_cmp_gt_u32 s62, 0x100000
    s_cbranch_scc1 .mg_end_1
    s_waitcnt vmcnt(2)
    v_cmp_eq_u32 vcc, -1, v35
    s_cbranch_vccnz .nk_154
.ok_155:
    v_smfmac_f32_16x16x64_bf16 v[64:67], v[32:35], a[208:215], v2
    s_waitcnt vmcnt(1)
    v_cmp_eq_u32 vcc, -1, v39
    v_smfmac_f32_16x16x64_bf16 v[68:71], v[32:35], a[240:247], v2
    s_cbranch_vccnz .nk_156
.ok_157:
    v_smfmac_f32_16x16x64_bf16 v[64:67], v[36:39], a[216:223], v2
    s_waitcnt vmcnt(0)
    v_cmp_eq_u32 vcc, -1, v31
    v_smfmac_f32_16x16x64_bf16 v[68:71], v[36:39], a[248:255], v2
    s_cbranch_vccnz .nk_158
.ok_159:
    v_smfmac_f32_16x16x64_bf16 v[64:67], v[28:31], a[200:207], v2
    v_smfmac_f32_16x16x64_bf16 v[68:71], v[28:31], a[232:239], v2
    s_setpc_b64 s[98:99]
.nk_142:
    buffer_load_dwordx4 v[32:35], v4, s[8:11], s30 offen offset:2048 sc1
    s_add_u32 s62, s62, 1
    s_cmp_gt_u32 s62, 0x100000
    s_cbranch_scc1 .mg_end_1
    s_waitcnt vmcnt(1)
    v_cmp_eq_u32 vcc, -1, v39
    s_cbranch_vccnz .nk_160
.ok_161:
    v_smfmac_f32_16x16x64_bf16 v[64:67], v[36:39], a[216:223], v2
    s_waitcnt vmcnt(0)
    v_cmp_eq_u32 vcc, -1, v35
    v_smfmac_f32_16x16x64_bf16 v[68:71], v[36:39], a[248:255], v2
    s_cbranch_vccnz .nk_162
.ok_163:
    v_smfmac_f32_16x16x64_bf16 v[64:67], v[32:35], a[208:215], v2
    v_smfmac_f32_16x16x64_bf16 v[68:71], v[32:35], a[240:247], v2
    s_setpc_b64 s[98:99]
.nk_144:
    buffer_load_dwordx4 v[36:39], v4, s[8:11], s30 offen offset:3072 sc1
    s_add_u32 s62, s62, 1
    s_cmp_gt_u32 s62, 0x100000
    s_cbranch_scc1 .mg_end_1
    s_waitcnt vmcnt(0)
    v_cmp_eq_u32 vcc, -1, v39
    s_cbranch_vccnz .nk_144
    s_branch .ok_145
.nk_146:
    buffer_load_dwordx4 v[28:31], v4, s[8:11], s30 offen offset:1024 sc1
    s_add_u32 s62, s62, 1
    s_cmp_gt_u32 s62, 0x100000
    s_cbranch_scc1 .mg_end_1
    s_waitcnt vmcnt(3)
    v_cmp_eq_u32 vcc, -1, v35
    s_cbranch_vccnz .nk_164
.ok_165:
    v_smfmac_f32_16x16x64_bf16 v[64:67], v[32:35], a[208:215], v2
    s_waitcnt vmcnt(2)
    v_cmp_eq_u32 vcc, -1, v39
    v_smfmac_f32_16x16x64_bf16 v[68:71], v[32:35], a[240:247], v2
    s_cbranch_vccnz .nk_166
.ok_167:
    v_smfmac_f32_16x16x64_bf16 v[64:67], v[36:39], a[216:223], v2
    s_waitcnt vmcnt(1)
    v_cmp_eq_u32 vcc, -1, v27
    v_smfmac_f32_16x16x64_bf16 v[68:71], v[36:39], a[248:255], v2
    s_cbranch_vccnz .nk_168
.ok_169:
    v_smfmac_f32_16x16x64_bf16 v[64:67], v[24:27], a[192:199], v2
    s_waitcnt vmcnt(0)
    v_cmp_eq_u32 vcc, -1, v31
    v_smfmac_f32_16x16x64_bf16 v[68:71], v[24:27], a[224:231], v2
    s_cbranch_vccnz .nk_158
    s_branch .ok_159
.nk_148:
    buffer_load_dwordx4 v[32:35], v4, s[8:11], s30 offen offset:2048 sc1
    s_add_u32 s62, s62, 1
    s_cmp_gt_u32 s62, 0x100000
    s_cbranch_scc1 .mg_end_1
    s_waitcnt vmcnt(2)
    v_cmp_eq_u32 vcc, -1, v39
    s_cbranch_vccnz .nk_170
.ok_171:
    v_smfmac_f32_16x16x64_bf16 v[64:67], v[36:39], a[216:223], v2
    s_waitcnt vmcnt(1)
    v_cmp_eq_u32 vcc, -1, v27
    v_smfmac_f32_16x16x64_bf16 v[68:71], v[36:39], a[248:255], v2
    s_cbranch_vccnz .nk_172
.ok_173:
    v_smfmac_f32_16x16x64_bf16 v[64:67], v[24:27], a[192:199], v2
    s_waitcnt vmcnt(0)
    v_cmp_eq_u32 vcc, -1, v35
    v_smfmac_f32_16x16x64_bf16 v[68:71], v[24:27], a[224:231], v2
    s_cbranch_vccnz .nk_162
    s_branch .ok_163
.nk_150:
    buffer_load_dwordx4 v[36:39], v4, s[8:11], s30 offen offset:3072 sc1
    s_add_u32 s62, s62, 1
    s_cmp_gt_u32 s62, 0x100000
    s_cbranch_scc1 .mg_end_1
    s_waitcnt vmcnt(1)
    v_cmp_eq_u32 vcc, -1, v27
    s_cbranch_vccnz .nk_174
.ok_175:
    v_smfmac_f32_16x16x64_bf16 v[64:67], v[24:27], a[192:199], v2
    s_waitcnt vmcnt(0)
    v_cmp_eq_u32 vcc, -1, v39
    v_smfmac_f32_16x16x64_bf16 v[68:71], v[24:27], a[224:231], v2
    s_cbranch_vccnz .nk_144
    s_branch .ok_145
.nk_152:
    buffer_load_dwordx4 v[24:27], v4, s[8:11], s30 offen offset:0 sc1
    s_add_u32 s62, s62, 1
    s_cmp_gt_u32 s62, 0x100000
    s_cbranch_scc1 .mg_end_1
    s_waitcnt vmcnt(0)
    v_cmp_eq_u32 vcc, -1, v27
    s_cbranch_vccnz .nk_152
    s_branch .ok_153
.nk_154:
    buffer_load_dwordx4 v[32:35], v4, s[8:11], s30 offen offset:2048 sc1
    s_add_u32 s62, s62, 1
    s_cmp_gt_u32 s62, 0x100000
    s_cbranch_scc1 .mg_end_1
    s_waitcnt vmcnt(2)
    v_cmp_eq_u32 vcc, -1, v39
    s_cbranch_vccnz .nk_176
.ok_177:
    v_smfmac_f32_16x16x64_bf16 v[64:67], v[36:39], a[216:223], v2
    s_waitcnt vmcnt(1)
    v_cmp_eq_u32 vcc, -1, v31
    v_smfmac_f32_16x16x64_bf16 v[68:71], v[36:39], a[248:255], v2
    s_cbranch_vccnz .nk_178
.ok_179:
    v_smfmac_f32_16x16x64_bf16 v[64:67], v[28:31], a[200:207], v2
    s_waitcnt vmcnt(0)
    v_cmp_eq_u32 vcc, -1, v35
    v_smfmac_f32_16x16x64_bf16 v[68:71], v[28:31], a[232:239], v2
    s_cbranch_vccnz .nk_162
    s_branch .ok_163
.nk_156:
    buffer_load_dwordx4 v[36:39], v4, s[8:11], s30 offen offset:3072 sc1
    s_add_u32 s62, s62, 1
    s_cmp_gt_u32 s62, 0x100000
    s_cbranch_scc1 .mg_end_1
    s_waitcnt vmcnt(1)
    v_cmp_eq_u32 vcc, -1, v31
    s_cbranch_vccnz .nk_180
.ok_181:
    v_smfmac_f32_16x16x64_bf16 v[64:67], v[28:31], a[200:207], v2
    s_waitcnt vmcnt(0)
    v_cmp_eq_u32 vcc, -1, v39
    v_smfmac_f32_16x16x64_bf16 v[68:71], v[28:31], a[232:239], v2
    s_cbranch_vccnz .nk_144
    s_branch .ok_145
.nk_158:
    buffer_load_dwordx4 v[28:31], v4, s[8:11], s30 offen offset:1024 sc1
    s_add_u32 s62, s62, 1
    s_cmp_gt_u32 s62, 0x100000
    s_cbranch_scc1 .mg_end_1
    s_waitcnt vmcnt(0)
    v_cmp_eq_u32 vcc, -1, v31
    s_cbranch_vccnz .nk_158
    s_branch .ok_159
.nk_160:
    buffer_load_dwordx4 v[36:39], v4, s[8:11], s30 offen offset:3072 sc1
    s_add_u32 s62, s62, 1
    s_cmp_gt_u32 s62, 0x100000
    s_cbranch_scc1 .mg_end_1
    s_waitcnt vmcnt(1)
    v_cmp_eq_u32 vcc, -1, v35
    s_cbranch_vccnz .nk_142
    s_branch .ok_143
.nk_162:
    buffer_load_dwordx4 v[32:35], v4, s[8:11], s30 offen offset:2048 sc1
    s_add_u32 s62, s62, 1
    s_cmp_gt_u32 s62, 0x100000
    s_cbranch_scc1 .mg_end_1
    s_waitcnt vmcnt(0)
    v_cmp_eq_u32 vcc, -1, v35
    s_cbranch_vccnz .nk_162
    s_branch .ok_163
.nk_164:
    buffer_load_dwordx4 v[32:35], v4, s[8:11], s30 offen offset:2048 sc1
    s_add_u32 s62, s62, 1
    s_cmp_gt_u32 s62, 0x100000
    s_cbranch_scc1 .mg_end_1
    s_waitcnt vmcnt(3)
    v_cmp_eq_u32 vcc, -1, v39
    s_cbranch_vccnz .nk_182
.ok_183:
    v_smfmac_f32_16x16x64_bf16 v[64:67], v[36:39], a[216:223], v2
    s_waitcnt vmcnt(2)
    v_cmp_eq_u32 vcc, -1, v27
    v_smfmac_f32_16x16x64_bf16 v[68:71], v[36:39], a[248:255], v2
    s_cbranch_vccnz .nk_184
.ok_185:
    v_smfmac_f32_16x16x64_bf16 v[64:67], v[24:27], a[192:199], v2
    s_waitcnt vmcnt(1)
    v_cmp_eq_u32 vcc, -1, v31
    v_smfmac_f32_16x16x64_bf16 v[68:71], v[24:27], a[224:231], v2
    s_cbranch_vccnz .nk_178
    s_branch .ok_179
.nk_166:
    buffer_load_dwordx4 v[36:39], v4, s[8:11], s30 offen offset:3072 sc1
    s_add_u32 s62, s62, 1
    s_cmp_gt_u32 s62, 0x100000
    s_cbranch_scc1 .mg_end_1
    s_waitcnt vmcnt(2)
    v_cmp_eq_u32 vcc, -1, v27
    s_cbranch_vccnz .nk_186
.ok_187:
    v_smfmac_f32_16x16x64_bf16 v[64:67], v[24:27], a[192:199], v2
    s_waitcnt vmcnt(1)
    v_cmp_eq_u32 vcc, -1, v31
    v_smfmac_f32_16x16x64_bf16 v[68:71], v[24:27], a[224:231], v2
    s_cbranch_vccnz .nk_180
    s_branch .ok_181
.nk_168:
    buffer_load_dwordx4 v[24:27], v4, s[8:11], s30 offen offset:0 sc1
    s_add_u32 s62, s62, 1
    s_cmp_gt_u32 s62, 0x100000
    s_cbranch_scc1 .mg_end_1
    s_waitcnt vmcnt(1)
    v_cmp_eq_u32 vcc, -1, v31
    s_cbranch_vccnz .nk_188
.ok_189:
    v_smfmac_f32_16x16x64_bf16 v[64:67], v[28:31], a[200:207], v2
    s_waitcnt vmcnt(0)
    v_cmp_eq_u32 vcc, -1, v27
    v_smfmac_f32_16x16x64_bf16 v[68:71], v[28:31], a[232:239], v2
    s_cbranch_vccnz .nk_152
    s_branch .ok_153
.nk_170:
    buffer_load_dwordx4 v[36:39], v4, s[8:11], s30 offen offset:3072 sc1
    s_add_u32 s62, s62, 1
    s_cmp_gt_u32 s62, 0x100000
    s_cbranch_scc1 .mg_end_1
    s_waitcnt vmcnt(2)
    v_cmp_eq_u32 vcc, -1, v27
    s_cbranch_vccnz .nk_190
.ok_191:
    v_smfmac_f32_16x16x64_bf16 v[64:67], v[24:27], a[192:199], v2
    s_waitcnt vmcnt(1)
    v_cmp_eq_u32 vcc, -1, v35
    v_smfmac_f32_16x16x64_bf16 v[68:71], v[24:27], a[224:231], v2
    s_cbranch_vccnz .nk_142
    s_branch .ok_143
.nk_172:
    buffer_load_dwordx4 v[24:27], v4, s[8:11], s30 offen offset:0 sc1
    s_add_u32 s62, s62, 1
    s_cmp_gt_u32 s62, 0x100000
    s_cbranch_scc1 .mg_end_1
    s_waitcnt vmcnt(1)
    v_cmp_eq_u32 vcc, -1, v35
    s_cbranch_vccnz .nk_192
.ok_193:
    v_smfmac_f32_16x16x64_bf16 v[64:67], v[32:35], a[208:215], v2
    s_waitcnt vmcnt(0)
    v_cmp_eq_u32 vcc, -1, v27
    v_smfmac_f32_16x16x64_bf16 v[68:71], v[32:35], a[240:247], v2
    s_cbranch_vccnz .nk_152
    s_branch .ok_153
.nk_174:
    buffer_load_dwordx4 v[24:27], v4, s[8:11], s30 offen offset:0 sc1
    s_add_u32 s62, s62, 1
    s_cmp_gt_u32 s62, 0x100000
    s_cbranch_scc1 .mg_end_1
    s_waitcnt vmcnt(1)
    v_cmp_eq_u32 vcc, -1, v39
    s_cbranch_vccnz .nk_150
    s_branch .ok_151
.nk_176:
    buffer_load_dwordx4 v[36:39], v4, s[8:11], s30 offen offset:3072 sc1
    s_add_u32 s62, s62, 1
    s_cmp_gt_u32 s62, 0x100000
    s_cbranch_scc1 .mg_end_1
    s_waitcnt vmcnt(2)
    v_cmp_eq_u32 vcc, -1, v31
    s_cbranch_vccnz .nk_140
    s_branch .ok_141
.nk_178:
    buffer_load_dwordx4 v[28:31], v4, s[8:11], s30 offen offset:1024 sc1
    s_add_u32 s62, s62, 1
    s_cmp_gt_u32 s62, 0x100000
    s_cbranch_scc1 .mg_end_1
    s_waitcnt vmcnt(1)
    v_cmp_eq_u32 vcc, -1, v35
    s_cbranch_vccnz .nk_194
.ok_195:
    v_smfmac_f32_16x16x64_bf16 v[64:67], v[32:35], a[208:215], v2
    s_waitcnt vmcnt(0)
    v_cmp_eq_u32 vcc, -1, v31
    v_smfmac_f32_16x16x64_bf16 v[68:71], v[32:35], a[240:247], v2
    s_cbranch_vccnz .nk_158
    s_branch .ok_159
.nk_180:
    buffer_load_dwordx4 v[28:31], v4, s[8:11], s30 offen offset:1024 sc1
    s_add_u32 s62, s62, 1
    s_cmp_gt_u32 s62, 0x100000
    s_cbranch_scc1 .mg_end_1
    s_waitcnt vmcnt(1)
    v_cmp_eq_u32 vcc, -1, v39
    s_cbranch_vccnz .nk_156
    s_branch .ok_157
.nk_182:
    buffer_load_dwordx4 v[36:39], v4, s[8:11], s30 offen offset:3072 sc1
    s_add_u32 s62, s62, 1
    s_cmp_gt_u32 s62, 0x100000
    s_cbranch_scc1 .mg_end_1
    s_waitcnt vmcnt(3)
    v_cmp_eq_u32 vcc, -1, v27
    s_cbranch_vccnz .nk_138
    s_branch .ok_139
.nk_184:
    buffer_load_dwordx4 v[24:27], v4, s[8:11], s30 offen offset:0 sc1
    s_add_u32 s62, s62, 1
    s_cmp_gt_u32 s62, 0x100000
    s_cbranch_scc1 .mg_end_1
    s_waitcnt vmcnt(2)
    v_cmp_eq_u32 vcc, -1, v31
    s_cbranch_vccnz .nk_196
.ok_197:
    v_smfmac_f32_16x16x64_bf16 v[64:67], v[28:31], a[200:207], v2
    s_waitcnt vmcnt(1)
    v_cmp_eq_u32 vcc, -1, v35
    v_smfmac_f32_16x16x64_bf16 v[68:71], v[28:31], a[232:239], v2
    s_cbranch_vccnz .nk_192
    s_branch .ok_193
.nk_186:
    buffer_load_dwordx4 v[24:27], v4, s[8:11], s30 offen offset:0 sc1
    s_add_u32 s62, s62, 1
    s_cmp_gt_u32 s62, 0x100000
    s_cbranch_scc1 .mg_end_1
    s_waitcnt vmcnt(2)
    v_cmp_eq_u32 vcc, -1, v31
    s_cbranch_vccnz .nk_198
.ok_199:
    v_smfmac_f32_16x16x64_bf16 v[64:67], v[28:31], a[200:207], v2
    s_waitcnt vmcnt(1)
    v_cmp_eq_u32 vcc, -1, v39
    v_smfmac_f32_16x16x64_bf16 v[68:71], v[28:31], a[232:239], v2
    s_cbranch_vccnz .nk_150
    s_branch .ok_151
.nk_188:
    buffer_load_dwordx4 v[28:31], v4, s[8:11], s30 offen offset:1024 sc1
    s_add_u32 s62, s62, 1
    s_cmp_gt_u32 s62, 0x100000
    s_cbranch_scc1 .mg_end_1
    s_waitcnt vmcnt(1)
    v_cmp_eq_u32 vcc, -1, v27
    s_cbranch_vccnz .nk_168
    s_branch .ok_169
.nk_190:
    buffer_load_dwordx4 v[24:27], v4, s[8:11], s30 offen offset:0 sc1
    s_add_u32 s62, s62, 1
    s_cmp_gt_u32 s62, 0x100000
    s_cbranch_scc1 .mg_end_1
    s_waitcnt vmcnt(2)
    v_cmp_eq_u32 vcc, -1, v35
    s_cbranch_vccnz .nk_148
    s_branch .ok_149
.nk_192:
    buffer_load_dwordx4 v[32:35], v4, s[8:11], s30 offen offset:2048 sc1
    s_add_u32 s62, s62, 1
    s_cmp_gt_u32 s62, 0x100000
    s_cbranch_scc1 .mg_end_1
    s_waitcnt vmcnt(1)
    v_cmp_eq_u32 vcc, -1, v27
    s_cbranch_vccnz .nk_172
    s_branch .ok_173
.nk_194:
    buffer_load_dwordx4 v[32:35], v4, s[8:11], s30 offen offset:2048 sc1
    s_add_u32 s62, s62, 1
    s_cmp_gt_u32 s62, 0x100000
    s_cbranch_scc1 .mg_end_1
    s_waitcnt vmcnt(1)
    v_cmp_eq_u32 vcc, -1, v31
    s_cbranch_vccnz .nk_178
    s_branch .ok_179
.nk_196:
    buffer_load_dwordx4 v[28:31], v4, s[8:11], s30 offen offset:1024 sc1
    s_add_u32 s62, s62, 1
    s_cmp_gt_u32 s62, 0x100000
    s_cbranch_scc1 .mg_end_1
    s_waitcnt vmcnt(2)
    v_cmp_eq_u32 vcc, -1, v35
    s_cbranch_vccnz .nk_200
.ok_201:
    v_smfmac_f32_16x16x64_bf16 v[64:67], v[32:35], a[208:215], v2
    s_waitcnt vmcnt(1)
    v_cmp_eq_u32 vcc, -1, v27
    v_smfmac_f32_16x16x64_bf16 v[68:71], v[32:35], a[240:247], v2
    s_cbranch_vccnz .nk_168
    s_branch .ok_169
.nk_198:
    buffer_load_dwordx4 v[28:31], v4, s[8:11], s30 offen offset:1024 sc1
    s_add_u32 s62, s62, 1
    s_cmp_gt_u32 s62, 0x100000
    s_cbranch_scc1 .mg_end_1
    s_waitcnt vmcnt(2)
    v_cmp_eq_u32 vcc, -1, v39
    s_cbranch_vccnz .nk_166
    s_branch .ok_167
.nk_200:
    buffer_load_dwordx4 v[32:35], v4, s[8:11], s30 offen offset:2048 sc1
    s_add_u32 s62, s62, 1
    s_cmp_gt_u32 s62, 0x100000
    s_cbranch_scc1 .mg_end_1
    s_waitcnt vmcnt(2)
    v_cmp_eq_u32 vcc, -1, v27
    s_cbranch_vccnz .nk_184
    s_branch .ok_185
.slowv_17:
    s_mov_b32 s28, 0
    s_mov_b32 s30, 83886080
    s_mov_b32 s31, 84180992
    s_mov_b32 s32, 84475904
    s_mov_b32 s33, 84770816
    s_mov_b32 s41, 66977792
    s_lshl_b32 s42, s56, 13
    s_lshl_b32 s4, s53, 11
    s_add_u32 s44, s42, s4
    s_add_u32 s44, s44, 33554432
    s_add_u32 s42, s42, 16777216
    s_xor_b32 s4, s53, 2
    s_lshl_b32 s4, s4, 10
    s_add_u32 s42, s42, s4
    s_add_u32 s43, s42, 4096
    s_add_u32 s96, s44, 524288
    s_sub_u32 s95, s96, 16777216
    s_mov_b32 s62, 0
    s_mov_b32 s45, 0x3e0293ee
    s_mov_b32 s46, 0
    s_and_b32 s4, s25, 1
    s_lshl_b32 s4, s4, 14
    s_lshr_b32 s5, s25, 1
    s_lshl_b32 s5, s5, 12
    s_or_b32 s4, s4, s5
    s_xor_b32 s47, s47, s4
    s_and_b32 s5, s26, 1
    s_lshl_b32 s5, s5, 11
    s_lshr_b32 s4, s26, 1
    s_lshl_b32 s4, s4, 15
    s_or_b32 s5, s5, s4
    s_bfe_u32 s4, s26, 0x10004
    s_lshl_b32 s4, s4, 11
    s_xor_b32 s5, s5, s4
    s_xor_b32 s34, s5, s47
    s_xor_b32 s35, s34, 0x84000
    s_xor_b32 s36, s34, 0x101000
    s_xor_b32 s37, s34, 0x185000
    s_and_b32 s4, s25, 1
    s_lshl_b32 s35, s4, 14
    s_lshr_b32 s4, s25, 1
    s_lshl_b32 s4, s4, 12
    s_or_b32 s35, s35, s4
    s_and_b32 s4, s26, 1
    s_lshl_b32 s4, s4, 11
    s_or_b32 s35, s35, s4
    s_lshr_b32 s4, s26, 1
    s_lshl_b32 s4, s4, 15
    s_or_b32 s35, s35, s4
    s_cmp_eq_u32 s24, 1
    s_cbranch_scc1 .w1_203
    s_cmp_eq_u32 s24, 2
    s_cbranch_scc1 .w2_204
    s_cmp_eq_u32 s24, 3
    s_cbranch_scc1 .w3_205
.w0_202:
    v_bfe_u32 v254, v1, 4, 1
    v_mul_u32_u24 v168, 1024, v254
    v_bfe_u32 v254, v1, 5, 1
    v_mul_u32_u24 v254, 128, v254
    v_add_u32 v168, v168, v254
    v_bfe_u32 v254, v1, 3, 1
    v_mul_u32_u24 v254, 64, v254
    v_add_u32 v168, v168, v254
    v_bfe_u32 v254, v1, 0, 2
    v_mul_u32_u24 v254, 16, v254
    v_add_u32 v168, v168, v254
    v_bfe_u32 v254, v1, 2, 1
    v_mul_u32_u24 v254, 8, v254
    v_add_u32 v168, v168, v254
    v_add_u32 v168, s101, v168
    v_bfe_u32 v254, v1, 0, 1
    v_mul_u32_u24 v9, 144, v254
    v_bfe_u32 v254, v1, 1, 1
    v_mul_u32_u24 v254, 576, v254
    v_add_u32 v9, v9, v254
    v_bfe_u32 v254, v1, 2, 1
    v_mul_u32_u24 v254, 288, v254
    v_add_u32 v9, v9, v254
    v_bfe_u32 v254, v1, 3, 1
    v_mul_u32_u24 v254, 1152, v254
    v_add_u32 v9, v9, v254
    v_bfe_u32 v254, v1, 4, 2
    v_mul_u32_u24 v254, 32, v254
    v_add_u32 v9, v9, v254
    s_lshl_b32 s4, s56, 10
    v_bfe_u32 v254, v1, 0, 6
    v_mul_u32_u24 v13, 16, v254
    v_add_u32 v13, 262144, v13
    v_add_u32 v13, s4, v13
    v_xor_b32 v156, 1024, v246
    v_xor_b32 v157, 2048, v246
    v_xor_b32 v158, 3072, v246
    v_bfe_u32 v254, v1, 0, 1
    v_mul_u32_u24 v14, 16, v254
    v_bfe_u32 v254, v1, 4, 1
    v_mul_u32_u24 v254, 32, v254
    v_add_u32 v14, v14, v254
    v_bfe_u32 v254, v1, 1, 2
    v_mul_u32_u24 v254, 64, v254
    v_add_u32 v14, v14, v254
    v_bfe_u32 v254, v1, 5, 1
    v_mul_u32_u24 v254, 256, v254
    v_add_u32 v14, v14, v254
    v_add_u32 v14, 65536, v14
    v_add_u32 v14, s55, v14
    v_bfe_u32 v254, v1, 0, 6
    v_mul_u32_u24 v15, 16, v254
    v_bfe_u32 v254, v1, 2, 2
    v_mul_u32_u24 v16, 128, v254
    v_bfe_u32 v254, v1, 0, 2
    v_mul_u32_u24 v254, 16, v254
    v_add_u32 v16, v16, v254
    v_bfe_u32 v254, v1, 4, 2
    v_mul_u32_u24 v254, 4, v254
    v_add_u32 v16, v16, v254
    v_add_u32 v16, 18688, v16
    v_mov_b32 v208, 0
    v_mov_b32 v209, 0
    v_mov_b32 v210, 0
    v_mov_b32 v211, 0
    v_mov_b32 v212, 0
    v_mov_b32 v213, 0
    v_mov_b32 v214, 0
    v_mov_b32 v215, 0
    v_mov_b32 v216, 0
    v_mov_b32 v217, 0
    v_mov_b32 v218, 0
    v_mov_b32 v219, 0
    s_mov_b64 s[50:51], s[48:49]
    v_mov_b32 v164, 0
    v_mov_b32 v165, 0
    v_mov_b32 v166, 0
    v_mov_b32 v167, 0
    v_mov_b32 v164, 0x3f803f80
    v_mov_b32 v200, s45
    v_mov_b32 v220, 0x3f803f80
    v_mov_b32 v201, s45
    v_mov_b32 v221, 0x3f803f80
    v_mov_b32 v202, s45
    v_mov_b32 v222, 0x3f803f80
    v_mov_b32 v203, s45
    v_mov_b32 v223, 0x3f803f80
    s_waitcnt vmcnt(0)
    ds_read_b64_tr_b16 a[192:193], v242 offset:16384
    ds_read_b64_tr_b16 a[194:195], v242 offset:16896
    ds_read_b64_tr_b16 a[196:197], v242 offset:18432
    ds_read_b64_tr_b16 a[198:199], v242 offset:18944
    ds_read_b64_tr_b16 a[200:201], v242 offset:20480
    ds_read_b64_tr_b16 a[202:203], v242 offset:20992
    ds_read_b64_tr_b16 a[204:205], v242 offset:22528
    ds_read_b64_tr_b16 a[206:207], v242 offset:23040
    ds_read_b64_tr_b16 a[208:209], v242 offset:24576
    ds_read_b64_tr_b16 a[210:211], v242 offset:25088
    ds_read_b64_tr_b16 a[212:213], v242 offset:26624
    ds_read_b64_tr_b16 a[214:215], v242 offset:27136
    ds_read_b64_tr_b16 a[216:217], v242 offset:28672
    ds_read_b64_tr_b16 a[218:219], v242 offset:29184
    ds_read_b64_tr_b16 a[220:221], v242 offset:30720
    ds_read_b64_tr_b16 a[222:223], v242 offset:31232
    ds_read_b64_tr_b16 a[224:225], v243 offset:16384
    ds_read_b64_tr_b16 a[226:227], v243 offset:16896
    ds_read_b64_tr_b16 a[228:229], v243 offset:18432
    ds_read_b64_tr_b16 a[230:231], v243 offset:18944
    ds_read_b64_tr_b16 a[232:233], v243 offset:20480
    ds_read_b64_tr_b16 a[234:235], v243 offset:20992
    ds_read_b64_tr_b16 a[236:237], v243 offset:22528
    ds_read_b64_tr_b16 a[238:239], v243 offset:23040
    ds_read_b64_tr_b16 a[240:241], v243 offset:24576
    ds_read_b64_tr_b16 a[242:243], v243 offset:25088
    ds_read_b64_tr_b16 a[244:245], v243 offset:26624
    ds_read_b64_tr_b16 a[246:247], v243 offset:27136
    ds_read_b64_tr_b16 a[248:249], v243 offset:28672
    ds_read_b64_tr_b16 a[250:251], v243 offset:29184
    ds_read_b64_tr_b16 a[252:253], v243 offset:30720
    ds_read_b64_tr_b16 a[254:255], v243 offset:31232
    s_waitcnt lgkmcnt(0)
    s_barrier
    buffer_load_dwordx4 v[104:107], v15, s[8:11], s42 offen offset:0
    buffer_load_dwordx4 v[120:123], v15, s[8:11], s43 offen offset:0
    buffer_load_dwordx4 v[136:139], v15, s[8:11], s44 offen offset:0
    buffer_load_dwordx4 v[140:143], v15, s[8:11], s44 offen offset:1024
    s_add_u32 s37, s28, 0
    s_bitcmp1_b32 s37, 0
    s_cselect_b32 s4, 0x84000, 0
    s_xor_b32 s34, s35, s4
    s_bitcmp1_b32 s37, 1
    s_cselect_b32 s4, 0x101000, 0
    s_xor_b32 s34, s34, s4
    s_lshr_b32 s37, s37, 2
    s_bitcmp1_b32 s63, s37
    s_cselect_b32 s4, 0x2000, 0
    s_xor_b32 s34, s34, s4
    s_lshl_b32 s37, s37, 21
    s_add_u32 s34, s34, s37
.p2align 6
.step_208:
    s_barrier
    s_setprio 3
    buffer_load_dwordx4 v[24:27], v3, s[8:11], s30 offen offset:0 sc1
    s_setprio 2
    buffer_load_dwordx4 v[28:31], v3, s[8:11], s30 offen offset:1024 sc1
    s_setprio 1
    buffer_load_dwordx4 v[32:35], v3, s[8:11], s30 offen offset:2048 sc1
    s_setprio 0
    buffer_load_dwordx4 v[36:39], v3, s[8:11], s30 offen offset:3072 sc1
    s_call_b64 s[98:99], .gm_206
    v_pk_add_f32 v[40:41], v[40:41], v[42:43]
    v_pk_add_f32 v[42:43], v[44:45], v[46:47]
    ds_write2_b32 v5, v40, v41 offset0:0 offset1:36
    ds_write2_b32 v5, v42, v43 offset0:16 offset1:52
    s_nop 1
    v_pk_add_f32 v[48:49], v[48:49], v[50:51]
    v_pk_add_f32 v[50:51], v[52:53], v[54:55]
    ds_write2_b32 v6, v48, v49 offset0:0 offset1:36
    ds_write2_b32 v6, v50, v51 offset0:16 offset1:52
    s_waitcnt lgkmcnt(2)
    s_barrier
    ds_read_b128 v[72:75], v9 offset:0
    ds_read_b128 v[76:79], v9 offset:2304
    ds_read_b128 v[80:83], v9 offset:16
    ds_read_b128 v[84:87], v9 offset:2320
    v_smfmac_f32_16x16x64_bf16 v[56:59], v[24:27], a[128:135], v2
    v_smfmac_f32_16x16x64_bf16 v[60:63], v[24:27], a[160:167], v2
    s_waitcnt lgkmcnt(4)
    s_barrier
    v_smfmac_f32_16x16x64_bf16 v[56:59], v[28:31], a[136:143], v2
    s_waitcnt lgkmcnt(2)
    v_pk_add_f32 v[72:73], v[72:73], v[76:77]
    v_pk_add_f32 v[74:75], v[74:75], v[78:79]
    v_cvt_pk_bf16_f32 v144, v72, v73
    v_cvt_pk_bf16_f32 v145, v74, v75
    s_waitcnt lgkmcnt(0)
    v_pk_add_f32 v[80:81], v[80:81], v[84:85]
    v_pk_add_f32 v[82:83], v[82:83], v[86:87]
    v_cvt_pk_bf16_f32 v146, v80, v81
    v_cvt_pk_bf16_f32 v147, v82, v83
    s_nop 1
    v_mfma_f32_16x16x32_bf16 v[192:195], v[104:107], v[144:147], 0
    v_mfma_f32_16x16x32_bf16 v[160:163], v[120:123], v[144:147], 0
    v_smfmac_f32_16x16x64_bf16 v[60:63], v[28:31], a[168:175], v2
    v_add_f32_dpp v151, v195, v195 row_ror:8 row_mask:0xf bank_mask:0x3
    v_add_f32_dpp v148, v192, v192 row_ror:8 row_mask:0xf bank_mask:0x3
    v_add_f32_dpp v149, v193, v193 row_ror:8 row_mask:0xf bank_mask:0x3
    v_add_f32_dpp v150, v194, v194 row_ror:8 row_mask:0xf bank_mask:0x3
    v_add_f32_dpp v151, v163, v163 row_ror:8 row_mask:0xf bank_mask:0xc
    v_add_f32_dpp v148, v160, v160 row_ror:8 row_mask:0xf bank_mask:0xc
    v_add_f32_dpp v149, v161, v161 row_ror:8 row_mask:0xf bank_mask:0xc
    v_add_f32_dpp v150, v162, v162 row_ror:8 row_mask:0xf bank_mask:0xc
    v_min_u32 v151, 0xfffffffe, v151
    buffer_store_dwordx4 v[148:151], v246, s[8:11], s30 offen sc1
    v_smfmac_f32_16x16x64_bf16 v[56:59], v[32:35], a[144:151], v2
    v_smfmac_f32_16x16x64_bf16 v[60:63], v[32:35], a[176:183], v2
    v_smfmac_f32_16x16x64_bf16 v[56:59], v[36:39], a[152:159], v2
    v_smfmac_f32_16x16x64_bf16 v[60:63], v[36:39], a[184:191], v2
    v_mov_b32 v40, 0
    v_mov_b32 v41, 0
    v_mov_b32 v42, 0
    v_mov_b32 v43, 0
    v_mov_b32 v44, 0
    v_mov_b32 v45, 0
    v_mov_b32 v46, 0
    v_mov_b32 v47, 0
    v_pk_add_f32 v[56:57], v[56:57], v[58:59]
    v_pk_add_f32 v[58:59], v[60:61], v[62:63]
    v_cvt_pk_bf16_f32 v60, v56, v57
    v_cvt_pk_bf16_f32 v61, v58, v59
    ds_write2_b32 v255, v60, v61 offset0:0 offset1:32
    ds_write_b128 v8, v[56:59]
    s_cmp_eq_u32 s28, 63
    s_cbranch_scc1 .fin_209
    s_waitcnt lgkmcnt(0)
    buffer_load_dwordx4 v[176:179], v13, s[8:11], s30 offen sc1
    buffer_load_dwordx4 v[180:183], v156, s[8:11], s30 offen sc1
    buffer_load_dwordx4 v[184:187], v157, s[8:11], s30 offen sc1
    buffer_load_dwordx4 v[188:191], v158, s[8:11], s30 offen sc1
    s_waitcnt lgkmcnt(0)
    s_barrier
    ds_read_b128 v[212:215], v15 offset:20224
    ds_read_b128 v[216:219], v15 offset:21248
    v_mov_b32 v48, 0
    v_mov_b32 v49, 0
    v_mov_b32 v50, 0
    v_mov_b32 v51, 0
    v_mov_b32 v52, 0
    v_mov_b32 v53, 0
    v_mov_b32 v54, 0
    v_mov_b32 v55, 0
    v_mov_b32 v56, 0
    v_mov_b32 v57, 0
    v_mov_b32 v58, 0
    v_mov_b32 v59, 0
    v_mov_b32 v60, 0
    v_mov_b32 v61, 0
    v_mov_b32 v62, 0
    v_mov_b32 v63, 0
    buffer_load_dwordx4 v[72:75], v13, s[8:11], s30 offen sc1
    buffer_load_dwordx4 v[76:79], v156, s[8:11], s30 offen sc1
    buffer_load_dwordx4 v[80:83], v157, s[8:11], s30 offen sc1
    buffer_load_dwordx4 v[84:87], v158, s[8:11], s30 offen sc1
.mf_210:
    s_waitcnt vmcnt(7)
    v_max3_u32 v18, v176, v177, v178
    v_pk_add_f32 v[196:197], v[176:177], v[178:179]
    s_waitcnt vmcnt(6)
    v_max3_u32 v18, v18, v179, v183
    v_pk_add_f32 v[192:193], v[148:149], v[180:181]
    v_pk_add_f32 v[194:195], v[150:151], v[182:183]
    v_add_f32 v196, v196, v197
    s_waitcnt vmcnt(5)
    v_pk_add_f32 v[192:193], v[192:193], v[184:185]
    v_pk_add_f32 v[194:195], v[194:195], v[186:187]
    s_waitcnt vmcnt(4)
    v_max3_u32 v18, v18, v187, v191
    v_pk_add_f32 v[192:193], v[192:193], v[188:189]
    v_pk_add_f32 v[194:195], v[194:195], v[190:191]
    v_cmp_eq_u32 vcc, -1, v18
    v_max3_f32 v19, v192, v193, v196
    v_max3_f32 v19, v19, v194, v195
    s_cbranch_vccnz .re_211
.sj_212:
    s_nop 0
    v_max_f32_dpp v18, v19, v19 row_ror:8 row_mask:0xf bank_mask:0xf
    v_max_f32_dpp v17, v19, v19 row_ror:8 row_mask:0xf bank_mask:0xf
    s_nop 1
    v_permlane16_swap_b32 v18, v17
    v_max_f32 v19, v18, v17
    v_max_f32 v18, v18, v17
    s_nop 1
    v_permlane32_swap_b32 v18, v19
    v_max_f32 v18, v18, v19
    v_mul_f32 v18, s45, v18
    v_fma_f32 v244, v196, s45, -v18
    v_pk_fma_f32 v[240:241], v[192:193], v[200:201], v[18:19] op_sel_hi:[1,1,0] neg_lo:[0,0,1] neg_hi:[0,0,1]
    v_exp_f32 v244, v244
    v_pk_fma_f32 v[242:243], v[194:195], v[200:201], v[18:19] op_sel_hi:[1,1,0] neg_lo:[0,0,1] neg_hi:[0,0,1]
    v_exp_f32 v240, v240
    v_mov_b32_dpp v245, v244 row_ror:8 row_mask:0xf bank_mask:0xf
    v_cvt_pk_bf16_f32 v208, v244, v245
    v_cvt_pk_bf16_f32 v209, v244, v245
    v_pk_mov_b32 v[210:211], v[208:209], v[208:209] op_sel:[0,1]
    v_exp_f32 v241, v241
    s_waitcnt lgkmcnt(0)
    v_mfma_f32_16x16x32_bf16 v[228:231], v[212:215], v[208:211], 0
    v_exp_f32 v242, v242
    v_mfma_f32_16x16x32_bf16 v[224:227], v[164:167], v[208:211], 0
    v_exp_f32 v243, v243
    v_cvt_pk_bf16_f32 v204, v240, v241
    v_cvt_pk_bf16_f32 v205, v242, v243
    v_mfma_f32_16x16x32_bf16 v[232:235], v[216:219], v[208:211], 0
    v_mov_b32_dpp v206, v204 row_ror:8 row_mask:0xf bank_mask:0xf
    v_mov_b32_dpp v207, v205 row_ror:8 row_mask:0xf bank_mask:0xf
    s_nop 1
    v_mfma_f32_16x16x32_bf16 v[224:227], v[220:223], v[204:207], v[224:227]
    v_mfma_f32_16x16x32_bf16 v[228:231], v[136:139], v[204:207], v[228:231]
    v_mfma_f32_16x16x32_bf16 v[232:235], v[140:143], v[204:207], v[232:235]
    s_mov_b64 exec, s[50:51]
    v_rcp_f32 v18, v224
    s_nop 1
    v_mul_f32 v228, v18, v228
    v_mul_f32 v229, v18, v229
    v_mul_f32 v230, v18, v230
    v_mul_f32 v231, v18, v231
    v_pk_mul_f32 v[232:233], v[18:19], v[232:233] op_sel_hi:[0,1]
    v_pk_mul_f32 v[234:235], v[18:19], v[234:235] op_sel_hi:[0,1]
    v_cvt_pk_bf16_f32 v236, v228, v229
    v_cvt_pk_bf16_f32 v239, v234, v235
    v_cvt_pk_bf16_f32 v237, v230, v231
    v_cvt_pk_bf16_f32 v238, v232, v233
    v_min_u32 v239, 0xfffffffe, v239
    buffer_store_dwordx4 v[236:239], v14, s[8:11], s30 offen sc1
    s_mov_b64 exec, -1
    s_add_u32 s37, s28, 0
    s_bitcmp1_b32 s37, 0
    s_cselect_b32 s4, 0x84000, 0
    s_xor_b32 s34, s35, s4
    s_bitcmp1_b32 s37, 1
    s_cselect_b32 s4, 0x101000, 0
    s_xor_b32 s34, s34, s4
    s_lshr_b32 s37, s37, 2
    s_bitcmp1_b32 s63, s37
    s_cselect_b32 s4, 0x2000, 0
    s_xor_b32 s34, s34, s4
    s_lshl_b32 s37, s37, 21
    s_add_u32 s34, s34, s37
    s_add_u32 s42, s42, 262144
    s_add_u32 s43, s43, 262144
    s_add_u32 s44, s44, 262144
    v_mov_b32 v64, 0
    v_mov_b32 v65, 0
    v_mov_b32 v66, 0
    v_mov_b32 v67, 0
    v_mov_b32 v68, 0
    v_mov_b32 v69, 0
    v_mov_b32 v70, 0
    v_mov_b32 v71, 0
    s_barrier
    s_setprio 3
    buffer_load_dwordx4 v[24:27], v4, s[8:11], s30 offen offset:0 sc1
    s_setprio 2
    buffer_load_dwordx4 v[28:31], v4, s[8:11], s30 offen offset:1024 sc1
    s_setprio 1
    buffer_load_dwordx4 v[32:35], v4, s[8:11], s30 offen offset:2048 sc1
    s_setprio 0
    buffer_load_dwordx4 v[36:39], v4, s[8:11], s30 offen offset:3072 sc1
    s_call_b64 s[98:99], .gm_207
    s_nop 4
    v_pk_add_f32 v[64:65], v[64:65], v[66:67]
    v_cvt_pk_bf16_f32 v66, v64, v65
    v_pk_add_f32 v[68:69], v[68:69], v[70:71]
    v_cvt_pk_bf16_f32 v67, v68, v69
    v_min_u32 v67, 0xfffffffe, v67
    buffer_store_dwordx2 v[66:67], v168, s[8:11], s34 offen sc1
    ds_write2_b32 v7, v64, v65 offset0:0 offset1:36
    ds_write2_b32 v7, v68, v69 offset0:16 offset1:52
    s_waitcnt lgkmcnt(0)
    s_barrier
    buffer_load_dwordx4 v[104:107], v15, s[8:11], s42 offen offset:0
    buffer_load_dwordx4 v[120:123], v15, s[8:11], s43 offen offset:0
    buffer_load_dwordx4 v[136:139], v15, s[8:11], s44 offen offset:0
    buffer_load_dwordx4 v[140:143], v15, s[8:11], s44 offen offset:1024
    s_mov_b32 s4, s30
    s_mov_b32 s30, s31
    s_mov_b32 s31, s32
    s_mov_b32 s32, s33
    s_mov_b32 s33, s4
    s_add_u32 s28, s28, 1
    s_mov_b32 s62, 0
    s_branch .step_208
.fin_209:
    s_waitcnt lgkmcnt(0)
    s_barrier
    s_barrier
    s_endpgm
.re_211:
    buffer_load_dwordx4 v[176:179], v13, s[8:11], s30 offen sc1
    buffer_load_dwordx4 v[180:183], v156, s[8:11], s30 offen sc1
    buffer_load_dwordx4 v[184:187], v157, s[8:11], s30 offen sc1
    buffer_load_dwordx4 v[188:191], v158, s[8:11], s30 offen sc1
    s_waitcnt vmcnt(7)
    v_max3_u32 v18, v72, v73, v74
    v_pk_add_f32 v[196:197], v[72:73], v[74:75]
    s_waitcnt vmcnt(6)
    v_max3_u32 v18, v18, v75, v79
    v_pk_add_f32 v[192:193], v[148:149], v[76:77]
    v_pk_add_f32 v[194:195], v[150:151], v[78:79]
    v_add_f32 v196, v196, v197
    s_waitcnt vmcnt(5)
    v_pk_add_f32 v[192:193], v[192:193], v[80:81]
    v_pk_add_f32 v[194:195], v[194:195], v[82:83]
    s_waitcnt vmcnt(4)
    v_max3_u32 v18, v18, v83, v87
    v_pk_add_f32 v[192:193], v[192:193], v[84:85]
    v_pk_add_f32 v[194:195], v[194:195], v[86:87]
    v_cmp_eq_u32 vcc, -1, v18
    v_max3_f32 v19, v192, v193, v196
    v_max3_f32 v19, v19, v194, v195
    s_cbranch_vccnz .re_213
    s_branch .sj_212
.re_213:
    buffer_load_dwordx4 v[72:75], v13, s[8:11], s30 offen sc1
    buffer_load_dwordx4 v[76:79], v156, s[8:11], s30 offen sc1
    buffer_load_dwordx4 v[80:83], v157, s[8:11], s30 offen sc1
    buffer_load_dwordx4 v[84:87], v158, s[8:11], s30 offen sc1
    s_add_u32 s62, s62, 1
    s_cmp_gt_u32 s62, 0x100000
    s_cbranch_scc1 .mg_end_1
    s_branch .mf_210
.w1_203:
    v_bfe_u32 v254, v1, 4, 1
    v_mul_u32_u24 v168, 1024, v254
    v_bfe_u32 v254, v1, 5, 1
    v_mul_u32_u24 v254, 128, v254
    v_add_u32 v168, v168, v254
    v_bfe_u32 v254, v1, 3, 1
    v_mul_u32_u24 v254, 64, v254
    v_add_u32 v168, v168, v254
    v_bfe_u32 v254, v1, 0, 2
    v_mul_u32_u24 v254, 16, v254
    v_add_u32 v168, v168, v254
    v_bfe_u32 v254, v1, 2, 1
    v_mul_u32_u24 v254, 8, v254
    v_add_u32 v168, v168, v254
    v_add_u32 v168, 256, v168
    v_add_u32 v168, s101, v168
    v_bfe_u32 v254, v1, 0, 1
    v_mul_u32_u24 v17, 2, v254
    v_bfe_u32 v254, v1, 2, 1
    v_mul_u32_u24 v254, 1, v254
    v_add_u32 v17, v17, v254
    v_bfe_u32 v254, v1, 3, 1
    v_mul_u32_u24 v254, 4, v254
    v_add_u32 v17, v17, v254
    v_bfe_u32 v254, v1, 1, 1
    v_mul_u32_u24 v18, 16, v254
    v_mov_b32 v19, 0x3f80
    v_lshlrev_b32 v18, v18, v19
    v_cmp_eq_u32 vcc, 0, v17
    s_nop 1
    v_cndmask_b32 v124, 0, v18, vcc
    v_cmp_eq_u32 vcc, 1, v17
    s_nop 1
    v_cndmask_b32 v125, 0, v18, vcc
    v_cmp_eq_u32 vcc, 2, v17
    s_nop 1
    v_cndmask_b32 v126, 0, v18, vcc
    v_cmp_eq_u32 vcc, 3, v17
    s_nop 1
    v_cndmask_b32 v127, 0, v18, vcc
    v_cmp_eq_u32 vcc, 4, v17
    s_nop 1
    v_cndmask_b32 v128, 0, v18, vcc
    v_cmp_eq_u32 vcc, 5, v17
    s_nop 1
    v_cndmask_b32 v129, 0, v18, vcc
    v_cmp_eq_u32 vcc, 6, v17
    s_nop 1
    v_cndmask_b32 v130, 0, v18, vcc
    v_cmp_eq_u32 vcc, 7, v17
    s_nop 1
    v_cndmask_b32 v131, 0, v18, vcc
    v_bfe_u32 v254, v1, 0, 1
    v_mul_u32_u24 v9, 144, v254
    v_bfe_u32 v254, v1, 1, 1
    v_mul_u32_u24 v254, 576, v254
    v_add_u32 v9, v9, v254
    v_bfe_u32 v254, v1, 2, 1
    v_mul_u32_u24 v254, 288, v254
    v_add_u32 v9, v9, v254
    v_bfe_u32 v254, v1, 3, 1
    v_mul_u32_u24 v254, 1152, v254
    v_add_u32 v9, v9, v254
    v_bfe_u32 v254, v1, 4, 2
    v_mul_u32_u24 v254, 32, v254
    v_add_u32 v9, v9, v254
    v_bfe_u32 v254, v1, 0, 1
    v_mul_u32_u24 v11, 144, v254
    v_bfe_u32 v254, v1, 2, 2
    v_mul_u32_u24 v254, 288, v254
    v_add_u32 v11, v11, v254
    v_bfe_u32 v254, v1, 1, 1
    v_mul_u32_u24 v254, 1152, v254
    v_add_u32 v11, v11, v254
    v_bfe_u32 v254, v1, 4, 2
    v_mul_u32_u24 v254, 32, v254
    v_add_u32 v11, v11, v254
    v_add_u32 v11, 4736, v11
    s_lshl_b32 s4, s56, 10
    s_lshl_b32 s5, s53, 2
    v_bfe_u32 v254, v1, 0, 6
    v_mul_u32_u24 v10, 16, v254
    v_add_u32 v10, 262144, v10
    v_add_u32 v10, s4, v10
    v_add_u32 v10, s5, v10
    v_bfe_u32 v254, v1, 1, 1
    v_mul_u32_u24 v12, 144, v254
    v_bfe_u32 v254, v1, 5, 1
    v_mul_u32_u24 v254, 288, v254
    v_add_u32 v12, v12, v254
    v_bfe_u32 v254, v1, 3, 1
    v_mul_u32_u24 v254, 576, v254
    v_add_u32 v12, v12, v254
    v_bfe_u32 v254, v1, 4, 1
    v_mul_u32_u24 v254, 32, v254
    v_add_u32 v12, v12, v254
    v_bfe_u32 v254, v1, 2, 1
    v_mul_u32_u24 v254, 64, v254
    v_add_u32 v12, v12, v254
    v_bfe_u32 v254, v1, 0, 1
    v_mul_u32_u24 v254, 16, v254
    v_add_u32 v12, v12, v254
    v_add_u32 v12, 9472, v12
    v_bfe_u32 v254, v1, 0, 6
    v_mul_u32_u24 v13, 16, v254
    v_add_u32 v13, s101, v13
    v_bfe_u32 v254, v1, 0, 2
    v_mul_u32_u24 v14, 8, v254
    v_bfe_u32 v254, v1, 4, 1
    v_mul_u32_u24 v254, 32, v254
    v_add_u32 v14, v14, v254
    v_bfe_u32 v254, v1, 3, 1
    v_mul_u32_u24 v254, 64, v254
    v_add_u32 v14, v14, v254
    v_bfe_u32 v254, v1, 5, 1
    v_mul_u32_u24 v254, 128, v254
    v_add_u32 v14, v14, v254
    v_bfe_u32 v254, v1, 2, 1
    v_mul_u32_u24 v254, 256, v254
    v_add_u32 v14, v14, v254
    v_add_u32 v14, s55, v14
    v_xor_b32 v14, 2048, v14
    v_min_u32 v249, 0xfffffffe, v249
    buffer_store_dwordx2 v[248:249], v14, s[8:11], s30 offen sc1
    v_bfe_u32 v254, v1, 0, 6
    v_mul_u32_u24 v15, 16, v254
    s_add_u32 s42, s42, 262144
    s_add_u32 s43, s43, 262144
    s_add_u32 s44, s44, 262144
    s_waitcnt vmcnt(0)
    ds_read_b64_tr_b16 a[192:193], v242 offset:16384
    ds_read_b64_tr_b16 a[194:195], v242 offset:16896
    ds_read_b64_tr_b16 a[196:197], v242 offset:18432
    ds_read_b64_tr_b16 a[198:199], v242 offset:18944
    ds_read_b64_tr_b16 a[200:201], v242 offset:20480
    ds_read_b64_tr_b16 a[202:203], v242 offset:20992
    ds_read_b64_tr_b16 a[204:205], v242 offset:22528
    ds_read_b64_tr_b16 a[206:207], v242 offset:23040
    ds_read_b64_tr_b16 a[208:209], v242 offset:24576
    ds_read_b64_tr_b16 a[210:211], v242 offset:25088
    ds_read_b64_tr_b16 a[212:213], v242 offset:26624
    ds_read_b64_tr_b16 a[214:215], v242 offset:27136
    ds_read_b64_tr_b16 a[216:217], v242 offset:28672
    ds_read_b64_tr_b16 a[218:219], v242 offset:29184
    ds_read_b64_tr_b16 a[220:221], v242 offset:30720
    ds_read_b64_tr_b16 a[222:223], v242 offset:31232
    ds_read_b64_tr_b16 a[224:225], v243 offset:16384
    ds_read_b64_tr_b16 a[226:227], v243 offset:16896
    ds_read_b64_tr_b16 a[228:229], v243 offset:18432
    ds_read_b64_tr_b16 a[230:231], v243 offset:18944
    ds_read_b64_tr_b16 a[232:233], v243 offset:20480
    ds_read_b64_tr_b16 a[234:235], v243 offset:20992
    ds_read_b64_tr_b16 a[236:237], v243 offset:22528
    ds_read_b64_tr_b16 a[238:239], v243 offset:23040
    ds_read_b64_tr_b16 a[240:241], v243 offset:24576
    ds_read_b64_tr_b16 a[242:243], v243 offset:25088
    ds_read_b64_tr_b16 a[244:245], v243 offset:26624
    ds_read_b64_tr_b16 a[246:247], v243 offset:27136
    ds_read_b64_tr_b16 a[248:249], v243 offset:28672
    ds_read_b64_tr_b16 a[250:251], v243 offset:29184
    ds_read_b64_tr_b16 a[252:253], v243 offset:30720
    ds_read_b64_tr_b16 a[254:255], v243 offset:31232
    s_waitcnt lgkmcnt(0)
    s_barrier
    s_add_u32 s37, s28, 0
    s_bitcmp1_b32 s37, 0
    s_cselect_b32 s4, 0x84000, 0
    s_xor_b32 s34, s35, s4
    s_bitcmp1_b32 s37, 1
    s_cselect_b32 s4, 0x101000, 0
    s_xor_b32 s34, s34, s4
    s_lshr_b32 s37, s37, 2
    s_bitcmp1_b32 s63, s37
    s_cselect_b32 s4, 0x2000, 0
    s_xor_b32 s34, s34, s4
    s_lshl_b32 s37, s37, 21
    s_add_u32 s34, s34, s37
.p2align 6
.step_214:
    s_barrier
    s_setprio 3
    buffer_load_dwordx4 v[24:27], v3, s[8:11], s30 offen offset:0 sc1
    s_setprio 2
    buffer_load_dwordx4 v[28:31], v3, s[8:11], s30 offen offset:1024 sc1
    s_setprio 1
    buffer_load_dwordx4 v[32:35], v3, s[8:11], s30 offen offset:2048 sc1
    s_setprio 0
    buffer_load_dwordx4 v[36:39], v3, s[8:11], s30 offen offset:3072 sc1
    s_call_b64 s[98:99], .gm_206
    v_pk_add_f32 v[40:41], v[40:41], v[42:43]
    v_pk_add_f32 v[42:43], v[44:45], v[46:47]
    ds_write2_b32 v5, v40, v41 offset0:0 offset1:36
    ds_write2_b32 v5, v42, v43 offset0:16 offset1:52
    s_nop 1
    v_pk_add_f32 v[48:49], v[48:49], v[50:51]
    v_pk_add_f32 v[50:51], v[52:53], v[54:55]
    ds_write2_b32 v6, v48, v49 offset0:0 offset1:36
    ds_write2_b32 v6, v50, v51 offset0:16 offset1:52
    s_waitcnt lgkmcnt(2)
    s_barrier
    ds_read_b128 v[72:75], v9 offset:0
    ds_read_b128 v[76:79], v9 offset:2304
    ds_read_b128 v[80:83], v9 offset:16
    ds_read_b128 v[84:87], v9 offset:2320
    v_smfmac_f32_16x16x64_bf16 v[56:59], v[24:27], a[128:135], v2
    v_smfmac_f32_16x16x64_bf16 v[60:63], v[24:27], a[160:167], v2
    s_waitcnt lgkmcnt(4)
    s_barrier
    ds_read_b128 v[88:91], v11 offset:0
    ds_read_b128 v[92:95], v11 offset:2304
    ds_read_b128 v[96:99], v11 offset:16
    ds_read_b128 v[100:103], v11 offset:2320
    v_smfmac_f32_16x16x64_bf16 v[56:59], v[28:31], a[136:143], v2
    s_waitcnt lgkmcnt(6)
    v_pk_add_f32 v[72:73], v[72:73], v[76:77]
    v_pk_add_f32 v[74:75], v[74:75], v[78:79]
    v_cvt_pk_bf16_f32 v144, v72, v73
    v_cvt_pk_bf16_f32 v145, v74, v75
    s_waitcnt lgkmcnt(4)
    v_pk_add_f32 v[80:81], v[80:81], v[84:85]
    v_pk_add_f32 v[82:83], v[82:83], v[86:87]
    v_cvt_pk_bf16_f32 v146, v80, v81
    v_cvt_pk_bf16_f32 v147, v82, v83
    s_waitcnt lgkmcnt(2)
    v_pk_add_f32 v[88:89], v[88:89], v[92:93]
    v_pk_add_f32 v[90:91], v[90:91], v[94:95]
    v_cvt_pk_bf16_f32 v148, v88, v89
    v_cvt_pk_bf16_f32 v149, v90, v91
    s_waitcnt lgkmcnt(0)
    v_pk_add_f32 v[96:97], v[96:97], v[100:101]
    v_pk_add_f32 v[98:99], v[98:99], v[102:103]
    v_cvt_pk_bf16_f32 v150, v96, v97
    v_cvt_pk_bf16_f32 v151, v98, v99
    s_nop 1
    v_mfma_f32_16x16x32_bf16 v[196:199], v[148:151], v[144:147], 0
    v_smfmac_f32_16x16x64_bf16 v[60:63], v[28:31], a[168:175], v2
    v_smfmac_f32_16x16x64_bf16 v[56:59], v[32:35], a[144:151], v2
    v_pk_add_f32 v[196:197], v[196:197], v[198:199]
    s_nop 1
    v_add_f32_dpp v198, v196, v196 row_ror:8 row_mask:0xf bank_mask:0xf
    v_add_f32_dpp v199, v197, v197 row_ror:8 row_mask:0xf bank_mask:0xf
    v_cndmask_b32 v198, v199, v198, s[48:49]
    v_min_u32 v198, 0xfffffffe, v198
    buffer_store_dword v198, v10, s[8:11], s30 offen sc1
    v_smfmac_f32_16x16x64_bf16 v[60:63], v[32:35], a[176:183], v2
    v_smfmac_f32_16x16x64_bf16 v[56:59], v[36:39], a[152:159], v2
    v_smfmac_f32_16x16x64_bf16 v[60:63], v[36:39], a[184:191], v2
    v_mov_b32 v40, 0
    v_mov_b32 v41, 0
    v_mov_b32 v42, 0
    v_mov_b32 v43, 0
    v_mov_b32 v44, 0
    v_mov_b32 v45, 0
    v_mov_b32 v46, 0
    v_mov_b32 v47, 0
    v_pk_add_f32 v[56:57], v[56:57], v[58:59]
    v_pk_add_f32 v[58:59], v[60:61], v[62:63]
    v_cvt_pk_bf16_f32 v60, v56, v57
    v_cvt_pk_bf16_f32 v61, v58, v59
    ds_write2_b32 v255, v60, v61 offset0:0 offset1:32
    ds_write_b128 v8, v[56:59]
    s_waitcnt lgkmcnt(0)
    s_barrier
    s_cmp_eq_u32 s28, 63
    s_cbranch_scc1 .fin_215
    s_barrier
    s_setprio 3
    buffer_load_dwordx4 v[24:27], v4, s[8:11], s30 offen offset:0 sc1
    s_setprio 2
    buffer_load_dwordx4 v[28:31], v4, s[8:11], s30 offen offset:1024 sc1
    s_setprio 1
    buffer_load_dwordx4 v[32:35], v4, s[8:11], s30 offen offset:2048 sc1
    s_setprio 0
    buffer_load_dwordx4 v[36:39], v4, s[8:11], s30 offen offset:3072 sc1
    s_call_b64 s[98:99], .gm_207
    s_nop 4
    v_pk_add_f32 v[64:65], v[64:65], v[66:67]
    v_cvt_pk_bf16_f32 v66, v64, v65
    v_pk_add_f32 v[68:69], v[68:69], v[70:71]
    v_cvt_pk_bf16_f32 v67, v68, v69
    v_min_u32 v67, 0xfffffffe, v67
    buffer_store_dwordx2 v[66:67], v168, s[8:11], s34 offen sc1
    ds_write2_b32 v7, v64, v65 offset0:0 offset1:36
    ds_write2_b32 v7, v68, v69 offset0:16 offset1:52
    s_waitcnt lgkmcnt(0)
    s_barrier
    ds_read_b128 v[72:75], v12 offset:0
    ds_read_b128 v[76:79], v12 offset:1152
    ds_read_b128 v[80:83], v12 offset:2304
    ds_read_b128 v[84:87], v12 offset:3456
    s_waitcnt lgkmcnt(2)
    v_pk_add_f32 v[72:73], v[72:73], v[76:77]
    v_pk_add_f32 v[74:75], v[74:75], v[78:79]
    s_waitcnt lgkmcnt(0)
    v_pk_add_f32 v[80:81], v[80:81], v[84:85]
    v_pk_add_f32 v[82:83], v[82:83], v[86:87]
    v_pk_add_f32 v[72:73], v[72:73], v[80:81]
    v_pk_add_f32 v[74:75], v[74:75], v[82:83]
    v_mov_b32 v64, 0
    v_mov_b32 v65, 0
    v_mov_b32 v66, 0
    v_mov_b32 v67, 0
    v_mov_b32 v68, 0
    v_mov_b32 v69, 0
    v_mov_b32 v70, 0
    v_mov_b32 v71, 0
    s_xor_b32 s38, s34, 0x4000
    s_xor_b32 s39, s34, 0x1000
    s_xor_b32 s40, s34, 0x5000
    s_add_u32 s37, s28, 1
    s_bitcmp1_b32 s37, 0
    s_cselect_b32 s4, 0x84000, 0
    s_xor_b32 s34, s35, s4
    s_bitcmp1_b32 s37, 1
    s_cselect_b32 s4, 0x101000, 0
    s_xor_b32 s34, s34, s4
    s_lshr_b32 s37, s37, 2
    s_bitcmp1_b32 s63, s37
    s_cselect_b32 s4, 0x2000, 0
    s_xor_b32 s34, s34, s4
    s_lshl_b32 s37, s37, 21
    s_add_u32 s34, s34, s37
    v_mov_b32 v48, 0
    v_mov_b32 v49, 0
    v_mov_b32 v50, 0
    v_mov_b32 v51, 0
    v_mov_b32 v52, 0
    v_mov_b32 v53, 0
    v_mov_b32 v54, 0
    v_mov_b32 v55, 0
    v_mov_b32 v56, 0
    v_mov_b32 v57, 0
    v_mov_b32 v58, 0
    v_mov_b32 v59, 0
    v_mov_b32 v60, 0
    v_mov_b32 v61, 0
    v_mov_b32 v62, 0
    v_mov_b32 v63, 0
.pl_216:
    buffer_load_dwordx4 v[76:79], v13, s[8:11], s38 offen offset:0 sc1
    buffer_load_dwordx4 v[80:83], v13, s[8:11], s38 offen offset:1024 sc1
    buffer_load_dwordx4 v[84:87], v13, s[8:11], s39 offen offset:0 sc1
    buffer_load_dwordx4 v[88:91], v13, s[8:11], s39 offen offset:1024 sc1
    buffer_load_dwordx4 v[92:95], v13, s[8:11], s40 offen offset:0 sc1
    buffer_load_dwordx4 v[96:99], v13, s[8:11], s40 offen offset:1024 sc1
.pk_219:
    s_waitcnt vmcnt(5)
    v_mfma_f32_16x16x32_bf16 v[108:111], v[76:79], v[124:127], v[72:75]
    v_max_u32 v18, v77, v79
    s_waitcnt vmcnt(4)
    v_mfma_f32_16x16x32_bf16 v[108:111], v[80:83], v[128:131], v[108:111]
    v_max3_u32 v18, v18, v81, v83
    v_cmp_eq_u32 vcc, -1, v18
    s_cbranch_vccnz .pf_220
.pk_221:
    s_waitcnt vmcnt(3)
    v_mfma_f32_16x16x32_bf16 v[112:115], v[84:87], v[124:127], v[108:111]
    v_max_u32 v18, v85, v87
    s_waitcnt vmcnt(2)
    v_mfma_f32_16x16x32_bf16 v[112:115], v[88:91], v[128:131], v[112:115]
    v_max3_u32 v18, v18, v89, v91
    v_cmp_eq_u32 vcc, -1, v18
    s_cbranch_vccnz .pf_222
.pk_223:
    s_waitcnt vmcnt(1)
    v_mfma_f32_16x16x32_bf16 v[100:103], v[92:95], v[124:127], v[112:115]
    v_max_u32 v18, v93, v95
    s_waitcnt vmcnt(0)
    v_mfma_f32_16x16x32_bf16 v[100:103], v[96:99], v[128:131], v[100:103]
    v_max3_u32 v18, v18, v97, v99
    v_cmp_eq_u32 vcc, -1, v18
    s_cbranch_vccnz .pf_224
.pd_218:
    s_nop 4
    v_cvt_pk_bf16_f32 v105, v102, v103
    v_cvt_pk_bf16_f32 v104, v100, v101
    v_min_u32 v105, 0xfffffffe, v105
    buffer_store_dwordx2 v[104:105], v14, s[8:11], s31 offen sc1
    s_mov_b32 s4, s30
    s_mov_b32 s30, s31
    s_mov_b32 s31, s32
    s_mov_b32 s32, s33
    s_mov_b32 s33, s4
    s_add_u32 s28, s28, 1
    s_mov_b32 s62, 0
    s_branch .step_214
.fin_215:
    s_barrier
    s_waitcnt vmcnt(0)
    s_endpgm
.pf_220:
    buffer_load_dwordx4 v[76:79], v13, s[8:11], s38 offen offset:0 sc1
    buffer_load_dwordx4 v[80:83], v13, s[8:11], s38 offen offset:1024 sc1
    s_add_u32 s62, s62, 1
    s_cmp_gt_u32 s62, 0x100000
    s_cbranch_scc1 .mg_end_1
.pk_225:
    s_waitcnt vmcnt(5)
    v_mfma_f32_16x16x32_bf16 v[108:111], v[84:87], v[124:127], v[72:75]
    v_max_u32 v18, v85, v87
    s_waitcnt vmcnt(4)
    v_mfma_f32_16x16x32_bf16 v[108:111], v[88:91], v[128:131], v[108:111]
    v_max3_u32 v18, v18, v89, v91
    v_cmp_eq_u32 vcc, -1, v18
    s_cbranch_vccnz .pf_226
.pk_227:
    s_waitcnt vmcnt(3)
    v_mfma_f32_16x16x32_bf16 v[112:115], v[92:95], v[124:127], v[108:111]
    v_max_u32 v18, v93, v95
    s_waitcnt vmcnt(2)
    v_mfma_f32_16x16x32_bf16 v[112:115], v[96:99], v[128:131], v[112:115]
    v_max3_u32 v18, v18, v97, v99
    v_cmp_eq_u32 vcc, -1, v18
    s_cbranch_vccnz .pf_228
.pk_229:
    s_waitcnt vmcnt(1)
    v_mfma_f32_16x16x32_bf16 v[100:103], v[76:79], v[124:127], v[112:115]
    v_max_u32 v18, v77, v79
    s_waitcnt vmcnt(0)
    v_mfma_f32_16x16x32_bf16 v[100:103], v[80:83], v[128:131], v[100:103]
    v_max3_u32 v18, v18, v81, v83
    v_cmp_eq_u32 vcc, -1, v18
    s_cbranch_vccnz .pf_230
    s_branch .pd_218
.pf_222:
    buffer_load_dwordx4 v[84:87], v13, s[8:11], s39 offen offset:0 sc1
    buffer_load_dwordx4 v[88:91], v13, s[8:11], s39 offen offset:1024 sc1
    s_add_u32 s62, s62, 1
    s_cmp_gt_u32 s62, 0x100000
    s_cbranch_scc1 .mg_end_1
.pk_231:
    s_waitcnt vmcnt(3)
    v_mfma_f32_16x16x32_bf16 v[112:115], v[92:95], v[124:127], v[108:111]
    v_max_u32 v18, v93, v95
    s_waitcnt vmcnt(2)
    v_mfma_f32_16x16x32_bf16 v[112:115], v[96:99], v[128:131], v[112:115]
    v_max3_u32 v18, v18, v97, v99
    v_cmp_eq_u32 vcc, -1, v18
    s_cbranch_vccnz .pf_232
.pk_233:
    s_waitcnt vmcnt(1)
    v_mfma_f32_16x16x32_bf16 v[100:103], v[84:87], v[124:127], v[112:115]
    v_max_u32 v18, v85, v87
    s_waitcnt vmcnt(0)
    v_mfma_f32_16x16x32_bf16 v[100:103], v[88:91], v[128:131], v[100:103]
    v_max3_u32 v18, v18, v89, v91
    v_cmp_eq_u32 vcc, -1, v18
    s_cbranch_vccnz .pf_234
    s_branch .pd_218
.pf_224:
    buffer_load_dwordx4 v[92:95], v13, s[8:11], s40 offen offset:0 sc1
    buffer_load_dwordx4 v[96:99], v13, s[8:11], s40 offen offset:1024 sc1
    s_add_u32 s62, s62, 1
    s_cmp_gt_u32 s62, 0x100000
    s_cbranch_scc1 .mg_end_1
    s_branch .pk_223
.pf_226:
    buffer_load_dwordx4 v[84:87], v13, s[8:11], s39 offen offset:0 sc1
    buffer_load_dwordx4 v[88:91], v13, s[8:11], s39 offen offset:1024 sc1
    s_add_u32 s62, s62, 1
    s_cmp_gt_u32 s62, 0x100000
    s_cbranch_scc1 .mg_end_1
.pk_235:
    s_waitcnt vmcnt(5)
    v_mfma_f32_16x16x32_bf16 v[108:111], v[92:95], v[124:127], v[72:75]
    v_max_u32 v18, v93, v95
    s_waitcnt vmcnt(4)
    v_mfma_f32_16x16x32_bf16 v[108:111], v[96:99], v[128:131], v[108:111]
    v_max3_u32 v18, v18, v97, v99
    v_cmp_eq_u32 vcc, -1, v18
    s_cbranch_vccnz .pf_236
.pk_237:
    s_waitcnt vmcnt(3)
    v_mfma_f32_16x16x32_bf16 v[112:115], v[76:79], v[124:127], v[108:111]
    v_max_u32 v18, v77, v79
    s_waitcnt vmcnt(2)
    v_mfma_f32_16x16x32_bf16 v[112:115], v[80:83], v[128:131], v[112:115]
    v_max3_u32 v18, v18, v81, v83
    v_cmp_eq_u32 vcc, -1, v18
    s_cbranch_vccnz .pf_238
    s_branch .pk_233
.pf_228:
    buffer_load_dwordx4 v[92:95], v13, s[8:11], s40 offen offset:0 sc1
    buffer_load_dwordx4 v[96:99], v13, s[8:11], s40 offen offset:1024 sc1
    s_add_u32 s62, s62, 1
    s_cmp_gt_u32 s62, 0x100000
    s_cbranch_scc1 .mg_end_1
.pk_239:
    s_waitcnt vmcnt(3)
    v_mfma_f32_16x16x32_bf16 v[112:115], v[76:79], v[124:127], v[108:111]
    v_max_u32 v18, v77, v79
    s_waitcnt vmcnt(2)
    v_mfma_f32_16x16x32_bf16 v[112:115], v[80:83], v[128:131], v[112:115]
    v_max3_u32 v18, v18, v81, v83
    v_cmp_eq_u32 vcc, -1, v18
    s_cbranch_vccnz .pf_240
    s_branch .pk_223
.pf_230:
    buffer_load_dwordx4 v[76:79], v13, s[8:11], s38 offen offset:0 sc1
    buffer_load_dwordx4 v[80:83], v13, s[8:11], s38 offen offset:1024 sc1
    s_add_u32 s62, s62, 1
    s_cmp_gt_u32 s62, 0x100000
    s_cbranch_scc1 .mg_end_1
    s_branch .pk_229
.pf_232:
    buffer_load_dwordx4 v[92:95], v13, s[8:11], s40 offen offset:0 sc1
    buffer_load_dwordx4 v[96:99], v13, s[8:11], s40 offen offset:1024 sc1
    s_add_u32 s62, s62, 1
    s_cmp_gt_u32 s62, 0x100000
    s_cbranch_scc1 .mg_end_1
    s_branch .pk_221
.pf_234:
    buffer_load_dwordx4 v[84:87], v13, s[8:11], s39 offen offset:0 sc1
    buffer_load_dwordx4 v[88:91], v13, s[8:11], s39 offen offset:1024 sc1
    s_add_u32 s62, s62, 1
    s_cmp_gt_u32 s62, 0x100000
    s_cbranch_scc1 .mg_end_1
    s_branch .pk_233
.pf_236:
    buffer_load_dwordx4 v[92:95], v13, s[8:11], s40 offen offset:0 sc1
    buffer_load_dwordx4 v[96:99], v13, s[8:11], s40 offen offset:1024 sc1
    s_add_u32 s62, s62, 1
    s_cmp_gt_u32 s62, 0x100000
    s_cbranch_scc1 .mg_end_1
    s_branch .pk_219
.pf_238:
    buffer_load_dwordx4 v[76:79], v13, s[8:11], s38 offen offset:0 sc1
    buffer_load_dwordx4 v[80:83], v13, s[8:11], s38 offen offset:1024 sc1
    s_add_u32 s62, s62, 1
    s_cmp_gt_u32 s62, 0x100000
    s_cbranch_scc1 .mg_end_1
.pk_241:
    s_waitcnt vmcnt(3)
    v_mfma_f32_16x16x32_bf16 v[112:115], v[84:87], v[124:127], v[108:111]
    v_max_u32 v18, v85, v87
    s_waitcnt vmcnt(2)
    v_mfma_f32_16x16x32_bf16 v[112:115], v[88:91], v[128:131], v[112:115]
    v_max3_u32 v18, v18, v89, v91
    v_cmp_eq_u32 vcc, -1, v18
    s_cbranch_vccnz .pf_242
    s_branch .pk_229
.pf_240:
    buffer_load_dwordx4 v[76:79], v13, s[8:11], s38 offen offset:0 sc1
    buffer_load_dwordx4 v[80:83], v13, s[8:11], s38 offen offset:1024 sc1
    s_add_u32 s62, s62, 1
    s_cmp_gt_u32 s62, 0x100000
    s_cbranch_scc1 .mg_end_1
    s_branch .pk_227
.pf_242:
    buffer_load_dwordx4 v[84:87], v13, s[8:11], s39 offen offset:0 sc1
    buffer_load_dwordx4 v[88:91], v13, s[8:11], s39 offen offset:1024 sc1
    s_add_u32 s62, s62, 1
    s_cmp_gt_u32 s62, 0x100000
    s_cbranch_scc1 .mg_end_1
    s_branch .pk_237
.pr_217:
    s_add_u32 s62, s62, 1
    s_cmp_gt_u32 s62, 0x100000
    s_cbranch_scc1 .mg_end_1
    s_branch .pl_216
.w2_204:
    v_bfe_u32 v254, v1, 4, 1
    v_mul_u32_u24 v168, 1024, v254
    v_bfe_u32 v254, v1, 5, 1
    v_mul_u32_u24 v254, 128, v254
    v_add_u32 v168, v168, v254
    v_bfe_u32 v254, v1, 3, 1
    v_mul_u32_u24 v254, 64, v254
    v_add_u32 v168, v168, v254
    v_bfe_u32 v254, v1, 0, 2
    v_mul_u32_u24 v254, 16, v254
    v_add_u32 v168, v168, v254
    v_bfe_u32 v254, v1, 2, 1
    v_mul_u32_u24 v254, 8, v254
    v_add_u32 v168, v168, v254
    v_add_u32 v168, 512, v168
    v_add_u32 v168, s101, v168
    s_lshl_b32 s4, s56, 9
    s_lshl_b32 s5, s53, 7
    s_add_u32 s4, s4, s5
    s_add_u32 s4, s4, 92274688
    v_mov_b32 v14, s4
    v_bfe_u32 v254, v1, 0, 6
    v_mul_u32_u24 v12, 16, v254
    v_add_u32 v12, 18176, v12
    v_bfe_u32 v254, v1, 0, 6
    v_mul_u32_u24 v15, 16, v254
    s_add_u32 s42, s42, 262144
    s_add_u32 s43, s43, 262144
    s_add_u32 s44, s44, 262144
    s_mov_b32 exec_hi, 0
    v_xor_b32 v244, 1024, v244
    s_mov_b32 exec_hi, -1
    s_waitcnt vmcnt(0)
    ds_read_b64_tr_b16 a[192:193], v242 offset:16384
    ds_read_b64_tr_b16 a[194:195], v242 offset:16896
    ds_read_b64_tr_b16 a[196:197], v242 offset:18432
    ds_read_b64_tr_b16 a[198:199], v242 offset:18944
    ds_read_b64_tr_b16 a[200:201], v242 offset:20480
    ds_read_b64_tr_b16 a[202:203], v242 offset:20992
    ds_read_b64_tr_b16 a[204:205], v242 offset:22528
    ds_read_b64_tr_b16 a[206:207], v242 offset:23040
    ds_read_b64_tr_b16 a[208:209], v242 offset:24576
    ds_read_b64_tr_b16 a[210:211], v242 offset:25088
    ds_read_b64_tr_b16 a[212:213], v242 offset:26624
    ds_read_b64_tr_b16 a[214:215], v242 offset:27136
    ds_read_b64_tr_b16 a[216:217], v242 offset:28672
    ds_read_b64_tr_b16 a[218:219], v242 offset:29184
    ds_read_b64_tr_b16 a[220:221], v242 offset:30720
    ds_read_b64_tr_b16 a[222:223], v242 offset:31232
    ds_read_b64_tr_b16 a[224:225], v243 offset:16384
    ds_read_b64_tr_b16 a[226:227], v243 offset:16896
    ds_read_b64_tr_b16 a[228:229], v243 offset:18432
    ds_read_b64_tr_b16 a[230:231], v243 offset:18944
    ds_read_b64_tr_b16 a[232:233], v243 offset:20480
    ds_read_b64_tr_b16 a[234:235], v243 offset:20992
    ds_read_b64_tr_b16 a[236:237], v243 offset:22528
    ds_read_b64_tr_b16 a[238:239], v243 offset:23040
    ds_read_b64_tr_b16 a[240:241], v243 offset:24576
    ds_read_b64_tr_b16 a[242:243], v243 offset:25088
    ds_read_b64_tr_b16 a[244:245], v243 offset:26624
    ds_read_b64_tr_b16 a[246:247], v243 offset:27136
    ds_read_b64_tr_b16 a[248:249], v243 offset:28672
    ds_read_b64_tr_b16 a[250:251], v243 offset:29184
    ds_read_b64_tr_b16 a[252:253], v243 offset:30720
    ds_read_b64_tr_b16 a[254:255], v243 offset:31232
    s_waitcnt lgkmcnt(0)
    s_barrier
.p2align 6
.step_243:
    s_barrier
    s_setprio 3
    buffer_load_dwordx4 v[24:27], v3, s[8:11], s30 offen offset:0 sc1
    s_setprio 2
    buffer_load_dwordx4 v[28:31], v3, s[8:11], s30 offen offset:1024 sc1
    s_setprio 1
    buffer_load_dwordx4 v[32:35], v3, s[8:11], s30 offen offset:2048 sc1
    s_setprio 0
    buffer_load_dwordx4 v[36:39], v3, s[8:11], s30 offen offset:3072 sc1
    s_call_b64 s[98:99], .gm_206
    v_pk_add_f32 v[40:41], v[40:41], v[42:43]
    v_pk_add_f32 v[42:43], v[44:45], v[46:47]
    ds_write2_b32 v5, v40, v41 offset0:0 offset1:36
    ds_write2_b32 v5, v42, v43 offset0:16 offset1:52
    s_nop 1
    v_pk_add_f32 v[48:49], v[48:49], v[50:51]
    v_pk_add_f32 v[50:51], v[52:53], v[54:55]
    ds_write2_b32 v6, v48, v49 offset0:0 offset1:36
    ds_write2_b32 v6, v50, v51 offset0:16 offset1:52
    s_waitcnt lgkmcnt(2)
    s_barrier
    s_waitcnt lgkmcnt(0)
    s_barrier
    v_smfmac_f32_16x16x64_bf16 v[56:59], v[24:27], a[128:135], v2
    v_smfmac_f32_16x16x64_bf16 v[60:63], v[24:27], a[160:167], v2
    v_smfmac_f32_16x16x64_bf16 v[56:59], v[28:31], a[136:143], v2
    v_smfmac_f32_16x16x64_bf16 v[60:63], v[28:31], a[168:175], v2
    v_smfmac_f32_16x16x64_bf16 v[56:59], v[32:35], a[144:151], v2
    v_smfmac_f32_16x16x64_bf16 v[60:63], v[32:35], a[176:183], v2
    v_smfmac_f32_16x16x64_bf16 v[56:59], v[36:39], a[152:159], v2
    v_smfmac_f32_16x16x64_bf16 v[60:63], v[36:39], a[184:191], v2
    ds_read_b64 v[72:73], v9 offset:0
    ds_read_b64 v[74:75], v9 offset:1152
    ds_read_b64 v[76:77], v9 offset:2304
    ds_read_b64 v[78:79], v9 offset:3456
    s_waitcnt lgkmcnt(0)
    v_pk_add_f32 v[72:73], v[72:73], v[74:75]
    v_pk_add_f32 v[76:77], v[76:77], v[78:79]
    v_pk_add_f32 v[72:73], v[72:73], v[76:77]
    v_cvt_pk_bf16_f32 v72, v72, v73
    ds_write_b32 v11, v72
    v_mov_b32 v40, 0
    v_mov_b32 v41, 0
    v_mov_b32 v42, 0
    v_mov_b32 v43, 0
    v_mov_b32 v44, 0
    v_mov_b32 v45, 0
    v_mov_b32 v46, 0
    v_mov_b32 v47, 0
    v_pk_add_f32 v[56:57], v[56:57], v[58:59]
    v_pk_add_f32 v[58:59], v[60:61], v[62:63]
    v_cvt_pk_bf16_f32 v60, v56, v57
    v_cvt_pk_bf16_f32 v61, v58, v59
    ds_write2_b32 v255, v60, v61 offset0:0 offset1:32
    ds_write_b128 v8, v[56:59]
    s_waitcnt lgkmcnt(0)
    s_barrier
    s_cmp_eq_u32 s28, 63
    s_cbranch_scc1 .fin_244
    s_add_u32 s37, s28, 0
    s_bitcmp1_b32 s37, 0
    s_cselect_b32 s4, 0x84000, 0
    s_xor_b32 s34, s35, s4
    s_bitcmp1_b32 s37, 1
    s_cselect_b32 s4, 0x101000, 0
    s_xor_b32 s34, s34, s4
    s_lshr_b32 s37, s37, 2
    s_bitcmp1_b32 s63, s37
    s_cselect_b32 s4, 0x2000, 0
    s_xor_b32 s34, s34, s4
    s_lshl_b32 s37, s37, 21
    s_add_u32 s34, s34, s37
    s_waitcnt lgkmcnt(0)
    v_mov_b32 v48, 0
    v_mov_b32 v49, 0
    v_mov_b32 v50, 0
    v_mov_b32 v51, 0
    v_mov_b32 v52, 0
    v_mov_b32 v53, 0
    v_mov_b32 v54, 0
    v_mov_b32 v55, 0
    v_mov_b32 v56, 0
    v_mov_b32 v57, 0
    v_mov_b32 v58, 0
    v_mov_b32 v59, 0
    v_mov_b32 v60, 0
    v_mov_b32 v61, 0
    v_mov_b32 v62, 0
    v_mov_b32 v63, 0
    s_barrier
    ds_read_b128 v[72:75], v12
    s_setprio 3
    buffer_load_dwordx4 v[24:27], v4, s[8:11], s30 offen offset:0 sc1
    s_setprio 2
    buffer_load_dwordx4 v[28:31], v4, s[8:11], s30 offen offset:1024 sc1
    s_setprio 1
    buffer_load_dwordx4 v[32:35], v4, s[8:11], s30 offen offset:2048 sc1
    s_setprio 0
    buffer_load_dwordx4 v[36:39], v4, s[8:11], s30 offen offset:3072 sc1
    s_call_b64 s[98:99], .gm_207
    s_waitcnt lgkmcnt(0)
    buffer_store_dwordx4 v[72:75], v244, s[8:11], s41 offen sc1
    s_nop 3
    v_pk_add_f32 v[64:65], v[64:65], v[66:67]
    v_cvt_pk_bf16_f32 v66, v64, v65
    v_pk_add_f32 v[68:69], v[68:69], v[70:71]
    v_cvt_pk_bf16_f32 v67, v68, v69
    v_min_u32 v67, 0xfffffffe, v67
    buffer_store_dwordx2 v[66:67], v168, s[8:11], s34 offen sc1
    ds_write2_b32 v7, v64, v65 offset0:0 offset1:36
    ds_write2_b32 v7, v68, v69 offset0:16 offset1:52
    s_waitcnt lgkmcnt(0)
    s_barrier
    s_cmp_lt_u32 s28, 52
    s_cselect_b32 s4, 1, 0
    s_andn2_b32 s4, s4, s28
    s_cbranch_scc1 .nl_245
    v_mov_b32 v18, s28
    v_add_u32 v18, 1, v18
    s_mov_b64 exec, 1
    s_waitcnt vmcnt(0)
    buffer_store_dword v18, v14, s[8:11], 0 offen sc1
    s_mov_b64 exec, -1
.nl_245:
    v_mov_b32 v64, 0
    v_mov_b32 v65, 0
    v_mov_b32 v66, 0
    v_mov_b32 v67, 0
    v_mov_b32 v68, 0
    v_mov_b32 v69, 0
    v_mov_b32 v70, 0
    v_mov_b32 v71, 0
    s_mov_b32 s4, s30
    s_mov_b32 s30, s31
    s_mov_b32 s31, s32
    s_mov_b32 s32, s33
    s_mov_b32 s33, s4
    s_add_u32 s28, s28, 1
    s_mov_b32 s62, 0
    s_add_u32 s41, s41, 0x20000
    s_branch .step_243
.fin_244:
    s_barrier
    s_endpgm
.w3_205:
    v_bfe_u32 v254, v1, 4, 1
    v_mul_u32_u24 v168, 1024, v254
    v_bfe_u32 v254, v1, 5, 1
    v_mul_u32_u24 v254, 128, v254
    v_add_u32 v168, v168, v254
    v_bfe_u32 v254, v1, 3, 1
    v_mul_u32_u24 v254, 64, v254
    v_add_u32 v168, v168, v254
    v_bfe_u32 v254, v1, 0, 2
    v_mul_u32_u24 v254, 16, v254
    v_add_u32 v168, v168, v254
    v_bfe_u32 v254, v1, 2, 1
    v_mul_u32_u24 v254, 8, v254
    v_add_u32 v168, v168, v254
    v_add_u32 v168, 768, v168
    v_add_u32 v168, s101, v168
    v_bfe_u32 v254, v1, 3, 1
    v_mul_u32_u24 v12, 8, v254
    v_bfe_u32 v254, v1, 5, 1
    v_mul_u32_u24 v254, 256, v254
    v_add_u32 v12, v12, v254
    v_bfe_u32 v254, v1, 2, 1
    v_mul_u32_u24 v254, 128, v254
    v_add_u32 v12, v12, v254
    v_bfe_u32 v254, v1, 0, 2
    v_mul_u32_u24 v254, 16, v254
    v_add_u32 v12, v12, v254
    v_bfe_u32 v254, v1, 4, 1
    v_mul_u32_u24 v254, 512, v254
    v_add_u32 v12, v12, v254
    v_add_u32 v12, 14080, v12
    v_bfe_u32 v254, v1, 2, 2
    v_mul_u32_u24 v14, 128, v254
    v_bfe_u32 v254, v1, 0, 2
    v_mul_u32_u24 v254, 16, v254
    v_add_u32 v14, v14, v254
    v_bfe_u32 v254, v1, 4, 2
    v_mul_u32_u24 v254, 4, v254
    v_add_u32 v14, v14, v254
    v_add_u32 v14, 18688, v14
    v_bfe_u32 v254, v1, 0, 6
    v_mul_u32_u24 v15, 16, v254
    v_add_u32 v15, s101, v15
    v_bfe_u32 v254, v1, 2, 2
    v_mul_u32_u24 v16, 128, v254
    v_bfe_u32 v254, v1, 0, 2
    v_mul_u32_u24 v254, 16, v254
    v_add_u32 v16, v16, v254
    v_bfe_u32 v254, v1, 4, 2
    v_mul_u32_u24 v254, 4, v254
    v_add_u32 v16, v16, v254
    v_add_u32 v16, 135168, v16
    v_add_u32 v16, s58, v16
    s_lshl_b32 s4, s56, 9
    s_add_u32 s4, s4, 92291072
    v_bfe_u32 v254, v1, 0, 2
    v_mul_u32_u24 v13, 128, v254
    v_bfe_u32 v254, v1, 2, 1
    v_mul_u32_u24 v254, 16384, v254
    v_add_u32 v13, v13, v254
    v_add_u32 v13, s4, v13
    s_lshl_b32 s4, s56, 9
    s_lshl_b32 s5, s53, 7
    s_add_u32 s4, s4, s5
    s_add_u32 s4, s4, 92274688
    v_mov_b32 v174, s4
    v_bfe_u32 v254, v1, 0, 6
    v_mul_u32_u24 v175, 16, v254
    v_add_u32 v175, 18176, v175
    s_mov_b32 exec_hi, 0
    v_xor_b32 v244, 1024, v244
    s_mov_b32 exec_hi, -1
    s_waitcnt vmcnt(0)
    ds_read_b64_tr_b16 a[192:193], v242 offset:16384
    ds_read_b64_tr_b16 a[194:195], v242 offset:16896
    ds_read_b64_tr_b16 a[196:197], v242 offset:18432
    ds_read_b64_tr_b16 a[198:199], v242 offset:18944
    ds_read_b64_tr_b16 a[200:201], v242 offset:20480
    ds_read_b64_tr_b16 a[202:203], v242 offset:20992
    ds_read_b64_tr_b16 a[204:205], v242 offset:22528
    ds_read_b64_tr_b16 a[206:207], v242 offset:23040
    ds_read_b64_tr_b16 a[208:209], v242 offset:24576
    ds_read_b64_tr_b16 a[210:211], v242 offset:25088
    ds_read_b64_tr_b16 a[212:213], v242 offset:26624
    ds_read_b64_tr_b16 a[214:215], v242 offset:27136
    ds_read_b64_tr_b16 a[216:217], v242 offset:28672
    ds_read_b64_tr_b16 a[218:219], v242 offset:29184
    ds_read_b64_tr_b16 a[220:221], v242 offset:30720
    ds_read_b64_tr_b16 a[222:223], v242 offset:31232
    ds_read_b64_tr_b16 a[224:225], v243 offset:16384
    ds_read_b64_tr_b16 a[226:227], v243 offset:16896
    ds_read_b64_tr_b16 a[228:229], v243 offset:18432
    ds_read_b64_tr_b16 a[230:231], v243 offset:18944
    ds_read_b64_tr_b16 a[232:233], v243 offset:20480
    ds_read_b64_tr_b16 a[234:235], v243 offset:20992
    ds_read_b64_tr_b16 a[236:237], v243 offset:22528
    ds_read_b64_tr_b16 a[238:239], v243 offset:23040
    ds_read_b64_tr_b16 a[240:241], v243 offset:24576
    ds_read_b64_tr_b16 a[242:243], v243 offset:25088
    ds_read_b64_tr_b16 a[244:245], v243 offset:26624
    ds_read_b64_tr_b16 a[246:247], v243 offset:27136
    ds_read_b64_tr_b16 a[248:249], v243 offset:28672
    ds_read_b64_tr_b16 a[250:251], v243 offset:29184
    ds_read_b64_tr_b16 a[252:253], v243 offset:30720
    ds_read_b64_tr_b16 a[254:255], v243 offset:31232
    s_waitcnt lgkmcnt(0)
    s_cmp_ge_u32 s46, 1
    s_cbranch_scc1 .kvd_247
    s_mov_b32 s62, 0
.kv_246:
    buffer_load_dword v18, v13, s[8:11], 0 offen sc1
    s_add_u32 s62, s62, 1
    s_cmp_gt_u32 s62, 0x100000
    s_cbranch_scc1 .mg_end_1
    s_waitcnt vmcnt(0)
    v_min_u32_dpp v18, v18, v18 quad_perm:[1,0,3,2] row_mask:0xf bank_mask:0xf
    s_nop 1
    v_min_u32_dpp v18, v18, v18 quad_perm:[2,3,0,1] row_mask:0xf bank_mask:0xf
    s_nop 1
    v_min_u32_dpp v18, v18, v18 row_half_mirror row_mask:0xf bank_mask:0xf
    s_nop 0
    v_readfirstlane_b32 s46, v18
    s_cmp_lt_u32 s46, 1
    s_cbranch_scc1 .kv_246
.kvd_247:
    s_barrier
.p2align 6
.step_248:
    s_barrier
    s_setprio 3
    buffer_load_dwordx4 v[24:27], v3, s[8:11], s30 offen offset:0 sc1
    s_setprio 2
    buffer_load_dwordx4 v[28:31], v3, s[8:11], s30 offen offset:1024 sc1
    s_setprio 1
    buffer_load_dwordx4 v[32:35], v3, s[8:11], s30 offen offset:2048 sc1
    s_setprio 0
    buffer_load_dwordx4 v[36:39], v3, s[8:11], s30 offen offset:3072 sc1
    s_call_b64 s[98:99], .gm_206
    v_pk_add_f32 v[40:41], v[40:41], v[42:43]
    v_pk_add_f32 v[42:43], v[44:45], v[46:47]
    ds_write2_b32 v5, v40, v41 offset0:0 offset1:36
    ds_write2_b32 v5, v42, v43 offset0:16 offset1:52
    s_nop 1
    v_pk_add_f32 v[48:49], v[48:49], v[50:51]
    v_pk_add_f32 v[50:51], v[52:53], v[54:55]
    ds_write2_b32 v6, v48, v49 offset0:0 offset1:36
    ds_write2_b32 v6, v50, v51 offset0:16 offset1:52
    s_waitcnt lgkmcnt(2)
    s_barrier
    s_waitcnt lgkmcnt(0)
    s_barrier
    v_smfmac_f32_16x16x64_bf16 v[56:59], v[24:27], a[128:135], v2
    v_smfmac_f32_16x16x64_bf16 v[60:63], v[24:27], a[160:167], v2
    v_smfmac_f32_16x16x64_bf16 v[56:59], v[28:31], a[136:143], v2
    v_smfmac_f32_16x16x64_bf16 v[60:63], v[28:31], a[168:175], v2
    v_smfmac_f32_16x16x64_bf16 v[56:59], v[32:35], a[144:151], v2
    v_smfmac_f32_16x16x64_bf16 v[60:63], v[32:35], a[176:183], v2
    v_smfmac_f32_16x16x64_bf16 v[56:59], v[36:39], a[152:159], v2
    v_smfmac_f32_16x16x64_bf16 v[60:63], v[36:39], a[184:191], v2
    ds_read_b64 v[72:73], v9 offset:0
    ds_read_b64 v[74:75], v9 offset:1152
    ds_read_b64 v[76:77], v9 offset:2304
    ds_read_b64 v[78:79], v9 offset:3456
    s_waitcnt lgkmcnt(0)
    v_pk_add_f32 v[72:73], v[72:73], v[74:75]
    v_pk_add_f32 v[76:77], v[76:77], v[78:79]
    v_pk_add_f32 v[72:73], v[72:73], v[76:77]
    v_cvt_pk_bf16_f32 v72, v72, v73
    ds_write_b32 v11, v72
    v_mov_b32 v40, 0
    v_mov_b32 v41, 0
    v_mov_b32 v42, 0
    v_mov_b32 v43, 0
    v_mov_b32 v44, 0
    v_mov_b32 v45, 0
    v_mov_b32 v46, 0
    v_mov_b32 v47, 0
    v_pk_add_f32 v[56:57], v[56:57], v[58:59]
    v_pk_add_f32 v[58:59], v[60:61], v[62:63]
    v_cvt_pk_bf16_f32 v60, v56, v57
    v_cvt_pk_bf16_f32 v61, v58, v59
    ds_write2_b32 v255, v60, v61 offset0:0 offset1:32
    ds_write_b128 v8, v[56:59]
    s_waitcnt lgkmcnt(0)
    s_barrier
    ds_read_b64 v[72:73], v12 offset:0
    ds_read_b64 v[74:75], v12 offset:1024
    ds_read_b64 v[76:77], v12 offset:2048
    ds_read_b64 v[78:79], v12 offset:3072
    ds_read_b64 v[80:81], v12 offset:64
    ds_read_b64 v[82:83], v12 offset:1088
    ds_read_b64 v[84:85], v12 offset:2112
    ds_read_b64 v[86:87], v12 offset:3136
    s_waitcnt lgkmcnt(4)
    v_add_f32 v72, v72, v74
    v_add_f32 v73, v73, v75
    v_add_f32 v76, v76, v78
    v_add_f32 v77, v77, v79
    v_add_f32 v72, v72, v76
    v_add_f32 v73, v73, v77
    v_cvt_pk_bf16_f32 v72, v72, v73
    s_waitcnt lgkmcnt(0)
    v_add_f32 v80, v80, v82
    v_add_f32 v81, v81, v83
    v_add_f32 v84, v84, v86
    v_add_f32 v85, v85, v87
    v_add_f32 v80, v80, v84
    v_add_f32 v81, v81, v85
    v_cvt_pk_bf16_f32 v80, v80, v81
    ds_write_b32 v14, v72
    ds_write_b32 v14, v80 offset:64
    s_waitcnt lgkmcnt(0)
    s_cmp_ge_u32 s28, 62
    s_cbranch_scc1 .ke_250
.kb_251:
    s_cmp_eq_u32 s28, 63
    s_cbranch_scc1 .fin_249
    s_add_u32 s37, s28, 0
    s_bitcmp1_b32 s37, 0
    s_cselect_b32 s4, 0x84000, 0
    s_xor_b32 s34, s35, s4
    s_bitcmp1_b32 s37, 1
    s_cselect_b32 s4, 0x101000, 0
    s_xor_b32 s34, s34, s4
    s_lshr_b32 s37, s37, 2
    s_bitcmp1_b32 s63, s37
    s_cselect_b32 s4, 0x2000, 0
    s_xor_b32 s34, s34, s4
    s_lshl_b32 s37, s37, 21
    s_add_u32 s34, s34, s37
    buffer_store_dwordx4 v[20:23], v246, s[8:11], s32 offen sc1
    buffer_store_dwordx4 v[20:23], v245, s[8:11], s32 offen sc1
    buffer_store_dword v20, v237, s[8:11], s32 offen sc1
    s_add_u32 s5, s28, 2
    s_cmp_ge_u32 s46, s5
    s_cbranch_scc1 .kvd_255
    s_mov_b32 s62, 0
.kv_254:
    buffer_load_dword v18, v13, s[8:11], 0 offen sc1
    s_add_u32 s62, s62, 1
    s_cmp_gt_u32 s62, 0x100000
    s_cbranch_scc1 .mg_end_1
    s_waitcnt vmcnt(0)
    v_min_u32_dpp v18, v18, v18 quad_perm:[1,0,3,2] row_mask:0xf bank_mask:0xf
    s_nop 1
    v_min_u32_dpp v18, v18, v18 quad_perm:[2,3,0,1] row_mask:0xf bank_mask:0xf
    s_nop 1
    v_min_u32_dpp v18, v18, v18 row_half_mirror row_mask:0xf bank_mask:0xf
    s_nop 0
    v_readfirstlane_b32 s46, v18
    s_cmp_lt_u32 s46, s5
    s_cbranch_scc1 .kv_254
.kvd_255:
    v_mov_b32 v48, 0
    v_mov_b32 v49, 0
    v_mov_b32 v50, 0
    v_mov_b32 v51, 0
    v_mov_b32 v52, 0
    v_mov_b32 v53, 0
    v_mov_b32 v54, 0
    v_mov_b32 v55, 0
    v_mov_b32 v56, 0
    v_mov_b32 v57, 0
    v_mov_b32 v58, 0
    v_mov_b32 v59, 0
    v_mov_b32 v60, 0
    v_mov_b32 v61, 0
    v_mov_b32 v62, 0
    v_mov_b32 v63, 0
    s_cmp_ge_u32 s28, 62
    s_cbranch_scc1 .kf_252
.kg_253:
    s_barrier
    s_setprio 3
    buffer_load_dwordx4 v[24:27], v4, s[8:11], s30 offen offset:0 sc1
    s_setprio 2
    buffer_load_dwordx4 v[28:31], v4, s[8:11], s30 offen offset:1024 sc1
    s_setprio 1
    buffer_load_dwordx4 v[32:35], v4, s[8:11], s30 offen offset:2048 sc1
    s_setprio 0
    buffer_load_dwordx4 v[36:39], v4, s[8:11], s30 offen offset:3072 sc1
    s_call_b64 s[98:99], .gm_207
    s_nop 4
    v_pk_add_f32 v[64:65], v[64:65], v[66:67]
    v_cvt_pk_bf16_f32 v66, v64, v65
    v_pk_add_f32 v[68:69], v[68:69], v[70:71]
    v_cvt_pk_bf16_f32 v67, v68, v69
    v_min_u32 v67, 0xfffffffe, v67
    buffer_store_dwordx2 v[66:67], v168, s[8:11], s34 offen sc1
    ds_write2_b32 v7, v64, v65 offset0:0 offset1:36
    ds_write2_b32 v7, v68, v69 offset0:16 offset1:52
    s_waitcnt lgkmcnt(0)
    s_barrier
    s_add_u32 s5, s28, 3
    s_min_u32 s5, s5, 64
    s_cmp_ge_u32 s46, s5
    s_cbranch_scc1 .kvd_257
    s_mov_b32 s62, 0
.kv_256:
    buffer_load_dword v18, v13, s[8:11], 0 offen sc1
    s_add_u32 s62, s62, 1
    s_cmp_gt_u32 s62, 0x100000
    s_cbranch_scc1 .mg_end_1
    s_waitcnt vmcnt(0)
    v_min_u32_dpp v18, v18, v18 quad_perm:[1,0,3,2] row_mask:0xf bank_mask:0xf
    s_nop 1
    v_min_u32_dpp v18, v18, v18 quad_perm:[2,3,0,1] row_mask:0xf bank_mask:0xf
    s_nop 1
    v_min_u32_dpp v18, v18, v18 row_half_mirror row_mask:0xf bank_mask:0xf
    s_nop 0
    v_readfirstlane_b32 s46, v18
.kvd_257:
    v_mov_b32 v64, 0
    v_mov_b32 v65, 0
    v_mov_b32 v66, 0
    v_mov_b32 v67, 0
    v_mov_b32 v68, 0
    v_mov_b32 v69, 0
    v_mov_b32 v70, 0
    v_mov_b32 v71, 0
    s_mov_b32 s4, s30
    s_mov_b32 s30, s31
    s_mov_b32 s31, s32
    s_mov_b32 s32, s33
    s_mov_b32 s33, s4
    s_add_u32 s28, s28, 1
    s_mov_b32 s62, 0
    s_add_u32 s41, s41, 0x20000
    s_branch .step_248
.fin_249:
    s_barrier
    s_add_u32 s4, s28, 1
    v_mov_b32 v18, s4
    s_mov_b64 exec, 1
    s_waitcnt vmcnt(0)
    buffer_store_dword v18, v174, s[8:11], 0 offen sc1
    s_mov_b64 exec, -1
    s_endpgm
.ke_250:
    ds_read_b128 v[72:75], v175
    s_waitcnt lgkmcnt(0)
    buffer_store_dwordx4 v[72:75], v244, s[8:11], s41 offen sc1
    s_branch .kb_251
.kf_252:
    s_add_u32 s4, s28, 1
    v_mov_b32 v18, s4
    s_mov_b64 exec, 1
    s_waitcnt vmcnt(0)
    buffer_store_dword v18, v174, s[8:11], 0 offen sc1
    s_mov_b64 exec, -1
    s_branch .kg_253
.p2align 6
.gm_206:
    s_waitcnt vmcnt(3)
    v_max_u32 v18, v25, v27
    v_cmp_eq_u32 vcc, -1, v18
    s_cbranch_vccnz .nk_258
.ok_259:
    v_smfmac_f32_16x16x64_bf16 v[40:43], v[24:27], a[0:7], v2
    v_smfmac_f32_16x16x64_bf16 v[44:47], v[24:27], a[32:39], v2
    s_waitcnt vmcnt(2)
    v_max_u32 v18, v29, v31
    v_cmp_eq_u32 vcc, -1, v18
    v_smfmac_f32_16x16x64_bf16 v[48:51], v[24:27], a[64:71], v2
    v_smfmac_f32_16x16x64_bf16 v[52:55], v[24:27], a[96:103], v2
    s_cbranch_vccnz .nk_260
.ok_261:
    v_smfmac_f32_16x16x64_bf16 v[40:43], v[28:31], a[8:15], v2
    v_smfmac_f32_16x16x64_bf16 v[44:47], v[28:31], a[40:47], v2
    s_waitcnt vmcnt(1)
    v_max_u32 v18, v33, v35
    v_cmp_eq_u32 vcc, -1, v18
    v_smfmac_f32_16x16x64_bf16 v[48:51], v[28:31], a[72:79], v2
    v_smfmac_f32_16x16x64_bf16 v[52:55], v[28:31], a[104:111], v2
    s_cbranch_vccnz .nk_262
.ok_263:
    v_smfmac_f32_16x16x64_bf16 v[40:43], v[32:35], a[16:23], v2
    v_smfmac_f32_16x16x64_bf16 v[44:47], v[32:35], a[48:55], v2
    s_waitcnt vmcnt(0)
    v_max_u32 v18, v37, v39
    v_cmp_eq_u32 vcc, -1, v18
    v_smfmac_f32_16x16x64_bf16 v[48:51], v[32:35], a[80:87], v2
    v_smfmac_f32_16x16x64_bf16 v[52:55], v[32:35], a[112:119], v2
    s_cbranch_vccnz .nk_264
.ok_265:
    v_smfmac_f32_16x16x64_bf16 v[40:43], v[36:39], a[24:31], v2
    v_smfmac_f32_16x16x64_bf16 v[44:47], v[36:39], a[56:63], v2
    v_smfmac_f32_16x16x64_bf16 v[48:51], v[36:39], a[88:95], v2
    v_smfmac_f32_16x16x64_bf16 v[52:55], v[36:39], a[120:127], v2
    s_setpc_b64 s[98:99]
.nk_258:
    buffer_load_dwordx4 v[24:27], v3, s[8:11], s30 offen offset:0 sc1
    s_add_u32 s62, s62, 1
    s_cmp_gt_u32 s62, 0x100000
    s_cbranch_scc1 .mg_end_1
    s_waitcnt vmcnt(3)
    v_max_u32 v18, v29, v31
    v_cmp_eq_u32 vcc, -1, v18
    s_cbranch_vccnz .nk_266
.ok_267:
    v_smfmac_f32_16x16x64_bf16 v[40:43], v[28:31], a[8:15], v2
    v_smfmac_f32_16x16x64_bf16 v[44:47], v[28:31], a[40:47], v2
    s_waitcnt vmcnt(2)
    v_max_u32 v18, v33, v35
    v_cmp_eq_u32 vcc, -1, v18
    v_smfmac_f32_16x16x64_bf16 v[48:51], v[28:31], a[72:79], v2
    v_smfmac_f32_16x16x64_bf16 v[52:55], v[28:31], a[104:111], v2
    s_cbranch_vccnz .nk_268
.ok_269:
    v_smfmac_f32_16x16x64_bf16 v[40:43], v[32:35], a[16:23], v2
    v_smfmac_f32_16x16x64_bf16 v[44:47], v[32:35], a[48:55], v2
    s_waitcnt vmcnt(1)
    v_max_u32 v18, v37, v39
    v_cmp_eq_u32 vcc, -1, v18
    v_smfmac_f32_16x16x64_bf16 v[48:51], v[32:35], a[80:87], v2
    v_smfmac_f32_16x16x64_bf16 v[52:55], v[32:35], a[112:119], v2
    s_cbranch_vccnz .nk_270
.ok_271:
    v_smfmac_f32_16x16x64_bf16 v[40:43], v[36:39], a[24:31], v2
    v_smfmac_f32_16x16x64_bf16 v[44:47], v[36:39], a[56:63], v2
    s_waitcnt vmcnt(0)
    v_max_u32 v18, v25, v27
    v_cmp_eq_u32 vcc, -1, v18
    v_smfmac_f32_16x16x64_bf16 v[48:51], v[36:39], a[88:95], v2
    v_smfmac_f32_16x16x64_bf16 v[52:55], v[36:39], a[120:127], v2
    s_cbranch_vccnz .nk_272
.ok_273:
    v_smfmac_f32_16x16x64_bf16 v[40:43], v[24:27], a[0:7], v2
    v_smfmac_f32_16x16x64_bf16 v[44:47], v[24:27], a[32:39], v2
    v_smfmac_f32_16x16x64_bf16 v[48:51], v[24:27], a[64:71], v2
    v_smfmac_f32_16x16x64_bf16 v[52:55], v[24:27], a[96:103], v2
    s_setpc_b64 s[98:99]
.nk_260:
    buffer_load_dwordx4 v[28:31], v3, s[8:11], s30 offen offset:1024 sc1
    s_add_u32 s62, s62, 1
    s_cmp_gt_u32 s62, 0x100000
    s_cbranch_scc1 .mg_end_1
    s_waitcnt vmcnt(2)
    v_max_u32 v18, v33, v35
    v_cmp_eq_u32 vcc, -1, v18
    s_cbranch_vccnz .nk_274
.ok_275:
    v_smfmac_f32_16x16x64_bf16 v[40:43], v[32:35], a[16:23], v2
    v_smfmac_f32_16x16x64_bf16 v[44:47], v[32:35], a[48:55], v2
    s_waitcnt vmcnt(1)
    v_max_u32 v18, v37, v39
    v_cmp_eq_u32 vcc, -1, v18
    v_smfmac_f32_16x16x64_bf16 v[48:51], v[32:35], a[80:87], v2
    v_smfmac_f32_16x16x64_bf16 v[52:55], v[32:35], a[112:119], v2
    s_cbranch_vccnz .nk_276
.ok_277:
    v_smfmac_f32_16x16x64_bf16 v[40:43], v[36:39], a[24:31], v2
    v_smfmac_f32_16x16x64_bf16 v[44:47], v[36:39], a[56:63], v2
    s_waitcnt vmcnt(0)
    v_max_u32 v18, v29, v31
    v_cmp_eq_u32 vcc, -1, v18
    v_smfmac_f32_16x16x64_bf16 v[48:51], v[36:39], a[88:95], v2
    v_smfmac_f32_16x16x64_bf16 v[52:55], v[36:39], a[120:127], v2
    s_cbranch_vccnz .nk_278
.ok_279:
    v_smfmac_f32_16x16x64_bf16 v[40:43], v[28:31], a[8:15], v2
    v_smfmac_f32_16x16x64_bf16 v[44:47], v[28:31], a[40:47], v2
    v_smfmac_f32_16x16x64_bf16 v[48:51], v[28:31], a[72:79], v2
    v_smfmac_f32_16x16x64_bf16 v[52:55], v[28:31], a[104:111], v2
    s_setpc_b64 s[98:99]
.nk_262:
    buffer_load_dwordx4 v[32:35], v3, s[8:11], s30 offen offset:2048 sc1
    s_add_u32 s62, s62, 1
    s_cmp_gt_u32 s62, 0x100000
    s_cbranch_scc1 .mg_end_1
    s_waitcnt vmcnt(1)
    v_max_u32 v18, v37, v39
    v_cmp_eq_u32 vcc, -1, v18
    s_cbranch_vccnz .nk_280
.ok_281:
    v_smfmac_f32_16x16x64_bf16 v[40:43], v[36:39], a[24:31], v2
    v_smfmac_f32_16x16x64_bf16 v[44:47], v[36:39], a[56:63], v2
    s_waitcnt vmcnt(0)
    v_max_u32 v18, v33, v35
    v_cmp_eq_u32 vcc, -1, v18
    v_smfmac_f32_16x16x64_bf16 v[48:51], v[36:39], a[88:95], v2
    v_smfmac_f32_16x16x64_bf16 v[52:55], v[36:39], a[120:127], v2
    s_cbranch_vccnz .nk_282
.ok_283:
    v_smfmac_f32_16x16x64_bf16 v[40:43], v[32:35], a[16:23], v2
    v_smfmac_f32_16x16x64_bf16 v[44:47], v[32:35], a[48:55], v2
    v_smfmac_f32_16x16x64_bf16 v[48:51], v[32:35], a[80:87], v2
    v_smfmac_f32_16x16x64_bf16 v[52:55], v[32:35], a[112:119], v2
    s_setpc_b64 s[98:99]
.nk_264:
    buffer_load_dwordx4 v[36:39], v3, s[8:11], s30 offen offset:3072 sc1
    s_add_u32 s62, s62, 1
    s_cmp_gt_u32 s62, 0x100000
    s_cbranch_scc1 .mg_end_1
    s_waitcnt vmcnt(0)
    v_max_u32 v18, v37, v39
    v_cmp_eq_u32 vcc, -1, v18
    s_cbranch_vccnz .nk_264
    s_branch .ok_265
.nk_266:
    buffer_load_dwordx4 v[28:31], v3, s[8:11], s30 offen offset:1024 sc1
    s_add_u32 s62, s62, 1
    s_cmp_gt_u32 s62, 0x100000
    s_cbranch_scc1 .mg_end_1
    s_waitcnt vmcnt(3)
    v_max_u32 v18, v33, v35
    v_cmp_eq_u32 vcc, -1, v18
    s_cbranch_vccnz .nk_284
.ok_285:
    v_smfmac_f32_16x16x64_bf16 v[40:43], v[32:35], a[16:23], v2
    v_smfmac_f32_16x16x64_bf16 v[44:47], v[32:35], a[48:55], v2
    s_waitcnt vmcnt(2)
    v_max_u32 v18, v37, v39
    v_cmp_eq_u32 vcc, -1, v18
    v_smfmac_f32_16x16x64_bf16 v[48:51], v[32:35], a[80:87], v2
    v_smfmac_f32_16x16x64_bf16 v[52:55], v[32:35], a[112:119], v2
    s_cbranch_vccnz .nk_286
.ok_287:
    v_smfmac_f32_16x16x64_bf16 v[40:43], v[36:39], a[24:31], v2
    v_smfmac_f32_16x16x64_bf16 v[44:47], v[36:39], a[56:63], v2
    s_waitcnt vmcnt(1)
    v_max_u32 v18, v25, v27
    v_cmp_eq_u32 vcc, -1, v18
    v_smfmac_f32_16x16x64_bf16 v[48:51], v[36:39], a[88:95], v2
    v_smfmac_f32_16x16x64_bf16 v[52:55], v[36:39], a[120:127], v2
    s_cbranch_vccnz .nk_288
.ok_289:
    v_smfmac_f32_16x16x64_bf16 v[40:43], v[24:27], a[0:7], v2
    v_smfmac_f32_16x16x64_bf16 v[44:47], v[24:27], a[32:39], v2
    s_waitcnt vmcnt(0)
    v_max_u32 v18, v29, v31
    v_cmp_eq_u32 vcc, -1, v18
    v_smfmac_f32_16x16x64_bf16 v[48:51], v[24:27], a[64:71], v2
    v_smfmac_f32_16x16x64_bf16 v[52:55], v[24:27], a[96:103], v2
    s_cbranch_vccnz .nk_278
    s_branch .ok_279
.nk_268:
    buffer_load_dwordx4 v[32:35], v3, s[8:11], s30 offen offset:2048 sc1
    s_add_u32 s62, s62, 1
    s_cmp_gt_u32 s62, 0x100000
    s_cbranch_scc1 .mg_end_1
    s_waitcnt vmcnt(2)
    v_max_u32 v18, v37, v39
    v_cmp_eq_u32 vcc, -1, v18
    s_cbranch_vccnz .nk_290
.ok_291:
    v_smfmac_f32_16x16x64_bf16 v[40:43], v[36:39], a[24:31], v2
    v_smfmac_f32_16x16x64_bf16 v[44:47], v[36:39], a[56:63], v2
    s_waitcnt vmcnt(1)
    v_max_u32 v18, v25, v27
    v_cmp_eq_u32 vcc, -1, v18
    v_smfmac_f32_16x16x64_bf16 v[48:51], v[36:39], a[88:95], v2
    v_smfmac_f32_16x16x64_bf16 v[52:55], v[36:39], a[120:127], v2
    s_cbranch_vccnz .nk_292
.ok_293:
    v_smfmac_f32_16x16x64_bf16 v[40:43], v[24:27], a[0:7], v2
    v_smfmac_f32_16x16x64_bf16 v[44:47], v[24:27], a[32:39], v2
    s_waitcnt vmcnt(0)
    v_max_u32 v18, v33, v35
    v_cmp_eq_u32 vcc, -1, v18
    v_smfmac_f32_16x16x64_bf16 v[48:51], v[24:27], a[64:71], v2
    v_smfmac_f32_16x16x64_bf16 v[52:55], v[24:27], a[96:103], v2
    s_cbranch_vccnz .nk_282
    s_branch .ok_283
.nk_270:
    buffer_load_dwordx4 v[36:39], v3, s[8:11], s30 offen offset:3072 sc1
    s_add_u32 s62, s62, 1
    s_cmp_gt_u32 s62, 0x100000
    s_cbranch_scc1 .mg_end_1
    s_waitcnt vmcnt(1)
    v_max_u32 v18, v25, v27
    v_cmp_eq_u32 vcc, -1, v18
    s_cbranch_vccnz .nk_294
.ok_295:
    v_smfmac_f32_16x16x64_bf16 v[40:43], v[24:27], a[0:7], v2
    v_smfmac_f32_16x16x64_bf16 v[44:47], v[24:27], a[32:39], v2
    s_waitcnt vmcnt(0)
    v_max_u32 v18, v37, v39
    v_cmp_eq_u32 vcc, -1, v18
    v_smfmac_f32_16x16x64_bf16 v[48:51], v[24:27], a[64:71], v2
    v_smfmac_f32_16x16x64_bf16 v[52:55], v[24:27], a[96:103], v2
    s_cbranch_vccnz .nk_264
    s_branch .ok_265
.nk_272:
    buffer_load_dwordx4 v[24:27], v3, s[8:11], s30 offen offset:0 sc1
    s_add_u32 s62, s62, 1
    s_cmp_gt_u32 s62, 0x100000
    s_cbranch_scc1 .mg_end_1
    s_waitcnt vmcnt(0)
    v_max_u32 v18, v25, v27
    v_cmp_eq_u32 vcc, -1, v18
    s_cbranch_vccnz .nk_272
    s_branch .ok_273
.nk_274:
    buffer_load_dwordx4 v[32:35], v3, s[8:11], s30 offen offset:2048 sc1
    s_add_u32 s62, s62, 1
    s_cmp_gt_u32 s62, 0x100000
    s_cbranch_scc1 .mg_end_1
    s_waitcnt vmcnt(2)
    v_max_u32 v18, v37, v39
    v_cmp_eq_u32 vcc, -1, v18
    s_cbranch_vccnz .nk_296
.ok_297:
    v_smfmac_f32_16x16x64_bf16 v[40:43], v[36:39], a[24:31], v2
    v_smfmac_f32_16x16x64_bf16 v[44:47], v[36:39], a[56:63], v2
    s_waitcnt vmcnt(1)
    v_max_u32 v18, v29, v31
    v_cmp_eq_u32 vcc, -1, v18
    v_smfmac_f32_16x16x64_bf16 v[48:51], v[36:39], a[88:95], v2
    v_smfmac_f32_16x16x64_bf16 v[52:55], v[36:39], a[120:127], v2
    s_cbranch_vccnz .nk_298
.ok_299:
    v_smfmac_f32_16x16x64_bf16 v[40:43], v[28:31], a[8:15], v2
    v_smfmac_f32_16x16x64_bf16 v[44:47], v[28:31], a[40:47], v2
    s_waitcnt vmcnt(0)
    v_max_u32 v18, v33, v35
    v_cmp_eq_u32 vcc, -1, v18
    v_smfmac_f32_16x16x64_bf16 v[48:51], v[28:31], a[72:79], v2
    v_smfmac_f32_16x16x64_bf16 v[52:55], v[28:31], a[104:111], v2
    s_cbranch_vccnz .nk_282
    s_branch .ok_283
.nk_276:
    buffer_load_dwordx4 v[36:39], v3, s[8:11], s30 offen offset:3072 sc1
    s_add_u32 s62, s62, 1
    s_cmp_gt_u32 s62, 0x100000
    s_cbranch_scc1 .mg_end_1
    s_waitcnt vmcnt(1)
    v_max_u32 v18, v29, v31
    v_cmp_eq_u32 vcc, -1, v18
    s_cbranch_vccnz .nk_300
.ok_301:
    v_smfmac_f32_16x16x64_bf16 v[40:43], v[28:31], a[8:15], v2
    v_smfmac_f32_16x16x64_bf16 v[44:47], v[28:31], a[40:47], v2
    s_waitcnt vmcnt(0)
    v_max_u32 v18, v37, v39
    v_cmp_eq_u32 vcc, -1, v18
    v_smfmac_f32_16x16x64_bf16 v[48:51], v[28:31], a[72:79], v2
    v_smfmac_f32_16x16x64_bf16 v[52:55], v[28:31], a[104:111], v2
    s_cbranch_vccnz .nk_264
    s_branch .ok_265
.nk_278:
    buffer_load_dwordx4 v[28:31], v3, s[8:11], s30 offen offset:1024 sc1
    s_add_u32 s62, s62, 1
    s_cmp_gt_u32 s62, 0x100000
    s_cbranch_scc1 .mg_end_1
    s_waitcnt vmcnt(0)
    v_max_u32 v18, v29, v31
    v_cmp_eq_u32 vcc, -1, v18
    s_cbranch_vccnz .nk_278
    s_branch .ok_279
.nk_280:
    buffer_load_dwordx4 v[36:39], v3, s[8:11], s30 offen offset:3072 sc1
    s_add_u32 s62, s62, 1
    s_cmp_gt_u32 s62, 0x100000
    s_cbranch_scc1 .mg_end_1
    s_waitcnt vmcnt(1)
    v_max_u32 v18, v33, v35
    v_cmp_eq_u32 vcc, -1, v18
    s_cbranch_vccnz .nk_262
    s_branch .ok_263
.nk_282:
    buffer_load_dwordx4 v[32:35], v3, s[8:11], s30 offen offset:2048 sc1
    s_add_u32 s62, s62, 1
    s_cmp_gt_u32 s62, 0x100000
    s_cbranch_scc1 .mg_end_1
    s_waitcnt vmcnt(0)
    v_max_u32 v18, v33, v35
    v_cmp_eq_u32 vcc, -1, v18
    s_cbranch_vccnz .nk_282
    s_branch .ok_283
.nk_284:
    buffer_load_dwordx4 v[32:35], v3, s[8:11], s30 offen offset:2048 sc1
    s_add_u32 s62, s62, 1
    s_cmp_gt_u32 s62, 0x100000
    s_cbranch_scc1 .mg_end_1
    s_waitcnt vmcnt(3)
    v_max_u32 v18, v37, v39
    v_cmp_eq_u32 vcc, -1, v18
    s_cbranch_vccnz .nk_302
.ok_303:
    v_smfmac_f32_16x16x64_bf16 v[40:43], v[36:39], a[24:31], v2
    v_smfmac_f32_16x16x64_bf16 v[44:47], v[36:39], a[56:63], v2
    s_waitcnt vmcnt(2)
    v_max_u32 v18, v25, v27
    v_cmp_eq_u32 vcc, -1, v18
    v_smfmac_f32_16x16x64_bf16 v[48:51], v[36:39], a[88:95], v2
    v_smfmac_f32_16x16x64_bf16 v[52:55], v[36:39], a[120:127], v2
    s_cbranch_vccnz .nk_304
.ok_305:
    v_smfmac_f32_16x16x64_bf16 v[40:43], v[24:27], a[0:7], v2
    v_smfmac_f32_16x16x64_bf16 v[44:47], v[24:27], a[32:39], v2
    s_waitcnt vmcnt(1)
    v_max_u32 v18, v29, v31
    v_cmp_eq_u32 vcc, -1, v18
    v_smfmac_f32_16x16x64_bf16 v[48:51], v[24:27], a[64:71], v2
    v_smfmac_f32_16x16x64_bf16 v[52:55], v[24:27], a[96:103], v2
    s_cbranch_vccnz .nk_298
    s_branch .ok_299
.nk_286:
    buffer_load_dwordx4 v[36:39], v3, s[8:11], s30 offen offset:3072 sc1
    s_add_u32 s62, s62, 1
    s_cmp_gt_u32 s62, 0x100000
    s_cbranch_scc1 .mg_end_1
    s_waitcnt vmcnt(2)
    v_max_u32 v18, v25, v27
    v_cmp_eq_u32 vcc, -1, v18
    s_cbranch_vccnz .nk_306
.ok_307:
    v_smfmac_f32_16x16x64_bf16 v[40:43], v[24:27], a[0:7], v2
    v_smfmac_f32_16x16x64_bf16 v[44:47], v[24:27], a[32:39], v2
    s_waitcnt vmcnt(1)
    v_max_u32 v18, v29, v31
    v_cmp_eq_u32 vcc, -1, v18
    v_smfmac_f32_16x16x64_bf16 v[48:51], v[24:27], a[64:71], v2
    v_smfmac_f32_16x16x64_bf16 v[52:55], v[24:27], a[96:103], v2
    s_cbranch_vccnz .nk_300
    s_branch .ok_301
.nk_288:
    buffer_load_dwordx4 v[24:27], v3, s[8:11], s30 offen offset:0 sc1
    s_add_u32 s62, s62, 1
    s_cmp_gt_u32 s62, 0x100000
    s_cbranch_scc1 .mg_end_1
    s_waitcnt vmcnt(1)
    v_max_u32 v18, v29, v31
    v_cmp_eq_u32 vcc, -1, v18
    s_cbranch_vccnz .nk_308
.ok_309:
    v_smfmac_f32_16x16x64_bf16 v[40:43], v[28:31], a[8:15], v2
    v_smfmac_f32_16x16x64_bf16 v[44:47], v[28:31], a[40:47], v2
    s_waitcnt vmcnt(0)
    v_max_u32 v18, v25, v27
    v_cmp_eq_u32 vcc, -1, v18
    v_smfmac_f32_16x16x64_bf16 v[48:51], v[28:31], a[72:79], v2
    v_smfmac_f32_16x16x64_bf16 v[52:55], v[28:31], a[104:111], v2
    s_cbranch_vccnz .nk_272
    s_branch .ok_273
.nk_290:
    buffer_load_dwordx4 v[36:39], v3, s[8:11], s30 offen offset:3072 sc1
    s_add_u32 s62, s62, 1
    s_cmp_gt_u32 s62, 0x100000
    s_cbranch_scc1 .mg_end_1
    s_waitcnt vmcnt(2)
    v_max_u32 v18, v25, v27
    v_cmp_eq_u32 vcc, -1, v18
    s_cbranch_vccnz .nk_310
.ok_311:
    v_smfmac_f32_16x16x64_bf16 v[40:43], v[24:27], a[0:7], v2
    v_smfmac_f32_16x16x64_bf16 v[44:47], v[24:27], a[32:39], v2
    s_waitcnt vmcnt(1)
    v_max_u32 v18, v33, v35
    v_cmp_eq_u32 vcc, -1, v18
    v_smfmac_f32_16x16x64_bf16 v[48:51], v[24:27], a[64:71], v2
    v_smfmac_f32_16x16x64_bf16 v[52:55], v[24:27], a[96:103], v2
    s_cbranch_vccnz .nk_262
    s_branch .ok_263
.nk_292:
    buffer_load_dwordx4 v[24:27], v3, s[8:11], s30 offen offset:0 sc1
    s_add_u32 s62, s62, 1
    s_cmp_gt_u32 s62, 0x100000
    s_cbranch_scc1 .mg_end_1
    s_waitcnt vmcnt(1)
    v_max_u32 v18, v33, v35
    v_cmp_eq_u32 vcc, -1, v18
    s_cbranch_vccnz .nk_312
.ok_313:
    v_smfmac_f32_16x16x64_bf16 v[40:43], v[32:35], a[16:23], v2
    v_smfmac_f32_16x16x64_bf16 v[44:47], v[32:35], a[48:55], v2
    s_waitcnt vmcnt(0)
    v_max_u32 v18, v25, v27
    v_cmp_eq_u32 vcc, -1, v18
    v_smfmac_f32_16x16x64_bf16 v[48:51], v[32:35], a[80:87], v2
    v_smfmac_f32_16x16x64_bf16 v[52:55], v[32:35], a[112:119], v2
    s_cbranch_vccnz .nk_272
    s_branch .ok_273
.nk_294:
    buffer_load_dwordx4 v[24:27], v3, s[8:11], s30 offen offset:0 sc1
    s_add_u32 s62, s62, 1
    s_cmp_gt_u32 s62, 0x100000
    s_cbranch_scc1 .mg_end_1
    s_waitcnt vmcnt(1)
    v_max_u32 v18, v37, v39
    v_cmp_eq_u32 vcc, -1, v18
    s_cbranch_vccnz .nk_270
    s_branch .ok_271
.nk_296:
    buffer_load_dwordx4 v[36:39], v3, s[8:11], s30 offen offset:3072 sc1
    s_add_u32 s62, s62, 1
    s_cmp_gt_u32 s62, 0x100000
    s_cbranch_scc1 .mg_end_1
    s_waitcnt vmcnt(2)
    v_max_u32 v18, v29, v31
    v_cmp_eq_u32 vcc, -1, v18
    s_cbranch_vccnz .nk_260
    s_branch .ok_261
.nk_298:
    buffer_load_dwordx4 v[28:31], v3, s[8:11], s30 offen offset:1024 sc1
    s_add_u32 s62, s62, 1
    s_cmp_gt_u32 s62, 0x100000
    s_cbranch_scc1 .mg_end_1
    s_waitcnt vmcnt(1)
    v_max_u32 v18, v33, v35
    v_cmp_eq_u32 vcc, -1, v18
    s_cbranch_vccnz .nk_314
.ok_315:
    v_smfmac_f32_16x16x64_bf16 v[40:43], v[32:35], a[16:23], v2
    v_smfmac_f32_16x16x64_bf16 v[44:47], v[32:35], a[48:55], v2
    s_waitcnt vmcnt(0)
    v_max_u32 v18, v29, v31
    v_cmp_eq_u32 vcc, -1, v18
    v_smfmac_f32_16x16x64_bf16 v[48:51], v[32:35], a[80:87], v2
    v_smfmac_f32_16x16x64_bf16 v[52:55], v[32:35], a[112:119], v2
    s_cbranch_vccnz .nk_278
    s_branch .ok_279
.nk_300:
    buffer_load_dwordx4 v[28:31], v3, s[8:11], s30 offen offset:1024 sc1
    s_add_u32 s62, s62, 1
    s_cmp_gt_u32 s62, 0x100000
    s_cbranch_scc1 .mg_end_1
    s_waitcnt vmcnt(1)
    v_max_u32 v18, v37, v39
    v_cmp_eq_u32 vcc, -1, v18
    s_cbranch_vccnz .nk_276
    s_branch .ok_277
.nk_302:
    buffer_load_dwordx4 v[36:39], v3, s[8:11], s30 offen offset:3072 sc1
    s_add_u32 s62, s62, 1
    s_cmp_gt_u32 s62, 0x100000
    s_cbranch_scc1 .mg_end_1
    s_waitcnt vmcnt(3)
    v_max_u32 v18, v25, v27
    v_cmp_eq_u32 vcc, -1, v18
    s_cbranch_vccnz .nk_258
    s_branch .ok_259
.nk_304:
    buffer_load_dwordx4 v[24:27], v3, s[8:11], s30 offen offset:0 sc1
    s_add_u32 s62, s62, 1
    s_cmp_gt_u32 s62, 0x100000
    s_cbranch_scc1 .mg_end_1
    s_waitcnt vmcnt(2)
    v_max_u32 v18, v29, v31
    v_cmp_eq_u32 vcc, -1, v18
    s_cbranch_vccnz .nk_316
.ok_317:
    v_smfmac_f32_16x16x64_bf16 v[40:43], v[28:31], a[8:15], v2
    v_smfmac_f32_16x16x64_bf16 v[44:47], v[28:31], a[40:47], v2
    s_waitcnt vmcnt(1)
    v_max_u32 v18, v33, v35
    v_cmp_eq_u32 vcc, -1, v18
    v_smfmac_f32_16x16x64_bf16 v[48:51], v[28:31], a[72:79], v2
    v_smfmac_f32_16x16x64_bf16 v[52:55], v[28:31], a[104:111], v2
    s_cbranch_vccnz .nk_312
    s_branch .ok_313
.nk_306:
    buffer_load_dwordx4 v[24:27], v3, s[8:11], s30 offen offset:0 sc1
    s_add_u32 s62, s62, 1
    s_cmp_gt_u32 s62, 0x100000
    s_cbranch_scc1 .mg_end_1
    s_waitcnt vmcnt(2)
    v_max_u32 v18, v29, v31
    v_cmp_eq_u32 vcc, -1, v18
    s_cbranch_vccnz .nk_318
.ok_319:
    v_smfmac_f32_16x16x64_bf16 v[40:43], v[28:31], a[8:15], v2
    v_smfmac_f32_16x16x64_bf16 v[44:47], v[28:31], a[40:47], v2
    s_waitcnt vmcnt(1)
    v_max_u32 v18, v37, v39
    v_cmp_eq_u32 vcc, -1, v18
    v_smfmac_f32_16x16x64_bf16 v[48:51], v[28:31], a[72:79], v2
    v_smfmac_f32_16x16x64_bf16 v[52:55], v[28:31], a[104:111], v2
    s_cbranch_vccnz .nk_270
    s_branch .ok_271
.nk_308:
    buffer_load_dwordx4 v[28:31], v3, s[8:11], s30 offen offset:1024 sc1
    s_add_u32 s62, s62, 1
    s_cmp_gt_u32 s62, 0x100000
    s_cbranch_scc1 .mg_end_1
    s_waitcnt vmcnt(1)
    v_max_u32 v18, v25, v27
    v_cmp_eq_u32 vcc, -1, v18
    s_cbranch_vccnz .nk_288
    s_branch .ok_289
.nk_310:
    buffer_load_dwordx4 v[24:27], v3, s[8:11], s30 offen offset:0 sc1
    s_add_u32 s62, s62, 1
    s_cmp_gt_u32 s62, 0x100000
    s_cbranch_scc1 .mg_end_1
    s_waitcnt vmcnt(2)
    v_max_u32 v18, v33, v35
    v_cmp_eq_u32 vcc, -1, v18
    s_cbranch_vccnz .nk_268
    s_branch .ok_269
.nk_312:
    buffer_load_dwordx4 v[32:35], v3, s[8:11], s30 offen offset:2048 sc1
    s_add_u32 s62, s62, 1
    s_cmp_gt_u32 s62, 0x100000
    s_cbranch_scc1 .mg_end_1
    s_waitcnt vmcnt(1)
    v_max_u32 v18, v25, v27
    v_cmp_eq_u32 vcc, -1, v18
    s_cbranch_vccnz .nk_292
    s_branch .ok_293
.nk_314:
    buffer_load_dwordx4 v[32:35], v3, s[8:11], s30 offen offset:2048 sc1
    s_add_u32 s62, s62, 1
    s_cmp_gt_u32 s62, 0x100000
    s_cbranch_scc1 .mg_end_1
    s_waitcnt vmcnt(1)
    v_max_u32 v18, v29, v31
    v_cmp_eq_u32 vcc, -1, v18
    s_cbranch_vccnz .nk_298
    s_branch .ok_299
.nk_316:
    buffer_load_dwordx4 v[28:31], v3, s[8:11], s30 offen offset:1024 sc1
    s_add_u32 s62, s62, 1
    s_cmp_gt_u32 s62, 0x100000
    s_cbranch_scc1 .mg_end_1
    s_waitcnt vmcnt(2)
    v_max_u32 v18, v33, v35
    v_cmp_eq_u32 vcc, -1, v18
    s_cbranch_vccnz .nk_320
.ok_321:
    v_smfmac_f32_16x16x64_bf16 v[40:43], v[32:35], a[16:23], v2
    v_smfmac_f32_16x16x64_bf16 v[44:47], v[32:35], a[48:55], v2
    s_waitcnt vmcnt(1)
    v_max_u32 v18, v25, v27
    v_cmp_eq_u32 vcc, -1, v18
    v_smfmac_f32_16x16x64_bf16 v[48:51], v[32:35], a[80:87], v2
    v_smfmac_f32_16x16x64_bf16 v[52:55], v[32:35], a[112:119], v2
    s_cbranch_vccnz .nk_288
    s_branch .ok_289
.nk_318:
    buffer_load_dwordx4 v[28:31], v3, s[8:11], s30 offen offset:1024 sc1
    s_add_u32 s62, s62, 1
    s_cmp_gt_u32 s62, 0x100000
    s_cbranch_scc1 .mg_end_1
    s_waitcnt vmcnt(2)
    v_max_u32 v18, v37, v39
    v_cmp_eq_u32 vcc, -1, v18
    s_cbranch_vccnz .nk_286
    s_branch .ok_287
.nk_320:
    buffer_load_dwordx4 v[32:35], v3, s[8:11], s30 offen offset:2048 sc1
    s_add_u32 s62, s62, 1
    s_cmp_gt_u32 s62, 0x100000
    s_cbranch_scc1 .mg_end_1
    s_waitcnt vmcnt(2)
    v_max_u32 v18, v25, v27
    v_cmp_eq_u32 vcc, -1, v18
    s_cbranch_vccnz .nk_304
    s_branch .ok_305
.p2align 6
.gm_207:
    s_waitcnt vmcnt(3)
    v_cmp_eq_u32 vcc, -1, v27
    s_cbranch_vccnz .nk_322
.ok_323:
    v_smfmac_f32_16x16x64_bf16 v[64:67], v[24:27], a[192:199], v2
    s_waitcnt vmcnt(2)
    v_cmp_eq_u32 vcc, -1, v31
    v_smfmac_f32_16x16x64_bf16 v[68:71], v[24:27], a[224:231], v2
    s_cbranch_vccnz .nk_324
.ok_325:
    v_smfmac_f32_16x16x64_bf16 v[64:67], v[28:31], a[200:207], v2
    s_waitcnt vmcnt(1)
    v_cmp_eq_u32 vcc, -1, v35
    v_smfmac_f32_16x16x64_bf16 v[68:71], v[28:31], a[232:239], v2
    s_cbranch_vccnz .nk_326
.ok_327:
    v_smfmac_f32_16x16x64_bf16 v[64:67], v[32:35], a[208:215], v2
    s_waitcnt vmcnt(0)
    v_cmp_eq_u32 vcc, -1, v39
    v_smfmac_f32_16x16x64_bf16 v[68:71], v[32:35], a[240:247], v2
    s_cbranch_vccnz .nk_328
.ok_329:
    v_smfmac_f32_16x16x64_bf16 v[64:67], v[36:39], a[216:223], v2
    v_smfmac_f32_16x16x64_bf16 v[68:71], v[36:39], a[248:255], v2
    s_setpc_b64 s[98:99]
.nk_322:
    buffer_load_dwordx4 v[24:27], v4, s[8:11], s30 offen offset:0 sc1
    s_add_u32 s62, s62, 1
    s_cmp_gt_u32 s62, 0x100000
    s_cbranch_scc1 .mg_end_1
    s_waitcnt vmcnt(3)
    v_cmp_eq_u32 vcc, -1, v31
    s_cbranch_vccnz .nk_330
.ok_331:
    v_smfmac_f32_16x16x64_bf16 v[64:67], v[28:31], a[200:207], v2
    s_waitcnt vmcnt(2)
    v_cmp_eq_u32 vcc, -1, v35
    v_smfmac_f32_16x16x64_bf16 v[68:71], v[28:31], a[232:239], v2
    s_cbranch_vccnz .nk_332
.ok_333:
    v_smfmac_f32_16x16x64_bf16 v[64:67], v[32:35], a[208:215], v2
    s_waitcnt vmcnt(1)
    v_cmp_eq_u32 vcc, -1, v39
    v_smfmac_f32_16x16x64_bf16 v[68:71], v[32:35], a[240:247], v2
    s_cbranch_vccnz .nk_334
.ok_335:
    v_smfmac_f32_16x16x64_bf16 v[64:67], v[36:39], a[216:223], v2
    s_waitcnt vmcnt(0)
    v_cmp_eq_u32 vcc, -1, v27
    v_smfmac_f32_16x16x64_bf16 v[68:71], v[36:39], a[248:255], v2
    s_cbranch_vccnz .nk_336
.ok_337:
    v_smfmac_f32_16x16x64_bf16 v[64:67], v[24:27], a[192:199], v2
    v_smfmac_f32_16x16x64_bf16 v[68:71], v[24:27], a[224:231], v2
    s_setpc_b64 s[98:99]
.nk_324:
    buffer_load_dwordx4 v[28:31], v4, s[8:11], s30 offen offset:1024 sc1
    s_add_u32 s62, s62, 1
    s_cmp_gt_u32 s62, 0x100000
    s_cbranch_scc1 .mg_end_1
    s_waitcnt vmcnt(2)
    v_cmp_eq_u32 vcc, -1, v35
    s_cbranch_vccnz .nk_338
.ok_339:
    v_smfmac_f32_16x16x64_bf16 v[64:67], v[32:35], a[208:215], v2
    s_waitcnt vmcnt(1)
    v_cmp_eq_u32 vcc, -1, v39
    v_smfmac_f32_16x16x64_bf16 v[68:71], v[32:35], a[240:247], v2
    s_cbranch_vccnz .nk_340
.ok_341:
    v_smfmac_f32_16x16x64_bf16 v[64:67], v[36:39], a[216:223], v2
    s_waitcnt vmcnt(0)
    v_cmp_eq_u32 vcc, -1, v31
    v_smfmac_f32_16x16x64_bf16 v[68:71], v[36:39], a[248:255], v2
    s_cbranch_vccnz .nk_342
.ok_343:
    v_smfmac_f32_16x16x64_bf16 v[64:67], v[28:31], a[200:207], v2
    v_smfmac_f32_16x16x64_bf16 v[68:71], v[28:31], a[232:239], v2
    s_setpc_b64 s[98:99]
.nk_326:
    buffer_load_dwordx4 v[32:35], v4, s[8:11], s30 offen offset:2048 sc1
    s_add_u32 s62, s62, 1
    s_cmp_gt_u32 s62, 0x100000
    s_cbranch_scc1 .mg_end_1
    s_waitcnt vmcnt(1)
    v_cmp_eq_u32 vcc, -1, v39
    s_cbranch_vccnz .nk_344
.ok_345:
    v_smfmac_f32_16x16x64_bf16 v[64:67], v[36:39], a[216:223], v2
    s_waitcnt vmcnt(0)
    v_cmp_eq_u32 vcc, -1, v35
    v_smfmac_f32_16x16x64_bf16 v[68:71], v[36:39], a[248:255], v2
    s_cbranch_vccnz .nk_346
.ok_347:
    v_smfmac_f32_16x16x64_bf16 v[64:67], v[32:35], a[208:215], v2
    v_smfmac_f32_16x16x64_bf16 v[68:71], v[32:35], a[240:247], v2
    s_setpc_b64 s[98:99]
.nk_328:
    buffer_load_dwordx4 v[36:39], v4, s[8:11], s30 offen offset:3072 sc1
    s_add_u32 s62, s62, 1
    s_cmp_gt_u32 s62, 0x100000
    s_cbranch_scc1 .mg_end_1
    s_waitcnt vmcnt(0)
    v_cmp_eq_u32 vcc, -1, v39
    s_cbranch_vccnz .nk_328
    s_branch .ok_329
.nk_330:
    buffer_load_dwordx4 v[28:31], v4, s[8:11], s30 offen offset:1024 sc1
    s_add_u32 s62, s62, 1
    s_cmp_gt_u32 s62, 0x100000
    s_cbranch_scc1 .mg_end_1
    s_waitcnt vmcnt(3)
    v_cmp_eq_u32 vcc, -1, v35
    s_cbranch_vccnz .nk_348
.ok_349:
    v_smfmac_f32_16x16x64_bf16 v[64:67], v[32:35], a[208:215], v2
    s_waitcnt vmcnt(2)
    v_cmp_eq_u32 vcc, -1, v39
    v_smfmac_f32_16x16x64_bf16 v[68:71], v[32:35], a[240:247], v2
    s_cbranch_vccnz .nk_350
.ok_351:
    v_smfmac_f32_16x16x64_bf16 v[64:67], v[36:39], a[216:223], v2
    s_waitcnt vmcnt(1)
    v_cmp_eq_u32 vcc, -1, v27
    v_smfmac_f32_16x16x64_bf16 v[68:71], v[36:39], a[248:255], v2
    s_cbranch_vccnz .nk_352
.ok_353:
    v_smfmac_f32_16x16x64_bf16 v[64:67], v[24:27], a[192:199], v2
    s_waitcnt vmcnt(0)
    v_cmp_eq_u32 vcc, -1, v31
    v_smfmac_f32_16x16x64_bf16 v[68:71], v[24:27], a[224:231], v2
    s_cbranch_vccnz .nk_342
    s_branch .ok_343
.nk_332:
    buffer_load_dwordx4 v[32:35], v4, s[8:11], s30 offen offset:2048 sc1
    s_add_u32 s62, s62, 1
    s_cmp_gt_u32 s62, 0x100000
    s_cbranch_scc1 .mg_end_1
    s_waitcnt vmcnt(2)
    v_cmp_eq_u32 vcc, -1, v39
    s_cbranch_vccnz .nk_354
.ok_355:
    v_smfmac_f32_16x16x64_bf16 v[64:67], v[36:39], a[216:223], v2
    s_waitcnt vmcnt(1)
    v_cmp_eq_u32 vcc, -1, v27
    v_smfmac_f32_16x16x64_bf16 v[68:71], v[36:39], a[248:255], v2
    s_cbranch_vccnz .nk_356
.ok_357:
    v_smfmac_f32_16x16x64_bf16 v[64:67], v[24:27], a[192:199], v2
    s_waitcnt vmcnt(0)
    v_cmp_eq_u32 vcc, -1, v35
    v_smfmac_f32_16x16x64_bf16 v[68:71], v[24:27], a[224:231], v2
    s_cbranch_vccnz .nk_346
    s_branch .ok_347
.nk_334:
    buffer_load_dwordx4 v[36:39], v4, s[8:11], s30 offen offset:3072 sc1
    s_add_u32 s62, s62, 1
    s_cmp_gt_u32 s62, 0x100000
    s_cbranch_scc1 .mg_end_1
    s_waitcnt vmcnt(1)
    v_cmp_eq_u32 vcc, -1, v27
    s_cbranch_vccnz .nk_358
.ok_359:
    v_smfmac_f32_16x16x64_bf16 v[64:67], v[24:27], a[192:199], v2
    s_waitcnt vmcnt(0)
    v_cmp_eq_u32 vcc, -1, v39
    v_smfmac_f32_16x16x64_bf16 v[68:71], v[24:27], a[224:231], v2
    s_cbranch_vccnz .nk_328
    s_branch .ok_329
.nk_336:
    buffer_load_dwordx4 v[24:27], v4, s[8:11], s30 offen offset:0 sc1
    s_add_u32 s62, s62, 1
    s_cmp_gt_u32 s62, 0x100000
    s_cbranch_scc1 .mg_end_1
    s_waitcnt vmcnt(0)
    v_cmp_eq_u32 vcc, -1, v27
    s_cbranch_vccnz .nk_336
    s_branch .ok_337
.nk_338:
    buffer_load_dwordx4 v[32:35], v4, s[8:11], s30 offen offset:2048 sc1
    s_add_u32 s62, s62, 1
    s_cmp_gt_u32 s62, 0x100000
    s_cbranch_scc1 .mg_end_1
    s_waitcnt vmcnt(2)
    v_cmp_eq_u32 vcc, -1, v39
    s_cbranch_vccnz .nk_360
.ok_361:
    v_smfmac_f32_16x16x64_bf16 v[64:67], v[36:39], a[216:223], v2
    s_waitcnt vmcnt(1)
    v_cmp_eq_u32 vcc, -1, v31
    v_smfmac_f32_16x16x64_bf16 v[68:71], v[36:39], a[248:255], v2
    s_cbranch_vccnz .nk_362
.ok_363:
    v_smfmac_f32_16x16x64_bf16 v[64:67], v[28:31], a[200:207], v2
    s_waitcnt vmcnt(0)
    v_cmp_eq_u32 vcc, -1, v35
    v_smfmac_f32_16x16x64_bf16 v[68:71], v[28:31], a[232:239], v2
    s_cbranch_vccnz .nk_346
    s_branch .ok_347
.nk_340:
    buffer_load_dwordx4 v[36:39], v4, s[8:11], s30 offen offset:3072 sc1
    s_add_u32 s62, s62, 1
    s_cmp_gt_u32 s62, 0x100000
    s_cbranch_scc1 .mg_end_1
    s_waitcnt vmcnt(1)
    v_cmp_eq_u32 vcc, -1, v31
    s_cbranch_vccnz .nk_364
.ok_365:
    v_smfmac_f32_16x16x64_bf16 v[64:67], v[28:31], a[200:207], v2
    s_waitcnt vmcnt(0)
    v_cmp_eq_u32 vcc, -1, v39
    v_smfmac_f32_16x16x64_bf16 v[68:71], v[28:31], a[232:239], v2
    s_cbranch_vccnz .nk_328
    s_branch .ok_329
.nk_342:
    buffer_load_dwordx4 v[28:31], v4, s[8:11], s30 offen offset:1024 sc1
    s_add_u32 s62, s62, 1
    s_cmp_gt_u32 s62, 0x100000
    s_cbranch_scc1 .mg_end_1
    s_waitcnt vmcnt(0)
    v_cmp_eq_u32 vcc, -1, v31
    s_cbranch_vccnz .nk_342
    s_branch .ok_343
.nk_344:
    buffer_load_dwordx4 v[36:39], v4, s[8:11], s30 offen offset:3072 sc1
    s_add_u32 s62, s62, 1
    s_cmp_gt_u32 s62, 0x100000
    s_cbranch_scc1 .mg_end_1
    s_waitcnt vmcnt(1)
    v_cmp_eq_u32 vcc, -1, v35
    s_cbranch_vccnz .nk_326
    s_branch .ok_327
.nk_346:
    buffer_load_dwordx4 v[32:35], v4, s[8:11], s30 offen offset:2048 sc1
    s_add_u32 s62, s62, 1
    s_cmp_gt_u32 s62, 0x100000
    s_cbranch_scc1 .mg_end_1
    s_waitcnt vmcnt(0)
    v_cmp_eq_u32 vcc, -1, v35
    s_cbranch_vccnz .nk_346
    s_branch .ok_347
.nk_348:
    buffer_load_dwordx4 v[32:35], v4, s[8:11], s30 offen offset:2048 sc1
    s_add_u32 s62, s62, 1
    s_cmp_gt_u32 s62, 0x100000
    s_cbranch_scc1 .mg_end_1
    s_waitcnt vmcnt(3)
    v_cmp_eq_u32 vcc, -1, v39
    s_cbranch_vccnz .nk_366
.ok_367:
    v_smfmac_f32_16x16x64_bf16 v[64:67], v[36:39], a[216:223], v2
    s_waitcnt vmcnt(2)
    v_cmp_eq_u32 vcc, -1, v27
    v_smfmac_f32_16x16x64_bf16 v[68:71], v[36:39], a[248:255], v2
    s_cbranch_vccnz .nk_368
.ok_369:
    v_smfmac_f32_16x16x64_bf16 v[64:67], v[24:27], a[192:199], v2
    s_waitcnt vmcnt(1)
    v_cmp_eq_u32 vcc, -1, v31
    v_smfmac_f32_16x16x64_bf16 v[68:71], v[24:27], a[224:231], v2
    s_cbranch_vccnz .nk_362
    s_branch .ok_363
.nk_350:
    buffer_load_dwordx4 v[36:39], v4, s[8:11], s30 offen offset:3072 sc1
    s_add_u32 s62, s62, 1
    s_cmp_gt_u32 s62, 0x100000
    s_cbranch_scc1 .mg_end_1
    s_waitcnt vmcnt(2)
    v_cmp_eq_u32 vcc, -1, v27
    s_cbranch_vccnz .nk_370
.ok_371:
    v_smfmac_f32_16x16x64_bf16 v[64:67], v[24:27], a[192:199], v2
    s_waitcnt vmcnt(1)
    v_cmp_eq_u32 vcc, -1, v31
    v_smfmac_f32_16x16x64_bf16 v[68:71], v[24:27], a[224:231], v2
    s_cbranch_vccnz .nk_364
    s_branch .ok_365
.nk_352:
    buffer_load_dwordx4 v[24:27], v4, s[8:11], s30 offen offset:0 sc1
    s_add_u32 s62, s62, 1
    s_cmp_gt_u32 s62, 0x100000
    s_cbranch_scc1 .mg_end_1
    s_waitcnt vmcnt(1)
    v_cmp_eq_u32 vcc, -1, v31
    s_cbranch_vccnz .nk_372
.ok_373:
    v_smfmac_f32_16x16x64_bf16 v[64:67], v[28:31], a[200:207], v2
    s_waitcnt vmcnt(0)
    v_cmp_eq_u32 vcc, -1, v27
    v_smfmac_f32_16x16x64_bf16 v[68:71], v[28:31], a[232:239], v2
    s_cbranch_vccnz .nk_336
    s_branch .ok_337
.nk_354:
    buffer_load_dwordx4 v[36:39], v4, s[8:11], s30 offen offset:3072 sc1
    s_add_u32 s62, s62, 1
    s_cmp_gt_u32 s62, 0x100000
    s_cbranch_scc1 .mg_end_1
    s_waitcnt vmcnt(2)
    v_cmp_eq_u32 vcc, -1, v27
    s_cbranch_vccnz .nk_374
.ok_375:
    v_smfmac_f32_16x16x64_bf16 v[64:67], v[24:27], a[192:199], v2
    s_waitcnt vmcnt(1)
    v_cmp_eq_u32 vcc, -1, v35
    v_smfmac_f32_16x16x64_bf16 v[68:71], v[24:27], a[224:231], v2
    s_cbranch_vccnz .nk_326
    s_branch .ok_327
.nk_356:
    buffer_load_dwordx4 v[24:27], v4, s[8:11], s30 offen offset:0 sc1
    s_add_u32 s62, s62, 1
    s_cmp_gt_u32 s62, 0x100000
    s_cbranch_scc1 .mg_end_1
    s_waitcnt vmcnt(1)
    v_cmp_eq_u32 vcc, -1, v35
    s_cbranch_vccnz .nk_376
.ok_377:
    v_smfmac_f32_16x16x64_bf16 v[64:67], v[32:35], a[208:215], v2
    s_waitcnt vmcnt(0)
    v_cmp_eq_u32 vcc, -1, v27
    v_smfmac_f32_16x16x64_bf16 v[68:71], v[32:35], a[240:247], v2
    s_cbranch_vccnz .nk_336
    s_branch .ok_337
.nk_358:
    buffer_load_dwordx4 v[24:27], v4, s[8:11], s30 offen offset:0 sc1
    s_add_u32 s62, s62, 1
    s_cmp_gt_u32 s62, 0x100000
    s_cbranch_scc1 .mg_end_1
    s_waitcnt vmcnt(1)
    v_cmp_eq_u32 vcc, -1, v39
    s_cbranch_vccnz .nk_334
    s_branch .ok_335
.nk_360:
    buffer_load_dwordx4 v[36:39], v4, s[8:11], s30 offen offset:3072 sc1
    s_add_u32 s62, s62, 1
    s_cmp_gt_u32 s62, 0x100000
    s_cbranch_scc1 .mg_end_1
    s_waitcnt vmcnt(2)
    v_cmp_eq_u32 vcc, -1, v31
    s_cbranch_vccnz .nk_324
    s_branch .ok_325
.nk_362:
    buffer_load_dwordx4 v[28:31], v4, s[8:11], s30 offen offset:1024 sc1
    s_add_u32 s62, s62, 1
    s_cmp_gt_u32 s62, 0x100000
    s_cbranch_scc1 .mg_end_1
    s_waitcnt vmcnt(1)
    v_cmp_eq_u32 vcc, -1, v35
    s_cbranch_vccnz .nk_378
.ok_379:
    v_smfmac_f32_16x16x64_bf16 v[64:67], v[32:35], a[208:215], v2
    s_waitcnt vmcnt(0)
    v_cmp_eq_u32 vcc, -1, v31
    v_smfmac_f32_16x16x64_bf16 v[68:71], v[32:35], a[240:247], v2
    s_cbranch_vccnz .nk_342
    s_branch .ok_343
.nk_364:
    buffer_load_dwordx4 v[28:31], v4, s[8:11], s30 offen offset:1024 sc1
    s_add_u32 s62, s62, 1
    s_cmp_gt_u32 s62, 0x100000
    s_cbranch_scc1 .mg_end_1
    s_waitcnt vmcnt(1)
    v_cmp_eq_u32 vcc, -1, v39
    s_cbranch_vccnz .nk_340
    s_branch .ok_341
.nk_366:
    buffer_load_dwordx4 v[36:39], v4, s[8:11], s30 offen offset:3072 sc1
    s_add_u32 s62, s62, 1
    s_cmp_gt_u32 s62, 0x100000
    s_cbranch_scc1 .mg_end_1
    s_waitcnt vmcnt(3)
    v_cmp_eq_u32 vcc, -1, v27
    s_cbranch_vccnz .nk_322
    s_branch .ok_323
.nk_368:
    buffer_load_dwordx4 v[24:27], v4, s[8:11], s30 offen offset:0 sc1
    s_add_u32 s62, s62, 1
    s_cmp_gt_u32 s62, 0x100000
    s_cbranch_scc1 .mg_end_1
    s_waitcnt vmcnt(2)
    v_cmp_eq_u32 vcc, -1, v31
    s_cbranch_vccnz .nk_380
.ok_381:
    v_smfmac_f32_16x16x64_bf16 v[64:67], v[28:31], a[200:207], v2
    s_waitcnt vmcnt(1)
    v_cmp_eq_u32 vcc, -1, v35
    v_smfmac_f32_16x16x64_bf16 v[68:71], v[28:31], a[232:239], v2
    s_cbranch_vccnz .nk_376
    s_branch .ok_377
.nk_370:
    buffer_load_dwordx4 v[24:27], v4, s[8:11], s30 offen offset:0 sc1
    s_add_u32 s62, s62, 1
    s_cmp_gt_u32 s62, 0x100000
    s_cbranch_scc1 .mg_end_1
    s_waitcnt vmcnt(2)
    v_cmp_eq_u32 vcc, -1, v31
    s_cbranch_vccnz .nk_382
.ok_383:
    v_smfmac_f32_16x16x64_bf16 v[64:67], v[28:31], a[200:207], v2
    s_waitcnt vmcnt(1)
    v_cmp_eq_u32 vcc, -1, v39
    v_smfmac_f32_16x16x64_bf16 v[68:71], v[28:31], a[232:239], v2
    s_cbranch_vccnz .nk_334
    s_branch .ok_335
.nk_372:
    buffer_load_dwordx4 v[28:31], v4, s[8:11], s30 offen offset:1024 sc1
    s_add_u32 s62, s62, 1
    s_cmp_gt_u32 s62, 0x100000
    s_cbranch_scc1 .mg_end_1
    s_waitcnt vmcnt(1)
    v_cmp_eq_u32 vcc, -1, v27
    s_cbranch_vccnz .nk_352
    s_branch .ok_353
.nk_374:
    buffer_load_dwordx4 v[24:27], v4, s[8:11], s30 offen offset:0 sc1
    s_add_u32 s62, s62, 1
    s_cmp_gt_u32 s62, 0x100000
    s_cbranch_scc1 .mg_end_1
    s_waitcnt vmcnt(2)
    v_cmp_eq_u32 vcc, -1, v35
    s_cbranch_vccnz .nk_332
    s_branch .ok_333
.nk_376:
    buffer_load_dwordx4 v[32:35], v4, s[8:11], s30 offen offset:2048 sc1
    s_add_u32 s62, s62, 1
    s_cmp_gt_u32 s62, 0x100000
    s_cbranch_scc1 .mg_end_1
    s_waitcnt vmcnt(1)
    v_cmp_eq_u32 vcc, -1, v27
    s_cbranch_vccnz .nk_356
    s_branch .ok_357
.nk_378:
    buffer_load_dwordx4 v[32:35], v4, s[8:11], s30 offen offset:2048 sc1
    s_add_u32 s62, s62, 1
    s_cmp_gt_u32 s62, 0x100000
    s_cbranch_scc1 .mg_end_1
    s_waitcnt vmcnt(1)
    v_cmp_eq_u32 vcc, -1, v31
    s_cbranch_vccnz .nk_362
    s_branch .ok_363
.nk_380:
    buffer_load_dwordx4 v[28:31], v4, s[8:11], s30 offen offset:1024 sc1
    s_add_u32 s62, s62, 1
    s_cmp_gt_u32 s62, 0x100000
    s_cbranch_scc1 .mg_end_1
    s_waitcnt vmcnt(2)
    v_cmp_eq_u32 vcc, -1, v35
    s_cbranch_vccnz .nk_384
.ok_385:
    v_smfmac_f32_16x16x64_bf16 v[64:67], v[32:35], a[208:215], v2
    s_waitcnt vmcnt(1)
    v_cmp_eq_u32 vcc, -1, v27
    v_smfmac_f32_16x16x64_bf16 v[68:71], v[32:35], a[240:247], v2
    s_cbranch_vccnz .nk_352
    s_branch .ok_353
.nk_382:
    buffer_load_dwordx4 v[28:31], v4, s[8:11], s30 offen offset:1024 sc1
    s_add_u32 s62, s62, 1
    s_cmp_gt_u32 s62, 0x100000
    s_cbranch_scc1 .mg_end_1
    s_waitcnt vmcnt(2)
    v_cmp_eq_u32 vcc, -1, v39
    s_cbranch_vccnz .nk_350
    s_branch .ok_351
.nk_384:
    buffer_load_dwordx4 v[32:35], v4, s[8:11], s30 offen offset:2048 sc1
    s_add_u32 s62, s62, 1
    s_cmp_gt_u32 s62, 0x100000
    s_cbranch_scc1 .mg_end_1
    s_waitcnt vmcnt(2)
    v_cmp_eq_u32 vcc, -1, v27
    s_cbranch_vccnz .nk_368
    s_branch .ok_369
.mg_bg_2:
    s_lshr_b32 s98, s26, 3
    s_add_u32 s98, s98, 1
    s_and_b32 s98, s98, 3
    s_and_b32 s99, s25, 3
    s_lshl_b32 s99, s99, 3
    s_and_b32 s4, s26, 7
    s_add_u32 s99, s99, s4
    s_mov_b32 s96, 0
    v_and_b32 v1, 63, v0
    v_mov_b32 v250, 0
    v_mov_b32 v251, 0
    s_bitcmp0_b32 s26, 4
    s_cbranch_scc1 .qkv_387
    s_bfe_u32 s95, s26, 0x10003
    s_load_dwordx2 s[40:41], s[0:1], 0
    s_lshl_b32 s4, s95, 3
    s_add_u32 s4, s4, 72
    s_load_dwordx2 s[42:43], s[0:1], s4
    s_lshl_b32 s4, s99, 8
    s_lshl_b32 s6, s24, 14
    s_mul_i32 s5, s24, 524288
    s_add_u32 s4, s4, s5
    v_bfe_u32 v2, v1, 4, 1
    v_lshlrev_b32 v2, 2, v2
    v_and_b32 v3, 7, v1
    v_xor_b32 v2, v2, v3
    v_lshlrev_b32 v2, 4, v2
    v_bfe_u32 v254, v1, 3, 2
    v_mul_u32_u24 v240, 8192, v254
    v_bfe_u32 v254, v1, 5, 1
    v_mul_u32_u24 v254, 128, v254
    v_add_u32 v240, v240, v254
    v_add_u32 v240, s4, v240
    v_add_u32 v240, v2, v240
    s_lshr_b32 s5, s24, 1
    s_lshl_b32 s5, s5, 9
    v_bfe_u32 v2, v1, 3, 1
    v_xor_b32 v2, s24, v2
    v_and_b32 v2, 1, v2
    v_lshlrev_b32 v2, 6, v2
    v_bfe_u32 v254, v1, 4, 2
    v_mul_u32_u24 v242, 2048, v254
    v_bfe_u32 v254, v1, 2, 2
    v_mul_u32_u24 v254, 128, v254
    v_add_u32 v242, v242, v254
    v_bfe_u32 v254, v1, 0, 2
    v_mul_u32_u24 v254, 16, v254
    v_add_u32 v242, v242, v254
    v_add_u32 v242, s5, v242
    v_add_u32 v242, v2, v242
    v_add_u32 v243, 0x10000, v242
    s_waitcnt lgkmcnt(0)
    s_mov_b32 s16, s42
    s_and_b32 s17, s43, 0xffff
    s_mov_b32 s18, 0x800000
    s_mov_b32 s19, 0x00020000
    s_add_u32 m0, s6, 0
    s_mov_b32 s5, 4194304
    buffer_load_dwordx4 v240, s[16:19], s5 offen  lds
    s_add_u32 m0, s6, 1024
    s_mov_b32 s5, 4227072
    buffer_load_dwordx4 v240, s[16:19], s5 offen  lds
    s_add_u32 m0, s6, 2048
    s_mov_b32 s5, 4259840
    buffer_load_dwordx4 v240, s[16:19], s5 offen  lds
    s_add_u32 m0, s6, 3072
    s_mov_b32 s5, 4292608
    buffer_load_dwordx4 v240, s[16:19], s5 offen  lds
    s_add_u32 m0, s6, 4096
    s_mov_b32 s5, 4325376
    buffer_load_dwordx4 v240, s[16:19], s5 offen  lds
    s_add_u32 m0, s6, 5120
    s_mov_b32 s5, 4358144
    buffer_load_dwordx4 v240, s[16:19], s5 offen  lds
    s_add_u32 m0, s6, 6144
    s_mov_b32 s5, 4390912
    buffer_load_dwordx4 v240, s[16:19], s5 offen  lds
    s_add_u32 m0, s6, 7168
    s_mov_b32 s5, 4423680
    buffer_load_dwordx4 v240, s[16:19], s5 offen  lds
    s_add_u32 m0, s6, 8192
    s_mov_b32 s5, 4456448
    buffer_load_dwordx4 v240, s[16:19], s5 offen  lds
    s_add_u32 m0, s6, 9216
    s_mov_b32 s5, 4489216
    buffer_load_dwordx4 v240, s[16:19], s5 offen  lds
    s_add_u32 m0, s6, 10240
    s_mov_b32 s5, 4521984
    buffer_load_dwordx4 v240, s[16:19], s5 offen  lds
    s_add_u32 m0, s6, 11264
    s_mov_b32 s5, 4554752
    buffer_load_dwordx4 v240, s[16:19], s5 offen  lds
    s_add_u32 m0, s6, 12288
    s_mov_b32 s5, 4587520
    buffer_load_dwordx4 v240, s[16:19], s5 offen  lds
    s_add_u32 m0, s6, 13312
    s_mov_b32 s5, 4620288
    buffer_load_dwordx4 v240, s[16:19], s5 offen  lds
    s_add_u32 m0, s6, 14336
    s_mov_b32 s5, 4653056
    buffer_load_dwordx4 v240, s[16:19], s5 offen  lds
    s_add_u32 m0, s6, 15360
    s_mov_b32 s5, 4685824
    buffer_load_dwordx4 v240, s[16:19], s5 offen  lds
    s_waitcnt vmcnt(16)
    s_barrier
    s_cmp_lg_u32 s24, 1
    s_cbranch_scc1 .ns_388
    s_mov_b64 exec, 1
    v_mov_b32 v238, s3
    v_mov_b32 v239, 0
    buffer_atomic_add v238, v239, s[20:23], 0 offen offset:196 sc1
    s_mov_b64 exec, -1
.ns_388:
    s_and_b32 s4, s26, 15
    s_lshl_b32 s4, s4, 2
    s_add_u32 s4, s4, s24
    s_lshl_b32 s5, s4, 13
    v_lshlrev_b32 v6, 7, v1
    s_waitcnt lgkmcnt(0)
    s_mov_b32 s12, s40
    s_and_b32 s13, s41, 0xffff
    s_mov_b32 s14, 0x400000
    s_mov_b32 s15, 0x00020000
    buffer_load_dword v7, v6, s[12:15], s5 offen
    s_and_b32 s5, s25, 3
    s_lshl_b32 s5, s5, 6
    s_add_u32 s4, s4, s5
    s_lshl_b32 s4, s4, 14
    s_add_u32 s4, s4, 0x80000
    v_add_u32 v6, s4, v6
    v_add_u32 v8, 0x2000, v6
    s_add_u32 m0, s6, 65536
    s_mov_b32 s5, 6291456
    buffer_load_dwordx4 v240, s[16:19], s5 offen  lds
    s_add_u32 m0, s6, 66560
    s_mov_b32 s5, 6324224
    buffer_load_dwordx4 v240, s[16:19], s5 offen  lds
    s_add_u32 m0, s6, 67584
    s_mov_b32 s5, 6356992
    buffer_load_dwordx4 v240, s[16:19], s5 offen  lds
    s_add_u32 m0, s6, 68608
    s_mov_b32 s5, 6389760
    buffer_load_dwordx4 v240, s[16:19], s5 offen  lds
    s_add_u32 m0, s6, 69632
    s_mov_b32 s5, 6422528
    buffer_load_dwordx4 v240, s[16:19], s5 offen  lds
    s_add_u32 m0, s6, 70656
    s_mov_b32 s5, 6455296
    buffer_load_dwordx4 v240, s[16:19], s5 offen  lds
    s_add_u32 m0, s6, 71680
    s_mov_b32 s5, 6488064
    buffer_load_dwordx4 v240, s[16:19], s5 offen  lds
    s_add_u32 m0, s6, 72704
    s_mov_b32 s5, 6520832
    buffer_load_dwordx4 v240, s[16:19], s5 offen  lds
    s_add_u32 m0, s6, 73728
    s_mov_b32 s5, 6553600
    buffer_load_dwordx4 v240, s[16:19], s5 offen  lds
    s_add_u32 m0, s6, 74752
    s_mov_b32 s5, 6586368
    buffer_load_dwordx4 v240, s[16:19], s5 offen  lds
    s_add_u32 m0, s6, 75776
    s_mov_b32 s5, 6619136
    buffer_load_dwordx4 v240, s[16:19], s5 offen  lds
    s_add_u32 m0, s6, 76800
    s_mov_b32 s5, 6651904
    buffer_load_dwordx4 v240, s[16:19], s5 offen  lds
    s_add_u32 m0, s6, 77824
    s_mov_b32 s5, 6684672
    buffer_load_dwordx4 v240, s[16:19], s5 offen  lds
    s_add_u32 m0, s6, 78848
    s_mov_b32 s5, 6717440
    buffer_load_dwordx4 v240, s[16:19], s5 offen  lds
    s_add_u32 m0, s6, 79872
    s_mov_b32 s5, 6750208
    buffer_load_dwordx4 v240, s[16:19], s5 offen  lds
    s_add_u32 m0, s6, 80896
    s_mov_b32 s5, 6782976
    buffer_load_dwordx4 v240, s[16:19], s5 offen  lds
    s_cmp_lg_u32 s24, 0
    s_cbranch_scc1 .aw_389
    s_mov_b32 s62, 0
.aw_390:
    s_sleep 64
    s_add_u32 s62, s62, 1
    s_cmp_gt_u32 s62, 0x200000
    s_cbranch_scc1 .mg_end_1
    v_or_b32 v239, 32, v1
    v_lshlrev_b32 v239, 2, v239
    buffer_load_dword v238, v239, s[20:23], 0 offen sc1
    s_waitcnt vmcnt(0)
    v_readlane_b32 s4, v238, 49
    s_and_b32 s5, s4, 0xffff
    s_cmp_lt_u32 s5, 256
    s_cbranch_scc1 .aw_390
    s_lshr_b32 s4, s4, 16
    s_cbranch_scc1 .aw_389
    s_and_b32 s4, s99, 30
    s_lshl_b32 s4, s4, 9
    s_lshl_b32 s5, s95, 14
    s_add_u32 s4, s4, s5
    s_and_b32 s5, s99, 1
    s_lshl_b32 s5, s5, 7
    s_add_u32 s4, s4, s5
    s_lshl_b32 s4, s99, 9
    s_add_u32 s4, s4, 92291072
    v_mov_b32 v5, 0
    s_mov_b32 s62, 0
.aw_391:
    buffer_load_dword v4, v5, s[8:11], s4 offen sc1
    s_add_u32 s62, s62, 1
    s_cmp_gt_u32 s62, 0x200000
    s_cbranch_scc1 .mg_end_1
    s_waitcnt vmcnt(0)
    v_readfirstlane_b32 s5, v4
    s_mul_i32 s7, s95, 4
    s_add_u32 s5, s5, s7
    s_cmp_ge_u32 s5, 5
    s_cbranch_scc1 .aw_389
    s_sleep 16
    s_branch .aw_391
.aw_389:
    s_barrier
    v_or_b32 v239, 32, v1
    v_lshlrev_b32 v239, 2, v239
    buffer_load_dword v238, v239, s[20:23], 0 offen sc1
    s_waitcnt vmcnt(0)
    s_cmp_lg_u32 s27, 0
    s_cbranch_scc1 .vd_393
    s_mov_b32 s62, 0
.vp_392:
    v_readlane_b32 s4, v238, 49
    s_and_b32 s5, s4, 0xffff
    s_cmp_ge_u32 s5, 256
    s_cbranch_scc1 .va_394
    s_add_u32 s62, s62, 1
    s_cmp_gt_u32 s62, 0x100000
    s_cbranch_scc1 .mg_end_1
    s_sleep 16
    buffer_load_dword v238, v239, s[20:23], 0 offen sc1
    s_waitcnt vmcnt(0)
    s_branch .vp_392
.va_394:
    s_lshr_b32 s4, s4, 16
    s_cbranch_scc0 .vd_393
    s_lshr_b32 s25, s2, 5
    s_and_b32 s26, s2, 31
    s_mov_b32 s27, 1
    s_waitcnt vmcnt(0) lgkmcnt(0)
    s_barrier
    s_branch .mg_role_3
.vd_393:
    s_cmp_eq_u32 s98, 3
    s_cbranch_scc1 .ph2_386
.qkv_387:
    s_lshl_b32 s4, s98, 3
    s_add_u32 s4, s4, 64
    s_load_dwordx2 s[40:41], s[0:1], 0
    s_load_dwordx2 s[42:43], s[0:1], s4
    s_lshl_b32 s4, s99, 8
    s_lshl_b32 s6, s24, 14
    s_mul_i32 s5, s24, 524288
    s_add_u32 s4, s4, s5
    v_bfe_u32 v2, v1, 4, 1
    v_lshlrev_b32 v2, 2, v2
    v_and_b32 v3, 7, v1
    v_xor_b32 v2, v2, v3
    v_lshlrev_b32 v2, 4, v2
    v_bfe_u32 v254, v1, 3, 2
    v_mul_u32_u24 v240, 8192, v254
    v_bfe_u32 v254, v1, 5, 1
    v_mul_u32_u24 v254, 128, v254
    v_add_u32 v240, v240, v254
    v_add_u32 v240, s4, v240
    v_add_u32 v240, v2, v240
    s_lshr_b32 s5, s24, 1
    s_lshl_b32 s5, s5, 9
    v_bfe_u32 v2, v1, 3, 1
    v_xor_b32 v2, s24, v2
    v_and_b32 v2, 1, v2
    v_lshlrev_b32 v2, 6, v2
    v_bfe_u32 v254, v1, 4, 2
    v_mul_u32_u24 v242, 2048, v254
    v_bfe_u32 v254, v1, 2, 2
    v_mul_u32_u24 v254, 128, v254
    v_add_u32 v242, v242, v254
    v_bfe_u32 v254, v1, 0, 2
    v_mul_u32_u24 v254, 16, v254
    v_add_u32 v242, v242, v254
    v_add_u32 v242, s5, v242
    v_add_u32 v242, v2, v242
    v_add_u32 v243, 0x10000, v242
    s_waitcnt lgkmcnt(0)
    s_mov_b32 s12, s40
    s_and_b32 s13, s41, 0xffff
    s_mov_b32 s14, 0x400000
    s_mov_b32 s15, 0x00020000
    s_mov_b32 s16, s42
    s_and_b32 s17, s43, 0xffff
    s_mov_b32 s18, 0x800000
    s_mov_b32 s19, 0x00020000
    s_add_u32 m0, s6, 0
    s_mov_b32 s5, 0
    buffer_load_dwordx4 v240, s[16:19], s5 offen nt lds
    s_add_u32 m0, s6, 1024
    s_mov_b32 s5, 32768
    buffer_load_dwordx4 v240, s[16:19], s5 offen nt lds
    s_add_u32 m0, s6, 2048
    s_mov_b32 s5, 65536
    buffer_load_dwordx4 v240, s[16:19], s5 offen nt lds
    s_add_u32 m0, s6, 3072
    s_mov_b32 s5, 98304
    buffer_load_dwordx4 v240, s[16:19], s5 offen nt lds
    s_add_u32 m0, s6, 4096
    s_mov_b32 s5, 131072
    buffer_load_dwordx4 v240, s[16:19], s5 offen nt lds
    s_add_u32 m0, s6, 5120
    s_mov_b32 s5, 163840
    buffer_load_dwordx4 v240, s[16:19], s5 offen nt lds
    s_add_u32 m0, s6, 6144
    s_mov_b32 s5, 196608
    buffer_load_dwordx4 v240, s[16:19], s5 offen nt lds
    s_add_u32 m0, s6, 7168
    s_mov_b32 s5, 229376
    buffer_load_dwordx4 v240, s[16:19], s5 offen nt lds
    s_add_u32 m0, s6, 8192
    s_mov_b32 s5, 262144
    buffer_load_dwordx4 v240, s[16:19], s5 offen nt lds
    s_add_u32 m0, s6, 9216
    s_mov_b32 s5, 294912
    buffer_load_dwordx4 v240, s[16:19], s5 offen nt lds
    s_add_u32 m0, s6, 10240
    s_mov_b32 s5, 327680
    buffer_load_dwordx4 v240, s[16:19], s5 offen nt lds
    s_add_u32 m0, s6, 11264
    s_mov_b32 s5, 360448
    buffer_load_dwordx4 v240, s[16:19], s5 offen nt lds
    s_add_u32 m0, s6, 12288
    s_mov_b32 s5, 393216
    buffer_load_dwordx4 v240, s[16:19], s5 offen nt lds
    s_add_u32 m0, s6, 13312
    s_mov_b32 s5, 425984
    buffer_load_dwordx4 v240, s[16:19], s5 offen nt lds
    s_add_u32 m0, s6, 14336
    s_mov_b32 s5, 458752
    buffer_load_dwordx4 v240, s[16:19], s5 offen nt lds
    s_add_u32 m0, s6, 15360
    s_mov_b32 s5, 491520
    buffer_load_dwordx4 v240, s[16:19], s5 offen nt lds
    s_waitcnt vmcnt(16)
    s_barrier
    s_cmp_lg_u32 s24, 1
    s_cbranch_scc1 .ns_395
    s_mov_b64 exec, 1
    v_mov_b32 v238, s3
    v_mov_b32 v239, 0
    buffer_atomic_add v238, v239, s[20:23], 0 offen offset:196 sc1
    s_mov_b64 exec, -1
.ns_395:
    s_add_u32 m0, s6, 65536
    s_mov_b32 s5, 2097152
    buffer_load_dwordx4 v240, s[16:19], s5 offen nt lds
    s_add_u32 m0, s6, 66560
    s_mov_b32 s5, 2129920
    buffer_load_dwordx4 v240, s[16:19], s5 offen nt lds
    s_add_u32 m0, s6, 67584
    s_mov_b32 s5, 2162688
    buffer_load_dwordx4 v240, s[16:19], s5 offen nt lds
    s_add_u32 m0, s6, 68608
    s_mov_b32 s5, 2195456
    buffer_load_dwordx4 v240, s[16:19], s5 offen nt lds
    s_add_u32 m0, s6, 69632
    s_mov_b32 s5, 2228224
    buffer_load_dwordx4 v240, s[16:19], s5 offen nt lds
    s_add_u32 m0, s6, 70656
    s_mov_b32 s5, 2260992
    buffer_load_dwordx4 v240, s[16:19], s5 offen nt lds
    s_add_u32 m0, s6, 71680
    s_mov_b32 s5, 2293760
    buffer_load_dwordx4 v240, s[16:19], s5 offen nt lds
    s_add_u32 m0, s6, 72704
    s_mov_b32 s5, 2326528
    buffer_load_dwordx4 v240, s[16:19], s5 offen nt lds
    s_add_u32 m0, s6, 73728
    s_mov_b32 s5, 2359296
    buffer_load_dwordx4 v240, s[16:19], s5 offen nt lds
    s_add_u32 m0, s6, 74752
    s_mov_b32 s5, 2392064
    buffer_load_dwordx4 v240, s[16:19], s5 offen nt lds
    s_add_u32 m0, s6, 75776
    s_mov_b32 s5, 2424832
    buffer_load_dwordx4 v240, s[16:19], s5 offen nt lds
    s_add_u32 m0, s6, 76800
    s_mov_b32 s5, 2457600
    buffer_load_dwordx4 v240, s[16:19], s5 offen nt lds
    s_add_u32 m0, s6, 77824
    s_mov_b32 s5, 2490368
    buffer_load_dwordx4 v240, s[16:19], s5 offen nt lds
    s_add_u32 m0, s6, 78848
    s_mov_b32 s5, 2523136
    buffer_load_dwordx4 v240, s[16:19], s5 offen nt lds
    s_add_u32 m0, s6, 79872
    s_mov_b32 s5, 2555904
    buffer_load_dwordx4 v240, s[16:19], s5 offen nt lds
    s_add_u32 m0, s6, 80896
    s_mov_b32 s5, 2588672
    buffer_load_dwordx4 v240, s[16:19], s5 offen nt lds
    s_cmp_lg_u32 s98, 0
    s_cbranch_scc1 .xt_396
    s_and_b32 s4, s99, 7
    s_lshl_b32 s4, s4, 2
    s_add_u32 s4, s4, s24
    s_mul_i32 s4, s4, 4096
    s_add_u32 s4, s4, 4063232
    v_lshlrev_b32 v30, 7, v1
    v_add_u32 v30, s4, v30
    buffer_load_dword v31, v30, s[12:15], 0 offen
.xt_396:
    v_and_b32 v2, 15, v1
    v_lshrrev_b32 v3, 4, v1
    v_lshlrev_b32 v4, 11, v2
    v_add_u32 v5, 0, v3
    v_xor_b32 v5, v5, v2
    v_lshl_add_u32 v8, v5, 4, v4
    v_add_u32 v12, 0x10000, v8
    v_add_u32 v5, 4, v3
    v_xor_b32 v5, v5, v2
    v_lshl_add_u32 v9, v5, 4, v4
    v_add_u32 v13, 0x10000, v9
    v_add_u32 v5, 8, v3
    v_xor_b32 v5, v5, v2
    v_lshl_add_u32 v10, v5, 4, v4
    v_add_u32 v14, 0x10000, v10
    v_add_u32 v5, 12, v3
    v_xor_b32 v5, v5, v2
    v_lshl_add_u32 v11, v5, 4, v4
    v_add_u32 v15, 0x10000, v11
    s_lshl_b32 s4, s24, 3
    s_and_b32 s4, s4, 8
    s_add_u32 s5, s4, 0
    v_xor_b32 v5, s5, v1
    s_add_u32 s5, s6, 0
    v_lshlrev_b32 v5, 4, v5
    v_add_u32 v16, s5, v5
    s_add_u32 s5, s4, 1
    v_xor_b32 v5, s5, v1
    s_add_u32 s5, s6, 0
    v_lshlrev_b32 v5, 4, v5
    v_add_u32 v17, s5, v5
    s_add_u32 s5, s4, 2
    v_xor_b32 v5, s5, v1
    s_add_u32 s5, s6, 4096
    v_lshlrev_b32 v5, 4, v5
    v_add_u32 v18, s5, v5
    s_add_u32 s5, s4, 3
    v_xor_b32 v5, s5, v1
    s_add_u32 s5, s6, 4096
    v_lshlrev_b32 v5, 4, v5
    v_add_u32 v19, s5, v5
    s_add_u32 s5, s4, 4
    v_xor_b32 v5, s5, v1
    s_add_u32 s5, s6, 8192
    v_lshlrev_b32 v5, 4, v5
    v_add_u32 v20, s5, v5
    s_add_u32 s5, s4, 5
    v_xor_b32 v5, s5, v1
    s_add_u32 s5, s6, 8192
    v_lshlrev_b32 v5, 4, v5
    v_add_u32 v21, s5, v5
    s_add_u32 s5, s4, 6
    v_xor_b32 v5, s5, v1
    s_add_u32 s5, s6, 12288
    v_lshlrev_b32 v5, 4, v5
    v_add_u32 v22, s5, v5
    s_add_u32 s5, s4, 7
    v_xor_b32 v5, s5, v1
    s_add_u32 s5, s6, 12288
    v_lshlrev_b32 v5, 4, v5
    v_add_u32 v23, s5, v5
    s_cmp_eq_u32 s98, 2
    s_cselect_b32 s4, 11, 10
    s_cselect_b32 s5, 1, 4
    s_lshl_b32 s5, s5, 10
    s_lshl_b32 s4, s24, s4
    v_lshlrev_b32 v24, 4, v1
    v_add_u32 v24, s4, v24
    v_add_u32 v25, s5, v24
    v_mov_b32 v26, 0
    s_and_b32 s4, s99, 7
    s_lshl_b32 s4, s4, 13
    s_lshl_b32 s5, s24, 11
    s_add_u32 s4, s4, s5
    s_add_u32 s4, s4, 196608
    v_lshlrev_b32 v28, 5, v1
    v_add_u32 v28, s4, v28
    s_lshl_b32 s31, s98, 24
    s_lshl_b32 s4, s99, 13
    s_add_u32 s31, s31, s4
    s_mov_b32 s30, 75497472
    s_cmp_eq_u32 s98, 0
    s_cselect_b32 s28, 62, 0
    s_lshl_b32 s29, s28, 16
    s_waitcnt vmcnt(16)
    s_barrier
    ds_read_b64_tr_b16 a[0:1], v242 offset:0
    ds_read_b64_tr_b16 a[2:3], v242 offset:1024
    ds_read_b64_tr_b16 a[4:5], v242 offset:8
    ds_read_b64_tr_b16 a[6:7], v242 offset:1032
    ds_read_b64_tr_b16 a[8:9], v242 offset:8192
    ds_read_b64_tr_b16 a[10:11], v242 offset:9216
    ds_read_b64_tr_b16 a[12:13], v242 offset:8200
    ds_read_b64_tr_b16 a[14:15], v242 offset:9224
    ds_read_b64_tr_b16 a[16:17], v242 offset:16384
    ds_read_b64_tr_b16 a[18:19], v242 offset:17408
    ds_read_b64_tr_b16 a[20:21], v242 offset:16392
    ds_read_b64_tr_b16 a[22:23], v242 offset:17416
    ds_read_b64_tr_b16 a[24:25], v242 offset:24576
    ds_read_b64_tr_b16 a[26:27], v242 offset:25600
    ds_read_b64_tr_b16 a[28:29], v242 offset:24584
    ds_read_b64_tr_b16 a[30:31], v242 offset:25608
    ds_read_b64_tr_b16 a[32:33], v242 offset:32768
    ds_read_b64_tr_b16 a[34:35], v242 offset:33792
    ds_read_b64_tr_b16 a[36:37], v242 offset:32776
    ds_read_b64_tr_b16 a[38:39], v242 offset:33800
    ds_read_b64_tr_b16 a[40:41], v242 offset:40960
    ds_read_b64_tr_b16 a[42:43], v242 offset:41984
    ds_read_b64_tr_b16 a[44:45], v242 offset:40968
    ds_read_b64_tr_b16 a[46:47], v242 offset:41992
    ds_read_b64_tr_b16 a[48:49], v242 offset:49152
    ds_read_b64_tr_b16 a[50:51], v242 offset:50176
    ds_read_b64_tr_b16 a[52:53], v242 offset:49160
    ds_read_b64_tr_b16 a[54:55], v242 offset:50184
    ds_read_b64_tr_b16 a[56:57], v242 offset:57344
    ds_read_b64_tr_b16 a[58:59], v242 offset:58368
    ds_read_b64_tr_b16 a[60:61], v242 offset:57352
    ds_read_b64_tr_b16 a[62:63], v242 offset:58376
    s_waitcnt lgkmcnt(0)
    s_barrier
    s_add_u32 m0, s6, 0
    s_mov_b32 s5, 4194304
    buffer_load_dwordx4 v240, s[16:19], s5 offen nt lds
    s_add_u32 m0, s6, 1024
    s_mov_b32 s5, 4227072
    buffer_load_dwordx4 v240, s[16:19], s5 offen nt lds
    s_add_u32 m0, s6, 2048
    s_mov_b32 s5, 4259840
    buffer_load_dwordx4 v240, s[16:19], s5 offen nt lds
    s_add_u32 m0, s6, 3072
    s_mov_b32 s5, 4292608
    buffer_load_dwordx4 v240, s[16:19], s5 offen nt lds
    s_add_u32 m0, s6, 4096
    s_mov_b32 s5, 4325376
    buffer_load_dwordx4 v240, s[16:19], s5 offen nt lds
    s_add_u32 m0, s6, 5120
    s_mov_b32 s5, 4358144
    buffer_load_dwordx4 v240, s[16:19], s5 offen nt lds
    s_add_u32 m0, s6, 6144
    s_mov_b32 s5, 4390912
    buffer_load_dwordx4 v240, s[16:19], s5 offen nt lds
    s_add_u32 m0, s6, 7168
    s_mov_b32 s5, 4423680
    buffer_load_dwordx4 v240, s[16:19], s5 offen nt lds
    s_add_u32 m0, s6, 8192
    s_mov_b32 s5, 4456448
    buffer_load_dwordx4 v240, s[16:19], s5 offen nt lds
    s_add_u32 m0, s6, 9216
    s_mov_b32 s5, 4489216
    buffer_load_dwordx4 v240, s[16:19], s5 offen nt lds
    s_add_u32 m0, s6, 10240
    s_mov_b32 s5, 4521984
    buffer_load_dwordx4 v240, s[16:19], s5 offen nt lds
    s_add_u32 m0, s6, 11264
    s_mov_b32 s5, 4554752
    buffer_load_dwordx4 v240, s[16:19], s5 offen nt lds
    s_add_u32 m0, s6, 12288
    s_mov_b32 s5, 4587520
    buffer_load_dwordx4 v240, s[16:19], s5 offen nt lds
    s_add_u32 m0, s6, 13312
    s_mov_b32 s5, 4620288
    buffer_load_dwordx4 v240, s[16:19], s5 offen nt lds
    s_add_u32 m0, s6, 14336
    s_mov_b32 s5, 4653056
    buffer_load_dwordx4 v240, s[16:19], s5 offen nt lds
    s_add_u32 m0, s6, 15360
    s_mov_b32 s5, 4685824
    buffer_load_dwordx4 v240, s[16:19], s5 offen nt lds
    s_waitcnt vmcnt(16)
    s_lshl_b32 s4, s99, 9
    s_lshl_b32 s5, s24, 7
    s_add_u32 s4, s4, s5
    s_lshl_b32 s5, s98, 14
    s_add_u32 s4, s4, s5
    s_add_u32 s94, s4, 92274688
    s_add_u32 s4, s4, 76546048
    s_cmp_eq_u32 s98, 0
    s_cselect_b32 s94, s4, s94
    s_barrier
    ds_read_b64_tr_b16 a[64:65], v243 offset:0
    ds_read_b64_tr_b16 a[66:67], v243 offset:1024
    ds_read_b64_tr_b16 a[68:69], v243 offset:8
    ds_read_b64_tr_b16 a[70:71], v243 offset:1032
    ds_read_b64_tr_b16 a[72:73], v243 offset:8192
    ds_read_b64_tr_b16 a[74:75], v243 offset:9216
    ds_read_b64_tr_b16 a[76:77], v243 offset:8200
    ds_read_b64_tr_b16 a[78:79], v243 offset:9224
    ds_read_b64_tr_b16 a[80:81], v243 offset:16384
    ds_read_b64_tr_b16 a[82:83], v243 offset:17408
    ds_read_b64_tr_b16 a[84:85], v243 offset:16392
    ds_read_b64_tr_b16 a[86:87], v243 offset:17416
    ds_read_b64_tr_b16 a[88:89], v243 offset:24576
    ds_read_b64_tr_b16 a[90:91], v243 offset:25600
    ds_read_b64_tr_b16 a[92:93], v243 offset:24584
    ds_read_b64_tr_b16 a[94:95], v243 offset:25608
    ds_read_b64_tr_b16 a[96:97], v243 offset:32768
    ds_read_b64_tr_b16 a[98:99], v243 offset:33792
    ds_read_b64_tr_b16 a[100:101], v243 offset:32776
    ds_read_b64_tr_b16 a[102:103], v243 offset:33800
    ds_read_b64_tr_b16 a[104:105], v243 offset:40960
    ds_read_b64_tr_b16 a[106:107], v243 offset:41984
    ds_read_b64_tr_b16 a[108:109], v243 offset:40968
    ds_read_b64_tr_b16 a[110:111], v243 offset:41992
    ds_read_b64_tr_b16 a[112:113], v243 offset:49152
    ds_read_b64_tr_b16 a[114:115], v243 offset:50176
    ds_read_b64_tr_b16 a[116:117], v243 offset:49160
    ds_read_b64_tr_b16 a[118:119], v243 offset:50184
    ds_read_b64_tr_b16 a[120:121], v243 offset:57344
    ds_read_b64_tr_b16 a[122:123], v243 offset:58368
    ds_read_b64_tr_b16 a[124:125], v243 offset:57352
    ds_read_b64_tr_b16 a[126:127], v243 offset:58376
    s_waitcnt lgkmcnt(0)
    s_barrier
    v_or_b32 v239, 32, v1
    v_lshlrev_b32 v239, 2, v239
    buffer_load_dword v238, v239, s[20:23], 0 offen sc1
    s_add_u32 m0, s6, 65536
    s_mov_b32 s5, 6291456
    buffer_load_dwordx4 v240, s[16:19], s5 offen nt lds
    s_add_u32 m0, s6, 66560
    s_mov_b32 s5, 6324224
    buffer_load_dwordx4 v240, s[16:19], s5 offen nt lds
    s_add_u32 m0, s6, 67584
    s_mov_b32 s5, 6356992
    buffer_load_dwordx4 v240, s[16:19], s5 offen nt lds
    s_add_u32 m0, s6, 68608
    s_mov_b32 s5, 6389760
    buffer_load_dwordx4 v240, s[16:19], s5 offen nt lds
    s_add_u32 m0, s6, 69632
    s_mov_b32 s5, 6422528
    buffer_load_dwordx4 v240, s[16:19], s5 offen nt lds
    s_add_u32 m0, s6, 70656
    s_mov_b32 s5, 6455296
    buffer_load_dwordx4 v240, s[16:19], s5 offen nt lds
    s_add_u32 m0, s6, 71680
    s_mov_b32 s5, 6488064
    buffer_load_dwordx4 v240, s[16:19], s5 offen nt lds
    s_add_u32 m0, s6, 72704
    s_mov_b32 s5, 6520832
    buffer_load_dwordx4 v240, s[16:19], s5 offen nt lds
    s_add_u32 m0, s6, 73728
    s_mov_b32 s5, 6553600
    buffer_load_dwordx4 v240, s[16:19], s5 offen nt lds
    s_add_u32 m0, s6, 74752
    s_mov_b32 s5, 6586368
    buffer_load_dwordx4 v240, s[16:19], s5 offen nt lds
    s_add_u32 m0, s6, 75776
    s_mov_b32 s5, 6619136
    buffer_load_dwordx4 v240, s[16:19], s5 offen nt lds
    s_add_u32 m0, s6, 76800
    s_mov_b32 s5, 6651904
    buffer_load_dwordx4 v240, s[16:19], s5 offen nt lds
    s_add_u32 m0, s6, 77824
    s_mov_b32 s5, 6684672
    buffer_load_dwordx4 v240, s[16:19], s5 offen nt lds
    s_add_u32 m0, s6, 78848
    s_mov_b32 s5, 6717440
    buffer_load_dwordx4 v240, s[16:19], s5 offen nt lds
    s_add_u32 m0, s6, 79872
    s_mov_b32 s5, 6750208
    buffer_load_dwordx4 v240, s[16:19], s5 offen nt lds
    s_add_u32 m0, s6, 80896
    s_mov_b32 s5, 6782976
    buffer_load_dwordx4 v240, s[16:19], s5 offen nt lds
    s_cmp_lg_u32 s98, 0
    s_cbranch_scc1 .xt_397
    s_and_b32 s4, s99, 7
    s_lshl_b32 s4, s4, 2
    s_add_u32 s4, s4, s24
    s_mul_i32 s4, s4, 6144
    s_add_u32 s4, s4, 0
    v_lshlrev_b32 v30, 7, v1
    v_add_u32 v30, s4, v30
    buffer_load_dword v31, v30, s[12:15], 0 offen
.xt_397:
    s_waitcnt vmcnt(16)
    s_cmp_lg_u32 s27, 0
    s_cbranch_scc1 .vd_399
    s_mov_b32 s62, 0
.vp_398:
    v_readlane_b32 s4, v238, 49
    s_and_b32 s5, s4, 0xffff
    s_cmp_ge_u32 s5, 256
    s_cbranch_scc1 .va_400
    s_add_u32 s62, s62, 1
    s_cmp_gt_u32 s62, 0x100000
    s_cbranch_scc1 .mg_end_1
    s_sleep 16
    buffer_load_dword v238, v239, s[20:23], 0 offen sc1
    s_waitcnt vmcnt(0)
    s_branch .vp_398
.va_400:
    s_lshr_b32 s4, s4, 16
    s_cbranch_scc0 .vd_399
    s_lshr_b32 s25, s2, 5
    s_and_b32 s26, s2, 31
    s_mov_b32 s27, 1
    s_waitcnt vmcnt(0) lgkmcnt(0)
    s_barrier
    s_branch .mg_role_3
.vd_399:
    s_mov_b32 s63, 0
    s_cmp_lg_u32 s27, 0
    s_cbranch_scc1 .cd_402
    s_mov_b32 s62, 0
.cp_401:
    v_and_b32 v33, 0xffff, v238
    v_lshrrev_b32 v34, 16, v238
    v_min_u32 v32, v33, v34
    v_cmp_eq_u32 vcc, 0, v32
    s_and_b32 s4, vcc_hi, 65280
    s_cbranch_scc0 .cg_403
    s_add_u32 s62, s62, 1
    s_cmp_gt_u32 s62, 0x100000
    s_cbranch_scc1 .mg_end_1
    s_sleep 16
    buffer_load_dword v238, v239, s[20:23], 0 offen sc1
    s_waitcnt vmcnt(0)
    s_branch .cp_401
.cg_403:
    v_cmp_eq_u32 vcc, 2, v33
    s_bfe_u32 s63, vcc_hi, 524296
    v_cmp_eq_u32 vcc, 2, v34
    s_bfe_u32 s4, vcc_hi, 524296
    s_lshl_b32 s4, s4, 8
    s_or_b32 s63, s63, s4
    s_xor_b32 s4, s63, 0xaaaa
    s_bcnt1_i32_b32 s4, s4
    s_cmp_le_u32 s4, 3
    s_cselect_b32 s63, 0xaaaa, s63
    s_cmp_ge_u32 s4, 13
    s_cselect_b32 s63, 0x5555, s63
.cd_402:
    s_lshr_b32 s36, s99, 3
    s_and_b32 s37, s99, 7
    s_lshl_b32 s37, s37, 2
    s_add_u32 s37, s37, s24
    s_and_b32 s4, s36, 1
    s_lshl_b32 s35, s4, 14
    s_lshr_b32 s4, s36, 1
    s_lshl_b32 s4, s4, 12
    s_or_b32 s35, s35, s4
    s_and_b32 s4, s37, 1
    s_lshl_b32 s4, s4, 11
    s_or_b32 s35, s35, s4
    s_lshr_b32 s4, s37, 1
    s_lshl_b32 s4, s4, 15
    s_or_b32 s35, s35, s4
    s_and_b32 s4, s98, 1
    s_lshl_b32 s4, s4, 10
    s_add_u32 s4, s4, s101
    v_lshlrev_b32 v36, 4, v1
    v_add_u32 v36, s4, v36
    v_mov_b32 v32, -1
    v_mov_b32 v33, -1
    v_mov_b32 v34, -1
    v_mov_b32 v35, -1
    s_add_u32 s37, s28, 4
    s_bitcmp1_b32 s37, 0
    s_cselect_b32 s4, 0x84000, 0
    s_xor_b32 s34, s35, s4
    s_bitcmp1_b32 s37, 1
    s_cselect_b32 s4, 0x101000, 0
    s_xor_b32 s34, s34, s4
    s_lshr_b32 s37, s37, 2
    s_bitcmp1_b32 s63, s37
    s_cselect_b32 s4, 0x2000, 0
    s_xor_b32 s34, s34, s4
    s_lshl_b32 s37, s37, 21
    s_add_u32 s34, s34, s37
    s_barrier
    ds_read_b64_tr_b16 a[128:129], v242 offset:0
    ds_read_b64_tr_b16 a[130:131], v242 offset:1024
    ds_read_b64_tr_b16 a[132:133], v242 offset:8
    ds_read_b64_tr_b16 a[134:135], v242 offset:1032
    ds_read_b64_tr_b16 a[136:137], v242 offset:8192
    ds_read_b64_tr_b16 a[138:139], v242 offset:9216
    ds_read_b64_tr_b16 a[140:141], v242 offset:8200
    ds_read_b64_tr_b16 a[142:143], v242 offset:9224
    ds_read_b64_tr_b16 a[144:145], v242 offset:16384
    ds_read_b64_tr_b16 a[146:147], v242 offset:17408
    ds_read_b64_tr_b16 a[148:149], v242 offset:16392
    ds_read_b64_tr_b16 a[150:151], v242 offset:17416
    ds_read_b64_tr_b16 a[152:153], v242 offset:24576
    ds_read_b64_tr_b16 a[154:155], v242 offset:25600
    ds_read_b64_tr_b16 a[156:157], v242 offset:24584
    ds_read_b64_tr_b16 a[158:159], v242 offset:25608
    ds_read_b64_tr_b16 a[160:161], v242 offset:32768
    ds_read_b64_tr_b16 a[162:163], v242 offset:33792
    ds_read_b64_tr_b16 a[164:165], v242 offset:32776
    ds_read_b64_tr_b16 a[166:167], v242 offset:33800
    ds_read_b64_tr_b16 a[168:169], v242 offset:40960
    ds_read_b64_tr_b16 a[170:171], v242 offset:41984
    ds_read_b64_tr_b16 a[172:173], v242 offset:40968
    ds_read_b64_tr_b16 a[174:175], v242 offset:41992
    ds_read_b64_tr_b16 a[176:177], v242 offset:49152
    ds_read_b64_tr_b16 a[178:179], v242 offset:50176
    ds_read_b64_tr_b16 a[180:181], v242 offset:49160
    ds_read_b64_tr_b16 a[182:183], v242 offset:50184
    ds_read_b64_tr_b16 a[184:185], v242 offset:57344
    ds_read_b64_tr_b16 a[186:187], v242 offset:58368
    ds_read_b64_tr_b16 a[188:189], v242 offset:57352
    ds_read_b64_tr_b16 a[190:191], v242 offset:58376
    s_waitcnt lgkmcnt(0)
    s_barrier
    s_add_u32 m0, s6, 0
    s_nop 0
    buffer_load_dwordx4 v16, s[12:15], s29 offen offset:0 lds
    buffer_load_dwordx4 v16, s[12:15], s29 offen offset:1024 lds
    buffer_load_dwordx4 v17, s[12:15], s29 offen offset:2048 lds
    buffer_load_dwordx4 v17, s[12:15], s29 offen offset:3072 lds
    s_add_u32 m0, s6, 4096
    s_nop 0
    buffer_load_dwordx4 v18, s[12:15], s29 offen offset:0 lds
    buffer_load_dwordx4 v18, s[12:15], s29 offen offset:1024 lds
    buffer_load_dwordx4 v19, s[12:15], s29 offen offset:2048 lds
    buffer_load_dwordx4 v19, s[12:15], s29 offen offset:3072 lds
    s_add_u32 m0, s6, 8192
    s_nop 0
    buffer_load_dwordx4 v20, s[12:15], s29 offen offset:0 lds
    buffer_load_dwordx4 v20, s[12:15], s29 offen offset:1024 lds
    buffer_load_dwordx4 v21, s[12:15], s29 offen offset:2048 lds
    buffer_load_dwordx4 v21, s[12:15], s29 offen offset:3072 lds
    s_add_u32 m0, s6, 12288
    s_nop 0
    buffer_load_dwordx4 v22, s[12:15], s29 offen offset:0 lds
    buffer_load_dwordx4 v22, s[12:15], s29 offen offset:1024 lds
    buffer_load_dwordx4 v23, s[12:15], s29 offen offset:2048 lds
    buffer_load_dwordx4 v23, s[12:15], s29 offen offset:3072 lds
    s_waitcnt vmcnt(16)
    s_barrier
    ds_read_b64_tr_b16 a[192:193], v243 offset:0
    ds_read_b64_tr_b16 a[194:195], v243 offset:1024
    ds_read_b64_tr_b16 a[196:197], v243 offset:8
    ds_read_b64_tr_b16 a[198:199], v243 offset:1032
    ds_read_b64_tr_b16 a[200:201], v243 offset:8192
    ds_read_b64_tr_b16 a[202:203], v243 offset:9216
    ds_read_b64_tr_b16 a[204:205], v243 offset:8200
    ds_read_b64_tr_b16 a[206:207], v243 offset:9224
    ds_read_b64_tr_b16 a[208:209], v243 offset:16384
    ds_read_b64_tr_b16 a[210:211], v243 offset:17408
    ds_read_b64_tr_b16 a[212:213], v243 offset:16392
    ds_read_b64_tr_b16 a[214:215], v243 offset:17416
    ds_read_b64_tr_b16 a[216:217], v243 offset:24576
    ds_read_b64_tr_b16 a[218:219], v243 offset:25600
    ds_read_b64_tr_b16 a[220:221], v243 offset:24584
    ds_read_b64_tr_b16 a[222:223], v243 offset:25608
    ds_read_b64_tr_b16 a[224:225], v243 offset:32768
    ds_read_b64_tr_b16 a[226:227], v243 offset:33792
    ds_read_b64_tr_b16 a[228:229], v243 offset:32776
    ds_read_b64_tr_b16 a[230:231], v243 offset:33800
    ds_read_b64_tr_b16 a[232:233], v243 offset:40960
    ds_read_b64_tr_b16 a[234:235], v243 offset:41984
    ds_read_b64_tr_b16 a[236:237], v243 offset:40968
    ds_read_b64_tr_b16 a[238:239], v243 offset:41992
    ds_read_b64_tr_b16 a[240:241], v243 offset:49152
    ds_read_b64_tr_b16 a[242:243], v243 offset:50176
    ds_read_b64_tr_b16 a[244:245], v243 offset:49160
    ds_read_b64_tr_b16 a[246:247], v243 offset:50184
    ds_read_b64_tr_b16 a[248:249], v243 offset:57344
    ds_read_b64_tr_b16 a[250:251], v243 offset:58368
    ds_read_b64_tr_b16 a[252:253], v243 offset:57352
    ds_read_b64_tr_b16 a[254:255], v243 offset:58376
    s_waitcnt lgkmcnt(0)
    s_barrier
    s_waitcnt vmcnt(0)
    s_barrier
    s_add_u32 s29, s29, 0x10000
    ds_read_b128 v[64:67], v8 offset:0
    ds_read_b128 v[68:71], v8 offset:32768
    ds_read_b128 v[72:75], v9 offset:0
    ds_read_b128 v[76:79], v9 offset:32768
    ds_read_b128 v[80:83], v10 offset:0
    ds_read_b128 v[84:87], v10 offset:32768
    ds_read_b128 v[88:91], v11 offset:0
    ds_read_b128 v[92:95], v11 offset:32768
    ds_read_b128 v[96:99], v8 offset:256
    ds_read_b128 v[100:103], v8 offset:33024
    ds_read_b128 v[104:107], v9 offset:256
    ds_read_b128 v[108:111], v9 offset:33024
    ds_read_b128 v[112:115], v10 offset:256
    ds_read_b128 v[116:119], v10 offset:33024
    ds_read_b128 v[120:123], v11 offset:256
    ds_read_b128 v[124:127], v11 offset:33024
    s_add_u32 m0, s6, 65536
    s_nop 0
    buffer_load_dwordx4 v16, s[12:15], s29 offen offset:0 lds
    buffer_load_dwordx4 v16, s[12:15], s29 offen offset:1024 lds
    buffer_load_dwordx4 v17, s[12:15], s29 offen offset:2048 lds
    buffer_load_dwordx4 v17, s[12:15], s29 offen offset:3072 lds
    s_add_u32 m0, s6, 69632
    s_nop 0
    buffer_load_dwordx4 v18, s[12:15], s29 offen offset:0 lds
    buffer_load_dwordx4 v18, s[12:15], s29 offen offset:1024 lds
    s_cmp_eq_u32 s98, 2
    s_cbranch_scc1 .vt_405
.p2align 6
.ql_407:
    s_waitcnt lgkmcnt(12)
    v_mfma_f32_16x16x32_bf16 v[192:195], a[0:3], v[64:67], 0
    ds_read_b128 v[128:131], v8 offset:512
    v_mfma_f32_16x16x32_bf16 v[196:199], a[4:7], v[64:67], 0
    v_mfma_f32_16x16x32_bf16 v[200:203], a[0:3], v[68:71], 0
    ds_read_b128 v[132:135], v8 offset:33280
    v_mfma_f32_16x16x32_bf16 v[204:207], a[4:7], v[68:71], 0
    buffer_load_dwordx4 v19, s[12:15], s29 offen offset:2048 lds
    v_mfma_f32_16x16x32_bf16 v[192:195], a[8:11], v[72:75], v[192:195]
    ds_read_b128 v[136:139], v9 offset:512
    v_mfma_f32_16x16x32_bf16 v[196:199], a[12:15], v[72:75], v[196:199]
    v_cvt_pk_bf16_f32 v224, v208, v209
    v_cvt_pk_bf16_f32 v225, v210, v211
    v_mfma_f32_16x16x32_bf16 v[200:203], a[8:11], v[76:79], v[200:203]
    ds_read_b128 v[140:143], v9 offset:33280
    v_mfma_f32_16x16x32_bf16 v[204:207], a[12:15], v[76:79], v[204:207]
    buffer_load_dwordx4 v19, s[12:15], s29 offen offset:3072 lds
    s_waitcnt lgkmcnt(12)
    v_mfma_f32_16x16x32_bf16 v[192:195], a[16:19], v[80:83], v[192:195]
    ds_read_b128 v[144:147], v10 offset:512
    v_mfma_f32_16x16x32_bf16 v[196:199], a[20:23], v[80:83], v[196:199]
    s_add_u32 m0, s6, 73728
    v_cvt_pk_bf16_f32 v226, v212, v213
    v_cvt_pk_bf16_f32 v227, v214, v215
    v_mfma_f32_16x16x32_bf16 v[200:203], a[16:19], v[84:87], v[200:203]
    ds_read_b128 v[148:151], v10 offset:33280
    v_mfma_f32_16x16x32_bf16 v[204:207], a[20:23], v[84:87], v[204:207]
    buffer_load_dwordx4 v20, s[12:15], s29 offen offset:0 lds
    v_mfma_f32_16x16x32_bf16 v[192:195], a[24:27], v[88:91], v[192:195]
    ds_read_b128 v[152:155], v11 offset:512
    v_cvt_pk_bf16_f32 v228, v216, v217
    v_mfma_f32_16x16x32_bf16 v[196:199], a[28:31], v[88:91], v[196:199]
    buffer_store_dwordx4 v[224:227], v24, s[8:11], s30 offen sc1
    v_mfma_f32_16x16x32_bf16 v[200:203], a[24:27], v[92:95], v[200:203]
    ds_read_b128 v[156:159], v11 offset:33280
    v_cvt_pk_bf16_f32 v229, v218, v219
    v_mfma_f32_16x16x32_bf16 v[204:207], a[28:31], v[92:95], v[204:207]
    buffer_load_dwordx4 v20, s[12:15], s29 offen offset:1024 lds
    s_waitcnt lgkmcnt(12)
    v_mfma_f32_16x16x32_bf16 v[192:195], a[32:35], v[96:99], v[192:195]
    ds_read_b128 v[160:163], v8 offset:768
    v_mfma_f32_16x16x32_bf16 v[196:199], a[36:39], v[96:99], v[196:199]
    v_cvt_pk_bf16_f32 v230, v220, v221
    v_cvt_pk_bf16_f32 v231, v222, v223
    v_mfma_f32_16x16x32_bf16 v[200:203], a[32:35], v[100:103], v[200:203]
    ds_read_b128 v[164:167], v8 offset:33536
    v_mfma_f32_16x16x32_bf16 v[204:207], a[36:39], v[100:103], v[204:207]
    buffer_load_dwordx4 v21, s[12:15], s29 offen offset:2048 lds
    v_mfma_f32_16x16x32_bf16 v[192:195], a[40:43], v[104:107], v[192:195]
    ds_read_b128 v[168:171], v9 offset:768
    v_mfma_f32_16x16x32_bf16 v[196:199], a[44:47], v[104:107], v[196:199]
    buffer_store_dwordx4 v[228:231], v25, s[8:11], s30 offen sc1
    v_mfma_f32_16x16x32_bf16 v[200:203], a[40:43], v[108:111], v[200:203]
    ds_read_b128 v[172:175], v9 offset:33536
    v_mfma_f32_16x16x32_bf16 v[204:207], a[44:47], v[108:111], v[204:207]
    buffer_load_dwordx4 v21, s[12:15], s29 offen offset:3072 lds
    s_waitcnt lgkmcnt(12)
    v_mfma_f32_16x16x32_bf16 v[192:195], a[48:51], v[112:115], v[192:195]
    ds_read_b128 v[176:179], v10 offset:768
    v_mfma_f32_16x16x32_bf16 v[196:199], a[52:55], v[112:115], v[196:199]
    s_add_u32 m0, s6, 77824
    s_mov_b32 s30, s31
    v_mfma_f32_16x16x32_bf16 v[200:203], a[48:51], v[116:119], v[200:203]
    ds_read_b128 v[180:183], v10 offset:33536
    v_mfma_f32_16x16x32_bf16 v[204:207], a[52:55], v[116:119], v[204:207]
    buffer_load_dwordx4 v22, s[12:15], s29 offen offset:0 lds
    v_mfma_f32_16x16x32_bf16 v[192:195], a[56:59], v[120:123], v[192:195]
    ds_read_b128 v[184:187], v11 offset:768
    v_mfma_f32_16x16x32_bf16 v[196:199], a[60:63], v[120:123], v[196:199]
    s_add_u32 s31, s31, 262144
    v_mfma_f32_16x16x32_bf16 v[200:203], a[56:59], v[124:127], v[200:203]
    ds_read_b128 v[188:191], v11 offset:33536
    v_mfma_f32_16x16x32_bf16 v[204:207], a[60:63], v[124:127], v[204:207]
    buffer_load_dwordx4 v22, s[12:15], s29 offen offset:1024 lds
    s_waitcnt lgkmcnt(12)
    v_mfma_f32_16x16x32_bf16 v[192:195], a[64:67], v[128:131], v[192:195]
    ds_read_b128 v[64:67], v8 offset:1024
    v_mfma_f32_16x16x32_bf16 v[196:199], a[68:71], v[128:131], v[196:199]
    v_mfma_f32_16x16x32_bf16 v[200:203], a[64:67], v[132:135], v[200:203]
    ds_read_b128 v[68:71], v8 offset:33792
    v_mfma_f32_16x16x32_bf16 v[204:207], a[68:71], v[132:135], v[204:207]
    buffer_load_dwordx4 v23, s[12:15], s29 offen offset:2048 lds
    v_mfma_f32_16x16x32_bf16 v[192:195], a[72:75], v[136:139], v[192:195]
    ds_read_b128 v[72:75], v9 offset:1024
    v_mfma_f32_16x16x32_bf16 v[196:199], a[76:79], v[136:139], v[196:199]
    v_mfma_f32_16x16x32_bf16 v[200:203], a[72:75], v[140:143], v[200:203]
    ds_read_b128 v[76:79], v9 offset:33792
    v_mfma_f32_16x16x32_bf16 v[204:207], a[76:79], v[140:143], v[204:207]
    buffer_load_dwordx4 v23, s[12:15], s29 offen offset:3072 lds
    s_waitcnt lgkmcnt(12)
    v_mfma_f32_16x16x32_bf16 v[192:195], a[80:83], v[144:147], v[192:195]
    ds_read_b128 v[80:83], v10 offset:1024
    v_mfma_f32_16x16x32_bf16 v[196:199], a[84:87], v[144:147], v[196:199]
    v_mfma_f32_16x16x32_bf16 v[200:203], a[80:83], v[148:151], v[200:203]
    ds_read_b128 v[84:87], v10 offset:33792
    v_mfma_f32_16x16x32_bf16 v[204:207], a[84:87], v[148:151], v[204:207]
    buffer_load_dword v29, v28, s[12:15], s29 offen
    v_mfma_f32_16x16x32_bf16 v[192:195], a[88:91], v[152:155], v[192:195]
    ds_read_b128 v[88:91], v11 offset:1024
    v_mfma_f32_16x16x32_bf16 v[196:199], a[92:95], v[152:155], v[196:199]
    v_mfma_f32_16x16x32_bf16 v[200:203], a[88:91], v[156:159], v[200:203]
    ds_read_b128 v[92:95], v11 offset:33792
    v_mfma_f32_16x16x32_bf16 v[204:207], a[92:95], v[156:159], v[204:207]
    buffer_store_dwordx4 v[32:35], v36, s[8:11], s34 offen sc1
    s_waitcnt lgkmcnt(12)
    v_mfma_f32_16x16x32_bf16 v[192:195], a[96:99], v[160:163], v[192:195]
    ds_read_b128 v[96:99], v8 offset:1280
    v_mfma_f32_16x16x32_bf16 v[196:199], a[100:103], v[160:163], v[196:199]
    v_mfma_f32_16x16x32_bf16 v[200:203], a[96:99], v[164:167], v[200:203]
    ds_read_b128 v[100:103], v8 offset:34048
    v_mfma_f32_16x16x32_bf16 v[204:207], a[100:103], v[164:167], v[204:207]
    v_mfma_f32_16x16x32_bf16 v[192:195], a[104:107], v[168:171], v[192:195]
    ds_read_b128 v[104:107], v9 offset:1280
    v_mfma_f32_16x16x32_bf16 v[196:199], a[108:111], v[168:171], v[196:199]
    v_mfma_f32_16x16x32_bf16 v[200:203], a[104:107], v[172:175], v[200:203]
    ds_read_b128 v[108:111], v9 offset:34048
    v_mfma_f32_16x16x32_bf16 v[204:207], a[108:111], v[172:175], v[204:207]
    s_waitcnt lgkmcnt(12)
    v_mfma_f32_16x16x32_bf16 v[192:195], a[112:115], v[176:179], v[192:195]
    ds_read_b128 v[112:115], v10 offset:1280
    v_mfma_f32_16x16x32_bf16 v[196:199], a[116:119], v[176:179], v[196:199]
    v_mfma_f32_16x16x32_bf16 v[200:203], a[112:115], v[180:183], v[200:203]
    ds_read_b128 v[116:119], v10 offset:34048
    v_mfma_f32_16x16x32_bf16 v[204:207], a[116:119], v[180:183], v[204:207]
    v_mfma_f32_16x16x32_bf16 v[192:195], a[120:123], v[184:187], v[192:195]
    ds_read_b128 v[120:123], v11 offset:1280
    v_mfma_f32_16x16x32_bf16 v[196:199], a[124:127], v[184:187], v[196:199]
    v_mfma_f32_16x16x32_bf16 v[200:203], a[120:123], v[188:191], v[200:203]
    ds_read_b128 v[124:127], v11 offset:34048
    v_mfma_f32_16x16x32_bf16 v[204:207], a[124:127], v[188:191], v[204:207]
    s_waitcnt lgkmcnt(12)
    v_mfma_f32_16x16x32_bf16 v[192:195], a[128:131], v[64:67], v[192:195]
    ds_read_b128 v[128:131], v8 offset:1536
    v_mfma_f32_16x16x32_bf16 v[196:199], a[132:135], v[64:67], v[196:199]
    v_mfma_f32_16x16x32_bf16 v[200:203], a[128:131], v[68:71], v[200:203]
    ds_read_b128 v[132:135], v8 offset:34304
    v_mfma_f32_16x16x32_bf16 v[204:207], a[132:135], v[68:71], v[204:207]
    v_mfma_f32_16x16x32_bf16 v[192:195], a[136:139], v[72:75], v[192:195]
    ds_read_b128 v[136:139], v9 offset:1536
    v_mfma_f32_16x16x32_bf16 v[196:199], a[140:143], v[72:75], v[196:199]
    s_add_u32 s37, s28, 5
    v_mfma_f32_16x16x32_bf16 v[200:203], a[136:139], v[76:79], v[200:203]
    ds_read_b128 v[140:143], v9 offset:34304
    v_mfma_f32_16x16x32_bf16 v[204:207], a[140:143], v[76:79], v[204:207]
    s_bitcmp1_b32 s37, 0
    s_cselect_b32 s4, 0x84000, 0
    s_waitcnt lgkmcnt(12)
    v_mfma_f32_16x16x32_bf16 v[192:195], a[144:147], v[80:83], v[192:195]
    ds_read_b128 v[144:147], v10 offset:1536
    v_mfma_f32_16x16x32_bf16 v[196:199], a[148:151], v[80:83], v[196:199]
    s_xor_b32 s34, s35, s4
    v_mfma_f32_16x16x32_bf16 v[200:203], a[144:147], v[84:87], v[200:203]
    ds_read_b128 v[148:151], v10 offset:34304
    v_mfma_f32_16x16x32_bf16 v[204:207], a[148:151], v[84:87], v[204:207]
    s_bitcmp1_b32 s37, 1
    s_cselect_b32 s4, 0x101000, 0
    v_mfma_f32_16x16x32_bf16 v[192:195], a[152:155], v[88:91], v[192:195]
    ds_read_b128 v[152:155], v11 offset:1536
    v_mfma_f32_16x16x32_bf16 v[196:199], a[156:159], v[88:91], v[196:199]
    s_xor_b32 s34, s34, s4
    s_lshr_b32 s37, s37, 2
    v_mfma_f32_16x16x32_bf16 v[200:203], a[152:155], v[92:95], v[200:203]
    ds_read_b128 v[156:159], v11 offset:34304
    v_mfma_f32_16x16x32_bf16 v[204:207], a[156:159], v[92:95], v[204:207]
    s_bitcmp1_b32 s63, s37
    s_cselect_b32 s4, 0x2000, 0
    s_waitcnt lgkmcnt(12)
    v_mfma_f32_16x16x32_bf16 v[192:195], a[160:163], v[96:99], v[192:195]
    ds_read_b128 v[160:163], v8 offset:1792
    v_mfma_f32_16x16x32_bf16 v[196:199], a[164:167], v[96:99], v[196:199]
    s_xor_b32 s34, s34, s4
    s_lshl_b32 s37, s37, 21
    v_mfma_f32_16x16x32_bf16 v[200:203], a[160:163], v[100:103], v[200:203]
    ds_read_b128 v[164:167], v8 offset:34560
    v_mfma_f32_16x16x32_bf16 v[204:207], a[164:167], v[100:103], v[204:207]
    s_add_u32 s34, s34, s37
    v_mfma_f32_16x16x32_bf16 v[192:195], a[168:171], v[104:107], v[192:195]
    ds_read_b128 v[168:171], v9 offset:1792
    v_mfma_f32_16x16x32_bf16 v[196:199], a[172:175], v[104:107], v[196:199]
    v_mfma_f32_16x16x32_bf16 v[200:203], a[168:171], v[108:111], v[200:203]
    ds_read_b128 v[172:175], v9 offset:34560
    v_mfma_f32_16x16x32_bf16 v[204:207], a[172:175], v[108:111], v[204:207]
    s_waitcnt lgkmcnt(12)
    v_mfma_f32_16x16x32_bf16 v[192:195], a[176:179], v[112:115], v[192:195]
    ds_read_b128 v[176:179], v10 offset:1792
    v_mfma_f32_16x16x32_bf16 v[196:199], a[180:183], v[112:115], v[196:199]
    s_waitcnt vmcnt(7)
    v_mov_b32 v27, s28
    s_mov_b64 exec, 1
    buffer_store_dword v27, v26, s[8:11], s94 offen sc1
    s_mov_b64 exec, -1
    v_mfma_f32_16x16x32_bf16 v[200:203], a[176:179], v[116:119], v[200:203]
    ds_read_b128 v[180:183], v10 offset:34560
    v_mfma_f32_16x16x32_bf16 v[204:207], a[180:183], v[116:119], v[204:207]
    v_mfma_f32_16x16x32_bf16 v[192:195], a[184:187], v[120:123], v[192:195]
    ds_read_b128 v[184:187], v11 offset:1792
    v_mfma_f32_16x16x32_bf16 v[196:199], a[188:191], v[120:123], v[196:199]
    s_add_u32 s28, s28, 1
    v_mfma_f32_16x16x32_bf16 v[200:203], a[184:187], v[124:127], v[200:203]
    ds_read_b128 v[188:191], v11 offset:34560
    v_mfma_f32_16x16x32_bf16 v[204:207], a[188:191], v[124:127], v[204:207]
    s_waitcnt lgkmcnt(12)
    v_mfma_f32_16x16x32_bf16 v[192:195], a[192:195], v[128:131], v[192:195]
    v_mfma_f32_16x16x32_bf16 v[196:199], a[196:199], v[128:131], v[196:199]
    v_mfma_f32_16x16x32_bf16 v[200:203], a[192:195], v[132:135], v[200:203]
    v_mfma_f32_16x16x32_bf16 v[204:207], a[196:199], v[132:135], v[204:207]
    v_mfma_f32_16x16x32_bf16 v[192:195], a[200:203], v[136:139], v[192:195]
    v_mfma_f32_16x16x32_bf16 v[196:199], a[204:207], v[136:139], v[196:199]
    s_add_u32 s29, s29, 0x10000
    s_and_b32 s29, s29, 0x3fffff
    v_mfma_f32_16x16x32_bf16 v[200:203], a[200:203], v[140:143], v[200:203]
    v_mfma_f32_16x16x32_bf16 v[204:207], a[204:207], v[140:143], v[204:207]
    s_waitcnt vmcnt(3) lgkmcnt(0)
    s_barrier
    v_mfma_f32_16x16x32_bf16 v[192:195], a[208:211], v[144:147], v[192:195]
    ds_read_b128 v[64:67], v12 offset:0
    ds_read_b128 v[68:71], v12 offset:32768
    v_mfma_f32_16x16x32_bf16 v[196:199], a[212:215], v[144:147], v[196:199]
    s_add_u32 m0, s6, 0
    v_mfma_f32_16x16x32_bf16 v[200:203], a[208:211], v[148:151], v[200:203]
    ds_read_b128 v[72:75], v13 offset:0
    ds_read_b128 v[76:79], v13 offset:32768
    v_mfma_f32_16x16x32_bf16 v[204:207], a[212:215], v[148:151], v[204:207]
    buffer_load_dwordx4 v16, s[12:15], s29 offen offset:0 lds
    v_mfma_f32_16x16x32_bf16 v[192:195], a[216:219], v[152:155], v[192:195]
    ds_read_b128 v[80:83], v14 offset:0
    ds_read_b128 v[84:87], v14 offset:32768
    v_mfma_f32_16x16x32_bf16 v[196:199], a[220:223], v[152:155], v[196:199]
    v_mfma_f32_16x16x32_bf16 v[200:203], a[216:219], v[156:159], v[200:203]
    ds_read_b128 v[88:91], v15 offset:0
    ds_read_b128 v[92:95], v15 offset:32768
    v_mfma_f32_16x16x32_bf16 v[204:207], a[220:223], v[156:159], v[204:207]
    buffer_load_dwordx4 v16, s[12:15], s29 offen offset:1024 lds
    v_mfma_f32_16x16x32_bf16 v[192:195], a[224:227], v[160:163], v[192:195]
    ds_read_b128 v[96:99], v12 offset:256
    v_mfma_f32_16x16x32_bf16 v[196:199], a[228:231], v[160:163], v[196:199]
    v_mfma_f32_16x16x32_bf16 v[200:203], a[224:227], v[164:167], v[200:203]
    ds_read_b128 v[100:103], v12 offset:33024
    v_mfma_f32_16x16x32_bf16 v[204:207], a[228:231], v[164:167], v[204:207]
    buffer_load_dwordx4 v17, s[12:15], s29 offen offset:2048 lds
    v_mfma_f32_16x16x32_bf16 v[192:195], a[232:235], v[168:171], v[192:195]
    ds_read_b128 v[104:107], v13 offset:256
    v_mfma_f32_16x16x32_bf16 v[196:199], a[236:239], v[168:171], v[196:199]
    v_mfma_f32_16x16x32_bf16 v[200:203], a[232:235], v[172:175], v[200:203]
    ds_read_b128 v[108:111], v13 offset:33024
    v_mfma_f32_16x16x32_bf16 v[204:207], a[236:239], v[172:175], v[204:207]
    buffer_load_dwordx4 v17, s[12:15], s29 offen offset:3072 lds
    v_mfma_f32_16x16x32_bf16 v[192:195], a[240:243], v[176:179], v[192:195]
    ds_read_b128 v[112:115], v14 offset:256
    v_mfma_f32_16x16x32_bf16 v[196:199], a[244:247], v[176:179], v[196:199]
    s_add_u32 m0, s6, 4096
    v_mfma_f32_16x16x32_bf16 v[200:203], a[240:243], v[180:183], v[200:203]
    ds_read_b128 v[116:119], v14 offset:33024
    v_mfma_f32_16x16x32_bf16 v[204:207], a[244:247], v[180:183], v[204:207]
    buffer_load_dwordx4 v18, s[12:15], s29 offen offset:0 lds
    v_mfma_f32_16x16x32_bf16 v[192:195], a[248:251], v[184:187], v[192:195]
    ds_read_b128 v[120:123], v15 offset:256
    v_mfma_f32_16x16x32_bf16 v[196:199], a[252:255], v[184:187], v[196:199]
    v_mfma_f32_16x16x32_bf16 v[200:203], a[248:251], v[188:191], v[200:203]
    ds_read_b128 v[124:127], v15 offset:33024
    v_mfma_f32_16x16x32_bf16 v[204:207], a[252:255], v[188:191], v[204:207]
    buffer_load_dwordx4 v18, s[12:15], s29 offen offset:1024 lds
    s_waitcnt lgkmcnt(12)
    v_mfma_f32_16x16x32_bf16 v[208:211], a[0:3], v[64:67], 0
    ds_read_b128 v[128:131], v12 offset:512
    v_mfma_f32_16x16x32_bf16 v[212:215], a[4:7], v[64:67], 0
    v_mfma_f32_16x16x32_bf16 v[216:219], a[0:3], v[68:71], 0
    ds_read_b128 v[132:135], v12 offset:33280
    v_mfma_f32_16x16x32_bf16 v[220:223], a[4:7], v[68:71], 0
    buffer_load_dwordx4 v19, s[12:15], s29 offen offset:2048 lds
    v_mfma_f32_16x16x32_bf16 v[208:211], a[8:11], v[72:75], v[208:211]
    ds_read_b128 v[136:139], v13 offset:512
    v_mfma_f32_16x16x32_bf16 v[212:215], a[12:15], v[72:75], v[212:215]
    v_cvt_pk_bf16_f32 v224, v192, v193
    v_cvt_pk_bf16_f32 v225, v194, v195
    v_mfma_f32_16x16x32_bf16 v[216:219], a[8:11], v[76:79], v[216:219]
    ds_read_b128 v[140:143], v13 offset:33280
    v_mfma_f32_16x16x32_bf16 v[220:223], a[12:15], v[76:79], v[220:223]
    buffer_load_dwordx4 v19, s[12:15], s29 offen offset:3072 lds
    s_waitcnt lgkmcnt(12)
    v_mfma_f32_16x16x32_bf16 v[208:211], a[16:19], v[80:83], v[208:211]
    ds_read_b128 v[144:147], v14 offset:512
    v_mfma_f32_16x16x32_bf16 v[212:215], a[20:23], v[80:83], v[212:215]
    s_add_u32 m0, s6, 8192
    v_cvt_pk_bf16_f32 v226, v196, v197
    v_cvt_pk_bf16_f32 v227, v198, v199
    v_mfma_f32_16x16x32_bf16 v[216:219], a[16:19], v[84:87], v[216:219]
    ds_read_b128 v[148:151], v14 offset:33280
    v_mfma_f32_16x16x32_bf16 v[220:223], a[20:23], v[84:87], v[220:223]
    buffer_load_dwordx4 v20, s[12:15], s29 offen offset:0 lds
    v_mfma_f32_16x16x32_bf16 v[208:211], a[24:27], v[88:91], v[208:211]
    ds_read_b128 v[152:155], v15 offset:512
    v_cvt_pk_bf16_f32 v228, v200, v201
    v_mfma_f32_16x16x32_bf16 v[212:215], a[28:31], v[88:91], v[212:215]
    buffer_store_dwordx4 v[224:227], v24, s[8:11], s30 offen sc1
    v_mfma_f32_16x16x32_bf16 v[216:219], a[24:27], v[92:95], v[216:219]
    ds_read_b128 v[156:159], v15 offset:33280
    v_cvt_pk_bf16_f32 v229, v202, v203
    v_mfma_f32_16x16x32_bf16 v[220:223], a[28:31], v[92:95], v[220:223]
    buffer_load_dwordx4 v20, s[12:15], s29 offen offset:1024 lds
    s_waitcnt lgkmcnt(12)
    v_mfma_f32_16x16x32_bf16 v[208:211], a[32:35], v[96:99], v[208:211]
    ds_read_b128 v[160:163], v12 offset:768
    v_mfma_f32_16x16x32_bf16 v[212:215], a[36:39], v[96:99], v[212:215]
    v_cvt_pk_bf16_f32 v230, v204, v205
    v_cvt_pk_bf16_f32 v231, v206, v207
    v_mfma_f32_16x16x32_bf16 v[216:219], a[32:35], v[100:103], v[216:219]
    ds_read_b128 v[164:167], v12 offset:33536
    v_mfma_f32_16x16x32_bf16 v[220:223], a[36:39], v[100:103], v[220:223]
    buffer_load_dwordx4 v21, s[12:15], s29 offen offset:2048 lds
    v_mfma_f32_16x16x32_bf16 v[208:211], a[40:43], v[104:107], v[208:211]
    ds_read_b128 v[168:171], v13 offset:768
    v_mfma_f32_16x16x32_bf16 v[212:215], a[44:47], v[104:107], v[212:215]
    buffer_store_dwordx4 v[228:231], v25, s[8:11], s30 offen sc1
    v_mfma_f32_16x16x32_bf16 v[216:219], a[40:43], v[108:111], v[216:219]
    ds_read_b128 v[172:175], v13 offset:33536
    v_mfma_f32_16x16x32_bf16 v[220:223], a[44:47], v[108:111], v[220:223]
    buffer_load_dwordx4 v21, s[12:15], s29 offen offset:3072 lds
    s_waitcnt lgkmcnt(12)
    v_mfma_f32_16x16x32_bf16 v[208:211], a[48:51], v[112:115], v[208:211]
    ds_read_b128 v[176:179], v14 offset:768
    v_mfma_f32_16x16x32_bf16 v[212:215], a[52:55], v[112:115], v[212:215]
    s_add_u32 m0, s6, 12288
    s_mov_b32 s30, s31
    v_mfma_f32_16x16x32_bf16 v[216:219], a[48:51], v[116:119], v[216:219]
    ds_read_b128 v[180:183], v14 offset:33536
    v_mfma_f32_16x16x32_bf16 v[220:223], a[52:55], v[116:119], v[220:223]
    buffer_load_dwordx4 v22, s[12:15], s29 offen offset:0 lds
    v_mfma_f32_16x16x32_bf16 v[208:211], a[56:59], v[120:123], v[208:211]
    ds_read_b128 v[184:187], v15 offset:768
    v_mfma_f32_16x16x32_bf16 v[212:215], a[60:63], v[120:123], v[212:215]
    s_add_u32 s31, s31, 262144
    v_mfma_f32_16x16x32_bf16 v[216:219], a[56:59], v[124:127], v[216:219]
    ds_read_b128 v[188:191], v15 offset:33536
    v_mfma_f32_16x16x32_bf16 v[220:223], a[60:63], v[124:127], v[220:223]
    buffer_load_dwordx4 v22, s[12:15], s29 offen offset:1024 lds
    s_waitcnt lgkmcnt(12)
    v_mfma_f32_16x16x32_bf16 v[208:211], a[64:67], v[128:131], v[208:211]
    ds_read_b128 v[64:67], v12 offset:1024
    v_mfma_f32_16x16x32_bf16 v[212:215], a[68:71], v[128:131], v[212:215]
    v_mfma_f32_16x16x32_bf16 v[216:219], a[64:67], v[132:135], v[216:219]
    ds_read_b128 v[68:71], v12 offset:33792
    v_mfma_f32_16x16x32_bf16 v[220:223], a[68:71], v[132:135], v[220:223]
    buffer_load_dwordx4 v23, s[12:15], s29 offen offset:2048 lds
    v_mfma_f32_16x16x32_bf16 v[208:211], a[72:75], v[136:139], v[208:211]
    ds_read_b128 v[72:75], v13 offset:1024
    v_mfma_f32_16x16x32_bf16 v[212:215], a[76:79], v[136:139], v[212:215]
    v_mfma_f32_16x16x32_bf16 v[216:219], a[72:75], v[140:143], v[216:219]
    ds_read_b128 v[76:79], v13 offset:33792
    v_mfma_f32_16x16x32_bf16 v[220:223], a[76:79], v[140:143], v[220:223]
    buffer_load_dwordx4 v23, s[12:15], s29 offen offset:3072 lds
    s_waitcnt lgkmcnt(12)
    v_mfma_f32_16x16x32_bf16 v[208:211], a[80:83], v[144:147], v[208:211]
    ds_read_b128 v[80:83], v14 offset:1024
    v_mfma_f32_16x16x32_bf16 v[212:215], a[84:87], v[144:147], v[212:215]
    v_mfma_f32_16x16x32_bf16 v[216:219], a[80:83], v[148:151], v[216:219]
    ds_read_b128 v[84:87], v14 offset:33792
    v_mfma_f32_16x16x32_bf16 v[220:223], a[84:87], v[148:151], v[220:223]
    buffer_load_dword v29, v28, s[12:15], s29 offen
    v_mfma_f32_16x16x32_bf16 v[208:211], a[88:91], v[152:155], v[208:211]
    ds_read_b128 v[88:91], v15 offset:1024
    v_mfma_f32_16x16x32_bf16 v[212:215], a[92:95], v[152:155], v[212:215]
    v_mfma_f32_16x16x32_bf16 v[216:219], a[88:91], v[156:159], v[216:219]
    ds_read_b128 v[92:95], v15 offset:33792
    v_mfma_f32_16x16x32_bf16 v[220:223], a[92:95], v[156:159], v[220:223]
    buffer_store_dwordx4 v[32:35], v36, s[8:11], s34 offen sc1
    s_waitcnt lgkmcnt(12)
    v_mfma_f32_16x16x32_bf16 v[208:211], a[96:99], v[160:163], v[208:211]
    ds_read_b128 v[96:99], v12 offset:1280
    v_mfma_f32_16x16x32_bf16 v[212:215], a[100:103], v[160:163], v[212:215]
    v_mfma_f32_16x16x32_bf16 v[216:219], a[96:99], v[164:167], v[216:219]
    ds_read_b128 v[100:103], v12 offset:34048
    v_mfma_f32_16x16x32_bf16 v[220:223], a[100:103], v[164:167], v[220:223]
    v_mfma_f32_16x16x32_bf16 v[208:211], a[104:107], v[168:171], v[208:211]
    ds_read_b128 v[104:107], v13 offset:1280
    v_mfma_f32_16x16x32_bf16 v[212:215], a[108:111], v[168:171], v[212:215]
    v_mfma_f32_16x16x32_bf16 v[216:219], a[104:107], v[172:175], v[216:219]
    ds_read_b128 v[108:111], v13 offset:34048
    v_mfma_f32_16x16x32_bf16 v[220:223], a[108:111], v[172:175], v[220:223]
    s_waitcnt lgkmcnt(12)
    v_mfma_f32_16x16x32_bf16 v[208:211], a[112:115], v[176:179], v[208:211]
    ds_read_b128 v[112:115], v14 offset:1280
    v_mfma_f32_16x16x32_bf16 v[212:215], a[116:119], v[176:179], v[212:215]
    v_mfma_f32_16x16x32_bf16 v[216:219], a[112:115], v[180:183], v[216:219]
    ds_read_b128 v[116:119], v14 offset:34048
    v_mfma_f32_16x16x32_bf16 v[220:223], a[116:119], v[180:183], v[220:223]
    v_mfma_f32_16x16x32_bf16 v[208:211], a[120:123], v[184:187], v[208:211]
    ds_read_b128 v[120:123], v15 offset:1280
    v_mfma_f32_16x16x32_bf16 v[212:215], a[124:127], v[184:187], v[212:215]
    v_mfma_f32_16x16x32_bf16 v[216:219], a[120:123], v[188:191], v[216:219]
    ds_read_b128 v[124:127], v15 offset:34048
    v_mfma_f32_16x16x32_bf16 v[220:223], a[124:127], v[188:191], v[220:223]
    s_waitcnt lgkmcnt(12)
    v_mfma_f32_16x16x32_bf16 v[208:211], a[128:131], v[64:67], v[208:211]
    ds_read_b128 v[128:131], v12 offset:1536
    v_mfma_f32_16x16x32_bf16 v[212:215], a[132:135], v[64:67], v[212:215]
    v_mfma_f32_16x16x32_bf16 v[216:219], a[128:131], v[68:71], v[216:219]
    ds_read_b128 v[132:135], v12 offset:34304
    v_mfma_f32_16x16x32_bf16 v[220:223], a[132:135], v[68:71], v[220:223]
    v_mfma_f32_16x16x32_bf16 v[208:211], a[136:139], v[72:75], v[208:211]
    ds_read_b128 v[136:139], v13 offset:1536
    v_mfma_f32_16x16x32_bf16 v[212:215], a[140:143], v[72:75], v[212:215]
    s_add_u32 s37, s28, 5
    v_mfma_f32_16x16x32_bf16 v[216:219], a[136:139], v[76:79], v[216:219]
    ds_read_b128 v[140:143], v13 offset:34304
    v_mfma_f32_16x16x32_bf16 v[220:223], a[140:143], v[76:79], v[220:223]
    s_bitcmp1_b32 s37, 0
    s_cselect_b32 s4, 0x84000, 0
    s_waitcnt lgkmcnt(12)
    v_mfma_f32_16x16x32_bf16 v[208:211], a[144:147], v[80:83], v[208:211]
    ds_read_b128 v[144:147], v14 offset:1536
    v_mfma_f32_16x16x32_bf16 v[212:215], a[148:151], v[80:83], v[212:215]
    s_xor_b32 s34, s35, s4
    v_mfma_f32_16x16x32_bf16 v[216:219], a[144:147], v[84:87], v[216:219]
    ds_read_b128 v[148:151], v14 offset:34304
    v_mfma_f32_16x16x32_bf16 v[220:223], a[148:151], v[84:87], v[220:223]
    s_bitcmp1_b32 s37, 1
    s_cselect_b32 s4, 0x101000, 0
    v_mfma_f32_16x16x32_bf16 v[208:211], a[152:155], v[88:91], v[208:211]
    ds_read_b128 v[152:155], v15 offset:1536
    v_mfma_f32_16x16x32_bf16 v[212:215], a[156:159], v[88:91], v[212:215]
    s_xor_b32 s34, s34, s4
    s_lshr_b32 s37, s37, 2
    v_mfma_f32_16x16x32_bf16 v[216:219], a[152:155], v[92:95], v[216:219]
    ds_read_b128 v[156:159], v15 offset:34304
    v_mfma_f32_16x16x32_bf16 v[220:223], a[156:159], v[92:95], v[220:223]
    s_bitcmp1_b32 s63, s37
    s_cselect_b32 s4, 0x2000, 0
    s_waitcnt lgkmcnt(12)
    v_mfma_f32_16x16x32_bf16 v[208:211], a[160:163], v[96:99], v[208:211]
    ds_read_b128 v[160:163], v12 offset:1792
    v_mfma_f32_16x16x32_bf16 v[212:215], a[164:167], v[96:99], v[212:215]
    s_xor_b32 s34, s34, s4
    s_lshl_b32 s37, s37, 21
    v_mfma_f32_16x16x32_bf16 v[216:219], a[160:163], v[100:103], v[216:219]
    ds_read_b128 v[164:167], v12 offset:34560
    v_mfma_f32_16x16x32_bf16 v[220:223], a[164:167], v[100:103], v[220:223]
    s_add_u32 s34, s34, s37
    v_mfma_f32_16x16x32_bf16 v[208:211], a[168:171], v[104:107], v[208:211]
    ds_read_b128 v[168:171], v13 offset:1792
    v_mfma_f32_16x16x32_bf16 v[212:215], a[172:175], v[104:107], v[212:215]
    v_mfma_f32_16x16x32_bf16 v[216:219], a[168:171], v[108:111], v[216:219]
    ds_read_b128 v[172:175], v13 offset:34560
    v_mfma_f32_16x16x32_bf16 v[220:223], a[172:175], v[108:111], v[220:223]
    s_waitcnt lgkmcnt(12)
    v_mfma_f32_16x16x32_bf16 v[208:211], a[176:179], v[112:115], v[208:211]
    ds_read_b128 v[176:179], v14 offset:1792
    v_mfma_f32_16x16x32_bf16 v[212:215], a[180:183], v[112:115], v[212:215]
    s_waitcnt vmcnt(7)
    v_mov_b32 v27, s28
    s_mov_b64 exec, 1
    buffer_store_dword v27, v26, s[8:11], s94 offen sc1
    s_mov_b64 exec, -1
    v_mfma_f32_16x16x32_bf16 v[216:219], a[176:179], v[116:119], v[216:219]
    ds_read_b128 v[180:183], v14 offset:34560
    v_mfma_f32_16x16x32_bf16 v[220:223], a[180:183], v[116:119], v[220:223]
    v_mfma_f32_16x16x32_bf16 v[208:211], a[184:187], v[120:123], v[208:211]
    ds_read_b128 v[184:187], v15 offset:1792
    v_mfma_f32_16x16x32_bf16 v[212:215], a[188:191], v[120:123], v[212:215]
    s_add_u32 s28, s28, 1
    v_mfma_f32_16x16x32_bf16 v[216:219], a[184:187], v[124:127], v[216:219]
    ds_read_b128 v[188:191], v15 offset:34560
    v_mfma_f32_16x16x32_bf16 v[220:223], a[188:191], v[124:127], v[220:223]
    s_waitcnt lgkmcnt(12)
    v_mfma_f32_16x16x32_bf16 v[208:211], a[192:195], v[128:131], v[208:211]
    v_mfma_f32_16x16x32_bf16 v[212:215], a[196:199], v[128:131], v[212:215]
    v_mfma_f32_16x16x32_bf16 v[216:219], a[192:195], v[132:135], v[216:219]
    v_mfma_f32_16x16x32_bf16 v[220:223], a[196:199], v[132:135], v[220:223]
    v_mfma_f32_16x16x32_bf16 v[208:211], a[200:203], v[136:139], v[208:211]
    v_mfma_f32_16x16x32_bf16 v[212:215], a[204:207], v[136:139], v[212:215]
    s_add_u32 s29, s29, 0x10000
    s_and_b32 s29, s29, 0x3fffff
    v_mfma_f32_16x16x32_bf16 v[216:219], a[200:203], v[140:143], v[216:219]
    v_mfma_f32_16x16x32_bf16 v[220:223], a[204:207], v[140:143], v[220:223]
    s_waitcnt vmcnt(3) lgkmcnt(0)
    s_barrier
    v_mfma_f32_16x16x32_bf16 v[208:211], a[208:211], v[144:147], v[208:211]
    ds_read_b128 v[64:67], v8 offset:0
    ds_read_b128 v[68:71], v8 offset:32768
    v_mfma_f32_16x16x32_bf16 v[212:215], a[212:215], v[144:147], v[212:215]
    s_add_u32 m0, s6, 65536
    v_mfma_f32_16x16x32_bf16 v[216:219], a[208:211], v[148:151], v[216:219]
    ds_read_b128 v[72:75], v9 offset:0
    ds_read_b128 v[76:79], v9 offset:32768
    v_mfma_f32_16x16x32_bf16 v[220:223], a[212:215], v[148:151], v[220:223]
    buffer_load_dwordx4 v16, s[12:15], s29 offen offset:0 lds
    v_mfma_f32_16x16x32_bf16 v[208:211], a[216:219], v[152:155], v[208:211]
    ds_read_b128 v[80:83], v10 offset:0
    ds_read_b128 v[84:87], v10 offset:32768
    v_mfma_f32_16x16x32_bf16 v[212:215], a[220:223], v[152:155], v[212:215]
    v_mfma_f32_16x16x32_bf16 v[216:219], a[216:219], v[156:159], v[216:219]
    ds_read_b128 v[88:91], v11 offset:0
    ds_read_b128 v[92:95], v11 offset:32768
    v_mfma_f32_16x16x32_bf16 v[220:223], a[220:223], v[156:159], v[220:223]
    buffer_load_dwordx4 v16, s[12:15], s29 offen offset:1024 lds
    v_mfma_f32_16x16x32_bf16 v[208:211], a[224:227], v[160:163], v[208:211]
    ds_read_b128 v[96:99], v8 offset:256
    v_mfma_f32_16x16x32_bf16 v[212:215], a[228:231], v[160:163], v[212:215]
    v_mfma_f32_16x16x32_bf16 v[216:219], a[224:227], v[164:167], v[216:219]
    ds_read_b128 v[100:103], v8 offset:33024
    v_mfma_f32_16x16x32_bf16 v[220:223], a[228:231], v[164:167], v[220:223]
    buffer_load_dwordx4 v17, s[12:15], s29 offen offset:2048 lds
    v_mfma_f32_16x16x32_bf16 v[208:211], a[232:235], v[168:171], v[208:211]
    ds_read_b128 v[104:107], v9 offset:256
    v_mfma_f32_16x16x32_bf16 v[212:215], a[236:239], v[168:171], v[212:215]
    v_mfma_f32_16x16x32_bf16 v[216:219], a[232:235], v[172:175], v[216:219]
    ds_read_b128 v[108:111], v9 offset:33024
    v_mfma_f32_16x16x32_bf16 v[220:223], a[236:239], v[172:175], v[220:223]
    buffer_load_dwordx4 v17, s[12:15], s29 offen offset:3072 lds
    v_mfma_f32_16x16x32_bf16 v[208:211], a[240:243], v[176:179], v[208:211]
    ds_read_b128 v[112:115], v10 offset:256
    v_mfma_f32_16x16x32_bf16 v[212:215], a[244:247], v[176:179], v[212:215]
    s_add_u32 m0, s6, 69632
    v_mfma_f32_16x16x32_bf16 v[216:219], a[240:243], v[180:183], v[216:219]
    ds_read_b128 v[116:119], v10 offset:33024
    v_mfma_f32_16x16x32_bf16 v[220:223], a[244:247], v[180:183], v[220:223]
    buffer_load_dwordx4 v18, s[12:15], s29 offen offset:0 lds
    v_mfma_f32_16x16x32_bf16 v[208:211], a[248:251], v[184:187], v[208:211]
    ds_read_b128 v[120:123], v11 offset:256
    v_mfma_f32_16x16x32_bf16 v[212:215], a[252:255], v[184:187], v[212:215]
    v_mfma_f32_16x16x32_bf16 v[216:219], a[248:251], v[188:191], v[216:219]
    ds_read_b128 v[124:127], v11 offset:33024
    v_mfma_f32_16x16x32_bf16 v[220:223], a[252:255], v[188:191], v[220:223]
    buffer_load_dwordx4 v18, s[12:15], s29 offen offset:1024 lds
    s_cmp_lt_u32 s28, 64
    s_cbranch_scc1 .ql_407
    s_branch .qe_406
.vt_405:
.p2align 6
.ql_408:
    s_waitcnt lgkmcnt(12)
    v_mfma_f32_16x16x32_bf16 v[192:195], v[64:67], a[0:3], 0
    ds_read_b128 v[128:131], v8 offset:512
    v_mfma_f32_16x16x32_bf16 v[200:203], v[64:67], a[4:7], 0
    v_mfma_f32_16x16x32_bf16 v[196:199], v[68:71], a[0:3], 0
    ds_read_b128 v[132:135], v8 offset:33280
    v_mfma_f32_16x16x32_bf16 v[204:207], v[68:71], a[4:7], 0
    buffer_load_dwordx4 v19, s[12:15], s29 offen offset:2048 lds
    v_mfma_f32_16x16x32_bf16 v[192:195], v[72:75], a[8:11], v[192:195]
    ds_read_b128 v[136:139], v9 offset:512
    v_mfma_f32_16x16x32_bf16 v[200:203], v[72:75], a[12:15], v[200:203]
    v_cvt_pk_bf16_f32 v224, v208, v209
    v_cvt_pk_bf16_f32 v225, v210, v211
    v_mfma_f32_16x16x32_bf16 v[196:199], v[76:79], a[8:11], v[196:199]
    ds_read_b128 v[140:143], v9 offset:33280
    v_mfma_f32_16x16x32_bf16 v[204:207], v[76:79], a[12:15], v[204:207]
    buffer_load_dwordx4 v19, s[12:15], s29 offen offset:3072 lds
    s_waitcnt lgkmcnt(12)
    v_mfma_f32_16x16x32_bf16 v[192:195], v[80:83], a[16:19], v[192:195]
    ds_read_b128 v[144:147], v10 offset:512
    v_mfma_f32_16x16x32_bf16 v[200:203], v[80:83], a[20:23], v[200:203]
    s_add_u32 m0, s6, 73728
    v_cvt_pk_bf16_f32 v226, v212, v213
    v_cvt_pk_bf16_f32 v227, v214, v215
    v_mfma_f32_16x16x32_bf16 v[196:199], v[84:87], a[16:19], v[196:199]
    ds_read_b128 v[148:151], v10 offset:33280
    v_mfma_f32_16x16x32_bf16 v[204:207], v[84:87], a[20:23], v[204:207]
    buffer_load_dwordx4 v20, s[12:15], s29 offen offset:0 lds
    v_mfma_f32_16x16x32_bf16 v[192:195], v[88:91], a[24:27], v[192:195]
    ds_read_b128 v[152:155], v11 offset:512
    v_cvt_pk_bf16_f32 v228, v216, v217
    v_mfma_f32_16x16x32_bf16 v[200:203], v[88:91], a[28:31], v[200:203]
    buffer_store_dwordx4 v[224:227], v24, s[8:11], s30 offen sc1
    v_mfma_f32_16x16x32_bf16 v[196:199], v[92:95], a[24:27], v[196:199]
    ds_read_b128 v[156:159], v11 offset:33280
    v_cvt_pk_bf16_f32 v229, v218, v219
    v_mfma_f32_16x16x32_bf16 v[204:207], v[92:95], a[28:31], v[204:207]
    buffer_load_dwordx4 v20, s[12:15], s29 offen offset:1024 lds
    s_waitcnt lgkmcnt(12)
    v_mfma_f32_16x16x32_bf16 v[192:195], v[96:99], a[32:35], v[192:195]
    ds_read_b128 v[160:163], v8 offset:768
    v_mfma_f32_16x16x32_bf16 v[200:203], v[96:99], a[36:39], v[200:203]
    v_cvt_pk_bf16_f32 v230, v220, v221
    v_cvt_pk_bf16_f32 v231, v222, v223
    v_mfma_f32_16x16x32_bf16 v[196:199], v[100:103], a[32:35], v[196:199]
    ds_read_b128 v[164:167], v8 offset:33536
    v_mfma_f32_16x16x32_bf16 v[204:207], v[100:103], a[36:39], v[204:207]
    buffer_load_dwordx4 v21, s[12:15], s29 offen offset:2048 lds
    v_mfma_f32_16x16x32_bf16 v[192:195], v[104:107], a[40:43], v[192:195]
    ds_read_b128 v[168:171], v9 offset:768
    v_mfma_f32_16x16x32_bf16 v[200:203], v[104:107], a[44:47], v[200:203]
    buffer_store_dwordx4 v[228:231], v25, s[8:11], s30 offen sc1
    v_mfma_f32_16x16x32_bf16 v[196:199], v[108:111], a[40:43], v[196:199]
    ds_read_b128 v[172:175], v9 offset:33536
    v_mfma_f32_16x16x32_bf16 v[204:207], v[108:111], a[44:47], v[204:207]
    buffer_load_dwordx4 v21, s[12:15], s29 offen offset:3072 lds
    s_waitcnt lgkmcnt(12)
    v_mfma_f32_16x16x32_bf16 v[192:195], v[112:115], a[48:51], v[192:195]
    ds_read_b128 v[176:179], v10 offset:768
    v_mfma_f32_16x16x32_bf16 v[200:203], v[112:115], a[52:55], v[200:203]
    s_add_u32 m0, s6, 77824
    s_mov_b32 s30, s31
    v_mfma_f32_16x16x32_bf16 v[196:199], v[116:119], a[48:51], v[196:199]
    ds_read_b128 v[180:183], v10 offset:33536
    v_mfma_f32_16x16x32_bf16 v[204:207], v[116:119], a[52:55], v[204:207]
    buffer_load_dwordx4 v22, s[12:15], s29 offen offset:0 lds
    v_mfma_f32_16x16x32_bf16 v[192:195], v[120:123], a[56:59], v[192:195]
    ds_read_b128 v[184:187], v11 offset:768
    v_mfma_f32_16x16x32_bf16 v[200:203], v[120:123], a[60:63], v[200:203]
    s_add_u32 s31, s31, 262144
    v_mfma_f32_16x16x32_bf16 v[196:199], v[124:127], a[56:59], v[196:199]
    ds_read_b128 v[188:191], v11 offset:33536
    v_mfma_f32_16x16x32_bf16 v[204:207], v[124:127], a[60:63], v[204:207]
    buffer_load_dwordx4 v22, s[12:15], s29 offen offset:1024 lds
    s_waitcnt lgkmcnt(12)
    v_mfma_f32_16x16x32_bf16 v[192:195], v[128:131], a[64:67], v[192:195]
    ds_read_b128 v[64:67], v8 offset:1024
    v_mfma_f32_16x16x32_bf16 v[200:203], v[128:131], a[68:71], v[200:203]
    v_mfma_f32_16x16x32_bf16 v[196:199], v[132:135], a[64:67], v[196:199]
    ds_read_b128 v[68:71], v8 offset:33792
    v_mfma_f32_16x16x32_bf16 v[204:207], v[132:135], a[68:71], v[204:207]
    buffer_load_dwordx4 v23, s[12:15], s29 offen offset:2048 lds
    v_mfma_f32_16x16x32_bf16 v[192:195], v[136:139], a[72:75], v[192:195]
    ds_read_b128 v[72:75], v9 offset:1024
    v_mfma_f32_16x16x32_bf16 v[200:203], v[136:139], a[76:79], v[200:203]
    v_mfma_f32_16x16x32_bf16 v[196:199], v[140:143], a[72:75], v[196:199]
    ds_read_b128 v[76:79], v9 offset:33792
    v_mfma_f32_16x16x32_bf16 v[204:207], v[140:143], a[76:79], v[204:207]
    buffer_load_dwordx4 v23, s[12:15], s29 offen offset:3072 lds
    s_waitcnt lgkmcnt(12)
    v_mfma_f32_16x16x32_bf16 v[192:195], v[144:147], a[80:83], v[192:195]
    ds_read_b128 v[80:83], v10 offset:1024
    v_mfma_f32_16x16x32_bf16 v[200:203], v[144:147], a[84:87], v[200:203]
    v_mfma_f32_16x16x32_bf16 v[196:199], v[148:151], a[80:83], v[196:199]
    ds_read_b128 v[84:87], v10 offset:33792
    v_mfma_f32_16x16x32_bf16 v[204:207], v[148:151], a[84:87], v[204:207]
    buffer_load_dword v29, v28, s[12:15], s29 offen
    v_mfma_f32_16x16x32_bf16 v[192:195], v[152:155], a[88:91], v[192:195]
    ds_read_b128 v[88:91], v11 offset:1024
    v_mfma_f32_16x16x32_bf16 v[200:203], v[152:155], a[92:95], v[200:203]
    v_mfma_f32_16x16x32_bf16 v[196:199], v[156:159], a[88:91], v[196:199]
    ds_read_b128 v[92:95], v11 offset:33792
    v_mfma_f32_16x16x32_bf16 v[204:207], v[156:159], a[92:95], v[204:207]
    buffer_store_dwordx4 v[32:35], v36, s[8:11], s34 offen sc1
    s_waitcnt lgkmcnt(12)
    v_mfma_f32_16x16x32_bf16 v[192:195], v[160:163], a[96:99], v[192:195]
    ds_read_b128 v[96:99], v8 offset:1280
    v_mfma_f32_16x16x32_bf16 v[200:203], v[160:163], a[100:103], v[200:203]
    v_mfma_f32_16x16x32_bf16 v[196:199], v[164:167], a[96:99], v[196:199]
    ds_read_b128 v[100:103], v8 offset:34048
    v_mfma_f32_16x16x32_bf16 v[204:207], v[164:167], a[100:103], v[204:207]
    v_mfma_f32_16x16x32_bf16 v[192:195], v[168:171], a[104:107], v[192:195]
    ds_read_b128 v[104:107], v9 offset:1280
    v_mfma_f32_16x16x32_bf16 v[200:203], v[168:171], a[108:111], v[200:203]
    v_mfma_f32_16x16x32_bf16 v[196:199], v[172:175], a[104:107], v[196:199]
    ds_read_b128 v[108:111], v9 offset:34048
    v_mfma_f32_16x16x32_bf16 v[204:207], v[172:175], a[108:111], v[204:207]
    s_waitcnt lgkmcnt(12)
    v_mfma_f32_16x16x32_bf16 v[192:195], v[176:179], a[112:115], v[192:195]
    ds_read_b128 v[112:115], v10 offset:1280
    v_mfma_f32_16x16x32_bf16 v[200:203], v[176:179], a[116:119], v[200:203]
    v_mfma_f32_16x16x32_bf16 v[196:199], v[180:183], a[112:115], v[196:199]
    ds_read_b128 v[116:119], v10 offset:34048
    v_mfma_f32_16x16x32_bf16 v[204:207], v[180:183], a[116:119], v[204:207]
    v_mfma_f32_16x16x32_bf16 v[192:195], v[184:187], a[120:123], v[192:195]
    ds_read_b128 v[120:123], v11 offset:1280
    v_mfma_f32_16x16x32_bf16 v[200:203], v[184:187], a[124:127], v[200:203]
    v_mfma_f32_16x16x32_bf16 v[196:199], v[188:191], a[120:123], v[196:199]
    ds_read_b128 v[124:127], v11 offset:34048
    v_mfma_f32_16x16x32_bf16 v[204:207], v[188:191], a[124:127], v[204:207]
    s_waitcnt lgkmcnt(12)
    v_mfma_f32_16x16x32_bf16 v[192:195], v[64:67], a[128:131], v[192:195]
    ds_read_b128 v[128:131], v8 offset:1536
    v_mfma_f32_16x16x32_bf16 v[200:203], v[64:67], a[132:135], v[200:203]
    v_mfma_f32_16x16x32_bf16 v[196:199], v[68:71], a[128:131], v[196:199]
    ds_read_b128 v[132:135], v8 offset:34304
    v_mfma_f32_16x16x32_bf16 v[204:207], v[68:71], a[132:135], v[204:207]
    v_mfma_f32_16x16x32_bf16 v[192:195], v[72:75], a[136:139], v[192:195]
    ds_read_b128 v[136:139], v9 offset:1536
    v_mfma_f32_16x16x32_bf16 v[200:203], v[72:75], a[140:143], v[200:203]
    s_add_u32 s37, s28, 5
    v_mfma_f32_16x16x32_bf16 v[196:199], v[76:79], a[136:139], v[196:199]
    ds_read_b128 v[140:143], v9 offset:34304
    v_mfma_f32_16x16x32_bf16 v[204:207], v[76:79], a[140:143], v[204:207]
    s_bitcmp1_b32 s37, 0
    s_cselect_b32 s4, 0x84000, 0
    s_waitcnt lgkmcnt(12)
    v_mfma_f32_16x16x32_bf16 v[192:195], v[80:83], a[144:147], v[192:195]
    ds_read_b128 v[144:147], v10 offset:1536
    v_mfma_f32_16x16x32_bf16 v[200:203], v[80:83], a[148:151], v[200:203]
    s_xor_b32 s34, s35, s4
    v_mfma_f32_16x16x32_bf16 v[196:199], v[84:87], a[144:147], v[196:199]
    ds_read_b128 v[148:151], v10 offset:34304
    v_mfma_f32_16x16x32_bf16 v[204:207], v[84:87], a[148:151], v[204:207]
    s_bitcmp1_b32 s37, 1
    s_cselect_b32 s4, 0x101000, 0
    v_mfma_f32_16x16x32_bf16 v[192:195], v[88:91], a[152:155], v[192:195]
    ds_read_b128 v[152:155], v11 offset:1536
    v_mfma_f32_16x16x32_bf16 v[200:203], v[88:91], a[156:159], v[200:203]
    s_xor_b32 s34, s34, s4
    s_lshr_b32 s37, s37, 2
    v_mfma_f32_16x16x32_bf16 v[196:199], v[92:95], a[152:155], v[196:199]
    ds_read_b128 v[156:159], v11 offset:34304
    v_mfma_f32_16x16x32_bf16 v[204:207], v[92:95], a[156:159], v[204:207]
    s_bitcmp1_b32 s63, s37
    s_cselect_b32 s4, 0x2000, 0
    s_waitcnt lgkmcnt(12)
    v_mfma_f32_16x16x32_bf16 v[192:195], v[96:99], a[160:163], v[192:195]
    ds_read_b128 v[160:163], v8 offset:1792
    v_mfma_f32_16x16x32_bf16 v[200:203], v[96:99], a[164:167], v[200:203]
    s_xor_b32 s34, s34, s4
    s_lshl_b32 s37, s37, 21
    v_mfma_f32_16x16x32_bf16 v[196:199], v[100:103], a[160:163], v[196:199]
    ds_read_b128 v[164:167], v8 offset:34560
    v_mfma_f32_16x16x32_bf16 v[204:207], v[100:103], a[164:167], v[204:207]
    s_add_u32 s34, s34, s37
    v_mfma_f32_16x16x32_bf16 v[192:195], v[104:107], a[168:171], v[192:195]
    ds_read_b128 v[168:171], v9 offset:1792
    v_mfma_f32_16x16x32_bf16 v[200:203], v[104:107], a[172:175], v[200:203]
    v_mfma_f32_16x16x32_bf16 v[196:199], v[108:111], a[168:171], v[196:199]
    ds_read_b128 v[172:175], v9 offset:34560
    v_mfma_f32_16x16x32_bf16 v[204:207], v[108:111], a[172:175], v[204:207]
    s_waitcnt lgkmcnt(12)
    v_mfma_f32_16x16x32_bf16 v[192:195], v[112:115], a[176:179], v[192:195]
    ds_read_b128 v[176:179], v10 offset:1792
    v_mfma_f32_16x16x32_bf16 v[200:203], v[112:115], a[180:183], v[200:203]
    s_waitcnt vmcnt(7)
    v_mov_b32 v27, s28
    s_mov_b64 exec, 1
    buffer_store_dword v27, v26, s[8:11], s94 offen sc1
    s_mov_b64 exec, -1
    v_mfma_f32_16x16x32_bf16 v[196:199], v[116:119], a[176:179], v[196:199]
    ds_read_b128 v[180:183], v10 offset:34560
    v_mfma_f32_16x16x32_bf16 v[204:207], v[116:119], a[180:183], v[204:207]
    v_mfma_f32_16x16x32_bf16 v[192:195], v[120:123], a[184:187], v[192:195]
    ds_read_b128 v[184:187], v11 offset:1792
    v_mfma_f32_16x16x32_bf16 v[200:203], v[120:123], a[188:191], v[200:203]
    s_add_u32 s28, s28, 1
    v_mfma_f32_16x16x32_bf16 v[196:199], v[124:127], a[184:187], v[196:199]
    ds_read_b128 v[188:191], v11 offset:34560
    v_mfma_f32_16x16x32_bf16 v[204:207], v[124:127], a[188:191], v[204:207]
    s_waitcnt lgkmcnt(12)
    v_mfma_f32_16x16x32_bf16 v[192:195], v[128:131], a[192:195], v[192:195]
    v_mfma_f32_16x16x32_bf16 v[200:203], v[128:131], a[196:199], v[200:203]
    v_mfma_f32_16x16x32_bf16 v[196:199], v[132:135], a[192:195], v[196:199]
    v_mfma_f32_16x16x32_bf16 v[204:207], v[132:135], a[196:199], v[204:207]
    v_mfma_f32_16x16x32_bf16 v[192:195], v[136:139], a[200:203], v[192:195]
    v_mfma_f32_16x16x32_bf16 v[200:203], v[136:139], a[204:207], v[200:203]
    s_add_u32 s29, s29, 0x10000
    s_and_b32 s29, s29, 0x3fffff
    v_mfma_f32_16x16x32_bf16 v[196:199], v[140:143], a[200:203], v[196:199]
    v_mfma_f32_16x16x32_bf16 v[204:207], v[140:143], a[204:207], v[204:207]
    s_waitcnt vmcnt(3) lgkmcnt(0)
    s_barrier
    v_mfma_f32_16x16x32_bf16 v[192:195], v[144:147], a[208:211], v[192:195]
    ds_read_b128 v[64:67], v12 offset:0
    ds_read_b128 v[68:71], v12 offset:32768
    v_mfma_f32_16x16x32_bf16 v[200:203], v[144:147], a[212:215], v[200:203]
    s_add_u32 m0, s6, 0
    v_mfma_f32_16x16x32_bf16 v[196:199], v[148:151], a[208:211], v[196:199]
    ds_read_b128 v[72:75], v13 offset:0
    ds_read_b128 v[76:79], v13 offset:32768
    v_mfma_f32_16x16x32_bf16 v[204:207], v[148:151], a[212:215], v[204:207]
    buffer_load_dwordx4 v16, s[12:15], s29 offen offset:0 lds
    v_mfma_f32_16x16x32_bf16 v[192:195], v[152:155], a[216:219], v[192:195]
    ds_read_b128 v[80:83], v14 offset:0
    ds_read_b128 v[84:87], v14 offset:32768
    v_mfma_f32_16x16x32_bf16 v[200:203], v[152:155], a[220:223], v[200:203]
    v_mfma_f32_16x16x32_bf16 v[196:199], v[156:159], a[216:219], v[196:199]
    ds_read_b128 v[88:91], v15 offset:0
    ds_read_b128 v[92:95], v15 offset:32768
    v_mfma_f32_16x16x32_bf16 v[204:207], v[156:159], a[220:223], v[204:207]
    buffer_load_dwordx4 v16, s[12:15], s29 offen offset:1024 lds
    v_mfma_f32_16x16x32_bf16 v[192:195], v[160:163], a[224:227], v[192:195]
    ds_read_b128 v[96:99], v12 offset:256
    v_mfma_f32_16x16x32_bf16 v[200:203], v[160:163], a[228:231], v[200:203]
    v_mfma_f32_16x16x32_bf16 v[196:199], v[164:167], a[224:227], v[196:199]
    ds_read_b128 v[100:103], v12 offset:33024
    v_mfma_f32_16x16x32_bf16 v[204:207], v[164:167], a[228:231], v[204:207]
    buffer_load_dwordx4 v17, s[12:15], s29 offen offset:2048 lds
    v_mfma_f32_16x16x32_bf16 v[192:195], v[168:171], a[232:235], v[192:195]
    ds_read_b128 v[104:107], v13 offset:256
    v_mfma_f32_16x16x32_bf16 v[200:203], v[168:171], a[236:239], v[200:203]
    v_mfma_f32_16x16x32_bf16 v[196:199], v[172:175], a[232:235], v[196:199]
    ds_read_b128 v[108:111], v13 offset:33024
    v_mfma_f32_16x16x32_bf16 v[204:207], v[172:175], a[236:239], v[204:207]
    buffer_load_dwordx4 v17, s[12:15], s29 offen offset:3072 lds
    v_mfma_f32_16x16x32_bf16 v[192:195], v[176:179], a[240:243], v[192:195]
    ds_read_b128 v[112:115], v14 offset:256
    v_mfma_f32_16x16x32_bf16 v[200:203], v[176:179], a[244:247], v[200:203]
    s_add_u32 m0, s6, 4096
    v_mfma_f32_16x16x32_bf16 v[196:199], v[180:183], a[240:243], v[196:199]
    ds_read_b128 v[116:119], v14 offset:33024
    v_mfma_f32_16x16x32_bf16 v[204:207], v[180:183], a[244:247], v[204:207]
    buffer_load_dwordx4 v18, s[12:15], s29 offen offset:0 lds
    v_mfma_f32_16x16x32_bf16 v[192:195], v[184:187], a[248:251], v[192:195]
    ds_read_b128 v[120:123], v15 offset:256
    v_mfma_f32_16x16x32_bf16 v[200:203], v[184:187], a[252:255], v[200:203]
    v_mfma_f32_16x16x32_bf16 v[196:199], v[188:191], a[248:251], v[196:199]
    ds_read_b128 v[124:127], v15 offset:33024
    v_mfma_f32_16x16x32_bf16 v[204:207], v[188:191], a[252:255], v[204:207]
    buffer_load_dwordx4 v18, s[12:15], s29 offen offset:1024 lds
    s_waitcnt lgkmcnt(12)
    v_mfma_f32_16x16x32_bf16 v[208:211], v[64:67], a[0:3], 0
    ds_read_b128 v[128:131], v12 offset:512
    v_mfma_f32_16x16x32_bf16 v[216:219], v[64:67], a[4:7], 0
    v_mfma_f32_16x16x32_bf16 v[212:215], v[68:71], a[0:3], 0
    ds_read_b128 v[132:135], v12 offset:33280
    v_mfma_f32_16x16x32_bf16 v[220:223], v[68:71], a[4:7], 0
    buffer_load_dwordx4 v19, s[12:15], s29 offen offset:2048 lds
    v_mfma_f32_16x16x32_bf16 v[208:211], v[72:75], a[8:11], v[208:211]
    ds_read_b128 v[136:139], v13 offset:512
    v_mfma_f32_16x16x32_bf16 v[216:219], v[72:75], a[12:15], v[216:219]
    v_cvt_pk_bf16_f32 v224, v192, v193
    v_cvt_pk_bf16_f32 v225, v194, v195
    v_mfma_f32_16x16x32_bf16 v[212:215], v[76:79], a[8:11], v[212:215]
    ds_read_b128 v[140:143], v13 offset:33280
    v_mfma_f32_16x16x32_bf16 v[220:223], v[76:79], a[12:15], v[220:223]
    buffer_load_dwordx4 v19, s[12:15], s29 offen offset:3072 lds
    s_waitcnt lgkmcnt(12)
    v_mfma_f32_16x16x32_bf16 v[208:211], v[80:83], a[16:19], v[208:211]
    ds_read_b128 v[144:147], v14 offset:512
    v_mfma_f32_16x16x32_bf16 v[216:219], v[80:83], a[20:23], v[216:219]
    s_add_u32 m0, s6, 8192
    v_cvt_pk_bf16_f32 v226, v196, v197
    v_cvt_pk_bf16_f32 v227, v198, v199
    v_mfma_f32_16x16x32_bf16 v[212:215], v[84:87], a[16:19], v[212:215]
    ds_read_b128 v[148:151], v14 offset:33280
    v_mfma_f32_16x16x32_bf16 v[220:223], v[84:87], a[20:23], v[220:223]
    buffer_load_dwordx4 v20, s[12:15], s29 offen offset:0 lds
    v_mfma_f32_16x16x32_bf16 v[208:211], v[88:91], a[24:27], v[208:211]
    ds_read_b128 v[152:155], v15 offset:512
    v_cvt_pk_bf16_f32 v228, v200, v201
    v_mfma_f32_16x16x32_bf16 v[216:219], v[88:91], a[28:31], v[216:219]
    buffer_store_dwordx4 v[224:227], v24, s[8:11], s30 offen sc1
    v_mfma_f32_16x16x32_bf16 v[212:215], v[92:95], a[24:27], v[212:215]
    ds_read_b128 v[156:159], v15 offset:33280
    v_cvt_pk_bf16_f32 v229, v202, v203
    v_mfma_f32_16x16x32_bf16 v[220:223], v[92:95], a[28:31], v[220:223]
    buffer_load_dwordx4 v20, s[12:15], s29 offen offset:1024 lds
    s_waitcnt lgkmcnt(12)
    v_mfma_f32_16x16x32_bf16 v[208:211], v[96:99], a[32:35], v[208:211]
    ds_read_b128 v[160:163], v12 offset:768
    v_mfma_f32_16x16x32_bf16 v[216:219], v[96:99], a[36:39], v[216:219]
    v_cvt_pk_bf16_f32 v230, v204, v205
    v_cvt_pk_bf16_f32 v231, v206, v207
    v_mfma_f32_16x16x32_bf16 v[212:215], v[100:103], a[32:35], v[212:215]
    ds_read_b128 v[164:167], v12 offset:33536
    v_mfma_f32_16x16x32_bf16 v[220:223], v[100:103], a[36:39], v[220:223]
    buffer_load_dwordx4 v21, s[12:15], s29 offen offset:2048 lds
    v_mfma_f32_16x16x32_bf16 v[208:211], v[104:107], a[40:43], v[208:211]
    ds_read_b128 v[168:171], v13 offset:768
    v_mfma_f32_16x16x32_bf16 v[216:219], v[104:107], a[44:47], v[216:219]
    buffer_store_dwordx4 v[228:231], v25, s[8:11], s30 offen sc1
    v_mfma_f32_16x16x32_bf16 v[212:215], v[108:111], a[40:43], v[212:215]
    ds_read_b128 v[172:175], v13 offset:33536
    v_mfma_f32_16x16x32_bf16 v[220:223], v[108:111], a[44:47], v[220:223]
    buffer_load_dwordx4 v21, s[12:15], s29 offen offset:3072 lds
    s_waitcnt lgkmcnt(12)
    v_mfma_f32_16x16x32_bf16 v[208:211], v[112:115], a[48:51], v[208:211]
    ds_read_b128 v[176:179], v14 offset:768
    v_mfma_f32_16x16x32_bf16 v[216:219], v[112:115], a[52:55], v[216:219]
    s_add_u32 m0, s6, 12288
    s_mov_b32 s30, s31
    v_mfma_f32_16x16x32_bf16 v[212:215], v[116:119], a[48:51], v[212:215]
    ds_read_b128 v[180:183], v14 offset:33536
    v_mfma_f32_16x16x32_bf16 v[220:223], v[116:119], a[52:55], v[220:223]
    buffer_load_dwordx4 v22, s[12:15], s29 offen offset:0 lds
    v_mfma_f32_16x16x32_bf16 v[208:211], v[120:123], a[56:59], v[208:211]
    ds_read_b128 v[184:187], v15 offset:768
    v_mfma_f32_16x16x32_bf16 v[216:219], v[120:123], a[60:63], v[216:219]
    s_add_u32 s31, s31, 262144
    v_mfma_f32_16x16x32_bf16 v[212:215], v[124:127], a[56:59], v[212:215]
    ds_read_b128 v[188:191], v15 offset:33536
    v_mfma_f32_16x16x32_bf16 v[220:223], v[124:127], a[60:63], v[220:223]
    buffer_load_dwordx4 v22, s[12:15], s29 offen offset:1024 lds
    s_waitcnt lgkmcnt(12)
    v_mfma_f32_16x16x32_bf16 v[208:211], v[128:131], a[64:67], v[208:211]
    ds_read_b128 v[64:67], v12 offset:1024
    v_mfma_f32_16x16x32_bf16 v[216:219], v[128:131], a[68:71], v[216:219]
    v_mfma_f32_16x16x32_bf16 v[212:215], v[132:135], a[64:67], v[212:215]
    ds_read_b128 v[68:71], v12 offset:33792
    v_mfma_f32_16x16x32_bf16 v[220:223], v[132:135], a[68:71], v[220:223]
    buffer_load_dwordx4 v23, s[12:15], s29 offen offset:2048 lds
    v_mfma_f32_16x16x32_bf16 v[208:211], v[136:139], a[72:75], v[208:211]
    ds_read_b128 v[72:75], v13 offset:1024
    v_mfma_f32_16x16x32_bf16 v[216:219], v[136:139], a[76:79], v[216:219]
    v_mfma_f32_16x16x32_bf16 v[212:215], v[140:143], a[72:75], v[212:215]
    ds_read_b128 v[76:79], v13 offset:33792
    v_mfma_f32_16x16x32_bf16 v[220:223], v[140:143], a[76:79], v[220:223]
    buffer_load_dwordx4 v23, s[12:15], s29 offen offset:3072 lds
    s_waitcnt lgkmcnt(12)
    v_mfma_f32_16x16x32_bf16 v[208:211], v[144:147], a[80:83], v[208:211]
    ds_read_b128 v[80:83], v14 offset:1024
    v_mfma_f32_16x16x32_bf16 v[216:219], v[144:147], a[84:87], v[216:219]
    v_mfma_f32_16x16x32_bf16 v[212:215], v[148:151], a[80:83], v[212:215]
    ds_read_b128 v[84:87], v14 offset:33792
    v_mfma_f32_16x16x32_bf16 v[220:223], v[148:151], a[84:87], v[220:223]
    buffer_load_dword v29, v28, s[12:15], s29 offen
    v_mfma_f32_16x16x32_bf16 v[208:211], v[152:155], a[88:91], v[208:211]
    ds_read_b128 v[88:91], v15 offset:1024
    v_mfma_f32_16x16x32_bf16 v[216:219], v[152:155], a[92:95], v[216:219]
    v_mfma_f32_16x16x32_bf16 v[212:215], v[156:159], a[88:91], v[212:215]
    ds_read_b128 v[92:95], v15 offset:33792
    v_mfma_f32_16x16x32_bf16 v[220:223], v[156:159], a[92:95], v[220:223]
    buffer_store_dwordx4 v[32:35], v36, s[8:11], s34 offen sc1
    s_waitcnt lgkmcnt(12)
    v_mfma_f32_16x16x32_bf16 v[208:211], v[160:163], a[96:99], v[208:211]
    ds_read_b128 v[96:99], v12 offset:1280
    v_mfma_f32_16x16x32_bf16 v[216:219], v[160:163], a[100:103], v[216:219]
    v_mfma_f32_16x16x32_bf16 v[212:215], v[164:167], a[96:99], v[212:215]
    ds_read_b128 v[100:103], v12 offset:34048
    v_mfma_f32_16x16x32_bf16 v[220:223], v[164:167], a[100:103], v[220:223]
    v_mfma_f32_16x16x32_bf16 v[208:211], v[168:171], a[104:107], v[208:211]
    ds_read_b128 v[104:107], v13 offset:1280
    v_mfma_f32_16x16x32_bf16 v[216:219], v[168:171], a[108:111], v[216:219]
    v_mfma_f32_16x16x32_bf16 v[212:215], v[172:175], a[104:107], v[212:215]
    ds_read_b128 v[108:111], v13 offset:34048
    v_mfma_f32_16x16x32_bf16 v[220:223], v[172:175], a[108:111], v[220:223]
    s_waitcnt lgkmcnt(12)
    v_mfma_f32_16x16x32_bf16 v[208:211], v[176:179], a[112:115], v[208:211]
    ds_read_b128 v[112:115], v14 offset:1280
    v_mfma_f32_16x16x32_bf16 v[216:219], v[176:179], a[116:119], v[216:219]
    v_mfma_f32_16x16x32_bf16 v[212:215], v[180:183], a[112:115], v[212:215]
    ds_read_b128 v[116:119], v14 offset:34048
    v_mfma_f32_16x16x32_bf16 v[220:223], v[180:183], a[116:119], v[220:223]
    v_mfma_f32_16x16x32_bf16 v[208:211], v[184:187], a[120:123], v[208:211]
    ds_read_b128 v[120:123], v15 offset:1280
    v_mfma_f32_16x16x32_bf16 v[216:219], v[184:187], a[124:127], v[216:219]
    v_mfma_f32_16x16x32_bf16 v[212:215], v[188:191], a[120:123], v[212:215]
    ds_read_b128 v[124:127], v15 offset:34048
    v_mfma_f32_16x16x32_bf16 v[220:223], v[188:191], a[124:127], v[220:223]
    s_waitcnt lgkmcnt(12)
    v_mfma_f32_16x16x32_bf16 v[208:211], v[64:67], a[128:131], v[208:211]
    ds_read_b128 v[128:131], v12 offset:1536
    v_mfma_f32_16x16x32_bf16 v[216:219], v[64:67], a[132:135], v[216:219]
    v_mfma_f32_16x16x32_bf16 v[212:215], v[68:71], a[128:131], v[212:215]
    ds_read_b128 v[132:135], v12 offset:34304
    v_mfma_f32_16x16x32_bf16 v[220:223], v[68:71], a[132:135], v[220:223]
    v_mfma_f32_16x16x32_bf16 v[208:211], v[72:75], a[136:139], v[208:211]
    ds_read_b128 v[136:139], v13 offset:1536
    v_mfma_f32_16x16x32_bf16 v[216:219], v[72:75], a[140:143], v[216:219]
    s_add_u32 s37, s28, 5
    v_mfma_f32_16x16x32_bf16 v[212:215], v[76:79], a[136:139], v[212:215]
    ds_read_b128 v[140:143], v13 offset:34304
    v_mfma_f32_16x16x32_bf16 v[220:223], v[76:79], a[140:143], v[220:223]
    s_bitcmp1_b32 s37, 0
    s_cselect_b32 s4, 0x84000, 0
    s_waitcnt lgkmcnt(12)
    v_mfma_f32_16x16x32_bf16 v[208:211], v[80:83], a[144:147], v[208:211]
    ds_read_b128 v[144:147], v14 offset:1536
    v_mfma_f32_16x16x32_bf16 v[216:219], v[80:83], a[148:151], v[216:219]
    s_xor_b32 s34, s35, s4
    v_mfma_f32_16x16x32_bf16 v[212:215], v[84:87], a[144:147], v[212:215]
    ds_read_b128 v[148:151], v14 offset:34304
    v_mfma_f32_16x16x32_bf16 v[220:223], v[84:87], a[148:151], v[220:223]
    s_bitcmp1_b32 s37, 1
    s_cselect_b32 s4, 0x101000, 0
    v_mfma_f32_16x16x32_bf16 v[208:211], v[88:91], a[152:155], v[208:211]
    ds_read_b128 v[152:155], v15 offset:1536
    v_mfma_f32_16x16x32_bf16 v[216:219], v[88:91], a[156:159], v[216:219]
    s_xor_b32 s34, s34, s4
    s_lshr_b32 s37, s37, 2
    v_mfma_f32_16x16x32_bf16 v[212:215], v[92:95], a[152:155], v[212:215]
    ds_read_b128 v[156:159], v15 offset:34304
    v_mfma_f32_16x16x32_bf16 v[220:223], v[92:95], a[156:159], v[220:223]
    s_bitcmp1_b32 s63, s37
    s_cselect_b32 s4, 0x2000, 0
    s_waitcnt lgkmcnt(12)
    v_mfma_f32_16x16x32_bf16 v[208:211], v[96:99], a[160:163], v[208:211]
    ds_read_b128 v[160:163], v12 offset:1792
    v_mfma_f32_16x16x32_bf16 v[216:219], v[96:99], a[164:167], v[216:219]
    s_xor_b32 s34, s34, s4
    s_lshl_b32 s37, s37, 21
    v_mfma_f32_16x16x32_bf16 v[212:215], v[100:103], a[160:163], v[212:215]
    ds_read_b128 v[164:167], v12 offset:34560
    v_mfma_f32_16x16x32_bf16 v[220:223], v[100:103], a[164:167], v[220:223]
    s_add_u32 s34, s34, s37
    v_mfma_f32_16x16x32_bf16 v[208:211], v[104:107], a[168:171], v[208:211]
    ds_read_b128 v[168:171], v13 offset:1792
    v_mfma_f32_16x16x32_bf16 v[216:219], v[104:107], a[172:175], v[216:219]
    v_mfma_f32_16x16x32_bf16 v[212:215], v[108:111], a[168:171], v[212:215]
    ds_read_b128 v[172:175], v13 offset:34560
    v_mfma_f32_16x16x32_bf16 v[220:223], v[108:111], a[172:175], v[220:223]
    s_waitcnt lgkmcnt(12)
    v_mfma_f32_16x16x32_bf16 v[208:211], v[112:115], a[176:179], v[208:211]
    ds_read_b128 v[176:179], v14 offset:1792
    v_mfma_f32_16x16x32_bf16 v[216:219], v[112:115], a[180:183], v[216:219]
    s_waitcnt vmcnt(7)
    v_mov_b32 v27, s28
    s_mov_b64 exec, 1
    buffer_store_dword v27, v26, s[8:11], s94 offen sc1
    s_mov_b64 exec, -1
    v_mfma_f32_16x16x32_bf16 v[212:215], v[116:119], a[176:179], v[212:215]
    ds_read_b128 v[180:183], v14 offset:34560
    v_mfma_f32_16x16x32_bf16 v[220:223], v[116:119], a[180:183], v[220:223]
    v_mfma_f32_16x16x32_bf16 v[208:211], v[120:123], a[184:187], v[208:211]
    ds_read_b128 v[184:187], v15 offset:1792
    v_mfma_f32_16x16x32_bf16 v[216:219], v[120:123], a[188:191], v[216:219]
    s_add_u32 s28, s28, 1
    v_mfma_f32_16x16x32_bf16 v[212:215], v[124:127], a[184:187], v[212:215]
    ds_read_b128 v[188:191], v15 offset:34560
    v_mfma_f32_16x16x32_bf16 v[220:223], v[124:127], a[188:191], v[220:223]
    s_waitcnt lgkmcnt(12)
    v_mfma_f32_16x16x32_bf16 v[208:211], v[128:131], a[192:195], v[208:211]
    v_mfma_f32_16x16x32_bf16 v[216:219], v[128:131], a[196:199], v[216:219]
    v_mfma_f32_16x16x32_bf16 v[212:215], v[132:135], a[192:195], v[212:215]
    v_mfma_f32_16x16x32_bf16 v[220:223], v[132:135], a[196:199], v[220:223]
    v_mfma_f32_16x16x32_bf16 v[208:211], v[136:139], a[200:203], v[208:211]
    v_mfma_f32_16x16x32_bf16 v[216:219], v[136:139], a[204:207], v[216:219]
    s_add_u32 s29, s29, 0x10000
    s_and_b32 s29, s29, 0x3fffff
    v_mfma_f32_16x16x32_bf16 v[212:215], v[140:143], a[200:203], v[212:215]
    v_mfma_f32_16x16x32_bf16 v[220:223], v[140:143], a[204:207], v[220:223]
    s_waitcnt vmcnt(3) lgkmcnt(0)
    s_barrier
    v_mfma_f32_16x16x32_bf16 v[208:211], v[144:147], a[208:211], v[208:211]
    ds_read_b128 v[64:67], v8 offset:0
    ds_read_b128 v[68:71], v8 offset:32768
    v_mfma_f32_16x16x32_bf16 v[216:219], v[144:147], a[212:215], v[216:219]
    s_add_u32 m0, s6, 65536
    v_mfma_f32_16x16x32_bf16 v[212:215], v[148:151], a[208:211], v[212:215]
    ds_read_b128 v[72:75], v9 offset:0
    ds_read_b128 v[76:79], v9 offset:32768
    v_mfma_f32_16x16x32_bf16 v[220:223], v[148:151], a[212:215], v[220:223]
    buffer_load_dwordx4 v16, s[12:15], s29 offen offset:0 lds
    v_mfma_f32_16x16x32_bf16 v[208:211], v[152:155], a[216:219], v[208:211]
    ds_read_b128 v[80:83], v10 offset:0
    ds_read_b128 v[84:87], v10 offset:32768
    v_mfma_f32_16x16x32_bf16 v[216:219], v[152:155], a[220:223], v[216:219]
    v_mfma_f32_16x16x32_bf16 v[212:215], v[156:159], a[216:219], v[212:215]
    ds_read_b128 v[88:91], v11 offset:0
    ds_read_b128 v[92:95], v11 offset:32768
    v_mfma_f32_16x16x32_bf16 v[220:223], v[156:159], a[220:223], v[220:223]
    buffer_load_dwordx4 v16, s[12:15], s29 offen offset:1024 lds
    v_mfma_f32_16x16x32_bf16 v[208:211], v[160:163], a[224:227], v[208:211]
    ds_read_b128 v[96:99], v8 offset:256
    v_mfma_f32_16x16x32_bf16 v[216:219], v[160:163], a[228:231], v[216:219]
    v_mfma_f32_16x16x32_bf16 v[212:215], v[164:167], a[224:227], v[212:215]
    ds_read_b128 v[100:103], v8 offset:33024
    v_mfma_f32_16x16x32_bf16 v[220:223], v[164:167], a[228:231], v[220:223]
    buffer_load_dwordx4 v17, s[12:15], s29 offen offset:2048 lds
    v_mfma_f32_16x16x32_bf16 v[208:211], v[168:171], a[232:235], v[208:211]
    ds_read_b128 v[104:107], v9 offset:256
    v_mfma_f32_16x16x32_bf16 v[216:219], v[168:171], a[236:239], v[216:219]
    v_mfma_f32_16x16x32_bf16 v[212:215], v[172:175], a[232:235], v[212:215]
    ds_read_b128 v[108:111], v9 offset:33024
    v_mfma_f32_16x16x32_bf16 v[220:223], v[172:175], a[236:239], v[220:223]
    buffer_load_dwordx4 v17, s[12:15], s29 offen offset:3072 lds
    v_mfma_f32_16x16x32_bf16 v[208:211], v[176:179], a[240:243], v[208:211]
    ds_read_b128 v[112:115], v10 offset:256
    v_mfma_f32_16x16x32_bf16 v[216:219], v[176:179], a[244:247], v[216:219]
    s_add_u32 m0, s6, 69632
    v_mfma_f32_16x16x32_bf16 v[212:215], v[180:183], a[240:243], v[212:215]
    ds_read_b128 v[116:119], v10 offset:33024
    v_mfma_f32_16x16x32_bf16 v[220:223], v[180:183], a[244:247], v[220:223]
    buffer_load_dwordx4 v18, s[12:15], s29 offen offset:0 lds
    v_mfma_f32_16x16x32_bf16 v[208:211], v[184:187], a[248:251], v[208:211]
    ds_read_b128 v[120:123], v11 offset:256
    v_mfma_f32_16x16x32_bf16 v[216:219], v[184:187], a[252:255], v[216:219]
    v_mfma_f32_16x16x32_bf16 v[212:215], v[188:191], a[248:251], v[212:215]
    ds_read_b128 v[124:127], v11 offset:33024
    v_mfma_f32_16x16x32_bf16 v[220:223], v[188:191], a[252:255], v[220:223]
    buffer_load_dwordx4 v18, s[12:15], s29 offen offset:1024 lds
    s_cmp_lt_u32 s28, 64
    s_cbranch_scc1 .ql_408
.qe_406:
    s_nop 7
    v_cvt_pk_bf16_f32 v224, v208, v209
    v_cvt_pk_bf16_f32 v225, v210, v211
    v_cvt_pk_bf16_f32 v226, v212, v213
    v_cvt_pk_bf16_f32 v227, v214, v215
    v_cvt_pk_bf16_f32 v228, v216, v217
    v_cvt_pk_bf16_f32 v229, v218, v219
    v_cvt_pk_bf16_f32 v230, v220, v221
    v_cvt_pk_bf16_f32 v231, v222, v223
    buffer_store_dwordx4 v[224:227], v24, s[8:11], s30 offen sc1
    buffer_store_dwordx4 v[228:231], v25, s[8:11], s30 offen sc1
    s_cmp_eq_u32 s98, 0
    s_cbranch_scc1 .qa_404
    s_waitcnt vmcnt(0) lgkmcnt(0)
    v_mov_b32 v27, s28
    s_mov_b64 exec, 1
    buffer_store_dword v27, v26, s[8:11], s94 offen sc1
    s_mov_b64 exec, -1
    s_barrier
    s_sub_u32 s95, s98, 1
    s_load_dwordx8 s[40:47], s[0:1], 0
    s_load_dwordx4 s[48:51], s[0:1], 32
    s_load_dwordx2 s[52:53], s[0:1], 104
    s_mul_i32 s6, s24, 8320
    s_add_u32 s6, s6, 122880
    s_lshl_b32 s97, s95, 4
    s_and_b32 s4, s99, 16
    s_add_u32 s97, s97, s4
    s_add_u32 s97, s97, s99
    s_lshl1_add_u32 s97, s99, s95
    s_lshl_b32 s4, s97, 16
    s_lshl_b32 s5, s24, 14
    s_add_u32 s4, s4, s5
    v_lshlrev_b32 v2, 4, v1
    v_bfe_u32 v254, v1, 0, 3
    v_mul_u32_u24 v3, 2048, v254
    v_bfe_u32 v254, v1, 4, 2
    v_mul_u32_u24 v254, 16, v254
    v_add_u32 v3, v3, v254
    v_add_u32 v3, s4, v3
    v_bfe_u32 v254, v1, 4, 2
    v_mul_u32_u24 v4, 16, v254
    v_add_u32 v4, s6, v4
    s_waitcnt lgkmcnt(0)
    s_mov_b32 s12, s40
    s_and_b32 s13, s41, 0xffff
    s_mov_b32 s14, 0x400000
    s_mov_b32 s15, 0x00020000
    s_mov_b32 s16, s42
    s_and_b32 s17, s43, 0xffff
    s_mov_b32 s18, 0x400000
    s_mov_b32 s19, 0x00020000
    s_mov_b32 s28, s44
    s_and_b32 s29, s45, 0xffff
    s_mov_b32 s30, 0x400000
    s_mov_b32 s31, 0x00020000
    s_mov_b32 s32, s46
    s_and_b32 s33, s47, 0xffff
    s_mov_b32 s34, 0x2000
    s_mov_b32 s35, 0x00020000
    s_mov_b32 s36, s48
    s_and_b32 s37, s49, 0xffff
    s_mov_b32 s38, 0x400000
    s_mov_b32 s39, 0x00020000
    s_mov_b32 s56, s52
    s_and_b32 s57, s53, 0xffff
    s_mov_b32 s58, 0x800
    s_mov_b32 s59, 0x00020000
    s_lshr_b32 s4, s97, 4
    s_lshl_b32 s4, s4, 2
    s_add_u32 s4, s4, 92344320
    v_bfe_u32 v254, v1, 0, 5
    v_mul_u32_u24 v8, 128, v254
    v_add_u32 v8, s4, v8
    s_lshl_b32 s4, s97, 16
    s_lshr_b32 s5, s24, 1
    s_lshl_b32 s5, s5, 15
    s_add_u32 s4, s4, s5
    s_and_b32 s5, s24, 1
    s_lshl_b32 s5, s5, 10
    s_add_u32 s4, s4, s5
    s_add_u32 s4, s4, 125829120
    v_add_u32 v7, s4, v2
    s_mov_b32 s62, 0
.kw_409:
    buffer_load_dword v12, v8, s[8:11], 0 offen sc1
    s_add_u32 s62, s62, 1
    s_cmp_gt_u32 s62, 0x100000
    s_cbranch_scc1 .mg_end_1
    s_waitcnt vmcnt(0)
    v_cmp_eq_u32 vcc, 0, v12
    s_cbranch_vccz .kw_410
    s_sleep 16
    s_branch .kw_409
.kw_410:
    s_mov_b32 m0, s6
    s_lshl_b32 s60, s97, 4
    buffer_load_dwordx4 v2, s[56:59], 0 offen lds
    buffer_load_dwordx4 v2, s[56:59], 0 offen offset:1024 lds
    s_add_u32 s61, s60, s24
    v_subrev_u32 v5, 4, v2
    buffer_load_dwordx4 a[0:3], v3, s[12:15], 0 offen offset:0
    buffer_load_dwordx4 a[4:7], v3, s[12:15], 0 offen offset:64
    buffer_load_dwordx4 a[8:11], v3, s[12:15], 0 offen offset:128
    buffer_load_dwordx4 a[12:15], v3, s[12:15], 0 offen offset:192
    buffer_load_dwordx4 a[16:19], v3, s[12:15], 0 offen offset:256
    buffer_load_dwordx4 a[20:23], v3, s[12:15], 0 offen offset:320
    buffer_load_dwordx4 a[24:27], v3, s[12:15], 0 offen offset:384
    buffer_load_dwordx4 a[28:31], v3, s[12:15], 0 offen offset:448
    buffer_load_dwordx4 a[32:35], v3, s[12:15], 0 offen offset:512
    buffer_load_dwordx4 a[36:39], v3, s[12:15], 0 offen offset:576
    buffer_load_dwordx4 a[40:43], v3, s[12:15], 0 offen offset:640
    buffer_load_dwordx4 a[44:47], v3, s[12:15], 0 offen offset:704
    buffer_load_dwordx4 a[48:51], v3, s[12:15], 0 offen offset:768
    buffer_load_dwordx4 a[52:55], v3, s[12:15], 0 offen offset:832
    buffer_load_dwordx4 a[56:59], v3, s[12:15], 0 offen offset:896
    buffer_load_dwordx4 a[60:63], v3, s[12:15], 0 offen offset:960
    buffer_load_dwordx4 a[64:67], v3, s[12:15], 0 offen offset:1024
    buffer_load_dwordx4 a[68:71], v3, s[12:15], 0 offen offset:1088
    buffer_load_dwordx4 a[72:75], v3, s[12:15], 0 offen offset:1152
    buffer_load_dwordx4 a[76:79], v3, s[12:15], 0 offen offset:1216
    buffer_load_dwordx4 a[80:83], v3, s[12:15], 0 offen offset:1280
    buffer_load_dwordx4 a[84:87], v3, s[12:15], 0 offen offset:1344
    buffer_load_dwordx4 a[88:91], v3, s[12:15], 0 offen offset:1408
    buffer_load_dwordx4 a[92:95], v3, s[12:15], 0 offen offset:1472
    buffer_load_dwordx4 a[96:99], v3, s[12:15], 0 offen offset:1536
    buffer_load_dwordx4 a[100:103], v3, s[12:15], 0 offen offset:1600
    buffer_load_dwordx4 a[104:107], v3, s[12:15], 0 offen offset:1664
    buffer_load_dwordx4 a[108:111], v3, s[12:15], 0 offen offset:1728
    buffer_load_dwordx4 a[112:115], v3, s[12:15], 0 offen offset:1792
    buffer_load_dwordx4 a[116:119], v3, s[12:15], 0 offen offset:1856
    buffer_load_dwordx4 a[120:123], v3, s[12:15], 0 offen offset:1920
    buffer_load_dwordx4 a[124:127], v3, s[12:15], 0 offen offset:1984
    s_waitcnt vmcnt(32)
    ds_read_b128 a[128:131], v4 offset:0
    ds_read_b128 a[132:135], v4 offset:64
    ds_read_b128 a[136:139], v4 offset:128
    ds_read_b128 a[140:143], v4 offset:192
    ds_read_b128 a[144:147], v4 offset:256
    ds_read_b128 a[148:151], v4 offset:320
    ds_read_b128 a[152:155], v4 offset:384
    ds_read_b128 a[156:159], v4 offset:448
    ds_read_b128 a[160:163], v4 offset:512
    ds_read_b128 a[164:167], v4 offset:576
    ds_read_b128 a[168:171], v4 offset:640
    ds_read_b128 a[172:175], v4 offset:704
    ds_read_b128 a[176:179], v4 offset:768
    ds_read_b128 a[180:183], v4 offset:832
    ds_read_b128 a[184:187], v4 offset:896
    ds_read_b128 a[188:191], v4 offset:960
    ds_read_b128 a[192:195], v4 offset:1024
    ds_read_b128 a[196:199], v4 offset:1088
    ds_read_b128 a[200:203], v4 offset:1152
    ds_read_b128 a[204:207], v4 offset:1216
    ds_read_b128 a[208:211], v4 offset:1280
    ds_read_b128 a[212:215], v4 offset:1344
    ds_read_b128 a[216:219], v4 offset:1408
    ds_read_b128 a[220:223], v4 offset:1472
    ds_read_b128 a[224:227], v4 offset:1536
    ds_read_b128 a[228:231], v4 offset:1600
    ds_read_b128 a[232:235], v4 offset:1664
    ds_read_b128 a[236:239], v4 offset:1728
    ds_read_b128 a[240:243], v4 offset:1792
    ds_read_b128 a[244:247], v4 offset:1856
    ds_read_b128 a[248:251], v4 offset:1920
    ds_read_b128 a[252:255], v4 offset:1984
    s_mov_b32 s4, 0
    buffer_load_dwordx4 v[32:35], v7, s[8:11], s4 offen offset:0
    buffer_load_dwordx4 v[36:39], v7, s[8:11], s4 offen offset:2048
    s_mov_b32 s4, 4096
    buffer_load_dwordx4 v[40:43], v7, s[8:11], s4 offen offset:0
    buffer_load_dwordx4 v[44:47], v7, s[8:11], s4 offen offset:2048
    s_mov_b32 s4, 8192
    buffer_load_dwordx4 v[48:51], v7, s[8:11], s4 offen offset:0
    buffer_load_dwordx4 v[52:55], v7, s[8:11], s4 offen offset:2048
    s_mov_b32 s4, 12288
    buffer_load_dwordx4 v[56:59], v7, s[8:11], s4 offen offset:0
    buffer_load_dwordx4 v[60:63], v7, s[8:11], s4 offen offset:2048
    s_mov_b32 s4, 16384
    buffer_load_dwordx4 v[64:67], v7, s[8:11], s4 offen offset:0
    buffer_load_dwordx4 v[68:71], v7, s[8:11], s4 offen offset:2048
    s_mov_b32 s4, 20480
    buffer_load_dwordx4 v[72:75], v7, s[8:11], s4 offen offset:0
    buffer_load_dwordx4 v[76:79], v7, s[8:11], s4 offen offset:2048
    s_mov_b32 s4, 24576
    buffer_load_dwordx4 v[80:83], v7, s[8:11], s4 offen offset:0
    buffer_load_dwordx4 v[84:87], v7, s[8:11], s4 offen offset:2048
    s_mov_b32 s4, 28672
    buffer_load_dwordx4 v[88:91], v7, s[8:11], s4 offen offset:0
    buffer_load_dwordx4 v[92:95], v7, s[8:11], s4 offen offset:2048
    v_add_u32 v9, s6, v2
    v_and_b32 v12, 31, v1
    v_lshrrev_b32 v13, 5, v1
    v_lshlrev_b32 v14, 3, v13
    v_sub_u32 v14, v12, v14
    v_add_u32 v15, 10, v14
    v_and_b32 v10, 1, v15
    v_xor_b32 v10, 1, v10
    v_mul_u32_u24 v10, 4160, v10
    v_lshrrev_b32 v15, 1, v15
    v_lshl_add_u32 v10, v15, 2, v10
    v_add_u32 v10, s6, v10
    v_mul_u32_u24 v11, 80, v12
    v_lshl_add_u32 v11, v13, 4, v11
    s_mul_i32 s4, s24, 7680
    s_sub_u32 s4, s4, 2480
    v_add_u32 v11, s4, v11
    v_cmp_eq_u32 vcc, 7, v14
    v_mov_b32 v15, 0xffff
    s_nop 0
    v_cndmask_b32 v24, 0, v15, vcc
    v_cmp_eq_u32 vcc, 6, v14
    v_mov_b32 v15, 0xffff0000
    s_nop 0
    v_cndmask_b32 v24, v24, v15, vcc
    v_cmp_eq_u32 vcc, 5, v14
    v_mov_b32 v15, 0xffff
    s_nop 0
    v_cndmask_b32 v25, 0, v15, vcc
    v_cmp_eq_u32 vcc, 4, v14
    v_mov_b32 v15, 0xffff0000
    s_nop 0
    v_cndmask_b32 v25, v25, v15, vcc
    v_cmp_eq_u32 vcc, 3, v14
    v_mov_b32 v15, 0xffff
    s_nop 0
    v_cndmask_b32 v26, 0, v15, vcc
    v_cmp_eq_u32 vcc, 2, v14
    v_mov_b32 v15, 0xffff0000
    s_nop 0
    v_cndmask_b32 v26, v26, v15, vcc
    v_cmp_eq_u32 vcc, 1, v14
    v_mov_b32 v15, 0xffff
    s_nop 0
    v_cndmask_b32 v27, 0, v15, vcc
    v_cmp_eq_u32 vcc, 0, v14
    v_mov_b32 v15, 0xffff0000
    s_nop 0
    v_cndmask_b32 v27, v27, v15, vcc
    v_cmp_eq_u32 vcc, 23, v14
    v_mov_b32 v15, 0xffff
    s_nop 0
    v_cndmask_b32 v28, 0, v15, vcc
    v_cmp_eq_u32 vcc, 22, v14
    v_mov_b32 v15, 0xffff0000
    s_nop 0
    v_cndmask_b32 v28, v28, v15, vcc
    v_cmp_eq_u32 vcc, 21, v14
    v_mov_b32 v15, 0xffff
    s_nop 0
    v_cndmask_b32 v29, 0, v15, vcc
    v_cmp_eq_u32 vcc, 20, v14
    v_mov_b32 v15, 0xffff0000
    s_nop 0
    v_cndmask_b32 v29, v29, v15, vcc
    v_cmp_eq_u32 vcc, 19, v14
    v_mov_b32 v15, 0xffff
    s_nop 0
    v_cndmask_b32 v30, 0, v15, vcc
    v_cmp_eq_u32 vcc, 18, v14
    v_mov_b32 v15, 0xffff0000
    s_nop 0
    v_cndmask_b32 v30, v30, v15, vcc
    v_cmp_eq_u32 vcc, 17, v14
    v_mov_b32 v15, 0xffff
    s_nop 0
    v_cndmask_b32 v31, 0, v15, vcc
    v_cmp_eq_u32 vcc, 16, v14
    v_mov_b32 v15, 0xffff0000
    s_nop 0
    v_cndmask_b32 v31, v31, v15, vcc
    s_waitcnt lgkmcnt(0)
    s_waitcnt vmcnt(47)
    v_mfma_f32_16x16x32_bf16 v[216:219], a[128:131], a[0:3], 0
    s_waitcnt vmcnt(46)
    v_mfma_f32_16x16x32_bf16 v[216:219], a[132:135], a[4:7], v[216:219]
    s_waitcnt vmcnt(45)
    v_mfma_f32_16x16x32_bf16 v[216:219], a[136:139], a[8:11], v[216:219]
    s_waitcnt vmcnt(44)
    v_mfma_f32_16x16x32_bf16 v[216:219], a[140:143], a[12:15], v[216:219]
    s_waitcnt vmcnt(43)
    v_mfma_f32_16x16x32_bf16 v[216:219], a[144:147], a[16:19], v[216:219]
    s_waitcnt vmcnt(42)
    v_mfma_f32_16x16x32_bf16 v[216:219], a[148:151], a[20:23], v[216:219]
    s_waitcnt vmcnt(41)
    v_mfma_f32_16x16x32_bf16 v[216:219], a[152:155], a[24:27], v[216:219]
    s_waitcnt vmcnt(40)
    v_mfma_f32_16x16x32_bf16 v[216:219], a[156:159], a[28:31], v[216:219]
    s_waitcnt vmcnt(39)
    v_mfma_f32_16x16x32_bf16 v[216:219], a[160:163], a[32:35], v[216:219]
    s_waitcnt vmcnt(38)
    v_mfma_f32_16x16x32_bf16 v[216:219], a[164:167], a[36:39], v[216:219]
    s_waitcnt vmcnt(37)
    v_mfma_f32_16x16x32_bf16 v[216:219], a[168:171], a[40:43], v[216:219]
    s_waitcnt vmcnt(36)
    v_mfma_f32_16x16x32_bf16 v[216:219], a[172:175], a[44:47], v[216:219]
    s_waitcnt vmcnt(35)
    v_mfma_f32_16x16x32_bf16 v[216:219], a[176:179], a[48:51], v[216:219]
    s_waitcnt vmcnt(34)
    v_mfma_f32_16x16x32_bf16 v[216:219], a[180:183], a[52:55], v[216:219]
    s_waitcnt vmcnt(33)
    v_mfma_f32_16x16x32_bf16 v[216:219], a[184:187], a[56:59], v[216:219]
    s_waitcnt vmcnt(32)
    v_mfma_f32_16x16x32_bf16 v[216:219], a[188:191], a[60:63], v[216:219]
    s_waitcnt vmcnt(31)
    v_mfma_f32_16x16x32_bf16 v[216:219], a[192:195], a[64:67], v[216:219]
    s_waitcnt vmcnt(30)
    v_mfma_f32_16x16x32_bf16 v[216:219], a[196:199], a[68:71], v[216:219]
    s_waitcnt vmcnt(29)
    v_mfma_f32_16x16x32_bf16 v[216:219], a[200:203], a[72:75], v[216:219]
    s_waitcnt vmcnt(28)
    v_mfma_f32_16x16x32_bf16 v[216:219], a[204:207], a[76:79], v[216:219]
    s_waitcnt vmcnt(27)
    v_mfma_f32_16x16x32_bf16 v[216:219], a[208:211], a[80:83], v[216:219]
    s_waitcnt vmcnt(26)
    v_mfma_f32_16x16x32_bf16 v[216:219], a[212:215], a[84:87], v[216:219]
    s_waitcnt vmcnt(25)
    v_mfma_f32_16x16x32_bf16 v[216:219], a[216:219], a[88:91], v[216:219]
    s_waitcnt vmcnt(24)
    v_mfma_f32_16x16x32_bf16 v[216:219], a[220:223], a[92:95], v[216:219]
    s_waitcnt vmcnt(23)
    v_mfma_f32_16x16x32_bf16 v[216:219], a[224:227], a[96:99], v[216:219]
    s_waitcnt vmcnt(22)
    v_mfma_f32_16x16x32_bf16 v[216:219], a[228:231], a[100:103], v[216:219]
    s_waitcnt vmcnt(21)
    v_mfma_f32_16x16x32_bf16 v[216:219], a[232:235], a[104:107], v[216:219]
    s_waitcnt vmcnt(20)
    v_mfma_f32_16x16x32_bf16 v[216:219], a[236:239], a[108:111], v[216:219]
    s_waitcnt vmcnt(19)
    v_mfma_f32_16x16x32_bf16 v[216:219], a[240:243], a[112:115], v[216:219]
    s_waitcnt vmcnt(18)
    v_mfma_f32_16x16x32_bf16 v[216:219], a[244:247], a[116:119], v[216:219]
    s_waitcnt vmcnt(17)
    v_mfma_f32_16x16x32_bf16 v[216:219], a[248:251], a[120:123], v[216:219]
    s_waitcnt vmcnt(16)
    v_mfma_f32_16x16x32_bf16 v[216:219], a[252:255], a[124:127], v[216:219]
    s_lshl_b32 s4, s61, 12
    v_add_u32 v6, s4, v5
    buffer_load_dwordx4 v[184:187], v2, s[36:39], s4 offen offset:0
    buffer_load_dwordx4 v[188:191], v2, s[36:39], s4 offen offset:1024
    buffer_load_dwordx4 v[192:195], v2, s[36:39], s4 offen offset:2048
    buffer_load_dwordx4 v[196:199], v2, s[36:39], s4 offen offset:3072
    buffer_load_dword v200, v6, s[36:39], 0 offen
    buffer_load_dword v201, v2, s[36:39], s4 offen offset:1020
    buffer_load_dword v202, v2, s[36:39], s4 offen offset:2044
    buffer_load_dword v203, v2, s[36:39], s4 offen offset:3068
    v_cvt_pk_bf16_f32 v216, v216, v216
    v_lshlrev_b32 v216, 16, v216
    v_mul_f32 v216, 0xbfb8aa3b, v216
    v_exp_f32 v216, v216
    s_lshl_b32 s4, s97, 7
    v_add_f32 v216, 1.0, v216
    v_rcp_f32 v216, v216
    s_lshl_b32 s5, s24, 5
    v_cvt_pk_bf16_f32 v216, v216, v216
    v_lshlrev_b32 v216, 16, v216
    s_add_u32 s4, s4, s5
    s_add_u32 s4, s4, 121634816
    v_lshlrev_b32 v15, 2, v1
    s_mov_b64 exec, 0xff
    buffer_store_dword v216, v15, s[8:11], s4 offen sc1
    s_mov_b64 exec, -1
    v_mov_b32 v220, 0
    v_mov_b32 v221, 0
    v_mov_b32 v222, 0
    v_mov_b32 v223, 0
    s_mul_i32 s4, s24, 7680
    v_add_u32 v15, s4, v2
    ds_write_b128 v15, v[220:223] offset:0
    ds_write_b128 v15, v[220:223] offset:1024
    ds_write_b128 v15, v[220:223] offset:1536
    v_add_u32 v15, 30720, v15
    ds_write_b128 v15, v[220:223] offset:0
    ds_write_b128 v15, v[220:223] offset:1024
    ds_write_b128 v15, v[220:223] offset:1536
    v_add_u32 v15, 30720, v15
    ds_write_b128 v15, v[220:223] offset:0
    ds_write_b128 v15, v[220:223] offset:1024
    ds_write_b128 v15, v[220:223] offset:1536
    v_add_u32 v15, 30720, v15
    ds_write_b128 v15, v[220:223] offset:0
    ds_write_b128 v15, v[220:223] offset:1024
    ds_write_b128 v15, v[220:223] offset:1536
    v_add_u32 v15, 30720, v15
    s_mov_b64 exec, 0xf
    ds_write_b128 v9, v[220:223]
    ds_write_b128 v9, v[220:223] offset:4160
    s_mov_b64 exec, -1
    s_mul_i32 s4, s24, 640
    s_add_u32 s4, s4, 2560
    v_bfe_u32 v254, v1, 0, 1
    v_mul_u32_u24 v12, 61440, v254
    v_bfe_u32 v254, v1, 3, 3
    v_mul_u32_u24 v254, 80, v254
    v_add_u32 v12, v12, v254
    v_bfe_u32 v254, v1, 1, 2
    v_mul_u32_u24 v254, 16, v254
    v_add_u32 v12, v12, v254
    v_add_u32 v12, s4, v12
    s_lshl_b32 s4, s97, 7
    v_bfe_u32 v254, v1, 0, 1
    v_mul_u32_u24 v13, 64, v254
    v_add_u32 v13, s4, v13
    s_and_b32 s4, s97, 3
    s_lshl1_add_u32 s4, s4, s24
    s_and_b32 s5, s24, 2
    s_sub_u32 s4, s4, s5
    v_xor_b32 v13, s4, v1
    v_bfe_u32 v14, v13, 2, 1
    v_and_b32 v13, 3, v13
    v_lshlrev_b32 v13, 4, v13
    v_mul_u32_u24 v14, 80, v14
    v_add_u32 v13, v13, v14
    s_mul_i32 s5, s5, 1280
    s_and_b32 s4, s24, 1
    s_mul_i32 s4, s4, 61440
    s_add_u32 s4, s4, s5
    s_add_u32 s4, s4, 2560
    v_bfe_u32 v254, v1, 3, 3
    v_mul_u32_u24 v12, 7680, v254
    v_add_u32 v12, s4, v12
    v_add_u32 v12, v13, v12
    s_waitcnt vmcnt(0)
    ds_write_b128 v12, v[32:35] offset:0
    ds_write_b128 v12, v[36:39] offset:160
    ds_write_b128 v12, v[40:43] offset:320
    ds_write_b128 v12, v[44:47] offset:480
    ds_write_b128 v12, v[48:51] offset:640
    ds_write_b128 v12, v[52:55] offset:800
    ds_write_b128 v12, v[56:59] offset:960
    ds_write_b128 v12, v[60:63] offset:1120
    ds_write_b128 v12, v[64:67] offset:1280
    ds_write_b128 v12, v[68:71] offset:1440
    ds_write_b128 v12, v[72:75] offset:1600
    ds_write_b128 v12, v[76:79] offset:1760
    ds_write_b128 v12, v[80:83] offset:1920
    ds_write_b128 v12, v[84:87] offset:2080
    ds_write_b128 v12, v[88:91] offset:2240
    ds_write_b128 v12, v[92:95] offset:2400
    s_waitcnt vmcnt(0)
    s_waitcnt lgkmcnt(0)
    s_barrier
    s_mov_b32 s64, 0
    s_cmp_lg_u32 s24, 0
    s_cbranch_scc1 .sg_414
    s_mov_b64 exec, 1
    v_mov_b32 v4, 1
    v_mov_b32 v3, 0
    buffer_atomic_add v4, v3, s[20:23], 0 offen offset:192 sc1
    s_mov_b64 exec, -1
.sg_414:
.chan_412:
    s_lshr_b32 s4, s61, 1
    s_lshl_b32 s4, s4, 2
    s_load_dword s65, s[50:51], s4
    s_lshl_b32 s7, s61, 12
    s_add_u32 s7, s7, 130023424
    v_writelane_b32 v200, 0, 0
    ds_write_b128 v9, v[184:187] offset:64
    v_alignbit_b32 v204, v184, v200, 16
    v_alignbit_b32 v205, v185, v184, 16
    v_alignbit_b32 v206, v186, v185, 16
    v_alignbit_b32 v207, v187, v186, 16
    ds_write_b128 v9, v[204:207] offset:4224
    ds_write_b128 v9, v[188:191] offset:1088
    v_alignbit_b32 v208, v188, v201, 16
    v_alignbit_b32 v209, v189, v188, 16
    v_alignbit_b32 v210, v190, v189, 16
    v_alignbit_b32 v211, v191, v190, 16
    ds_write_b128 v9, v[208:211] offset:5248
    ds_write_b128 v9, v[192:195] offset:2112
    v_alignbit_b32 v212, v192, v202, 16
    v_alignbit_b32 v213, v193, v192, 16
    v_alignbit_b32 v214, v194, v193, 16
    v_alignbit_b32 v215, v195, v194, 16
    ds_write_b128 v9, v[212:215] offset:6272
    ds_write_b128 v9, v[196:199] offset:3136
    v_alignbit_b32 v216, v196, v203, 16
    v_alignbit_b32 v217, v197, v196, 16
    v_alignbit_b32 v218, v198, v197, 16
    v_alignbit_b32 v219, v199, v198, 16
    ds_write_b128 v9, v[216:219] offset:7296
    s_and_b32 s4, s61, 1
    s_lshl_b32 s4, s4, 4
    s_waitcnt lgkmcnt(0)
    s_lshr_b32 s65, s65, s4
    s_pack_ll_b32_b16 s65, s65, s65
    s_add_u32 s61, s61, 4
    s_cmp_eq_u32 s64, 3
    s_cbranch_scc1 .chan_412_ns
    s_lshl_b32 s4, s61, 12
    v_add_u32 v6, s4, v5
    buffer_load_dwordx4 v[184:187], v2, s[36:39], s4 offen offset:0
    buffer_load_dwordx4 v[188:191], v2, s[36:39], s4 offen offset:1024
    buffer_load_dwordx4 v[192:195], v2, s[36:39], s4 offen offset:2048
    buffer_load_dwordx4 v[196:199], v2, s[36:39], s4 offen offset:3072
    buffer_load_dword v200, v6, s[36:39], 0 offen
    buffer_load_dword v201, v2, s[36:39], s4 offen offset:1020
    buffer_load_dword v202, v2, s[36:39], s4 offen offset:2044
    buffer_load_dword v203, v2, s[36:39], s4 offen offset:3068
.chan_412_ns:
    v_and_b32 v16, s65, v24
    v_and_b32 v17, s65, v25
    v_and_b32 v18, s65, v26
    v_and_b32 v19, s65, v27
    v_and_b32 v20, s65, v28
    v_and_b32 v21, s65, v29
    v_and_b32 v22, s65, v30
    v_and_b32 v23, s65, v31
    v_mov_b32 v14, v10
    ds_read2_b32 a[32:33], v14 offset0:0 offset1:1
    ds_read2_b32 a[34:35], v14 offset0:2 offset1:3
    ds_read_b128 a[56:59], v11 offset:7632
    ds_read_b128 a[60:63], v11 offset:5072
    ds_read2_b32 a[36:37], v14 offset0:8 offset1:9
    ds_read2_b32 a[38:39], v14 offset0:10 offset1:11
    ds_read_b128 a[64:67], v11 offset:7600
    ds_read_b128 a[68:71], v11 offset:5040
    ds_read2_b32 a[40:41], v14 offset0:16 offset1:17
    ds_read2_b32 a[42:43], v14 offset0:18 offset1:19
    ds_read_b128 a[72:75], v11 offset:7552
    ds_read_b128 a[76:79], v11 offset:4992
    s_waitcnt lgkmcnt(9)
    v_mfma_f32_32x32x16_bf16 a[16:31], a[32:35], a[56:59], 0
    v_mfma_f32_32x32x16_bf16 a[16:31], v[20:23], a[56:59], a[16:31]
    ds_read2_b32 a[44:45], v14 offset0:24 offset1:25
    ds_read2_b32 a[46:47], v14 offset0:26 offset1:27
    s_waitcnt lgkmcnt(10)
    v_mfma_f32_32x32x16_bf16 a[0:15], a[32:35], a[60:63], 0
    v_mfma_f32_32x32x16_bf16 a[0:15], v[20:23], a[60:63], a[0:15]
    ds_read_b128 a[80:83], v11 offset:7520
    ds_read_b128 a[84:87], v11 offset:4960
    s_waitcnt lgkmcnt(9)
    v_mfma_f32_32x32x16_bf16 a[16:31], a[36:39], a[64:67], a[16:31]
    v_mfma_f32_32x32x16_bf16 a[16:31], v[16:19], a[64:67], a[16:31]
    ds_read2_b32 a[48:49], v14 offset0:32 offset1:33
    ds_read2_b32 a[50:51], v14 offset0:34 offset1:35
    s_waitcnt lgkmcnt(10)
    v_mfma_f32_32x32x16_bf16 a[0:15], a[36:39], a[68:71], a[0:15]
    v_mfma_f32_32x32x16_bf16 a[0:15], v[16:19], a[68:71], a[0:15]
    ds_read_b128 a[56:59], v11 offset:7472
    ds_read_b128 a[60:63], v11 offset:4912
    s_waitcnt lgkmcnt(9)
    v_mfma_f32_32x32x16_bf16 a[16:31], a[40:43], a[72:75], a[16:31]
    ds_read2_b32 a[52:53], v14 offset0:40 offset1:41
    ds_read2_b32 a[54:55], v14 offset0:42 offset1:43
    s_waitcnt lgkmcnt(10)
    v_mfma_f32_32x32x16_bf16 a[0:15], a[40:43], a[76:79], a[0:15]
    ds_read_b128 a[64:67], v11 offset:7440
    ds_read_b128 a[68:71], v11 offset:4880
    s_waitcnt lgkmcnt(9)
    v_mfma_f32_32x32x16_bf16 a[16:31], a[44:47], a[80:83], a[16:31]
    ds_read2_b32 a[32:33], v14 offset0:48 offset1:49
    ds_read2_b32 a[34:35], v14 offset0:50 offset1:51
    s_waitcnt lgkmcnt(10)
    v_mfma_f32_32x32x16_bf16 a[0:15], a[44:47], a[84:87], a[0:15]
    ds_read_b128 a[72:75], v11 offset:7392
    ds_read_b128 a[76:79], v11 offset:4832
    s_waitcnt lgkmcnt(9)
    v_mfma_f32_32x32x16_bf16 a[16:31], a[48:51], a[56:59], a[16:31]
    ds_read2_b32 a[36:37], v14 offset0:56 offset1:57
    ds_read2_b32 a[38:39], v14 offset0:58 offset1:59
    s_waitcnt lgkmcnt(10)
    v_mfma_f32_32x32x16_bf16 a[0:15], a[48:51], a[60:63], a[0:15]
    ds_read_b128 a[80:83], v11 offset:7360
    ds_read_b128 a[84:87], v11 offset:4800
    s_waitcnt lgkmcnt(9)
    v_mfma_f32_32x32x16_bf16 a[16:31], a[52:55], a[64:67], a[16:31]
    ds_read2_b32 a[40:41], v14 offset0:64 offset1:65
    ds_read2_b32 a[42:43], v14 offset0:66 offset1:67
    s_waitcnt lgkmcnt(10)
    v_mfma_f32_32x32x16_bf16 a[0:15], a[52:55], a[68:71], a[0:15]
    ds_read_b128 a[56:59], v11 offset:7312
    ds_read_b128 a[60:63], v11 offset:4752
    s_waitcnt lgkmcnt(9)
    v_mfma_f32_32x32x16_bf16 a[16:31], a[32:35], a[72:75], a[16:31]
    ds_read2_b32 a[44:45], v14 offset0:72 offset1:73
    ds_read2_b32 a[46:47], v14 offset0:74 offset1:75
    s_waitcnt lgkmcnt(10)
    v_mfma_f32_32x32x16_bf16 a[0:15], a[32:35], a[76:79], a[0:15]
    ds_read_b128 a[64:67], v11 offset:7280
    ds_read_b128 a[68:71], v11 offset:4720
    s_waitcnt lgkmcnt(9)
    v_mfma_f32_32x32x16_bf16 a[16:31], a[36:39], a[80:83], a[16:31]
    ds_read2_b32 a[48:49], v14 offset0:80 offset1:81
    ds_read2_b32 a[50:51], v14 offset0:82 offset1:83
    s_waitcnt lgkmcnt(10)
    v_mfma_f32_32x32x16_bf16 a[0:15], a[36:39], a[84:87], a[0:15]
    ds_read_b128 a[72:75], v11 offset:7232
    ds_read_b128 a[76:79], v11 offset:4672
    s_waitcnt lgkmcnt(9)
    v_mfma_f32_32x32x16_bf16 a[16:31], a[40:43], a[56:59], a[16:31]
    ds_read2_b32 a[52:53], v14 offset0:88 offset1:89
    ds_read2_b32 a[54:55], v14 offset0:90 offset1:91
    s_waitcnt lgkmcnt(10)
    v_mfma_f32_32x32x16_bf16 a[0:15], a[40:43], a[60:63], a[0:15]
    ds_read_b128 a[80:83], v11 offset:7200
    ds_read_b128 a[84:87], v11 offset:4640
    s_waitcnt lgkmcnt(9)
    v_mfma_f32_32x32x16_bf16 a[16:31], a[44:47], a[64:67], a[16:31]
    ds_read2_b32 a[32:33], v14 offset0:96 offset1:97
    ds_read2_b32 a[34:35], v14 offset0:98 offset1:99
    s_waitcnt lgkmcnt(10)
    v_mfma_f32_32x32x16_bf16 a[0:15], a[44:47], a[68:71], a[0:15]
    ds_read_b128 a[56:59], v11 offset:7152
    ds_read_b128 a[60:63], v11 offset:4592
    s_waitcnt lgkmcnt(9)
    v_mfma_f32_32x32x16_bf16 a[16:31], a[48:51], a[72:75], a[16:31]
    ds_read2_b32 a[36:37], v14 offset0:104 offset1:105
    ds_read2_b32 a[38:39], v14 offset0:106 offset1:107
    s_waitcnt lgkmcnt(10)
    v_mfma_f32_32x32x16_bf16 a[0:15], a[48:51], a[76:79], a[0:15]
    ds_read_b128 a[64:67], v11 offset:7120
    ds_read_b128 a[68:71], v11 offset:4560
    s_waitcnt lgkmcnt(9)
    v_mfma_f32_32x32x16_bf16 a[16:31], a[52:55], a[80:83], a[16:31]
    ds_read2_b32 a[40:41], v14 offset0:112 offset1:113
    ds_read2_b32 a[42:43], v14 offset0:114 offset1:115
    s_waitcnt lgkmcnt(10)
    v_mfma_f32_32x32x16_bf16 a[0:15], a[52:55], a[84:87], a[0:15]
    ds_read_b128 a[72:75], v11 offset:7072
    ds_read_b128 a[76:79], v11 offset:4512
    s_waitcnt lgkmcnt(9)
    v_mfma_f32_32x32x16_bf16 a[16:31], a[32:35], a[56:59], a[16:31]
    ds_read2_b32 a[44:45], v14 offset0:120 offset1:121
    ds_read2_b32 a[46:47], v14 offset0:122 offset1:123
    s_waitcnt lgkmcnt(10)
    v_mfma_f32_32x32x16_bf16 a[0:15], a[32:35], a[60:63], a[0:15]
    ds_read_b128 a[80:83], v11 offset:7040
    ds_read_b128 a[84:87], v11 offset:4480
    s_waitcnt lgkmcnt(9)
    v_mfma_f32_32x32x16_bf16 a[16:31], a[36:39], a[64:67], a[16:31]
    ds_read2_b32 a[48:49], v14 offset0:128 offset1:129
    ds_read2_b32 a[50:51], v14 offset0:130 offset1:131
    s_waitcnt lgkmcnt(10)
    v_mfma_f32_32x32x16_bf16 a[0:15], a[36:39], a[68:71], a[0:15]
    ds_read_b128 a[56:59], v11 offset:6992
    ds_read_b128 a[60:63], v11 offset:4432
    s_waitcnt lgkmcnt(9)
    v_mfma_f32_32x32x16_bf16 a[16:31], a[40:43], a[72:75], a[16:31]
    ds_read2_b32 a[52:53], v14 offset0:136 offset1:137
    ds_read2_b32 a[54:55], v14 offset0:138 offset1:139
    s_waitcnt lgkmcnt(10)
    v_mfma_f32_32x32x16_bf16 a[0:15], a[40:43], a[76:79], a[0:15]
    ds_read_b128 a[64:67], v11 offset:6960
    ds_read_b128 a[68:71], v11 offset:4400
    s_waitcnt lgkmcnt(9)
    v_mfma_f32_32x32x16_bf16 a[16:31], a[44:47], a[80:83], a[16:31]
    ds_read2_b32 a[32:33], v14 offset0:144 offset1:145
    ds_read2_b32 a[34:35], v14 offset0:146 offset1:147
    s_waitcnt lgkmcnt(10)
    v_mfma_f32_32x32x16_bf16 a[0:15], a[44:47], a[84:87], a[0:15]
    ds_read_b128 a[72:75], v11 offset:6912
    ds_read_b128 a[76:79], v11 offset:4352
    s_waitcnt lgkmcnt(9)
    v_mfma_f32_32x32x16_bf16 a[16:31], a[48:51], a[56:59], a[16:31]
    ds_read2_b32 a[36:37], v14 offset0:152 offset1:153
    ds_read2_b32 a[38:39], v14 offset0:154 offset1:155
    s_waitcnt lgkmcnt(10)
    v_mfma_f32_32x32x16_bf16 a[0:15], a[48:51], a[60:63], a[0:15]
    ds_read_b128 a[80:83], v11 offset:6880
    ds_read_b128 a[84:87], v11 offset:4320
    s_waitcnt lgkmcnt(9)
    v_mfma_f32_32x32x16_bf16 a[16:31], a[52:55], a[64:67], a[16:31]
    ds_read2_b32 a[40:41], v14 offset0:160 offset1:161
    ds_read2_b32 a[42:43], v14 offset0:162 offset1:163
    s_waitcnt lgkmcnt(10)
    v_mfma_f32_32x32x16_bf16 a[0:15], a[52:55], a[68:71], a[0:15]
    ds_read_b128 a[56:59], v11 offset:6832
    ds_read_b128 a[60:63], v11 offset:4272
    s_waitcnt lgkmcnt(9)
    v_mfma_f32_32x32x16_bf16 a[16:31], a[32:35], a[72:75], a[16:31]
    ds_read2_b32 a[44:45], v14 offset0:168 offset1:169
    ds_read2_b32 a[46:47], v14 offset0:170 offset1:171
    s_waitcnt lgkmcnt(10)
    v_mfma_f32_32x32x16_bf16 a[0:15], a[32:35], a[76:79], a[0:15]
    ds_read_b128 a[64:67], v11 offset:6800
    ds_read_b128 a[68:71], v11 offset:4240
    s_waitcnt lgkmcnt(9)
    v_mfma_f32_32x32x16_bf16 a[16:31], a[36:39], a[80:83], a[16:31]
    ds_read2_b32 a[48:49], v14 offset0:176 offset1:177
    ds_read2_b32 a[50:51], v14 offset0:178 offset1:179
    s_waitcnt lgkmcnt(10)
    v_mfma_f32_32x32x16_bf16 a[0:15], a[36:39], a[84:87], a[0:15]
    ds_read_b128 a[72:75], v11 offset:6752
    ds_read_b128 a[76:79], v11 offset:4192
    s_waitcnt lgkmcnt(9)
    v_mfma_f32_32x32x16_bf16 a[16:31], a[40:43], a[56:59], a[16:31]
    ds_read2_b32 a[52:53], v14 offset0:184 offset1:185
    ds_read2_b32 a[54:55], v14 offset0:186 offset1:187
    s_waitcnt lgkmcnt(10)
    v_mfma_f32_32x32x16_bf16 a[0:15], a[40:43], a[60:63], a[0:15]
    ds_read_b128 a[80:83], v11 offset:6720
    ds_read_b128 a[84:87], v11 offset:4160
    s_waitcnt lgkmcnt(9)
    v_mfma_f32_32x32x16_bf16 a[16:31], a[44:47], a[64:67], a[16:31]
    ds_read2_b32 a[32:33], v14 offset0:192 offset1:193
    ds_read2_b32 a[34:35], v14 offset0:194 offset1:195
    s_waitcnt lgkmcnt(10)
    v_mfma_f32_32x32x16_bf16 a[0:15], a[44:47], a[68:71], a[0:15]
    ds_read_b128 a[56:59], v11 offset:6672
    ds_read_b128 a[60:63], v11 offset:4112
    s_waitcnt lgkmcnt(9)
    v_mfma_f32_32x32x16_bf16 a[16:31], a[48:51], a[72:75], a[16:31]
    ds_read2_b32 a[36:37], v14 offset0:200 offset1:201
    ds_read2_b32 a[38:39], v14 offset0:202 offset1:203
    s_waitcnt lgkmcnt(10)
    v_mfma_f32_32x32x16_bf16 a[0:15], a[48:51], a[76:79], a[0:15]
    ds_read_b128 a[64:67], v11 offset:6640
    ds_read_b128 a[68:71], v11 offset:4080
    s_waitcnt lgkmcnt(9)
    v_mfma_f32_32x32x16_bf16 a[16:31], a[52:55], a[80:83], a[16:31]
    ds_read2_b32 a[40:41], v14 offset0:208 offset1:209
    ds_read2_b32 a[42:43], v14 offset0:210 offset1:211
    s_waitcnt lgkmcnt(10)
    v_mfma_f32_32x32x16_bf16 a[0:15], a[52:55], a[84:87], a[0:15]
    ds_read_b128 a[72:75], v11 offset:6592
    ds_read_b128 a[76:79], v11 offset:4032
    s_waitcnt lgkmcnt(9)
    v_mfma_f32_32x32x16_bf16 a[16:31], a[32:35], a[56:59], a[16:31]
    ds_read2_b32 a[44:45], v14 offset0:216 offset1:217
    ds_read2_b32 a[46:47], v14 offset0:218 offset1:219
    s_waitcnt lgkmcnt(10)
    v_mfma_f32_32x32x16_bf16 a[0:15], a[32:35], a[60:63], a[0:15]
    ds_read_b128 a[80:83], v11 offset:6560
    ds_read_b128 a[84:87], v11 offset:4000
    s_waitcnt lgkmcnt(9)
    v_mfma_f32_32x32x16_bf16 a[16:31], a[36:39], a[64:67], a[16:31]
    ds_read2_b32 a[48:49], v14 offset0:224 offset1:225
    ds_read2_b32 a[50:51], v14 offset0:226 offset1:227
    s_waitcnt lgkmcnt(10)
    v_mfma_f32_32x32x16_bf16 a[0:15], a[36:39], a[68:71], a[0:15]
    ds_read_b128 a[56:59], v11 offset:6512
    ds_read_b128 a[60:63], v11 offset:3952
    s_waitcnt lgkmcnt(9)
    v_mfma_f32_32x32x16_bf16 a[16:31], a[40:43], a[72:75], a[16:31]
    ds_read2_b32 a[52:53], v14 offset0:232 offset1:233
    ds_read2_b32 a[54:55], v14 offset0:234 offset1:235
    s_waitcnt lgkmcnt(10)
    v_mfma_f32_32x32x16_bf16 a[0:15], a[40:43], a[76:79], a[0:15]
    ds_read_b128 a[64:67], v11 offset:6480
    ds_read_b128 a[68:71], v11 offset:3920
    s_waitcnt lgkmcnt(9)
    v_mfma_f32_32x32x16_bf16 a[16:31], a[44:47], a[80:83], a[16:31]
    ds_read2_b32 a[32:33], v14 offset0:240 offset1:241
    ds_read2_b32 a[34:35], v14 offset0:242 offset1:243
    s_waitcnt lgkmcnt(10)
    v_mfma_f32_32x32x16_bf16 a[0:15], a[44:47], a[84:87], a[0:15]
    ds_read_b128 a[72:75], v11 offset:6432
    ds_read_b128 a[76:79], v11 offset:3872
    s_waitcnt lgkmcnt(9)
    v_mfma_f32_32x32x16_bf16 a[16:31], a[48:51], a[56:59], a[16:31]
    ds_read2_b32 a[36:37], v14 offset0:248 offset1:249
    ds_read2_b32 a[38:39], v14 offset0:250 offset1:251
    v_add_u32 v14, 1024, v14
    s_waitcnt lgkmcnt(10)
    v_mfma_f32_32x32x16_bf16 a[0:15], a[48:51], a[60:63], a[0:15]
    ds_read_b128 a[80:83], v11 offset:6400
    ds_read_b128 a[84:87], v11 offset:3840
    s_waitcnt lgkmcnt(9)
    v_mfma_f32_32x32x16_bf16 a[16:31], a[52:55], a[64:67], a[16:31]
    ds_read2_b32 a[40:41], v14 offset0:0 offset1:1
    ds_read2_b32 a[42:43], v14 offset0:2 offset1:3
    s_waitcnt lgkmcnt(10)
    v_mfma_f32_32x32x16_bf16 a[0:15], a[52:55], a[68:71], a[0:15]
    ds_read_b128 a[56:59], v11 offset:6352
    ds_read_b128 a[60:63], v11 offset:3792
    s_waitcnt lgkmcnt(9)
    v_mfma_f32_32x32x16_bf16 a[16:31], a[32:35], a[72:75], a[16:31]
    ds_read2_b32 a[44:45], v14 offset0:8 offset1:9
    ds_read2_b32 a[46:47], v14 offset0:10 offset1:11
    s_waitcnt lgkmcnt(10)
    v_mfma_f32_32x32x16_bf16 a[0:15], a[32:35], a[76:79], a[0:15]
    ds_read_b128 a[64:67], v11 offset:6320
    ds_read_b128 a[68:71], v11 offset:3760
    s_waitcnt lgkmcnt(9)
    v_mfma_f32_32x32x16_bf16 a[16:31], a[36:39], a[80:83], a[16:31]
    ds_read2_b32 a[48:49], v14 offset0:16 offset1:17
    ds_read2_b32 a[50:51], v14 offset0:18 offset1:19
    s_waitcnt lgkmcnt(10)
    v_mfma_f32_32x32x16_bf16 a[0:15], a[36:39], a[84:87], a[0:15]
    ds_read_b128 a[72:75], v11 offset:6272
    ds_read_b128 a[76:79], v11 offset:3712
    s_waitcnt lgkmcnt(9)
    v_mfma_f32_32x32x16_bf16 a[16:31], a[40:43], a[56:59], a[16:31]
    ds_read2_b32 a[52:53], v14 offset0:24 offset1:25
    ds_read2_b32 a[54:55], v14 offset0:26 offset1:27
    s_waitcnt lgkmcnt(10)
    v_mfma_f32_32x32x16_bf16 a[0:15], a[40:43], a[60:63], a[0:15]
    ds_read_b128 a[80:83], v11 offset:6240
    ds_read_b128 a[84:87], v11 offset:3680
    s_waitcnt lgkmcnt(9)
    v_mfma_f32_32x32x16_bf16 a[16:31], a[44:47], a[64:67], a[16:31]
    ds_read2_b32 a[32:33], v14 offset0:32 offset1:33
    ds_read2_b32 a[34:35], v14 offset0:34 offset1:35
    s_waitcnt lgkmcnt(10)
    v_mfma_f32_32x32x16_bf16 a[0:15], a[44:47], a[68:71], a[0:15]
    ds_read_b128 a[56:59], v11 offset:6192
    ds_read_b128 a[60:63], v11 offset:3632
    s_waitcnt lgkmcnt(9)
    v_mfma_f32_32x32x16_bf16 a[16:31], a[48:51], a[72:75], a[16:31]
    ds_read2_b32 a[36:37], v14 offset0:40 offset1:41
    ds_read2_b32 a[38:39], v14 offset0:42 offset1:43
    s_waitcnt lgkmcnt(10)
    v_mfma_f32_32x32x16_bf16 a[0:15], a[48:51], a[76:79], a[0:15]
    ds_read_b128 a[64:67], v11 offset:6160
    ds_read_b128 a[68:71], v11 offset:3600
    s_waitcnt lgkmcnt(9)
    v_mfma_f32_32x32x16_bf16 a[16:31], a[52:55], a[80:83], a[16:31]
    ds_read2_b32 a[40:41], v14 offset0:48 offset1:49
    ds_read2_b32 a[42:43], v14 offset0:50 offset1:51
    s_waitcnt lgkmcnt(10)
    v_mfma_f32_32x32x16_bf16 a[0:15], a[52:55], a[84:87], a[0:15]
    ds_read_b128 a[72:75], v11 offset:6112
    ds_read_b128 a[76:79], v11 offset:3552
    s_waitcnt lgkmcnt(9)
    v_mfma_f32_32x32x16_bf16 a[16:31], a[32:35], a[56:59], a[16:31]
    ds_read2_b32 a[44:45], v14 offset0:56 offset1:57
    ds_read2_b32 a[46:47], v14 offset0:58 offset1:59
    s_waitcnt lgkmcnt(10)
    v_mfma_f32_32x32x16_bf16 a[0:15], a[32:35], a[60:63], a[0:15]
    ds_read_b128 a[80:83], v11 offset:6080
    ds_read_b128 a[84:87], v11 offset:3520
    s_waitcnt lgkmcnt(9)
    v_mfma_f32_32x32x16_bf16 a[16:31], a[36:39], a[64:67], a[16:31]
    ds_read2_b32 a[48:49], v14 offset0:64 offset1:65
    ds_read2_b32 a[50:51], v14 offset0:66 offset1:67
    s_waitcnt lgkmcnt(10)
    v_mfma_f32_32x32x16_bf16 a[0:15], a[36:39], a[68:71], a[0:15]
    ds_read_b128 a[56:59], v11 offset:6032
    ds_read_b128 a[60:63], v11 offset:3472
    s_waitcnt lgkmcnt(9)
    v_mfma_f32_32x32x16_bf16 a[16:31], a[40:43], a[72:75], a[16:31]
    ds_read2_b32 a[52:53], v14 offset0:72 offset1:73
    ds_read2_b32 a[54:55], v14 offset0:74 offset1:75
    s_waitcnt lgkmcnt(10)
    v_mfma_f32_32x32x16_bf16 a[0:15], a[40:43], a[76:79], a[0:15]
    ds_read_b128 a[64:67], v11 offset:6000
    ds_read_b128 a[68:71], v11 offset:3440
    s_waitcnt lgkmcnt(9)
    v_mfma_f32_32x32x16_bf16 a[16:31], a[44:47], a[80:83], a[16:31]
    ds_read2_b32 a[32:33], v14 offset0:80 offset1:81
    ds_read2_b32 a[34:35], v14 offset0:82 offset1:83
    s_waitcnt lgkmcnt(10)
    v_mfma_f32_32x32x16_bf16 a[0:15], a[44:47], a[84:87], a[0:15]
    ds_read_b128 a[72:75], v11 offset:5952
    ds_read_b128 a[76:79], v11 offset:3392
    s_waitcnt lgkmcnt(9)
    v_mfma_f32_32x32x16_bf16 a[16:31], a[48:51], a[56:59], a[16:31]
    ds_read2_b32 a[36:37], v14 offset0:88 offset1:89
    ds_read2_b32 a[38:39], v14 offset0:90 offset1:91
    s_waitcnt lgkmcnt(10)
    v_mfma_f32_32x32x16_bf16 a[0:15], a[48:51], a[60:63], a[0:15]
    ds_read_b128 a[80:83], v11 offset:5920
    ds_read_b128 a[84:87], v11 offset:3360
    s_waitcnt lgkmcnt(9)
    v_mfma_f32_32x32x16_bf16 a[16:31], a[52:55], a[64:67], a[16:31]
    ds_read2_b32 a[40:41], v14 offset0:96 offset1:97
    ds_read2_b32 a[42:43], v14 offset0:98 offset1:99
    s_waitcnt lgkmcnt(10)
    v_mfma_f32_32x32x16_bf16 a[0:15], a[52:55], a[68:71], a[0:15]
    ds_read_b128 a[56:59], v11 offset:5872
    ds_read_b128 a[60:63], v11 offset:3312
    s_waitcnt lgkmcnt(9)
    v_mfma_f32_32x32x16_bf16 a[16:31], a[32:35], a[72:75], a[16:31]
    ds_read2_b32 a[44:45], v14 offset0:104 offset1:105
    ds_read2_b32 a[46:47], v14 offset0:106 offset1:107
    s_waitcnt lgkmcnt(10)
    v_mfma_f32_32x32x16_bf16 a[0:15], a[32:35], a[76:79], a[0:15]
    ds_read_b128 a[64:67], v11 offset:5840
    ds_read_b128 a[68:71], v11 offset:3280
    s_waitcnt lgkmcnt(9)
    v_mfma_f32_32x32x16_bf16 a[16:31], a[36:39], a[80:83], a[16:31]
    ds_read2_b32 a[48:49], v14 offset0:112 offset1:113
    ds_read2_b32 a[50:51], v14 offset0:114 offset1:115
    s_waitcnt lgkmcnt(10)
    v_mfma_f32_32x32x16_bf16 a[0:15], a[36:39], a[84:87], a[0:15]
    ds_read_b128 a[72:75], v11 offset:5792
    ds_read_b128 a[76:79], v11 offset:3232
    s_waitcnt lgkmcnt(9)
    v_mfma_f32_32x32x16_bf16 a[16:31], a[40:43], a[56:59], a[16:31]
    ds_read2_b32 a[52:53], v14 offset0:120 offset1:121
    ds_read2_b32 a[54:55], v14 offset0:122 offset1:123
    s_waitcnt lgkmcnt(10)
    v_mfma_f32_32x32x16_bf16 a[0:15], a[40:43], a[60:63], a[0:15]
    ds_read_b128 a[80:83], v11 offset:5760
    ds_read_b128 a[84:87], v11 offset:3200
    s_waitcnt lgkmcnt(9)
    v_mfma_f32_32x32x16_bf16 a[16:31], a[44:47], a[64:67], a[16:31]
    ds_read2_b32 a[32:33], v14 offset0:128 offset1:129
    ds_read2_b32 a[34:35], v14 offset0:130 offset1:131
    s_waitcnt lgkmcnt(10)
    v_mfma_f32_32x32x16_bf16 a[0:15], a[44:47], a[68:71], a[0:15]
    ds_read_b128 a[56:59], v11 offset:5712
    ds_read_b128 a[60:63], v11 offset:3152
    s_waitcnt lgkmcnt(9)
    v_mfma_f32_32x32x16_bf16 a[16:31], a[48:51], a[72:75], a[16:31]
    ds_read2_b32 a[36:37], v14 offset0:136 offset1:137
    ds_read2_b32 a[38:39], v14 offset0:138 offset1:139
    s_waitcnt lgkmcnt(10)
    v_mfma_f32_32x32x16_bf16 a[0:15], a[48:51], a[76:79], a[0:15]
    ds_read_b128 a[64:67], v11 offset:5680
    ds_read_b128 a[68:71], v11 offset:3120
    s_waitcnt lgkmcnt(9)
    v_mfma_f32_32x32x16_bf16 a[16:31], a[52:55], a[80:83], a[16:31]
    ds_read2_b32 a[40:41], v14 offset0:144 offset1:145
    ds_read2_b32 a[42:43], v14 offset0:146 offset1:147
    s_waitcnt lgkmcnt(10)
    v_mfma_f32_32x32x16_bf16 a[0:15], a[52:55], a[84:87], a[0:15]
    ds_read_b128 a[72:75], v11 offset:5632
    ds_read_b128 a[76:79], v11 offset:3072
    s_waitcnt lgkmcnt(9)
    v_mfma_f32_32x32x16_bf16 a[16:31], a[32:35], a[56:59], a[16:31]
    ds_read2_b32 a[44:45], v14 offset0:152 offset1:153
    ds_read2_b32 a[46:47], v14 offset0:154 offset1:155
    s_waitcnt lgkmcnt(10)
    v_mfma_f32_32x32x16_bf16 a[0:15], a[32:35], a[60:63], a[0:15]
    ds_read_b128 a[80:83], v11 offset:5600
    ds_read_b128 a[84:87], v11 offset:3040
    s_waitcnt lgkmcnt(9)
    v_mfma_f32_32x32x16_bf16 a[16:31], a[36:39], a[64:67], a[16:31]
    ds_read2_b32 a[48:49], v14 offset0:160 offset1:161
    ds_read2_b32 a[50:51], v14 offset0:162 offset1:163
    s_waitcnt lgkmcnt(10)
    v_mfma_f32_32x32x16_bf16 a[0:15], a[36:39], a[68:71], a[0:15]
    ds_read_b128 a[56:59], v11 offset:5552
    ds_read_b128 a[60:63], v11 offset:2992
    s_waitcnt lgkmcnt(9)
    v_mfma_f32_32x32x16_bf16 a[16:31], a[40:43], a[72:75], a[16:31]
    ds_read2_b32 a[52:53], v14 offset0:168 offset1:169
    ds_read2_b32 a[54:55], v14 offset0:170 offset1:171
    s_waitcnt lgkmcnt(10)
    v_mfma_f32_32x32x16_bf16 a[0:15], a[40:43], a[76:79], a[0:15]
    ds_read_b128 a[64:67], v11 offset:5520
    ds_read_b128 a[68:71], v11 offset:2960
    s_waitcnt lgkmcnt(9)
    v_mfma_f32_32x32x16_bf16 a[16:31], a[44:47], a[80:83], a[16:31]
    ds_read2_b32 a[32:33], v14 offset0:176 offset1:177
    ds_read2_b32 a[34:35], v14 offset0:178 offset1:179
    s_waitcnt lgkmcnt(10)
    v_mfma_f32_32x32x16_bf16 a[0:15], a[44:47], a[84:87], a[0:15]
    ds_read_b128 a[72:75], v11 offset:5472
    ds_read_b128 a[76:79], v11 offset:2912
    s_waitcnt lgkmcnt(9)
    v_mfma_f32_32x32x16_bf16 a[16:31], a[48:51], a[56:59], a[16:31]
    ds_read2_b32 a[36:37], v14 offset0:184 offset1:185
    ds_read2_b32 a[38:39], v14 offset0:186 offset1:187
    s_waitcnt lgkmcnt(10)
    v_mfma_f32_32x32x16_bf16 a[0:15], a[48:51], a[60:63], a[0:15]
    ds_read_b128 a[80:83], v11 offset:5440
    ds_read_b128 a[84:87], v11 offset:2880
    s_waitcnt lgkmcnt(9)
    v_mfma_f32_32x32x16_bf16 a[16:31], a[52:55], a[64:67], a[16:31]
    ds_read2_b32 a[40:41], v14 offset0:192 offset1:193
    ds_read2_b32 a[42:43], v14 offset0:194 offset1:195
    s_waitcnt lgkmcnt(10)
    v_mfma_f32_32x32x16_bf16 a[0:15], a[52:55], a[68:71], a[0:15]
    ds_read_b128 a[56:59], v11 offset:5392
    ds_read_b128 a[60:63], v11 offset:2832
    s_waitcnt lgkmcnt(9)
    v_mfma_f32_32x32x16_bf16 a[16:31], a[32:35], a[72:75], a[16:31]
    ds_read2_b32 a[44:45], v14 offset0:200 offset1:201
    ds_read2_b32 a[46:47], v14 offset0:202 offset1:203
    s_waitcnt lgkmcnt(10)
    v_mfma_f32_32x32x16_bf16 a[0:15], a[32:35], a[76:79], a[0:15]
    ds_read_b128 a[64:67], v11 offset:5360
    ds_read_b128 a[68:71], v11 offset:2800
    s_waitcnt lgkmcnt(9)
    v_mfma_f32_32x32x16_bf16 a[16:31], a[36:39], a[80:83], a[16:31]
    ds_read2_b32 a[48:49], v14 offset0:208 offset1:209
    ds_read2_b32 a[50:51], v14 offset0:210 offset1:211
    s_waitcnt lgkmcnt(10)
    v_mfma_f32_32x32x16_bf16 a[0:15], a[36:39], a[84:87], a[0:15]
    ds_read_b128 a[72:75], v11 offset:5312
    ds_read_b128 a[76:79], v11 offset:2752
    s_waitcnt lgkmcnt(9)
    v_mfma_f32_32x32x16_bf16 a[16:31], a[40:43], a[56:59], a[16:31]
    ds_read2_b32 a[52:53], v14 offset0:216 offset1:217
    ds_read2_b32 a[54:55], v14 offset0:218 offset1:219
    s_waitcnt lgkmcnt(10)
    v_mfma_f32_32x32x16_bf16 a[0:15], a[40:43], a[60:63], a[0:15]
    ds_read_b128 a[80:83], v11 offset:5280
    ds_read_b128 a[84:87], v11 offset:2720
    s_waitcnt lgkmcnt(9)
    v_mfma_f32_32x32x16_bf16 a[16:31], a[44:47], a[64:67], a[16:31]
    ds_read2_b32 a[32:33], v14 offset0:224 offset1:225
    ds_read2_b32 a[34:35], v14 offset0:226 offset1:227
    s_waitcnt lgkmcnt(10)
    v_mfma_f32_32x32x16_bf16 a[0:15], a[44:47], a[68:71], a[0:15]
    ds_read_b128 a[56:59], v11 offset:5232
    ds_read_b128 a[60:63], v11 offset:2672
    s_waitcnt lgkmcnt(9)
    v_mfma_f32_32x32x16_bf16 a[16:31], a[48:51], a[72:75], a[16:31]
    ds_read2_b32 a[36:37], v14 offset0:232 offset1:233
    ds_read2_b32 a[38:39], v14 offset0:234 offset1:235
    s_waitcnt lgkmcnt(10)
    v_mfma_f32_32x32x16_bf16 a[0:15], a[48:51], a[76:79], a[0:15]
    ds_read_b128 a[64:67], v11 offset:5200
    ds_read_b128 a[68:71], v11 offset:2640
    s_waitcnt lgkmcnt(9)
    v_mfma_f32_32x32x16_bf16 a[16:31], a[52:55], a[80:83], a[16:31]
    ds_read2_b32 a[40:41], v14 offset0:240 offset1:241
    ds_read2_b32 a[42:43], v14 offset0:242 offset1:243
    s_waitcnt lgkmcnt(10)
    v_mfma_f32_32x32x16_bf16 a[0:15], a[52:55], a[84:87], a[0:15]
    ds_read_b128 a[72:75], v11 offset:5152
    ds_read_b128 a[76:79], v11 offset:2592
    s_waitcnt lgkmcnt(9)
    v_mfma_f32_32x32x16_bf16 a[16:31], a[32:35], a[56:59], a[16:31]
    ds_read2_b32 a[44:45], v14 offset0:248 offset1:249
    ds_read2_b32 a[46:47], v14 offset0:250 offset1:251
    v_add_u32 v14, 1024, v14
    s_waitcnt lgkmcnt(10)
    v_mfma_f32_32x32x16_bf16 a[0:15], a[32:35], a[60:63], a[0:15]
    ds_read_b128 a[80:83], v11 offset:5120
    ds_read_b128 a[84:87], v11 offset:2560
    s_waitcnt lgkmcnt(9)
    v_mfma_f32_32x32x16_bf16 a[16:31], a[36:39], a[64:67], a[16:31]
    ds_read2_b32 a[48:49], v14 offset0:0 offset1:1
    ds_read2_b32 a[50:51], v14 offset0:2 offset1:3
    s_waitcnt lgkmcnt(10)
    v_mfma_f32_32x32x16_bf16 a[0:15], a[36:39], a[68:71], a[0:15]
    ds_read_b128 a[56:59], v11 offset:5072
    ds_read2_b32 a[52:53], v14 offset0:8 offset1:9
    ds_read2_b32 a[54:55], v14 offset0:10 offset1:11
    s_waitcnt lgkmcnt(10)
    v_mfma_f32_32x32x16_bf16 a[16:31], a[40:43], a[72:75], a[16:31]
    ds_read_b128 a[60:63], v11 offset:5040
    s_waitcnt lgkmcnt(10)
    v_mfma_f32_32x32x16_bf16 a[0:15], a[40:43], a[76:79], a[0:15]
    ds_read2_b32 a[32:33], v14 offset0:16 offset1:17
    ds_read2_b32 a[34:35], v14 offset0:18 offset1:19
    ds_read_b128 a[64:67], v11 offset:4992
    s_waitcnt lgkmcnt(10)
    v_mfma_f32_32x32x16_bf16 a[16:31], a[44:47], a[80:83], a[16:31]
    ds_read2_b32 a[36:37], v14 offset0:24 offset1:25
    ds_read2_b32 a[38:39], v14 offset0:26 offset1:27
    s_waitcnt lgkmcnt(11)
    v_mfma_f32_32x32x16_bf16 a[0:15], a[44:47], a[84:87], a[0:15]
    ds_read_b128 a[68:71], v11 offset:4960
    ds_read2_b32 a[40:41], v14 offset0:32 offset1:33
    ds_read2_b32 a[42:43], v14 offset0:34 offset1:35
    s_waitcnt lgkmcnt(11)
    v_mfma_f32_32x32x16_bf16 a[16:31], a[48:51], a[56:59], a[16:31]
    ds_read_b128 a[72:75], v11 offset:4912
    ds_read2_b32 a[44:45], v14 offset0:40 offset1:41
    ds_read2_b32 a[46:47], v14 offset0:42 offset1:43
    s_waitcnt lgkmcnt(11)
    v_mfma_f32_32x32x16_bf16 a[16:31], a[52:55], a[60:63], a[16:31]
    ds_read_b128 a[76:79], v11 offset:4880
    ds_read2_b32 a[48:49], v14 offset0:48 offset1:49
    ds_read2_b32 a[50:51], v14 offset0:50 offset1:51
    s_waitcnt lgkmcnt(11)
    v_mfma_f32_32x32x16_bf16 a[16:31], a[32:35], a[64:67], a[16:31]
    ds_read_b128 a[80:83], v11 offset:4832
    ds_read2_b32 a[52:53], v14 offset0:56 offset1:57
    ds_read2_b32 a[54:55], v14 offset0:58 offset1:59
    s_waitcnt lgkmcnt(11)
    v_mfma_f32_32x32x16_bf16 a[16:31], a[36:39], a[68:71], a[16:31]
    ds_read_b128 a[84:87], v11 offset:4800
    ds_read2_b32 a[32:33], v14 offset0:64 offset1:65
    ds_read2_b32 a[34:35], v14 offset0:66 offset1:67
    s_waitcnt lgkmcnt(11)
    v_mfma_f32_32x32x16_bf16 a[16:31], a[40:43], a[72:75], a[16:31]
    ds_read_b128 a[56:59], v11 offset:4752
    ds_read2_b32 a[36:37], v14 offset0:72 offset1:73
    ds_read2_b32 a[38:39], v14 offset0:74 offset1:75
    s_waitcnt lgkmcnt(11)
    v_mfma_f32_32x32x16_bf16 a[16:31], a[44:47], a[76:79], a[16:31]
    ds_read_b128 a[60:63], v11 offset:4720
    ds_read2_b32 a[40:41], v14 offset0:80 offset1:81
    ds_read2_b32 a[42:43], v14 offset0:82 offset1:83
    s_waitcnt lgkmcnt(11)
    v_mfma_f32_32x32x16_bf16 a[16:31], a[48:51], a[80:83], a[16:31]
    ds_read_b128 a[64:67], v11 offset:4672
    ds_read2_b32 a[44:45], v14 offset0:88 offset1:89
    ds_read2_b32 a[46:47], v14 offset0:90 offset1:91
    s_waitcnt lgkmcnt(11)
    v_mfma_f32_32x32x16_bf16 a[16:31], a[52:55], a[84:87], a[16:31]
    ds_read_b128 a[68:71], v11 offset:4640
    ds_read2_b32 a[48:49], v14 offset0:96 offset1:97
    ds_read2_b32 a[50:51], v14 offset0:98 offset1:99
    s_waitcnt lgkmcnt(11)
    v_mfma_f32_32x32x16_bf16 a[16:31], a[32:35], a[56:59], a[16:31]
    ds_read_b128 a[72:75], v11 offset:4592
    ds_read2_b32 a[52:53], v14 offset0:104 offset1:105
    ds_read2_b32 a[54:55], v14 offset0:106 offset1:107
    s_waitcnt lgkmcnt(11)
    v_mfma_f32_32x32x16_bf16 a[16:31], a[36:39], a[60:63], a[16:31]
    ds_read_b128 a[76:79], v11 offset:4560
    ds_read2_b32 a[32:33], v14 offset0:112 offset1:113
    ds_read2_b32 a[34:35], v14 offset0:114 offset1:115
    s_waitcnt lgkmcnt(11)
    v_mfma_f32_32x32x16_bf16 a[16:31], a[40:43], a[64:67], a[16:31]
    ds_read_b128 a[80:83], v11 offset:4512
    ds_read2_b32 a[36:37], v14 offset0:120 offset1:121
    ds_read2_b32 a[38:39], v14 offset0:122 offset1:123
    s_waitcnt lgkmcnt(11)
    v_mfma_f32_32x32x16_bf16 a[16:31], a[44:47], a[68:71], a[16:31]
    ds_read_b128 a[84:87], v11 offset:4480
    ds_read2_b32 a[40:41], v14 offset0:128 offset1:129
    ds_read2_b32 a[42:43], v14 offset0:130 offset1:131
    s_waitcnt lgkmcnt(11)
    v_mfma_f32_32x32x16_bf16 a[16:31], a[48:51], a[72:75], a[16:31]
    ds_read_b128 a[56:59], v11 offset:4432
    ds_read2_b32 a[44:45], v14 offset0:136 offset1:137
    ds_read2_b32 a[46:47], v14 offset0:138 offset1:139
    s_waitcnt lgkmcnt(11)
    v_mfma_f32_32x32x16_bf16 a[16:31], a[52:55], a[76:79], a[16:31]
    ds_read_b128 a[60:63], v11 offset:4400
    ds_read2_b32 a[48:49], v14 offset0:144 offset1:145
    ds_read2_b32 a[50:51], v14 offset0:146 offset1:147
    s_waitcnt lgkmcnt(11)
    v_mfma_f32_32x32x16_bf16 a[16:31], a[32:35], a[80:83], a[16:31]
    ds_read_b128 a[64:67], v11 offset:4352
    ds_read2_b32 a[52:53], v14 offset0:152 offset1:153
    ds_read2_b32 a[54:55], v14 offset0:154 offset1:155
    s_waitcnt lgkmcnt(11)
    v_mfma_f32_32x32x16_bf16 a[16:31], a[36:39], a[84:87], a[16:31]
    ds_read_b128 a[68:71], v11 offset:4320
    ds_read2_b32 a[32:33], v14 offset0:160 offset1:161
    ds_read2_b32 a[34:35], v14 offset0:162 offset1:163
    s_waitcnt lgkmcnt(11)
    v_mfma_f32_32x32x16_bf16 a[16:31], a[40:43], a[56:59], a[16:31]
    ds_read_b128 a[72:75], v11 offset:4272
    ds_read2_b32 a[36:37], v14 offset0:168 offset1:169
    ds_read2_b32 a[38:39], v14 offset0:170 offset1:171
    s_waitcnt lgkmcnt(11)
    v_mfma_f32_32x32x16_bf16 a[16:31], a[44:47], a[60:63], a[16:31]
    ds_read_b128 a[76:79], v11 offset:4240
    ds_read2_b32 a[40:41], v14 offset0:176 offset1:177
    ds_read2_b32 a[42:43], v14 offset0:178 offset1:179
    s_waitcnt lgkmcnt(11)
    v_mfma_f32_32x32x16_bf16 a[16:31], a[48:51], a[64:67], a[16:31]
    ds_read_b128 a[80:83], v11 offset:4192
    ds_read2_b32 a[44:45], v14 offset0:184 offset1:185
    ds_read2_b32 a[46:47], v14 offset0:186 offset1:187
    s_waitcnt lgkmcnt(11)
    v_mfma_f32_32x32x16_bf16 a[16:31], a[52:55], a[68:71], a[16:31]
    ds_read_b128 a[84:87], v11 offset:4160
    ds_read2_b32 a[48:49], v14 offset0:192 offset1:193
    ds_read2_b32 a[50:51], v14 offset0:194 offset1:195
    s_waitcnt lgkmcnt(11)
    v_mfma_f32_32x32x16_bf16 a[16:31], a[32:35], a[72:75], a[16:31]
    ds_read_b128 a[56:59], v11 offset:4112
    ds_read2_b32 a[52:53], v14 offset0:200 offset1:201
    ds_read2_b32 a[54:55], v14 offset0:202 offset1:203
    s_waitcnt lgkmcnt(11)
    v_mfma_f32_32x32x16_bf16 a[16:31], a[36:39], a[76:79], a[16:31]
    ds_read_b128 a[60:63], v11 offset:4080
    ds_read2_b32 a[32:33], v14 offset0:208 offset1:209
    ds_read2_b32 a[34:35], v14 offset0:210 offset1:211
    s_waitcnt lgkmcnt(11)
    v_mfma_f32_32x32x16_bf16 a[16:31], a[40:43], a[80:83], a[16:31]
    ds_read_b128 a[64:67], v11 offset:4032
    ds_read2_b32 a[36:37], v14 offset0:216 offset1:217
    ds_read2_b32 a[38:39], v14 offset0:218 offset1:219
    s_waitcnt lgkmcnt(11)
    v_mfma_f32_32x32x16_bf16 a[16:31], a[44:47], a[84:87], a[16:31]
    ds_read_b128 a[68:71], v11 offset:4000
    ds_read2_b32 a[40:41], v14 offset0:224 offset1:225
    ds_read2_b32 a[42:43], v14 offset0:226 offset1:227
    s_waitcnt lgkmcnt(11)
    v_mfma_f32_32x32x16_bf16 a[16:31], a[48:51], a[56:59], a[16:31]
    ds_read_b128 a[72:75], v11 offset:3952
    ds_read2_b32 a[44:45], v14 offset0:232 offset1:233
    ds_read2_b32 a[46:47], v14 offset0:234 offset1:235
    s_waitcnt lgkmcnt(11)
    v_mfma_f32_32x32x16_bf16 a[16:31], a[52:55], a[60:63], a[16:31]
    ds_read_b128 a[76:79], v11 offset:3920
    ds_read2_b32 a[48:49], v14 offset0:240 offset1:241
    ds_read2_b32 a[50:51], v14 offset0:242 offset1:243
    s_waitcnt lgkmcnt(11)
    v_mfma_f32_32x32x16_bf16 a[16:31], a[32:35], a[64:67], a[16:31]
    ds_read_b128 a[80:83], v11 offset:3872
    ds_read2_b32 a[52:53], v14 offset0:248 offset1:249
    ds_read2_b32 a[54:55], v14 offset0:250 offset1:251
    v_add_u32 v14, 1024, v14
    s_waitcnt lgkmcnt(11)
    v_mfma_f32_32x32x16_bf16 a[16:31], a[36:39], a[68:71], a[16:31]
    ds_read_b128 a[84:87], v11 offset:3840
    ds_read2_b32 a[32:33], v14 offset0:0 offset1:1
    ds_read2_b32 a[34:35], v14 offset0:2 offset1:3
    s_waitcnt lgkmcnt(11)
    v_mfma_f32_32x32x16_bf16 a[16:31], a[40:43], a[72:75], a[16:31]
    ds_read_b128 a[56:59], v11 offset:3792
    ds_read2_b32 a[36:37], v14 offset0:8 offset1:9
    ds_read2_b32 a[38:39], v14 offset0:10 offset1:11
    s_waitcnt lgkmcnt(11)
    v_mfma_f32_32x32x16_bf16 a[16:31], a[44:47], a[76:79], a[16:31]
    ds_read_b128 a[60:63], v11 offset:3760
    ds_read2_b32 a[40:41], v14 offset0:16 offset1:17
    ds_read2_b32 a[42:43], v14 offset0:18 offset1:19
    s_waitcnt lgkmcnt(11)
    v_mfma_f32_32x32x16_bf16 a[16:31], a[48:51], a[80:83], a[16:31]
    ds_read_b128 a[64:67], v11 offset:3712
    ds_read2_b32 a[44:45], v14 offset0:24 offset1:25
    ds_read2_b32 a[46:47], v14 offset0:26 offset1:27
    s_waitcnt lgkmcnt(11)
    v_mfma_f32_32x32x16_bf16 a[16:31], a[52:55], a[84:87], a[16:31]
    ds_read_b128 a[68:71], v11 offset:3680
    ds_read2_b32 a[48:49], v14 offset0:32 offset1:33
    ds_read2_b32 a[50:51], v14 offset0:34 offset1:35
    s_waitcnt lgkmcnt(11)
    v_mfma_f32_32x32x16_bf16 a[16:31], a[32:35], a[56:59], a[16:31]
    ds_read_b128 a[72:75], v11 offset:3632
    ds_read2_b32 a[52:53], v14 offset0:40 offset1:41
    ds_read2_b32 a[54:55], v14 offset0:42 offset1:43
    s_waitcnt lgkmcnt(11)
    v_mfma_f32_32x32x16_bf16 a[16:31], a[36:39], a[60:63], a[16:31]
    ds_read_b128 a[76:79], v11 offset:3600
    ds_read2_b32 a[32:33], v14 offset0:48 offset1:49
    ds_read2_b32 a[34:35], v14 offset0:50 offset1:51
    s_waitcnt lgkmcnt(11)
    v_mfma_f32_32x32x16_bf16 a[16:31], a[40:43], a[64:67], a[16:31]
    ds_read_b128 a[80:83], v11 offset:3552
    ds_read2_b32 a[36:37], v14 offset0:56 offset1:57
    ds_read2_b32 a[38:39], v14 offset0:58 offset1:59
    s_waitcnt lgkmcnt(11)
    v_mfma_f32_32x32x16_bf16 a[16:31], a[44:47], a[68:71], a[16:31]
    ds_read_b128 a[84:87], v11 offset:3520
    ds_read2_b32 a[40:41], v14 offset0:64 offset1:65
    ds_read2_b32 a[42:43], v14 offset0:66 offset1:67
    s_waitcnt lgkmcnt(11)
    v_mfma_f32_32x32x16_bf16 a[16:31], a[48:51], a[72:75], a[16:31]
    ds_read_b128 a[56:59], v11 offset:3472
    ds_read2_b32 a[44:45], v14 offset0:72 offset1:73
    ds_read2_b32 a[46:47], v14 offset0:74 offset1:75
    s_waitcnt lgkmcnt(11)
    v_mfma_f32_32x32x16_bf16 a[16:31], a[52:55], a[76:79], a[16:31]
    ds_read_b128 a[60:63], v11 offset:3440
    ds_read2_b32 a[48:49], v14 offset0:80 offset1:81
    ds_read2_b32 a[50:51], v14 offset0:82 offset1:83
    s_waitcnt lgkmcnt(11)
    v_mfma_f32_32x32x16_bf16 a[16:31], a[32:35], a[80:83], a[16:31]
    ds_read_b128 a[64:67], v11 offset:3392
    ds_read2_b32 a[52:53], v14 offset0:88 offset1:89
    ds_read2_b32 a[54:55], v14 offset0:90 offset1:91
    s_waitcnt lgkmcnt(11)
    v_mfma_f32_32x32x16_bf16 a[16:31], a[36:39], a[84:87], a[16:31]
    ds_read_b128 a[68:71], v11 offset:3360
    ds_read2_b32 a[32:33], v14 offset0:96 offset1:97
    ds_read2_b32 a[34:35], v14 offset0:98 offset1:99
    s_waitcnt lgkmcnt(11)
    v_mfma_f32_32x32x16_bf16 a[16:31], a[40:43], a[56:59], a[16:31]
    ds_read_b128 a[72:75], v11 offset:3312
    ds_read2_b32 a[36:37], v14 offset0:104 offset1:105
    ds_read2_b32 a[38:39], v14 offset0:106 offset1:107
    s_waitcnt lgkmcnt(11)
    v_mfma_f32_32x32x16_bf16 a[16:31], a[44:47], a[60:63], a[16:31]
    ds_read_b128 a[76:79], v11 offset:3280
    ds_read2_b32 a[40:41], v14 offset0:112 offset1:113
    ds_read2_b32 a[42:43], v14 offset0:114 offset1:115
    s_waitcnt lgkmcnt(11)
    v_mfma_f32_32x32x16_bf16 a[16:31], a[48:51], a[64:67], a[16:31]
    ds_read_b128 a[80:83], v11 offset:3232
    ds_read2_b32 a[44:45], v14 offset0:120 offset1:121
    ds_read2_b32 a[46:47], v14 offset0:122 offset1:123
    s_waitcnt lgkmcnt(11)
    v_mfma_f32_32x32x16_bf16 a[16:31], a[52:55], a[68:71], a[16:31]
    ds_read_b128 a[84:87], v11 offset:3200
    ds_read2_b32 a[48:49], v14 offset0:128 offset1:129
    ds_read2_b32 a[50:51], v14 offset0:130 offset1:131
    s_waitcnt lgkmcnt(11)
    v_mfma_f32_32x32x16_bf16 a[16:31], a[32:35], a[72:75], a[16:31]
    ds_read_b128 a[56:59], v11 offset:3152
    ds_read2_b32 a[52:53], v14 offset0:136 offset1:137
    ds_read2_b32 a[54:55], v14 offset0:138 offset1:139
    s_waitcnt lgkmcnt(11)
    v_mfma_f32_32x32x16_bf16 a[16:31], a[36:39], a[76:79], a[16:31]
    ds_read_b128 a[60:63], v11 offset:3120
    ds_read2_b32 a[32:33], v14 offset0:144 offset1:145
    ds_read2_b32 a[34:35], v14 offset0:146 offset1:147
    s_waitcnt lgkmcnt(11)
    v_mfma_f32_32x32x16_bf16 a[16:31], a[40:43], a[80:83], a[16:31]
    ds_read_b128 a[64:67], v11 offset:3072
    ds_read2_b32 a[36:37], v14 offset0:152 offset1:153
    ds_read2_b32 a[38:39], v14 offset0:154 offset1:155
    s_waitcnt lgkmcnt(11)
    v_mfma_f32_32x32x16_bf16 a[16:31], a[44:47], a[84:87], a[16:31]
    ds_read_b128 a[68:71], v11 offset:3040
    ds_read2_b32 a[40:41], v14 offset0:160 offset1:161
    ds_read2_b32 a[42:43], v14 offset0:162 offset1:163
    s_waitcnt lgkmcnt(11)
    v_mfma_f32_32x32x16_bf16 a[16:31], a[48:51], a[56:59], a[16:31]
    ds_read_b128 a[72:75], v11 offset:2992
    ds_read2_b32 a[44:45], v14 offset0:168 offset1:169
    ds_read2_b32 a[46:47], v14 offset0:170 offset1:171
    s_waitcnt lgkmcnt(11)
    v_mfma_f32_32x32x16_bf16 a[16:31], a[52:55], a[60:63], a[16:31]
    ds_read_b128 a[76:79], v11 offset:2960
    ds_read2_b32 a[48:49], v14 offset0:176 offset1:177
    ds_read2_b32 a[50:51], v14 offset0:178 offset1:179
    s_waitcnt lgkmcnt(11)
    v_mfma_f32_32x32x16_bf16 a[16:31], a[32:35], a[64:67], a[16:31]
    ds_read_b128 a[80:83], v11 offset:2912
    ds_read2_b32 a[52:53], v14 offset0:184 offset1:185
    ds_read2_b32 a[54:55], v14 offset0:186 offset1:187
    s_waitcnt lgkmcnt(11)
    v_mfma_f32_32x32x16_bf16 a[16:31], a[36:39], a[68:71], a[16:31]
    ds_read_b128 a[84:87], v11 offset:2880
    ds_read2_b32 a[32:33], v14 offset0:192 offset1:193
    ds_read2_b32 a[34:35], v14 offset0:194 offset1:195
    s_waitcnt lgkmcnt(11)
    v_mfma_f32_32x32x16_bf16 a[16:31], a[40:43], a[72:75], a[16:31]
    ds_read_b128 a[56:59], v11 offset:2832
    ds_read2_b32 a[36:37], v14 offset0:200 offset1:201
    ds_read2_b32 a[38:39], v14 offset0:202 offset1:203
    s_waitcnt lgkmcnt(11)
    v_mfma_f32_32x32x16_bf16 a[16:31], a[44:47], a[76:79], a[16:31]
    ds_read_b128 a[60:63], v11 offset:2800
    ds_read2_b32 a[40:41], v14 offset0:208 offset1:209
    ds_read2_b32 a[42:43], v14 offset0:210 offset1:211
    s_waitcnt lgkmcnt(11)
    v_mfma_f32_32x32x16_bf16 a[16:31], a[48:51], a[80:83], a[16:31]
    ds_read_b128 a[64:67], v11 offset:2752
    ds_read2_b32 a[44:45], v14 offset0:216 offset1:217
    ds_read2_b32 a[46:47], v14 offset0:218 offset1:219
    s_waitcnt lgkmcnt(11)
    v_mfma_f32_32x32x16_bf16 a[16:31], a[52:55], a[84:87], a[16:31]
    ds_read_b128 a[68:71], v11 offset:2720
    ds_read2_b32 a[48:49], v14 offset0:224 offset1:225
    ds_read2_b32 a[50:51], v14 offset0:226 offset1:227
    s_waitcnt lgkmcnt(11)
    v_mfma_f32_32x32x16_bf16 a[16:31], a[32:35], a[56:59], a[16:31]
    ds_read_b128 a[72:75], v11 offset:2672
    ds_read2_b32 a[52:53], v14 offset0:232 offset1:233
    ds_read2_b32 a[54:55], v14 offset0:234 offset1:235
    s_waitcnt lgkmcnt(11)
    v_mfma_f32_32x32x16_bf16 a[16:31], a[36:39], a[60:63], a[16:31]
    ds_read_b128 a[76:79], v11 offset:2640
    ds_read2_b32 a[32:33], v14 offset0:240 offset1:241
    ds_read2_b32 a[34:35], v14 offset0:242 offset1:243
    s_waitcnt lgkmcnt(11)
    v_mfma_f32_32x32x16_bf16 a[16:31], a[40:43], a[64:67], a[16:31]
    ds_read_b128 a[80:83], v11 offset:2592
    ds_read2_b32 a[36:37], v14 offset0:248 offset1:249
    ds_read2_b32 a[38:39], v14 offset0:250 offset1:251
    v_add_u32 v14, 1024, v14
    s_waitcnt lgkmcnt(11)
    v_mfma_f32_32x32x16_bf16 a[16:31], a[44:47], a[68:71], a[16:31]
    ds_read_b128 a[84:87], v11 offset:2560
    s_waitcnt lgkmcnt(9)
    v_mfma_f32_32x32x16_bf16 a[16:31], a[48:51], a[72:75], a[16:31]
    s_waitcnt lgkmcnt(6)
    v_mfma_f32_32x32x16_bf16 a[16:31], a[52:55], a[76:79], a[16:31]
    s_waitcnt lgkmcnt(3)
    v_mfma_f32_32x32x16_bf16 a[16:31], a[32:35], a[80:83], a[16:31]
    s_waitcnt lgkmcnt(0)
    v_mfma_f32_32x32x16_bf16 a[16:31], a[36:39], a[84:87], a[16:31]
    v_accvgpr_read_b32 v220, a0
    v_accvgpr_read_b32 v221, a1
    v_accvgpr_read_b32 v222, a2
    v_accvgpr_read_b32 v223, a3
    v_accvgpr_read_b32 v224, a4
    v_accvgpr_read_b32 v225, a5
    v_accvgpr_read_b32 v226, a6
    v_accvgpr_read_b32 v227, a7
    v_accvgpr_read_b32 v228, a8
    v_accvgpr_read_b32 v229, a9
    v_accvgpr_read_b32 v230, a10
    v_accvgpr_read_b32 v231, a11
    v_accvgpr_read_b32 v232, a12
    v_accvgpr_read_b32 v233, a13
    v_accvgpr_read_b32 v234, a14
    v_accvgpr_read_b32 v235, a15
    v_cvt_pk_bf16_f32 v236, v220, v221
    v_cvt_pk_bf16_f32 v237, v222, v223
    v_cvt_pk_bf16_f32 v238, v224, v225
    v_cvt_pk_bf16_f32 v239, v226, v227
    v_cvt_pk_bf16_f32 v240, v228, v229
    v_cvt_pk_bf16_f32 v241, v230, v231
    v_cvt_pk_bf16_f32 v242, v232, v233
    v_cvt_pk_bf16_f32 v243, v234, v235
    s_nop 0
    v_permlane32_swap_b32 v236, v238
    v_permlane32_swap_b32 v237, v239
    v_permlane32_swap_b32 v240, v242
    v_permlane32_swap_b32 v241, v243
    buffer_store_dwordx4 v[236:239], v2, s[8:11], s7 offen offset:0 sc1
    buffer_store_dwordx4 v[240:243], v2, s[8:11], s7 offen offset:1024 sc1
    v_accvgpr_read_b32 v220, a16
    v_accvgpr_read_b32 v221, a17
    v_accvgpr_read_b32 v222, a18
    v_accvgpr_read_b32 v223, a19
    v_accvgpr_read_b32 v224, a20
    v_accvgpr_read_b32 v225, a21
    v_accvgpr_read_b32 v226, a22
    v_accvgpr_read_b32 v227, a23
    v_accvgpr_read_b32 v228, a24
    v_accvgpr_read_b32 v229, a25
    v_accvgpr_read_b32 v230, a26
    v_accvgpr_read_b32 v231, a27
    v_accvgpr_read_b32 v232, a28
    v_accvgpr_read_b32 v233, a29
    v_accvgpr_read_b32 v234, a30
    v_accvgpr_read_b32 v235, a31
    v_cvt_pk_bf16_f32 v236, v220, v221
    v_cvt_pk_bf16_f32 v237, v222, v223
    v_cvt_pk_bf16_f32 v238, v224, v225
    v_cvt_pk_bf16_f32 v239, v226, v227
    v_cvt_pk_bf16_f32 v240, v228, v229
    v_cvt_pk_bf16_f32 v241, v230, v231
    v_cvt_pk_bf16_f32 v242, v232, v233
    v_cvt_pk_bf16_f32 v243, v234, v235
    s_nop 0
    v_permlane32_swap_b32 v236, v238
    v_permlane32_swap_b32 v237, v239
    v_permlane32_swap_b32 v240, v242
    v_permlane32_swap_b32 v241, v243
    buffer_store_dwordx4 v[236:239], v2, s[8:11], s7 offen offset:2048 sc1
    buffer_store_dwordx4 v[240:243], v2, s[8:11], s7 offen offset:3072 sc1
    v_add_u32 v11, 30720, v11
    s_add_u32 s64, s64, 1
    s_cmp_lt_u32 s64, 4
    s_waitcnt vmcnt(4)
    s_cbranch_scc1 .chan_412
    s_waitcnt vmcnt(0)
    s_barrier
    v_mov_b32 v4, 1
    v_mov_b32 v5, 0
    s_mov_b64 exec, 1
    buffer_store_dword v4, v5, s[8:11], s94 offen offset:4 sc1
    s_mov_b64 exec, -1
    s_branch .fin_415
.qa_404:
    s_and_b32 s34, s24, 1
    s_lshr_b32 s35, s24, 1
    s_lshl_b32 s4, s35, 10
    s_add_u32 s4, s4, 2048
    v_lshlrev_b32 v2, 4, v1
    s_lshl_b32 s5, s24, 10
    s_add_u32 s5, s5, 131072
    v_add_u32 v24, s5, v2
    s_lshl_b32 s5, s34, 12
    s_add_u32 s5, s5, 131072
    v_add_u32 v25, s5, v2
    v_add_u32 v31, 139264, v2
    s_lshl_b32 s5, s35, 12
    v_add_u32 v5, s5, v31
    s_lshl_b32 s43, s24, 11
    v_bfe_u32 v254, v1, 4, 2
    v_mul_u32_u24 v3, 128, v254
    v_bfe_u32 v254, v1, 2, 2
    v_mul_u32_u24 v254, 32, v254
    v_add_u32 v3, v3, v254
    v_bfe_u32 v254, v1, 0, 1
    v_mul_u32_u24 v254, 16, v254
    v_add_u32 v3, v3, v254
    v_add_u32 v3, 155648, v3
    v_bfe_u32 v254, v1, 2, 2
    v_mul_u32_u24 v6, 128, v254
    v_bfe_u32 v254, v1, 0, 2
    v_mul_u32_u24 v254, 16, v254
    v_add_u32 v6, v6, v254
    v_bfe_u32 v254, v1, 4, 2
    v_mul_u32_u24 v254, 4, v254
    v_add_u32 v6, v6, v254
    v_add_u32 v6, 155648, v6
    v_add_u32 v6, s4, v6
    s_lshl_b32 s4, s99, 9
    s_add_u32 s4, s4, 92274688
    v_bfe_u32 v254, v1, 0, 2
    v_mul_u32_u24 v7, 128, v254
    v_add_u32 v7, s4, v7
    v_mov_b32 v232, 0
    v_mov_b32 v233, 0
    v_mov_b32 v234, 0
    v_mov_b32 v235, 0
    v_mov_b32 v236, 0
    v_mov_b32 v237, 0
    v_mov_b32 v238, 0
    v_mov_b32 v239, 0
    v_mov_b32 v240, 0
    v_mov_b32 v241, 0
    v_mov_b32 v40, 0
    v_mov_b32 v44, 0x3f803f80
    v_mov_b32 v41, 0
    v_mov_b32 v45, 0x3f803f80
    v_mov_b32 v42, 0
    v_mov_b32 v46, 0x3f803f80
    v_mov_b32 v43, 0
    v_mov_b32 v47, 0x3f803f80
    s_lshl_b32 s4, s34, 4
    v_and_b32 v48, 15, v1
    v_add_u32 v48, s4, v48
    v_lshrrev_b32 v49, 4, v1
    v_lshlrev_b32 v49, 2, v49
    v_mov_b32 v51, 0xff800000
    v_add_u32 v50, 0, v49
    v_cmp_le_u32 vcc, v50, v48
    s_nop 1
    v_cndmask_b32 v32, v51, v40, vcc
    v_add_u32 v50, 1, v49
    v_cmp_le_u32 vcc, v50, v48
    s_nop 1
    v_cndmask_b32 v33, v51, v40, vcc
    v_add_u32 v50, 2, v49
    v_cmp_le_u32 vcc, v50, v48
    s_nop 1
    v_cndmask_b32 v34, v51, v40, vcc
    v_add_u32 v50, 3, v49
    v_cmp_le_u32 vcc, v50, v48
    s_nop 1
    v_cndmask_b32 v35, v51, v40, vcc
    v_add_u32 v50, 16, v49
    v_cmp_le_u32 vcc, v50, v48
    s_nop 1
    v_cndmask_b32 v36, v51, v40, vcc
    v_add_u32 v50, 17, v49
    v_cmp_le_u32 vcc, v50, v48
    s_nop 1
    v_cndmask_b32 v37, v51, v40, vcc
    v_add_u32 v50, 18, v49
    v_cmp_le_u32 vcc, v50, v48
    s_nop 1
    v_cndmask_b32 v38, v51, v40, vcc
    v_add_u32 v50, 19, v49
    v_cmp_le_u32 vcc, v50, v48
    s_nop 1
    v_cndmask_b32 v39, v51, v40, vcc
    s_lshl_b32 s4, s99, 7
    s_lshl_b32 s5, s24, 2
    s_add_u32 s4, s4, s5
    s_add_u32 s94, s4, 92340224
    s_mov_b32 s46, 16384
    s_mov_b32 s47, 32768
    s_mov_b32 s30, -1
    s_mov_b32 s32, 0
    s_mov_b32 s33, 0
    s_mov_b32 s42, 0
    s_mov_b32 s53, 75497472
    s_mov_b32 s45, 0x3e0293ee
    s_lshl_b32 s36, s99, 13
    s_add_u32 s36, s36, s43
    s_add_u32 s36, s36, 16777216
    s_add_u32 s43, s43, 139264
    s_sub_u32 s37, s36, 0x40000
    v_and_b32 v255, 15, v1
    v_bfe_u32 v254, v1, 4, 1
    v_lshlrev_b32 v255, 7, v255
    v_lshl_add_u32 v255, v254, 24, v255
    s_lshl_b32 s39, s99, 12
    s_lshl_b32 s4, s34, 12
    s_lshl_b32 s40, s99, 13
    s_add_u32 s40, s40, s4
    s_lshl_b32 s4, s35, 11
    s_add_u32 s40, s40, s4
    s_add_u32 s53, s40, 77594624
    s_add_u32 s40, s40, 16777216
    s_add_u32 s39, s39, 67108864
    s_lshl_b32 s52, s24, 10
    s_add_u32 s39, s39, s52
    s_add_u32 s52, s52, 155648
    s_mov_b32 s31, 1
    s_mov_b32 s54, s53
    s_sub_u32 s48, s39, 0x20000
    s_mov_b32 s49, s37
    s_mov_b32 vcc_lo, s27
    s_mov_b32 vcc_hi, 0
    s_cmp_gt_u32 s32, 0
    s_cbranch_scc1 .ndd_431
    s_mov_b32 s62, 0
.nd_430:
    buffer_load_dword v29, v7, s[8:11], s46 offen sc1
    buffer_load_dword v30, v7, s[8:11], s47 offen sc1
    s_add_u32 s62, s62, 1
    s_cmp_gt_u32 s62, 0x200000
    s_cbranch_scc1 .mg_end_1
    s_waitcnt vmcnt(0)
    v_min_u32 v29, v29, v30
    s_nop 1
    v_min_u32_dpp v29, v29, v29 quad_perm:[1,0,3,2] row_mask:0xf bank_mask:0xf
    s_nop 1
    v_min_u32_dpp v29, v29, v29 quad_perm:[2,3,0,1] row_mask:0xf bank_mask:0xf
    s_nop 1
    v_readfirstlane_b32 s32, v29
    s_lshl_b32 s55, s32, 18
    s_add_u32 s55, s55, s37
    s_cmp_gt_u32 s32, 0
    s_cbranch_scc1 .ndd_431
    s_sleep 2
    s_branch .nd_430
.ndd_431:
    s_waitcnt lgkmcnt(0)
    s_mov_b32 s14, 4063232
.p2align 6
.ql_432:
    s_waitcnt lgkmcnt(8)
    v_mfma_f32_16x16x32_bf16 v[192:195], a[0:3], v[64:67], 0
    buffer_load_dwordx4 v19, s[12:15], s29 offen offset:2048 lds
    v_mfma_f32_16x16x32_bf16 v[196:199], a[4:7], v[64:67], 0
    ds_read_b128 v[112:115], v10 offset:256
    ds_read_b128 v[116:119], v10 offset:33024
    v_mfma_f32_16x16x32_bf16 v[200:203], a[0:3], v[68:71], 0
    ds_read_b128 v[120:123], v11 offset:256
    ds_read_b128 v[124:127], v11 offset:33024
    v_mfma_f32_16x16x32_bf16 v[204:207], a[4:7], v[68:71], 0
    ds_read_b128 v[64:67], v8 offset:512
    ds_read_b128 v[68:71], v8 offset:33280
    v_mfma_f32_16x16x32_bf16 v[192:195], a[8:11], v[72:75], v[192:195]
    buffer_load_dwordx4 v19, s[12:15], s29 offen offset:3072 lds
    v_mfma_f32_16x16x32_bf16 v[196:199], a[12:15], v[72:75], v[196:199]
    v_cvt_pk_bf16_f32 v224, v208, v209
    v_cvt_pk_bf16_f32 v225, v210, v211
    v_mfma_f32_16x16x32_bf16 v[200:203], a[8:11], v[76:79], v[200:203]
    v_cvt_pk_bf16_f32 v226, v212, v213
    v_cvt_pk_bf16_f32 v227, v214, v215
    v_mfma_f32_16x16x32_bf16 v[204:207], a[12:15], v[76:79], v[204:207]
    ds_write_b128 v24, v[224:227] offset:0
    s_waitcnt lgkmcnt(11)
    v_mfma_f32_16x16x32_bf16 v[192:195], a[16:19], v[80:83], v[192:195]
    s_add_u32 m0, s6, 73728
    v_cvt_pk_bf16_f32 v228, v216, v217
    v_mfma_f32_16x16x32_bf16 v[196:199], a[20:23], v[80:83], v[196:199]
    buffer_load_dwordx4 v20, s[12:15], s29 offen offset:0 lds
    v_mfma_f32_16x16x32_bf16 v[200:203], a[16:19], v[84:87], v[200:203]
    v_cvt_pk_bf16_f32 v229, v218, v219
    v_cvt_pk_bf16_f32 v230, v220, v221
    v_mfma_f32_16x16x32_bf16 v[204:207], a[20:23], v[84:87], v[204:207]
    v_cvt_pk_bf16_f32 v231, v222, v223
    ds_write_b128 v24, v[228:231] offset:4096
    v_mfma_f32_16x16x32_bf16 v[192:195], a[24:27], v[88:91], v[192:195]
    ds_read_b128 v[72:75], v9 offset:512
    ds_read_b128 v[76:79], v9 offset:33280
    v_mfma_f32_16x16x32_bf16 v[196:199], a[28:31], v[88:91], v[196:199]
    buffer_load_dwordx4 v20, s[12:15], s29 offen offset:1024 lds
    v_mfma_f32_16x16x32_bf16 v[200:203], a[24:27], v[92:95], v[200:203]
    ds_read_b128 v[80:83], v10 offset:512
    ds_read_b128 v[84:87], v10 offset:33280
    v_mfma_f32_16x16x32_bf16 v[204:207], a[28:31], v[92:95], v[204:207]
    ds_read_b128 v[88:91], v11 offset:512
    s_waitcnt lgkmcnt(13)
    v_mfma_f32_16x16x32_bf16 v[192:195], a[32:35], v[96:99], v[192:195]
    s_waitcnt vmcnt(12) lgkmcnt(5)
    s_barrier
    v_mfma_f32_16x16x32_bf16 v[196:199], a[36:39], v[96:99], v[196:199]
    buffer_load_dwordx4 v21, s[12:15], s29 offen offset:2048 lds
    v_mfma_f32_16x16x32_bf16 v[200:203], a[32:35], v[100:103], v[200:203]
    ds_read_b128 v[208:211], v25 offset:0
    ds_read_b128 v[128:131], v31 offset:0
    v_mfma_f32_16x16x32_bf16 v[204:207], a[36:39], v[100:103], v[204:207]
    ds_read_b128 v[144:147], v31 offset:4096
    ds_read_b128 v[212:215], v25 offset:1024
    v_mfma_f32_16x16x32_bf16 v[192:195], a[40:43], v[104:107], v[192:195]
    ds_read_b128 v[132:135], v31 offset:1024
    ds_read_b128 v[148:151], v31 offset:5120
    v_mfma_f32_16x16x32_bf16 v[196:199], a[44:47], v[104:107], v[196:199]
    buffer_load_dwordx4 v21, s[12:15], s29 offen offset:3072 lds
    v_mfma_f32_16x16x32_bf16 v[200:203], a[40:43], v[108:111], v[200:203]
    ds_read_b128 v[92:95], v11 offset:33280
    ds_read_b128 v[216:219], v25 offset:2048
    v_mfma_f32_16x16x32_bf16 v[204:207], a[44:47], v[108:111], v[204:207]
    ds_read_b128 v[136:139], v31 offset:2048
    ds_read_b128 v[152:155], v31 offset:6144
    v_mfma_f32_16x16x32_bf16 v[192:195], a[48:51], v[112:115], v[192:195]
    ds_read_b128 v[220:223], v25 offset:3072
    ds_read_b128 v[140:143], v31 offset:3072
    v_mfma_f32_16x16x32_bf16 v[196:199], a[52:55], v[112:115], v[196:199]
    s_add_u32 m0, s6, 77824
    s_waitcnt lgkmcnt(9)
    v_mfma_f32_16x16x32_bf16 v[48:51], v[128:131], v[208:211], v[32:35]
    buffer_load_dwordx4 v22, s[12:15], s29 offen offset:0 lds
    v_mfma_f32_16x16x32_bf16 v[52:55], v[144:147], v[208:211], v[36:39]
    ds_read_b128 v[156:159], v31 offset:7168
    s_waitcnt lgkmcnt(7)
    v_mfma_f32_16x16x32_bf16 v[48:51], v[132:135], v[212:215], v[48:51]
    ds_read_b128 v[160:163], v5 offset:8192
    ds_read_b128 v[164:167], v5 offset:9216
    v_mfma_f32_16x16x32_bf16 v[52:55], v[148:151], v[212:215], v[52:55]
    ds_read_b128 v[96:99], v8 offset:768
    s_waitcnt lgkmcnt(6)
    v_mfma_f32_16x16x32_bf16 v[48:51], v[136:139], v[216:219], v[48:51]
    buffer_load_dwordx4 v22, s[12:15], s29 offen offset:1024 lds
    v_mfma_f32_16x16x32_bf16 v[52:55], v[152:155], v[216:219], v[52:55]
    ds_read_b128 v[100:103], v8 offset:33536
    ds_read_b128 v[104:107], v9 offset:768
    v_mfma_f32_16x16x32_bf16 v[200:203], a[48:51], v[116:119], v[200:203]
    ds_read_b128 v[108:111], v9 offset:33536
    ds_read_b128 v[168:171], v5 offset:10240
    v_mfma_f32_16x16x32_bf16 v[204:207], a[52:55], v[116:119], v[204:207]
    ds_read_b128 v[172:175], v5 offset:11264
    s_waitcnt lgkmcnt(8)
    v_mfma_f32_16x16x32_bf16 v[48:51], v[140:143], v[220:223], v[48:51]
    buffer_load_dwordx4 v23, s[12:15], s29 offen offset:2048 lds
    v_mfma_f32_16x16x32_bf16 v[52:55], v[156:159], v[220:223], v[52:55]
    v_max_i32 v27, s30, v26
    ds_read_b128 v[112:115], v10 offset:768
    v_mfma_f32_16x16x32_bf16 v[192:195], a[56:59], v[120:123], v[192:195]
    s_waitcnt vmcnt(12)
    s_cbranch_vccnz .cp_438
    buffer_store_dword v27, v26, s[8:11], s94 offen
.cb_439:
    v_mfma_f32_16x16x32_bf16 v[196:199], a[60:63], v[120:123], v[196:199]
    ds_read_b128 v[116:119], v10 offset:33536
    ds_read_b128 v[120:123], v11 offset:768
    v_mfma_f32_16x16x32_bf16 v[200:203], a[56:59], v[124:127], v[200:203]
    buffer_load_dwordx4 v23, s[12:15], s29 offen offset:3072 lds
    v_mfma_f32_16x16x32_bf16 v[204:207], a[60:63], v[124:127], v[204:207]
    s_cmp_eq_u32 s31, 0
    s_cbranch_scc1 .cp_442
.cb_443:
    v_mfma_f32_16x16x32_bf16 v[192:195], a[64:67], v[64:67], v[192:195]
    buffer_load_dword v29, v28, s[12:15], s29 offen
    ds_read_b128 v[124:127], v11 offset:33536
    v_mfma_f32_16x16x32_bf16 v[196:199], a[68:71], v[64:67], v[196:199]
    s_waitcnt lgkmcnt(4)
    s_barrier
    v_mfma_f32_16x16x32_bf16 v[200:203], a[64:67], v[68:71], v[200:203]
    ds_read_b128 v[176:179], v3 offset:0
    ds_read_b128 v[180:183], v3 offset:512
    v_mfma_f32_16x16x32_bf16 v[204:207], a[68:71], v[68:71], v[204:207]
    ds_read_b128 v[184:187], v3 offset:1024
    ds_read_b128 v[188:191], v3 offset:1536
    v_mfma_f32_16x16x32_bf16 v[192:195], a[72:75], v[72:75], v[192:195]
    s_add_u32 m0, s52, 4096
    s_add_u32 s48, s48, 0x20000
    v_mfma_f32_16x16x32_bf16 v[196:199], a[76:79], v[72:75], v[196:199]
    s_cmp_gt_u32 s33, s42
    s_cselect_b32 s31, 1, 0
    s_cselect_b32 s4, s48, s54
    v_mfma_f32_16x16x32_bf16 v[200:203], a[72:75], v[76:79], v[200:203]
    buffer_load_dwordx4 v2, s[8:11], s4 offen lds
    v_mfma_f32_16x16x32_bf16 v[204:207], a[76:79], v[76:79], v[204:207]
    buffer_load_dword v4, v7, s[8:11], 0 offen sc1
    ds_read_b128 v[64:67], v8 offset:1024
    v_mfma_f32_16x16x32_bf16 v[192:195], a[80:83], v[80:83], v[192:195]
    ds_read_b128 v[68:71], v8 offset:33792
    ds_read_b128 v[72:75], v9 offset:1024
    v_mfma_f32_16x16x32_bf16 v[196:199], a[84:87], v[80:83], v[196:199]
    ds_read_b128 v[76:79], v9 offset:33792
    v_max3_f32 v248, v48, v49, v50
    v_mfma_f32_16x16x32_bf16 v[200:203], a[80:83], v[84:87], v[200:203]
    v_max3_f32 v248, v248, v51, v52
    v_max3_f32 v249, v53, v54, v55
    s_waitcnt lgkmcnt(4)
    v_mfma_f32_16x16x32_bf16 v[56:59], v[176:179], v[208:211], 0
    ds_read_b128 v[80:83], v10 offset:1024
    s_add_u32 s29, s29, 0x10000
    v_mfma_f32_16x16x32_bf16 v[56:59], v[180:183], v[212:215], v[56:59]
    s_cmp_gt_u32 s32, s42
    s_cbranch_scc0 .cp_440
.cb_441:
    v_mfma_f32_16x16x32_bf16 v[56:59], v[184:187], v[216:219], v[56:59]
    ds_read_b32 v232, v6 offset:0
    ds_read_b32 v234, v6 offset:64
    v_mfma_f32_16x16x32_bf16 v[56:59], v[188:191], v[220:223], v[56:59]
    ds_read_b32 v236, v6 offset:512
    ds_read_b32 v238, v6 offset:576
    v_mfma_f32_16x16x32_bf16 v[204:207], a[84:87], v[84:87], v[204:207]
    s_add_u32 s5, s49, 0x80000
    s_min_u32 s5, s5, s55
    v_mfma_f32_16x16x32_bf16 v[192:195], a[88:91], v[88:91], v[192:195]
    buffer_load_dword v29, v255, s[8:11], s5 offen
    s_mov_b32 m0, s43
    v_mfma_f32_16x16x32_bf16 v[196:199], a[92:95], v[88:91], v[196:199]
    s_add_u32 s49, s49, 0x40000
    ds_read_b128 v[84:87], v10 offset:33792
    v_mfma_f32_16x16x32_bf16 v[200:203], a[88:91], v[92:95], v[200:203]
    buffer_load_dwordx4 v2, s[8:11], s49 offen lds
    v_mfma_f32_16x16x32_bf16 v[204:207], a[92:95], v[92:95], v[204:207]
    s_add_u32 s50, s49, 16777216
    ds_read_b128 v[88:91], v11 offset:1024
    v_mfma_f32_16x16x32_bf16 v[192:195], a[96:99], v[96:99], v[192:195]
    ds_read_b128 v[92:95], v11 offset:33792
    v_max3_f32 v248, v248, v56, v57
    v_mfma_f32_16x16x32_bf16 v[196:199], a[100:103], v[96:99], v[196:199]
    v_max_f32 v30, v248, v249
    v_max_f32 v249, v248, v249
    v_mfma_f32_16x16x32_bf16 v[200:203], a[96:99], v[100:103], v[200:203]
    buffer_load_dwordx4 v2, s[8:11], s49 offen offset:1024 lds
    v_mfma_f32_16x16x32_bf16 v[204:207], a[100:103], v[100:103], v[204:207]
    s_add_u32 m0, s43, 8192
    v_permlane16_swap_b32 v249, v30
    v_mfma_f32_16x16x32_bf16 v[192:195], a[104:107], v[104:107], v[192:195]
    v_max_f32 v248, v249, v30
    v_max_f32 v249, v249, v30
    v_mfma_f32_16x16x32_bf16 v[196:199], a[108:111], v[104:107], v[196:199]
    ds_read_b128 v[96:99], v8 offset:1280
    ds_read_b128 v[100:103], v8 offset:34048
    v_mfma_f32_16x16x32_bf16 v[200:203], a[104:107], v[108:111], v[200:203]
    buffer_load_dwordx4 v2, s[8:11], s50 offen lds
    v_mfma_f32_16x16x32_bf16 v[204:207], a[108:111], v[108:111], v[204:207]
    v_permlane32_swap_b32 v248, v249
    v_max_f32 v248, v248, v249
    v_mfma_f32_16x16x32_bf16 v[192:195], a[112:115], v[112:115], v[192:195]
    v_mul_f32 v248, s45, v248
    ds_read_b128 v[104:107], v9 offset:1280
    v_mfma_f32_16x16x32_bf16 v[196:199], a[116:119], v[112:115], v[196:199]
    ds_read_b128 v[108:111], v9 offset:34048
    v_fma_f32 v60, v48, s45, -v248
    v_mfma_f32_16x16x32_bf16 v[200:203], a[112:115], v[116:119], v[200:203]
    buffer_load_dwordx4 v2, s[8:11], s50 offen offset:1024 lds
    v_mfma_f32_16x16x32_bf16 v[204:207], a[116:119], v[116:119], v[204:207]
    v_fma_f32 v61, v49, s45, -v248
    v_fma_f32 v62, v50, s45, -v248
    v_mfma_f32_16x16x32_bf16 v[192:195], a[120:123], v[120:123], v[192:195]
    v_fma_f32 v63, v51, s45, -v248
    v_fma_f32 v242, v52, s45, -v248
    v_mfma_f32_16x16x32_bf16 v[196:199], a[124:127], v[120:123], v[196:199]
    v_fma_f32 v243, v53, s45, -v248
    v_fma_f32 v244, v54, s45, -v248
    v_mfma_f32_16x16x32_bf16 v[200:203], a[120:123], v[124:127], v[200:203]
    v_fma_f32 v245, v55, s45, -v248
    v_fma_f32 v246, v56, s45, -v248
    v_mfma_f32_16x16x32_bf16 v[204:207], a[124:127], v[124:127], v[204:207]
    v_fma_f32 v247, v57, s45, -v248
    s_waitcnt lgkmcnt(12)
    v_mfma_f32_16x16x32_bf16 v[192:195], a[128:131], v[64:67], v[192:195]
    ds_read_b128 v[112:115], v10 offset:1280
    ds_read_b128 v[116:119], v10 offset:34048
    v_mfma_f32_16x16x32_bf16 v[196:199], a[132:135], v[64:67], v[196:199]
    ds_read_b128 v[120:123], v11 offset:1280
    ds_read_b128 v[124:127], v11 offset:34048
    v_mfma_f32_16x16x32_bf16 v[200:203], a[128:131], v[68:71], v[200:203]
    v_exp_f32 v60, v60
    v_mfma_f32_16x16x32_bf16 v[204:207], a[132:135], v[68:71], v[204:207]
    v_exp_f32 v61, v61
    v_mfma_f32_16x16x32_bf16 v[192:195], a[136:139], v[72:75], v[192:195]
    v_exp_f32 v62, v62
    v_mfma_f32_16x16x32_bf16 v[196:199], a[140:143], v[72:75], v[196:199]
    v_exp_f32 v63, v63
    v_mfma_f32_16x16x32_bf16 v[200:203], a[136:139], v[76:79], v[200:203]
    v_exp_f32 v242, v242
    v_mfma_f32_16x16x32_bf16 v[204:207], a[140:143], v[76:79], v[204:207]
    ds_read_b128 v[64:67], v8 offset:1536
    s_waitcnt lgkmcnt(9)
    v_mfma_f32_16x16x32_bf16 v[192:195], a[144:147], v[80:83], v[192:195]
    v_exp_f32 v243, v243
    v_mfma_f32_16x16x32_bf16 v[196:199], a[148:151], v[80:83], v[196:199]
    v_exp_f32 v244, v244
    v_mfma_f32_16x16x32_bf16 v[200:203], a[144:147], v[84:87], v[200:203]
    v_exp_f32 v245, v245
    v_mfma_f32_16x16x32_bf16 v[204:207], a[148:151], v[84:87], v[204:207]
    v_exp_f32 v246, v246
    v_mfma_f32_16x16x32_bf16 v[192:195], a[152:155], v[88:91], v[192:195]
    v_exp_f32 v247, v247
    v_mfma_f32_16x16x32_bf16 v[196:199], a[156:159], v[88:91], v[196:199]
    ds_read_b128 v[68:71], v8 offset:34304
    ds_read_b128 v[72:75], v9 offset:1536
    v_mfma_f32_16x16x32_bf16 v[200:203], a[152:155], v[92:95], v[200:203]
    ds_read_b128 v[76:79], v9 offset:34304
    v_cvt_pk_bf16_f32 v48, v60, v61
    v_mfma_f32_16x16x32_bf16 v[204:207], a[156:159], v[92:95], v[204:207]
    v_cvt_pk_bf16_f32 v49, v62, v63
    s_waitcnt lgkmcnt(8)
    v_mfma_f32_16x16x32_bf16 v[192:195], a[160:163], v[96:99], v[192:195]
    v_cvt_pk_bf16_f32 v50, v242, v243
    v_cvt_pk_bf16_f32 v51, v244, v245
    v_mfma_f32_16x16x32_bf16 v[196:199], a[164:167], v[96:99], v[196:199]
    v_cvt_pk_bf16_f32 v40, v246, v247
    ds_read_b128 v[80:83], v10 offset:1536
    v_mfma_f32_16x16x32_bf16 v[200:203], a[160:163], v[100:103], v[200:203]
    ds_read_b128 v[84:87], v10 offset:34304
    ds_read_b128 v[88:91], v11 offset:1536
    v_mfma_f32_16x16x32_bf16 v[52:55], v[44:47], v[48:51], 0
    ds_read_b128 v[92:95], v11 offset:34304
    ds_read_b128 v[96:99], v8 offset:1792
    v_mfma_f32_16x16x32_bf16 v[52:55], v[44:47], v[40:43], v[52:55]
    v_mfma_f32_16x16x32_bf16 v[208:211], v[160:163], v[48:51], 0
    v_mfma_f32_16x16x32_bf16 v[208:211], v[232:235], v[40:43], v[208:211]
    v_mfma_f32_16x16x32_bf16 v[212:215], v[164:167], v[48:51], 0
    v_mfma_f32_16x16x32_bf16 v[212:215], v[234:237], v[40:43], v[212:215]
    v_mfma_f32_16x16x32_bf16 v[216:219], v[168:171], v[48:51], 0
    v_mfma_f32_16x16x32_bf16 v[216:219], v[236:239], v[40:43], v[216:219]
    v_mfma_f32_16x16x32_bf16 v[220:223], v[172:175], v[48:51], 0
    v_mfma_f32_16x16x32_bf16 v[220:223], v[238:241], v[40:43], v[220:223]
    v_rcp_f32 v248, v52
    v_mfma_f32_16x16x32_bf16 v[204:207], a[164:167], v[100:103], v[204:207]
    ds_read_b128 v[100:103], v8 offset:34560
    v_mul_f32 v208, v248, v208
    v_mfma_f32_16x16x32_bf16 v[192:195], a[168:171], v[104:107], v[192:195]
    v_mul_f32 v209, v248, v209
    v_mul_f32 v210, v248, v210
    v_mfma_f32_16x16x32_bf16 v[196:199], a[172:175], v[104:107], v[196:199]
    ds_read_b128 v[104:107], v9 offset:1792
    v_mul_f32 v211, v248, v211
    v_mfma_f32_16x16x32_bf16 v[200:203], a[168:171], v[108:111], v[200:203]
    v_cvt_pk_bf16_f32 v224, v208, v209
    v_cvt_pk_bf16_f32 v225, v210, v211
    v_mfma_f32_16x16x32_bf16 v[204:207], a[172:175], v[108:111], v[204:207]
    ds_read_b128 v[108:111], v9 offset:34560
    s_waitcnt lgkmcnt(12)
    v_mfma_f32_16x16x32_bf16 v[192:195], a[176:179], v[112:115], v[192:195]
    v_mul_f32 v212, v248, v212
    v_mul_f32 v213, v248, v213
    v_mfma_f32_16x16x32_bf16 v[196:199], a[180:183], v[112:115], v[196:199]
    ds_read_b128 v[112:115], v10 offset:1792
    v_mul_f32 v214, v248, v214
    v_mfma_f32_16x16x32_bf16 v[200:203], a[176:179], v[116:119], v[200:203]
    v_mul_f32 v215, v248, v215
    v_cvt_pk_bf16_f32 v226, v212, v213
    v_mfma_f32_16x16x32_bf16 v[204:207], a[180:183], v[116:119], v[204:207]
    s_waitcnt vmcnt(5)
    v_min_u32_dpp v4, v4, v4 quad_perm:[1,0,3,2] row_mask:0xf bank_mask:0xf
    v_mfma_f32_16x16x32_bf16 v[192:195], a[184:187], v[120:123], v[192:195]
    ds_read_b128 v[116:119], v10 offset:34560
    v_cvt_pk_bf16_f32 v227, v214, v215
    v_mfma_f32_16x16x32_bf16 v[196:199], a[188:191], v[120:123], v[196:199]
    v_min_u32_dpp v4, v4, v4 quad_perm:[2,3,0,1] row_mask:0xf bank_mask:0xf
    ds_read_b128 v[120:123], v11 offset:1792
    v_mfma_f32_16x16x32_bf16 v[200:203], a[184:187], v[124:127], v[200:203]
    v_readfirstlane_b32 s33, v4
    v_mfma_f32_16x16x32_bf16 v[204:207], a[188:191], v[124:127], v[204:207]
    ds_read_b128 v[124:127], v11 offset:34560
    s_waitcnt lgkmcnt(12)
    v_mfma_f32_16x16x32_bf16 v[192:195], a[192:195], v[64:67], v[192:195]
    s_cmp_eq_u32 s31, 0
    s_cbranch_scc1 .cp_446
.cb_447:
    v_mfma_f32_16x16x32_bf16 v[196:199], a[196:199], v[64:67], v[196:199]
    s_cbranch_vccnz .cp_434
    buffer_store_dwordx4 v[224:227], v2, s[8:11], s53 offen offset:0
.cb_435:
    v_mfma_f32_16x16x32_bf16 v[200:203], a[192:195], v[68:71], v[200:203]
    v_mul_f32 v216, v248, v216
    v_mul_f32 v217, v248, v217
    v_mfma_f32_16x16x32_bf16 v[204:207], a[196:199], v[68:71], v[204:207]
    v_mul_f32 v218, v248, v218
    v_mul_f32 v219, v248, v219
    v_mfma_f32_16x16x32_bf16 v[192:195], a[200:203], v[72:75], v[192:195]
    s_waitcnt lgkmcnt(0)
    s_barrier
    v_mfma_f32_16x16x32_bf16 v[196:199], a[204:207], v[72:75], v[196:199]
    s_add_u32 m0, s6, 0
    ds_read_b128 v[64:67], v12 offset:0
    v_mfma_f32_16x16x32_bf16 v[200:203], a[200:203], v[76:79], v[200:203]
    buffer_load_dwordx4 v16, s[12:15], s29 offen offset:0 lds
    v_mfma_f32_16x16x32_bf16 v[204:207], a[204:207], v[76:79], v[204:207]
    ds_read_b128 v[68:71], v12 offset:32768
    ds_read_b128 v[72:75], v13 offset:0
    v_mfma_f32_16x16x32_bf16 v[192:195], a[208:211], v[80:83], v[192:195]
    ds_read_b128 v[76:79], v13 offset:32768
    v_cvt_pk_bf16_f32 v228, v216, v217
    v_mfma_f32_16x16x32_bf16 v[196:199], a[212:215], v[80:83], v[196:199]
    v_cvt_pk_bf16_f32 v229, v218, v219
    v_mul_f32 v220, v248, v220
    v_mfma_f32_16x16x32_bf16 v[200:203], a[208:211], v[84:87], v[200:203]
    buffer_load_dwordx4 v16, s[12:15], s29 offen offset:1024 lds
    v_mfma_f32_16x16x32_bf16 v[204:207], a[212:215], v[84:87], v[204:207]
    v_mul_f32 v221, v248, v221
    v_mul_f32 v222, v248, v222
    v_mfma_f32_16x16x32_bf16 v[192:195], a[216:219], v[88:91], v[192:195]
    v_mul_f32 v223, v248, v223
    v_cvt_pk_bf16_f32 v230, v220, v221
    v_mfma_f32_16x16x32_bf16 v[196:199], a[220:223], v[88:91], v[196:199]
    v_cvt_pk_bf16_f32 v231, v222, v223
    ds_read_b128 v[80:83], v14 offset:0
    v_mfma_f32_16x16x32_bf16 v[200:203], a[216:219], v[92:95], v[200:203]
    buffer_load_dwordx4 v17, s[12:15], s29 offen offset:2048 lds
    v_mfma_f32_16x16x32_bf16 v[204:207], a[220:223], v[92:95], v[204:207]
    s_cbranch_vccnz .cp_436
    buffer_store_dwordx4 v[228:231], v2, s[8:11], s53 offen offset:1024
.cb_437:
    v_mfma_f32_16x16x32_bf16 v[192:195], a[224:227], v[96:99], v[192:195]
    ds_read_b128 v[84:87], v14 offset:32768
    ds_read_b128 v[88:91], v15 offset:0
    v_mfma_f32_16x16x32_bf16 v[196:199], a[228:231], v[96:99], v[196:199]
    ds_read_b128 v[92:95], v15 offset:32768
    ds_read_b128 v[96:99], v12 offset:256
    v_mfma_f32_16x16x32_bf16 v[200:203], a[224:227], v[100:103], v[200:203]
    buffer_load_dwordx4 v17, s[12:15], s29 offen offset:3072 lds
    v_mfma_f32_16x16x32_bf16 v[204:207], a[228:231], v[100:103], v[204:207]
    ds_read_b128 v[100:103], v12 offset:33024
    s_mov_b32 s53, s40
    v_mfma_f32_16x16x32_bf16 v[192:195], a[232:235], v[104:107], v[192:195]
    s_add_u32 s40, s40, 0x40000
    s_mov_b32 s30, s42
    v_mfma_f32_16x16x32_bf16 v[196:199], a[236:239], v[104:107], v[196:199]
    ds_read_b128 v[104:107], v13 offset:256
    s_add_u32 s42, s42, 1
    v_mfma_f32_16x16x32_bf16 v[200:203], a[232:235], v[108:111], v[200:203]
    s_add_u32 m0, s6, 4096
    v_mfma_f32_16x16x32_bf16 v[204:207], a[236:239], v[108:111], v[204:207]
    buffer_load_dwordx4 v18, s[12:15], s29 offen offset:0 lds
    v_mfma_f32_16x16x32_bf16 v[192:195], a[240:243], v[112:115], v[192:195]
    ds_read_b128 v[108:111], v13 offset:33024
    v_mfma_f32_16x16x32_bf16 v[196:199], a[244:247], v[112:115], v[196:199]
    v_mfma_f32_16x16x32_bf16 v[200:203], a[240:243], v[116:119], v[200:203]
    v_mfma_f32_16x16x32_bf16 v[204:207], a[244:247], v[116:119], v[204:207]
    buffer_load_dwordx4 v18, s[12:15], s29 offen offset:1024 lds
    v_mfma_f32_16x16x32_bf16 v[192:195], a[248:251], v[120:123], v[192:195]
    v_mfma_f32_16x16x32_bf16 v[196:199], a[252:255], v[120:123], v[196:199]
    v_mfma_f32_16x16x32_bf16 v[200:203], a[248:251], v[124:127], v[200:203]
    v_mfma_f32_16x16x32_bf16 v[204:207], a[252:255], v[124:127], v[204:207]
    s_waitcnt lgkmcnt(8)
    v_mfma_f32_16x16x32_bf16 v[208:211], a[0:3], v[64:67], 0
    buffer_load_dwordx4 v19, s[12:15], s29 offen offset:2048 lds
    v_mfma_f32_16x16x32_bf16 v[212:215], a[4:7], v[64:67], 0
    ds_read_b128 v[112:115], v14 offset:256
    ds_read_b128 v[116:119], v14 offset:33024
    v_mfma_f32_16x16x32_bf16 v[216:219], a[0:3], v[68:71], 0
    ds_read_b128 v[120:123], v15 offset:256
    ds_read_b128 v[124:127], v15 offset:33024
    v_mfma_f32_16x16x32_bf16 v[220:223], a[4:7], v[68:71], 0
    ds_read_b128 v[64:67], v12 offset:512
    ds_read_b128 v[68:71], v12 offset:33280
    v_mfma_f32_16x16x32_bf16 v[208:211], a[8:11], v[72:75], v[208:211]
    buffer_load_dwordx4 v19, s[12:15], s29 offen offset:3072 lds
    v_mfma_f32_16x16x32_bf16 v[212:215], a[12:15], v[72:75], v[212:215]
    v_cvt_pk_bf16_f32 v224, v192, v193
    v_cvt_pk_bf16_f32 v225, v194, v195
    v_mfma_f32_16x16x32_bf16 v[216:219], a[8:11], v[76:79], v[216:219]
    v_cvt_pk_bf16_f32 v226, v196, v197
    v_cvt_pk_bf16_f32 v227, v198, v199
    v_mfma_f32_16x16x32_bf16 v[220:223], a[12:15], v[76:79], v[220:223]
    ds_write_b128 v24, v[224:227] offset:0
    s_waitcnt lgkmcnt(11)
    v_mfma_f32_16x16x32_bf16 v[208:211], a[16:19], v[80:83], v[208:211]
    s_add_u32 m0, s6, 8192
    v_cvt_pk_bf16_f32 v228, v200, v201
    v_mfma_f32_16x16x32_bf16 v[212:215], a[20:23], v[80:83], v[212:215]
    buffer_load_dwordx4 v20, s[12:15], s29 offen offset:0 lds
    v_mfma_f32_16x16x32_bf16 v[216:219], a[16:19], v[84:87], v[216:219]
    v_cvt_pk_bf16_f32 v229, v202, v203
    v_cvt_pk_bf16_f32 v230, v204, v205
    v_mfma_f32_16x16x32_bf16 v[220:223], a[20:23], v[84:87], v[220:223]
    v_cvt_pk_bf16_f32 v231, v206, v207
    ds_write_b128 v24, v[228:231] offset:4096
    v_mfma_f32_16x16x32_bf16 v[208:211], a[24:27], v[88:91], v[208:211]
    ds_read_b128 v[72:75], v13 offset:512
    ds_read_b128 v[76:79], v13 offset:33280
    v_mfma_f32_16x16x32_bf16 v[212:215], a[28:31], v[88:91], v[212:215]
    buffer_load_dwordx4 v20, s[12:15], s29 offen offset:1024 lds
    v_mfma_f32_16x16x32_bf16 v[216:219], a[24:27], v[92:95], v[216:219]
    ds_read_b128 v[80:83], v14 offset:512
    ds_read_b128 v[84:87], v14 offset:33280
    v_mfma_f32_16x16x32_bf16 v[220:223], a[28:31], v[92:95], v[220:223]
    ds_read_b128 v[88:91], v15 offset:512
    s_waitcnt lgkmcnt(13)
    v_mfma_f32_16x16x32_bf16 v[208:211], a[32:35], v[96:99], v[208:211]
    s_waitcnt vmcnt(12) lgkmcnt(5)
    s_barrier
    v_mfma_f32_16x16x32_bf16 v[212:215], a[36:39], v[96:99], v[212:215]
    buffer_load_dwordx4 v21, s[12:15], s29 offen offset:2048 lds
    v_mfma_f32_16x16x32_bf16 v[216:219], a[32:35], v[100:103], v[216:219]
    ds_read_b128 v[192:195], v25 offset:0
    ds_read_b128 v[128:131], v31 offset:0
    v_mfma_f32_16x16x32_bf16 v[220:223], a[36:39], v[100:103], v[220:223]
    ds_read_b128 v[144:147], v31 offset:4096
    ds_read_b128 v[196:199], v25 offset:1024
    v_mfma_f32_16x16x32_bf16 v[208:211], a[40:43], v[104:107], v[208:211]
    ds_read_b128 v[132:135], v31 offset:1024
    ds_read_b128 v[148:151], v31 offset:5120
    v_mfma_f32_16x16x32_bf16 v[212:215], a[44:47], v[104:107], v[212:215]
    buffer_load_dwordx4 v21, s[12:15], s29 offen offset:3072 lds
    v_mfma_f32_16x16x32_bf16 v[216:219], a[40:43], v[108:111], v[216:219]
    ds_read_b128 v[92:95], v15 offset:33280
    ds_read_b128 v[200:203], v25 offset:2048
    v_mfma_f32_16x16x32_bf16 v[220:223], a[44:47], v[108:111], v[220:223]
    ds_read_b128 v[136:139], v31 offset:2048
    ds_read_b128 v[152:155], v31 offset:6144
    v_mfma_f32_16x16x32_bf16 v[208:211], a[48:51], v[112:115], v[208:211]
    ds_read_b128 v[204:207], v25 offset:3072
    ds_read_b128 v[140:143], v31 offset:3072
    v_mfma_f32_16x16x32_bf16 v[212:215], a[52:55], v[112:115], v[212:215]
    s_add_u32 m0, s6, 12288
    s_waitcnt lgkmcnt(9)
    v_mfma_f32_16x16x32_bf16 v[48:51], v[128:131], v[192:195], v[32:35]
    buffer_load_dwordx4 v22, s[12:15], s29 offen offset:0 lds
    v_mfma_f32_16x16x32_bf16 v[52:55], v[144:147], v[192:195], v[36:39]
    ds_read_b128 v[156:159], v31 offset:7168
    s_waitcnt lgkmcnt(7)
    v_mfma_f32_16x16x32_bf16 v[48:51], v[132:135], v[196:199], v[48:51]
    ds_read_b128 v[160:163], v5 offset:8192
    ds_read_b128 v[164:167], v5 offset:9216
    v_mfma_f32_16x16x32_bf16 v[52:55], v[148:151], v[196:199], v[52:55]
    ds_read_b128 v[96:99], v12 offset:768
    s_waitcnt lgkmcnt(6)
    v_mfma_f32_16x16x32_bf16 v[48:51], v[136:139], v[200:203], v[48:51]
    buffer_load_dwordx4 v22, s[12:15], s29 offen offset:1024 lds
    v_mfma_f32_16x16x32_bf16 v[52:55], v[152:155], v[200:203], v[52:55]
    ds_read_b128 v[100:103], v12 offset:33536
    ds_read_b128 v[104:107], v13 offset:768
    v_mfma_f32_16x16x32_bf16 v[216:219], a[48:51], v[116:119], v[216:219]
    ds_read_b128 v[108:111], v13 offset:33536
    ds_read_b128 v[168:171], v5 offset:10240
    v_mfma_f32_16x16x32_bf16 v[220:223], a[52:55], v[116:119], v[220:223]
    ds_read_b128 v[172:175], v5 offset:11264
    s_waitcnt lgkmcnt(8)
    v_mfma_f32_16x16x32_bf16 v[48:51], v[140:143], v[204:207], v[48:51]
    buffer_load_dwordx4 v23, s[12:15], s29 offen offset:2048 lds
    v_mfma_f32_16x16x32_bf16 v[52:55], v[156:159], v[204:207], v[52:55]
    v_max_i32 v27, s30, v26
    ds_read_b128 v[112:115], v14 offset:768
    v_mfma_f32_16x16x32_bf16 v[208:211], a[56:59], v[120:123], v[208:211]
    s_waitcnt vmcnt(12)
    s_cbranch_vccnz .cp_452
    buffer_store_dword v27, v26, s[8:11], s94 offen
.cb_453:
    v_mfma_f32_16x16x32_bf16 v[212:215], a[60:63], v[120:123], v[212:215]
    ds_read_b128 v[116:119], v14 offset:33536
    ds_read_b128 v[120:123], v15 offset:768
    v_mfma_f32_16x16x32_bf16 v[216:219], a[56:59], v[124:127], v[216:219]
    buffer_load_dwordx4 v23, s[12:15], s29 offen offset:3072 lds
    v_mfma_f32_16x16x32_bf16 v[220:223], a[60:63], v[124:127], v[220:223]
    s_cmp_eq_u32 s31, 0
    s_cbranch_scc1 .cp_456
.cb_457:
    v_mfma_f32_16x16x32_bf16 v[208:211], a[64:67], v[64:67], v[208:211]
    buffer_load_dword v29, v28, s[12:15], s29 offen
    ds_read_b128 v[124:127], v15 offset:33536
    v_mfma_f32_16x16x32_bf16 v[212:215], a[68:71], v[64:67], v[212:215]
    s_waitcnt lgkmcnt(4)
    s_barrier
    v_mfma_f32_16x16x32_bf16 v[216:219], a[64:67], v[68:71], v[216:219]
    ds_read_b128 v[176:179], v3 offset:4096
    ds_read_b128 v[180:183], v3 offset:4608
    v_mfma_f32_16x16x32_bf16 v[220:223], a[68:71], v[68:71], v[220:223]
    ds_read_b128 v[184:187], v3 offset:5120
    ds_read_b128 v[188:191], v3 offset:5632
    v_mfma_f32_16x16x32_bf16 v[208:211], a[72:75], v[72:75], v[208:211]
    s_add_u32 m0, s52, 0
    s_add_u32 s48, s48, 0x20000
    v_mfma_f32_16x16x32_bf16 v[212:215], a[76:79], v[72:75], v[212:215]
    s_cmp_gt_u32 s33, s42
    s_cselect_b32 s31, 1, 0
    s_cselect_b32 s4, s48, s54
    v_mfma_f32_16x16x32_bf16 v[216:219], a[72:75], v[76:79], v[216:219]
    buffer_load_dwordx4 v2, s[8:11], s4 offen lds
    v_mfma_f32_16x16x32_bf16 v[220:223], a[76:79], v[76:79], v[220:223]
    buffer_load_dword v4, v7, s[8:11], 0 offen sc1
    ds_read_b128 v[64:67], v12 offset:1024
    v_mfma_f32_16x16x32_bf16 v[208:211], a[80:83], v[80:83], v[208:211]
    ds_read_b128 v[68:71], v12 offset:33792
    ds_read_b128 v[72:75], v13 offset:1024
    v_mfma_f32_16x16x32_bf16 v[212:215], a[84:87], v[80:83], v[212:215]
    ds_read_b128 v[76:79], v13 offset:33792
    v_max3_f32 v248, v48, v49, v50
    v_mfma_f32_16x16x32_bf16 v[216:219], a[80:83], v[84:87], v[216:219]
    v_max3_f32 v248, v248, v51, v52
    v_max3_f32 v249, v53, v54, v55
    s_waitcnt lgkmcnt(4)
    v_mfma_f32_16x16x32_bf16 v[56:59], v[176:179], v[192:195], 0
    ds_read_b128 v[80:83], v14 offset:1024
    s_add_u32 s29, s29, 0x10000
    v_mfma_f32_16x16x32_bf16 v[56:59], v[180:183], v[196:199], v[56:59]
    s_cmp_gt_u32 s32, s42
    s_cbranch_scc0 .cp_454
.cb_455:
    v_mfma_f32_16x16x32_bf16 v[56:59], v[184:187], v[200:203], v[56:59]
    ds_read_b32 v232, v6 offset:4096
    ds_read_b32 v234, v6 offset:4160
    v_mfma_f32_16x16x32_bf16 v[56:59], v[188:191], v[204:207], v[56:59]
    ds_read_b32 v236, v6 offset:4608
    ds_read_b32 v238, v6 offset:4672
    v_mfma_f32_16x16x32_bf16 v[220:223], a[84:87], v[84:87], v[220:223]
    s_add_u32 s5, s49, 0x80000
    s_min_u32 s5, s5, s55
    v_mfma_f32_16x16x32_bf16 v[208:211], a[88:91], v[88:91], v[208:211]
    buffer_load_dword v29, v255, s[8:11], s5 offen
    s_mov_b32 m0, s43
    v_mfma_f32_16x16x32_bf16 v[212:215], a[92:95], v[88:91], v[212:215]
    s_add_u32 s49, s49, 0x40000
    ds_read_b128 v[84:87], v14 offset:33792
    v_mfma_f32_16x16x32_bf16 v[216:219], a[88:91], v[92:95], v[216:219]
    buffer_load_dwordx4 v2, s[8:11], s49 offen lds
    v_mfma_f32_16x16x32_bf16 v[220:223], a[92:95], v[92:95], v[220:223]
    s_add_u32 s50, s49, 16777216
    ds_read_b128 v[88:91], v15 offset:1024
    v_mfma_f32_16x16x32_bf16 v[208:211], a[96:99], v[96:99], v[208:211]
    ds_read_b128 v[92:95], v15 offset:33792
    v_max3_f32 v248, v248, v56, v57
    v_mfma_f32_16x16x32_bf16 v[212:215], a[100:103], v[96:99], v[212:215]
    v_max_f32 v30, v248, v249
    v_max_f32 v249, v248, v249
    v_mfma_f32_16x16x32_bf16 v[216:219], a[96:99], v[100:103], v[216:219]
    buffer_load_dwordx4 v2, s[8:11], s49 offen offset:1024 lds
    v_mfma_f32_16x16x32_bf16 v[220:223], a[100:103], v[100:103], v[220:223]
    s_add_u32 m0, s43, 8192
    v_permlane16_swap_b32 v249, v30
    v_mfma_f32_16x16x32_bf16 v[208:211], a[104:107], v[104:107], v[208:211]
    v_max_f32 v248, v249, v30
    v_max_f32 v249, v249, v30
    v_mfma_f32_16x16x32_bf16 v[212:215], a[108:111], v[104:107], v[212:215]
    ds_read_b128 v[96:99], v12 offset:1280
    ds_read_b128 v[100:103], v12 offset:34048
    v_mfma_f32_16x16x32_bf16 v[216:219], a[104:107], v[108:111], v[216:219]
    buffer_load_dwordx4 v2, s[8:11], s50 offen lds
    v_mfma_f32_16x16x32_bf16 v[220:223], a[108:111], v[108:111], v[220:223]
    v_permlane32_swap_b32 v248, v249
    v_max_f32 v248, v248, v249
    v_mfma_f32_16x16x32_bf16 v[208:211], a[112:115], v[112:115], v[208:211]
    v_mul_f32 v248, s45, v248
    ds_read_b128 v[104:107], v13 offset:1280
    v_mfma_f32_16x16x32_bf16 v[212:215], a[116:119], v[112:115], v[212:215]
    ds_read_b128 v[108:111], v13 offset:34048
    v_fma_f32 v60, v48, s45, -v248
    v_mfma_f32_16x16x32_bf16 v[216:219], a[112:115], v[116:119], v[216:219]
    buffer_load_dwordx4 v2, s[8:11], s50 offen offset:1024 lds
    v_mfma_f32_16x16x32_bf16 v[220:223], a[116:119], v[116:119], v[220:223]
    v_fma_f32 v61, v49, s45, -v248
    v_fma_f32 v62, v50, s45, -v248
    v_mfma_f32_16x16x32_bf16 v[208:211], a[120:123], v[120:123], v[208:211]
    v_fma_f32 v63, v51, s45, -v248
    v_fma_f32 v242, v52, s45, -v248
    v_mfma_f32_16x16x32_bf16 v[212:215], a[124:127], v[120:123], v[212:215]
    v_fma_f32 v243, v53, s45, -v248
    v_fma_f32 v244, v54, s45, -v248
    v_mfma_f32_16x16x32_bf16 v[216:219], a[120:123], v[124:127], v[216:219]
    v_fma_f32 v245, v55, s45, -v248
    v_fma_f32 v246, v56, s45, -v248
    v_mfma_f32_16x16x32_bf16 v[220:223], a[124:127], v[124:127], v[220:223]
    v_fma_f32 v247, v57, s45, -v248
    s_waitcnt lgkmcnt(12)
    v_mfma_f32_16x16x32_bf16 v[208:211], a[128:131], v[64:67], v[208:211]
    ds_read_b128 v[112:115], v14 offset:1280
    ds_read_b128 v[116:119], v14 offset:34048
    v_mfma_f32_16x16x32_bf16 v[212:215], a[132:135], v[64:67], v[212:215]
    ds_read_b128 v[120:123], v15 offset:1280
    ds_read_b128 v[124:127], v15 offset:34048
    v_mfma_f32_16x16x32_bf16 v[216:219], a[128:131], v[68:71], v[216:219]
    v_exp_f32 v60, v60
    v_mfma_f32_16x16x32_bf16 v[220:223], a[132:135], v[68:71], v[220:223]
    v_exp_f32 v61, v61
    v_mfma_f32_16x16x32_bf16 v[208:211], a[136:139], v[72:75], v[208:211]
    v_exp_f32 v62, v62
    v_mfma_f32_16x16x32_bf16 v[212:215], a[140:143], v[72:75], v[212:215]
    v_exp_f32 v63, v63
    v_mfma_f32_16x16x32_bf16 v[216:219], a[136:139], v[76:79], v[216:219]
    v_exp_f32 v242, v242
    v_mfma_f32_16x16x32_bf16 v[220:223], a[140:143], v[76:79], v[220:223]
    ds_read_b128 v[64:67], v12 offset:1536
    s_waitcnt lgkmcnt(9)
    v_mfma_f32_16x16x32_bf16 v[208:211], a[144:147], v[80:83], v[208:211]
    v_exp_f32 v243, v243
    v_mfma_f32_16x16x32_bf16 v[212:215], a[148:151], v[80:83], v[212:215]
    v_exp_f32 v244, v244
    v_mfma_f32_16x16x32_bf16 v[216:219], a[144:147], v[84:87], v[216:219]
    v_exp_f32 v245, v245
    v_mfma_f32_16x16x32_bf16 v[220:223], a[148:151], v[84:87], v[220:223]
    v_exp_f32 v246, v246
    v_mfma_f32_16x16x32_bf16 v[208:211], a[152:155], v[88:91], v[208:211]
    v_exp_f32 v247, v247
    v_mfma_f32_16x16x32_bf16 v[212:215], a[156:159], v[88:91], v[212:215]
    ds_read_b128 v[68:71], v12 offset:34304
    ds_read_b128 v[72:75], v13 offset:1536
    v_mfma_f32_16x16x32_bf16 v[216:219], a[152:155], v[92:95], v[216:219]
    ds_read_b128 v[76:79], v13 offset:34304
    v_cvt_pk_bf16_f32 v48, v60, v61
    v_mfma_f32_16x16x32_bf16 v[220:223], a[156:159], v[92:95], v[220:223]
    v_cvt_pk_bf16_f32 v49, v62, v63
    s_waitcnt lgkmcnt(8)
    v_mfma_f32_16x16x32_bf16 v[208:211], a[160:163], v[96:99], v[208:211]
    v_cvt_pk_bf16_f32 v50, v242, v243
    v_cvt_pk_bf16_f32 v51, v244, v245
    v_mfma_f32_16x16x32_bf16 v[212:215], a[164:167], v[96:99], v[212:215]
    v_cvt_pk_bf16_f32 v40, v246, v247
    ds_read_b128 v[80:83], v14 offset:1536
    v_mfma_f32_16x16x32_bf16 v[216:219], a[160:163], v[100:103], v[216:219]
    ds_read_b128 v[84:87], v14 offset:34304
    ds_read_b128 v[88:91], v15 offset:1536
    v_mfma_f32_16x16x32_bf16 v[52:55], v[44:47], v[48:51], 0
    ds_read_b128 v[92:95], v15 offset:34304
    ds_read_b128 v[96:99], v12 offset:1792
    v_mfma_f32_16x16x32_bf16 v[52:55], v[44:47], v[40:43], v[52:55]
    v_mfma_f32_16x16x32_bf16 v[192:195], v[160:163], v[48:51], 0
    v_mfma_f32_16x16x32_bf16 v[192:195], v[232:235], v[40:43], v[192:195]
    v_mfma_f32_16x16x32_bf16 v[196:199], v[164:167], v[48:51], 0
    v_mfma_f32_16x16x32_bf16 v[196:199], v[234:237], v[40:43], v[196:199]
    v_mfma_f32_16x16x32_bf16 v[200:203], v[168:171], v[48:51], 0
    v_mfma_f32_16x16x32_bf16 v[200:203], v[236:239], v[40:43], v[200:203]
    v_mfma_f32_16x16x32_bf16 v[204:207], v[172:175], v[48:51], 0
    v_mfma_f32_16x16x32_bf16 v[204:207], v[238:241], v[40:43], v[204:207]
    v_rcp_f32 v248, v52
    v_mfma_f32_16x16x32_bf16 v[220:223], a[164:167], v[100:103], v[220:223]
    ds_read_b128 v[100:103], v12 offset:34560
    v_mul_f32 v192, v248, v192
    v_mfma_f32_16x16x32_bf16 v[208:211], a[168:171], v[104:107], v[208:211]
    v_mul_f32 v193, v248, v193
    v_mul_f32 v194, v248, v194
    v_mfma_f32_16x16x32_bf16 v[212:215], a[172:175], v[104:107], v[212:215]
    ds_read_b128 v[104:107], v13 offset:1792
    v_mul_f32 v195, v248, v195
    v_mfma_f32_16x16x32_bf16 v[216:219], a[168:171], v[108:111], v[216:219]
    v_cvt_pk_bf16_f32 v224, v192, v193
    v_cvt_pk_bf16_f32 v225, v194, v195
    v_mfma_f32_16x16x32_bf16 v[220:223], a[172:175], v[108:111], v[220:223]
    ds_read_b128 v[108:111], v13 offset:34560
    s_waitcnt lgkmcnt(12)
    v_mfma_f32_16x16x32_bf16 v[208:211], a[176:179], v[112:115], v[208:211]
    v_mul_f32 v196, v248, v196
    v_mul_f32 v197, v248, v197
    v_mfma_f32_16x16x32_bf16 v[212:215], a[180:183], v[112:115], v[212:215]
    ds_read_b128 v[112:115], v14 offset:1792
    v_mul_f32 v198, v248, v198
    v_mfma_f32_16x16x32_bf16 v[216:219], a[176:179], v[116:119], v[216:219]
    v_mul_f32 v199, v248, v199
    v_cvt_pk_bf16_f32 v226, v196, v197
    v_mfma_f32_16x16x32_bf16 v[220:223], a[180:183], v[116:119], v[220:223]
    s_waitcnt vmcnt(5)
    v_min_u32_dpp v4, v4, v4 quad_perm:[1,0,3,2] row_mask:0xf bank_mask:0xf
    v_mfma_f32_16x16x32_bf16 v[208:211], a[184:187], v[120:123], v[208:211]
    ds_read_b128 v[116:119], v14 offset:34560
    v_cvt_pk_bf16_f32 v227, v198, v199
    v_mfma_f32_16x16x32_bf16 v[212:215], a[188:191], v[120:123], v[212:215]
    v_min_u32_dpp v4, v4, v4 quad_perm:[2,3,0,1] row_mask:0xf bank_mask:0xf
    ds_read_b128 v[120:123], v15 offset:1792
    v_mfma_f32_16x16x32_bf16 v[216:219], a[184:187], v[124:127], v[216:219]
    v_readfirstlane_b32 s33, v4
    v_mfma_f32_16x16x32_bf16 v[220:223], a[188:191], v[124:127], v[220:223]
    ds_read_b128 v[124:127], v15 offset:34560
    s_waitcnt lgkmcnt(12)
    v_mfma_f32_16x16x32_bf16 v[208:211], a[192:195], v[64:67], v[208:211]
    s_cmp_eq_u32 s31, 0
    s_cbranch_scc1 .cp_460
.cb_461:
    v_mfma_f32_16x16x32_bf16 v[212:215], a[196:199], v[64:67], v[212:215]
    s_cbranch_vccnz .cp_448
    buffer_store_dwordx4 v[224:227], v2, s[8:11], s53 offen offset:0
.cb_449:
    v_mfma_f32_16x16x32_bf16 v[216:219], a[192:195], v[68:71], v[216:219]
    v_mul_f32 v200, v248, v200
    v_mul_f32 v201, v248, v201
    v_mfma_f32_16x16x32_bf16 v[220:223], a[196:199], v[68:71], v[220:223]
    v_mul_f32 v202, v248, v202
    v_mul_f32 v203, v248, v203
    v_mfma_f32_16x16x32_bf16 v[208:211], a[200:203], v[72:75], v[208:211]
    s_waitcnt lgkmcnt(0)
    s_barrier
    v_mfma_f32_16x16x32_bf16 v[212:215], a[204:207], v[72:75], v[212:215]
    s_add_u32 m0, s6, 65536
    ds_read_b128 v[64:67], v8 offset:0
    v_mfma_f32_16x16x32_bf16 v[216:219], a[200:203], v[76:79], v[216:219]
    buffer_load_dwordx4 v16, s[12:15], s29 offen offset:0 lds
    v_mfma_f32_16x16x32_bf16 v[220:223], a[204:207], v[76:79], v[220:223]
    ds_read_b128 v[68:71], v8 offset:32768
    ds_read_b128 v[72:75], v9 offset:0
    v_mfma_f32_16x16x32_bf16 v[208:211], a[208:211], v[80:83], v[208:211]
    ds_read_b128 v[76:79], v9 offset:32768
    v_cvt_pk_bf16_f32 v228, v200, v201
    v_mfma_f32_16x16x32_bf16 v[212:215], a[212:215], v[80:83], v[212:215]
    v_cvt_pk_bf16_f32 v229, v202, v203
    v_mul_f32 v204, v248, v204
    v_mfma_f32_16x16x32_bf16 v[216:219], a[208:211], v[84:87], v[216:219]
    buffer_load_dwordx4 v16, s[12:15], s29 offen offset:1024 lds
    v_mfma_f32_16x16x32_bf16 v[220:223], a[212:215], v[84:87], v[220:223]
    v_mul_f32 v205, v248, v205
    v_mul_f32 v206, v248, v206
    v_mfma_f32_16x16x32_bf16 v[208:211], a[216:219], v[88:91], v[208:211]
    v_mul_f32 v207, v248, v207
    v_cvt_pk_bf16_f32 v230, v204, v205
    v_mfma_f32_16x16x32_bf16 v[212:215], a[220:223], v[88:91], v[212:215]
    v_cvt_pk_bf16_f32 v231, v206, v207
    ds_read_b128 v[80:83], v10 offset:0
    v_mfma_f32_16x16x32_bf16 v[216:219], a[216:219], v[92:95], v[216:219]
    buffer_load_dwordx4 v17, s[12:15], s29 offen offset:2048 lds
    v_mfma_f32_16x16x32_bf16 v[220:223], a[220:223], v[92:95], v[220:223]
    s_cbranch_vccnz .cp_450
    buffer_store_dwordx4 v[228:231], v2, s[8:11], s53 offen offset:1024
.cb_451:
    v_mfma_f32_16x16x32_bf16 v[208:211], a[224:227], v[96:99], v[208:211]
    ds_read_b128 v[84:87], v10 offset:32768
    ds_read_b128 v[88:91], v11 offset:0
    v_mfma_f32_16x16x32_bf16 v[212:215], a[228:231], v[96:99], v[212:215]
    ds_read_b128 v[92:95], v11 offset:32768
    ds_read_b128 v[96:99], v8 offset:256
    v_mfma_f32_16x16x32_bf16 v[216:219], a[224:227], v[100:103], v[216:219]
    buffer_load_dwordx4 v17, s[12:15], s29 offen offset:3072 lds
    v_mfma_f32_16x16x32_bf16 v[220:223], a[228:231], v[100:103], v[220:223]
    ds_read_b128 v[100:103], v8 offset:33024
    s_mov_b32 s53, s40
    v_mfma_f32_16x16x32_bf16 v[208:211], a[232:235], v[104:107], v[208:211]
    s_add_u32 s40, s40, 0x40000
    s_mov_b32 s30, s42
    v_mfma_f32_16x16x32_bf16 v[212:215], a[236:239], v[104:107], v[212:215]
    ds_read_b128 v[104:107], v9 offset:256
    s_add_u32 s42, s42, 1
    v_mfma_f32_16x16x32_bf16 v[216:219], a[232:235], v[108:111], v[216:219]
    s_add_u32 m0, s6, 69632
    v_mfma_f32_16x16x32_bf16 v[220:223], a[236:239], v[108:111], v[220:223]
    buffer_load_dwordx4 v18, s[12:15], s29 offen offset:0 lds
    v_mfma_f32_16x16x32_bf16 v[208:211], a[240:243], v[112:115], v[208:211]
    ds_read_b128 v[108:111], v9 offset:33024
    v_mfma_f32_16x16x32_bf16 v[212:215], a[244:247], v[112:115], v[212:215]
    v_mfma_f32_16x16x32_bf16 v[216:219], a[240:243], v[116:119], v[216:219]
    v_mfma_f32_16x16x32_bf16 v[220:223], a[244:247], v[116:119], v[220:223]
    buffer_load_dwordx4 v18, s[12:15], s29 offen offset:1024 lds
    v_mfma_f32_16x16x32_bf16 v[208:211], a[248:251], v[120:123], v[208:211]
    v_mfma_f32_16x16x32_bf16 v[212:215], a[252:255], v[120:123], v[212:215]
    v_mfma_f32_16x16x32_bf16 v[216:219], a[248:251], v[124:127], v[216:219]
    v_mfma_f32_16x16x32_bf16 v[220:223], a[252:255], v[124:127], v[220:223]
    s_cmp_lg_u32 s42, 62
    s_cbranch_scc1 .ql_432
    s_nop 5
    v_cvt_pk_bf16_f32 v224, v208, v209
    v_cvt_pk_bf16_f32 v225, v210, v211
    v_cvt_pk_bf16_f32 v226, v212, v213
    v_cvt_pk_bf16_f32 v227, v214, v215
    v_cvt_pk_bf16_f32 v228, v216, v217
    v_cvt_pk_bf16_f32 v229, v218, v219
    v_cvt_pk_bf16_f32 v230, v220, v221
    v_cvt_pk_bf16_f32 v231, v222, v223
    ds_write_b128 v24, v[224:227] offset:0
    ds_write_b128 v24, v[228:231] offset:4096
    s_waitcnt vmcnt(0)
    v_max_i32 v27, s30, v26
    s_cbranch_vccnz .cp_462
    buffer_store_dword v27, v26, s[8:11], s94 offen
.cb_463:
    s_waitcnt lgkmcnt(0)
    s_barrier
    ds_read_b128 v[208:211], v25 offset:0
    ds_read_b128 v[128:131], v31 offset:0
    ds_read_b128 v[144:147], v31 offset:4096
    ds_read_b128 v[212:215], v25 offset:1024
    ds_read_b128 v[132:135], v31 offset:1024
    ds_read_b128 v[148:151], v31 offset:5120
    ds_read_b128 v[216:219], v25 offset:2048
    ds_read_b128 v[136:139], v31 offset:2048
    ds_read_b128 v[152:155], v31 offset:6144
    ds_read_b128 v[220:223], v25 offset:3072
    ds_read_b128 v[140:143], v31 offset:3072
    ds_read_b128 v[156:159], v31 offset:7168
    ds_read_b128 v[160:163], v5 offset:8192
    ds_read_b128 v[164:167], v5 offset:9216
    ds_read_b128 v[168:171], v5 offset:10240
    ds_read_b128 v[172:175], v5 offset:11264
    s_waitcnt lgkmcnt(4)
    v_mfma_f32_16x16x32_bf16 v[48:51], v[128:131], v[208:211], v[32:35]
    v_mfma_f32_16x16x32_bf16 v[52:55], v[144:147], v[208:211], v[36:39]
    v_mfma_f32_16x16x32_bf16 v[48:51], v[132:135], v[212:215], v[48:51]
    v_mfma_f32_16x16x32_bf16 v[52:55], v[148:151], v[212:215], v[52:55]
    v_mfma_f32_16x16x32_bf16 v[48:51], v[136:139], v[216:219], v[48:51]
    v_mfma_f32_16x16x32_bf16 v[52:55], v[152:155], v[216:219], v[52:55]
    v_mfma_f32_16x16x32_bf16 v[48:51], v[140:143], v[220:223], v[48:51]
    v_mfma_f32_16x16x32_bf16 v[52:55], v[156:159], v[220:223], v[52:55]
    s_cmp_eq_u32 s31, 0
    s_cbranch_scc1 .cp_472
.cb_473:
    s_waitcnt vmcnt(0)
    s_barrier
    ds_read_b128 v[176:179], v3 offset:0
    ds_read_b128 v[180:183], v3 offset:512
    ds_read_b128 v[184:187], v3 offset:1024
    ds_read_b128 v[188:191], v3 offset:1536
    ds_read_b32 v232, v6 offset:0
    ds_read_b32 v234, v6 offset:64
    ds_read_b32 v236, v6 offset:512
    ds_read_b32 v238, v6 offset:576
    v_max3_f32 v248, v48, v49, v50
    v_max3_f32 v248, v248, v51, v52
    v_max3_f32 v249, v53, v54, v55
    s_waitcnt lgkmcnt(4)
    v_mfma_f32_16x16x32_bf16 v[56:59], v[176:179], v[208:211], 0
    v_mfma_f32_16x16x32_bf16 v[56:59], v[180:183], v[212:215], v[56:59]
    v_mfma_f32_16x16x32_bf16 v[56:59], v[184:187], v[216:219], v[56:59]
    v_mfma_f32_16x16x32_bf16 v[56:59], v[188:191], v[220:223], v[56:59]
    s_nop 7
    v_max3_f32 v248, v248, v56, v57
    v_max_f32 v30, v248, v249
    v_max_f32 v249, v248, v249
    s_nop 1
    v_permlane16_swap_b32 v249, v30
    v_max_f32 v248, v249, v30
    v_max_f32 v249, v249, v30
    s_nop 1
    v_permlane32_swap_b32 v248, v249
    v_max_f32 v248, v248, v249
    v_mul_f32 v248, s45, v248
    v_fma_f32 v60, v48, s45, -v248
    v_fma_f32 v61, v49, s45, -v248
    v_fma_f32 v62, v50, s45, -v248
    v_fma_f32 v63, v51, s45, -v248
    v_fma_f32 v242, v52, s45, -v248
    v_fma_f32 v243, v53, s45, -v248
    v_fma_f32 v244, v54, s45, -v248
    v_fma_f32 v245, v55, s45, -v248
    v_fma_f32 v246, v56, s45, -v248
    v_fma_f32 v247, v57, s45, -v248
    v_exp_f32 v60, v60
    v_exp_f32 v61, v61
    v_exp_f32 v62, v62
    v_exp_f32 v63, v63
    v_exp_f32 v242, v242
    v_exp_f32 v243, v243
    v_exp_f32 v244, v244
    v_exp_f32 v245, v245
    v_exp_f32 v246, v246
    v_exp_f32 v247, v247
    v_cvt_pk_bf16_f32 v48, v60, v61
    v_cvt_pk_bf16_f32 v49, v62, v63
    v_cvt_pk_bf16_f32 v50, v242, v243
    v_cvt_pk_bf16_f32 v51, v244, v245
    v_cvt_pk_bf16_f32 v40, v246, v247
    s_waitcnt lgkmcnt(0)
    v_mfma_f32_16x16x32_bf16 v[52:55], v[44:47], v[48:51], 0
    v_mfma_f32_16x16x32_bf16 v[52:55], v[44:47], v[40:43], v[52:55]
    v_mfma_f32_16x16x32_bf16 v[208:211], v[160:163], v[48:51], 0
    v_mfma_f32_16x16x32_bf16 v[208:211], v[232:235], v[40:43], v[208:211]
    v_mfma_f32_16x16x32_bf16 v[212:215], v[164:167], v[48:51], 0
    v_mfma_f32_16x16x32_bf16 v[212:215], v[234:237], v[40:43], v[212:215]
    v_mfma_f32_16x16x32_bf16 v[216:219], v[168:171], v[48:51], 0
    v_mfma_f32_16x16x32_bf16 v[216:219], v[236:239], v[40:43], v[216:219]
    v_mfma_f32_16x16x32_bf16 v[220:223], v[172:175], v[48:51], 0
    v_mfma_f32_16x16x32_bf16 v[220:223], v[238:241], v[40:43], v[220:223]
    v_rcp_f32 v248, v52
    s_nop 0
    v_mul_f32 v208, v248, v208
    v_mul_f32 v209, v248, v209
    v_mul_f32 v210, v248, v210
    v_mul_f32 v211, v248, v211
    v_cvt_pk_bf16_f32 v224, v208, v209
    v_cvt_pk_bf16_f32 v225, v210, v211
    v_mul_f32 v212, v248, v212
    v_mul_f32 v213, v248, v213
    v_mul_f32 v214, v248, v214
    v_mul_f32 v215, v248, v215
    v_cvt_pk_bf16_f32 v226, v212, v213
    v_cvt_pk_bf16_f32 v227, v214, v215
    s_cbranch_vccnz .cp_468
    buffer_store_dwordx4 v[224:227], v2, s[8:11], s53 offen offset:0
.cb_469:
    v_mul_f32 v216, v248, v216
    v_mul_f32 v217, v248, v217
    v_mul_f32 v218, v248, v218
    v_mul_f32 v219, v248, v219
    v_cvt_pk_bf16_f32 v228, v216, v217
    v_cvt_pk_bf16_f32 v229, v218, v219
    v_mul_f32 v220, v248, v220
    v_mul_f32 v221, v248, v221
    v_mul_f32 v222, v248, v222
    v_mul_f32 v223, v248, v223
    v_cvt_pk_bf16_f32 v230, v220, v221
    v_cvt_pk_bf16_f32 v231, v222, v223
    s_cbranch_vccnz .cp_470
    buffer_store_dwordx4 v[228:231], v2, s[8:11], s53 offen offset:1024
.cb_471:
    s_add_u32 s30, s30, 1
    s_mov_b32 s53, s40
    s_waitcnt vmcnt(0)
    v_max_i32 v27, s30, v26
    s_cbranch_vccnz .cp_474
    buffer_store_dword v27, v26, s[8:11], s94 offen
.cb_475:
    s_cmp_gt_u32 s32, 63
    s_cbranch_scc1 .ndd_477
    s_mov_b32 s62, 0
.nd_476:
    buffer_load_dword v29, v7, s[8:11], s46 offen sc1
    buffer_load_dword v30, v7, s[8:11], s47 offen sc1
    s_add_u32 s62, s62, 1
    s_cmp_gt_u32 s62, 0x200000
    s_cbranch_scc1 .mg_end_1
    s_waitcnt vmcnt(0)
    v_min_u32 v29, v29, v30
    s_nop 1
    v_min_u32_dpp v29, v29, v29 quad_perm:[1,0,3,2] row_mask:0xf bank_mask:0xf
    s_nop 1
    v_min_u32_dpp v29, v29, v29 quad_perm:[2,3,0,1] row_mask:0xf bank_mask:0xf
    s_nop 1
    v_readfirstlane_b32 s32, v29
    s_lshl_b32 s55, s32, 18
    s_add_u32 s55, s55, s37
    s_cmp_gt_u32 s32, 63
    s_cbranch_scc1 .ndd_477
    s_sleep 2
    s_branch .nd_476
.ndd_477:
    s_sub_u32 s4, s36, 16777216
    s_sub_u32 s5, s43, 139264
    s_add_u32 s49, s49, 0x40000
    s_add_u32 s50, s49, 16777216
    s_add_u32 m0, s5, 0
    s_nop 0
    buffer_load_dwordx4 v2, s[8:11], s4 offen lds
    buffer_load_dwordx4 v2, s[8:11], s4 offen offset:1024 lds
    s_add_u32 m0, s5, 8192
    s_nop 0
    buffer_load_dwordx4 v2, s[8:11], s49 offen lds
    buffer_load_dwordx4 v2, s[8:11], s49 offen offset:1024 lds
    s_add_u32 m0, s5, 16384
    s_nop 0
    buffer_load_dwordx4 v2, s[8:11], s50 offen lds
    buffer_load_dwordx4 v2, s[8:11], s50 offen offset:1024 lds
    s_add_u32 s4, s4, 0x40000
    s_add_u32 s49, s49, 0x40000
    s_add_u32 s50, s49, 16777216
    s_add_u32 m0, s5, 32768
    s_nop 0
    buffer_load_dwordx4 v2, s[8:11], s4 offen lds
    buffer_load_dwordx4 v2, s[8:11], s4 offen offset:1024 lds
    s_add_u32 m0, s5, 40960
    s_nop 0
    buffer_load_dwordx4 v2, s[8:11], s49 offen lds
    buffer_load_dwordx4 v2, s[8:11], s49 offen offset:1024 lds
    s_add_u32 m0, s5, 49152
    s_nop 0
    buffer_load_dwordx4 v2, s[8:11], s50 offen lds
    buffer_load_dwordx4 v2, s[8:11], s50 offen offset:1024 lds
    s_add_u32 s4, s4, 0x40000
    buffer_load_dword v4, v7, s[8:11], 0 offen sc1
    v_subrev_u32 v25, 131072, v25
    v_subrev_u32 v31, 131072, v31
    v_subrev_u32 v5, 131072, v5
    s_add_u32 s48, s48, 0x20000
    s_mov_b32 s31, 0
    s_add_u32 s40, s40, 0x40000
    s_waitcnt vmcnt(7)
    s_barrier
    ds_read_b128 v[192:195], v25 offset:0
    ds_read_b128 v[128:131], v31 offset:0
    ds_read_b128 v[144:147], v31 offset:4096
    ds_read_b128 v[196:199], v25 offset:1024
    ds_read_b128 v[132:135], v31 offset:1024
    ds_read_b128 v[148:151], v31 offset:5120
    ds_read_b128 v[200:203], v25 offset:2048
    ds_read_b128 v[136:139], v31 offset:2048
    ds_read_b128 v[152:155], v31 offset:6144
    ds_read_b128 v[204:207], v25 offset:3072
    ds_read_b128 v[140:143], v31 offset:3072
    ds_read_b128 v[156:159], v31 offset:7168
    ds_read_b128 v[160:163], v5 offset:8192
    ds_read_b128 v[164:167], v5 offset:9216
    ds_read_b128 v[168:171], v5 offset:10240
    ds_read_b128 v[172:175], v5 offset:11264
    s_waitcnt lgkmcnt(4)
    v_mfma_f32_16x16x32_bf16 v[48:51], v[128:131], v[192:195], v[32:35]
    v_mfma_f32_16x16x32_bf16 v[52:55], v[144:147], v[192:195], v[36:39]
    v_mfma_f32_16x16x32_bf16 v[48:51], v[132:135], v[196:199], v[48:51]
    v_mfma_f32_16x16x32_bf16 v[52:55], v[148:151], v[196:199], v[52:55]
    v_mfma_f32_16x16x32_bf16 v[48:51], v[136:139], v[200:203], v[48:51]
    v_mfma_f32_16x16x32_bf16 v[52:55], v[152:155], v[200:203], v[52:55]
    v_mfma_f32_16x16x32_bf16 v[48:51], v[140:143], v[204:207], v[48:51]
    v_mfma_f32_16x16x32_bf16 v[52:55], v[156:159], v[204:207], v[52:55]
    s_waitcnt vmcnt(0)
    v_min_u32_dpp v4, v4, v4 quad_perm:[1,0,3,2] row_mask:0xf bank_mask:0xf
    s_nop 1
    v_min_u32_dpp v4, v4, v4 quad_perm:[2,3,0,1] row_mask:0xf bank_mask:0xf
    s_nop 1
    v_readfirstlane_b32 s33, v4
    s_cmp_eq_u32 s31, 0
    s_cbranch_scc1 .cp_487
.cb_488:
    s_waitcnt vmcnt(0)
    s_barrier
    ds_read_b128 v[176:179], v3 offset:4096
    ds_read_b128 v[180:183], v3 offset:4608
    ds_read_b128 v[184:187], v3 offset:5120
    ds_read_b128 v[188:191], v3 offset:5632
    ds_read_b32 v232, v6 offset:4096
    ds_read_b32 v234, v6 offset:4160
    ds_read_b32 v236, v6 offset:4608
    ds_read_b32 v238, v6 offset:4672
    v_max3_f32 v248, v48, v49, v50
    v_max3_f32 v248, v248, v51, v52
    v_max3_f32 v249, v53, v54, v55
    s_waitcnt lgkmcnt(4)
    v_mfma_f32_16x16x32_bf16 v[56:59], v[176:179], v[192:195], 0
    v_mfma_f32_16x16x32_bf16 v[56:59], v[180:183], v[196:199], v[56:59]
    v_mfma_f32_16x16x32_bf16 v[56:59], v[184:187], v[200:203], v[56:59]
    v_mfma_f32_16x16x32_bf16 v[56:59], v[188:191], v[204:207], v[56:59]
    s_nop 7
    v_max3_f32 v248, v248, v56, v57
    v_max_f32 v30, v248, v249
    v_max_f32 v249, v248, v249
    s_nop 1
    v_permlane16_swap_b32 v249, v30
    v_max_f32 v248, v249, v30
    v_max_f32 v249, v249, v30
    s_nop 1
    v_permlane32_swap_b32 v248, v249
    v_max_f32 v248, v248, v249
    v_mul_f32 v248, s45, v248
    v_fma_f32 v60, v48, s45, -v248
    v_fma_f32 v61, v49, s45, -v248
    v_fma_f32 v62, v50, s45, -v248
    v_fma_f32 v63, v51, s45, -v248
    v_fma_f32 v242, v52, s45, -v248
    v_fma_f32 v243, v53, s45, -v248
    v_fma_f32 v244, v54, s45, -v248
    v_fma_f32 v245, v55, s45, -v248
    v_fma_f32 v246, v56, s45, -v248
    v_fma_f32 v247, v57, s45, -v248
    v_exp_f32 v60, v60
    v_exp_f32 v61, v61
    v_exp_f32 v62, v62
    v_exp_f32 v63, v63
    v_exp_f32 v242, v242
    v_exp_f32 v243, v243
    v_exp_f32 v244, v244
    v_exp_f32 v245, v245
    v_exp_f32 v246, v246
    v_exp_f32 v247, v247
    v_cvt_pk_bf16_f32 v48, v60, v61
    v_cvt_pk_bf16_f32 v49, v62, v63
    v_cvt_pk_bf16_f32 v50, v242, v243
    v_cvt_pk_bf16_f32 v51, v244, v245
    v_cvt_pk_bf16_f32 v40, v246, v247
    s_waitcnt lgkmcnt(0)
    v_mfma_f32_16x16x32_bf16 v[52:55], v[44:47], v[48:51], 0
    v_mfma_f32_16x16x32_bf16 v[52:55], v[44:47], v[40:43], v[52:55]
    v_mfma_f32_16x16x32_bf16 v[192:195], v[160:163], v[48:51], 0
    v_mfma_f32_16x16x32_bf16 v[192:195], v[232:235], v[40:43], v[192:195]
    v_mfma_f32_16x16x32_bf16 v[196:199], v[164:167], v[48:51], 0
    v_mfma_f32_16x16x32_bf16 v[196:199], v[234:237], v[40:43], v[196:199]
    v_mfma_f32_16x16x32_bf16 v[200:203], v[168:171], v[48:51], 0
    v_mfma_f32_16x16x32_bf16 v[200:203], v[236:239], v[40:43], v[200:203]
    v_mfma_f32_16x16x32_bf16 v[204:207], v[172:175], v[48:51], 0
    v_mfma_f32_16x16x32_bf16 v[204:207], v[238:241], v[40:43], v[204:207]
    v_rcp_f32 v248, v52
    s_nop 0
    v_mul_f32 v192, v248, v192
    v_mul_f32 v193, v248, v193
    v_mul_f32 v194, v248, v194
    v_mul_f32 v195, v248, v195
    v_cvt_pk_bf16_f32 v224, v192, v193
    v_cvt_pk_bf16_f32 v225, v194, v195
    v_mul_f32 v196, v248, v196
    v_mul_f32 v197, v248, v197
    v_mul_f32 v198, v248, v198
    v_mul_f32 v199, v248, v199
    v_cvt_pk_bf16_f32 v226, v196, v197
    v_cvt_pk_bf16_f32 v227, v198, v199
    s_cbranch_vccnz .cp_483
    buffer_store_dwordx4 v[224:227], v2, s[8:11], s53 offen offset:0
.cb_484:
    v_mul_f32 v200, v248, v200
    v_mul_f32 v201, v248, v201
    v_mul_f32 v202, v248, v202
    v_mul_f32 v203, v248, v203
    v_cvt_pk_bf16_f32 v228, v200, v201
    v_cvt_pk_bf16_f32 v229, v202, v203
    v_mul_f32 v204, v248, v204
    v_mul_f32 v205, v248, v205
    v_mul_f32 v206, v248, v206
    v_mul_f32 v207, v248, v207
    v_cvt_pk_bf16_f32 v230, v204, v205
    v_cvt_pk_bf16_f32 v231, v206, v207
    s_cbranch_vccnz .cp_485
    buffer_store_dwordx4 v[228:231], v2, s[8:11], s53 offen offset:1024
.cb_486:
    buffer_load_dword v4, v7, s[8:11], 0 offen sc1
    s_add_u32 s30, s30, 1
    s_mov_b32 s53, s40
    s_waitcnt vmcnt(1)
    v_max_i32 v27, s30, v26
    s_cbranch_vccnz .cp_489
    buffer_store_dword v27, v26, s[8:11], s94 offen
.cb_490:
    v_add_u32 v25, 32768, v25
    v_add_u32 v31, 32768, v31
    v_add_u32 v5, 32768, v5
    s_add_u32 s48, s48, 0x20000
    s_mov_b32 s31, 0
    s_add_u32 s40, s40, 0x40000
    ds_read_b128 v[208:211], v25 offset:0
    ds_read_b128 v[128:131], v31 offset:0
    ds_read_b128 v[144:147], v31 offset:4096
    ds_read_b128 v[212:215], v25 offset:1024
    ds_read_b128 v[132:135], v31 offset:1024
    ds_read_b128 v[148:151], v31 offset:5120
    ds_read_b128 v[216:219], v25 offset:2048
    ds_read_b128 v[136:139], v31 offset:2048
    ds_read_b128 v[152:155], v31 offset:6144
    ds_read_b128 v[220:223], v25 offset:3072
    ds_read_b128 v[140:143], v31 offset:3072
    ds_read_b128 v[156:159], v31 offset:7168
    ds_read_b128 v[160:163], v5 offset:8192
    ds_read_b128 v[164:167], v5 offset:9216
    ds_read_b128 v[168:171], v5 offset:10240
    ds_read_b128 v[172:175], v5 offset:11264
    s_waitcnt lgkmcnt(4)
    v_mfma_f32_16x16x32_bf16 v[48:51], v[128:131], v[208:211], v[32:35]
    v_mfma_f32_16x16x32_bf16 v[52:55], v[144:147], v[208:211], v[36:39]
    v_mfma_f32_16x16x32_bf16 v[48:51], v[132:135], v[212:215], v[48:51]
    v_mfma_f32_16x16x32_bf16 v[52:55], v[148:151], v[212:215], v[52:55]
    v_mfma_f32_16x16x32_bf16 v[48:51], v[136:139], v[216:219], v[48:51]
    v_mfma_f32_16x16x32_bf16 v[52:55], v[152:155], v[216:219], v[52:55]
    v_mfma_f32_16x16x32_bf16 v[48:51], v[140:143], v[220:223], v[48:51]
    v_mfma_f32_16x16x32_bf16 v[52:55], v[156:159], v[220:223], v[52:55]
    s_waitcnt vmcnt(1)
    v_min_u32_dpp v4, v4, v4 quad_perm:[1,0,3,2] row_mask:0xf bank_mask:0xf
    s_nop 1
    v_min_u32_dpp v4, v4, v4 quad_perm:[2,3,0,1] row_mask:0xf bank_mask:0xf
    s_nop 1
    v_readfirstlane_b32 s33, v4
    s_cmp_eq_u32 s31, 0
    s_cbranch_scc1 .cp_500
.cb_501:
    s_waitcnt vmcnt(0)
    s_barrier
    ds_read_b128 v[176:179], v3 offset:0
    ds_read_b128 v[180:183], v3 offset:512
    ds_read_b128 v[184:187], v3 offset:1024
    ds_read_b128 v[188:191], v3 offset:1536
    ds_read_b32 v232, v6 offset:0
    ds_read_b32 v234, v6 offset:64
    ds_read_b32 v236, v6 offset:512
    ds_read_b32 v238, v6 offset:576
    v_max3_f32 v248, v48, v49, v50
    v_max3_f32 v248, v248, v51, v52
    v_max3_f32 v249, v53, v54, v55
    s_waitcnt lgkmcnt(4)
    v_mfma_f32_16x16x32_bf16 v[56:59], v[176:179], v[208:211], 0
    v_mfma_f32_16x16x32_bf16 v[56:59], v[180:183], v[212:215], v[56:59]
    v_mfma_f32_16x16x32_bf16 v[56:59], v[184:187], v[216:219], v[56:59]
    v_mfma_f32_16x16x32_bf16 v[56:59], v[188:191], v[220:223], v[56:59]
    s_nop 7
    v_max3_f32 v248, v248, v56, v57
    v_max_f32 v30, v248, v249
    v_max_f32 v249, v248, v249
    s_nop 1
    v_permlane16_swap_b32 v249, v30
    v_max_f32 v248, v249, v30
    v_max_f32 v249, v249, v30
    s_nop 1
    v_permlane32_swap_b32 v248, v249
    v_max_f32 v248, v248, v249
    v_mul_f32 v248, s45, v248
    v_fma_f32 v60, v48, s45, -v248
    v_fma_f32 v61, v49, s45, -v248
    v_fma_f32 v62, v50, s45, -v248
    v_fma_f32 v63, v51, s45, -v248
    v_fma_f32 v242, v52, s45, -v248
    v_fma_f32 v243, v53, s45, -v248
    v_fma_f32 v244, v54, s45, -v248
    v_fma_f32 v245, v55, s45, -v248
    v_fma_f32 v246, v56, s45, -v248
    v_fma_f32 v247, v57, s45, -v248
    v_exp_f32 v60, v60
    v_exp_f32 v61, v61
    v_exp_f32 v62, v62
    v_exp_f32 v63, v63
    v_exp_f32 v242, v242
    v_exp_f32 v243, v243
    v_exp_f32 v244, v244
    v_exp_f32 v245, v245
    v_exp_f32 v246, v246
    v_exp_f32 v247, v247
    v_cvt_pk_bf16_f32 v48, v60, v61
    v_cvt_pk_bf16_f32 v49, v62, v63
    v_cvt_pk_bf16_f32 v50, v242, v243
    v_cvt_pk_bf16_f32 v51, v244, v245
    v_cvt_pk_bf16_f32 v40, v246, v247
    s_waitcnt lgkmcnt(0)
    v_mfma_f32_16x16x32_bf16 v[52:55], v[44:47], v[48:51], 0
    v_mfma_f32_16x16x32_bf16 v[52:55], v[44:47], v[40:43], v[52:55]
    v_mfma_f32_16x16x32_bf16 v[208:211], v[160:163], v[48:51], 0
    v_mfma_f32_16x16x32_bf16 v[208:211], v[232:235], v[40:43], v[208:211]
    v_mfma_f32_16x16x32_bf16 v[212:215], v[164:167], v[48:51], 0
    v_mfma_f32_16x16x32_bf16 v[212:215], v[234:237], v[40:43], v[212:215]
    v_mfma_f32_16x16x32_bf16 v[216:219], v[168:171], v[48:51], 0
    v_mfma_f32_16x16x32_bf16 v[216:219], v[236:239], v[40:43], v[216:219]
    v_mfma_f32_16x16x32_bf16 v[220:223], v[172:175], v[48:51], 0
    v_mfma_f32_16x16x32_bf16 v[220:223], v[238:241], v[40:43], v[220:223]
    v_rcp_f32 v248, v52
    s_nop 0
    v_mul_f32 v208, v248, v208
    v_mul_f32 v209, v248, v209
    v_mul_f32 v210, v248, v210
    v_mul_f32 v211, v248, v211
    v_cvt_pk_bf16_f32 v224, v208, v209
    v_cvt_pk_bf16_f32 v225, v210, v211
    v_mul_f32 v212, v248, v212
    v_mul_f32 v213, v248, v213
    v_mul_f32 v214, v248, v214
    v_mul_f32 v215, v248, v215
    v_cvt_pk_bf16_f32 v226, v212, v213
    v_cvt_pk_bf16_f32 v227, v214, v215
    s_cbranch_vccnz .cp_496
    buffer_store_dwordx4 v[224:227], v2, s[8:11], s53 offen offset:0
.cb_497:
    v_mul_f32 v216, v248, v216
    v_mul_f32 v217, v248, v217
    v_mul_f32 v218, v248, v218
    v_mul_f32 v219, v248, v219
    v_cvt_pk_bf16_f32 v228, v216, v217
    v_cvt_pk_bf16_f32 v229, v218, v219
    v_mul_f32 v220, v248, v220
    v_mul_f32 v221, v248, v221
    v_mul_f32 v222, v248, v222
    v_mul_f32 v223, v248, v223
    v_cvt_pk_bf16_f32 v230, v220, v221
    v_cvt_pk_bf16_f32 v231, v222, v223
    s_cbranch_vccnz .cp_498
    buffer_store_dwordx4 v[228:231], v2, s[8:11], s53 offen offset:1024
.cb_499:
    s_add_u32 s30, s30, 1
    s_mov_b32 s53, s40
    s_waitcnt vmcnt(0)
    v_max_i32 v27, s30, v26
    s_cbranch_vccnz .cp_502
    buffer_store_dword v27, v26, s[8:11], s94 offen
.cb_503:
    s_endpgm
.cp_434:
    buffer_store_dwordx4 v[224:227], v2, s[8:11], s53 offen offset:0 sc1
    s_branch .cb_435
.cp_436:
    buffer_store_dwordx4 v[228:231], v2, s[8:11], s53 offen offset:1024 sc1
    s_branch .cb_437
.cp_438:
    buffer_store_dword v27, v26, s[8:11], s94 offen sc1
    s_branch .cb_439
.cp_440:
    s_cmp_gt_u32 s32, s42
    s_cbranch_scc1 .ndd_505
    s_mov_b32 s62, 0
.nd_504:
    buffer_load_dword v29, v7, s[8:11], s46 offen sc1
    buffer_load_dword v30, v7, s[8:11], s47 offen sc1
    s_add_u32 s62, s62, 1
    s_cmp_gt_u32 s62, 0x200000
    s_cbranch_scc1 .mg_end_1
    s_waitcnt vmcnt(0)
    v_min_u32 v29, v29, v30
    s_nop 1
    v_min_u32_dpp v29, v29, v29 quad_perm:[1,0,3,2] row_mask:0xf bank_mask:0xf
    s_nop 1
    v_min_u32_dpp v29, v29, v29 quad_perm:[2,3,0,1] row_mask:0xf bank_mask:0xf
    s_nop 1
    v_readfirstlane_b32 s32, v29
    s_lshl_b32 s55, s32, 18
    s_add_u32 s55, s55, s37
    s_cmp_gt_u32 s32, s42
    s_cbranch_scc1 .ndd_505
    s_sleep 2
    s_branch .nd_504
.ndd_505:
    s_branch .cb_441
.cp_442:
    s_cmp_gt_u32 s33, s30
    s_cbranch_scc1 .ndd_507
    s_mov_b32 s62, 0
.nd_506:
    buffer_load_dword v4, v7, s[8:11], 0 offen sc1
    s_add_u32 s62, s62, 1
    s_cmp_gt_u32 s62, 0x200000
    s_cbranch_scc1 .mg_end_1
    s_waitcnt vmcnt(0)
    v_min_u32_dpp v4, v4, v4 quad_perm:[1,0,3,2] row_mask:0xf bank_mask:0xf
    s_nop 1
    v_min_u32_dpp v4, v4, v4 quad_perm:[2,3,0,1] row_mask:0xf bank_mask:0xf
    s_nop 1
    v_readfirstlane_b32 s33, v4
    s_cmp_gt_u32 s33, s30
    s_cbranch_scc1 .ndd_507
    s_sleep 2
    s_branch .nd_506
.ndd_507:
    s_add_u32 m0, s52, 0
    s_nop 0
    buffer_load_dwordx4 v2, s[8:11], s48 offen lds
    s_waitcnt vmcnt(0)
    s_branch .cb_443
.cp_446:
    s_cmp_gt_u32 s33, s42
    s_cbranch_scc0 .cb_447
    s_mov_b32 s31, 1
    s_add_u32 m0, s52, 4096
    s_nop 0
    buffer_load_dwordx4 v2, s[8:11], s48 offen lds
    s_branch .cb_447
.cp_448:
    buffer_store_dwordx4 v[224:227], v2, s[8:11], s53 offen offset:0 sc1
    s_branch .cb_449
.cp_450:
    buffer_store_dwordx4 v[228:231], v2, s[8:11], s53 offen offset:1024 sc1
    s_branch .cb_451
.cp_452:
    buffer_store_dword v27, v26, s[8:11], s94 offen sc1
    s_branch .cb_453
.cp_454:
    s_cmp_gt_u32 s32, s42
    s_cbranch_scc1 .ndd_509
    s_mov_b32 s62, 0
.nd_508:
    buffer_load_dword v29, v7, s[8:11], s46 offen sc1
    buffer_load_dword v30, v7, s[8:11], s47 offen sc1
    s_add_u32 s62, s62, 1
    s_cmp_gt_u32 s62, 0x200000
    s_cbranch_scc1 .mg_end_1
    s_waitcnt vmcnt(0)
    v_min_u32 v29, v29, v30
    s_nop 1
    v_min_u32_dpp v29, v29, v29 quad_perm:[1,0,3,2] row_mask:0xf bank_mask:0xf
    s_nop 1
    v_min_u32_dpp v29, v29, v29 quad_perm:[2,3,0,1] row_mask:0xf bank_mask:0xf
    s_nop 1
    v_readfirstlane_b32 s32, v29
    s_lshl_b32 s55, s32, 18
    s_add_u32 s55, s55, s37
    s_cmp_gt_u32 s32, s42
    s_cbranch_scc1 .ndd_509
    s_sleep 2
    s_branch .nd_508
.ndd_509:
    s_branch .cb_455
.cp_456:
    s_cmp_gt_u32 s33, s30
    s_cbranch_scc1 .ndd_511
    s_mov_b32 s62, 0
.nd_510:
    buffer_load_dword v4, v7, s[8:11], 0 offen sc1
    s_add_u32 s62, s62, 1
    s_cmp_gt_u32 s62, 0x200000
    s_cbranch_scc1 .mg_end_1
    s_waitcnt vmcnt(0)
    v_min_u32_dpp v4, v4, v4 quad_perm:[1,0,3,2] row_mask:0xf bank_mask:0xf
    s_nop 1
    v_min_u32_dpp v4, v4, v4 quad_perm:[2,3,0,1] row_mask:0xf bank_mask:0xf
    s_nop 1
    v_readfirstlane_b32 s33, v4
    s_cmp_gt_u32 s33, s30
    s_cbranch_scc1 .ndd_511
    s_sleep 2
    s_branch .nd_510
.ndd_511:
    s_add_u32 m0, s52, 4096
    s_nop 0
    buffer_load_dwordx4 v2, s[8:11], s48 offen lds
    s_waitcnt vmcnt(0)
    s_branch .cb_457
.cp_460:
    s_cmp_gt_u32 s33, s42
    s_cbranch_scc0 .cb_461
    s_mov_b32 s31, 1
    s_add_u32 m0, s52, 0
    s_nop 0
    buffer_load_dwordx4 v2, s[8:11], s48 offen lds
    s_branch .cb_461
.cp_462:
    buffer_store_dword v27, v26, s[8:11], s94 offen sc1
    s_branch .cb_463
.cp_468:
    buffer_store_dwordx4 v[224:227], v2, s[8:11], s53 offen offset:0 sc1
    s_branch .cb_469
.cp_470:
    buffer_store_dwordx4 v[228:231], v2, s[8:11], s53 offen offset:1024 sc1
    s_branch .cb_471
.cp_472:
    s_cmp_gt_u32 s33, s30
    s_cbranch_scc1 .ndd_513
    s_mov_b32 s62, 0
.nd_512:
    buffer_load_dword v4, v7, s[8:11], 0 offen sc1
    s_add_u32 s62, s62, 1
    s_cmp_gt_u32 s62, 0x200000
    s_cbranch_scc1 .mg_end_1
    s_waitcnt vmcnt(0)
    v_min_u32_dpp v4, v4, v4 quad_perm:[1,0,3,2] row_mask:0xf bank_mask:0xf
    s_nop 1
    v_min_u32_dpp v4, v4, v4 quad_perm:[2,3,0,1] row_mask:0xf bank_mask:0xf
    s_nop 1
    v_readfirstlane_b32 s33, v4
    s_cmp_gt_u32 s33, s30
    s_cbranch_scc1 .ndd_513
    s_sleep 2
    s_branch .nd_512
.ndd_513:
    s_add_u32 m0, s52, 0
    s_nop 0
    buffer_load_dwordx4 v2, s[8:11], s48 offen lds
    s_waitcnt vmcnt(0)
    s_branch .cb_473
.cp_474:
    buffer_store_dword v27, v26, s[8:11], s94 offen sc1
    s_branch .cb_475
.cp_483:
    buffer_store_dwordx4 v[224:227], v2, s[8:11], s53 offen offset:0 sc1
    s_branch .cb_484
.cp_485:
    buffer_store_dwordx4 v[228:231], v2, s[8:11], s53 offen offset:1024 sc1
    s_branch .cb_486
.cp_487:
    s_cmp_gt_u32 s33, s30
    s_cbranch_scc1 .ndd_515
    s_mov_b32 s62, 0
.nd_514:
    buffer_load_dword v4, v7, s[8:11], 0 offen sc1
    s_add_u32 s62, s62, 1
    s_cmp_gt_u32 s62, 0x200000
    s_cbranch_scc1 .mg_end_1
    s_waitcnt vmcnt(0)
    v_min_u32_dpp v4, v4, v4 quad_perm:[1,0,3,2] row_mask:0xf bank_mask:0xf
    s_nop 1
    v_min_u32_dpp v4, v4, v4 quad_perm:[2,3,0,1] row_mask:0xf bank_mask:0xf
    s_nop 1
    v_readfirstlane_b32 s33, v4
    s_cmp_gt_u32 s33, s30
    s_cbranch_scc1 .ndd_515
    s_sleep 2
    s_branch .nd_514
.ndd_515:
    s_add_u32 m0, s52, 4096
    s_nop 0
    buffer_load_dwordx4 v2, s[8:11], s48 offen lds
    s_waitcnt vmcnt(0)
    s_branch .cb_488
.cp_489:
    buffer_store_dword v27, v26, s[8:11], s94 offen sc1
    s_branch .cb_490
.cp_496:
    buffer_store_dwordx4 v[224:227], v2, s[8:11], s53 offen offset:0 sc1
    s_branch .cb_497
.cp_498:
    buffer_store_dwordx4 v[228:231], v2, s[8:11], s53 offen offset:1024 sc1
    s_branch .cb_499
.cp_500:
    s_cmp_gt_u32 s33, s30
    s_cbranch_scc1 .ndd_517
    s_mov_b32 s62, 0
.nd_516:
    buffer_load_dword v4, v7, s[8:11], 0 offen sc1
    s_add_u32 s62, s62, 1
    s_cmp_gt_u32 s62, 0x200000
    s_cbranch_scc1 .mg_end_1
    s_waitcnt vmcnt(0)
    v_min_u32_dpp v4, v4, v4 quad_perm:[1,0,3,2] row_mask:0xf bank_mask:0xf
    s_nop 1
    v_min_u32_dpp v4, v4, v4 quad_perm:[2,3,0,1] row_mask:0xf bank_mask:0xf
    s_nop 1
    v_readfirstlane_b32 s33, v4
    s_cmp_gt_u32 s33, s30
    s_cbranch_scc1 .ndd_517
    s_sleep 2
    s_branch .nd_516
.ndd_517:
    s_add_u32 m0, s52, 0
    s_nop 0
    buffer_load_dwordx4 v2, s[8:11], s48 offen lds
    s_waitcnt vmcnt(0)
    s_branch .cb_501
.cp_502:
    buffer_store_dword v27, v26, s[8:11], s94 offen sc1
    s_branch .cb_503
.ph2_386:
    s_load_dwordx2 s[42:43], s[0:1], 88
    s_lshr_b32 s34, s99, 3
    s_and_b32 s35, s99, 7
    s_lshl_b32 s4, s34, 21
    s_lshl_b32 s5, s35, 8
    s_add_u32 s4, s4, s5
    s_lshl_b32 s6, s24, 14
    s_mul_i32 s5, s24, 131072
    s_add_u32 s4, s4, s5
    v_bfe_u32 v2, v1, 4, 1
    v_lshlrev_b32 v2, 2, v2
    v_and_b32 v3, 7, v1
    v_xor_b32 v2, v2, v3
    v_lshlrev_b32 v2, 4, v2
    v_bfe_u32 v254, v1, 3, 2
    v_mul_u32_u24 v240, 2048, v254
    v_bfe_u32 v254, v1, 5, 1
    v_mul_u32_u24 v254, 128, v254
    v_add_u32 v240, v240, v254
    v_add_u32 v240, s4, v240
    v_add_u32 v240, v2, v240
    s_lshr_b32 s5, s24, 1
    s_lshl_b32 s5, s5, 9
    v_bfe_u32 v2, v1, 3, 1
    v_xor_b32 v2, s24, v2
    v_and_b32 v2, 1, v2
    v_lshlrev_b32 v2, 6, v2
    v_bfe_u32 v254, v1, 4, 2
    v_mul_u32_u24 v242, 2048, v254
    v_bfe_u32 v254, v1, 2, 2
    v_mul_u32_u24 v254, 128, v254
    v_add_u32 v242, v242, v254
    v_bfe_u32 v254, v1, 0, 2
    v_mul_u32_u24 v254, 16, v254
    v_add_u32 v242, v242, v254
    v_add_u32 v242, s5, v242
    v_add_u32 v242, v2, v242
    v_add_u32 v243, 0x10000, v242
    s_waitcnt lgkmcnt(0)
    s_mov_b32 s16, s42
    s_and_b32 s17, s43, 0xffff
    s_mov_b32 s18, 0x800000
    s_mov_b32 s19, 0x00020000
    s_add_u32 m0, s6, 0
    s_mov_b32 s5, 0
    buffer_load_dwordx4 v240, s[16:19], s5 offen nt lds
    s_add_u32 m0, s6, 1024
    s_mov_b32 s5, 8192
    buffer_load_dwordx4 v240, s[16:19], s5 offen nt lds
    s_add_u32 m0, s6, 2048
    s_mov_b32 s5, 16384
    buffer_load_dwordx4 v240, s[16:19], s5 offen nt lds
    s_add_u32 m0, s6, 3072
    s_mov_b32 s5, 24576
    buffer_load_dwordx4 v240, s[16:19], s5 offen nt lds
    s_add_u32 m0, s6, 4096
    s_mov_b32 s5, 32768
    buffer_load_dwordx4 v240, s[16:19], s5 offen nt lds
    s_add_u32 m0, s6, 5120
    s_mov_b32 s5, 40960
    buffer_load_dwordx4 v240, s[16:19], s5 offen nt lds
    s_add_u32 m0, s6, 6144
    s_mov_b32 s5, 49152
    buffer_load_dwordx4 v240, s[16:19], s5 offen nt lds
    s_add_u32 m0, s6, 7168
    s_mov_b32 s5, 57344
    buffer_load_dwordx4 v240, s[16:19], s5 offen nt lds
    s_add_u32 m0, s6, 8192
    s_mov_b32 s5, 65536
    buffer_load_dwordx4 v240, s[16:19], s5 offen nt lds
    s_add_u32 m0, s6, 9216
    s_mov_b32 s5, 73728
    buffer_load_dwordx4 v240, s[16:19], s5 offen nt lds
    s_add_u32 m0, s6, 10240
    s_mov_b32 s5, 81920
    buffer_load_dwordx4 v240, s[16:19], s5 offen nt lds
    s_add_u32 m0, s6, 11264
    s_mov_b32 s5, 90112
    buffer_load_dwordx4 v240, s[16:19], s5 offen nt lds
    s_add_u32 m0, s6, 12288
    s_mov_b32 s5, 98304
    buffer_load_dwordx4 v240, s[16:19], s5 offen nt lds
    s_add_u32 m0, s6, 13312
    s_mov_b32 s5, 106496
    buffer_load_dwordx4 v240, s[16:19], s5 offen nt lds
    s_add_u32 m0, s6, 14336
    s_mov_b32 s5, 114688
    buffer_load_dwordx4 v240, s[16:19], s5 offen nt lds
    s_add_u32 m0, s6, 15360
    s_mov_b32 s5, 122880
    buffer_load_dwordx4 v240, s[16:19], s5 offen nt lds
    s_add_u32 m0, s6, 65536
    s_mov_b32 s5, 524288
    buffer_load_dwordx4 v240, s[16:19], s5 offen nt lds
    s_add_u32 m0, s6, 66560
    s_mov_b32 s5, 532480
    buffer_load_dwordx4 v240, s[16:19], s5 offen nt lds
    s_add_u32 m0, s6, 67584
    s_mov_b32 s5, 540672
    buffer_load_dwordx4 v240, s[16:19], s5 offen nt lds
    s_add_u32 m0, s6, 68608
    s_mov_b32 s5, 548864
    buffer_load_dwordx4 v240, s[16:19], s5 offen nt lds
    s_add_u32 m0, s6, 69632
    s_mov_b32 s5, 557056
    buffer_load_dwordx4 v240, s[16:19], s5 offen nt lds
    s_add_u32 m0, s6, 70656
    s_mov_b32 s5, 565248
    buffer_load_dwordx4 v240, s[16:19], s5 offen nt lds
    s_add_u32 m0, s6, 71680
    s_mov_b32 s5, 573440
    buffer_load_dwordx4 v240, s[16:19], s5 offen nt lds
    s_add_u32 m0, s6, 72704
    s_mov_b32 s5, 581632
    buffer_load_dwordx4 v240, s[16:19], s5 offen nt lds
    s_add_u32 m0, s6, 73728
    s_mov_b32 s5, 589824
    buffer_load_dwordx4 v240, s[16:19], s5 offen nt lds
    s_add_u32 m0, s6, 74752
    s_mov_b32 s5, 598016
    buffer_load_dwordx4 v240, s[16:19], s5 offen nt lds
    s_add_u32 m0, s6, 75776
    s_mov_b32 s5, 606208
    buffer_load_dwordx4 v240, s[16:19], s5 offen nt lds
    s_add_u32 m0, s6, 76800
    s_mov_b32 s5, 614400
    buffer_load_dwordx4 v240, s[16:19], s5 offen nt lds
    s_add_u32 m0, s6, 77824
    s_mov_b32 s5, 622592
    buffer_load_dwordx4 v240, s[16:19], s5 offen nt lds
    s_add_u32 m0, s6, 78848
    s_mov_b32 s5, 630784
    buffer_load_dwordx4 v240, s[16:19], s5 offen nt lds
    s_add_u32 m0, s6, 79872
    s_mov_b32 s5, 638976
    buffer_load_dwordx4 v240, s[16:19], s5 offen nt lds
    s_add_u32 m0, s6, 80896
    s_mov_b32 s5, 647168
    buffer_load_dwordx4 v240, s[16:19], s5 offen nt lds
    v_lshlrev_b32 v2, 4, v1
    v_mov_b32 v8, v2
    s_lshl_b32 s36, s24, 12
    s_lshl_b32 s4, s34, 16
    s_add_u32 s4, s4, s36
    v_add_u32 v9, s4, v2
    s_lshl_b32 s4, s34, 10
    s_add_u32 s4, s4, 92340224
    v_bfe_u32 v254, v1, 0, 3
    v_mul_u32_u24 v7, 128, v254
    v_add_u32 v7, s4, v7
    s_lshl_b32 s4, s35, 2
    s_add_u32 s4, s4, s24
    s_lshl_b32 s5, s4, 9
    s_lshl_b32 s94, s34, 7
    s_add_u32 s94, s94, s5
    s_add_u32 s94, s94, 92323840
    s_lshl_b32 s38, s4, 1
    s_and_b32 s5, s34, 1
    s_or_b32 s38, s38, s5
    s_lshl_b32 s4, s35, 22
    s_lshl_b32 s37, s34, 20
    s_add_u32 s37, s37, s4
    s_lshl_b32 s4, s24, 18
    s_add_u32 s37, s37, s4
    s_add_u32 s37, s37, 150994944
    s_mov_b32 s29, 16777216
    s_mov_b32 s28, 0
    s_mov_b32 s33, 0
    s_mov_b32 s39, 0
    v_mov_b32 v26, 0
    s_waitcnt vmcnt(16)
    s_barrier
    ds_read_b64_tr_b16 a[0:1], v242 offset:0
    ds_read_b64_tr_b16 a[2:3], v242 offset:1024
    ds_read_b64_tr_b16 a[4:5], v242 offset:8
    ds_read_b64_tr_b16 a[6:7], v242 offset:1032
    ds_read_b64_tr_b16 a[8:9], v242 offset:8192
    ds_read_b64_tr_b16 a[10:11], v242 offset:9216
    ds_read_b64_tr_b16 a[12:13], v242 offset:8200
    ds_read_b64_tr_b16 a[14:15], v242 offset:9224
    ds_read_b64_tr_b16 a[16:17], v242 offset:16384
    ds_read_b64_tr_b16 a[18:19], v242 offset:17408
    ds_read_b64_tr_b16 a[20:21], v242 offset:16392
    ds_read_b64_tr_b16 a[22:23], v242 offset:17416
    ds_read_b64_tr_b16 a[24:25], v242 offset:24576
    ds_read_b64_tr_b16 a[26:27], v242 offset:25600
    ds_read_b64_tr_b16 a[28:29], v242 offset:24584
    ds_read_b64_tr_b16 a[30:31], v242 offset:25608
    ds_read_b64_tr_b16 a[32:33], v242 offset:32768
    ds_read_b64_tr_b16 a[34:35], v242 offset:33792
    ds_read_b64_tr_b16 a[36:37], v242 offset:32776
    ds_read_b64_tr_b16 a[38:39], v242 offset:33800
    ds_read_b64_tr_b16 a[40:41], v242 offset:40960
    ds_read_b64_tr_b16 a[42:43], v242 offset:41984
    ds_read_b64_tr_b16 a[44:45], v242 offset:40968
    ds_read_b64_tr_b16 a[46:47], v242 offset:41992
    ds_read_b64_tr_b16 a[48:49], v242 offset:49152
    ds_read_b64_tr_b16 a[50:51], v242 offset:50176
    ds_read_b64_tr_b16 a[52:53], v242 offset:49160
    ds_read_b64_tr_b16 a[54:55], v242 offset:50184
    ds_read_b64_tr_b16 a[56:57], v242 offset:57344
    ds_read_b64_tr_b16 a[58:59], v242 offset:58368
    ds_read_b64_tr_b16 a[60:61], v242 offset:57352
    ds_read_b64_tr_b16 a[62:63], v242 offset:58376
    s_waitcnt lgkmcnt(0)
    s_barrier
    s_add_u32 m0, s6, 0
    s_mov_b32 s5, 1048576
    buffer_load_dwordx4 v240, s[16:19], s5 offen nt lds
    s_add_u32 m0, s6, 1024
    s_mov_b32 s5, 1056768
    buffer_load_dwordx4 v240, s[16:19], s5 offen nt lds
    s_add_u32 m0, s6, 2048
    s_mov_b32 s5, 1064960
    buffer_load_dwordx4 v240, s[16:19], s5 offen nt lds
    s_add_u32 m0, s6, 3072
    s_mov_b32 s5, 1073152
    buffer_load_dwordx4 v240, s[16:19], s5 offen nt lds
    s_add_u32 m0, s6, 4096
    s_mov_b32 s5, 1081344
    buffer_load_dwordx4 v240, s[16:19], s5 offen nt lds
    s_add_u32 m0, s6, 5120
    s_mov_b32 s5, 1089536
    buffer_load_dwordx4 v240, s[16:19], s5 offen nt lds
    s_add_u32 m0, s6, 6144
    s_mov_b32 s5, 1097728
    buffer_load_dwordx4 v240, s[16:19], s5 offen nt lds
    s_add_u32 m0, s6, 7168
    s_mov_b32 s5, 1105920
    buffer_load_dwordx4 v240, s[16:19], s5 offen nt lds
    s_add_u32 m0, s6, 8192
    s_mov_b32 s5, 1114112
    buffer_load_dwordx4 v240, s[16:19], s5 offen nt lds
    s_add_u32 m0, s6, 9216
    s_mov_b32 s5, 1122304
    buffer_load_dwordx4 v240, s[16:19], s5 offen nt lds
    s_add_u32 m0, s6, 10240
    s_mov_b32 s5, 1130496
    buffer_load_dwordx4 v240, s[16:19], s5 offen nt lds
    s_add_u32 m0, s6, 11264
    s_mov_b32 s5, 1138688
    buffer_load_dwordx4 v240, s[16:19], s5 offen nt lds
    s_add_u32 m0, s6, 12288
    s_mov_b32 s5, 1146880
    buffer_load_dwordx4 v240, s[16:19], s5 offen nt lds
    s_add_u32 m0, s6, 13312
    s_mov_b32 s5, 1155072
    buffer_load_dwordx4 v240, s[16:19], s5 offen nt lds
    s_add_u32 m0, s6, 14336
    s_mov_b32 s5, 1163264
    buffer_load_dwordx4 v240, s[16:19], s5 offen nt lds
    s_add_u32 m0, s6, 15360
    s_mov_b32 s5, 1171456
    buffer_load_dwordx4 v240, s[16:19], s5 offen nt lds
    s_waitcnt vmcnt(16)
    s_barrier
    ds_read_b64_tr_b16 a[64:65], v243 offset:0
    ds_read_b64_tr_b16 a[66:67], v243 offset:1024
    ds_read_b64_tr_b16 a[68:69], v243 offset:8
    ds_read_b64_tr_b16 a[70:71], v243 offset:1032
    ds_read_b64_tr_b16 a[72:73], v243 offset:8192
    ds_read_b64_tr_b16 a[74:75], v243 offset:9216
    ds_read_b64_tr_b16 a[76:77], v243 offset:8200
    ds_read_b64_tr_b16 a[78:79], v243 offset:9224
    ds_read_b64_tr_b16 a[80:81], v243 offset:16384
    ds_read_b64_tr_b16 a[82:83], v243 offset:17408
    ds_read_b64_tr_b16 a[84:85], v243 offset:16392
    ds_read_b64_tr_b16 a[86:87], v243 offset:17416
    ds_read_b64_tr_b16 a[88:89], v243 offset:24576
    ds_read_b64_tr_b16 a[90:91], v243 offset:25600
    ds_read_b64_tr_b16 a[92:93], v243 offset:24584
    ds_read_b64_tr_b16 a[94:95], v243 offset:25608
    ds_read_b64_tr_b16 a[96:97], v243 offset:32768
    ds_read_b64_tr_b16 a[98:99], v243 offset:33792
    ds_read_b64_tr_b16 a[100:101], v243 offset:32776
    ds_read_b64_tr_b16 a[102:103], v243 offset:33800
    ds_read_b64_tr_b16 a[104:105], v243 offset:40960
    ds_read_b64_tr_b16 a[106:107], v243 offset:41984
    ds_read_b64_tr_b16 a[108:109], v243 offset:40968
    ds_read_b64_tr_b16 a[110:111], v243 offset:41992
    ds_read_b64_tr_b16 a[112:113], v243 offset:49152
    ds_read_b64_tr_b16 a[114:115], v243 offset:50176
    ds_read_b64_tr_b16 a[116:117], v243 offset:49160
    ds_read_b64_tr_b16 a[118:119], v243 offset:50184
    ds_read_b64_tr_b16 a[120:121], v243 offset:57344
    ds_read_b64_tr_b16 a[122:123], v243 offset:58368
    ds_read_b64_tr_b16 a[124:125], v243 offset:57352
    ds_read_b64_tr_b16 a[126:127], v243 offset:58376
    s_waitcnt lgkmcnt(0)
    s_barrier
    s_add_u32 m0, s6, 65536
    s_mov_b32 s5, 1572864
    buffer_load_dwordx4 v240, s[16:19], s5 offen nt lds
    s_add_u32 m0, s6, 66560
    s_mov_b32 s5, 1581056
    buffer_load_dwordx4 v240, s[16:19], s5 offen nt lds
    s_add_u32 m0, s6, 67584
    s_mov_b32 s5, 1589248
    buffer_load_dwordx4 v240, s[16:19], s5 offen nt lds
    s_add_u32 m0, s6, 68608
    s_mov_b32 s5, 1597440
    buffer_load_dwordx4 v240, s[16:19], s5 offen nt lds
    s_add_u32 m0, s6, 69632
    s_mov_b32 s5, 1605632
    buffer_load_dwordx4 v240, s[16:19], s5 offen nt lds
    s_add_u32 m0, s6, 70656
    s_mov_b32 s5, 1613824
    buffer_load_dwordx4 v240, s[16:19], s5 offen nt lds
    s_add_u32 m0, s6, 71680
    s_mov_b32 s5, 1622016
    buffer_load_dwordx4 v240, s[16:19], s5 offen nt lds
    s_add_u32 m0, s6, 72704
    s_mov_b32 s5, 1630208
    buffer_load_dwordx4 v240, s[16:19], s5 offen nt lds
    s_add_u32 m0, s6, 73728
    s_mov_b32 s5, 1638400
    buffer_load_dwordx4 v240, s[16:19], s5 offen nt lds
    s_add_u32 m0, s6, 74752
    s_mov_b32 s5, 1646592
    buffer_load_dwordx4 v240, s[16:19], s5 offen nt lds
    s_add_u32 m0, s6, 75776
    s_mov_b32 s5, 1654784
    buffer_load_dwordx4 v240, s[16:19], s5 offen nt lds
    s_add_u32 m0, s6, 76800
    s_mov_b32 s5, 1662976
    buffer_load_dwordx4 v240, s[16:19], s5 offen nt lds
    s_add_u32 m0, s6, 77824
    s_mov_b32 s5, 1671168
    buffer_load_dwordx4 v240, s[16:19], s5 offen nt lds
    s_add_u32 m0, s6, 78848
    s_mov_b32 s5, 1679360
    buffer_load_dwordx4 v240, s[16:19], s5 offen nt lds
    s_add_u32 m0, s6, 79872
    s_mov_b32 s5, 1687552
    buffer_load_dwordx4 v240, s[16:19], s5 offen nt lds
    s_add_u32 m0, s6, 80896
    s_mov_b32 s5, 1695744
    buffer_load_dwordx4 v240, s[16:19], s5 offen nt lds
    s_waitcnt vmcnt(16)
    s_load_dwordx4 s[56:59], s[0:1], 8
    s_load_dwordx2 s[60:61], s[0:1], 24
    s_lshl_b32 s4, s99, 17
    s_lshl_b32 s5, s24, 9
    s_add_u32 s4, s4, s5
    v_bfe_u32 v254, v1, 5, 1
    v_mul_u32_u24 v10, 65536, v254
    v_bfe_u32 v254, v1, 0, 5
    v_mul_u32_u24 v254, 16, v254
    v_add_u32 v10, v10, v254
    v_add_u32 v10, s4, v10
    s_lshl_b32 s4, s24, 11
    v_bfe_u32 v254, v1, 0, 5
    v_mul_u32_u24 v11, 64, v254
    v_add_u32 v11, s4, v11
    s_waitcnt lgkmcnt(0)
    s_mov_b32 s44, s56
    s_and_b32 s45, s57, 0xffff
    s_mov_b32 s46, 0x400000
    s_mov_b32 s47, 0x00020000
    s_mov_b32 s48, s58
    s_and_b32 s49, s59, 0xffff
    s_mov_b32 s50, 0x400000
    s_mov_b32 s51, 0x00020000
    s_mov_b32 s52, s60
    s_and_b32 s53, s61, 0xffff
    s_mov_b32 s54, 0x2000
    s_mov_b32 s55, 0x00020000
    buffer_load_dwordx4 v[216:219], v11, s[52:55], 0 offen offset:0
    buffer_load_dwordx4 v[220:223], v11, s[52:55], 0 offen offset:16
    buffer_load_dwordx4 v[224:227], v11, s[52:55], 0 offen offset:32
    buffer_load_dwordx4 v[228:231], v11, s[52:55], 0 offen offset:48
    v_subrev_u32 v11, 6144, v10
    buffer_load_dwordx4 v[32:35], v11, s[44:47], 0 offen nt
    v_subrev_u32 v11, 4096, v10
    buffer_load_dwordx4 v[36:39], v11, s[44:47], 0 offen nt
    v_subrev_u32 v11, 2048, v10
    buffer_load_dwordx4 v[40:43], v11, s[44:47], 0 offen nt
    s_mov_b32 s4, 0
    buffer_load_dwordx4 v[44:47], v10, s[44:47], s4 offen offset:0 nt
    buffer_load_dwordx4 v[76:79], v10, s[48:51], s4 offen offset:0 nt
    buffer_load_dwordx4 v[48:51], v10, s[44:47], s4 offen offset:2048 nt
    buffer_load_dwordx4 v[80:83], v10, s[48:51], s4 offen offset:2048 nt
    s_mov_b32 s4, 4096
    buffer_load_dwordx4 v[52:55], v10, s[44:47], s4 offen offset:0 nt
    buffer_load_dwordx4 v[84:87], v10, s[48:51], s4 offen offset:0 nt
    buffer_load_dwordx4 v[56:59], v10, s[44:47], s4 offen offset:2048 nt
    buffer_load_dwordx4 v[88:91], v10, s[48:51], s4 offen offset:2048 nt
    s_mov_b32 s4, 8192
    buffer_load_dwordx4 v[60:63], v10, s[44:47], s4 offen offset:0 nt
    buffer_load_dwordx4 v[92:95], v10, s[48:51], s4 offen offset:0 nt
    buffer_load_dwordx4 v[64:67], v10, s[44:47], s4 offen offset:2048 nt
    buffer_load_dwordx4 v[96:99], v10, s[48:51], s4 offen offset:2048 nt
    s_mov_b32 s4, 12288
    buffer_load_dwordx4 v[68:71], v10, s[44:47], s4 offen offset:0 nt
    buffer_load_dwordx4 v[100:103], v10, s[48:51], s4 offen offset:0 nt
    buffer_load_dwordx4 v[72:75], v10, s[44:47], s4 offen offset:2048 nt
    buffer_load_dwordx4 v[104:107], v10, s[48:51], s4 offen offset:2048 nt
    v_add_u32 v10, 16384, v10
    v_subrev_u32 v11, 6144, v10
    buffer_load_dwordx4 v[108:111], v11, s[44:47], 0 offen nt
    v_subrev_u32 v11, 4096, v10
    buffer_load_dwordx4 v[112:115], v11, s[44:47], 0 offen nt
    v_subrev_u32 v11, 2048, v10
    buffer_load_dwordx4 v[116:119], v11, s[44:47], 0 offen nt
    s_mov_b32 s4, 0
    buffer_load_dwordx4 v[120:123], v10, s[44:47], s4 offen offset:0 nt
    buffer_load_dwordx4 v[152:155], v10, s[48:51], s4 offen offset:0 nt
    buffer_load_dwordx4 v[124:127], v10, s[44:47], s4 offen offset:2048 nt
    buffer_load_dwordx4 v[156:159], v10, s[48:51], s4 offen offset:2048 nt
    s_mov_b32 s4, 4096
    buffer_load_dwordx4 v[128:131], v10, s[44:47], s4 offen offset:0 nt
    buffer_load_dwordx4 v[160:163], v10, s[48:51], s4 offen offset:0 nt
    buffer_load_dwordx4 v[132:135], v10, s[44:47], s4 offen offset:2048 nt
    buffer_load_dwordx4 v[164:167], v10, s[48:51], s4 offen offset:2048 nt
    s_mov_b32 s4, 8192
    buffer_load_dwordx4 v[136:139], v10, s[44:47], s4 offen offset:0 nt
    buffer_load_dwordx4 v[168:171], v10, s[48:51], s4 offen offset:0 nt
    buffer_load_dwordx4 v[140:143], v10, s[44:47], s4 offen offset:2048 nt
    buffer_load_dwordx4 v[172:175], v10, s[48:51], s4 offen offset:2048 nt
    s_mov_b32 s4, 12288
    buffer_load_dwordx4 v[144:147], v10, s[44:47], s4 offen offset:0 nt
    buffer_load_dwordx4 v[176:179], v10, s[48:51], s4 offen offset:0 nt
    buffer_load_dwordx4 v[148:151], v10, s[44:47], s4 offen offset:2048 nt
    buffer_load_dwordx4 v[180:183], v10, s[48:51], s4 offen offset:2048 nt
    v_add_u32 v10, 16384, v10
    s_barrier
    ds_read_b64_tr_b16 a[128:129], v242 offset:0
    ds_read_b64_tr_b16 a[130:131], v242 offset:1024
    ds_read_b64_tr_b16 a[132:133], v242 offset:8
    ds_read_b64_tr_b16 a[134:135], v242 offset:1032
    ds_read_b64_tr_b16 a[136:137], v242 offset:8192
    ds_read_b64_tr_b16 a[138:139], v242 offset:9216
    ds_read_b64_tr_b16 a[140:141], v242 offset:8200
    ds_read_b64_tr_b16 a[142:143], v242 offset:9224
    ds_read_b64_tr_b16 a[144:145], v242 offset:16384
    ds_read_b64_tr_b16 a[146:147], v242 offset:17408
    ds_read_b64_tr_b16 a[148:149], v242 offset:16392
    ds_read_b64_tr_b16 a[150:151], v242 offset:17416
    ds_read_b64_tr_b16 a[152:153], v242 offset:24576
    ds_read_b64_tr_b16 a[154:155], v242 offset:25600
    ds_read_b64_tr_b16 a[156:157], v242 offset:24584
    ds_read_b64_tr_b16 a[158:159], v242 offset:25608
    ds_read_b64_tr_b16 a[160:161], v242 offset:32768
    ds_read_b64_tr_b16 a[162:163], v242 offset:33792
    ds_read_b64_tr_b16 a[164:165], v242 offset:32776
    ds_read_b64_tr_b16 a[166:167], v242 offset:33800
    ds_read_b64_tr_b16 a[168:169], v242 offset:40960
    ds_read_b64_tr_b16 a[170:171], v242 offset:41984
    ds_read_b64_tr_b16 a[172:173], v242 offset:40968
    ds_read_b64_tr_b16 a[174:175], v242 offset:41992
    ds_read_b64_tr_b16 a[176:177], v242 offset:49152
    ds_read_b64_tr_b16 a[178:179], v242 offset:50176
    ds_read_b64_tr_b16 a[180:181], v242 offset:49160
    ds_read_b64_tr_b16 a[182:183], v242 offset:50184
    ds_read_b64_tr_b16 a[184:185], v242 offset:57344
    ds_read_b64_tr_b16 a[186:187], v242 offset:58368
    ds_read_b64_tr_b16 a[188:189], v242 offset:57352
    ds_read_b64_tr_b16 a[190:191], v242 offset:58376
    s_waitcnt lgkmcnt(0)
    s_barrier
    s_waitcnt vmcnt(42)
    s_barrier
    ds_read_b64_tr_b16 a[192:193], v243 offset:0
    ds_read_b64_tr_b16 a[194:195], v243 offset:1024
    ds_read_b64_tr_b16 a[196:197], v243 offset:8
    ds_read_b64_tr_b16 a[198:199], v243 offset:1032
    ds_read_b64_tr_b16 a[200:201], v243 offset:8192
    ds_read_b64_tr_b16 a[202:203], v243 offset:9216
    ds_read_b64_tr_b16 a[204:205], v243 offset:8200
    ds_read_b64_tr_b16 a[206:207], v243 offset:9224
    ds_read_b64_tr_b16 a[208:209], v243 offset:16384
    ds_read_b64_tr_b16 a[210:211], v243 offset:17408
    ds_read_b64_tr_b16 a[212:213], v243 offset:16392
    ds_read_b64_tr_b16 a[214:215], v243 offset:17416
    ds_read_b64_tr_b16 a[216:217], v243 offset:24576
    ds_read_b64_tr_b16 a[218:219], v243 offset:25600
    ds_read_b64_tr_b16 a[220:221], v243 offset:24584
    ds_read_b64_tr_b16 a[222:223], v243 offset:25608
    ds_read_b64_tr_b16 a[224:225], v243 offset:32768
    ds_read_b64_tr_b16 a[226:227], v243 offset:33792
    ds_read_b64_tr_b16 a[228:229], v243 offset:32776
    ds_read_b64_tr_b16 a[230:231], v243 offset:33800
    ds_read_b64_tr_b16 a[232:233], v243 offset:40960
    ds_read_b64_tr_b16 a[234:235], v243 offset:41984
    ds_read_b64_tr_b16 a[236:237], v243 offset:40968
    ds_read_b64_tr_b16 a[238:239], v243 offset:41992
    ds_read_b64_tr_b16 a[240:241], v243 offset:49152
    ds_read_b64_tr_b16 a[242:243], v243 offset:50176
    ds_read_b64_tr_b16 a[244:245], v243 offset:49160
    ds_read_b64_tr_b16 a[246:247], v243 offset:50184
    ds_read_b64_tr_b16 a[248:249], v243 offset:57344
    ds_read_b64_tr_b16 a[250:251], v243 offset:58368
    ds_read_b64_tr_b16 a[252:253], v243 offset:57352
    ds_read_b64_tr_b16 a[254:255], v243 offset:58376
    s_waitcnt lgkmcnt(0)
    s_barrier
    s_lshl_b32 s5, s24, 15
    v_bfe_u32 v254, v1, 0, 3
    v_mul_u32_u24 v12, 16, v254
    v_bfe_u32 v254, v1, 5, 1
    v_mul_u32_u24 v13, 64, v254
    v_xor_b32 v12, v12, v13
    v_bfe_u32 v254, v1, 0, 5
    v_mul_u32_u24 v13, 1024, v254
    v_add_u32 v13, s5, v13
    v_add_u32 v13, v12, v13
    s_waitcnt vmcnt(38)
    v_lshlrev_b32 v184, 16, v216
    v_lshlrev_b32 v185, 16, v218
    v_and_b32 v186, 0xffff0000, v216
    v_and_b32 v187, 0xffff0000, v218
    v_lshlrev_b32 v188, 16, v217
    v_lshlrev_b32 v189, 16, v219
    v_and_b32 v190, 0xffff0000, v217
    v_and_b32 v191, 0xffff0000, v219
    v_lshlrev_b32 v192, 16, v220
    v_lshlrev_b32 v193, 16, v222
    v_and_b32 v194, 0xffff0000, v220
    v_and_b32 v195, 0xffff0000, v222
    v_lshlrev_b32 v196, 16, v221
    v_lshlrev_b32 v197, 16, v223
    v_and_b32 v198, 0xffff0000, v221
    v_and_b32 v199, 0xffff0000, v223
    v_lshlrev_b32 v200, 16, v224
    v_lshlrev_b32 v201, 16, v226
    v_and_b32 v202, 0xffff0000, v224
    v_and_b32 v203, 0xffff0000, v226
    v_lshlrev_b32 v204, 16, v225
    v_lshlrev_b32 v205, 16, v227
    v_and_b32 v206, 0xffff0000, v225
    v_and_b32 v207, 0xffff0000, v227
    v_lshlrev_b32 v208, 16, v228
    v_lshlrev_b32 v209, 16, v230
    v_and_b32 v210, 0xffff0000, v228
    v_and_b32 v211, 0xffff0000, v230
    v_lshlrev_b32 v212, 16, v229
    v_lshlrev_b32 v213, 16, v231
    v_and_b32 v214, 0xffff0000, v229
    v_and_b32 v215, 0xffff0000, v231
    v_xor_b32 v12, 0, v13
    s_waitcnt vmcnt(19)
    v_lshlrev_b32 v216, 16, v32
    v_and_b32 v217, 0xffff0000, v32
    v_lshlrev_b32 v218, 16, v36
    v_and_b32 v219, 0xffff0000, v36
    v_lshlrev_b32 v220, 16, v40
    v_and_b32 v221, 0xffff0000, v40
    v_lshlrev_b32 v222, 16, v44
    v_and_b32 v223, 0xffff0000, v44
    v_lshlrev_b32 v224, 16, v48
    v_and_b32 v225, 0xffff0000, v48
    v_lshlrev_b32 v226, 16, v52
    v_and_b32 v227, 0xffff0000, v52
    v_lshlrev_b32 v228, 16, v56
    v_and_b32 v229, 0xffff0000, v56
    v_lshlrev_b32 v230, 16, v60
    v_and_b32 v231, 0xffff0000, v60
    v_lshlrev_b32 v232, 16, v64
    v_and_b32 v233, 0xffff0000, v64
    v_lshlrev_b32 v234, 16, v68
    v_and_b32 v235, 0xffff0000, v68
    v_lshlrev_b32 v236, 16, v72
    v_and_b32 v237, 0xffff0000, v72
    v_pk_mul_f32 v[216:217], v[216:217], v[190:191]
    v_lshlrev_b32 v238, 16, v76
    v_pk_fma_f32 v[216:217], v[218:219], v[188:189], v[216:217]
    v_and_b32 v239, 0xffff0000, v76
    v_pk_fma_f32 v[216:217], v[220:221], v[186:187], v[216:217]
    v_pk_fma_f32 v[216:217], v[222:223], v[184:185], v[216:217]
    v_pk_mul_f32 v[216:217], v[216:217], v[238:239]
    v_pk_mul_f32 v[218:219], v[218:219], v[190:191]
    v_lshlrev_b32 v240, 16, v80
    v_pk_fma_f32 v[218:219], v[220:221], v[188:189], v[218:219]
    v_and_b32 v241, 0xffff0000, v80
    v_pk_fma_f32 v[218:219], v[222:223], v[186:187], v[218:219]
    v_pk_fma_f32 v[218:219], v[224:225], v[184:185], v[218:219]
    v_pk_mul_f32 v[218:219], v[218:219], v[240:241]
    v_pk_mul_f32 v[220:221], v[220:221], v[190:191]
    v_lshlrev_b32 v238, 16, v84
    v_pk_fma_f32 v[220:221], v[222:223], v[188:189], v[220:221]
    v_and_b32 v239, 0xffff0000, v84
    v_pk_fma_f32 v[220:221], v[224:225], v[186:187], v[220:221]
    v_pk_fma_f32 v[220:221], v[226:227], v[184:185], v[220:221]
    v_pk_mul_f32 v[220:221], v[220:221], v[238:239]
    v_pk_mul_f32 v[222:223], v[222:223], v[190:191]
    v_lshlrev_b32 v240, 16, v88
    v_pk_fma_f32 v[222:223], v[224:225], v[188:189], v[222:223]
    v_and_b32 v241, 0xffff0000, v88
    v_pk_fma_f32 v[222:223], v[226:227], v[186:187], v[222:223]
    v_pk_fma_f32 v[222:223], v[228:229], v[184:185], v[222:223]
    v_pk_mul_f32 v[222:223], v[222:223], v[240:241]
    v_pk_mul_f32 v[224:225], v[224:225], v[190:191]
    v_lshlrev_b32 v238, 16, v92
    v_pk_fma_f32 v[224:225], v[226:227], v[188:189], v[224:225]
    v_and_b32 v239, 0xffff0000, v92
    v_pk_fma_f32 v[224:225], v[228:229], v[186:187], v[224:225]
    v_pk_fma_f32 v[224:225], v[230:231], v[184:185], v[224:225]
    v_pk_mul_f32 v[224:225], v[224:225], v[238:239]
    v_pk_mul_f32 v[226:227], v[226:227], v[190:191]
    v_lshlrev_b32 v240, 16, v96
    v_pk_fma_f32 v[226:227], v[228:229], v[188:189], v[226:227]
    v_and_b32 v241, 0xffff0000, v96
    v_pk_fma_f32 v[226:227], v[230:231], v[186:187], v[226:227]
    v_pk_fma_f32 v[226:227], v[232:233], v[184:185], v[226:227]
    v_pk_mul_f32 v[226:227], v[226:227], v[240:241]
    v_pk_mul_f32 v[228:229], v[228:229], v[190:191]
    v_lshlrev_b32 v238, 16, v100
    v_pk_fma_f32 v[228:229], v[230:231], v[188:189], v[228:229]
    v_and_b32 v239, 0xffff0000, v100
    v_pk_fma_f32 v[228:229], v[232:233], v[186:187], v[228:229]
    v_pk_fma_f32 v[228:229], v[234:235], v[184:185], v[228:229]
    v_pk_mul_f32 v[228:229], v[228:229], v[238:239]
    v_pk_mul_f32 v[230:231], v[230:231], v[190:191]
    v_lshlrev_b32 v240, 16, v104
    v_pk_fma_f32 v[230:231], v[232:233], v[188:189], v[230:231]
    v_and_b32 v241, 0xffff0000, v104
    v_pk_fma_f32 v[230:231], v[234:235], v[186:187], v[230:231]
    v_pk_fma_f32 v[230:231], v[236:237], v[184:185], v[230:231]
    v_pk_mul_f32 v[230:231], v[230:231], v[240:241]
    v_cvt_pk_bf16_f32 v242, v230, v228
    v_cvt_pk_bf16_f32 v243, v226, v224
    v_cvt_pk_bf16_f32 v244, v222, v220
    v_cvt_pk_bf16_f32 v245, v218, v216
    ds_write_b128 v12, v[242:245] offset:0
    v_cvt_pk_bf16_f32 v246, v231, v229
    v_cvt_pk_bf16_f32 v247, v227, v225
    v_cvt_pk_bf16_f32 v248, v223, v221
    v_cvt_pk_bf16_f32 v249, v219, v217
    ds_write_b128 v12, v[246:249] offset:128
    v_lshlrev_b32 v216, 16, v33
    v_and_b32 v217, 0xffff0000, v33
    v_lshlrev_b32 v218, 16, v37
    v_and_b32 v219, 0xffff0000, v37
    v_lshlrev_b32 v220, 16, v41
    v_and_b32 v221, 0xffff0000, v41
    v_lshlrev_b32 v222, 16, v45
    v_and_b32 v223, 0xffff0000, v45
    v_lshlrev_b32 v224, 16, v49
    v_and_b32 v225, 0xffff0000, v49
    v_lshlrev_b32 v226, 16, v53
    v_and_b32 v227, 0xffff0000, v53
    v_lshlrev_b32 v228, 16, v57
    v_and_b32 v229, 0xffff0000, v57
    v_lshlrev_b32 v230, 16, v61
    v_and_b32 v231, 0xffff0000, v61
    v_lshlrev_b32 v232, 16, v65
    v_and_b32 v233, 0xffff0000, v65
    v_lshlrev_b32 v234, 16, v69
    v_and_b32 v235, 0xffff0000, v69
    v_lshlrev_b32 v236, 16, v73
    v_and_b32 v237, 0xffff0000, v73
    v_pk_mul_f32 v[216:217], v[216:217], v[198:199]
    v_lshlrev_b32 v238, 16, v77
    v_pk_fma_f32 v[216:217], v[218:219], v[196:197], v[216:217]
    v_and_b32 v239, 0xffff0000, v77
    v_pk_fma_f32 v[216:217], v[220:221], v[194:195], v[216:217]
    v_pk_fma_f32 v[216:217], v[222:223], v[192:193], v[216:217]
    v_pk_mul_f32 v[216:217], v[216:217], v[238:239]
    v_pk_mul_f32 v[218:219], v[218:219], v[198:199]
    v_lshlrev_b32 v240, 16, v81
    v_pk_fma_f32 v[218:219], v[220:221], v[196:197], v[218:219]
    v_and_b32 v241, 0xffff0000, v81
    v_pk_fma_f32 v[218:219], v[222:223], v[194:195], v[218:219]
    v_pk_fma_f32 v[218:219], v[224:225], v[192:193], v[218:219]
    v_pk_mul_f32 v[218:219], v[218:219], v[240:241]
    v_pk_mul_f32 v[220:221], v[220:221], v[198:199]
    v_lshlrev_b32 v238, 16, v85
    v_pk_fma_f32 v[220:221], v[222:223], v[196:197], v[220:221]
    v_and_b32 v239, 0xffff0000, v85
    v_pk_fma_f32 v[220:221], v[224:225], v[194:195], v[220:221]
    v_pk_fma_f32 v[220:221], v[226:227], v[192:193], v[220:221]
    v_pk_mul_f32 v[220:221], v[220:221], v[238:239]
    v_pk_mul_f32 v[222:223], v[222:223], v[198:199]
    v_lshlrev_b32 v240, 16, v89
    v_pk_fma_f32 v[222:223], v[224:225], v[196:197], v[222:223]
    v_and_b32 v241, 0xffff0000, v89
    v_pk_fma_f32 v[222:223], v[226:227], v[194:195], v[222:223]
    v_pk_fma_f32 v[222:223], v[228:229], v[192:193], v[222:223]
    v_pk_mul_f32 v[222:223], v[222:223], v[240:241]
    v_pk_mul_f32 v[224:225], v[224:225], v[198:199]
    v_lshlrev_b32 v238, 16, v93
    v_pk_fma_f32 v[224:225], v[226:227], v[196:197], v[224:225]
    v_and_b32 v239, 0xffff0000, v93
    v_pk_fma_f32 v[224:225], v[228:229], v[194:195], v[224:225]
    v_pk_fma_f32 v[224:225], v[230:231], v[192:193], v[224:225]
    v_pk_mul_f32 v[224:225], v[224:225], v[238:239]
    v_pk_mul_f32 v[226:227], v[226:227], v[198:199]
    v_lshlrev_b32 v240, 16, v97
    v_pk_fma_f32 v[226:227], v[228:229], v[196:197], v[226:227]
    v_and_b32 v241, 0xffff0000, v97
    v_pk_fma_f32 v[226:227], v[230:231], v[194:195], v[226:227]
    v_pk_fma_f32 v[226:227], v[232:233], v[192:193], v[226:227]
    v_pk_mul_f32 v[226:227], v[226:227], v[240:241]
    v_pk_mul_f32 v[228:229], v[228:229], v[198:199]
    v_lshlrev_b32 v238, 16, v101
    v_pk_fma_f32 v[228:229], v[230:231], v[196:197], v[228:229]
    v_and_b32 v239, 0xffff0000, v101
    v_pk_fma_f32 v[228:229], v[232:233], v[194:195], v[228:229]
    v_pk_fma_f32 v[228:229], v[234:235], v[192:193], v[228:229]
    v_pk_mul_f32 v[228:229], v[228:229], v[238:239]
    v_pk_mul_f32 v[230:231], v[230:231], v[198:199]
    v_lshlrev_b32 v240, 16, v105
    v_pk_fma_f32 v[230:231], v[232:233], v[196:197], v[230:231]
    v_and_b32 v241, 0xffff0000, v105
    v_pk_fma_f32 v[230:231], v[234:235], v[194:195], v[230:231]
    v_pk_fma_f32 v[230:231], v[236:237], v[192:193], v[230:231]
    v_pk_mul_f32 v[230:231], v[230:231], v[240:241]
    v_cvt_pk_bf16_f32 v242, v230, v228
    v_cvt_pk_bf16_f32 v243, v226, v224
    v_cvt_pk_bf16_f32 v244, v222, v220
    v_cvt_pk_bf16_f32 v245, v218, v216
    ds_write_b128 v12, v[242:245] offset:256
    v_cvt_pk_bf16_f32 v246, v231, v229
    v_cvt_pk_bf16_f32 v247, v227, v225
    v_cvt_pk_bf16_f32 v248, v223, v221
    v_cvt_pk_bf16_f32 v249, v219, v217
    ds_write_b128 v12, v[246:249] offset:384
    v_lshlrev_b32 v216, 16, v34
    v_and_b32 v217, 0xffff0000, v34
    v_lshlrev_b32 v218, 16, v38
    v_and_b32 v219, 0xffff0000, v38
    v_lshlrev_b32 v220, 16, v42
    v_and_b32 v221, 0xffff0000, v42
    v_lshlrev_b32 v222, 16, v46
    v_and_b32 v223, 0xffff0000, v46
    v_lshlrev_b32 v224, 16, v50
    v_and_b32 v225, 0xffff0000, v50
    v_lshlrev_b32 v226, 16, v54
    v_and_b32 v227, 0xffff0000, v54
    v_lshlrev_b32 v228, 16, v58
    v_and_b32 v229, 0xffff0000, v58
    v_lshlrev_b32 v230, 16, v62
    v_and_b32 v231, 0xffff0000, v62
    v_lshlrev_b32 v232, 16, v66
    v_and_b32 v233, 0xffff0000, v66
    v_lshlrev_b32 v234, 16, v70
    v_and_b32 v235, 0xffff0000, v70
    v_lshlrev_b32 v236, 16, v74
    v_and_b32 v237, 0xffff0000, v74
    v_pk_mul_f32 v[216:217], v[216:217], v[206:207]
    v_lshlrev_b32 v238, 16, v78
    v_pk_fma_f32 v[216:217], v[218:219], v[204:205], v[216:217]
    v_and_b32 v239, 0xffff0000, v78
    v_pk_fma_f32 v[216:217], v[220:221], v[202:203], v[216:217]
    v_pk_fma_f32 v[216:217], v[222:223], v[200:201], v[216:217]
    v_pk_mul_f32 v[216:217], v[216:217], v[238:239]
    v_pk_mul_f32 v[218:219], v[218:219], v[206:207]
    v_lshlrev_b32 v240, 16, v82
    v_pk_fma_f32 v[218:219], v[220:221], v[204:205], v[218:219]
    v_and_b32 v241, 0xffff0000, v82
    v_pk_fma_f32 v[218:219], v[222:223], v[202:203], v[218:219]
    v_pk_fma_f32 v[218:219], v[224:225], v[200:201], v[218:219]
    v_pk_mul_f32 v[218:219], v[218:219], v[240:241]
    v_pk_mul_f32 v[220:221], v[220:221], v[206:207]
    v_lshlrev_b32 v238, 16, v86
    v_pk_fma_f32 v[220:221], v[222:223], v[204:205], v[220:221]
    v_and_b32 v239, 0xffff0000, v86
    v_pk_fma_f32 v[220:221], v[224:225], v[202:203], v[220:221]
    v_pk_fma_f32 v[220:221], v[226:227], v[200:201], v[220:221]
    v_pk_mul_f32 v[220:221], v[220:221], v[238:239]
    v_pk_mul_f32 v[222:223], v[222:223], v[206:207]
    v_lshlrev_b32 v240, 16, v90
    v_pk_fma_f32 v[222:223], v[224:225], v[204:205], v[222:223]
    v_and_b32 v241, 0xffff0000, v90
    v_pk_fma_f32 v[222:223], v[226:227], v[202:203], v[222:223]
    v_pk_fma_f32 v[222:223], v[228:229], v[200:201], v[222:223]
    v_pk_mul_f32 v[222:223], v[222:223], v[240:241]
    v_pk_mul_f32 v[224:225], v[224:225], v[206:207]
    v_lshlrev_b32 v238, 16, v94
    v_pk_fma_f32 v[224:225], v[226:227], v[204:205], v[224:225]
    v_and_b32 v239, 0xffff0000, v94
    v_pk_fma_f32 v[224:225], v[228:229], v[202:203], v[224:225]
    v_pk_fma_f32 v[224:225], v[230:231], v[200:201], v[224:225]
    v_pk_mul_f32 v[224:225], v[224:225], v[238:239]
    v_pk_mul_f32 v[226:227], v[226:227], v[206:207]
    v_lshlrev_b32 v240, 16, v98
    v_pk_fma_f32 v[226:227], v[228:229], v[204:205], v[226:227]
    v_and_b32 v241, 0xffff0000, v98
    v_pk_fma_f32 v[226:227], v[230:231], v[202:203], v[226:227]
    v_pk_fma_f32 v[226:227], v[232:233], v[200:201], v[226:227]
    v_pk_mul_f32 v[226:227], v[226:227], v[240:241]
    v_pk_mul_f32 v[228:229], v[228:229], v[206:207]
    v_lshlrev_b32 v238, 16, v102
    v_pk_fma_f32 v[228:229], v[230:231], v[204:205], v[228:229]
    v_and_b32 v239, 0xffff0000, v102
    v_pk_fma_f32 v[228:229], v[232:233], v[202:203], v[228:229]
    v_pk_fma_f32 v[228:229], v[234:235], v[200:201], v[228:229]
    v_pk_mul_f32 v[228:229], v[228:229], v[238:239]
    v_pk_mul_f32 v[230:231], v[230:231], v[206:207]
    v_lshlrev_b32 v240, 16, v106
    v_pk_fma_f32 v[230:231], v[232:233], v[204:205], v[230:231]
    v_and_b32 v241, 0xffff0000, v106
    v_pk_fma_f32 v[230:231], v[234:235], v[202:203], v[230:231]
    v_pk_fma_f32 v[230:231], v[236:237], v[200:201], v[230:231]
    v_pk_mul_f32 v[230:231], v[230:231], v[240:241]
    v_cvt_pk_bf16_f32 v242, v230, v228
    v_cvt_pk_bf16_f32 v243, v226, v224
    v_cvt_pk_bf16_f32 v244, v222, v220
    v_cvt_pk_bf16_f32 v245, v218, v216
    ds_write_b128 v12, v[242:245] offset:512
    v_cvt_pk_bf16_f32 v246, v231, v229
    v_cvt_pk_bf16_f32 v247, v227, v225
    v_cvt_pk_bf16_f32 v248, v223, v221
    v_cvt_pk_bf16_f32 v249, v219, v217
    ds_write_b128 v12, v[246:249] offset:640
    v_lshlrev_b32 v216, 16, v35
    v_and_b32 v217, 0xffff0000, v35
    v_lshlrev_b32 v218, 16, v39
    v_and_b32 v219, 0xffff0000, v39
    v_lshlrev_b32 v220, 16, v43
    v_and_b32 v221, 0xffff0000, v43
    v_lshlrev_b32 v222, 16, v47
    v_and_b32 v223, 0xffff0000, v47
    v_lshlrev_b32 v224, 16, v51
    v_and_b32 v225, 0xffff0000, v51
    v_lshlrev_b32 v226, 16, v55
    v_and_b32 v227, 0xffff0000, v55
    v_lshlrev_b32 v228, 16, v59
    v_and_b32 v229, 0xffff0000, v59
    v_lshlrev_b32 v230, 16, v63
    v_and_b32 v231, 0xffff0000, v63
    v_lshlrev_b32 v232, 16, v67
    v_and_b32 v233, 0xffff0000, v67
    v_lshlrev_b32 v234, 16, v71
    v_and_b32 v235, 0xffff0000, v71
    v_lshlrev_b32 v236, 16, v75
    v_and_b32 v237, 0xffff0000, v75
    v_pk_mul_f32 v[216:217], v[216:217], v[214:215]
    v_lshlrev_b32 v238, 16, v79
    v_pk_fma_f32 v[216:217], v[218:219], v[212:213], v[216:217]
    v_and_b32 v239, 0xffff0000, v79
    v_pk_fma_f32 v[216:217], v[220:221], v[210:211], v[216:217]
    v_pk_fma_f32 v[216:217], v[222:223], v[208:209], v[216:217]
    v_pk_mul_f32 v[216:217], v[216:217], v[238:239]
    v_pk_mul_f32 v[218:219], v[218:219], v[214:215]
    v_lshlrev_b32 v240, 16, v83
    v_pk_fma_f32 v[218:219], v[220:221], v[212:213], v[218:219]
    v_and_b32 v241, 0xffff0000, v83
    v_pk_fma_f32 v[218:219], v[222:223], v[210:211], v[218:219]
    v_pk_fma_f32 v[218:219], v[224:225], v[208:209], v[218:219]
    v_pk_mul_f32 v[218:219], v[218:219], v[240:241]
    v_pk_mul_f32 v[220:221], v[220:221], v[214:215]
    v_lshlrev_b32 v238, 16, v87
    v_pk_fma_f32 v[220:221], v[222:223], v[212:213], v[220:221]
    v_and_b32 v239, 0xffff0000, v87
    v_pk_fma_f32 v[220:221], v[224:225], v[210:211], v[220:221]
    v_pk_fma_f32 v[220:221], v[226:227], v[208:209], v[220:221]
    v_pk_mul_f32 v[220:221], v[220:221], v[238:239]
    v_pk_mul_f32 v[222:223], v[222:223], v[214:215]
    v_lshlrev_b32 v240, 16, v91
    v_pk_fma_f32 v[222:223], v[224:225], v[212:213], v[222:223]
    v_and_b32 v241, 0xffff0000, v91
    v_pk_fma_f32 v[222:223], v[226:227], v[210:211], v[222:223]
    v_pk_fma_f32 v[222:223], v[228:229], v[208:209], v[222:223]
    v_pk_mul_f32 v[222:223], v[222:223], v[240:241]
    v_pk_mul_f32 v[224:225], v[224:225], v[214:215]
    v_lshlrev_b32 v238, 16, v95
    v_pk_fma_f32 v[224:225], v[226:227], v[212:213], v[224:225]
    v_and_b32 v239, 0xffff0000, v95
    v_pk_fma_f32 v[224:225], v[228:229], v[210:211], v[224:225]
    v_pk_fma_f32 v[224:225], v[230:231], v[208:209], v[224:225]
    v_pk_mul_f32 v[224:225], v[224:225], v[238:239]
    v_pk_mul_f32 v[226:227], v[226:227], v[214:215]
    v_lshlrev_b32 v240, 16, v99
    v_pk_fma_f32 v[226:227], v[228:229], v[212:213], v[226:227]
    v_and_b32 v241, 0xffff0000, v99
    v_pk_fma_f32 v[226:227], v[230:231], v[210:211], v[226:227]
    v_pk_fma_f32 v[226:227], v[232:233], v[208:209], v[226:227]
    v_pk_mul_f32 v[226:227], v[226:227], v[240:241]
    v_pk_mul_f32 v[228:229], v[228:229], v[214:215]
    v_lshlrev_b32 v238, 16, v103
    v_pk_fma_f32 v[228:229], v[230:231], v[212:213], v[228:229]
    v_and_b32 v239, 0xffff0000, v103
    v_pk_fma_f32 v[228:229], v[232:233], v[210:211], v[228:229]
    v_pk_fma_f32 v[228:229], v[234:235], v[208:209], v[228:229]
    v_pk_mul_f32 v[228:229], v[228:229], v[238:239]
    v_pk_mul_f32 v[230:231], v[230:231], v[214:215]
    v_lshlrev_b32 v240, 16, v107
    v_pk_fma_f32 v[230:231], v[232:233], v[212:213], v[230:231]
    v_and_b32 v241, 0xffff0000, v107
    v_pk_fma_f32 v[230:231], v[234:235], v[210:211], v[230:231]
    v_pk_fma_f32 v[230:231], v[236:237], v[208:209], v[230:231]
    v_pk_mul_f32 v[230:231], v[230:231], v[240:241]
    v_cvt_pk_bf16_f32 v242, v230, v228
    v_cvt_pk_bf16_f32 v243, v226, v224
    v_cvt_pk_bf16_f32 v244, v222, v220
    v_cvt_pk_bf16_f32 v245, v218, v216
    ds_write_b128 v12, v[242:245] offset:768
    v_cvt_pk_bf16_f32 v246, v231, v229
    v_cvt_pk_bf16_f32 v247, v227, v225
    v_cvt_pk_bf16_f32 v248, v223, v221
    v_cvt_pk_bf16_f32 v249, v219, v217
    ds_write_b128 v12, v[246:249] offset:896
    v_subrev_u32 v11, 6144, v10
    buffer_load_dwordx4 v[32:35], v11, s[44:47], 0 offen nt
    v_subrev_u32 v11, 4096, v10
    buffer_load_dwordx4 v[36:39], v11, s[44:47], 0 offen nt
    v_subrev_u32 v11, 2048, v10
    buffer_load_dwordx4 v[40:43], v11, s[44:47], 0 offen nt
    s_mov_b32 s4, 0
    buffer_load_dwordx4 v[44:47], v10, s[44:47], s4 offen offset:0 nt
    buffer_load_dwordx4 v[76:79], v10, s[48:51], s4 offen offset:0 nt
    buffer_load_dwordx4 v[48:51], v10, s[44:47], s4 offen offset:2048 nt
    buffer_load_dwordx4 v[80:83], v10, s[48:51], s4 offen offset:2048 nt
    s_mov_b32 s4, 4096
    buffer_load_dwordx4 v[52:55], v10, s[44:47], s4 offen offset:0 nt
    buffer_load_dwordx4 v[84:87], v10, s[48:51], s4 offen offset:0 nt
    buffer_load_dwordx4 v[56:59], v10, s[44:47], s4 offen offset:2048 nt
    buffer_load_dwordx4 v[88:91], v10, s[48:51], s4 offen offset:2048 nt
    s_mov_b32 s4, 8192
    buffer_load_dwordx4 v[60:63], v10, s[44:47], s4 offen offset:0 nt
    buffer_load_dwordx4 v[92:95], v10, s[48:51], s4 offen offset:0 nt
    buffer_load_dwordx4 v[64:67], v10, s[44:47], s4 offen offset:2048 nt
    buffer_load_dwordx4 v[96:99], v10, s[48:51], s4 offen offset:2048 nt
    s_mov_b32 s4, 12288
    buffer_load_dwordx4 v[68:71], v10, s[44:47], s4 offen offset:0 nt
    buffer_load_dwordx4 v[100:103], v10, s[48:51], s4 offen offset:0 nt
    buffer_load_dwordx4 v[72:75], v10, s[44:47], s4 offen offset:2048 nt
    buffer_load_dwordx4 v[104:107], v10, s[48:51], s4 offen offset:2048 nt
    v_add_u32 v10, 16384, v10
    v_xor_b32 v12, 16, v13
    s_waitcnt vmcnt(19)
    v_lshlrev_b32 v216, 16, v108
    v_and_b32 v217, 0xffff0000, v108
    v_lshlrev_b32 v218, 16, v112
    v_and_b32 v219, 0xffff0000, v112
    v_lshlrev_b32 v220, 16, v116
    v_and_b32 v221, 0xffff0000, v116
    v_lshlrev_b32 v222, 16, v120
    v_and_b32 v223, 0xffff0000, v120
    v_lshlrev_b32 v224, 16, v124
    v_and_b32 v225, 0xffff0000, v124
    v_lshlrev_b32 v226, 16, v128
    v_and_b32 v227, 0xffff0000, v128
    v_lshlrev_b32 v228, 16, v132
    v_and_b32 v229, 0xffff0000, v132
    v_lshlrev_b32 v230, 16, v136
    v_and_b32 v231, 0xffff0000, v136
    v_lshlrev_b32 v232, 16, v140
    v_and_b32 v233, 0xffff0000, v140
    v_lshlrev_b32 v234, 16, v144
    v_and_b32 v235, 0xffff0000, v144
    v_lshlrev_b32 v236, 16, v148
    v_and_b32 v237, 0xffff0000, v148
    v_pk_mul_f32 v[216:217], v[216:217], v[190:191]
    v_lshlrev_b32 v238, 16, v152
    v_pk_fma_f32 v[216:217], v[218:219], v[188:189], v[216:217]
    v_and_b32 v239, 0xffff0000, v152
    v_pk_fma_f32 v[216:217], v[220:221], v[186:187], v[216:217]
    v_pk_fma_f32 v[216:217], v[222:223], v[184:185], v[216:217]
    v_pk_mul_f32 v[216:217], v[216:217], v[238:239]
    v_pk_mul_f32 v[218:219], v[218:219], v[190:191]
    v_lshlrev_b32 v240, 16, v156
    v_pk_fma_f32 v[218:219], v[220:221], v[188:189], v[218:219]
    v_and_b32 v241, 0xffff0000, v156
    v_pk_fma_f32 v[218:219], v[222:223], v[186:187], v[218:219]
    v_pk_fma_f32 v[218:219], v[224:225], v[184:185], v[218:219]
    v_pk_mul_f32 v[218:219], v[218:219], v[240:241]
    v_pk_mul_f32 v[220:221], v[220:221], v[190:191]
    v_lshlrev_b32 v238, 16, v160
    v_pk_fma_f32 v[220:221], v[222:223], v[188:189], v[220:221]
    v_and_b32 v239, 0xffff0000, v160
    v_pk_fma_f32 v[220:221], v[224:225], v[186:187], v[220:221]
    v_pk_fma_f32 v[220:221], v[226:227], v[184:185], v[220:221]
    v_pk_mul_f32 v[220:221], v[220:221], v[238:239]
    v_pk_mul_f32 v[222:223], v[222:223], v[190:191]
    v_lshlrev_b32 v240, 16, v164
    v_pk_fma_f32 v[222:223], v[224:225], v[188:189], v[222:223]
    v_and_b32 v241, 0xffff0000, v164
    v_pk_fma_f32 v[222:223], v[226:227], v[186:187], v[222:223]
    v_pk_fma_f32 v[222:223], v[228:229], v[184:185], v[222:223]
    v_pk_mul_f32 v[222:223], v[222:223], v[240:241]
    v_pk_mul_f32 v[224:225], v[224:225], v[190:191]
    v_lshlrev_b32 v238, 16, v168
    v_pk_fma_f32 v[224:225], v[226:227], v[188:189], v[224:225]
    v_and_b32 v239, 0xffff0000, v168
    v_pk_fma_f32 v[224:225], v[228:229], v[186:187], v[224:225]
    v_pk_fma_f32 v[224:225], v[230:231], v[184:185], v[224:225]
    v_pk_mul_f32 v[224:225], v[224:225], v[238:239]
    v_pk_mul_f32 v[226:227], v[226:227], v[190:191]
    v_lshlrev_b32 v240, 16, v172
    v_pk_fma_f32 v[226:227], v[228:229], v[188:189], v[226:227]
    v_and_b32 v241, 0xffff0000, v172
    v_pk_fma_f32 v[226:227], v[230:231], v[186:187], v[226:227]
    v_pk_fma_f32 v[226:227], v[232:233], v[184:185], v[226:227]
    v_pk_mul_f32 v[226:227], v[226:227], v[240:241]
    v_pk_mul_f32 v[228:229], v[228:229], v[190:191]
    v_lshlrev_b32 v238, 16, v176
    v_pk_fma_f32 v[228:229], v[230:231], v[188:189], v[228:229]
    v_and_b32 v239, 0xffff0000, v176
    v_pk_fma_f32 v[228:229], v[232:233], v[186:187], v[228:229]
    v_pk_fma_f32 v[228:229], v[234:235], v[184:185], v[228:229]
    v_pk_mul_f32 v[228:229], v[228:229], v[238:239]
    v_pk_mul_f32 v[230:231], v[230:231], v[190:191]
    v_lshlrev_b32 v240, 16, v180
    v_pk_fma_f32 v[230:231], v[232:233], v[188:189], v[230:231]
    v_and_b32 v241, 0xffff0000, v180
    v_pk_fma_f32 v[230:231], v[234:235], v[186:187], v[230:231]
    v_pk_fma_f32 v[230:231], v[236:237], v[184:185], v[230:231]
    v_pk_mul_f32 v[230:231], v[230:231], v[240:241]
    v_cvt_pk_bf16_f32 v242, v230, v228
    v_cvt_pk_bf16_f32 v243, v226, v224
    v_cvt_pk_bf16_f32 v244, v222, v220
    v_cvt_pk_bf16_f32 v245, v218, v216
    ds_write_b128 v12, v[242:245] offset:0
    v_cvt_pk_bf16_f32 v246, v231, v229
    v_cvt_pk_bf16_f32 v247, v227, v225
    v_cvt_pk_bf16_f32 v248, v223, v221
    v_cvt_pk_bf16_f32 v249, v219, v217
    ds_write_b128 v12, v[246:249] offset:128
    v_lshlrev_b32 v216, 16, v109
    v_and_b32 v217, 0xffff0000, v109
    v_lshlrev_b32 v218, 16, v113
    v_and_b32 v219, 0xffff0000, v113
    v_lshlrev_b32 v220, 16, v117
    v_and_b32 v221, 0xffff0000, v117
    v_lshlrev_b32 v222, 16, v121
    v_and_b32 v223, 0xffff0000, v121
    v_lshlrev_b32 v224, 16, v125
    v_and_b32 v225, 0xffff0000, v125
    v_lshlrev_b32 v226, 16, v129
    v_and_b32 v227, 0xffff0000, v129
    v_lshlrev_b32 v228, 16, v133
    v_and_b32 v229, 0xffff0000, v133
    v_lshlrev_b32 v230, 16, v137
    v_and_b32 v231, 0xffff0000, v137
    v_lshlrev_b32 v232, 16, v141
    v_and_b32 v233, 0xffff0000, v141
    v_lshlrev_b32 v234, 16, v145
    v_and_b32 v235, 0xffff0000, v145
    v_lshlrev_b32 v236, 16, v149
    v_and_b32 v237, 0xffff0000, v149
    v_pk_mul_f32 v[216:217], v[216:217], v[198:199]
    v_lshlrev_b32 v238, 16, v153
    v_pk_fma_f32 v[216:217], v[218:219], v[196:197], v[216:217]
    v_and_b32 v239, 0xffff0000, v153
    v_pk_fma_f32 v[216:217], v[220:221], v[194:195], v[216:217]
    v_pk_fma_f32 v[216:217], v[222:223], v[192:193], v[216:217]
    v_pk_mul_f32 v[216:217], v[216:217], v[238:239]
    v_pk_mul_f32 v[218:219], v[218:219], v[198:199]
    v_lshlrev_b32 v240, 16, v157
    v_pk_fma_f32 v[218:219], v[220:221], v[196:197], v[218:219]
    v_and_b32 v241, 0xffff0000, v157
    v_pk_fma_f32 v[218:219], v[222:223], v[194:195], v[218:219]
    v_pk_fma_f32 v[218:219], v[224:225], v[192:193], v[218:219]
    v_pk_mul_f32 v[218:219], v[218:219], v[240:241]
    v_pk_mul_f32 v[220:221], v[220:221], v[198:199]
    v_lshlrev_b32 v238, 16, v161
    v_pk_fma_f32 v[220:221], v[222:223], v[196:197], v[220:221]
    v_and_b32 v239, 0xffff0000, v161
    v_pk_fma_f32 v[220:221], v[224:225], v[194:195], v[220:221]
    v_pk_fma_f32 v[220:221], v[226:227], v[192:193], v[220:221]
    v_pk_mul_f32 v[220:221], v[220:221], v[238:239]
    v_pk_mul_f32 v[222:223], v[222:223], v[198:199]
    v_lshlrev_b32 v240, 16, v165
    v_pk_fma_f32 v[222:223], v[224:225], v[196:197], v[222:223]
    v_and_b32 v241, 0xffff0000, v165
    v_pk_fma_f32 v[222:223], v[226:227], v[194:195], v[222:223]
    v_pk_fma_f32 v[222:223], v[228:229], v[192:193], v[222:223]
    v_pk_mul_f32 v[222:223], v[222:223], v[240:241]
    v_pk_mul_f32 v[224:225], v[224:225], v[198:199]
    v_lshlrev_b32 v238, 16, v169
    v_pk_fma_f32 v[224:225], v[226:227], v[196:197], v[224:225]
    v_and_b32 v239, 0xffff0000, v169
    v_pk_fma_f32 v[224:225], v[228:229], v[194:195], v[224:225]
    v_pk_fma_f32 v[224:225], v[230:231], v[192:193], v[224:225]
    v_pk_mul_f32 v[224:225], v[224:225], v[238:239]
    v_pk_mul_f32 v[226:227], v[226:227], v[198:199]
    v_lshlrev_b32 v240, 16, v173
    v_pk_fma_f32 v[226:227], v[228:229], v[196:197], v[226:227]
    v_and_b32 v241, 0xffff0000, v173
    v_pk_fma_f32 v[226:227], v[230:231], v[194:195], v[226:227]
    v_pk_fma_f32 v[226:227], v[232:233], v[192:193], v[226:227]
    v_pk_mul_f32 v[226:227], v[226:227], v[240:241]
    v_pk_mul_f32 v[228:229], v[228:229], v[198:199]
    v_lshlrev_b32 v238, 16, v177
    v_pk_fma_f32 v[228:229], v[230:231], v[196:197], v[228:229]
    v_and_b32 v239, 0xffff0000, v177
    v_pk_fma_f32 v[228:229], v[232:233], v[194:195], v[228:229]
    v_pk_fma_f32 v[228:229], v[234:235], v[192:193], v[228:229]
    v_pk_mul_f32 v[228:229], v[228:229], v[238:239]
    v_pk_mul_f32 v[230:231], v[230:231], v[198:199]
    v_lshlrev_b32 v240, 16, v181
    v_pk_fma_f32 v[230:231], v[232:233], v[196:197], v[230:231]
    v_and_b32 v241, 0xffff0000, v181
    v_pk_fma_f32 v[230:231], v[234:235], v[194:195], v[230:231]
    v_pk_fma_f32 v[230:231], v[236:237], v[192:193], v[230:231]
    v_pk_mul_f32 v[230:231], v[230:231], v[240:241]
    v_cvt_pk_bf16_f32 v242, v230, v228
    v_cvt_pk_bf16_f32 v243, v226, v224
    v_cvt_pk_bf16_f32 v244, v222, v220
    v_cvt_pk_bf16_f32 v245, v218, v216
    ds_write_b128 v12, v[242:245] offset:256
    v_cvt_pk_bf16_f32 v246, v231, v229
    v_cvt_pk_bf16_f32 v247, v227, v225
    v_cvt_pk_bf16_f32 v248, v223, v221
    v_cvt_pk_bf16_f32 v249, v219, v217
    ds_write_b128 v12, v[246:249] offset:384
    v_lshlrev_b32 v216, 16, v110
    v_and_b32 v217, 0xffff0000, v110
    v_lshlrev_b32 v218, 16, v114
    v_and_b32 v219, 0xffff0000, v114
    v_lshlrev_b32 v220, 16, v118
    v_and_b32 v221, 0xffff0000, v118
    v_lshlrev_b32 v222, 16, v122
    v_and_b32 v223, 0xffff0000, v122
    v_lshlrev_b32 v224, 16, v126
    v_and_b32 v225, 0xffff0000, v126
    v_lshlrev_b32 v226, 16, v130
    v_and_b32 v227, 0xffff0000, v130
    v_lshlrev_b32 v228, 16, v134
    v_and_b32 v229, 0xffff0000, v134
    v_lshlrev_b32 v230, 16, v138
    v_and_b32 v231, 0xffff0000, v138
    v_lshlrev_b32 v232, 16, v142
    v_and_b32 v233, 0xffff0000, v142
    v_lshlrev_b32 v234, 16, v146
    v_and_b32 v235, 0xffff0000, v146
    v_lshlrev_b32 v236, 16, v150
    v_and_b32 v237, 0xffff0000, v150
    v_pk_mul_f32 v[216:217], v[216:217], v[206:207]
    v_lshlrev_b32 v238, 16, v154
    v_pk_fma_f32 v[216:217], v[218:219], v[204:205], v[216:217]
    v_and_b32 v239, 0xffff0000, v154
    v_pk_fma_f32 v[216:217], v[220:221], v[202:203], v[216:217]
    v_pk_fma_f32 v[216:217], v[222:223], v[200:201], v[216:217]
    v_pk_mul_f32 v[216:217], v[216:217], v[238:239]
    v_pk_mul_f32 v[218:219], v[218:219], v[206:207]
    v_lshlrev_b32 v240, 16, v158
    v_pk_fma_f32 v[218:219], v[220:221], v[204:205], v[218:219]
    v_and_b32 v241, 0xffff0000, v158
    v_pk_fma_f32 v[218:219], v[222:223], v[202:203], v[218:219]
    v_pk_fma_f32 v[218:219], v[224:225], v[200:201], v[218:219]
    v_pk_mul_f32 v[218:219], v[218:219], v[240:241]
    v_pk_mul_f32 v[220:221], v[220:221], v[206:207]
    v_lshlrev_b32 v238, 16, v162
    v_pk_fma_f32 v[220:221], v[222:223], v[204:205], v[220:221]
    v_and_b32 v239, 0xffff0000, v162
    v_pk_fma_f32 v[220:221], v[224:225], v[202:203], v[220:221]
    v_pk_fma_f32 v[220:221], v[226:227], v[200:201], v[220:221]
    v_pk_mul_f32 v[220:221], v[220:221], v[238:239]
    v_pk_mul_f32 v[222:223], v[222:223], v[206:207]
    v_lshlrev_b32 v240, 16, v166
    v_pk_fma_f32 v[222:223], v[224:225], v[204:205], v[222:223]
    v_and_b32 v241, 0xffff0000, v166
    v_pk_fma_f32 v[222:223], v[226:227], v[202:203], v[222:223]
    v_pk_fma_f32 v[222:223], v[228:229], v[200:201], v[222:223]
    v_pk_mul_f32 v[222:223], v[222:223], v[240:241]
    v_pk_mul_f32 v[224:225], v[224:225], v[206:207]
    v_lshlrev_b32 v238, 16, v170
    v_pk_fma_f32 v[224:225], v[226:227], v[204:205], v[224:225]
    v_and_b32 v239, 0xffff0000, v170
    v_pk_fma_f32 v[224:225], v[228:229], v[202:203], v[224:225]
    v_pk_fma_f32 v[224:225], v[230:231], v[200:201], v[224:225]
    v_pk_mul_f32 v[224:225], v[224:225], v[238:239]
    v_pk_mul_f32 v[226:227], v[226:227], v[206:207]
    v_lshlrev_b32 v240, 16, v174
    v_pk_fma_f32 v[226:227], v[228:229], v[204:205], v[226:227]
    v_and_b32 v241, 0xffff0000, v174
    v_pk_fma_f32 v[226:227], v[230:231], v[202:203], v[226:227]
    v_pk_fma_f32 v[226:227], v[232:233], v[200:201], v[226:227]
    v_pk_mul_f32 v[226:227], v[226:227], v[240:241]
    v_pk_mul_f32 v[228:229], v[228:229], v[206:207]
    v_lshlrev_b32 v238, 16, v178
    v_pk_fma_f32 v[228:229], v[230:231], v[204:205], v[228:229]
    v_and_b32 v239, 0xffff0000, v178
    v_pk_fma_f32 v[228:229], v[232:233], v[202:203], v[228:229]
    v_pk_fma_f32 v[228:229], v[234:235], v[200:201], v[228:229]
    v_pk_mul_f32 v[228:229], v[228:229], v[238:239]
    v_pk_mul_f32 v[230:231], v[230:231], v[206:207]
    v_lshlrev_b32 v240, 16, v182
    v_pk_fma_f32 v[230:231], v[232:233], v[204:205], v[230:231]
    v_and_b32 v241, 0xffff0000, v182
    v_pk_fma_f32 v[230:231], v[234:235], v[202:203], v[230:231]
    v_pk_fma_f32 v[230:231], v[236:237], v[200:201], v[230:231]
    v_pk_mul_f32 v[230:231], v[230:231], v[240:241]
    v_cvt_pk_bf16_f32 v242, v230, v228
    v_cvt_pk_bf16_f32 v243, v226, v224
    v_cvt_pk_bf16_f32 v244, v222, v220
    v_cvt_pk_bf16_f32 v245, v218, v216
    ds_write_b128 v12, v[242:245] offset:512
    v_cvt_pk_bf16_f32 v246, v231, v229
    v_cvt_pk_bf16_f32 v247, v227, v225
    v_cvt_pk_bf16_f32 v248, v223, v221
    v_cvt_pk_bf16_f32 v249, v219, v217
    ds_write_b128 v12, v[246:249] offset:640
    v_lshlrev_b32 v216, 16, v111
    v_and_b32 v217, 0xffff0000, v111
    v_lshlrev_b32 v218, 16, v115
    v_and_b32 v219, 0xffff0000, v115
    v_lshlrev_b32 v220, 16, v119
    v_and_b32 v221, 0xffff0000, v119
    v_lshlrev_b32 v222, 16, v123
    v_and_b32 v223, 0xffff0000, v123
    v_lshlrev_b32 v224, 16, v127
    v_and_b32 v225, 0xffff0000, v127
    v_lshlrev_b32 v226, 16, v131
    v_and_b32 v227, 0xffff0000, v131
    v_lshlrev_b32 v228, 16, v135
    v_and_b32 v229, 0xffff0000, v135
    v_lshlrev_b32 v230, 16, v139
    v_and_b32 v231, 0xffff0000, v139
    v_lshlrev_b32 v232, 16, v143
    v_and_b32 v233, 0xffff0000, v143
    v_lshlrev_b32 v234, 16, v147
    v_and_b32 v235, 0xffff0000, v147
    v_lshlrev_b32 v236, 16, v151
    v_and_b32 v237, 0xffff0000, v151
    v_pk_mul_f32 v[216:217], v[216:217], v[214:215]
    v_lshlrev_b32 v238, 16, v155
    v_pk_fma_f32 v[216:217], v[218:219], v[212:213], v[216:217]
    v_and_b32 v239, 0xffff0000, v155
    v_pk_fma_f32 v[216:217], v[220:221], v[210:211], v[216:217]
    v_pk_fma_f32 v[216:217], v[222:223], v[208:209], v[216:217]
    v_pk_mul_f32 v[216:217], v[216:217], v[238:239]
    v_pk_mul_f32 v[218:219], v[218:219], v[214:215]
    v_lshlrev_b32 v240, 16, v159
    v_pk_fma_f32 v[218:219], v[220:221], v[212:213], v[218:219]
    v_and_b32 v241, 0xffff0000, v159
    v_pk_fma_f32 v[218:219], v[222:223], v[210:211], v[218:219]
    v_pk_fma_f32 v[218:219], v[224:225], v[208:209], v[218:219]
    v_pk_mul_f32 v[218:219], v[218:219], v[240:241]
    v_pk_mul_f32 v[220:221], v[220:221], v[214:215]
    v_lshlrev_b32 v238, 16, v163
    v_pk_fma_f32 v[220:221], v[222:223], v[212:213], v[220:221]
    v_and_b32 v239, 0xffff0000, v163
    v_pk_fma_f32 v[220:221], v[224:225], v[210:211], v[220:221]
    v_pk_fma_f32 v[220:221], v[226:227], v[208:209], v[220:221]
    v_pk_mul_f32 v[220:221], v[220:221], v[238:239]
    v_pk_mul_f32 v[222:223], v[222:223], v[214:215]
    v_lshlrev_b32 v240, 16, v167
    v_pk_fma_f32 v[222:223], v[224:225], v[212:213], v[222:223]
    v_and_b32 v241, 0xffff0000, v167
    v_pk_fma_f32 v[222:223], v[226:227], v[210:211], v[222:223]
    v_pk_fma_f32 v[222:223], v[228:229], v[208:209], v[222:223]
    v_pk_mul_f32 v[222:223], v[222:223], v[240:241]
    v_pk_mul_f32 v[224:225], v[224:225], v[214:215]
    v_lshlrev_b32 v238, 16, v171
    v_pk_fma_f32 v[224:225], v[226:227], v[212:213], v[224:225]
    v_and_b32 v239, 0xffff0000, v171
    v_pk_fma_f32 v[224:225], v[228:229], v[210:211], v[224:225]
    v_pk_fma_f32 v[224:225], v[230:231], v[208:209], v[224:225]
    v_pk_mul_f32 v[224:225], v[224:225], v[238:239]
    v_pk_mul_f32 v[226:227], v[226:227], v[214:215]
    v_lshlrev_b32 v240, 16, v175
    v_pk_fma_f32 v[226:227], v[228:229], v[212:213], v[226:227]
    v_and_b32 v241, 0xffff0000, v175
    v_pk_fma_f32 v[226:227], v[230:231], v[210:211], v[226:227]
    v_pk_fma_f32 v[226:227], v[232:233], v[208:209], v[226:227]
    v_pk_mul_f32 v[226:227], v[226:227], v[240:241]
    v_pk_mul_f32 v[228:229], v[228:229], v[214:215]
    v_lshlrev_b32 v238, 16, v179
    v_pk_fma_f32 v[228:229], v[230:231], v[212:213], v[228:229]
    v_and_b32 v239, 0xffff0000, v179
    v_pk_fma_f32 v[228:229], v[232:233], v[210:211], v[228:229]
    v_pk_fma_f32 v[228:229], v[234:235], v[208:209], v[228:229]
    v_pk_mul_f32 v[228:229], v[228:229], v[238:239]
    v_pk_mul_f32 v[230:231], v[230:231], v[214:215]
    v_lshlrev_b32 v240, 16, v183
    v_pk_fma_f32 v[230:231], v[232:233], v[212:213], v[230:231]
    v_and_b32 v241, 0xffff0000, v183
    v_pk_fma_f32 v[230:231], v[234:235], v[210:211], v[230:231]
    v_pk_fma_f32 v[230:231], v[236:237], v[208:209], v[230:231]
    v_pk_mul_f32 v[230:231], v[230:231], v[240:241]
    v_cvt_pk_bf16_f32 v242, v230, v228
    v_cvt_pk_bf16_f32 v243, v226, v224
    v_cvt_pk_bf16_f32 v244, v222, v220
    v_cvt_pk_bf16_f32 v245, v218, v216
    ds_write_b128 v12, v[242:245] offset:768
    v_cvt_pk_bf16_f32 v246, v231, v229
    v_cvt_pk_bf16_f32 v247, v227, v225
    v_cvt_pk_bf16_f32 v248, v223, v221
    v_cvt_pk_bf16_f32 v249, v219, v217
    ds_write_b128 v12, v[246:249] offset:896
    v_subrev_u32 v11, 6144, v10
    buffer_load_dwordx4 v[108:111], v11, s[44:47], 0 offen nt
    v_subrev_u32 v11, 4096, v10
    buffer_load_dwordx4 v[112:115], v11, s[44:47], 0 offen nt
    v_subrev_u32 v11, 2048, v10
    buffer_load_dwordx4 v[116:119], v11, s[44:47], 0 offen nt
    s_mov_b32 s4, 0
    buffer_load_dwordx4 v[120:123], v10, s[44:47], s4 offen offset:0 nt
    buffer_load_dwordx4 v[152:155], v10, s[48:51], s4 offen offset:0 nt
    buffer_load_dwordx4 v[124:127], v10, s[44:47], s4 offen offset:2048 nt
    buffer_load_dwordx4 v[156:159], v10, s[48:51], s4 offen offset:2048 nt
    s_mov_b32 s4, 4096
    buffer_load_dwordx4 v[128:131], v10, s[44:47], s4 offen offset:0 nt
    buffer_load_dwordx4 v[160:163], v10, s[48:51], s4 offen offset:0 nt
    buffer_load_dwordx4 v[132:135], v10, s[44:47], s4 offen offset:2048 nt
    buffer_load_dwordx4 v[164:167], v10, s[48:51], s4 offen offset:2048 nt
    s_mov_b32 s4, 8192
    buffer_load_dwordx4 v[136:139], v10, s[44:47], s4 offen offset:0 nt
    buffer_load_dwordx4 v[168:171], v10, s[48:51], s4 offen offset:0 nt
    buffer_load_dwordx4 v[140:143], v10, s[44:47], s4 offen offset:2048 nt
    buffer_load_dwordx4 v[172:175], v10, s[48:51], s4 offen offset:2048 nt
    s_mov_b32 s4, 12288
    buffer_load_dwordx4 v[144:147], v10, s[44:47], s4 offen offset:0 nt
    buffer_load_dwordx4 v[176:179], v10, s[48:51], s4 offen offset:0 nt
    buffer_load_dwordx4 v[148:151], v10, s[44:47], s4 offen offset:2048 nt
    buffer_load_dwordx4 v[180:183], v10, s[48:51], s4 offen offset:2048 nt
    v_add_u32 v10, 16384, v10
    v_xor_b32 v12, 32, v13
    s_waitcnt vmcnt(19)
    v_lshlrev_b32 v216, 16, v32
    v_and_b32 v217, 0xffff0000, v32
    v_lshlrev_b32 v218, 16, v36
    v_and_b32 v219, 0xffff0000, v36
    v_lshlrev_b32 v220, 16, v40
    v_and_b32 v221, 0xffff0000, v40
    v_lshlrev_b32 v222, 16, v44
    v_and_b32 v223, 0xffff0000, v44
    v_lshlrev_b32 v224, 16, v48
    v_and_b32 v225, 0xffff0000, v48
    v_lshlrev_b32 v226, 16, v52
    v_and_b32 v227, 0xffff0000, v52
    v_lshlrev_b32 v228, 16, v56
    v_and_b32 v229, 0xffff0000, v56
    v_lshlrev_b32 v230, 16, v60
    v_and_b32 v231, 0xffff0000, v60
    v_lshlrev_b32 v232, 16, v64
    v_and_b32 v233, 0xffff0000, v64
    v_lshlrev_b32 v234, 16, v68
    v_and_b32 v235, 0xffff0000, v68
    v_lshlrev_b32 v236, 16, v72
    v_and_b32 v237, 0xffff0000, v72
    v_pk_mul_f32 v[216:217], v[216:217], v[190:191]
    v_lshlrev_b32 v238, 16, v76
    v_pk_fma_f32 v[216:217], v[218:219], v[188:189], v[216:217]
    v_and_b32 v239, 0xffff0000, v76
    v_pk_fma_f32 v[216:217], v[220:221], v[186:187], v[216:217]
    v_pk_fma_f32 v[216:217], v[222:223], v[184:185], v[216:217]
    v_pk_mul_f32 v[216:217], v[216:217], v[238:239]
    v_pk_mul_f32 v[218:219], v[218:219], v[190:191]
    v_lshlrev_b32 v240, 16, v80
    v_pk_fma_f32 v[218:219], v[220:221], v[188:189], v[218:219]
    v_and_b32 v241, 0xffff0000, v80
    v_pk_fma_f32 v[218:219], v[222:223], v[186:187], v[218:219]
    v_pk_fma_f32 v[218:219], v[224:225], v[184:185], v[218:219]
    v_pk_mul_f32 v[218:219], v[218:219], v[240:241]
    v_pk_mul_f32 v[220:221], v[220:221], v[190:191]
    v_lshlrev_b32 v238, 16, v84
    v_pk_fma_f32 v[220:221], v[222:223], v[188:189], v[220:221]
    v_and_b32 v239, 0xffff0000, v84
    v_pk_fma_f32 v[220:221], v[224:225], v[186:187], v[220:221]
    v_pk_fma_f32 v[220:221], v[226:227], v[184:185], v[220:221]
    v_pk_mul_f32 v[220:221], v[220:221], v[238:239]
    v_pk_mul_f32 v[222:223], v[222:223], v[190:191]
    v_lshlrev_b32 v240, 16, v88
    v_pk_fma_f32 v[222:223], v[224:225], v[188:189], v[222:223]
    v_and_b32 v241, 0xffff0000, v88
    v_pk_fma_f32 v[222:223], v[226:227], v[186:187], v[222:223]
    v_pk_fma_f32 v[222:223], v[228:229], v[184:185], v[222:223]
    v_pk_mul_f32 v[222:223], v[222:223], v[240:241]
    v_pk_mul_f32 v[224:225], v[224:225], v[190:191]
    v_lshlrev_b32 v238, 16, v92
    v_pk_fma_f32 v[224:225], v[226:227], v[188:189], v[224:225]
    v_and_b32 v239, 0xffff0000, v92
    v_pk_fma_f32 v[224:225], v[228:229], v[186:187], v[224:225]
    v_pk_fma_f32 v[224:225], v[230:231], v[184:185], v[224:225]
    v_pk_mul_f32 v[224:225], v[224:225], v[238:239]
    v_pk_mul_f32 v[226:227], v[226:227], v[190:191]
    v_lshlrev_b32 v240, 16, v96
    v_pk_fma_f32 v[226:227], v[228:229], v[188:189], v[226:227]
    v_and_b32 v241, 0xffff0000, v96
    v_pk_fma_f32 v[226:227], v[230:231], v[186:187], v[226:227]
    v_pk_fma_f32 v[226:227], v[232:233], v[184:185], v[226:227]
    v_pk_mul_f32 v[226:227], v[226:227], v[240:241]
    v_pk_mul_f32 v[228:229], v[228:229], v[190:191]
    v_lshlrev_b32 v238, 16, v100
    v_pk_fma_f32 v[228:229], v[230:231], v[188:189], v[228:229]
    v_and_b32 v239, 0xffff0000, v100
    v_pk_fma_f32 v[228:229], v[232:233], v[186:187], v[228:229]
    v_pk_fma_f32 v[228:229], v[234:235], v[184:185], v[228:229]
    v_pk_mul_f32 v[228:229], v[228:229], v[238:239]
    v_pk_mul_f32 v[230:231], v[230:231], v[190:191]
    v_lshlrev_b32 v240, 16, v104
    v_pk_fma_f32 v[230:231], v[232:233], v[188:189], v[230:231]
    v_and_b32 v241, 0xffff0000, v104
    v_pk_fma_f32 v[230:231], v[234:235], v[186:187], v[230:231]
    v_pk_fma_f32 v[230:231], v[236:237], v[184:185], v[230:231]
    v_pk_mul_f32 v[230:231], v[230:231], v[240:241]
    v_cvt_pk_bf16_f32 v242, v230, v228
    v_cvt_pk_bf16_f32 v243, v226, v224
    v_cvt_pk_bf16_f32 v244, v222, v220
    v_cvt_pk_bf16_f32 v245, v218, v216
    ds_write_b128 v12, v[242:245] offset:0
    v_cvt_pk_bf16_f32 v246, v231, v229
    v_cvt_pk_bf16_f32 v247, v227, v225
    v_cvt_pk_bf16_f32 v248, v223, v221
    v_cvt_pk_bf16_f32 v249, v219, v217
    ds_write_b128 v12, v[246:249] offset:128
    v_lshlrev_b32 v216, 16, v33
    v_and_b32 v217, 0xffff0000, v33
    v_lshlrev_b32 v218, 16, v37
    v_and_b32 v219, 0xffff0000, v37
    v_lshlrev_b32 v220, 16, v41
    v_and_b32 v221, 0xffff0000, v41
    v_lshlrev_b32 v222, 16, v45
    v_and_b32 v223, 0xffff0000, v45
    v_lshlrev_b32 v224, 16, v49
    v_and_b32 v225, 0xffff0000, v49
    v_lshlrev_b32 v226, 16, v53
    v_and_b32 v227, 0xffff0000, v53
    v_lshlrev_b32 v228, 16, v57
    v_and_b32 v229, 0xffff0000, v57
    v_lshlrev_b32 v230, 16, v61
    v_and_b32 v231, 0xffff0000, v61
    v_lshlrev_b32 v232, 16, v65
    v_and_b32 v233, 0xffff0000, v65
    v_lshlrev_b32 v234, 16, v69
    v_and_b32 v235, 0xffff0000, v69
    v_lshlrev_b32 v236, 16, v73
    v_and_b32 v237, 0xffff0000, v73
    v_pk_mul_f32 v[216:217], v[216:217], v[198:199]
    v_lshlrev_b32 v238, 16, v77
    v_pk_fma_f32 v[216:217], v[218:219], v[196:197], v[216:217]
    v_and_b32 v239, 0xffff0000, v77
    v_pk_fma_f32 v[216:217], v[220:221], v[194:195], v[216:217]
    v_pk_fma_f32 v[216:217], v[222:223], v[192:193], v[216:217]
    v_pk_mul_f32 v[216:217], v[216:217], v[238:239]
    v_pk_mul_f32 v[218:219], v[218:219], v[198:199]
    v_lshlrev_b32 v240, 16, v81
    v_pk_fma_f32 v[218:219], v[220:221], v[196:197], v[218:219]
    v_and_b32 v241, 0xffff0000, v81
    v_pk_fma_f32 v[218:219], v[222:223], v[194:195], v[218:219]
    v_pk_fma_f32 v[218:219], v[224:225], v[192:193], v[218:219]
    v_pk_mul_f32 v[218:219], v[218:219], v[240:241]
    v_pk_mul_f32 v[220:221], v[220:221], v[198:199]
    v_lshlrev_b32 v238, 16, v85
    v_pk_fma_f32 v[220:221], v[222:223], v[196:197], v[220:221]
    v_and_b32 v239, 0xffff0000, v85
    v_pk_fma_f32 v[220:221], v[224:225], v[194:195], v[220:221]
    v_pk_fma_f32 v[220:221], v[226:227], v[192:193], v[220:221]
    v_pk_mul_f32 v[220:221], v[220:221], v[238:239]
    v_pk_mul_f32 v[222:223], v[222:223], v[198:199]
    v_lshlrev_b32 v240, 16, v89
    v_pk_fma_f32 v[222:223], v[224:225], v[196:197], v[222:223]
    v_and_b32 v241, 0xffff0000, v89
    v_pk_fma_f32 v[222:223], v[226:227], v[194:195], v[222:223]
    v_pk_fma_f32 v[222:223], v[228:229], v[192:193], v[222:223]
    v_pk_mul_f32 v[222:223], v[222:223], v[240:241]
    v_pk_mul_f32 v[224:225], v[224:225], v[198:199]
    v_lshlrev_b32 v238, 16, v93
    v_pk_fma_f32 v[224:225], v[226:227], v[196:197], v[224:225]
    v_and_b32 v239, 0xffff0000, v93
    v_pk_fma_f32 v[224:225], v[228:229], v[194:195], v[224:225]
    v_pk_fma_f32 v[224:225], v[230:231], v[192:193], v[224:225]
    v_pk_mul_f32 v[224:225], v[224:225], v[238:239]
    v_pk_mul_f32 v[226:227], v[226:227], v[198:199]
    v_lshlrev_b32 v240, 16, v97
    v_pk_fma_f32 v[226:227], v[228:229], v[196:197], v[226:227]
    v_and_b32 v241, 0xffff0000, v97
    v_pk_fma_f32 v[226:227], v[230:231], v[194:195], v[226:227]
    v_pk_fma_f32 v[226:227], v[232:233], v[192:193], v[226:227]
    v_pk_mul_f32 v[226:227], v[226:227], v[240:241]
    v_pk_mul_f32 v[228:229], v[228:229], v[198:199]
    v_lshlrev_b32 v238, 16, v101
    v_pk_fma_f32 v[228:229], v[230:231], v[196:197], v[228:229]
    v_and_b32 v239, 0xffff0000, v101
    v_pk_fma_f32 v[228:229], v[232:233], v[194:195], v[228:229]
    v_pk_fma_f32 v[228:229], v[234:235], v[192:193], v[228:229]
    v_pk_mul_f32 v[228:229], v[228:229], v[238:239]
    v_pk_mul_f32 v[230:231], v[230:231], v[198:199]
    v_lshlrev_b32 v240, 16, v105
    v_pk_fma_f32 v[230:231], v[232:233], v[196:197], v[230:231]
    v_and_b32 v241, 0xffff0000, v105
    v_pk_fma_f32 v[230:231], v[234:235], v[194:195], v[230:231]
    v_pk_fma_f32 v[230:231], v[236:237], v[192:193], v[230:231]
    v_pk_mul_f32 v[230:231], v[230:231], v[240:241]
    v_cvt_pk_bf16_f32 v242, v230, v228
    v_cvt_pk_bf16_f32 v243, v226, v224
    v_cvt_pk_bf16_f32 v244, v222, v220
    v_cvt_pk_bf16_f32 v245, v218, v216
    ds_write_b128 v12, v[242:245] offset:256
    v_cvt_pk_bf16_f32 v246, v231, v229
    v_cvt_pk_bf16_f32 v247, v227, v225
    v_cvt_pk_bf16_f32 v248, v223, v221
    v_cvt_pk_bf16_f32 v249, v219, v217
    ds_write_b128 v12, v[246:249] offset:384
    v_lshlrev_b32 v216, 16, v34
    v_and_b32 v217, 0xffff0000, v34
    v_lshlrev_b32 v218, 16, v38
    v_and_b32 v219, 0xffff0000, v38
    v_lshlrev_b32 v220, 16, v42
    v_and_b32 v221, 0xffff0000, v42
    v_lshlrev_b32 v222, 16, v46
    v_and_b32 v223, 0xffff0000, v46
    v_lshlrev_b32 v224, 16, v50
    v_and_b32 v225, 0xffff0000, v50
    v_lshlrev_b32 v226, 16, v54
    v_and_b32 v227, 0xffff0000, v54
    v_lshlrev_b32 v228, 16, v58
    v_and_b32 v229, 0xffff0000, v58
    v_lshlrev_b32 v230, 16, v62
    v_and_b32 v231, 0xffff0000, v62
    v_lshlrev_b32 v232, 16, v66
    v_and_b32 v233, 0xffff0000, v66
    v_lshlrev_b32 v234, 16, v70
    v_and_b32 v235, 0xffff0000, v70
    v_lshlrev_b32 v236, 16, v74
    v_and_b32 v237, 0xffff0000, v74
    v_pk_mul_f32 v[216:217], v[216:217], v[206:207]
    v_lshlrev_b32 v238, 16, v78
    v_pk_fma_f32 v[216:217], v[218:219], v[204:205], v[216:217]
    v_and_b32 v239, 0xffff0000, v78
    v_pk_fma_f32 v[216:217], v[220:221], v[202:203], v[216:217]
    v_pk_fma_f32 v[216:217], v[222:223], v[200:201], v[216:217]
    v_pk_mul_f32 v[216:217], v[216:217], v[238:239]
    v_pk_mul_f32 v[218:219], v[218:219], v[206:207]
    v_lshlrev_b32 v240, 16, v82
    v_pk_fma_f32 v[218:219], v[220:221], v[204:205], v[218:219]
    v_and_b32 v241, 0xffff0000, v82
    v_pk_fma_f32 v[218:219], v[222:223], v[202:203], v[218:219]
    v_pk_fma_f32 v[218:219], v[224:225], v[200:201], v[218:219]
    v_pk_mul_f32 v[218:219], v[218:219], v[240:241]
    v_pk_mul_f32 v[220:221], v[220:221], v[206:207]
    v_lshlrev_b32 v238, 16, v86
    v_pk_fma_f32 v[220:221], v[222:223], v[204:205], v[220:221]
    v_and_b32 v239, 0xffff0000, v86
    v_pk_fma_f32 v[220:221], v[224:225], v[202:203], v[220:221]
    v_pk_fma_f32 v[220:221], v[226:227], v[200:201], v[220:221]
    v_pk_mul_f32 v[220:221], v[220:221], v[238:239]
    v_pk_mul_f32 v[222:223], v[222:223], v[206:207]
    v_lshlrev_b32 v240, 16, v90
    v_pk_fma_f32 v[222:223], v[224:225], v[204:205], v[222:223]
    v_and_b32 v241, 0xffff0000, v90
    v_pk_fma_f32 v[222:223], v[226:227], v[202:203], v[222:223]
    v_pk_fma_f32 v[222:223], v[228:229], v[200:201], v[222:223]
    v_pk_mul_f32 v[222:223], v[222:223], v[240:241]
    v_pk_mul_f32 v[224:225], v[224:225], v[206:207]
    v_lshlrev_b32 v238, 16, v94
    v_pk_fma_f32 v[224:225], v[226:227], v[204:205], v[224:225]
    v_and_b32 v239, 0xffff0000, v94
    v_pk_fma_f32 v[224:225], v[228:229], v[202:203], v[224:225]
    v_pk_fma_f32 v[224:225], v[230:231], v[200:201], v[224:225]
    v_pk_mul_f32 v[224:225], v[224:225], v[238:239]
    v_pk_mul_f32 v[226:227], v[226:227], v[206:207]
    v_lshlrev_b32 v240, 16, v98
    v_pk_fma_f32 v[226:227], v[228:229], v[204:205], v[226:227]
    v_and_b32 v241, 0xffff0000, v98
    v_pk_fma_f32 v[226:227], v[230:231], v[202:203], v[226:227]
    v_pk_fma_f32 v[226:227], v[232:233], v[200:201], v[226:227]
    v_pk_mul_f32 v[226:227], v[226:227], v[240:241]
    v_pk_mul_f32 v[228:229], v[228:229], v[206:207]
    v_lshlrev_b32 v238, 16, v102
    v_pk_fma_f32 v[228:229], v[230:231], v[204:205], v[228:229]
    v_and_b32 v239, 0xffff0000, v102
    v_pk_fma_f32 v[228:229], v[232:233], v[202:203], v[228:229]
    v_pk_fma_f32 v[228:229], v[234:235], v[200:201], v[228:229]
    v_pk_mul_f32 v[228:229], v[228:229], v[238:239]
    v_pk_mul_f32 v[230:231], v[230:231], v[206:207]
    v_lshlrev_b32 v240, 16, v106
    v_pk_fma_f32 v[230:231], v[232:233], v[204:205], v[230:231]
    v_and_b32 v241, 0xffff0000, v106
    v_pk_fma_f32 v[230:231], v[234:235], v[202:203], v[230:231]
    v_pk_fma_f32 v[230:231], v[236:237], v[200:201], v[230:231]
    v_pk_mul_f32 v[230:231], v[230:231], v[240:241]
    v_cvt_pk_bf16_f32 v242, v230, v228
    v_cvt_pk_bf16_f32 v243, v226, v224
    v_cvt_pk_bf16_f32 v244, v222, v220
    v_cvt_pk_bf16_f32 v245, v218, v216
    ds_write_b128 v12, v[242:245] offset:512
    v_cvt_pk_bf16_f32 v246, v231, v229
    v_cvt_pk_bf16_f32 v247, v227, v225
    v_cvt_pk_bf16_f32 v248, v223, v221
    v_cvt_pk_bf16_f32 v249, v219, v217
    ds_write_b128 v12, v[246:249] offset:640
    v_lshlrev_b32 v216, 16, v35
    v_and_b32 v217, 0xffff0000, v35
    v_lshlrev_b32 v218, 16, v39
    v_and_b32 v219, 0xffff0000, v39
    v_lshlrev_b32 v220, 16, v43
    v_and_b32 v221, 0xffff0000, v43
    v_lshlrev_b32 v222, 16, v47
    v_and_b32 v223, 0xffff0000, v47
    v_lshlrev_b32 v224, 16, v51
    v_and_b32 v225, 0xffff0000, v51
    v_lshlrev_b32 v226, 16, v55
    v_and_b32 v227, 0xffff0000, v55
    v_lshlrev_b32 v228, 16, v59
    v_and_b32 v229, 0xffff0000, v59
    v_lshlrev_b32 v230, 16, v63
    v_and_b32 v231, 0xffff0000, v63
    v_lshlrev_b32 v232, 16, v67
    v_and_b32 v233, 0xffff0000, v67
    v_lshlrev_b32 v234, 16, v71
    v_and_b32 v235, 0xffff0000, v71
    v_lshlrev_b32 v236, 16, v75
    v_and_b32 v237, 0xffff0000, v75
    v_pk_mul_f32 v[216:217], v[216:217], v[214:215]
    v_lshlrev_b32 v238, 16, v79
    v_pk_fma_f32 v[216:217], v[218:219], v[212:213], v[216:217]
    v_and_b32 v239, 0xffff0000, v79
    v_pk_fma_f32 v[216:217], v[220:221], v[210:211], v[216:217]
    v_pk_fma_f32 v[216:217], v[222:223], v[208:209], v[216:217]
    v_pk_mul_f32 v[216:217], v[216:217], v[238:239]
    v_pk_mul_f32 v[218:219], v[218:219], v[214:215]
    v_lshlrev_b32 v240, 16, v83
    v_pk_fma_f32 v[218:219], v[220:221], v[212:213], v[218:219]
    v_and_b32 v241, 0xffff0000, v83
    v_pk_fma_f32 v[218:219], v[222:223], v[210:211], v[218:219]
    v_pk_fma_f32 v[218:219], v[224:225], v[208:209], v[218:219]
    v_pk_mul_f32 v[218:219], v[218:219], v[240:241]
    v_pk_mul_f32 v[220:221], v[220:221], v[214:215]
    v_lshlrev_b32 v238, 16, v87
    v_pk_fma_f32 v[220:221], v[222:223], v[212:213], v[220:221]
    v_and_b32 v239, 0xffff0000, v87
    v_pk_fma_f32 v[220:221], v[224:225], v[210:211], v[220:221]
    v_pk_fma_f32 v[220:221], v[226:227], v[208:209], v[220:221]
    v_pk_mul_f32 v[220:221], v[220:221], v[238:239]
    v_pk_mul_f32 v[222:223], v[222:223], v[214:215]
    v_lshlrev_b32 v240, 16, v91
    v_pk_fma_f32 v[222:223], v[224:225], v[212:213], v[222:223]
    v_and_b32 v241, 0xffff0000, v91
    v_pk_fma_f32 v[222:223], v[226:227], v[210:211], v[222:223]
    v_pk_fma_f32 v[222:223], v[228:229], v[208:209], v[222:223]
    v_pk_mul_f32 v[222:223], v[222:223], v[240:241]
    v_pk_mul_f32 v[224:225], v[224:225], v[214:215]
    v_lshlrev_b32 v238, 16, v95
    v_pk_fma_f32 v[224:225], v[226:227], v[212:213], v[224:225]
    v_and_b32 v239, 0xffff0000, v95
    v_pk_fma_f32 v[224:225], v[228:229], v[210:211], v[224:225]
    v_pk_fma_f32 v[224:225], v[230:231], v[208:209], v[224:225]
    v_pk_mul_f32 v[224:225], v[224:225], v[238:239]
    v_pk_mul_f32 v[226:227], v[226:227], v[214:215]
    v_lshlrev_b32 v240, 16, v99
    v_pk_fma_f32 v[226:227], v[228:229], v[212:213], v[226:227]
    v_and_b32 v241, 0xffff0000, v99
    v_pk_fma_f32 v[226:227], v[230:231], v[210:211], v[226:227]
    v_pk_fma_f32 v[226:227], v[232:233], v[208:209], v[226:227]
    v_pk_mul_f32 v[226:227], v[226:227], v[240:241]
    v_pk_mul_f32 v[228:229], v[228:229], v[214:215]
    v_lshlrev_b32 v238, 16, v103
    v_pk_fma_f32 v[228:229], v[230:231], v[212:213], v[228:229]
    v_and_b32 v239, 0xffff0000, v103
    v_pk_fma_f32 v[228:229], v[232:233], v[210:211], v[228:229]
    v_pk_fma_f32 v[228:229], v[234:235], v[208:209], v[228:229]
    v_pk_mul_f32 v[228:229], v[228:229], v[238:239]
    v_pk_mul_f32 v[230:231], v[230:231], v[214:215]
    v_lshlrev_b32 v240, 16, v107
    v_pk_fma_f32 v[230:231], v[232:233], v[212:213], v[230:231]
    v_and_b32 v241, 0xffff0000, v107
    v_pk_fma_f32 v[230:231], v[234:235], v[210:211], v[230:231]
    v_pk_fma_f32 v[230:231], v[236:237], v[208:209], v[230:231]
    v_pk_mul_f32 v[230:231], v[230:231], v[240:241]
    v_cvt_pk_bf16_f32 v242, v230, v228
    v_cvt_pk_bf16_f32 v243, v226, v224
    v_cvt_pk_bf16_f32 v244, v222, v220
    v_cvt_pk_bf16_f32 v245, v218, v216
    ds_write_b128 v12, v[242:245] offset:768
    v_cvt_pk_bf16_f32 v246, v231, v229
    v_cvt_pk_bf16_f32 v247, v227, v225
    v_cvt_pk_bf16_f32 v248, v223, v221
    v_cvt_pk_bf16_f32 v249, v219, v217
    ds_write_b128 v12, v[246:249] offset:896
    v_xor_b32 v12, 48, v13
    s_waitcnt vmcnt(0)
    v_lshlrev_b32 v216, 16, v108
    v_and_b32 v217, 0xffff0000, v108
    v_lshlrev_b32 v218, 16, v112
    v_and_b32 v219, 0xffff0000, v112
    v_lshlrev_b32 v220, 16, v116
    v_and_b32 v221, 0xffff0000, v116
    v_lshlrev_b32 v222, 16, v120
    v_and_b32 v223, 0xffff0000, v120
    v_lshlrev_b32 v224, 16, v124
    v_and_b32 v225, 0xffff0000, v124
    v_lshlrev_b32 v226, 16, v128
    v_and_b32 v227, 0xffff0000, v128
    v_lshlrev_b32 v228, 16, v132
    v_and_b32 v229, 0xffff0000, v132
    v_lshlrev_b32 v230, 16, v136
    v_and_b32 v231, 0xffff0000, v136
    v_lshlrev_b32 v232, 16, v140
    v_and_b32 v233, 0xffff0000, v140
    v_lshlrev_b32 v234, 16, v144
    v_and_b32 v235, 0xffff0000, v144
    v_lshlrev_b32 v236, 16, v148
    v_and_b32 v237, 0xffff0000, v148
    v_pk_mul_f32 v[216:217], v[216:217], v[190:191]
    v_lshlrev_b32 v238, 16, v152
    v_pk_fma_f32 v[216:217], v[218:219], v[188:189], v[216:217]
    v_and_b32 v239, 0xffff0000, v152
    v_pk_fma_f32 v[216:217], v[220:221], v[186:187], v[216:217]
    v_pk_fma_f32 v[216:217], v[222:223], v[184:185], v[216:217]
    v_pk_mul_f32 v[216:217], v[216:217], v[238:239]
    v_pk_mul_f32 v[218:219], v[218:219], v[190:191]
    v_lshlrev_b32 v240, 16, v156
    v_pk_fma_f32 v[218:219], v[220:221], v[188:189], v[218:219]
    v_and_b32 v241, 0xffff0000, v156
    v_pk_fma_f32 v[218:219], v[222:223], v[186:187], v[218:219]
    v_pk_fma_f32 v[218:219], v[224:225], v[184:185], v[218:219]
    v_pk_mul_f32 v[218:219], v[218:219], v[240:241]
    v_pk_mul_f32 v[220:221], v[220:221], v[190:191]
    v_lshlrev_b32 v238, 16, v160
    v_pk_fma_f32 v[220:221], v[222:223], v[188:189], v[220:221]
    v_and_b32 v239, 0xffff0000, v160
    v_pk_fma_f32 v[220:221], v[224:225], v[186:187], v[220:221]
    v_pk_fma_f32 v[220:221], v[226:227], v[184:185], v[220:221]
    v_pk_mul_f32 v[220:221], v[220:221], v[238:239]
    v_pk_mul_f32 v[222:223], v[222:223], v[190:191]
    v_lshlrev_b32 v240, 16, v164
    v_pk_fma_f32 v[222:223], v[224:225], v[188:189], v[222:223]
    v_and_b32 v241, 0xffff0000, v164
    v_pk_fma_f32 v[222:223], v[226:227], v[186:187], v[222:223]
    v_pk_fma_f32 v[222:223], v[228:229], v[184:185], v[222:223]
    v_pk_mul_f32 v[222:223], v[222:223], v[240:241]
    v_pk_mul_f32 v[224:225], v[224:225], v[190:191]
    v_lshlrev_b32 v238, 16, v168
    v_pk_fma_f32 v[224:225], v[226:227], v[188:189], v[224:225]
    v_and_b32 v239, 0xffff0000, v168
    v_pk_fma_f32 v[224:225], v[228:229], v[186:187], v[224:225]
    v_pk_fma_f32 v[224:225], v[230:231], v[184:185], v[224:225]
    v_pk_mul_f32 v[224:225], v[224:225], v[238:239]
    v_pk_mul_f32 v[226:227], v[226:227], v[190:191]
    v_lshlrev_b32 v240, 16, v172
    v_pk_fma_f32 v[226:227], v[228:229], v[188:189], v[226:227]
    v_and_b32 v241, 0xffff0000, v172
    v_pk_fma_f32 v[226:227], v[230:231], v[186:187], v[226:227]
    v_pk_fma_f32 v[226:227], v[232:233], v[184:185], v[226:227]
    v_pk_mul_f32 v[226:227], v[226:227], v[240:241]
    v_pk_mul_f32 v[228:229], v[228:229], v[190:191]
    v_lshlrev_b32 v238, 16, v176
    v_pk_fma_f32 v[228:229], v[230:231], v[188:189], v[228:229]
    v_and_b32 v239, 0xffff0000, v176
    v_pk_fma_f32 v[228:229], v[232:233], v[186:187], v[228:229]
    v_pk_fma_f32 v[228:229], v[234:235], v[184:185], v[228:229]
    v_pk_mul_f32 v[228:229], v[228:229], v[238:239]
    v_pk_mul_f32 v[230:231], v[230:231], v[190:191]
    v_lshlrev_b32 v240, 16, v180
    v_pk_fma_f32 v[230:231], v[232:233], v[188:189], v[230:231]
    v_and_b32 v241, 0xffff0000, v180
    v_pk_fma_f32 v[230:231], v[234:235], v[186:187], v[230:231]
    v_pk_fma_f32 v[230:231], v[236:237], v[184:185], v[230:231]
    v_pk_mul_f32 v[230:231], v[230:231], v[240:241]
    v_cvt_pk_bf16_f32 v242, v230, v228
    v_cvt_pk_bf16_f32 v243, v226, v224
    v_cvt_pk_bf16_f32 v244, v222, v220
    v_cvt_pk_bf16_f32 v245, v218, v216
    ds_write_b128 v12, v[242:245] offset:0
    v_cvt_pk_bf16_f32 v246, v231, v229
    v_cvt_pk_bf16_f32 v247, v227, v225
    v_cvt_pk_bf16_f32 v248, v223, v221
    v_cvt_pk_bf16_f32 v249, v219, v217
    ds_write_b128 v12, v[246:249] offset:128
    v_lshlrev_b32 v216, 16, v109
    v_and_b32 v217, 0xffff0000, v109
    v_lshlrev_b32 v218, 16, v113
    v_and_b32 v219, 0xffff0000, v113
    v_lshlrev_b32 v220, 16, v117
    v_and_b32 v221, 0xffff0000, v117
    v_lshlrev_b32 v222, 16, v121
    v_and_b32 v223, 0xffff0000, v121
    v_lshlrev_b32 v224, 16, v125
    v_and_b32 v225, 0xffff0000, v125
    v_lshlrev_b32 v226, 16, v129
    v_and_b32 v227, 0xffff0000, v129
    v_lshlrev_b32 v228, 16, v133
    v_and_b32 v229, 0xffff0000, v133
    v_lshlrev_b32 v230, 16, v137
    v_and_b32 v231, 0xffff0000, v137
    v_lshlrev_b32 v232, 16, v141
    v_and_b32 v233, 0xffff0000, v141
    v_lshlrev_b32 v234, 16, v145
    v_and_b32 v235, 0xffff0000, v145
    v_lshlrev_b32 v236, 16, v149
    v_and_b32 v237, 0xffff0000, v149
    v_pk_mul_f32 v[216:217], v[216:217], v[198:199]
    v_lshlrev_b32 v238, 16, v153
    v_pk_fma_f32 v[216:217], v[218:219], v[196:197], v[216:217]
    v_and_b32 v239, 0xffff0000, v153
    v_pk_fma_f32 v[216:217], v[220:221], v[194:195], v[216:217]
    v_pk_fma_f32 v[216:217], v[222:223], v[192:193], v[216:217]
    v_pk_mul_f32 v[216:217], v[216:217], v[238:239]
    v_pk_mul_f32 v[218:219], v[218:219], v[198:199]
    v_lshlrev_b32 v240, 16, v157
    v_pk_fma_f32 v[218:219], v[220:221], v[196:197], v[218:219]
    v_and_b32 v241, 0xffff0000, v157
    v_pk_fma_f32 v[218:219], v[222:223], v[194:195], v[218:219]
    v_pk_fma_f32 v[218:219], v[224:225], v[192:193], v[218:219]
    v_pk_mul_f32 v[218:219], v[218:219], v[240:241]
    v_pk_mul_f32 v[220:221], v[220:221], v[198:199]
    v_lshlrev_b32 v238, 16, v161
    v_pk_fma_f32 v[220:221], v[222:223], v[196:197], v[220:221]
    v_and_b32 v239, 0xffff0000, v161
    v_pk_fma_f32 v[220:221], v[224:225], v[194:195], v[220:221]
    v_pk_fma_f32 v[220:221], v[226:227], v[192:193], v[220:221]
    v_pk_mul_f32 v[220:221], v[220:221], v[238:239]
    v_pk_mul_f32 v[222:223], v[222:223], v[198:199]
    v_lshlrev_b32 v240, 16, v165
    v_pk_fma_f32 v[222:223], v[224:225], v[196:197], v[222:223]
    v_and_b32 v241, 0xffff0000, v165
    v_pk_fma_f32 v[222:223], v[226:227], v[194:195], v[222:223]
    v_pk_fma_f32 v[222:223], v[228:229], v[192:193], v[222:223]
    v_pk_mul_f32 v[222:223], v[222:223], v[240:241]
    v_pk_mul_f32 v[224:225], v[224:225], v[198:199]
    v_lshlrev_b32 v238, 16, v169
    v_pk_fma_f32 v[224:225], v[226:227], v[196:197], v[224:225]
    v_and_b32 v239, 0xffff0000, v169
    v_pk_fma_f32 v[224:225], v[228:229], v[194:195], v[224:225]
    v_pk_fma_f32 v[224:225], v[230:231], v[192:193], v[224:225]
    v_pk_mul_f32 v[224:225], v[224:225], v[238:239]
    v_pk_mul_f32 v[226:227], v[226:227], v[198:199]
    v_lshlrev_b32 v240, 16, v173
    v_pk_fma_f32 v[226:227], v[228:229], v[196:197], v[226:227]
    v_and_b32 v241, 0xffff0000, v173
    v_pk_fma_f32 v[226:227], v[230:231], v[194:195], v[226:227]
    v_pk_fma_f32 v[226:227], v[232:233], v[192:193], v[226:227]
    v_pk_mul_f32 v[226:227], v[226:227], v[240:241]
    v_pk_mul_f32 v[228:229], v[228:229], v[198:199]
    v_lshlrev_b32 v238, 16, v177
    v_pk_fma_f32 v[228:229], v[230:231], v[196:197], v[228:229]
    v_and_b32 v239, 0xffff0000, v177
    v_pk_fma_f32 v[228:229], v[232:233], v[194:195], v[228:229]
    v_pk_fma_f32 v[228:229], v[234:235], v[192:193], v[228:229]
    v_pk_mul_f32 v[228:229], v[228:229], v[238:239]
    v_pk_mul_f32 v[230:231], v[230:231], v[198:199]
    v_lshlrev_b32 v240, 16, v181
    v_pk_fma_f32 v[230:231], v[232:233], v[196:197], v[230:231]
    v_and_b32 v241, 0xffff0000, v181
    v_pk_fma_f32 v[230:231], v[234:235], v[194:195], v[230:231]
    v_pk_fma_f32 v[230:231], v[236:237], v[192:193], v[230:231]
    v_pk_mul_f32 v[230:231], v[230:231], v[240:241]
    v_cvt_pk_bf16_f32 v242, v230, v228
    v_cvt_pk_bf16_f32 v243, v226, v224
    v_cvt_pk_bf16_f32 v244, v222, v220
    v_cvt_pk_bf16_f32 v245, v218, v216
    ds_write_b128 v12, v[242:245] offset:256
    v_cvt_pk_bf16_f32 v246, v231, v229
    v_cvt_pk_bf16_f32 v247, v227, v225
    v_cvt_pk_bf16_f32 v248, v223, v221
    v_cvt_pk_bf16_f32 v249, v219, v217
    ds_write_b128 v12, v[246:249] offset:384
    v_lshlrev_b32 v216, 16, v110
    v_and_b32 v217, 0xffff0000, v110
    v_lshlrev_b32 v218, 16, v114
    v_and_b32 v219, 0xffff0000, v114
    v_lshlrev_b32 v220, 16, v118
    v_and_b32 v221, 0xffff0000, v118
    v_lshlrev_b32 v222, 16, v122
    v_and_b32 v223, 0xffff0000, v122
    v_lshlrev_b32 v224, 16, v126
    v_and_b32 v225, 0xffff0000, v126
    v_lshlrev_b32 v226, 16, v130
    v_and_b32 v227, 0xffff0000, v130
    v_lshlrev_b32 v228, 16, v134
    v_and_b32 v229, 0xffff0000, v134
    v_lshlrev_b32 v230, 16, v138
    v_and_b32 v231, 0xffff0000, v138
    v_lshlrev_b32 v232, 16, v142
    v_and_b32 v233, 0xffff0000, v142
    v_lshlrev_b32 v234, 16, v146
    v_and_b32 v235, 0xffff0000, v146
    v_lshlrev_b32 v236, 16, v150
    v_and_b32 v237, 0xffff0000, v150
    v_pk_mul_f32 v[216:217], v[216:217], v[206:207]
    v_lshlrev_b32 v238, 16, v154
    v_pk_fma_f32 v[216:217], v[218:219], v[204:205], v[216:217]
    v_and_b32 v239, 0xffff0000, v154
    v_pk_fma_f32 v[216:217], v[220:221], v[202:203], v[216:217]
    v_pk_fma_f32 v[216:217], v[222:223], v[200:201], v[216:217]
    v_pk_mul_f32 v[216:217], v[216:217], v[238:239]
    v_pk_mul_f32 v[218:219], v[218:219], v[206:207]
    v_lshlrev_b32 v240, 16, v158
    v_pk_fma_f32 v[218:219], v[220:221], v[204:205], v[218:219]
    v_and_b32 v241, 0xffff0000, v158
    v_pk_fma_f32 v[218:219], v[222:223], v[202:203], v[218:219]
    v_pk_fma_f32 v[218:219], v[224:225], v[200:201], v[218:219]
    v_pk_mul_f32 v[218:219], v[218:219], v[240:241]
    v_pk_mul_f32 v[220:221], v[220:221], v[206:207]
    v_lshlrev_b32 v238, 16, v162
    v_pk_fma_f32 v[220:221], v[222:223], v[204:205], v[220:221]
    v_and_b32 v239, 0xffff0000, v162
    v_pk_fma_f32 v[220:221], v[224:225], v[202:203], v[220:221]
    v_pk_fma_f32 v[220:221], v[226:227], v[200:201], v[220:221]
    v_pk_mul_f32 v[220:221], v[220:221], v[238:239]
    v_pk_mul_f32 v[222:223], v[222:223], v[206:207]
    v_lshlrev_b32 v240, 16, v166
    v_pk_fma_f32 v[222:223], v[224:225], v[204:205], v[222:223]
    v_and_b32 v241, 0xffff0000, v166
    v_pk_fma_f32 v[222:223], v[226:227], v[202:203], v[222:223]
    v_pk_fma_f32 v[222:223], v[228:229], v[200:201], v[222:223]
    v_pk_mul_f32 v[222:223], v[222:223], v[240:241]
    v_pk_mul_f32 v[224:225], v[224:225], v[206:207]
    v_lshlrev_b32 v238, 16, v170
    v_pk_fma_f32 v[224:225], v[226:227], v[204:205], v[224:225]
    v_and_b32 v239, 0xffff0000, v170
    v_pk_fma_f32 v[224:225], v[228:229], v[202:203], v[224:225]
    v_pk_fma_f32 v[224:225], v[230:231], v[200:201], v[224:225]
    v_pk_mul_f32 v[224:225], v[224:225], v[238:239]
    v_pk_mul_f32 v[226:227], v[226:227], v[206:207]
    v_lshlrev_b32 v240, 16, v174
    v_pk_fma_f32 v[226:227], v[228:229], v[204:205], v[226:227]
    v_and_b32 v241, 0xffff0000, v174
    v_pk_fma_f32 v[226:227], v[230:231], v[202:203], v[226:227]
    v_pk_fma_f32 v[226:227], v[232:233], v[200:201], v[226:227]
    v_pk_mul_f32 v[226:227], v[226:227], v[240:241]
    v_pk_mul_f32 v[228:229], v[228:229], v[206:207]
    v_lshlrev_b32 v238, 16, v178
    v_pk_fma_f32 v[228:229], v[230:231], v[204:205], v[228:229]
    v_and_b32 v239, 0xffff0000, v178
    v_pk_fma_f32 v[228:229], v[232:233], v[202:203], v[228:229]
    v_pk_fma_f32 v[228:229], v[234:235], v[200:201], v[228:229]
    v_pk_mul_f32 v[228:229], v[228:229], v[238:239]
    v_pk_mul_f32 v[230:231], v[230:231], v[206:207]
    v_lshlrev_b32 v240, 16, v182
    v_pk_fma_f32 v[230:231], v[232:233], v[204:205], v[230:231]
    v_and_b32 v241, 0xffff0000, v182
    v_pk_fma_f32 v[230:231], v[234:235], v[202:203], v[230:231]
    v_pk_fma_f32 v[230:231], v[236:237], v[200:201], v[230:231]
    v_pk_mul_f32 v[230:231], v[230:231], v[240:241]
    v_cvt_pk_bf16_f32 v242, v230, v228
    v_cvt_pk_bf16_f32 v243, v226, v224
    v_cvt_pk_bf16_f32 v244, v222, v220
    v_cvt_pk_bf16_f32 v245, v218, v216
    ds_write_b128 v12, v[242:245] offset:512
    v_cvt_pk_bf16_f32 v246, v231, v229
    v_cvt_pk_bf16_f32 v247, v227, v225
    v_cvt_pk_bf16_f32 v248, v223, v221
    v_cvt_pk_bf16_f32 v249, v219, v217
    ds_write_b128 v12, v[246:249] offset:640
    v_lshlrev_b32 v216, 16, v111
    v_and_b32 v217, 0xffff0000, v111
    v_lshlrev_b32 v218, 16, v115
    v_and_b32 v219, 0xffff0000, v115
    v_lshlrev_b32 v220, 16, v119
    v_and_b32 v221, 0xffff0000, v119
    v_lshlrev_b32 v222, 16, v123
    v_and_b32 v223, 0xffff0000, v123
    v_lshlrev_b32 v224, 16, v127
    v_and_b32 v225, 0xffff0000, v127
    v_lshlrev_b32 v226, 16, v131
    v_and_b32 v227, 0xffff0000, v131
    v_lshlrev_b32 v228, 16, v135
    v_and_b32 v229, 0xffff0000, v135
    v_lshlrev_b32 v230, 16, v139
    v_and_b32 v231, 0xffff0000, v139
    v_lshlrev_b32 v232, 16, v143
    v_and_b32 v233, 0xffff0000, v143
    v_lshlrev_b32 v234, 16, v147
    v_and_b32 v235, 0xffff0000, v147
    v_lshlrev_b32 v236, 16, v151
    v_and_b32 v237, 0xffff0000, v151
    v_pk_mul_f32 v[216:217], v[216:217], v[214:215]
    v_lshlrev_b32 v238, 16, v155
    v_pk_fma_f32 v[216:217], v[218:219], v[212:213], v[216:217]
    v_and_b32 v239, 0xffff0000, v155
    v_pk_fma_f32 v[216:217], v[220:221], v[210:211], v[216:217]
    v_pk_fma_f32 v[216:217], v[222:223], v[208:209], v[216:217]
    v_pk_mul_f32 v[216:217], v[216:217], v[238:239]
    v_pk_mul_f32 v[218:219], v[218:219], v[214:215]
    v_lshlrev_b32 v240, 16, v159
    v_pk_fma_f32 v[218:219], v[220:221], v[212:213], v[218:219]
    v_and_b32 v241, 0xffff0000, v159
    v_pk_fma_f32 v[218:219], v[222:223], v[210:211], v[218:219]
    v_pk_fma_f32 v[218:219], v[224:225], v[208:209], v[218:219]
    v_pk_mul_f32 v[218:219], v[218:219], v[240:241]
    v_pk_mul_f32 v[220:221], v[220:221], v[214:215]
    v_lshlrev_b32 v238, 16, v163
    v_pk_fma_f32 v[220:221], v[222:223], v[212:213], v[220:221]
    v_and_b32 v239, 0xffff0000, v163
    v_pk_fma_f32 v[220:221], v[224:225], v[210:211], v[220:221]
    v_pk_fma_f32 v[220:221], v[226:227], v[208:209], v[220:221]
    v_pk_mul_f32 v[220:221], v[220:221], v[238:239]
    v_pk_mul_f32 v[222:223], v[222:223], v[214:215]
    v_lshlrev_b32 v240, 16, v167
    v_pk_fma_f32 v[222:223], v[224:225], v[212:213], v[222:223]
    v_and_b32 v241, 0xffff0000, v167
    v_pk_fma_f32 v[222:223], v[226:227], v[210:211], v[222:223]
    v_pk_fma_f32 v[222:223], v[228:229], v[208:209], v[222:223]
    v_pk_mul_f32 v[222:223], v[222:223], v[240:241]
    v_pk_mul_f32 v[224:225], v[224:225], v[214:215]
    v_lshlrev_b32 v238, 16, v171
    v_pk_fma_f32 v[224:225], v[226:227], v[212:213], v[224:225]
    v_and_b32 v239, 0xffff0000, v171
    v_pk_fma_f32 v[224:225], v[228:229], v[210:211], v[224:225]
    v_pk_fma_f32 v[224:225], v[230:231], v[208:209], v[224:225]
    v_pk_mul_f32 v[224:225], v[224:225], v[238:239]
    v_pk_mul_f32 v[226:227], v[226:227], v[214:215]
    v_lshlrev_b32 v240, 16, v175
    v_pk_fma_f32 v[226:227], v[228:229], v[212:213], v[226:227]
    v_and_b32 v241, 0xffff0000, v175
    v_pk_fma_f32 v[226:227], v[230:231], v[210:211], v[226:227]
    v_pk_fma_f32 v[226:227], v[232:233], v[208:209], v[226:227]
    v_pk_mul_f32 v[226:227], v[226:227], v[240:241]
    v_pk_mul_f32 v[228:229], v[228:229], v[214:215]
    v_lshlrev_b32 v238, 16, v179
    v_pk_fma_f32 v[228:229], v[230:231], v[212:213], v[228:229]
    v_and_b32 v239, 0xffff0000, v179
    v_pk_fma_f32 v[228:229], v[232:233], v[210:211], v[228:229]
    v_pk_fma_f32 v[228:229], v[234:235], v[208:209], v[228:229]
    v_pk_mul_f32 v[228:229], v[228:229], v[238:239]
    v_pk_mul_f32 v[230:231], v[230:231], v[214:215]
    v_lshlrev_b32 v240, 16, v183
    v_pk_fma_f32 v[230:231], v[232:233], v[212:213], v[230:231]
    v_and_b32 v241, 0xffff0000, v183
    v_pk_fma_f32 v[230:231], v[234:235], v[210:211], v[230:231]
    v_pk_fma_f32 v[230:231], v[236:237], v[208:209], v[230:231]
    v_pk_mul_f32 v[230:231], v[230:231], v[240:241]
    v_cvt_pk_bf16_f32 v242, v230, v228
    v_cvt_pk_bf16_f32 v243, v226, v224
    v_cvt_pk_bf16_f32 v244, v222, v220
    v_cvt_pk_bf16_f32 v245, v218, v216
    ds_write_b128 v12, v[242:245] offset:768
    v_cvt_pk_bf16_f32 v246, v231, v229
    v_cvt_pk_bf16_f32 v247, v227, v225
    v_cvt_pk_bf16_f32 v248, v223, v221
    v_cvt_pk_bf16_f32 v249, v219, v217
    ds_write_b128 v12, v[246:249] offset:896
    v_lshlrev_b32 v12, 4, v1
    v_add_u32 v13, s5, v12
    s_lshl_b32 s4, s24, 20
    s_lshl_b32 s5, s99, 11
    s_add_u32 s4, s4, s5
    s_add_u32 s4, s4, 125829120
    s_waitcnt lgkmcnt(0)
    ds_read_b128 v[32:35], v13 offset:0
    ds_read_b128 v[36:39], v13 offset:1024
    ds_read_b128 v[40:43], v13 offset:2048
    ds_read_b128 v[44:47], v13 offset:3072
    ds_read_b128 v[48:51], v13 offset:4096
    ds_read_b128 v[52:55], v13 offset:5120
    ds_read_b128 v[56:59], v13 offset:6144
    ds_read_b128 v[60:63], v13 offset:7168
    ds_read_b128 v[64:67], v13 offset:8192
    ds_read_b128 v[68:71], v13 offset:9216
    ds_read_b128 v[72:75], v13 offset:10240
    ds_read_b128 v[76:79], v13 offset:11264
    ds_read_b128 v[80:83], v13 offset:12288
    ds_read_b128 v[84:87], v13 offset:13312
    ds_read_b128 v[88:91], v13 offset:14336
    ds_read_b128 v[92:95], v13 offset:15360
    ds_read_b128 v[96:99], v13 offset:16384
    ds_read_b128 v[100:103], v13 offset:17408
    ds_read_b128 v[104:107], v13 offset:18432
    ds_read_b128 v[108:111], v13 offset:19456
    ds_read_b128 v[112:115], v13 offset:20480
    ds_read_b128 v[116:119], v13 offset:21504
    ds_read_b128 v[120:123], v13 offset:22528
    ds_read_b128 v[124:127], v13 offset:23552
    ds_read_b128 v[128:131], v13 offset:24576
    ds_read_b128 v[132:135], v13 offset:25600
    ds_read_b128 v[136:139], v13 offset:26624
    ds_read_b128 v[140:143], v13 offset:27648
    ds_read_b128 v[144:147], v13 offset:28672
    ds_read_b128 v[148:151], v13 offset:29696
    ds_read_b128 v[152:155], v13 offset:30720
    ds_read_b128 v[156:159], v13 offset:31744
    s_waitcnt lgkmcnt(15)
    buffer_store_dwordx4 v[32:35], v12, s[8:11], s4 offen offset:0 sc1
    buffer_store_dwordx4 v[36:39], v12, s[8:11], s4 offen offset:1024 sc1
    s_add_u32 s4, s4, 0x10000
    buffer_store_dwordx4 v[40:43], v12, s[8:11], s4 offen offset:0 sc1
    buffer_store_dwordx4 v[44:47], v12, s[8:11], s4 offen offset:1024 sc1
    s_add_u32 s4, s4, 0x10000
    buffer_store_dwordx4 v[48:51], v12, s[8:11], s4 offen offset:0 sc1
    buffer_store_dwordx4 v[52:55], v12, s[8:11], s4 offen offset:1024 sc1
    s_add_u32 s4, s4, 0x10000
    buffer_store_dwordx4 v[56:59], v12, s[8:11], s4 offen offset:0 sc1
    buffer_store_dwordx4 v[60:63], v12, s[8:11], s4 offen offset:1024 sc1
    s_add_u32 s4, s4, 0x10000
    buffer_store_dwordx4 v[64:67], v12, s[8:11], s4 offen offset:0 sc1
    buffer_store_dwordx4 v[68:71], v12, s[8:11], s4 offen offset:1024 sc1
    s_add_u32 s4, s4, 0x10000
    buffer_store_dwordx4 v[72:75], v12, s[8:11], s4 offen offset:0 sc1
    buffer_store_dwordx4 v[76:79], v12, s[8:11], s4 offen offset:1024 sc1
    s_add_u32 s4, s4, 0x10000
    buffer_store_dwordx4 v[80:83], v12, s[8:11], s4 offen offset:0 sc1
    buffer_store_dwordx4 v[84:87], v12, s[8:11], s4 offen offset:1024 sc1
    s_add_u32 s4, s4, 0x10000
    buffer_store_dwordx4 v[88:91], v12, s[8:11], s4 offen offset:0 sc1
    buffer_store_dwordx4 v[92:95], v12, s[8:11], s4 offen offset:1024 sc1
    s_add_u32 s4, s4, 0x10000
    s_waitcnt lgkmcnt(15)
    buffer_store_dwordx4 v[96:99], v12, s[8:11], s4 offen offset:0 sc1
    s_waitcnt lgkmcnt(14)
    buffer_store_dwordx4 v[100:103], v12, s[8:11], s4 offen offset:1024 sc1
    s_add_u32 s4, s4, 0x10000
    s_waitcnt lgkmcnt(13)
    buffer_store_dwordx4 v[104:107], v12, s[8:11], s4 offen offset:0 sc1
    s_waitcnt lgkmcnt(12)
    buffer_store_dwordx4 v[108:111], v12, s[8:11], s4 offen offset:1024 sc1
    s_add_u32 s4, s4, 0x10000
    s_waitcnt lgkmcnt(11)
    buffer_store_dwordx4 v[112:115], v12, s[8:11], s4 offen offset:0 sc1
    s_waitcnt lgkmcnt(10)
    buffer_store_dwordx4 v[116:119], v12, s[8:11], s4 offen offset:1024 sc1
    s_add_u32 s4, s4, 0x10000
    s_waitcnt lgkmcnt(9)
    buffer_store_dwordx4 v[120:123], v12, s[8:11], s4 offen offset:0 sc1
    s_waitcnt lgkmcnt(8)
    buffer_store_dwordx4 v[124:127], v12, s[8:11], s4 offen offset:1024 sc1
    s_add_u32 s4, s4, 0x10000
    s_waitcnt lgkmcnt(7)
    buffer_store_dwordx4 v[128:131], v12, s[8:11], s4 offen offset:0 sc1
    s_waitcnt lgkmcnt(6)
    buffer_store_dwordx4 v[132:135], v12, s[8:11], s4 offen offset:1024 sc1
    s_add_u32 s4, s4, 0x10000
    s_waitcnt lgkmcnt(5)
    buffer_store_dwordx4 v[136:139], v12, s[8:11], s4 offen offset:0 sc1
    s_waitcnt lgkmcnt(4)
    buffer_store_dwordx4 v[140:143], v12, s[8:11], s4 offen offset:1024 sc1
    s_add_u32 s4, s4, 0x10000
    s_waitcnt lgkmcnt(3)
    buffer_store_dwordx4 v[144:147], v12, s[8:11], s4 offen offset:0 sc1
    s_waitcnt lgkmcnt(2)
    buffer_store_dwordx4 v[148:151], v12, s[8:11], s4 offen offset:1024 sc1
    s_add_u32 s4, s4, 0x10000
    s_waitcnt lgkmcnt(1)
    buffer_store_dwordx4 v[152:155], v12, s[8:11], s4 offen offset:0 sc1
    s_waitcnt lgkmcnt(0)
    buffer_store_dwordx4 v[156:159], v12, s[8:11], s4 offen offset:1024 sc1
    s_add_u32 s4, s4, 0x10000
    s_lshl_b32 s4, s99, 7
    s_lshl_b32 s5, s24, 2
    s_add_u32 s4, s4, s5
    s_add_u32 s4, s4, 92344320
    v_mov_b32 v12, 1
    v_mov_b32 v13, 0
    s_waitcnt vmcnt(0)
    s_mov_b64 exec, 1
    buffer_store_dword v12, v13, s[8:11], s4 offen sc1
    s_mov_b64 exec, -1
    s_barrier
    s_lshl_b32 s30, s99, 14
    s_lshl_b32 s4, s24, 12
    s_add_u32 s30, s30, s4
    s_add_u32 s30, s30, 77070336
.cold_518:
    s_mov_b32 s62, 0
.gp_522:
    buffer_load_dwordx4 v[12:15], v7, s[8:11], 0 offen sc1
    s_add_u32 s62, s62, 1
    s_cmp_gt_u32 s62, 0x200000
    s_cbranch_scc1 .mg_end_1
    s_waitcnt vmcnt(0)
    v_min3_u32 v4, v12, v13, v14
    v_min_u32 v4, v4, v15
    s_nop 1
    v_min_u32_dpp v4, v4, v4 quad_perm:[1,0,3,2] row_mask:0xf bank_mask:0xf
    s_nop 1
    v_min_u32_dpp v4, v4, v4 quad_perm:[2,3,0,1] row_mask:0xf bank_mask:0xf
    s_nop 1
    v_min_u32_dpp v4, v4, v4 row_half_mirror row_mask:0xf bank_mask:0xf
    s_nop 1
    v_readfirstlane_b32 s33, v4
    s_cmp_gt_u32 s33, s28
    s_cbranch_scc1 .go_519
    s_sleep 1
    s_branch .gp_522
.go_519:
    s_add_u32 m0, s36, 0
    s_add_u32 s31, s29, 0
    buffer_load_dwordx4 v9, s[8:11], s31 offen offset:0 sc1 lds
    buffer_load_dwordx4 v9, s[8:11], s31 offen offset:1024 sc1 lds
    buffer_load_dwordx4 v9, s[8:11], s31 offen offset:2048 sc1 lds
    buffer_load_dwordx4 v9, s[8:11], s31 offen offset:3072 sc1 lds
    s_add_u32 m0, s36, 16384
    s_add_u32 s31, s29, 16384
    buffer_load_dwordx4 v9, s[8:11], s31 offen offset:0 sc1 lds
    buffer_load_dwordx4 v9, s[8:11], s31 offen offset:1024 sc1 lds
    buffer_load_dwordx4 v9, s[8:11], s31 offen offset:2048 sc1 lds
    buffer_load_dwordx4 v9, s[8:11], s31 offen offset:3072 sc1 lds
.body_520:
    s_waitcnt vmcnt(4)
    s_barrier
    ds_read_b128 v[64:67], v8 offset:0
    ds_read_b128 v[68:71], v8 offset:4096
    ds_read_b128 v[72:75], v8 offset:1024
    ds_read_b128 v[76:79], v8 offset:5120
    ds_read_b128 v[80:83], v8 offset:2048
    ds_read_b128 v[84:87], v8 offset:6144
    ds_read_b128 v[88:91], v8 offset:3072
    ds_read_b128 v[92:95], v8 offset:7168
    s_waitcnt lgkmcnt(6)
    v_mfma_f32_16x16x32_bf16 v[192:195], a[0:3], v[64:67], 0
    s_add_u32 m0, s36, 32768
    s_add_u32 s31, s29, 32768
    v_mfma_f32_16x16x32_bf16 v[196:199], a[4:7], v[64:67], 0
    buffer_load_dwordx4 v9, s[8:11], s31 offen offset:0 sc1 lds
    v_mfma_f32_16x16x32_bf16 v[200:203], a[0:3], v[68:71], 0
    ds_read_b128 v[96:99], v8 offset:8192
    ds_read_b128 v[100:103], v8 offset:12288
    v_mfma_f32_16x16x32_bf16 v[204:207], a[4:7], v[68:71], 0
    ds_read_b128 v[104:107], v8 offset:9216
    s_waitcnt lgkmcnt(7)
    v_mfma_f32_16x16x32_bf16 v[192:195], a[8:11], v[72:75], v[192:195]
    ds_read_b128 v[108:111], v8 offset:13312
    ds_read_b128 v[112:115], v8 offset:10240
    v_mfma_f32_16x16x32_bf16 v[196:199], a[12:15], v[72:75], v[196:199]
    buffer_load_dwordx4 v9, s[8:11], s31 offen offset:1024 sc1 lds
    v_mfma_f32_16x16x32_bf16 v[200:203], a[8:11], v[76:79], v[200:203]
    ds_read_b128 v[116:119], v8 offset:14336
    ds_read_b128 v[120:123], v8 offset:11264
    v_mfma_f32_16x16x32_bf16 v[204:207], a[12:15], v[76:79], v[204:207]
    ds_read_b128 v[124:127], v8 offset:15360
    s_waitcnt lgkmcnt(10)
    v_mfma_f32_16x16x32_bf16 v[192:195], a[16:19], v[80:83], v[192:195]
    buffer_load_dwordx4 v9, s[8:11], s31 offen offset:2048 sc1 lds
    v_mfma_f32_16x16x32_bf16 v[196:199], a[20:23], v[80:83], v[196:199]
    v_mfma_f32_16x16x32_bf16 v[200:203], a[16:19], v[84:87], v[200:203]
    v_mfma_f32_16x16x32_bf16 v[204:207], a[20:23], v[84:87], v[204:207]
    s_waitcnt lgkmcnt(8)
    v_mfma_f32_16x16x32_bf16 v[192:195], a[24:27], v[88:91], v[192:195]
    buffer_load_dwordx4 v9, s[8:11], s31 offen offset:3072 sc1 lds
    v_mfma_f32_16x16x32_bf16 v[196:199], a[28:31], v[88:91], v[196:199]
    v_mfma_f32_16x16x32_bf16 v[200:203], a[24:27], v[92:95], v[200:203]
    s_waitcnt vmcnt(4)
    s_barrier
    v_mfma_f32_16x16x32_bf16 v[204:207], a[28:31], v[92:95], v[204:207]
    ds_read_b128 v[128:131], v8 offset:16384
    s_waitcnt lgkmcnt(5)
    v_mfma_f32_16x16x32_bf16 v[192:195], a[32:35], v[96:99], v[192:195]
    s_add_u32 m0, s36, 49152
    s_add_u32 s31, s29, 49152
    v_mfma_f32_16x16x32_bf16 v[196:199], a[36:39], v[96:99], v[196:199]
    buffer_load_dwordx4 v9, s[8:11], s31 offen offset:0 sc1 lds
    v_mfma_f32_16x16x32_bf16 v[200:203], a[32:35], v[100:103], v[200:203]
    ds_read_b128 v[132:135], v8 offset:20480
    ds_read_b128 v[136:139], v8 offset:17408
    v_mfma_f32_16x16x32_bf16 v[204:207], a[36:39], v[100:103], v[204:207]
    ds_read_b128 v[140:143], v8 offset:21504
    ds_read_b128 v[144:147], v8 offset:18432
    v_mfma_f32_16x16x32_bf16 v[192:195], a[40:43], v[104:107], v[192:195]
    buffer_load_dwordx4 v9, s[8:11], s31 offen offset:1024 sc1 lds
    v_mfma_f32_16x16x32_bf16 v[196:199], a[44:47], v[104:107], v[196:199]
    ds_read_b128 v[148:151], v8 offset:22528
    ds_read_b128 v[152:155], v8 offset:19456
    v_mfma_f32_16x16x32_bf16 v[200:203], a[40:43], v[108:111], v[200:203]
    ds_read_b128 v[156:159], v8 offset:23552
    ds_read_b128 v[160:163], v8 offset:24576
    v_mfma_f32_16x16x32_bf16 v[204:207], a[44:47], v[108:111], v[204:207]
    ds_read_b128 v[164:167], v8 offset:28672
    s_waitcnt lgkmcnt(10)
    v_mfma_f32_16x16x32_bf16 v[192:195], a[48:51], v[112:115], v[192:195]
    buffer_load_dwordx4 v9, s[8:11], s31 offen offset:2048 sc1 lds
    v_mfma_f32_16x16x32_bf16 v[196:199], a[52:55], v[112:115], v[196:199]
    ds_read_b128 v[168:171], v8 offset:25600
    ds_read_b128 v[172:175], v8 offset:29696
    v_mfma_f32_16x16x32_bf16 v[200:203], a[48:51], v[116:119], v[200:203]
    ds_read_b128 v[176:179], v8 offset:26624
    ds_read_b128 v[180:183], v8 offset:30720
    v_mfma_f32_16x16x32_bf16 v[204:207], a[52:55], v[116:119], v[204:207]
    buffer_load_dwordx4 v9, s[8:11], s31 offen offset:3072 sc1 lds
    v_mfma_f32_16x16x32_bf16 v[192:195], a[56:59], v[120:123], v[192:195]
    ds_read_b128 v[184:187], v8 offset:27648
    ds_read_b128 v[188:191], v8 offset:31744
    v_mfma_f32_16x16x32_bf16 v[196:199], a[60:63], v[120:123], v[196:199]
    buffer_load_dwordx4 v[12:15], v7, s[8:11], 0 offen sc1
    s_xor_b32 s36, s36, 0x10000
    v_mfma_f32_16x16x32_bf16 v[200:203], a[56:59], v[124:127], v[200:203]
    s_add_u32 s29, s29, 0x40000
    v_mfma_f32_16x16x32_bf16 v[204:207], a[60:63], v[124:127], v[204:207]
    s_waitcnt lgkmcnt(12)
    v_mfma_f32_16x16x32_bf16 v[192:195], a[64:67], v[128:131], v[192:195]
    s_sub_u32 s4, s28, 1
    s_max_i32 s4, s4, 0
    v_mfma_f32_16x16x32_bf16 v[196:199], a[68:71], v[128:131], v[196:199]
    v_mov_b32 v27, s4
    v_mfma_f32_16x16x32_bf16 v[200:203], a[64:67], v[132:135], v[200:203]
    s_mov_b64 exec, 1
    buffer_store_dword v27, v26, s[8:11], s94 offen sc1
    s_mov_b64 exec, -1
    v_mfma_f32_16x16x32_bf16 v[204:207], a[68:71], v[132:135], v[204:207]
    v_mfma_f32_16x16x32_bf16 v[192:195], a[72:75], v[136:139], v[192:195]
    buffer_store_dwordx4 v[208:211], v2, s[8:11], s30 offen offset:0 sc1
    v_mfma_f32_16x16x32_bf16 v[196:199], a[76:79], v[136:139], v[196:199]
    v_mfma_f32_16x16x32_bf16 v[200:203], a[72:75], v[140:143], v[200:203]
    buffer_store_dwordx4 v[212:215], v2, s[8:11], s30 offen offset:1024 sc1
    v_mfma_f32_16x16x32_bf16 v[204:207], a[76:79], v[140:143], v[204:207]
    s_xor_b32 s30, s28, s38
    s_waitcnt lgkmcnt(8)
    v_mfma_f32_16x16x32_bf16 v[192:195], a[80:83], v[144:147], v[192:195]
    s_lshl_b32 s30, s30, 11
    s_add_u32 s30, s30, s37
    v_mfma_f32_16x16x32_bf16 v[196:199], a[84:87], v[144:147], v[196:199]
    s_add_u32 s28, s28, 1
    v_mfma_f32_16x16x32_bf16 v[200:203], a[80:83], v[148:151], v[200:203]
    v_mfma_f32_16x16x32_bf16 v[204:207], a[84:87], v[148:151], v[204:207]
    v_mfma_f32_16x16x32_bf16 v[192:195], a[88:91], v[152:155], v[192:195]
    v_mfma_f32_16x16x32_bf16 v[196:199], a[92:95], v[152:155], v[196:199]
    v_mfma_f32_16x16x32_bf16 v[200:203], a[88:91], v[156:159], v[200:203]
    v_mfma_f32_16x16x32_bf16 v[204:207], a[92:95], v[156:159], v[204:207]
    s_waitcnt lgkmcnt(4)
    v_mfma_f32_16x16x32_bf16 v[192:195], a[96:99], v[160:163], v[192:195]
    v_mfma_f32_16x16x32_bf16 v[196:199], a[100:103], v[160:163], v[196:199]
    v_mfma_f32_16x16x32_bf16 v[200:203], a[96:99], v[164:167], v[200:203]
    s_waitcnt vmcnt(3)
    s_barrier
    v_mfma_f32_16x16x32_bf16 v[204:207], a[100:103], v[164:167], v[204:207]
    ds_read_b128 v[64:67], v8 offset:32768
    ds_read_b128 v[68:71], v8 offset:36864
    v_mfma_f32_16x16x32_bf16 v[192:195], a[104:107], v[168:171], v[192:195]
    ds_read_b128 v[72:75], v8 offset:33792
    ds_read_b128 v[76:79], v8 offset:37888
    v_mfma_f32_16x16x32_bf16 v[196:199], a[108:111], v[168:171], v[196:199]
    ds_read_b128 v[80:83], v8 offset:34816
    ds_read_b128 v[84:87], v8 offset:38912
    v_mfma_f32_16x16x32_bf16 v[200:203], a[104:107], v[172:175], v[200:203]
    ds_read_b128 v[88:91], v8 offset:35840
    ds_read_b128 v[92:95], v8 offset:39936
    v_mfma_f32_16x16x32_bf16 v[204:207], a[108:111], v[172:175], v[204:207]
    ds_read_b128 v[96:99], v8 offset:40960
    s_waitcnt lgkmcnt(9)
    v_mfma_f32_16x16x32_bf16 v[192:195], a[112:115], v[176:179], v[192:195]
    v_min3_u32 v4, v12, v13, v14
    v_min_u32 v4, v4, v15
    v_mfma_f32_16x16x32_bf16 v[196:199], a[116:119], v[176:179], v[196:199]
    ds_read_b128 v[100:103], v8 offset:45056
    ds_read_b128 v[104:107], v8 offset:41984
    v_mfma_f32_16x16x32_bf16 v[200:203], a[112:115], v[180:183], v[200:203]
    v_min_u32_dpp v4, v4, v4 quad_perm:[1,0,3,2] row_mask:0xf bank_mask:0xf
    ds_read_b128 v[108:111], v8 offset:46080
    v_mfma_f32_16x16x32_bf16 v[204:207], a[116:119], v[180:183], v[204:207]
    ds_read_b128 v[112:115], v8 offset:43008
    ds_read_b128 v[116:119], v8 offset:47104
    v_mfma_f32_16x16x32_bf16 v[192:195], a[120:123], v[184:187], v[192:195]
    v_min_u32_dpp v4, v4, v4 quad_perm:[2,3,0,1] row_mask:0xf bank_mask:0xf
    ds_read_b128 v[120:123], v8 offset:44032
    v_mfma_f32_16x16x32_bf16 v[196:199], a[124:127], v[184:187], v[196:199]
    ds_read_b128 v[124:127], v8 offset:48128
    ds_read_b128 v[128:131], v8 offset:49152
    v_mfma_f32_16x16x32_bf16 v[200:203], a[120:123], v[188:191], v[200:203]
    v_min_u32_dpp v4, v4, v4 row_half_mirror row_mask:0xf bank_mask:0xf
    ds_read_b128 v[132:135], v8 offset:53248
    v_mfma_f32_16x16x32_bf16 v[204:207], a[124:127], v[188:191], v[204:207]
    ds_read_b128 v[136:139], v8 offset:50176
    s_waitcnt lgkmcnt(15)
    v_mfma_f32_16x16x32_bf16 v[192:195], a[128:131], v[64:67], v[192:195]
    v_readfirstlane_b32 s33, v4
    ds_read_b128 v[140:143], v8 offset:54272
    v_mfma_f32_16x16x32_bf16 v[196:199], a[132:135], v[64:67], v[196:199]
    s_cmp_gt_u32 s33, s28
    s_cbranch_scc1 .hot_521
    v_mfma_f32_16x16x32_bf16 v[200:203], a[128:131], v[68:71], v[200:203]
    ds_read_b128 v[144:147], v8 offset:51200
    ds_read_b128 v[148:151], v8 offset:55296
    v_mfma_f32_16x16x32_bf16 v[204:207], a[132:135], v[68:71], v[204:207]
    ds_read_b128 v[152:155], v8 offset:52224
    ds_read_b128 v[156:159], v8 offset:56320
    v_mfma_f32_16x16x32_bf16 v[192:195], a[136:139], v[72:75], v[192:195]
    ds_read_b128 v[160:163], v8 offset:57344
    ds_read_b128 v[164:167], v8 offset:61440
    v_mfma_f32_16x16x32_bf16 v[196:199], a[140:143], v[72:75], v[196:199]
    ds_read_b128 v[168:171], v8 offset:58368
    ds_read_b128 v[172:175], v8 offset:62464
    v_mfma_f32_16x16x32_bf16 v[200:203], a[136:139], v[76:79], v[200:203]
    ds_read_b128 v[176:179], v8 offset:59392
    ds_read_b128 v[180:183], v8 offset:63488
    v_mfma_f32_16x16x32_bf16 v[204:207], a[140:143], v[76:79], v[204:207]
    ds_read_b128 v[184:187], v8 offset:60416
    s_waitcnt lgkmcnt(15)
    v_mfma_f32_16x16x32_bf16 v[192:195], a[144:147], v[80:83], v[192:195]
    ds_read_b128 v[188:191], v8 offset:64512
    v_xor_b32 v8, 0x10000, v8
    v_mfma_f32_16x16x32_bf16 v[196:199], a[148:151], v[80:83], v[196:199]
    v_mfma_f32_16x16x32_bf16 v[200:203], a[144:147], v[84:87], v[200:203]
    v_mfma_f32_16x16x32_bf16 v[204:207], a[148:151], v[84:87], v[204:207]
    v_mfma_f32_16x16x32_bf16 v[192:195], a[152:155], v[88:91], v[192:195]
    v_mfma_f32_16x16x32_bf16 v[196:199], a[156:159], v[88:91], v[196:199]
    v_mfma_f32_16x16x32_bf16 v[200:203], a[152:155], v[92:95], v[200:203]
    v_mfma_f32_16x16x32_bf16 v[204:207], a[156:159], v[92:95], v[204:207]
    v_mfma_f32_16x16x32_bf16 v[192:195], a[160:163], v[96:99], v[192:195]
    v_mfma_f32_16x16x32_bf16 v[196:199], a[164:167], v[96:99], v[196:199]
    v_mfma_f32_16x16x32_bf16 v[200:203], a[160:163], v[100:103], v[200:203]
    v_mfma_f32_16x16x32_bf16 v[204:207], a[164:167], v[100:103], v[204:207]
    v_mfma_f32_16x16x32_bf16 v[192:195], a[168:171], v[104:107], v[192:195]
    v_mfma_f32_16x16x32_bf16 v[196:199], a[172:175], v[104:107], v[196:199]
    v_mfma_f32_16x16x32_bf16 v[200:203], a[168:171], v[108:111], v[200:203]
    v_mfma_f32_16x16x32_bf16 v[204:207], a[172:175], v[108:111], v[204:207]
    v_mfma_f32_16x16x32_bf16 v[192:195], a[176:179], v[112:115], v[192:195]
    v_mfma_f32_16x16x32_bf16 v[196:199], a[180:183], v[112:115], v[196:199]
    v_mfma_f32_16x16x32_bf16 v[200:203], a[176:179], v[116:119], v[200:203]
    v_mfma_f32_16x16x32_bf16 v[204:207], a[180:183], v[116:119], v[204:207]
    v_mfma_f32_16x16x32_bf16 v[192:195], a[184:187], v[120:123], v[192:195]
    buffer_load_dwordx4 v[12:15], v7, s[8:11], 0 offen sc1
    v_mfma_f32_16x16x32_bf16 v[196:199], a[188:191], v[120:123], v[196:199]
    v_mfma_f32_16x16x32_bf16 v[200:203], a[184:187], v[124:127], v[200:203]
    v_mfma_f32_16x16x32_bf16 v[204:207], a[188:191], v[124:127], v[204:207]
    s_waitcnt lgkmcnt(12)
    v_mfma_f32_16x16x32_bf16 v[192:195], a[192:195], v[128:131], v[192:195]
    v_mfma_f32_16x16x32_bf16 v[196:199], a[196:199], v[128:131], v[196:199]
    v_mfma_f32_16x16x32_bf16 v[200:203], a[192:195], v[132:135], v[200:203]
    v_mfma_f32_16x16x32_bf16 v[204:207], a[196:199], v[132:135], v[204:207]
    v_mfma_f32_16x16x32_bf16 v[192:195], a[200:203], v[136:139], v[192:195]
    v_mfma_f32_16x16x32_bf16 v[196:199], a[204:207], v[136:139], v[196:199]
    v_mfma_f32_16x16x32_bf16 v[200:203], a[200:203], v[140:143], v[200:203]
    v_mfma_f32_16x16x32_bf16 v[204:207], a[204:207], v[140:143], v[204:207]
    s_waitcnt lgkmcnt(8)
    v_mfma_f32_16x16x32_bf16 v[192:195], a[208:211], v[144:147], v[192:195]
    v_mfma_f32_16x16x32_bf16 v[196:199], a[212:215], v[144:147], v[196:199]
    v_mfma_f32_16x16x32_bf16 v[200:203], a[208:211], v[148:151], v[200:203]
    v_mfma_f32_16x16x32_bf16 v[204:207], a[212:215], v[148:151], v[204:207]
    v_mfma_f32_16x16x32_bf16 v[192:195], a[216:219], v[152:155], v[192:195]
    v_mfma_f32_16x16x32_bf16 v[196:199], a[220:223], v[152:155], v[196:199]
    v_mfma_f32_16x16x32_bf16 v[200:203], a[216:219], v[156:159], v[200:203]
    v_mfma_f32_16x16x32_bf16 v[204:207], a[220:223], v[156:159], v[204:207]
    s_waitcnt lgkmcnt(4)
    v_mfma_f32_16x16x32_bf16 v[192:195], a[224:227], v[160:163], v[192:195]
    v_mfma_f32_16x16x32_bf16 v[196:199], a[228:231], v[160:163], v[196:199]
    v_mfma_f32_16x16x32_bf16 v[200:203], a[224:227], v[164:167], v[200:203]
    v_mfma_f32_16x16x32_bf16 v[204:207], a[228:231], v[164:167], v[204:207]
    v_mfma_f32_16x16x32_bf16 v[192:195], a[232:235], v[168:171], v[192:195]
    v_mfma_f32_16x16x32_bf16 v[196:199], a[236:239], v[168:171], v[196:199]
    v_mfma_f32_16x16x32_bf16 v[200:203], a[232:235], v[172:175], v[200:203]
    s_waitcnt vmcnt(0)
    v_min3_u32 v4, v12, v13, v14
    v_min_u32 v4, v4, v15
    v_mfma_f32_16x16x32_bf16 v[204:207], a[236:239], v[172:175], v[204:207]
    s_waitcnt lgkmcnt(0)
    v_mfma_f32_16x16x32_bf16 v[192:195], a[240:243], v[176:179], v[192:195]
    v_min_u32_dpp v4, v4, v4 quad_perm:[1,0,3,2] row_mask:0xf bank_mask:0xf
    v_mfma_f32_16x16x32_bf16 v[196:199], a[244:247], v[176:179], v[196:199]
    v_mfma_f32_16x16x32_bf16 v[200:203], a[240:243], v[180:183], v[200:203]
    v_min_u32_dpp v4, v4, v4 quad_perm:[2,3,0,1] row_mask:0xf bank_mask:0xf
    v_mfma_f32_16x16x32_bf16 v[204:207], a[244:247], v[180:183], v[204:207]
    v_mfma_f32_16x16x32_bf16 v[192:195], a[248:251], v[184:187], v[192:195]
    v_min_u32_dpp v4, v4, v4 row_half_mirror row_mask:0xf bank_mask:0xf
    v_mfma_f32_16x16x32_bf16 v[196:199], a[252:255], v[184:187], v[196:199]
    v_mfma_f32_16x16x32_bf16 v[200:203], a[248:251], v[188:191], v[200:203]
    v_readfirstlane_b32 s33, v4
    v_mfma_f32_16x16x32_bf16 v[204:207], a[252:255], v[188:191], v[204:207]
    s_cmp_gt_u32 s33, s28
    s_cbranch_scc1 .gx_523
    s_cmp_ge_u32 s28, 64
    s_cbranch_scc1 .last_527
    s_mov_b32 s39, 1
    s_nop 2
    v_cvt_pk_bf16_f32 v208, v192, v193
    v_cvt_pk_bf16_f32 v209, v194, v195
    v_cvt_pk_bf16_f32 v210, v196, v197
    v_cvt_pk_bf16_f32 v211, v198, v199
    v_cvt_pk_bf16_f32 v212, v200, v201
    v_cvt_pk_bf16_f32 v213, v202, v203
    v_cvt_pk_bf16_f32 v214, v204, v205
    v_cvt_pk_bf16_f32 v215, v206, v207
    s_branch .cold_518
.last_527:
    s_nop 3
    v_cvt_pk_bf16_f32 v208, v192, v193
    v_cvt_pk_bf16_f32 v209, v194, v195
    v_cvt_pk_bf16_f32 v210, v196, v197
    v_cvt_pk_bf16_f32 v211, v198, v199
    v_cvt_pk_bf16_f32 v212, v200, v201
    v_cvt_pk_bf16_f32 v213, v202, v203
    v_cvt_pk_bf16_f32 v214, v204, v205
    v_cvt_pk_bf16_f32 v215, v206, v207
    buffer_store_dwordx4 v[208:211], v2, s[8:11], s30 offen offset:0 sc1
    buffer_store_dwordx4 v[212:215], v2, s[8:11], s30 offen offset:1024 sc1
    s_mov_b32 s39, 0
    s_waitcnt vmcnt(0)
    v_mov_b32 v27, s28
    s_mov_b64 exec, 1
    buffer_store_dword v27, v26, s[8:11], s94 offen sc1
    s_mov_b64 exec, -1
    s_cmp_lt_u32 s28, 64
    s_cbranch_scc1 .cold_518
    s_endpgm
.gx_523:
    s_add_u32 m0, s36, 0
    s_add_u32 s31, s29, 0
    buffer_load_dwordx4 v9, s[8:11], s31 offen offset:0 sc1 lds
    buffer_load_dwordx4 v9, s[8:11], s31 offen offset:1024 sc1 lds
    buffer_load_dwordx4 v9, s[8:11], s31 offen offset:2048 sc1 lds
    buffer_load_dwordx4 v9, s[8:11], s31 offen offset:3072 sc1 lds
    s_add_u32 m0, s36, 16384
    s_add_u32 s31, s29, 16384
    buffer_load_dwordx4 v9, s[8:11], s31 offen offset:0 sc1 lds
    buffer_load_dwordx4 v9, s[8:11], s31 offen offset:1024 sc1 lds
    buffer_load_dwordx4 v9, s[8:11], s31 offen offset:2048 sc1 lds
    buffer_load_dwordx4 v9, s[8:11], s31 offen offset:3072 sc1 lds
    s_branch .cpy_526
.hot_521:
    v_mfma_f32_16x16x32_bf16 v[200:203], a[128:131], v[68:71], v[200:203]
    s_add_u32 m0, s36, 0
    s_add_u32 s31, s29, 0
    v_mfma_f32_16x16x32_bf16 v[204:207], a[132:135], v[68:71], v[204:207]
    buffer_load_dwordx4 v9, s[8:11], s31 offen offset:0 sc1 lds
    v_mfma_f32_16x16x32_bf16 v[192:195], a[136:139], v[72:75], v[192:195]
    ds_read_b128 v[144:147], v8 offset:51200
    ds_read_b128 v[148:151], v8 offset:55296
    v_mfma_f32_16x16x32_bf16 v[196:199], a[140:143], v[72:75], v[196:199]
    ds_read_b128 v[152:155], v8 offset:52224
    ds_read_b128 v[156:159], v8 offset:56320
    v_mfma_f32_16x16x32_bf16 v[200:203], a[136:139], v[76:79], v[200:203]
    ds_read_b128 v[160:163], v8 offset:57344
    ds_read_b128 v[164:167], v8 offset:61440
    v_mfma_f32_16x16x32_bf16 v[204:207], a[140:143], v[76:79], v[204:207]
    ds_read_b128 v[168:171], v8 offset:58368
    s_waitcnt lgkmcnt(15)
    v_mfma_f32_16x16x32_bf16 v[192:195], a[144:147], v[80:83], v[192:195]
    buffer_load_dwordx4 v9, s[8:11], s31 offen offset:1024 sc1 lds
    v_mfma_f32_16x16x32_bf16 v[196:199], a[148:151], v[80:83], v[196:199]
    ds_read_b128 v[172:175], v8 offset:62464
    ds_read_b128 v[176:179], v8 offset:59392
    v_mfma_f32_16x16x32_bf16 v[200:203], a[144:147], v[84:87], v[200:203]
    ds_read_b128 v[180:183], v8 offset:63488
    ds_read_b128 v[184:187], v8 offset:60416
    v_mfma_f32_16x16x32_bf16 v[204:207], a[148:151], v[84:87], v[204:207]
    ds_read_b128 v[188:191], v8 offset:64512
    v_xor_b32 v8, 0x10000, v8
    v_mfma_f32_16x16x32_bf16 v[192:195], a[152:155], v[88:91], v[192:195]
    v_mfma_f32_16x16x32_bf16 v[196:199], a[156:159], v[88:91], v[196:199]
    buffer_load_dwordx4 v9, s[8:11], s31 offen offset:2048 sc1 lds
    v_mfma_f32_16x16x32_bf16 v[200:203], a[152:155], v[92:95], v[200:203]
    v_mfma_f32_16x16x32_bf16 v[204:207], a[156:159], v[92:95], v[204:207]
    v_mfma_f32_16x16x32_bf16 v[192:195], a[160:163], v[96:99], v[192:195]
    v_mfma_f32_16x16x32_bf16 v[196:199], a[164:167], v[96:99], v[196:199]
    v_mfma_f32_16x16x32_bf16 v[200:203], a[160:163], v[100:103], v[200:203]
    buffer_load_dwordx4 v9, s[8:11], s31 offen offset:3072 sc1 lds
    v_mfma_f32_16x16x32_bf16 v[204:207], a[164:167], v[100:103], v[204:207]
    v_mfma_f32_16x16x32_bf16 v[192:195], a[168:171], v[104:107], v[192:195]
    v_mfma_f32_16x16x32_bf16 v[196:199], a[172:175], v[104:107], v[196:199]
    v_mfma_f32_16x16x32_bf16 v[200:203], a[168:171], v[108:111], v[200:203]
    v_mfma_f32_16x16x32_bf16 v[204:207], a[172:175], v[108:111], v[204:207]
    s_waitcnt lgkmcnt(15)
    v_mfma_f32_16x16x32_bf16 v[192:195], a[176:179], v[112:115], v[192:195]
    s_add_u32 m0, s36, 16384
    s_add_u32 s31, s29, 16384
    v_mfma_f32_16x16x32_bf16 v[196:199], a[180:183], v[112:115], v[196:199]
    buffer_load_dwordx4 v9, s[8:11], s31 offen offset:0 sc1 lds
    v_mfma_f32_16x16x32_bf16 v[200:203], a[176:179], v[116:119], v[200:203]
    v_mfma_f32_16x16x32_bf16 v[204:207], a[180:183], v[116:119], v[204:207]
    v_mfma_f32_16x16x32_bf16 v[192:195], a[184:187], v[120:123], v[192:195]
    v_mfma_f32_16x16x32_bf16 v[196:199], a[188:191], v[120:123], v[196:199]
    v_mfma_f32_16x16x32_bf16 v[200:203], a[184:187], v[124:127], v[200:203]
    buffer_load_dwordx4 v9, s[8:11], s31 offen offset:1024 sc1 lds
    v_mfma_f32_16x16x32_bf16 v[204:207], a[188:191], v[124:127], v[204:207]
    s_waitcnt lgkmcnt(12)
    v_mfma_f32_16x16x32_bf16 v[192:195], a[192:195], v[128:131], v[192:195]
    v_mfma_f32_16x16x32_bf16 v[196:199], a[196:199], v[128:131], v[196:199]
    v_mfma_f32_16x16x32_bf16 v[200:203], a[192:195], v[132:135], v[200:203]
    v_mfma_f32_16x16x32_bf16 v[204:207], a[196:199], v[132:135], v[204:207]
    buffer_load_dwordx4 v9, s[8:11], s31 offen offset:2048 sc1 lds
    v_mfma_f32_16x16x32_bf16 v[192:195], a[200:203], v[136:139], v[192:195]
    v_mfma_f32_16x16x32_bf16 v[196:199], a[204:207], v[136:139], v[196:199]
    v_mfma_f32_16x16x32_bf16 v[200:203], a[200:203], v[140:143], v[200:203]
    v_mfma_f32_16x16x32_bf16 v[204:207], a[204:207], v[140:143], v[204:207]
    s_waitcnt lgkmcnt(8)
    v_mfma_f32_16x16x32_bf16 v[192:195], a[208:211], v[144:147], v[192:195]
    buffer_load_dwordx4 v9, s[8:11], s31 offen offset:3072 sc1 lds
    v_mfma_f32_16x16x32_bf16 v[196:199], a[212:215], v[144:147], v[196:199]
    v_mfma_f32_16x16x32_bf16 v[200:203], a[208:211], v[148:151], v[200:203]
    v_mfma_f32_16x16x32_bf16 v[204:207], a[212:215], v[148:151], v[204:207]
    v_mfma_f32_16x16x32_bf16 v[192:195], a[216:219], v[152:155], v[192:195]
    v_mfma_f32_16x16x32_bf16 v[196:199], a[220:223], v[152:155], v[196:199]
    v_mfma_f32_16x16x32_bf16 v[200:203], a[216:219], v[156:159], v[200:203]
    v_mfma_f32_16x16x32_bf16 v[204:207], a[220:223], v[156:159], v[204:207]
    s_waitcnt lgkmcnt(4)
    v_mfma_f32_16x16x32_bf16 v[192:195], a[224:227], v[160:163], v[192:195]
    v_mfma_f32_16x16x32_bf16 v[196:199], a[228:231], v[160:163], v[196:199]
    v_mfma_f32_16x16x32_bf16 v[200:203], a[224:227], v[164:167], v[200:203]
    v_mfma_f32_16x16x32_bf16 v[204:207], a[228:231], v[164:167], v[204:207]
    v_mfma_f32_16x16x32_bf16 v[192:195], a[232:235], v[168:171], v[192:195]
    v_mfma_f32_16x16x32_bf16 v[196:199], a[236:239], v[168:171], v[196:199]
    v_mfma_f32_16x16x32_bf16 v[200:203], a[232:235], v[172:175], v[200:203]
    v_mfma_f32_16x16x32_bf16 v[204:207], a[236:239], v[172:175], v[204:207]
    s_waitcnt lgkmcnt(0)
    v_mfma_f32_16x16x32_bf16 v[192:195], a[240:243], v[176:179], v[192:195]
    v_mfma_f32_16x16x32_bf16 v[196:199], a[244:247], v[176:179], v[196:199]
    v_mfma_f32_16x16x32_bf16 v[200:203], a[240:243], v[180:183], v[200:203]
    v_mfma_f32_16x16x32_bf16 v[204:207], a[244:247], v[180:183], v[204:207]
    v_mfma_f32_16x16x32_bf16 v[192:195], a[248:251], v[184:187], v[192:195]
    v_mfma_f32_16x16x32_bf16 v[196:199], a[252:255], v[184:187], v[196:199]
    v_mfma_f32_16x16x32_bf16 v[200:203], a[248:251], v[188:191], v[200:203]
    v_mfma_f32_16x16x32_bf16 v[204:207], a[252:255], v[188:191], v[204:207]
.cpy_526:
    s_mov_b32 s39, 1
    s_nop 2
    v_cvt_pk_bf16_f32 v208, v192, v193
    v_cvt_pk_bf16_f32 v209, v194, v195
    v_cvt_pk_bf16_f32 v210, v196, v197
    v_cvt_pk_bf16_f32 v211, v198, v199
    v_cvt_pk_bf16_f32 v212, v200, v201
    v_cvt_pk_bf16_f32 v213, v202, v203
    v_cvt_pk_bf16_f32 v214, v204, v205
    v_cvt_pk_bf16_f32 v215, v206, v207
    s_branch .body_520
.pd_524:
.fin_415:
    s_load_dwordx2 s[44:45], s[0:1], 112
    s_sub_u32 s34, s98, 1
    s_lshl_b32 s4, s34, 10
    s_lshr_b32 s5, s99, 2
    s_lshl_b32 s5, s5, 22
    s_add_u32 s4, s4, s5
    s_and_b32 s5, s99, 3
    s_lshl_b32 s5, s5, 18
    s_add_u32 s4, s4, s5
    s_lshl_b32 s38, s99, 1
    v_lshlrev_b32 v2, 4, v1
    v_add_u32 v2, s4, v2
    s_lshl_b32 s4, s34, 15
    s_lshl_b32 s5, s99, 6
    s_add_u32 s4, s4, s5
    v_bfe_u32 v254, v1, 0, 4
    v_mul_u32_u24 v13, 2048, v254
    v_bfe_u32 v254, v1, 4, 2
    v_mul_u32_u24 v254, 16, v254
    v_add_u32 v13, v13, v254
    v_add_u32 v13, s4, v13
    s_lshl_b32 s4, s99, 17
    s_lshl_b32 s5, s34, 10
    s_add_u32 s4, s4, s5
    v_bfe_u32 v254, v1, 4, 2
    v_mul_u32_u24 v14, 32768, v254
    v_bfe_u32 v254, v1, 3, 1
    v_mul_u32_u24 v254, 512, v254
    v_add_u32 v14, v14, v254
    v_bfe_u32 v254, v1, 0, 3
    v_mul_u32_u24 v254, 2, v254
    v_add_u32 v14, v14, v254
    v_add_u32 v14, s4, v14
    v_add_u32 v15, 4096, v14
    v_add_u32 v16, 8192, v14
    v_add_u32 v17, 12288, v14
    v_add_u32 v18, 16384, v14
    v_add_u32 v19, 20480, v14
    v_add_u32 v20, 24576, v14
    v_add_u32 v21, 28672, v14
    s_lshl_b32 s4, s34, 6
    v_bfe_u32 v254, v1, 0, 4
    v_mul_u32_u24 v22, 4, v254
    v_add_u32 v22, s4, v22
    s_lshl_b32 s4, s99, 9
    s_add_u32 s4, s4, 92323840
    v_bfe_u32 v254, v1, 0, 2
    v_mul_u32_u24 v7, 128, v254
    v_add_u32 v7, s4, v7
    s_mov_b32 s28, s24
    s_mov_b32 s33, 0
    s_waitcnt lgkmcnt(0)
    s_mov_b32 s84, s44
    s_and_b32 s85, s45, 0xffff
    s_mov_b32 s86, 0x400000
    s_mov_b32 s87, 0x00020000
    s_xor_b32 s5, s94, 49152
    s_mov_b32 s62, 0
.pw_528:
    buffer_load_dword v4, v5, s[8:11], s5 offen offset:4 sc1
    s_add_u32 s62, s62, 1
    s_cmp_gt_u32 s62, 0x200000
    s_cbranch_scc1 .mg_end_1
    s_waitcnt vmcnt(0)
    v_readfirstlane_b32 s4, v4
    s_cmp_lg_u32 s4, 0
    s_cbranch_scc1 .pw_529
    s_sleep 8
    s_branch .pw_528
.pw_529:
    s_mov_b32 s62, 0
    v_mov_b32 v5, 0
.wc_530:
    buffer_load_dword v4, v5, s[20:23], 0 offen offset:192 sc1
    s_add_u32 s62, s62, 1
    s_cmp_gt_u32 s62, 0x200000
    s_cbranch_scc1 .mg_end_1
    s_waitcnt vmcnt(0)
    v_readfirstlane_b32 s4, v4
    s_cmp_ge_u32 s4, 64
    s_cbranch_scc1 .wd_531
    s_sleep 64
    s_branch .wc_530
.wd_531:
.fl_532:
    s_lshl_b32 s57, s28, 16
    s_and_b32 s4, s28, 31
    s_lshl_b32 s4, s4, 4
    s_lshr_b32 s5, s28, 5
    s_lshl_b32 s5, s5, 11
    s_add_u32 s58, s4, s5
    s_add_u32 s58, s58, 130023424
    s_lshl_b32 s59, s28, 7
    s_add_u32 s59, s59, 121634816
    buffer_load_dwordx4 v[32:35], v13, s[12:15], s57 offen
    buffer_load_dword v44, v22, s[8:11], s59 offen
    buffer_load_ushort v36, v14, s[8:11], s58 offen
    buffer_load_ushort v37, v15, s[8:11], s58 offen
    buffer_load_ushort v38, v16, s[8:11], s58 offen
    buffer_load_ushort v39, v17, s[8:11], s58 offen
    buffer_load_ushort v40, v18, s[8:11], s58 offen
    buffer_load_ushort v41, v19, s[8:11], s58 offen
    buffer_load_ushort v42, v20, s[8:11], s58 offen
    buffer_load_ushort v43, v21, s[8:11], s58 offen
    s_xor_b32 s48, s28, s38
    s_lshl_b32 s48, s48, 11
    s_add_u32 s48, s48, 150994944
    s_xor_b32 s49, s48, 1050624
    s_add_u32 s50, s48, 0x200000
    s_add_u32 s51, s49, 0x200000
    s_cmp_gt_u32 s33, s28
    s_cbranch_scc1 .fd_534
    s_mov_b32 s62, 0
.fp_533:
    buffer_load_dword v4, v7, s[8:11], 0 offen sc1
    s_add_u32 s62, s62, 1
    s_cmp_gt_u32 s62, 0x200000
    s_cbranch_scc1 .mg_end_1
    s_waitcnt vmcnt(0)
    v_min_u32_dpp v4, v4, v4 quad_perm:[1,0,3,2] row_mask:0xf bank_mask:0xf
    s_nop 1
    v_min_u32_dpp v4, v4, v4 quad_perm:[2,3,0,1] row_mask:0xf bank_mask:0xf
    s_nop 1
    v_readfirstlane_b32 s33, v4
    s_cmp_gt_u32 s33, s28
    s_cbranch_scc1 .fd_534
    s_sleep 2
    s_add_u32 s4, s33, 1
    s_cmp_ge_u32 s4, s28
    s_cbranch_scc1 .fp_533
    s_sleep 12
    s_branch .fp_533
.fd_534:
    buffer_load_dwordx4 v[96:99], v2, s[8:11], s48 offen
    buffer_load_dwordx4 v[100:103], v2, s[8:11], s49 offen
    buffer_load_dwordx4 v[104:107], v2, s[8:11], s50 offen
    buffer_load_dwordx4 v[108:111], v2, s[8:11], s51 offen
    s_waitcnt vmcnt(4)
    v_lshlrev_b32 v48, 16, v32
    v_lshlrev_b32 v36, 16, v36
    v_and_b32 v49, 0xffff0000, v32
    v_lshlrev_b32 v37, 16, v37
    v_lshlrev_b32 v50, 16, v33
    v_lshlrev_b32 v38, 16, v38
    v_and_b32 v51, 0xffff0000, v33
    v_lshlrev_b32 v39, 16, v39
    v_lshlrev_b32 v52, 16, v34
    v_lshlrev_b32 v40, 16, v40
    v_and_b32 v53, 0xffff0000, v34
    v_lshlrev_b32 v41, 16, v41
    v_lshlrev_b32 v54, 16, v35
    v_lshlrev_b32 v42, 16, v42
    v_and_b32 v55, 0xffff0000, v35
    v_lshlrev_b32 v43, 16, v43
    v_mul_f32 v48, v48, v36
    v_mul_f32 v49, v49, v37
    v_mul_f32 v50, v50, v38
    v_mul_f32 v51, v51, v39
    v_mul_f32 v52, v52, v40
    v_mul_f32 v53, v53, v41
    v_mul_f32 v54, v54, v42
    v_mul_f32 v55, v55, v43
    v_mul_f32 v48, v48, v44
    v_mul_f32 v49, v49, v44
    v_mul_f32 v50, v50, v44
    v_mul_f32 v51, v51, v44
    v_mul_f32 v52, v52, v44
    v_mul_f32 v53, v53, v44
    v_mul_f32 v54, v54, v44
    v_mul_f32 v55, v55, v44
    v_sub_f32 v44, 1.0, v44
    s_waitcnt vmcnt(3)
    v_lshlrev_b32 v64, 16, v96
    v_and_b32 v65, 0xffff0000, v96
    v_lshlrev_b32 v66, 16, v97
    v_and_b32 v67, 0xffff0000, v97
    v_lshlrev_b32 v68, 16, v98
    v_and_b32 v69, 0xffff0000, v98
    v_lshlrev_b32 v70, 16, v99
    v_and_b32 v71, 0xffff0000, v99
    s_waitcnt vmcnt(2)
    v_lshlrev_b32 v72, 16, v100
    v_and_b32 v73, 0xffff0000, v100
    v_lshlrev_b32 v74, 16, v101
    v_and_b32 v75, 0xffff0000, v101
    v_lshlrev_b32 v76, 16, v102
    v_and_b32 v77, 0xffff0000, v102
    v_lshlrev_b32 v78, 16, v103
    v_and_b32 v79, 0xffff0000, v103
    v_pk_add_f32 v[64:65], v[64:65], v[72:73]
    v_pk_add_f32 v[66:67], v[66:67], v[74:75]
    v_pk_add_f32 v[68:69], v[68:69], v[76:77]
    v_pk_add_f32 v[70:71], v[70:71], v[78:79]
    s_waitcnt vmcnt(1)
    v_lshlrev_b32 v80, 16, v104
    v_and_b32 v81, 0xffff0000, v104
    v_lshlrev_b32 v82, 16, v105
    v_and_b32 v83, 0xffff0000, v105
    v_lshlrev_b32 v84, 16, v106
    v_and_b32 v85, 0xffff0000, v106
    v_lshlrev_b32 v86, 16, v107
    v_and_b32 v87, 0xffff0000, v107
    v_pk_add_f32 v[64:65], v[64:65], v[80:81]
    v_pk_add_f32 v[66:67], v[66:67], v[82:83]
    v_pk_add_f32 v[68:69], v[68:69], v[84:85]
    v_pk_add_f32 v[70:71], v[70:71], v[86:87]
    s_waitcnt vmcnt(0)
    v_lshlrev_b32 v88, 16, v108
    v_and_b32 v89, 0xffff0000, v108
    v_lshlrev_b32 v90, 16, v109
    v_and_b32 v91, 0xffff0000, v109
    v_lshlrev_b32 v92, 16, v110
    v_and_b32 v93, 0xffff0000, v110
    v_lshlrev_b32 v94, 16, v111
    v_and_b32 v95, 0xffff0000, v111
    v_pk_add_f32 v[64:65], v[64:65], v[88:89]
    v_pk_add_f32 v[66:67], v[66:67], v[90:91]
    v_pk_add_f32 v[68:69], v[68:69], v[92:93]
    v_pk_add_f32 v[70:71], v[70:71], v[94:95]
    v_fma_f32 v64, v64, v44, v48
    v_fma_f32 v65, v65, v44, v49
    v_fma_f32 v66, v66, v44, v50
    v_fma_f32 v67, v67, v44, v51
    v_fma_f32 v68, v68, v44, v52
    v_fma_f32 v69, v69, v44, v53
    v_fma_f32 v70, v70, v44, v54
    v_fma_f32 v71, v71, v44, v55
    v_cvt_pk_bf16_f32 v56, v64, v65
    v_cvt_pk_bf16_f32 v57, v66, v67
    v_cvt_pk_bf16_f32 v58, v68, v69
    v_cvt_pk_bf16_f32 v59, v70, v71
    buffer_store_dwordx4 v[56:59], v13, s[84:87], s57 offen
    s_add_u32 s28, s28, 4
    s_cmp_lt_u32 s28, 64
    s_cbranch_scc1 .fl_532
    s_endpgm
.mg_end_1:
    s_endpgm
.section .rodata,"a"
.p2align 6
.amdhsa_kernel mega_kernel
  .amdhsa_next_free_vgpr 512
  .amdhsa_next_free_sgpr 102
  .amdhsa_accum_offset 256
  .amdhsa_group_segment_fixed_size 0
  .amdhsa_kernarg_size 136
  .amdhsa_user_sgpr_count 2
  .amdhsa_user_sgpr_kernarg_segment_ptr 1
  .amdhsa_system_sgpr_workgroup_id_x 1
.end_amdhsa_kernel
```

```asm
; @launch kernel=mega_kernel grid=(256,1,1) block=(256,1,1) lds=163840
.amdgcn_target "amdgcn-amd-amdhsa--gfx950"
.text
.globl mega_kernel
.p2align 8
.type mega_kernel,@function
mega_kernel:
    s_cmp_ge_u32 s2, 256
    s_cbranch_scc1 .mg_end_1
    s_load_dwordx4 s[52:55], s[0:1], 120
    s_getreg_b32 s3, hwreg(HW_REG_XCC_ID)
    v_and_b32 v1, 63, v0
    v_lshrrev_b32 v4, 6, v0
    s_and_b32 s3, s3, 7
    v_readfirstlane_b32 s24, v4
    s_waitcnt lgkmcnt(0)
    s_mov_b32 s8, s54
    s_and_b32 s9, s55, 0xffff
    s_mov_b32 s10, 0x10000000
    s_mov_b32 s11, 0x00020000
    s_mov_b32 s20, s52
    s_and_b32 s21, s53, 0xffff
    s_mov_b32 s22, 0x100
    s_mov_b32 s23, 0x00020000
    s_mov_b32 s100, s54
    v_mov_b32 v7, 163832
    s_cmp_lg_u32 s24, 0
    s_cbranch_scc1 .noat_4
    s_mov_b64 exec, 1
    v_mov_b32 v5, 1
    s_lshl_b32 s4, s3, 3
    s_mov_b32 s6, 0x60402000
    s_mov_b32 s7, 0xe4e08480
    s_lshr_b64 s[6:7], s[6:7], s4
    s_and_b32 s4, s6, 0xff
    v_mov_b32 v6, s4
    buffer_atomic_add v5, v6, s[20:23], 0 offen sc0 sc1
    s_mov_b64 exec, -1
.noat_4:
    s_sub_u32 s101, 0, s100
    s_and_b32 s101, s101, 0x1fffff
    s_add_u32 s101, s101, 184549376
    s_lshl_b32 s4, s2, 2
    s_add_u32 s4, s4, s24
    s_lshl_b32 s5, s4, 11
    s_add_u32 s5, s5, s101
    v_lshlrev_b32 v8, 4, v1
    v_mov_b32 v20, -1
    v_mov_b32 v21, -1
    v_mov_b32 v22, -1
    v_mov_b32 v23, -1
    s_lshl_b32 s4, s4, 10
    s_add_u32 s4, s4, 83886080
    buffer_store_dwordx4 v[20:23], v8, s[8:11], s5 offen sc1
    buffer_store_dwordx4 v[20:23], v8, s[8:11], s5 offen offset:1024 sc1
    buffer_store_dwordx4 v[20:23], v8, s[8:11], s4 offen sc1
    s_cmp_eq_u32 s24, 2
    s_cselect_b32 s6, s2, -1
    s_cmp_ge_u32 s6, 128
    s_cbranch_scc1 .nr_7
    s_lshl_b32 s6, s6, 10
    s_add_u32 s6, s6, 84934656
    buffer_store_dwordx4 v[20:23], v8, s[8:11], s6 offen sc1
.nr_7:
    s_cmp_eq_u32 s24, 3
    s_cselect_b32 s6, s2, -1
    s_cmp_ge_u32 s6, 72
    s_cbranch_scc1 .nf_5
    v_mov_b32 v24, 0
    v_mov_b32 v25, 0
    v_mov_b32 v26, 0
    v_mov_b32 v27, 0
    s_lshl_b32 s6, s6, 10
    s_add_u32 s6, s6, 92274688
    buffer_store_dwordx4 v[24:27], v8, s[8:11], s6 offen sc1
.nf_5:
    s_cmp_lg_u32 s24, 0
    s_cbranch_scc1 .nw_6
    s_mov_b64 exec, 1
    s_waitcnt vmcnt(3)
    ds_write_b32 v7, v5
    s_waitcnt lgkmcnt(0)
    s_mov_b64 exec, -1
.nw_6:
    s_barrier
    ds_read_b32 v5, v7
    s_mov_b32 s25, s3
    s_mov_b32 s27, 0
    s_waitcnt lgkmcnt(0)
    v_readfirstlane_b32 s26, v5
    s_cmp_ge_u32 s26, 32
    s_cselect_b32 s3, 0x10001, 1
    s_and_b32 s26, s26, 31
.mg_role_3:
    s_cmp_ge_u32 s25, 4
    s_cbranch_scc1 .mg_bg_2
    s_load_dwordx8 s[84:91], s[0:1], 64
    s_load_dwordx2 s[40:41], s[0:1], 56
    v_and_b32 v1, 63, v0
    s_lshl_b32 s4, s25, 11
    s_lshl_b32 s5, s26, 6
    s_add_u32 s4, s4, s5
    s_lshl_b32 s6, s24, 21
    s_add_u32 s4, s4, s6
    s_lshl_b32 s7, s25, 21
    s_lshl_b32 s6, s24, 19
    s_add_u32 s7, s7, s6
    s_add_u32 s7, s7, s5
    s_lshl_b32 s6, s24, 15
    v_bfe_u32 v4, v1, 4, 1
    v_lshlrev_b32 v4, 1, v4
    v_and_b32 v5, 3, v1
    v_xor_b32 v4, v4, v5
    v_lshlrev_b32 v4, 4, v4
    v_bfe_u32 v254, v1, 2, 1
    v_mul_u32_u24 v5, 1, v254
    v_bfe_u32 v254, v1, 3, 1
    v_mul_u32_u24 v254, 8, v254
    v_add_u32 v5, v5, v254
    v_bfe_u32 v254, v1, 4, 1
    v_mul_u32_u24 v254, 4, v254
    v_add_u32 v5, v5, v254
    v_bfe_u32 v254, v1, 5, 1
    v_mul_u32_u24 v254, 2, v254
    v_add_u32 v5, v5, v254
    v_lshlrev_b32 v6, 13, v5
    v_add_u32 v6, v6, v4
    v_add_u32 v240, s4, v6
    v_lshlrev_b32 v6, 11, v5
    v_add_u32 v6, v6, v4
    v_add_u32 v241, s7, v6
    v_xor_b32 v241, 256, v241
    v_bfe_u32 v254, v1, 2, 2
    v_mul_u32_u24 v242, 64, v254
    v_bfe_u32 v254, v1, 4, 1
    v_mul_u32_u24 v254, 288, v254
    v_add_u32 v242, v242, v254
    v_bfe_u32 v254, v1, 5, 1
    v_mul_u32_u24 v254, 1024, v254
    v_add_u32 v242, v242, v254
    v_bfe_u32 v254, v1, 0, 2
    v_mul_u32_u24 v254, 8, v254
    v_add_u32 v242, v242, v254
    v_add_u32 v242, s6, v242
    v_xor_b32 v243, 32, v242
    s_waitcnt lgkmcnt(0)
    s_and_b32 s5, s26, 16
    s_lshl_b32 s5, s5, 6
    s_add_u32 s5, s5, 384
    s_lshl_b32 s99, s25, 11
    s_add_u32 s98, s5, s99
    s_lshl_b32 s99, s25, 21
    s_add_u32 s99, s99, s5
    s_and_b32 s4, s26, 7
    s_lshl_b32 s4, s4, 2
    s_add_u32 s4, s4, s24
    s_and_b32 s80, s26, 10
    s_xor_b32 s80, s80, 2
    s_lshr_b32 s5, s26, 1
    s_xor_b32 s64, s5, s26
    s_and_b32 s64, s64, 2
    s_and_b32 s81, s26, 8
    s_or_b32 s64, s64, s81
    s_and_b32 s5, s5, 2
    s_and_b32 s82, s26, 1
    s_or_b32 s5, s5, s82
    s_lshl_b32 s5, s5, 2
    s_add_u32 s5, s5, s24
    s_cmp_eq_u32 s81, 0
    s_cselect_b32 s4, s5, s4
    s_cselect_b32 s5, 6, 5
    s_cselect_b32 s81, 63, 31
    s_cselect_b32 s82, 0, 64
    s_lshl_b32 s4, s4, s5
    v_and_b32 v235, s81, v1
    v_add_u32 v235, s4, v235
    v_lshlrev_b32 v234, 1, v1
    v_and_b32 v234, s82, v234
    v_lshlrev_b32 v233, 13, v235
    v_add3_u32 v233, v233, v234, s98
    v_lshlrev_b32 v235, 11, v235
    v_add3_u32 v234, v235, v234, s99
    s_bfe_u32 s81, s26, 0x10003
    s_xor_b32 s81, s81, 1
    s_lshl_b32 s83, s25, 2
    s_lshr_b32 s4, s26, 3
    s_add_u32 s83, s83, s4
    s_xor_b32 s83, s83, 13
    s_and_b32 s4, s26, 7
    s_lshl_b32 s4, s4, 2
    s_add_u32 s4, s4, s24
    s_lshl_b32 s4, s4, 18
    v_bfe_u32 v254, v1, 0, 5
    v_mul_u32_u24 v236, 8192, v254
    v_bfe_u32 v254, v1, 5, 1
    v_mul_u32_u24 v254, 64, v254
    v_add_u32 v236, v236, v254
    v_add_u32 v236, 8064, v236
    v_add_u32 v236, s4, v236
    s_mov_b32 s16, s84
    s_and_b32 s17, s85, 0xffff
    s_mov_b32 s18, 0x800000
    s_mov_b32 s19, 0x00020000
    v_xor_b32 v240, 128, v240
    s_and_b32 s4, s26, 1
    s_lshl_b32 s98, s4, 11
    s_lshl_b32 s99, s4, 18
    s_add_u32 s98, s98, s6
    s_xor_b32 m0, s98, 0
    s_xor_b32 s5, s99, 0
    buffer_load_dwordx4 v240, s[16:19], s5 offen nt lds
    s_xor_b32 m0, s98, 1024
    s_xor_b32 s5, s99, 131072
    buffer_load_dwordx4 v240, s[16:19], s5 offen nt lds
    s_xor_b32 m0, s98, 2048
    s_xor_b32 s5, s99, 262144
    buffer_load_dwordx4 v240, s[16:19], s5 offen nt lds
    s_xor_b32 m0, s98, 3072
    s_xor_b32 s5, s99, 393216
    buffer_load_dwordx4 v240, s[16:19], s5 offen nt lds
    s_cmp_lg_u32 s80, 0
    s_cbranch_scc1 .th_8
    s_mov_b32 s76, s86
    s_and_b32 s77, s87, 0xffff
    s_mov_b32 s78, 0x800000
    s_mov_b32 s79, 0x00020000
    s_mov_b32 s82, 0
    buffer_load_dword v235, v233, s[76:79], s82 offen
    .th_8:
    s_xor_b32 m0, s98, 4096
    s_xor_b32 s5, s99, 524288
    buffer_load_dwordx4 v240, s[16:19], s5 offen nt lds
    s_xor_b32 m0, s98, 5120
    s_xor_b32 s5, s99, 655360
    buffer_load_dwordx4 v240, s[16:19], s5 offen nt lds
    s_xor_b32 m0, s98, 6144
    s_xor_b32 s5, s99, 786432
    buffer_load_dwordx4 v240, s[16:19], s5 offen nt lds
    s_xor_b32 m0, s98, 7168
    s_xor_b32 s5, s99, 917504
    buffer_load_dwordx4 v240, s[16:19], s5 offen nt lds
    s_cmp_lg_u32 s83, 0
    s_cbranch_scc1 .th_9
    s_mov_b32 s76, s86
    s_and_b32 s77, s87, 0xffff
    s_mov_b32 s78, 0x800000
    s_mov_b32 s79, 0x00020000
    s_mov_b32 s82, 0
    buffer_load_dword v235, v236, s[76:79], s82 offen
    .th_9:
    s_xor_b32 m0, s98, 8192
    s_xor_b32 s5, s99, 1048576
    buffer_load_dwordx4 v240, s[16:19], s5 offen nt lds
    s_xor_b32 m0, s98, 9216
    s_xor_b32 s5, s99, 1179648
    buffer_load_dwordx4 v240, s[16:19], s5 offen nt lds
    s_xor_b32 m0, s98, 10240
    s_xor_b32 s5, s99, 1310720
    buffer_load_dwordx4 v240, s[16:19], s5 offen nt lds
    s_xor_b32 m0, s98, 11264
    s_xor_b32 s5, s99, 1441792
    buffer_load_dwordx4 v240, s[16:19], s5 offen nt lds
    s_xor_b32 m0, s98, 12288
    s_xor_b32 s5, s99, 1572864
    buffer_load_dwordx4 v240, s[16:19], s5 offen nt lds
    s_xor_b32 m0, s98, 13312
    s_xor_b32 s5, s99, 1703936
    buffer_load_dwordx4 v240, s[16:19], s5 offen nt lds
    s_xor_b32 m0, s98, 14336
    s_xor_b32 s5, s99, 1835008
    buffer_load_dwordx4 v240, s[16:19], s5 offen nt lds
    s_xor_b32 m0, s98, 15360
    s_xor_b32 s5, s99, 1966080
    buffer_load_dwordx4 v240, s[16:19], s5 offen nt lds
    s_waitcnt vmcnt(16)
    s_barrier
    s_cmp_lg_u32 s24, 1
    s_cbranch_scc1 .ns_10
    s_mov_b64 exec, 1
    v_mov_b32 v238, s3
    v_mov_b32 v239, 0
    buffer_atomic_add v238, v239, s[20:23], 0 offen offset:196 sc1
    s_mov_b64 exec, -1
.ns_10:
    s_mov_b32 s16, s86
    s_and_b32 s17, s87, 0xffff
    s_mov_b32 s18, 0x800000
    s_mov_b32 s19, 0x00020000
    v_xor_b32 v240, 0, v240
    s_and_b32 s4, s26, 1
    s_lshl_b32 s98, s4, 11
    s_lshl_b32 s99, s4, 18
    s_add_u32 s98, s98, s6
    s_cmp_lg_u32 s81, 0
    s_cbranch_scc1 .th_11
    s_mov_b32 s76, s88
    s_and_b32 s77, s89, 0xffff
    s_mov_b32 s78, 0x800000
    s_mov_b32 s79, 0x00020000
    s_mov_b32 s82, 0
    buffer_load_dword v235, v233, s[76:79], s82 offen
    .th_11:
    s_xor_b32 m0, s98, 16384
    s_xor_b32 s5, s99, 0
    buffer_load_dwordx4 v240, s[16:19], s5 offen nt lds
    s_xor_b32 m0, s98, 17408
    s_xor_b32 s5, s99, 131072
    buffer_load_dwordx4 v240, s[16:19], s5 offen nt lds
    s_xor_b32 m0, s98, 18432
    s_xor_b32 s5, s99, 262144
    buffer_load_dwordx4 v240, s[16:19], s5 offen nt lds
    s_xor_b32 m0, s98, 19456
    s_xor_b32 s5, s99, 393216
    buffer_load_dwordx4 v240, s[16:19], s5 offen nt lds
    s_xor_b32 m0, s98, 20480
    s_xor_b32 s5, s99, 524288
    buffer_load_dwordx4 v240, s[16:19], s5 offen nt lds
    s_xor_b32 m0, s98, 21504
    s_xor_b32 s5, s99, 655360
    buffer_load_dwordx4 v240, s[16:19], s5 offen nt lds
    s_xor_b32 m0, s98, 22528
    s_xor_b32 s5, s99, 786432
    buffer_load_dwordx4 v240, s[16:19], s5 offen nt lds
    s_xor_b32 m0, s98, 23552
    s_xor_b32 s5, s99, 917504
    buffer_load_dwordx4 v240, s[16:19], s5 offen nt lds
    s_xor_b32 m0, s98, 24576
    s_xor_b32 s5, s99, 1048576
    buffer_load_dwordx4 v240, s[16:19], s5 offen nt lds
    s_xor_b32 m0, s98, 25600
    s_xor_b32 s5, s99, 1179648
    buffer_load_dwordx4 v240, s[16:19], s5 offen nt lds
    s_xor_b32 m0, s98, 26624
    s_xor_b32 s5, s99, 1310720
    buffer_load_dwordx4 v240, s[16:19], s5 offen nt lds
    s_xor_b32 m0, s98, 27648
    s_xor_b32 s5, s99, 1441792
    buffer_load_dwordx4 v240, s[16:19], s5 offen nt lds
    s_xor_b32 m0, s98, 28672
    s_xor_b32 s5, s99, 1572864
    buffer_load_dwordx4 v240, s[16:19], s5 offen nt lds
    s_xor_b32 m0, s98, 29696
    s_xor_b32 s5, s99, 1703936
    buffer_load_dwordx4 v240, s[16:19], s5 offen nt lds
    s_xor_b32 m0, s98, 30720
    s_xor_b32 s5, s99, 1835008
    buffer_load_dwordx4 v240, s[16:19], s5 offen nt lds
    s_xor_b32 m0, s98, 31744
    s_xor_b32 s5, s99, 1966080
    buffer_load_dwordx4 v240, s[16:19], s5 offen nt lds
    s_lshr_b32 s52, s26, 2
    s_and_b32 s53, s26, 3
    s_lshl_b32 s54, s25, 14
    s_lshl_b32 s55, s26, 9
    s_add_u32 s55, s55, s54
    s_lshl_b32 s56, s25, 3
    s_add_u32 s56, s56, s52
    s_lshl_b32 s57, s56, 12
    s_lshl_b32 s58, s53, 9
    s_add_u32 s58, s58, s57
    s_mov_b32 s48, 0x00ff00ff
    s_mov_b32 s49, 0x00ff00ff
    s_mov_b32 s50, 0xff00ff00
    s_mov_b32 s51, 0xff00ff00
    v_mov_b32 v2, 0x4444
    v_mov_b32 v4, 0xeeee
    s_lshl_b32 s4, s24, 12
    s_add_u32 s4, s4, s54
    s_mov_b32 vcc_lo, 0x33333333
    s_mov_b32 vcc_hi, 0x33333333
    v_cndmask_b32 v2, v4, v2, vcc
    v_bfe_u32 v254, v1, 0, 6
    v_mul_u32_u24 v3, 16, v254
    v_add_u32 v3, s4, v3
    v_add_u32 v4, 0x10000, v3
    s_mul_i32 s4, s24, 1152
    v_bfe_u32 v254, v1, 4, 1
    v_mul_u32_u24 v5, 576, v254
    v_bfe_u32 v254, v1, 5, 1
    v_mul_u32_u24 v254, 288, v254
    v_add_u32 v5, v5, v254
    v_bfe_u32 v254, v1, 0, 4
    v_mul_u32_u24 v254, 4, v254
    v_add_u32 v5, v5, v254
    v_add_u32 v5, s4, v5
    v_bfe_u32 v254, v1, 4, 1
    v_mul_u32_u24 v7, 576, v254
    v_bfe_u32 v254, v1, 5, 1
    v_mul_u32_u24 v254, 288, v254
    v_add_u32 v7, v7, v254
    v_bfe_u32 v254, v1, 0, 4
    v_mul_u32_u24 v254, 4, v254
    v_add_u32 v7, v7, v254
    v_add_u32 v7, 9472, v7
    v_add_u32 v7, s4, v7
    v_add_u32 v6, 4736, v5
    s_lshl_b32 s4, s24, 10
    v_bfe_u32 v254, v1, 0, 6
    v_mul_u32_u24 v8, 16, v254
    v_add_u32 v8, 14080, v8
    v_add_u32 v8, s4, v8
    s_and_b32 s4, s24, 1
    s_lshr_b32 s5, s24, 1
    s_lshl_b32 s59, s4, 6
    s_mul_i32 s60, s5, 4736
    s_add_u32 s59, s59, s60
    s_lshl_b32 s4, s4, 8
    s_add_u32 s60, s58, s4
    s_lshl_b32 s5, s5, 11
    s_add_u32 s61, s60, s5
    s_cmp_lt_u32 s24, 2
    s_cselect_b32 s5, 8, 1
    s_lshl_b32 s5, s5, 10
    s_xor_b32 s61, s61, s5
    v_bfe_u32 v254, v1, 2, 3
    v_mul_u32_u24 v9, 144, v254
    v_bfe_u32 v254, v1, 5, 1
    v_mul_u32_u24 v254, 32, v254
    v_add_u32 v9, v9, v254
    v_bfe_u32 v254, v1, 0, 2
    v_mul_u32_u24 v254, 8, v254
    v_add_u32 v9, v9, v254
    v_add_u32 v9, s59, v9
    v_bfe_u32 v254, v1, 0, 6
    v_mul_u32_u24 v10, 4, v254
    v_add_u32 v10, 131072, v10
    v_add_u32 v10, s61, v10
    v_bfe_u32 v254, v1, 0, 6
    v_mul_u32_u24 v11, 4, v254
    v_add_u32 v11, 18176, v11
    v_add_u32 v11, s4, v11
    s_lshl_b32 s4, s24, 2
    v_bfe_u32 v254, v1, 2, 1
    v_mul_u32_u24 v255, 1024, v254
    v_bfe_u32 v254, v1, 4, 1
    v_mul_u32_u24 v254, 512, v254
    v_add_u32 v255, v255, v254
    v_bfe_u32 v254, v1, 5, 1
    v_mul_u32_u24 v254, 256, v254
    v_add_u32 v255, v255, v254
    v_bfe_u32 v254, v1, 3, 1
    v_mul_u32_u24 v254, 64, v254
    v_add_u32 v255, v255, v254
    v_bfe_u32 v254, v1, 0, 2
    v_mul_u32_u24 v254, 16, v254
    v_add_u32 v255, v255, v254
    v_add_u32 v255, 20224, v255
    v_add_u32 v255, s4, v255
    v_mov_b32 v20, -1
    v_mov_b32 v21, -1
    v_mov_b32 v22, -1
    v_mov_b32 v23, -1
    v_mov_b32 v40, 0
    v_mov_b32 v41, 0
    v_mov_b32 v42, 0
    v_mov_b32 v43, 0
    v_mov_b32 v44, 0
    v_mov_b32 v45, 0
    v_mov_b32 v46, 0
    v_mov_b32 v47, 0
    v_mov_b32 v48, 0
    v_mov_b32 v49, 0
    v_mov_b32 v50, 0
    v_mov_b32 v51, 0
    v_mov_b32 v52, 0
    v_mov_b32 v53, 0
    v_mov_b32 v54, 0
    v_mov_b32 v55, 0
    v_mov_b32 v56, 0
    v_mov_b32 v57, 0
    v_mov_b32 v58, 0
    v_mov_b32 v59, 0
    v_mov_b32 v60, 0
    v_mov_b32 v61, 0
    v_mov_b32 v62, 0
    v_mov_b32 v63, 0
    v_mov_b32 v64, 0
    v_mov_b32 v65, 0
    v_mov_b32 v66, 0
    v_mov_b32 v67, 0
    v_mov_b32 v68, 0
    v_mov_b32 v69, 0
    v_mov_b32 v70, 0
    v_mov_b32 v71, 0
    v_bfe_u32 v254, v1, 0, 5
    v_mul_u32_u24 v244, 16, v254
    v_bfe_u32 v254, v1, 5, 1
    v_mul_u32_u24 v254, 2048, v254
    v_add_u32 v244, v244, v254
    v_add_u32 v244, 131072, v244
    v_add_u32 v244, s58, v244
    v_bfe_u32 v254, v1, 0, 5
    v_mul_u32_u24 v245, 16, v254
    v_bfe_u32 v254, v1, 5, 1
    v_mul_u32_u24 v254, 65536, v254
    v_add_u32 v245, v245, v254
    v_add_u32 v245, s55, v245
    s_lshl_b32 s4, s53, 10
    s_add_u32 s4, s4, s57
    v_bfe_u32 v254, v1, 0, 6
    v_mul_u32_u24 v246, 16, v254
    v_add_u32 v246, 131072, v246
    v_add_u32 v246, s4, v246
    v_subrev_u32 v237, 0x20000, v246
    v_lshrrev_b32 v237, 2, v237
    v_add_u32 v237, 262144, v237
    s_waitcnt vmcnt(16)
    ds_read_b64_tr_b16 a[0:1], v242 offset:0
    ds_read_b64_tr_b16 a[2:3], v242 offset:512
    ds_read_b64_tr_b16 a[4:5], v242 offset:2048
    ds_read_b64_tr_b16 a[6:7], v242 offset:2560
    ds_read_b64_tr_b16 a[8:9], v242 offset:4096
    ds_read_b64_tr_b16 a[10:11], v242 offset:4608
    ds_read_b64_tr_b16 a[12:13], v242 offset:6144
    ds_read_b64_tr_b16 a[14:15], v242 offset:6656
    ds_read_b64_tr_b16 a[16:17], v242 offset:8192
    ds_read_b64_tr_b16 a[18:19], v242 offset:8704
    ds_read_b64_tr_b16 a[20:21], v242 offset:10240
    ds_read_b64_tr_b16 a[22:23], v242 offset:10752
    ds_read_b64_tr_b16 a[24:25], v242 offset:12288
    ds_read_b64_tr_b16 a[26:27], v242 offset:12800
    ds_read_b64_tr_b16 a[28:29], v242 offset:14336
    ds_read_b64_tr_b16 a[30:31], v242 offset:14848
    ds_read_b64_tr_b16 a[32:33], v243 offset:0
    ds_read_b64_tr_b16 a[34:35], v243 offset:512
    ds_read_b64_tr_b16 a[36:37], v243 offset:2048
    ds_read_b64_tr_b16 a[38:39], v243 offset:2560
    ds_read_b64_tr_b16 a[40:41], v243 offset:4096
    ds_read_b64_tr_b16 a[42:43], v243 offset:4608
    ds_read_b64_tr_b16 a[44:45], v243 offset:6144
    ds_read_b64_tr_b16 a[46:47], v243 offset:6656
    ds_read_b64_tr_b16 a[48:49], v243 offset:8192
    ds_read_b64_tr_b16 a[50:51], v243 offset:8704
    ds_read_b64_tr_b16 a[52:53], v243 offset:10240
    ds_read_b64_tr_b16 a[54:55], v243 offset:10752
    ds_read_b64_tr_b16 a[56:57], v243 offset:12288
    ds_read_b64_tr_b16 a[58:59], v243 offset:12800
    ds_read_b64_tr_b16 a[60:61], v243 offset:14336
    ds_read_b64_tr_b16 a[62:63], v243 offset:14848
    s_waitcnt lgkmcnt(0)
    s_mov_b32 s16, s88
    s_and_b32 s17, s89, 0xffff
    s_mov_b32 s18, 0x800000
    s_mov_b32 s19, 0x00020000
    v_xor_b32 v240, 128, v240
    s_and_b32 s4, s26, 1
    s_lshl_b32 s98, s4, 11
    s_lshl_b32 s99, s4, 18
    s_add_u32 s98, s98, s6
    s_cmp_lg_u32 s64, 0
    s_cbranch_scc1 .th_12
    s_mov_b32 s76, s90
    s_and_b32 s77, s91, 0xffff
    s_mov_b32 s78, 0x800000
    s_mov_b32 s79, 0x00020000
    s_mov_b32 s82, 0
    buffer_load_dword v235, v234, s[76:79], s82 offen
    .th_12:
    s_xor_b32 m0, s98, 0
    s_xor_b32 s5, s99, 0
    buffer_load_dwordx4 v240, s[16:19], s5 offen nt lds
    s_xor_b32 m0, s98, 1024
    s_xor_b32 s5, s99, 131072
    buffer_load_dwordx4 v240, s[16:19], s5 offen nt lds
    s_xor_b32 m0, s98, 2048
    s_xor_b32 s5, s99, 262144
    buffer_load_dwordx4 v240, s[16:19], s5 offen nt lds
    s_xor_b32 m0, s98, 3072
    s_xor_b32 s5, s99, 393216
    buffer_load_dwordx4 v240, s[16:19], s5 offen nt lds
    s_xor_b32 m0, s98, 4096
    s_xor_b32 s5, s99, 524288
    buffer_load_dwordx4 v240, s[16:19], s5 offen nt lds
    s_xor_b32 m0, s98, 5120
    s_xor_b32 s5, s99, 655360
    buffer_load_dwordx4 v240, s[16:19], s5 offen nt lds
    s_xor_b32 m0, s98, 6144
    s_xor_b32 s5, s99, 786432
    buffer_load_dwordx4 v240, s[16:19], s5 offen nt lds
    s_xor_b32 m0, s98, 7168
    s_xor_b32 s5, s99, 917504
    buffer_load_dwordx4 v240, s[16:19], s5 offen nt lds
    s_xor_b32 m0, s98, 8192
    s_xor_b32 s5, s99, 1048576
    buffer_load_dwordx4 v240, s[16:19], s5 offen nt lds
    s_xor_b32 m0, s98, 9216
    s_xor_b32 s5, s99, 1179648
    buffer_load_dwordx4 v240, s[16:19], s5 offen nt lds
    s_xor_b32 m0, s98, 10240
    s_xor_b32 s5, s99, 1310720
    buffer_load_dwordx4 v240, s[16:19], s5 offen nt lds
    s_xor_b32 m0, s98, 11264
    s_xor_b32 s5, s99, 1441792
    buffer_load_dwordx4 v240, s[16:19], s5 offen nt lds
    s_xor_b32 m0, s98, 12288
    s_xor_b32 s5, s99, 1572864
    buffer_load_dwordx4 v240, s[16:19], s5 offen nt lds
    s_xor_b32 m0, s98, 13312
    s_xor_b32 s5, s99, 1703936
    buffer_load_dwordx4 v240, s[16:19], s5 offen nt lds
    s_xor_b32 m0, s98, 14336
    s_xor_b32 s5, s99, 1835008
    buffer_load_dwordx4 v240, s[16:19], s5 offen nt lds
    s_xor_b32 m0, s98, 15360
    s_xor_b32 s5, s99, 1966080
    buffer_load_dwordx4 v240, s[16:19], s5 offen nt lds
    s_waitcnt vmcnt(16)
    ds_read_b64_tr_b16 a[64:65], v242 offset:16384
    ds_read_b64_tr_b16 a[66:67], v242 offset:16896
    ds_read_b64_tr_b16 a[68:69], v242 offset:18432
    ds_read_b64_tr_b16 a[70:71], v242 offset:18944
    ds_read_b64_tr_b16 a[72:73], v242 offset:20480
    ds_read_b64_tr_b16 a[74:75], v242 offset:20992
    ds_read_b64_tr_b16 a[76:77], v242 offset:22528
    ds_read_b64_tr_b16 a[78:79], v242 offset:23040
    ds_read_b64_tr_b16 a[80:81], v242 offset:24576
    ds_read_b64_tr_b16 a[82:83], v242 offset:25088
    ds_read_b64_tr_b16 a[84:85], v242 offset:26624
    ds_read_b64_tr_b16 a[86:87], v242 offset:27136
    ds_read_b64_tr_b16 a[88:89], v242 offset:28672
    ds_read_b64_tr_b16 a[90:91], v242 offset:29184
    ds_read_b64_tr_b16 a[92:93], v242 offset:30720
    ds_read_b64_tr_b16 a[94:95], v242 offset:31232
    ds_read_b64_tr_b16 a[96:97], v243 offset:16384
    ds_read_b64_tr_b16 a[98:99], v243 offset:16896
    ds_read_b64_tr_b16 a[100:101], v243 offset:18432
    ds_read_b64_tr_b16 a[102:103], v243 offset:18944
    ds_read_b64_tr_b16 a[104:105], v243 offset:20480
    ds_read_b64_tr_b16 a[106:107], v243 offset:20992
    ds_read_b64_tr_b16 a[108:109], v243 offset:22528
    ds_read_b64_tr_b16 a[110:111], v243 offset:23040
    ds_read_b64_tr_b16 a[112:113], v243 offset:24576
    ds_read_b64_tr_b16 a[114:115], v243 offset:25088
    ds_read_b64_tr_b16 a[116:117], v243 offset:26624
    ds_read_b64_tr_b16 a[118:119], v243 offset:27136
    ds_read_b64_tr_b16 a[120:121], v243 offset:28672
    ds_read_b64_tr_b16 a[122:123], v243 offset:29184
    ds_read_b64_tr_b16 a[124:125], v243 offset:30720
    ds_read_b64_tr_b16 a[126:127], v243 offset:31232
    s_waitcnt lgkmcnt(0)
    v_or_b32 v239, 32, v1
    v_lshlrev_b32 v239, 2, v239
    buffer_load_dword v238, v239, s[20:23], 0 offen sc1
    s_mov_b32 s12, s40
    s_and_b32 s13, s41, 0xffff
    s_mov_b32 s14, 0x4000
    s_mov_b32 s15, 0x00020000
    s_xor_b32 s4, s26, 4
    s_lshl_b32 s4, s4, 6
    v_bfe_u32 v254, v1, 1, 1
    v_mul_u32_u24 v247, 2048, v254
    v_bfe_u32 v254, v1, 5, 1
    v_mul_u32_u24 v254, 4096, v254
    v_add_u32 v247, v247, v254
    v_bfe_u32 v254, v1, 3, 1
    v_mul_u32_u24 v254, 8192, v254
    v_add_u32 v247, v247, v254
    v_bfe_u32 v254, v1, 4, 1
    v_mul_u32_u24 v254, 16, v254
    v_add_u32 v247, v247, v254
    v_bfe_u32 v254, v1, 2, 1
    v_mul_u32_u24 v254, 32, v254
    v_add_u32 v247, v247, v254
    v_bfe_u32 v254, v1, 0, 1
    v_mul_u32_u24 v254, 8, v254
    v_add_u32 v247, v247, v254
    buffer_load_dwordx2 v[248:249], v247, s[12:15], s4 offen
    s_mov_b32 s16, s90
    s_and_b32 s17, s91, 0xffff
    s_mov_b32 s18, 0x800000
    s_mov_b32 s19, 0x00020000
    s_and_b32 s4, s26, 1
    s_lshl_b32 s98, s4, 11
    s_lshl_b32 s99, s4, 16
    s_add_u32 s98, s98, s6
    s_xor_b32 m0, s98, 16384
    s_xor_b32 s5, s99, 0
    buffer_load_dwordx4 v241, s[16:19], s5 offen nt lds
    s_xor_b32 m0, s98, 17408
    s_xor_b32 s5, s99, 32768
    buffer_load_dwordx4 v241, s[16:19], s5 offen nt lds
    s_xor_b32 m0, s98, 18432
    s_xor_b32 s5, s99, 65536
    buffer_load_dwordx4 v241, s[16:19], s5 offen nt lds
    s_xor_b32 m0, s98, 19456
    s_xor_b32 s5, s99, 98304
    buffer_load_dwordx4 v241, s[16:19], s5 offen nt lds
    s_xor_b32 m0, s98, 20480
    s_xor_b32 s5, s99, 131072
    buffer_load_dwordx4 v241, s[16:19], s5 offen nt lds
    s_xor_b32 m0, s98, 21504
    s_xor_b32 s5, s99, 163840
    buffer_load_dwordx4 v241, s[16:19], s5 offen nt lds
    s_xor_b32 m0, s98, 22528
    s_xor_b32 s5, s99, 196608
    buffer_load_dwordx4 v241, s[16:19], s5 offen nt lds
    s_xor_b32 m0, s98, 23552
    s_xor_b32 s5, s99, 229376
    buffer_load_dwordx4 v241, s[16:19], s5 offen nt lds
    s_xor_b32 m0, s98, 24576
    s_xor_b32 s5, s99, 262144
    buffer_load_dwordx4 v241, s[16:19], s5 offen nt lds
    s_xor_b32 m0, s98, 25600
    s_xor_b32 s5, s99, 294912
    buffer_load_dwordx4 v241, s[16:19], s5 offen nt lds
    s_xor_b32 m0, s98, 26624
    s_xor_b32 s5, s99, 327680
    buffer_load_dwordx4 v241, s[16:19], s5 offen nt lds
    s_xor_b32 m0, s98, 27648
    s_xor_b32 s5, s99, 360448
    buffer_load_dwordx4 v241, s[16:19], s5 offen nt lds
    s_xor_b32 m0, s98, 28672
    s_xor_b32 s5, s99, 393216
    buffer_load_dwordx4 v241, s[16:19], s5 offen nt lds
    s_xor_b32 m0, s98, 29696
    s_xor_b32 s5, s99, 425984
    buffer_load_dwordx4 v241, s[16:19], s5 offen nt lds
    s_xor_b32 m0, s98, 30720
    s_xor_b32 s5, s99, 458752
    buffer_load_dwordx4 v241, s[16:19], s5 offen nt lds
    s_xor_b32 m0, s98, 31744
    s_xor_b32 s5, s99, 491520
    buffer_load_dwordx4 v241, s[16:19], s5 offen nt lds
    s_waitcnt vmcnt(16)
    s_cmp_lg_u32 s27, 0
    s_cbranch_scc1 .vd_14
    s_mov_b32 s62, 0
.vp_13:
    v_readlane_b32 s4, v238, 49
    s_and_b32 s5, s4, 0xffff
    s_cmp_ge_u32 s5, 256
    s_cbranch_scc1 .va_15
    s_add_u32 s62, s62, 1
    s_cmp_gt_u32 s62, 0x100000
    s_cbranch_scc1 .mg_end_1
    s_sleep 16
    buffer_load_dword v238, v239, s[20:23], 0 offen sc1
    s_waitcnt vmcnt(0)
    s_branch .vp_13
.va_15:
    s_lshr_b32 s4, s4, 16
    s_cbranch_scc0 .vd_14
    s_lshr_b32 s25, s2, 5
    s_and_b32 s26, s2, 31
    s_mov_b32 s27, 1
    s_waitcnt vmcnt(0) lgkmcnt(0)
    s_barrier
    s_branch .mg_role_3
.vd_14:
    ds_read_b64_tr_b16 a[128:129], v242 offset:0
    ds_read_b64_tr_b16 a[130:131], v242 offset:512
    ds_read_b64_tr_b16 a[132:133], v242 offset:2048
    ds_read_b64_tr_b16 a[134:135], v242 offset:2560
    ds_read_b64_tr_b16 a[136:137], v242 offset:4096
    ds_read_b64_tr_b16 a[138:139], v242 offset:4608
    ds_read_b64_tr_b16 a[140:141], v242 offset:6144
    ds_read_b64_tr_b16 a[142:143], v242 offset:6656
    ds_read_b64_tr_b16 a[144:145], v242 offset:8192
    ds_read_b64_tr_b16 a[146:147], v242 offset:8704
    ds_read_b64_tr_b16 a[148:149], v242 offset:10240
    ds_read_b64_tr_b16 a[150:151], v242 offset:10752
    ds_read_b64_tr_b16 a[152:153], v242 offset:12288
    ds_read_b64_tr_b16 a[154:155], v242 offset:12800
    ds_read_b64_tr_b16 a[156:157], v242 offset:14336
    ds_read_b64_tr_b16 a[158:159], v242 offset:14848
    ds_read_b64_tr_b16 a[160:161], v243 offset:0
    ds_read_b64_tr_b16 a[162:163], v243 offset:512
    ds_read_b64_tr_b16 a[164:165], v243 offset:2048
    ds_read_b64_tr_b16 a[166:167], v243 offset:2560
    ds_read_b64_tr_b16 a[168:169], v243 offset:4096
    ds_read_b64_tr_b16 a[170:171], v243 offset:4608
    ds_read_b64_tr_b16 a[172:173], v243 offset:6144
    ds_read_b64_tr_b16 a[174:175], v243 offset:6656
    ds_read_b64_tr_b16 a[176:177], v243 offset:8192
    ds_read_b64_tr_b16 a[178:179], v243 offset:8704
    ds_read_b64_tr_b16 a[180:181], v243 offset:10240
    ds_read_b64_tr_b16 a[182:183], v243 offset:10752
    ds_read_b64_tr_b16 a[184:185], v243 offset:12288
    ds_read_b64_tr_b16 a[186:187], v243 offset:12800
    ds_read_b64_tr_b16 a[188:189], v243 offset:14336
    ds_read_b64_tr_b16 a[190:191], v243 offset:14848
    s_waitcnt lgkmcnt(0)
    s_mov_b32 s63, 0
    s_cmp_lg_u32 s27, 0
    s_cbranch_scc1 .cd_17
    s_mov_b32 s62, 0
.cp_16:
    v_and_b32 v18, 0xffff, v238
    v_lshrrev_b32 v19, 16, v238
    v_min_u32 v17, v18, v19
    v_cmp_eq_u32 vcc, 0, v17
    s_and_b32 s4, vcc_hi, 65280
    s_cbranch_scc0 .cg_18
    s_add_u32 s62, s62, 1
    s_cmp_gt_u32 s62, 0x100000
    s_cbranch_scc1 .mg_end_1
    s_sleep 16
    buffer_load_dword v238, v239, s[20:23], 0 offen sc1
    s_waitcnt vmcnt(0)
    s_branch .cp_16
.cg_18:
    v_cmp_eq_u32 vcc, 2, v18
    s_bfe_u32 s63, vcc_hi, 524296
    v_cmp_eq_u32 vcc, 2, v19
    s_bfe_u32 s4, vcc_hi, 524296
    s_lshl_b32 s4, s4, 8
    s_or_b32 s63, s63, s4
    s_xor_b32 s4, s63, 0xaaaa
    s_bcnt1_i32_b32 s4, s4
    s_cmp_le_u32 s4, 3
    s_cselect_b32 s63, 0xaaaa, s63
    s_cmp_ge_u32 s4, 13
    s_cselect_b32 s63, 0x5555, s63
.cd_17:
    s_cmp_lg_u32 s27, 0
    s_cbranch_scc1 .slowv_19
    s_mov_b32 s28, 0
    s_mov_b32 s30, 83886080
    s_mov_b32 s31, 84180992
    s_mov_b32 s32, 84475904
    s_mov_b32 s33, 84770816
    s_mov_b32 s41, 66977792
    s_lshl_b32 s42, s56, 13
    s_lshl_b32 s4, s53, 11
    s_add_u32 s44, s42, s4
    s_add_u32 s44, s44, 33554432
    s_add_u32 s42, s42, 16777216
    s_xor_b32 s4, s53, 2
    s_lshl_b32 s4, s4, 10
    s_add_u32 s42, s42, s4
    s_add_u32 s43, s42, 4096
    s_add_u32 s96, s44, 524288
    s_sub_u32 s95, s96, 16777216
    s_mov_b32 s62, 0
    s_mov_b32 s45, 0x3e0293ee
    s_mov_b32 s46, 0
    s_and_b32 s4, s25, 1
    s_lshl_b32 s4, s4, 14
    s_lshr_b32 s5, s25, 1
    s_lshl_b32 s5, s5, 12
    s_or_b32 s4, s4, s5
    s_xor_b32 s47, s47, s4
    s_and_b32 s5, s26, 1
    s_lshl_b32 s5, s5, 11
    s_lshr_b32 s4, s26, 1
    s_lshl_b32 s4, s4, 15
    s_or_b32 s5, s5, s4
    s_bfe_u32 s4, s26, 0x10004
    s_lshl_b32 s4, s4, 11
    s_xor_b32 s5, s5, s4
    s_xor_b32 s34, s5, s47
    s_xor_b32 s35, s34, 0x84000
    s_xor_b32 s36, s34, 0x101000
    s_xor_b32 s37, s34, 0x185000
    s_and_b32 s4, s25, 1
    s_lshl_b32 s35, s4, 14
    s_lshr_b32 s4, s25, 1
    s_lshl_b32 s4, s4, 12
    s_or_b32 s35, s35, s4
    s_and_b32 s4, s26, 1
    s_lshl_b32 s4, s4, 11
    s_or_b32 s35, s35, s4
    s_lshr_b32 s4, s26, 1
    s_lshl_b32 s4, s4, 15
    s_or_b32 s35, s35, s4
    s_cmp_eq_u32 s24, 1
    s_cbranch_scc1 .w1_21
    s_cmp_eq_u32 s24, 2
    s_cbranch_scc1 .w2_22
    s_cmp_eq_u32 s24, 3
    s_cbranch_scc1 .w3_23
.w0_20:
    v_bfe_u32 v254, v1, 4, 1
    v_mul_u32_u24 v168, 1024, v254
    v_bfe_u32 v254, v1, 5, 1
    v_mul_u32_u24 v254, 128, v254
    v_add_u32 v168, v168, v254
    v_bfe_u32 v254, v1, 3, 1
    v_mul_u32_u24 v254, 64, v254
    v_add_u32 v168, v168, v254
    v_bfe_u32 v254, v1, 0, 2
    v_mul_u32_u24 v254, 16, v254
    v_add_u32 v168, v168, v254
    v_bfe_u32 v254, v1, 2, 1
    v_mul_u32_u24 v254, 8, v254
    v_add_u32 v168, v168, v254
    v_add_u32 v168, s101, v168
    v_bfe_u32 v254, v1, 0, 1
    v_mul_u32_u24 v9, 144, v254
    v_bfe_u32 v254, v1, 1, 1
    v_mul_u32_u24 v254, 576, v254
    v_add_u32 v9, v9, v254
    v_bfe_u32 v254, v1, 2, 1
    v_mul_u32_u24 v254, 288, v254
    v_add_u32 v9, v9, v254
    v_bfe_u32 v254, v1, 3, 1
    v_mul_u32_u24 v254, 1152, v254
    v_add_u32 v9, v9, v254
    v_bfe_u32 v254, v1, 4, 2
    v_mul_u32_u24 v254, 32, v254
    v_add_u32 v9, v9, v254
    s_lshl_b32 s4, s56, 10
    v_bfe_u32 v254, v1, 0, 6
    v_mul_u32_u24 v13, 16, v254
    v_add_u32 v13, 262144, v13
    v_add_u32 v13, s4, v13
    v_xor_b32 v156, 1024, v246
    v_xor_b32 v157, 2048, v246
    v_xor_b32 v158, 3072, v246
    v_bfe_u32 v254, v1, 0, 1
    v_mul_u32_u24 v14, 16, v254
    v_bfe_u32 v254, v1, 4, 1
    v_mul_u32_u24 v254, 32, v254
    v_add_u32 v14, v14, v254
    v_bfe_u32 v254, v1, 1, 2
    v_mul_u32_u24 v254, 64, v254
    v_add_u32 v14, v14, v254
    v_bfe_u32 v254, v1, 5, 1
    v_mul_u32_u24 v254, 256, v254
    v_add_u32 v14, v14, v254
    v_add_u32 v14, 65536, v14
    v_add_u32 v14, s55, v14
    v_bfe_u32 v254, v1, 0, 6
    v_mul_u32_u24 v15, 16, v254
    v_bfe_u32 v254, v1, 2, 2
    v_mul_u32_u24 v16, 128, v254
    v_bfe_u32 v254, v1, 0, 2
    v_mul_u32_u24 v254, 16, v254
    v_add_u32 v16, v16, v254
    v_bfe_u32 v254, v1, 4, 2
    v_mul_u32_u24 v254, 4, v254
    v_add_u32 v16, v16, v254
    v_add_u32 v16, 18688, v16
    v_mov_b32 v208, 0
    v_mov_b32 v209, 0
    v_mov_b32 v210, 0
    v_mov_b32 v211, 0
    v_mov_b32 v212, 0
    v_mov_b32 v213, 0
    v_mov_b32 v214, 0
    v_mov_b32 v215, 0
    v_mov_b32 v216, 0
    v_mov_b32 v217, 0
    v_mov_b32 v218, 0
    v_mov_b32 v219, 0
    s_mov_b64 s[50:51], s[48:49]
    v_mov_b32 v164, 0
    v_mov_b32 v165, 0
    v_mov_b32 v166, 0
    v_mov_b32 v167, 0
    v_mov_b32 v164, 0x3f803f80
    v_mov_b32 v200, s45
    v_mov_b32 v220, 0x3f803f80
    v_mov_b32 v201, s45
    v_mov_b32 v221, 0x3f803f80
    v_mov_b32 v202, s45
    v_mov_b32 v222, 0x3f803f80
    v_mov_b32 v203, s45
    v_mov_b32 v223, 0x3f803f80
    buffer_load_dwordx4 v[24:27], v246, s[8:11], s30 offen sc1
    buffer_load_dwordx4 v[28:31], v245, s[8:11], s30 offen sc1
    buffer_load_dword v32, v237, s[8:11], s30 offen sc1
    s_waitcnt vmcnt(0)
    ds_read_b64_tr_b16 a[192:193], v242 offset:16384
    ds_read_b64_tr_b16 a[194:195], v242 offset:16896
    ds_read_b64_tr_b16 a[196:197], v242 offset:18432
    ds_read_b64_tr_b16 a[198:199], v242 offset:18944
    ds_read_b64_tr_b16 a[200:201], v242 offset:20480
    ds_read_b64_tr_b16 a[202:203], v242 offset:20992
    ds_read_b64_tr_b16 a[204:205], v242 offset:22528
    ds_read_b64_tr_b16 a[206:207], v242 offset:23040
    ds_read_b64_tr_b16 a[208:209], v242 offset:24576
    ds_read_b64_tr_b16 a[210:211], v242 offset:25088
    ds_read_b64_tr_b16 a[212:213], v242 offset:26624
    ds_read_b64_tr_b16 a[214:215], v242 offset:27136
    ds_read_b64_tr_b16 a[216:217], v242 offset:28672
    ds_read_b64_tr_b16 a[218:219], v242 offset:29184
    ds_read_b64_tr_b16 a[220:221], v242 offset:30720
    ds_read_b64_tr_b16 a[222:223], v242 offset:31232
    ds_read_b64_tr_b16 a[224:225], v243 offset:16384
    ds_read_b64_tr_b16 a[226:227], v243 offset:16896
    ds_read_b64_tr_b16 a[228:229], v243 offset:18432
    ds_read_b64_tr_b16 a[230:231], v243 offset:18944
    ds_read_b64_tr_b16 a[232:233], v243 offset:20480
    ds_read_b64_tr_b16 a[234:235], v243 offset:20992
    ds_read_b64_tr_b16 a[236:237], v243 offset:22528
    ds_read_b64_tr_b16 a[238:239], v243 offset:23040
    ds_read_b64_tr_b16 a[240:241], v243 offset:24576
    ds_read_b64_tr_b16 a[242:243], v243 offset:25088
    ds_read_b64_tr_b16 a[244:245], v243 offset:26624
    ds_read_b64_tr_b16 a[246:247], v243 offset:27136
    ds_read_b64_tr_b16 a[248:249], v243 offset:28672
    ds_read_b64_tr_b16 a[250:251], v243 offset:29184
    ds_read_b64_tr_b16 a[252:253], v243 offset:30720
    ds_read_b64_tr_b16 a[254:255], v243 offset:31232
    s_waitcnt lgkmcnt(0)
    s_barrier
    buffer_load_dwordx4 v[104:107], v15, s[8:11], s42 offen offset:0
    buffer_load_dwordx4 v[120:123], v15, s[8:11], s43 offen offset:0
    buffer_load_dwordx4 v[136:139], v15, s[8:11], s44 offen offset:0
    buffer_load_dwordx4 v[140:143], v15, s[8:11], s44 offen offset:1024
    s_add_u32 s37, s28, 0
    s_bitcmp1_b32 s37, 0
    s_cselect_b32 s4, 0x84000, 0
    s_xor_b32 s34, s35, s4
    s_bitcmp1_b32 s37, 1
    s_cselect_b32 s4, 0x101000, 0
    s_xor_b32 s34, s34, s4
    s_lshr_b32 s37, s37, 2
    s_bitcmp1_b32 s63, s37
    s_cselect_b32 s4, 0x2000, 0
    s_xor_b32 s34, s34, s4
    s_lshl_b32 s37, s37, 21
    s_add_u32 s34, s34, s37
.p2align 6
.step_26:
    s_barrier
    s_setprio 3
    buffer_load_dwordx4 v[24:27], v3, s[8:11], s30 offen offset:0 sc1
    s_setprio 2
    buffer_load_dwordx4 v[28:31], v3, s[8:11], s30 offen offset:1024 sc1
    s_setprio 1
    buffer_load_dwordx4 v[32:35], v3, s[8:11], s30 offen offset:2048 sc1
    s_setprio 0
    buffer_load_dwordx4 v[36:39], v3, s[8:11], s30 offen offset:3072 sc1
    s_call_b64 s[98:99], .gm_24
    v_pk_add_f32 v[40:41], v[40:41], v[42:43]
    v_pk_add_f32 v[42:43], v[44:45], v[46:47]
    ds_write2_b32 v5, v40, v41 offset0:0 offset1:36
    ds_write2_b32 v5, v42, v43 offset0:16 offset1:52
    s_nop 1
    v_pk_add_f32 v[48:49], v[48:49], v[50:51]
    v_pk_add_f32 v[50:51], v[52:53], v[54:55]
    ds_write2_b32 v6, v48, v49 offset0:0 offset1:36
    ds_write2_b32 v6, v50, v51 offset0:16 offset1:52
    s_waitcnt lgkmcnt(2)
    s_barrier
    ds_read_b128 v[72:75], v9 offset:0
    ds_read_b128 v[76:79], v9 offset:2304
    ds_read_b128 v[80:83], v9 offset:16
    ds_read_b128 v[84:87], v9 offset:2320
    v_smfmac_f32_16x16x64_bf16 v[56:59], v[24:27], a[128:135], v2
    v_smfmac_f32_16x16x64_bf16 v[60:63], v[24:27], a[160:167], v2
    s_waitcnt lgkmcnt(4)
    s_barrier
    v_smfmac_f32_16x16x64_bf16 v[56:59], v[28:31], a[136:143], v2
    s_waitcnt lgkmcnt(2)
    v_pk_add_f32 v[72:73], v[72:73], v[76:77]
    v_pk_add_f32 v[74:75], v[74:75], v[78:79]
    v_cvt_pk_bf16_f32 v144, v72, v73
    v_cvt_pk_bf16_f32 v145, v74, v75
    s_waitcnt lgkmcnt(0)
    v_pk_add_f32 v[80:81], v[80:81], v[84:85]
    v_pk_add_f32 v[82:83], v[82:83], v[86:87]
    v_cvt_pk_bf16_f32 v146, v80, v81
    v_cvt_pk_bf16_f32 v147, v82, v83
    s_nop 1
    v_mfma_f32_16x16x32_bf16 v[192:195], v[104:107], v[144:147], 0
    v_mfma_f32_16x16x32_bf16 v[160:163], v[120:123], v[144:147], 0
    v_smfmac_f32_16x16x64_bf16 v[60:63], v[28:31], a[168:175], v2
    v_add_f32_dpp v151, v195, v195 row_ror:8 row_mask:0xf bank_mask:0x3
    v_add_f32_dpp v148, v192, v192 row_ror:8 row_mask:0xf bank_mask:0x3
    v_add_f32_dpp v149, v193, v193 row_ror:8 row_mask:0xf bank_mask:0x3
    v_add_f32_dpp v150, v194, v194 row_ror:8 row_mask:0xf bank_mask:0x3
    v_add_f32_dpp v151, v163, v163 row_ror:8 row_mask:0xf bank_mask:0xc
    v_add_f32_dpp v148, v160, v160 row_ror:8 row_mask:0xf bank_mask:0xc
    v_add_f32_dpp v149, v161, v161 row_ror:8 row_mask:0xf bank_mask:0xc
    v_add_f32_dpp v150, v162, v162 row_ror:8 row_mask:0xf bank_mask:0xc
    v_min_u32 v151, 0xfffffffe, v151
    buffer_store_dwordx4 v[148:151], v246, s[8:11], s30 offen
    v_smfmac_f32_16x16x64_bf16 v[56:59], v[32:35], a[144:151], v2
    v_smfmac_f32_16x16x64_bf16 v[60:63], v[32:35], a[176:183], v2
    v_smfmac_f32_16x16x64_bf16 v[56:59], v[36:39], a[152:159], v2
    v_smfmac_f32_16x16x64_bf16 v[60:63], v[36:39], a[184:191], v2
    v_mov_b32 v40, 0
    v_mov_b32 v41, 0
    v_mov_b32 v42, 0
    v_mov_b32 v43, 0
    v_mov_b32 v44, 0
    v_mov_b32 v45, 0
    v_mov_b32 v46, 0
    v_mov_b32 v47, 0
    v_pk_add_f32 v[56:57], v[56:57], v[58:59]
    v_pk_add_f32 v[58:59], v[60:61], v[62:63]
    v_cvt_pk_bf16_f32 v60, v56, v57
    v_cvt_pk_bf16_f32 v61, v58, v59
    ds_write2_b32 v255, v60, v61 offset0:0 offset1:32
    ds_write_b128 v8, v[56:59]
    s_cmp_eq_u32 s28, 63
    s_cbranch_scc1 .fin_27
    s_waitcnt lgkmcnt(0)
    buffer_load_dwordx4 v[176:179], v13, s[8:11], s30 offen sc1
    buffer_load_dwordx4 v[180:183], v156, s[8:11], s30 offen sc1
    buffer_load_dwordx4 v[184:187], v157, s[8:11], s30 offen sc1
    buffer_load_dwordx4 v[188:191], v158, s[8:11], s30 offen sc1
    s_waitcnt lgkmcnt(0)
    s_barrier
    ds_read_b128 v[212:215], v15 offset:20224
    ds_read_b128 v[216:219], v15 offset:21248
    v_mov_b32 v48, 0
    v_mov_b32 v49, 0
    v_mov_b32 v50, 0
    v_mov_b32 v51, 0
    v_mov_b32 v52, 0
    v_mov_b32 v53, 0
    v_mov_b32 v54, 0
    v_mov_b32 v55, 0
    v_mov_b32 v56, 0
    v_mov_b32 v57, 0
    v_mov_b32 v58, 0
    v_mov_b32 v59, 0
    v_mov_b32 v60, 0
    v_mov_b32 v61, 0
    v_mov_b32 v62, 0
    v_mov_b32 v63, 0
    buffer_load_dwordx4 v[72:75], v13, s[8:11], s30 offen sc1
    buffer_load_dwordx4 v[76:79], v156, s[8:11], s30 offen sc1
    buffer_load_dwordx4 v[80:83], v157, s[8:11], s30 offen sc1
    buffer_load_dwordx4 v[84:87], v158, s[8:11], s30 offen sc1
.mf_28:
    s_waitcnt vmcnt(7)
    v_max3_u32 v18, v176, v177, v178
    v_pk_add_f32 v[196:197], v[176:177], v[178:179]
    s_waitcnt vmcnt(6)
    v_max3_u32 v18, v18, v179, v183
    v_pk_add_f32 v[192:193], v[148:149], v[180:181]
    v_pk_add_f32 v[194:195], v[150:151], v[182:183]
    v_add_f32 v196, v196, v197
    s_waitcnt vmcnt(5)
    v_pk_add_f32 v[192:193], v[192:193], v[184:185]
    v_pk_add_f32 v[194:195], v[194:195], v[186:187]
    s_waitcnt vmcnt(4)
    v_max3_u32 v18, v18, v187, v191
    v_pk_add_f32 v[192:193], v[192:193], v[188:189]
    v_pk_add_f32 v[194:195], v[194:195], v[190:191]
    v_cmp_eq_u32 vcc, -1, v18
    v_max3_f32 v19, v192, v193, v196
    v_max3_f32 v19, v19, v194, v195
    s_cbranch_vccnz .re_29
.sj_30:
    s_nop 0
    v_max_f32_dpp v18, v19, v19 row_ror:8 row_mask:0xf bank_mask:0xf
    v_max_f32_dpp v17, v19, v19 row_ror:8 row_mask:0xf bank_mask:0xf
    s_nop 1
    v_permlane16_swap_b32 v18, v17
    v_max_f32 v19, v18, v17
    v_max_f32 v18, v18, v17
    s_nop 1
    v_permlane32_swap_b32 v18, v19
    v_max_f32 v18, v18, v19
    v_mul_f32 v18, s45, v18
    v_fma_f32 v244, v196, s45, -v18
    v_pk_fma_f32 v[240:241], v[192:193], v[200:201], v[18:19] op_sel_hi:[1,1,0] neg_lo:[0,0,1] neg_hi:[0,0,1]
    v_exp_f32 v244, v244
    v_pk_fma_f32 v[242:243], v[194:195], v[200:201], v[18:19] op_sel_hi:[1,1,0] neg_lo:[0,0,1] neg_hi:[0,0,1]
    v_exp_f32 v240, v240
    v_mov_b32_dpp v245, v244 row_ror:8 row_mask:0xf bank_mask:0xf
    v_cvt_pk_bf16_f32 v208, v244, v245
    v_cvt_pk_bf16_f32 v209, v244, v245
    v_pk_mov_b32 v[210:211], v[208:209], v[208:209] op_sel:[0,1]
    v_exp_f32 v241, v241
    s_waitcnt lgkmcnt(0)
    v_mfma_f32_16x16x32_bf16 v[228:231], v[212:215], v[208:211], 0
    v_exp_f32 v242, v242
    v_mfma_f32_16x16x32_bf16 v[224:227], v[164:167], v[208:211], 0
    v_exp_f32 v243, v243
    v_cvt_pk_bf16_f32 v204, v240, v241
    v_cvt_pk_bf16_f32 v205, v242, v243
    v_mfma_f32_16x16x32_bf16 v[232:235], v[216:219], v[208:211], 0
    v_mov_b32_dpp v206, v204 row_ror:8 row_mask:0xf bank_mask:0xf
    v_mov_b32_dpp v207, v205 row_ror:8 row_mask:0xf bank_mask:0xf
    s_nop 1
    v_mfma_f32_16x16x32_bf16 v[224:227], v[220:223], v[204:207], v[224:227]
    v_mfma_f32_16x16x32_bf16 v[228:231], v[136:139], v[204:207], v[228:231]
    v_mfma_f32_16x16x32_bf16 v[232:235], v[140:143], v[204:207], v[232:235]
    s_mov_b64 exec, s[50:51]
    v_rcp_f32 v18, v224
    s_nop 1
    v_mul_f32 v228, v18, v228
    v_mul_f32 v229, v18, v229
    v_mul_f32 v230, v18, v230
    v_mul_f32 v231, v18, v231
    v_pk_mul_f32 v[232:233], v[18:19], v[232:233] op_sel_hi:[0,1]
    v_pk_mul_f32 v[234:235], v[18:19], v[234:235] op_sel_hi:[0,1]
    v_cvt_pk_bf16_f32 v236, v228, v229
    v_cvt_pk_bf16_f32 v239, v234, v235
    v_cvt_pk_bf16_f32 v237, v230, v231
    v_cvt_pk_bf16_f32 v238, v232, v233
    v_min_u32 v239, 0xfffffffe, v239
    buffer_store_dwordx4 v[236:239], v14, s[8:11], s30 offen
    s_mov_b64 exec, -1
    s_add_u32 s37, s28, 0
    s_bitcmp1_b32 s37, 0
    s_cselect_b32 s4, 0x84000, 0
    s_xor_b32 s34, s35, s4
    s_bitcmp1_b32 s37, 1
    s_cselect_b32 s4, 0x101000, 0
    s_xor_b32 s34, s34, s4
    s_lshr_b32 s37, s37, 2
    s_bitcmp1_b32 s63, s37
    s_cselect_b32 s4, 0x2000, 0
    s_xor_b32 s34, s34, s4
    s_lshl_b32 s37, s37, 21
    s_add_u32 s34, s34, s37
    s_add_u32 s42, s42, 262144
    s_add_u32 s43, s43, 262144
    s_add_u32 s44, s44, 262144
    v_mov_b32 v64, 0
    v_mov_b32 v65, 0
    v_mov_b32 v66, 0
    v_mov_b32 v67, 0
    v_mov_b32 v68, 0
    v_mov_b32 v69, 0
    v_mov_b32 v70, 0
    v_mov_b32 v71, 0
    s_barrier
    s_setprio 3
    buffer_load_dwordx4 v[24:27], v4, s[8:11], s30 offen offset:0 sc1
    s_setprio 2
    buffer_load_dwordx4 v[28:31], v4, s[8:11], s30 offen offset:1024 sc1
    s_setprio 1
    buffer_load_dwordx4 v[32:35], v4, s[8:11], s30 offen offset:2048 sc1
    s_setprio 0
    buffer_load_dwordx4 v[36:39], v4, s[8:11], s30 offen offset:3072 sc1
    s_call_b64 s[98:99], .gm_25
    s_nop 4
    v_pk_add_f32 v[64:65], v[64:65], v[66:67]
    v_cvt_pk_bf16_f32 v66, v64, v65
    v_pk_add_f32 v[68:69], v[68:69], v[70:71]
    v_cvt_pk_bf16_f32 v67, v68, v69
    v_min_u32 v67, 0xfffffffe, v67
    buffer_store_dwordx2 v[66:67], v168, s[8:11], s34 offen sc1
    ds_write2_b32 v7, v64, v65 offset0:0 offset1:36
    ds_write2_b32 v7, v68, v69 offset0:16 offset1:52
    s_waitcnt lgkmcnt(0)
    s_barrier
    buffer_load_dwordx4 v[104:107], v15, s[8:11], s42 offen offset:0
    buffer_load_dwordx4 v[120:123], v15, s[8:11], s43 offen offset:0
    buffer_load_dwordx4 v[136:139], v15, s[8:11], s44 offen offset:0
    buffer_load_dwordx4 v[140:143], v15, s[8:11], s44 offen offset:1024
    s_mov_b32 s4, s30
    s_mov_b32 s30, s31
    s_mov_b32 s31, s32
    s_mov_b32 s32, s33
    s_mov_b32 s33, s4
    s_add_u32 s28, s28, 1
    s_mov_b32 s62, 0
    s_branch .step_26
.fin_27:
    s_waitcnt lgkmcnt(0)
    s_barrier
    s_barrier
    s_endpgm
.re_29:
    buffer_load_dwordx4 v[176:179], v13, s[8:11], s30 offen sc1
    buffer_load_dwordx4 v[180:183], v156, s[8:11], s30 offen sc1
    buffer_load_dwordx4 v[184:187], v157, s[8:11], s30 offen sc1
    buffer_load_dwordx4 v[188:191], v158, s[8:11], s30 offen sc1
    s_waitcnt vmcnt(7)
    v_max3_u32 v18, v72, v73, v74
    v_pk_add_f32 v[196:197], v[72:73], v[74:75]
    s_waitcnt vmcnt(6)
    v_max3_u32 v18, v18, v75, v79
    v_pk_add_f32 v[192:193], v[148:149], v[76:77]
    v_pk_add_f32 v[194:195], v[150:151], v[78:79]
    v_add_f32 v196, v196, v197
    s_waitcnt vmcnt(5)
    v_pk_add_f32 v[192:193], v[192:193], v[80:81]
    v_pk_add_f32 v[194:195], v[194:195], v[82:83]
    s_waitcnt vmcnt(4)
    v_max3_u32 v18, v18, v83, v87
    v_pk_add_f32 v[192:193], v[192:193], v[84:85]
    v_pk_add_f32 v[194:195], v[194:195], v[86:87]
    v_cmp_eq_u32 vcc, -1, v18
    v_max3_f32 v19, v192, v193, v196
    v_max3_f32 v19, v19, v194, v195
    s_cbranch_vccnz .re_31
    s_branch .sj_30
.re_31:
    buffer_load_dwordx4 v[72:75], v13, s[8:11], s30 offen sc1
    buffer_load_dwordx4 v[76:79], v156, s[8:11], s30 offen sc1
    buffer_load_dwordx4 v[80:83], v157, s[8:11], s30 offen sc1
    buffer_load_dwordx4 v[84:87], v158, s[8:11], s30 offen sc1
    s_add_u32 s62, s62, 1
    s_cmp_gt_u32 s62, 0x100000
    s_cbranch_scc1 .mg_end_1
    s_branch .mf_28
.w1_21:
    v_bfe_u32 v254, v1, 4, 1
    v_mul_u32_u24 v168, 1024, v254
    v_bfe_u32 v254, v1, 5, 1
    v_mul_u32_u24 v254, 128, v254
    v_add_u32 v168, v168, v254
    v_bfe_u32 v254, v1, 3, 1
    v_mul_u32_u24 v254, 64, v254
    v_add_u32 v168, v168, v254
    v_bfe_u32 v254, v1, 0, 2
    v_mul_u32_u24 v254, 16, v254
    v_add_u32 v168, v168, v254
    v_bfe_u32 v254, v1, 2, 1
    v_mul_u32_u24 v254, 8, v254
    v_add_u32 v168, v168, v254
    v_add_u32 v168, 256, v168
    v_add_u32 v168, s101, v168
    v_bfe_u32 v254, v1, 0, 1
    v_mul_u32_u24 v17, 2, v254
    v_bfe_u32 v254, v1, 2, 1
    v_mul_u32_u24 v254, 1, v254
    v_add_u32 v17, v17, v254
    v_bfe_u32 v254, v1, 3, 1
    v_mul_u32_u24 v254, 4, v254
    v_add_u32 v17, v17, v254
    v_bfe_u32 v254, v1, 1, 1
    v_mul_u32_u24 v18, 16, v254
    v_mov_b32 v19, 0x3f80
    v_lshlrev_b32 v18, v18, v19
    v_cmp_eq_u32 vcc, 0, v17
    s_nop 1
    v_cndmask_b32 v124, 0, v18, vcc
    v_cmp_eq_u32 vcc, 1, v17
    s_nop 1
    v_cndmask_b32 v125, 0, v18, vcc
    v_cmp_eq_u32 vcc, 2, v17
    s_nop 1
    v_cndmask_b32 v126, 0, v18, vcc
    v_cmp_eq_u32 vcc, 3, v17
    s_nop 1
    v_cndmask_b32 v127, 0, v18, vcc
    v_cmp_eq_u32 vcc, 4, v17
    s_nop 1
    v_cndmask_b32 v128, 0, v18, vcc
    v_cmp_eq_u32 vcc, 5, v17
    s_nop 1
    v_cndmask_b32 v129, 0, v18, vcc
    v_cmp_eq_u32 vcc, 6, v17
    s_nop 1
    v_cndmask_b32 v130, 0, v18, vcc
    v_cmp_eq_u32 vcc, 7, v17
    s_nop 1
    v_cndmask_b32 v131, 0, v18, vcc
    v_bfe_u32 v254, v1, 0, 1
    v_mul_u32_u24 v9, 144, v254
    v_bfe_u32 v254, v1, 1, 1
    v_mul_u32_u24 v254, 576, v254
    v_add_u32 v9, v9, v254
    v_bfe_u32 v254, v1, 2, 1
    v_mul_u32_u24 v254, 288, v254
    v_add_u32 v9, v9, v254
    v_bfe_u32 v254, v1, 3, 1
    v_mul_u32_u24 v254, 1152, v254
    v_add_u32 v9, v9, v254
    v_bfe_u32 v254, v1, 4, 2
    v_mul_u32_u24 v254, 32, v254
    v_add_u32 v9, v9, v254
    v_bfe_u32 v254, v1, 0, 1
    v_mul_u32_u24 v11, 144, v254
    v_bfe_u32 v254, v1, 2, 2
    v_mul_u32_u24 v254, 288, v254
    v_add_u32 v11, v11, v254
    v_bfe_u32 v254, v1, 1, 1
    v_mul_u32_u24 v254, 1152, v254
    v_add_u32 v11, v11, v254
    v_bfe_u32 v254, v1, 4, 2
    v_mul_u32_u24 v254, 32, v254
    v_add_u32 v11, v11, v254
    v_add_u32 v11, 4736, v11
    s_lshl_b32 s4, s56, 10
    s_lshl_b32 s5, s53, 2
    v_bfe_u32 v254, v1, 0, 6
    v_mul_u32_u24 v10, 16, v254
    v_add_u32 v10, 262144, v10
    v_add_u32 v10, s4, v10
    v_add_u32 v10, s5, v10
    v_bfe_u32 v254, v1, 1, 1
    v_mul_u32_u24 v12, 144, v254
    v_bfe_u32 v254, v1, 5, 1
    v_mul_u32_u24 v254, 288, v254
    v_add_u32 v12, v12, v254
    v_bfe_u32 v254, v1, 3, 1
    v_mul_u32_u24 v254, 576, v254
    v_add_u32 v12, v12, v254
    v_bfe_u32 v254, v1, 4, 1
    v_mul_u32_u24 v254, 32, v254
    v_add_u32 v12, v12, v254
    v_bfe_u32 v254, v1, 2, 1
    v_mul_u32_u24 v254, 64, v254
    v_add_u32 v12, v12, v254
    v_bfe_u32 v254, v1, 0, 1
    v_mul_u32_u24 v254, 16, v254
    v_add_u32 v12, v12, v254
    v_add_u32 v12, 9472, v12
    v_bfe_u32 v254, v1, 0, 6
    v_mul_u32_u24 v13, 16, v254
    v_add_u32 v13, s101, v13
    v_bfe_u32 v254, v1, 0, 2
    v_mul_u32_u24 v14, 8, v254
    v_bfe_u32 v254, v1, 4, 1
    v_mul_u32_u24 v254, 32, v254
    v_add_u32 v14, v14, v254
    v_bfe_u32 v254, v1, 3, 1
    v_mul_u32_u24 v254, 64, v254
    v_add_u32 v14, v14, v254
    v_bfe_u32 v254, v1, 5, 1
    v_mul_u32_u24 v254, 128, v254
    v_add_u32 v14, v14, v254
    v_bfe_u32 v254, v1, 2, 1
    v_mul_u32_u24 v254, 256, v254
    v_add_u32 v14, v14, v254
    v_add_u32 v14, s55, v14
    v_xor_b32 v14, 2048, v14
    v_min_u32 v249, 0xfffffffe, v249
    buffer_store_dwordx2 v[248:249], v14, s[8:11], s30 offen
    v_bfe_u32 v254, v1, 0, 6
    v_mul_u32_u24 v15, 16, v254
    s_add_u32 s42, s42, 262144
    s_add_u32 s43, s43, 262144
    s_add_u32 s44, s44, 262144
    buffer_load_dwordx4 v[24:27], v246, s[8:11], s31 offen sc1
    buffer_load_dwordx4 v[28:31], v245, s[8:11], s31 offen sc1
    buffer_load_dword v32, v237, s[8:11], s31 offen sc1
    s_waitcnt vmcnt(0)
    ds_read_b64_tr_b16 a[192:193], v242 offset:16384
    ds_read_b64_tr_b16 a[194:195], v242 offset:16896
    ds_read_b64_tr_b16 a[196:197], v242 offset:18432
    ds_read_b64_tr_b16 a[198:199], v242 offset:18944
    ds_read_b64_tr_b16 a[200:201], v242 offset:20480
    ds_read_b64_tr_b16 a[202:203], v242 offset:20992
    ds_read_b64_tr_b16 a[204:205], v242 offset:22528
    ds_read_b64_tr_b16 a[206:207], v242 offset:23040
    ds_read_b64_tr_b16 a[208:209], v242 offset:24576
    ds_read_b64_tr_b16 a[210:211], v242 offset:25088
    ds_read_b64_tr_b16 a[212:213], v242 offset:26624
    ds_read_b64_tr_b16 a[214:215], v242 offset:27136
    ds_read_b64_tr_b16 a[216:217], v242 offset:28672
    ds_read_b64_tr_b16 a[218:219], v242 offset:29184
    ds_read_b64_tr_b16 a[220:221], v242 offset:30720
    ds_read_b64_tr_b16 a[222:223], v242 offset:31232
    ds_read_b64_tr_b16 a[224:225], v243 offset:16384
    ds_read_b64_tr_b16 a[226:227], v243 offset:16896
    ds_read_b64_tr_b16 a[228:229], v243 offset:18432
    ds_read_b64_tr_b16 a[230:231], v243 offset:18944
    ds_read_b64_tr_b16 a[232:233], v243 offset:20480
    ds_read_b64_tr_b16 a[234:235], v243 offset:20992
    ds_read_b64_tr_b16 a[236:237], v243 offset:22528
    ds_read_b64_tr_b16 a[238:239], v243 offset:23040
    ds_read_b64_tr_b16 a[240:241], v243 offset:24576
    ds_read_b64_tr_b16 a[242:243], v243 offset:25088
    ds_read_b64_tr_b16 a[244:245], v243 offset:26624
    ds_read_b64_tr_b16 a[246:247], v243 offset:27136
    ds_read_b64_tr_b16 a[248:249], v243 offset:28672
    ds_read_b64_tr_b16 a[250:251], v243 offset:29184
    ds_read_b64_tr_b16 a[252:253], v243 offset:30720
    ds_read_b64_tr_b16 a[254:255], v243 offset:31232
    s_waitcnt lgkmcnt(0)
    s_barrier
    s_add_u32 s37, s28, 0
    s_bitcmp1_b32 s37, 0
    s_cselect_b32 s4, 0x84000, 0
    s_xor_b32 s34, s35, s4
    s_bitcmp1_b32 s37, 1
    s_cselect_b32 s4, 0x101000, 0
    s_xor_b32 s34, s34, s4
    s_lshr_b32 s37, s37, 2
    s_bitcmp1_b32 s63, s37
    s_cselect_b32 s4, 0x2000, 0
    s_xor_b32 s34, s34, s4
    s_lshl_b32 s37, s37, 21
    s_add_u32 s34, s34, s37
.p2align 6
.step_32:
    s_barrier
    s_setprio 3
    buffer_load_dwordx4 v[24:27], v3, s[8:11], s30 offen offset:0 sc1
    s_setprio 2
    buffer_load_dwordx4 v[28:31], v3, s[8:11], s30 offen offset:1024 sc1
    s_setprio 1
    buffer_load_dwordx4 v[32:35], v3, s[8:11], s30 offen offset:2048 sc1
    s_setprio 0
    buffer_load_dwordx4 v[36:39], v3, s[8:11], s30 offen offset:3072 sc1
    s_call_b64 s[98:99], .gm_24
    v_pk_add_f32 v[40:41], v[40:41], v[42:43]
    v_pk_add_f32 v[42:43], v[44:45], v[46:47]
    ds_write2_b32 v5, v40, v41 offset0:0 offset1:36
    ds_write2_b32 v5, v42, v43 offset0:16 offset1:52
    s_nop 1
    v_pk_add_f32 v[48:49], v[48:49], v[50:51]
    v_pk_add_f32 v[50:51], v[52:53], v[54:55]
    ds_write2_b32 v6, v48, v49 offset0:0 offset1:36
    ds_write2_b32 v6, v50, v51 offset0:16 offset1:52
    s_waitcnt lgkmcnt(2)
    s_barrier
    ds_read_b128 v[72:75], v9 offset:0
    ds_read_b128 v[76:79], v9 offset:2304
    ds_read_b128 v[80:83], v9 offset:16
    ds_read_b128 v[84:87], v9 offset:2320
    v_smfmac_f32_16x16x64_bf16 v[56:59], v[24:27], a[128:135], v2
    v_smfmac_f32_16x16x64_bf16 v[60:63], v[24:27], a[160:167], v2
    s_waitcnt lgkmcnt(4)
    s_barrier
    ds_read_b128 v[88:91], v11 offset:0
    ds_read_b128 v[92:95], v11 offset:2304
    ds_read_b128 v[96:99], v11 offset:16
    ds_read_b128 v[100:103], v11 offset:2320
    v_smfmac_f32_16x16x64_bf16 v[56:59], v[28:31], a[136:143], v2
    s_waitcnt lgkmcnt(6)
    v_pk_add_f32 v[72:73], v[72:73], v[76:77]
    v_pk_add_f32 v[74:75], v[74:75], v[78:79]
    v_cvt_pk_bf16_f32 v144, v72, v73
    v_cvt_pk_bf16_f32 v145, v74, v75
    s_waitcnt lgkmcnt(4)
    v_pk_add_f32 v[80:81], v[80:81], v[84:85]
    v_pk_add_f32 v[82:83], v[82:83], v[86:87]
    v_cvt_pk_bf16_f32 v146, v80, v81
    v_cvt_pk_bf16_f32 v147, v82, v83
    s_waitcnt lgkmcnt(2)
    v_pk_add_f32 v[88:89], v[88:89], v[92:93]
    v_pk_add_f32 v[90:91], v[90:91], v[94:95]
    v_cvt_pk_bf16_f32 v148, v88, v89
    v_cvt_pk_bf16_f32 v149, v90, v91
    s_waitcnt lgkmcnt(0)
    v_pk_add_f32 v[96:97], v[96:97], v[100:101]
    v_pk_add_f32 v[98:99], v[98:99], v[102:103]
    v_cvt_pk_bf16_f32 v150, v96, v97
    v_cvt_pk_bf16_f32 v151, v98, v99
    s_nop 1
    v_mfma_f32_16x16x32_bf16 v[196:199], v[148:151], v[144:147], 0
    v_smfmac_f32_16x16x64_bf16 v[60:63], v[28:31], a[168:175], v2
    v_smfmac_f32_16x16x64_bf16 v[56:59], v[32:35], a[144:151], v2
    v_pk_add_f32 v[196:197], v[196:197], v[198:199]
    s_nop 1
    v_add_f32_dpp v198, v196, v196 row_ror:8 row_mask:0xf bank_mask:0xf
    v_add_f32_dpp v199, v197, v197 row_ror:8 row_mask:0xf bank_mask:0xf
    v_cndmask_b32 v198, v199, v198, s[48:49]
    v_min_u32 v198, 0xfffffffe, v198
    buffer_store_dword v198, v10, s[8:11], s30 offen
    v_smfmac_f32_16x16x64_bf16 v[60:63], v[32:35], a[176:183], v2
    v_smfmac_f32_16x16x64_bf16 v[56:59], v[36:39], a[152:159], v2
    v_smfmac_f32_16x16x64_bf16 v[60:63], v[36:39], a[184:191], v2
    v_mov_b32 v40, 0
    v_mov_b32 v41, 0
    v_mov_b32 v42, 0
    v_mov_b32 v43, 0
    v_mov_b32 v44, 0
    v_mov_b32 v45, 0
    v_mov_b32 v46, 0
    v_mov_b32 v47, 0
    v_pk_add_f32 v[56:57], v[56:57], v[58:59]
    v_pk_add_f32 v[58:59], v[60:61], v[62:63]
    v_cvt_pk_bf16_f32 v60, v56, v57
    v_cvt_pk_bf16_f32 v61, v58, v59
    ds_write2_b32 v255, v60, v61 offset0:0 offset1:32
    ds_write_b128 v8, v[56:59]
    s_waitcnt lgkmcnt(0)
    s_barrier
    s_cmp_eq_u32 s28, 63
    s_cbranch_scc1 .fin_33
    s_barrier
    s_setprio 3
    buffer_load_dwordx4 v[24:27], v4, s[8:11], s30 offen offset:0 sc1
    s_setprio 2
    buffer_load_dwordx4 v[28:31], v4, s[8:11], s30 offen offset:1024 sc1
    s_setprio 1
    buffer_load_dwordx4 v[32:35], v4, s[8:11], s30 offen offset:2048 sc1
    s_setprio 0
    buffer_load_dwordx4 v[36:39], v4, s[8:11], s30 offen offset:3072 sc1
    s_call_b64 s[98:99], .gm_25
    s_nop 4
    v_pk_add_f32 v[64:65], v[64:65], v[66:67]
    v_cvt_pk_bf16_f32 v66, v64, v65
    v_pk_add_f32 v[68:69], v[68:69], v[70:71]
    v_cvt_pk_bf16_f32 v67, v68, v69
    v_min_u32 v67, 0xfffffffe, v67
    buffer_store_dwordx2 v[66:67], v168, s[8:11], s34 offen sc1
    ds_write2_b32 v7, v64, v65 offset0:0 offset1:36
    ds_write2_b32 v7, v68, v69 offset0:16 offset1:52
    s_waitcnt lgkmcnt(0)
    s_barrier
    ds_read_b128 v[72:75], v12 offset:0
    ds_read_b128 v[76:79], v12 offset:1152
    ds_read_b128 v[80:83], v12 offset:2304
    ds_read_b128 v[84:87], v12 offset:3456
    s_waitcnt lgkmcnt(2)
    v_pk_add_f32 v[72:73], v[72:73], v[76:77]
    v_pk_add_f32 v[74:75], v[74:75], v[78:79]
    s_waitcnt lgkmcnt(0)
    v_pk_add_f32 v[80:81], v[80:81], v[84:85]
    v_pk_add_f32 v[82:83], v[82:83], v[86:87]
    v_pk_add_f32 v[72:73], v[72:73], v[80:81]
    v_pk_add_f32 v[74:75], v[74:75], v[82:83]
    v_mov_b32 v64, 0
    v_mov_b32 v65, 0
    v_mov_b32 v66, 0
    v_mov_b32 v67, 0
    v_mov_b32 v68, 0
    v_mov_b32 v69, 0
    v_mov_b32 v70, 0
    v_mov_b32 v71, 0
    s_xor_b32 s38, s34, 0x4000
    s_xor_b32 s39, s34, 0x1000
    s_xor_b32 s40, s34, 0x5000
    s_add_u32 s37, s28, 1
    s_bitcmp1_b32 s37, 0
    s_cselect_b32 s4, 0x84000, 0
    s_xor_b32 s34, s35, s4
    s_bitcmp1_b32 s37, 1
    s_cselect_b32 s4, 0x101000, 0
    s_xor_b32 s34, s34, s4
    s_lshr_b32 s37, s37, 2
    s_bitcmp1_b32 s63, s37
    s_cselect_b32 s4, 0x2000, 0
    s_xor_b32 s34, s34, s4
    s_lshl_b32 s37, s37, 21
    s_add_u32 s34, s34, s37
    v_mov_b32 v48, 0
    v_mov_b32 v49, 0
    v_mov_b32 v50, 0
    v_mov_b32 v51, 0
    v_mov_b32 v52, 0
    v_mov_b32 v53, 0
    v_mov_b32 v54, 0
    v_mov_b32 v55, 0
    v_mov_b32 v56, 0
    v_mov_b32 v57, 0
    v_mov_b32 v58, 0
    v_mov_b32 v59, 0
    v_mov_b32 v60, 0
    v_mov_b32 v61, 0
    v_mov_b32 v62, 0
    v_mov_b32 v63, 0
.pl_34:
    buffer_load_dwordx4 v[76:79], v13, s[8:11], s38 offen offset:0 sc1
    buffer_load_dwordx4 v[80:83], v13, s[8:11], s38 offen offset:1024 sc1
    buffer_load_dwordx4 v[84:87], v13, s[8:11], s39 offen offset:0 sc1
    buffer_load_dwordx4 v[88:91], v13, s[8:11], s39 offen offset:1024 sc1
    buffer_load_dwordx4 v[92:95], v13, s[8:11], s40 offen offset:0 sc1
    buffer_load_dwordx4 v[96:99], v13, s[8:11], s40 offen offset:1024 sc1
.pk_37:
    s_waitcnt vmcnt(5)
    v_mfma_f32_16x16x32_bf16 v[108:111], v[76:79], v[124:127], v[72:75]
    v_max_u32 v18, v77, v79
    s_waitcnt vmcnt(4)
    v_mfma_f32_16x16x32_bf16 v[108:111], v[80:83], v[128:131], v[108:111]
    v_max3_u32 v18, v18, v81, v83
    v_cmp_eq_u32 vcc, -1, v18
    s_cbranch_vccnz .pf_38
.pk_39:
    s_waitcnt vmcnt(3)
    v_mfma_f32_16x16x32_bf16 v[112:115], v[84:87], v[124:127], v[108:111]
    v_max_u32 v18, v85, v87
    s_waitcnt vmcnt(2)
    v_mfma_f32_16x16x32_bf16 v[112:115], v[88:91], v[128:131], v[112:115]
    v_max3_u32 v18, v18, v89, v91
    v_cmp_eq_u32 vcc, -1, v18
    s_cbranch_vccnz .pf_40
.pk_41:
    s_waitcnt vmcnt(1)
    v_mfma_f32_16x16x32_bf16 v[100:103], v[92:95], v[124:127], v[112:115]
    v_max_u32 v18, v93, v95
    s_waitcnt vmcnt(0)
    v_mfma_f32_16x16x32_bf16 v[100:103], v[96:99], v[128:131], v[100:103]
    v_max3_u32 v18, v18, v97, v99
    v_cmp_eq_u32 vcc, -1, v18
    s_cbranch_vccnz .pf_42
.pd_36:
    s_nop 4
    v_cvt_pk_bf16_f32 v105, v102, v103
    v_cvt_pk_bf16_f32 v104, v100, v101
    v_min_u32 v105, 0xfffffffe, v105
    buffer_store_dwordx2 v[104:105], v14, s[8:11], s31 offen
    s_mov_b32 s4, s30
    s_mov_b32 s30, s31
    s_mov_b32 s31, s32
    s_mov_b32 s32, s33
    s_mov_b32 s33, s4
    s_add_u32 s28, s28, 1
    s_mov_b32 s62, 0
    s_branch .step_32
.fin_33:
    s_barrier
    s_waitcnt vmcnt(0)
    s_endpgm
.pf_38:
    buffer_load_dwordx4 v[76:79], v13, s[8:11], s38 offen offset:0 sc1
    buffer_load_dwordx4 v[80:83], v13, s[8:11], s38 offen offset:1024 sc1
    s_add_u32 s62, s62, 1
    s_cmp_gt_u32 s62, 0x100000
    s_cbranch_scc1 .mg_end_1
.pk_43:
    s_waitcnt vmcnt(5)
    v_mfma_f32_16x16x32_bf16 v[108:111], v[84:87], v[124:127], v[72:75]
    v_max_u32 v18, v85, v87
    s_waitcnt vmcnt(4)
    v_mfma_f32_16x16x32_bf16 v[108:111], v[88:91], v[128:131], v[108:111]
    v_max3_u32 v18, v18, v89, v91
    v_cmp_eq_u32 vcc, -1, v18
    s_cbranch_vccnz .pf_44
.pk_45:
    s_waitcnt vmcnt(3)
    v_mfma_f32_16x16x32_bf16 v[112:115], v[92:95], v[124:127], v[108:111]
    v_max_u32 v18, v93, v95
    s_waitcnt vmcnt(2)
    v_mfma_f32_16x16x32_bf16 v[112:115], v[96:99], v[128:131], v[112:115]
    v_max3_u32 v18, v18, v97, v99
    v_cmp_eq_u32 vcc, -1, v18
    s_cbranch_vccnz .pf_46
.pk_47:
    s_waitcnt vmcnt(1)
    v_mfma_f32_16x16x32_bf16 v[100:103], v[76:79], v[124:127], v[112:115]
    v_max_u32 v18, v77, v79
    s_waitcnt vmcnt(0)
    v_mfma_f32_16x16x32_bf16 v[100:103], v[80:83], v[128:131], v[100:103]
    v_max3_u32 v18, v18, v81, v83
    v_cmp_eq_u32 vcc, -1, v18
    s_cbranch_vccnz .pf_48
    s_branch .pd_36
.pf_40:
    buffer_load_dwordx4 v[84:87], v13, s[8:11], s39 offen offset:0 sc1
    buffer_load_dwordx4 v[88:91], v13, s[8:11], s39 offen offset:1024 sc1
    s_add_u32 s62, s62, 1
    s_cmp_gt_u32 s62, 0x100000
    s_cbranch_scc1 .mg_end_1
.pk_49:
    s_waitcnt vmcnt(3)
    v_mfma_f32_16x16x32_bf16 v[112:115], v[92:95], v[124:127], v[108:111]
    v_max_u32 v18, v93, v95
    s_waitcnt vmcnt(2)
    v_mfma_f32_16x16x32_bf16 v[112:115], v[96:99], v[128:131], v[112:115]
    v_max3_u32 v18, v18, v97, v99
    v_cmp_eq_u32 vcc, -1, v18
    s_cbranch_vccnz .pf_50
.pk_51:
    s_waitcnt vmcnt(1)
    v_mfma_f32_16x16x32_bf16 v[100:103], v[84:87], v[124:127], v[112:115]
    v_max_u32 v18, v85, v87
    s_waitcnt vmcnt(0)
    v_mfma_f32_16x16x32_bf16 v[100:103], v[88:91], v[128:131], v[100:103]
    v_max3_u32 v18, v18, v89, v91
    v_cmp_eq_u32 vcc, -1, v18
    s_cbranch_vccnz .pf_52
    s_branch .pd_36
.pf_42:
    buffer_load_dwordx4 v[92:95], v13, s[8:11], s40 offen offset:0 sc1
    buffer_load_dwordx4 v[96:99], v13, s[8:11], s40 offen offset:1024 sc1
    s_add_u32 s62, s62, 1
    s_cmp_gt_u32 s62, 0x100000
    s_cbranch_scc1 .mg_end_1
    s_branch .pk_41
.pf_44:
    buffer_load_dwordx4 v[84:87], v13, s[8:11], s39 offen offset:0 sc1
    buffer_load_dwordx4 v[88:91], v13, s[8:11], s39 offen offset:1024 sc1
    s_add_u32 s62, s62, 1
    s_cmp_gt_u32 s62, 0x100000
    s_cbranch_scc1 .mg_end_1
.pk_53:
    s_waitcnt vmcnt(5)
    v_mfma_f32_16x16x32_bf16 v[108:111], v[92:95], v[124:127], v[72:75]
    v_max_u32 v18, v93, v95
    s_waitcnt vmcnt(4)
    v_mfma_f32_16x16x32_bf16 v[108:111], v[96:99], v[128:131], v[108:111]
    v_max3_u32 v18, v18, v97, v99
    v_cmp_eq_u32 vcc, -1, v18
    s_cbranch_vccnz .pf_54
.pk_55:
    s_waitcnt vmcnt(3)
    v_mfma_f32_16x16x32_bf16 v[112:115], v[76:79], v[124:127], v[108:111]
    v_max_u32 v18, v77, v79
    s_waitcnt vmcnt(2)
    v_mfma_f32_16x16x32_bf16 v[112:115], v[80:83], v[128:131], v[112:115]
    v_max3_u32 v18, v18, v81, v83
    v_cmp_eq_u32 vcc, -1, v18
    s_cbranch_vccnz .pf_56
    s_branch .pk_51
.pf_46:
    buffer_load_dwordx4 v[92:95], v13, s[8:11], s40 offen offset:0 sc1
    buffer_load_dwordx4 v[96:99], v13, s[8:11], s40 offen offset:1024 sc1
    s_add_u32 s62, s62, 1
    s_cmp_gt_u32 s62, 0x100000
    s_cbranch_scc1 .mg_end_1
.pk_57:
    s_waitcnt vmcnt(3)
    v_mfma_f32_16x16x32_bf16 v[112:115], v[76:79], v[124:127], v[108:111]
    v_max_u32 v18, v77, v79
    s_waitcnt vmcnt(2)
    v_mfma_f32_16x16x32_bf16 v[112:115], v[80:83], v[128:131], v[112:115]
    v_max3_u32 v18, v18, v81, v83
    v_cmp_eq_u32 vcc, -1, v18
    s_cbranch_vccnz .pf_58
    s_branch .pk_41
.pf_48:
    buffer_load_dwordx4 v[76:79], v13, s[8:11], s38 offen offset:0 sc1
    buffer_load_dwordx4 v[80:83], v13, s[8:11], s38 offen offset:1024 sc1
    s_add_u32 s62, s62, 1
    s_cmp_gt_u32 s62, 0x100000
    s_cbranch_scc1 .mg_end_1
    s_branch .pk_47
.pf_50:
    buffer_load_dwordx4 v[92:95], v13, s[8:11], s40 offen offset:0 sc1
    buffer_load_dwordx4 v[96:99], v13, s[8:11], s40 offen offset:1024 sc1
    s_add_u32 s62, s62, 1
    s_cmp_gt_u32 s62, 0x100000
    s_cbranch_scc1 .mg_end_1
    s_branch .pk_39
.pf_52:
    buffer_load_dwordx4 v[84:87], v13, s[8:11], s39 offen offset:0 sc1
    buffer_load_dwordx4 v[88:91], v13, s[8:11], s39 offen offset:1024 sc1
    s_add_u32 s62, s62, 1
    s_cmp_gt_u32 s62, 0x100000
    s_cbranch_scc1 .mg_end_1
    s_branch .pk_51
.pf_54:
    buffer_load_dwordx4 v[92:95], v13, s[8:11], s40 offen offset:0 sc1
    buffer_load_dwordx4 v[96:99], v13, s[8:11], s40 offen offset:1024 sc1
    s_add_u32 s62, s62, 1
    s_cmp_gt_u32 s62, 0x100000
    s_cbranch_scc1 .mg_end_1
    s_branch .pk_37
.pf_56:
    buffer_load_dwordx4 v[76:79], v13, s[8:11], s38 offen offset:0 sc1
    buffer_load_dwordx4 v[80:83], v13, s[8:11], s38 offen offset:1024 sc1
    s_add_u32 s62, s62, 1
    s_cmp_gt_u32 s62, 0x100000
    s_cbranch_scc1 .mg_end_1
.pk_59:
    s_waitcnt vmcnt(3)
    v_mfma_f32_16x16x32_bf16 v[112:115], v[84:87], v[124:127], v[108:111]
    v_max_u32 v18, v85, v87
    s_waitcnt vmcnt(2)
    v_mfma_f32_16x16x32_bf16 v[112:115], v[88:91], v[128:131], v[112:115]
    v_max3_u32 v18, v18, v89, v91
    v_cmp_eq_u32 vcc, -1, v18
    s_cbranch_vccnz .pf_60
    s_branch .pk_47
.pf_58:
    buffer_load_dwordx4 v[76:79], v13, s[8:11], s38 offen offset:0 sc1
    buffer_load_dwordx4 v[80:83], v13, s[8:11], s38 offen offset:1024 sc1
    s_add_u32 s62, s62, 1
    s_cmp_gt_u32 s62, 0x100000
    s_cbranch_scc1 .mg_end_1
    s_branch .pk_45
.pf_60:
    buffer_load_dwordx4 v[84:87], v13, s[8:11], s39 offen offset:0 sc1
    buffer_load_dwordx4 v[88:91], v13, s[8:11], s39 offen offset:1024 sc1
    s_add_u32 s62, s62, 1
    s_cmp_gt_u32 s62, 0x100000
    s_cbranch_scc1 .mg_end_1
    s_branch .pk_55
.pr_35:
    s_add_u32 s62, s62, 1
    s_cmp_gt_u32 s62, 0x100000
    s_cbranch_scc1 .mg_end_1
    s_branch .pl_34
.w2_22:
    v_bfe_u32 v254, v1, 4, 1
    v_mul_u32_u24 v168, 1024, v254
    v_bfe_u32 v254, v1, 5, 1
    v_mul_u32_u24 v254, 128, v254
    v_add_u32 v168, v168, v254
    v_bfe_u32 v254, v1, 3, 1
    v_mul_u32_u24 v254, 64, v254
    v_add_u32 v168, v168, v254
    v_bfe_u32 v254, v1, 0, 2
    v_mul_u32_u24 v254, 16, v254
    v_add_u32 v168, v168, v254
    v_bfe_u32 v254, v1, 2, 1
    v_mul_u32_u24 v254, 8, v254
    v_add_u32 v168, v168, v254
    v_add_u32 v168, 512, v168
    v_add_u32 v168, s101, v168
    s_lshl_b32 s4, s56, 9
    s_lshl_b32 s5, s53, 7
    s_add_u32 s4, s4, s5
    s_add_u32 s4, s4, 92274688
    v_mov_b32 v14, s4
    v_bfe_u32 v254, v1, 0, 6
    v_mul_u32_u24 v12, 16, v254
    v_add_u32 v12, 18176, v12
    v_bfe_u32 v254, v1, 0, 6
    v_mul_u32_u24 v15, 16, v254
    s_add_u32 s42, s42, 262144
    s_add_u32 s43, s43, 262144
    s_add_u32 s44, s44, 262144
    s_mov_b32 exec_hi, 0
    v_xor_b32 v244, 1024, v244
    s_mov_b32 exec_hi, -1
    buffer_load_dwordx4 v[24:27], v246, s[8:11], s32 offen sc1
    buffer_load_dwordx4 v[28:31], v245, s[8:11], s32 offen sc1
    buffer_load_dword v32, v237, s[8:11], s32 offen sc1
    s_waitcnt vmcnt(0)
    ds_read_b64_tr_b16 a[192:193], v242 offset:16384
    ds_read_b64_tr_b16 a[194:195], v242 offset:16896
    ds_read_b64_tr_b16 a[196:197], v242 offset:18432
    ds_read_b64_tr_b16 a[198:199], v242 offset:18944
    ds_read_b64_tr_b16 a[200:201], v242 offset:20480
    ds_read_b64_tr_b16 a[202:203], v242 offset:20992
    ds_read_b64_tr_b16 a[204:205], v242 offset:22528
    ds_read_b64_tr_b16 a[206:207], v242 offset:23040
    ds_read_b64_tr_b16 a[208:209], v242 offset:24576
    ds_read_b64_tr_b16 a[210:211], v242 offset:25088
    ds_read_b64_tr_b16 a[212:213], v242 offset:26624
    ds_read_b64_tr_b16 a[214:215], v242 offset:27136
    ds_read_b64_tr_b16 a[216:217], v242 offset:28672
    ds_read_b64_tr_b16 a[218:219], v242 offset:29184
    ds_read_b64_tr_b16 a[220:221], v242 offset:30720
    ds_read_b64_tr_b16 a[222:223], v242 offset:31232
    ds_read_b64_tr_b16 a[224:225], v243 offset:16384
    ds_read_b64_tr_b16 a[226:227], v243 offset:16896
    ds_read_b64_tr_b16 a[228:229], v243 offset:18432
    ds_read_b64_tr_b16 a[230:231], v243 offset:18944
    ds_read_b64_tr_b16 a[232:233], v243 offset:20480
    ds_read_b64_tr_b16 a[234:235], v243 offset:20992
    ds_read_b64_tr_b16 a[236:237], v243 offset:22528
    ds_read_b64_tr_b16 a[238:239], v243 offset:23040
    ds_read_b64_tr_b16 a[240:241], v243 offset:24576
    ds_read_b64_tr_b16 a[242:243], v243 offset:25088
    ds_read_b64_tr_b16 a[244:245], v243 offset:26624
    ds_read_b64_tr_b16 a[246:247], v243 offset:27136
    ds_read_b64_tr_b16 a[248:249], v243 offset:28672
    ds_read_b64_tr_b16 a[250:251], v243 offset:29184
    ds_read_b64_tr_b16 a[252:253], v243 offset:30720
    ds_read_b64_tr_b16 a[254:255], v243 offset:31232
    s_waitcnt lgkmcnt(0)
    s_barrier
.p2align 6
.step_61:
    s_barrier
    s_setprio 3
    buffer_load_dwordx4 v[24:27], v3, s[8:11], s30 offen offset:0 sc1
    s_setprio 2
    buffer_load_dwordx4 v[28:31], v3, s[8:11], s30 offen offset:1024 sc1
    s_setprio 1
    buffer_load_dwordx4 v[32:35], v3, s[8:11], s30 offen offset:2048 sc1
    s_setprio 0
    buffer_load_dwordx4 v[36:39], v3, s[8:11], s30 offen offset:3072 sc1
    s_call_b64 s[98:99], .gm_24
    v_pk_add_f32 v[40:41], v[40:41], v[42:43]
    v_pk_add_f32 v[42:43], v[44:45], v[46:47]
    ds_write2_b32 v5, v40, v41 offset0:0 offset1:36
    ds_write2_b32 v5, v42, v43 offset0:16 offset1:52
    s_nop 1
    v_pk_add_f32 v[48:49], v[48:49], v[50:51]
    v_pk_add_f32 v[50:51], v[52:53], v[54:55]
    ds_write2_b32 v6, v48, v49 offset0:0 offset1:36
    ds_write2_b32 v6, v50, v51 offset0:16 offset1:52
    s_waitcnt lgkmcnt(2)
    s_barrier
    s_waitcnt lgkmcnt(0)
    s_barrier
    v_smfmac_f32_16x16x64_bf16 v[56:59], v[24:27], a[128:135], v2
    v_smfmac_f32_16x16x64_bf16 v[60:63], v[24:27], a[160:167], v2
    v_smfmac_f32_16x16x64_bf16 v[56:59], v[28:31], a[136:143], v2
    v_smfmac_f32_16x16x64_bf16 v[60:63], v[28:31], a[168:175], v2
    v_smfmac_f32_16x16x64_bf16 v[56:59], v[32:35], a[144:151], v2
    v_smfmac_f32_16x16x64_bf16 v[60:63], v[32:35], a[176:183], v2
    v_smfmac_f32_16x16x64_bf16 v[56:59], v[36:39], a[152:159], v2
    v_smfmac_f32_16x16x64_bf16 v[60:63], v[36:39], a[184:191], v2
    ds_read_b64 v[72:73], v9 offset:0
    ds_read_b64 v[74:75], v9 offset:1152
    ds_read_b64 v[76:77], v9 offset:2304
    ds_read_b64 v[78:79], v9 offset:3456
    s_waitcnt lgkmcnt(0)
    v_pk_add_f32 v[72:73], v[72:73], v[74:75]
    v_pk_add_f32 v[76:77], v[76:77], v[78:79]
    v_pk_add_f32 v[72:73], v[72:73], v[76:77]
    v_cvt_pk_bf16_f32 v72, v72, v73
    ds_write_b32 v11, v72
    v_mov_b32 v40, 0
    v_mov_b32 v41, 0
    v_mov_b32 v42, 0
    v_mov_b32 v43, 0
    v_mov_b32 v44, 0
    v_mov_b32 v45, 0
    v_mov_b32 v46, 0
    v_mov_b32 v47, 0
    v_pk_add_f32 v[56:57], v[56:57], v[58:59]
    v_pk_add_f32 v[58:59], v[60:61], v[62:63]
    v_cvt_pk_bf16_f32 v60, v56, v57
    v_cvt_pk_bf16_f32 v61, v58, v59
    ds_write2_b32 v255, v60, v61 offset0:0 offset1:32
    ds_write_b128 v8, v[56:59]
    s_waitcnt lgkmcnt(0)
    s_barrier
    s_cmp_eq_u32 s28, 63
    s_cbranch_scc1 .fin_62
    s_add_u32 s37, s28, 0
    s_bitcmp1_b32 s37, 0
    s_cselect_b32 s4, 0x84000, 0
    s_xor_b32 s34, s35, s4
    s_bitcmp1_b32 s37, 1
    s_cselect_b32 s4, 0x101000, 0
    s_xor_b32 s34, s34, s4
    s_lshr_b32 s37, s37, 2
    s_bitcmp1_b32 s63, s37
    s_cselect_b32 s4, 0x2000, 0
    s_xor_b32 s34, s34, s4
    s_lshl_b32 s37, s37, 21
    s_add_u32 s34, s34, s37
    s_waitcnt lgkmcnt(0)
    v_mov_b32 v48, 0
    v_mov_b32 v49, 0
    v_mov_b32 v50, 0
    v_mov_b32 v51, 0
    v_mov_b32 v52, 0
    v_mov_b32 v53, 0
    v_mov_b32 v54, 0
    v_mov_b32 v55, 0
    v_mov_b32 v56, 0
    v_mov_b32 v57, 0
    v_mov_b32 v58, 0
    v_mov_b32 v59, 0
    v_mov_b32 v60, 0
    v_mov_b32 v61, 0
    v_mov_b32 v62, 0
    v_mov_b32 v63, 0
    s_barrier
    ds_read_b128 v[72:75], v12
    s_setprio 3
    buffer_load_dwordx4 v[24:27], v4, s[8:11], s30 offen offset:0 sc1
    s_setprio 2
    buffer_load_dwordx4 v[28:31], v4, s[8:11], s30 offen offset:1024 sc1
    s_setprio 1
    buffer_load_dwordx4 v[32:35], v4, s[8:11], s30 offen offset:2048 sc1
    s_setprio 0
    buffer_load_dwordx4 v[36:39], v4, s[8:11], s30 offen offset:3072 sc1
    s_call_b64 s[98:99], .gm_25
    s_waitcnt lgkmcnt(0)
    buffer_store_dwordx4 v[72:75], v244, s[8:11], s41 offen sc1
    s_nop 3
    v_pk_add_f32 v[64:65], v[64:65], v[66:67]
    v_cvt_pk_bf16_f32 v66, v64, v65
    v_pk_add_f32 v[68:69], v[68:69], v[70:71]
    v_cvt_pk_bf16_f32 v67, v68, v69
    v_min_u32 v67, 0xfffffffe, v67
    buffer_store_dwordx2 v[66:67], v168, s[8:11], s34 offen sc1
    ds_write2_b32 v7, v64, v65 offset0:0 offset1:36
    ds_write2_b32 v7, v68, v69 offset0:16 offset1:52
    s_waitcnt lgkmcnt(0)
    s_barrier
    s_cmp_lt_u32 s28, 52
    s_cselect_b32 s4, 1, 0
    s_andn2_b32 s4, s4, s28
    s_cbranch_scc1 .nl_63
    v_mov_b32 v18, s28
    v_add_u32 v18, 1, v18
    s_mov_b64 exec, 1
    s_waitcnt vmcnt(0)
    buffer_store_dword v18, v14, s[8:11], 0 offen sc1
    s_mov_b64 exec, -1
.nl_63:
    v_mov_b32 v64, 0
    v_mov_b32 v65, 0
    v_mov_b32 v66, 0
    v_mov_b32 v67, 0
    v_mov_b32 v68, 0
    v_mov_b32 v69, 0
    v_mov_b32 v70, 0
    v_mov_b32 v71, 0
    s_mov_b32 s4, s30
    s_mov_b32 s30, s31
    s_mov_b32 s31, s32
    s_mov_b32 s32, s33
    s_mov_b32 s33, s4
    s_add_u32 s28, s28, 1
    s_mov_b32 s62, 0
    s_add_u32 s41, s41, 0x20000
    s_branch .step_61
.fin_62:
    s_barrier
    s_endpgm
.w3_23:
    v_bfe_u32 v254, v1, 4, 1
    v_mul_u32_u24 v168, 1024, v254
    v_bfe_u32 v254, v1, 5, 1
    v_mul_u32_u24 v254, 128, v254
    v_add_u32 v168, v168, v254
    v_bfe_u32 v254, v1, 3, 1
    v_mul_u32_u24 v254, 64, v254
    v_add_u32 v168, v168, v254
    v_bfe_u32 v254, v1, 0, 2
    v_mul_u32_u24 v254, 16, v254
    v_add_u32 v168, v168, v254
    v_bfe_u32 v254, v1, 2, 1
    v_mul_u32_u24 v254, 8, v254
    v_add_u32 v168, v168, v254
    v_add_u32 v168, 768, v168
    v_add_u32 v168, s101, v168
    v_bfe_u32 v254, v1, 3, 1
    v_mul_u32_u24 v12, 8, v254
    v_bfe_u32 v254, v1, 5, 1
    v_mul_u32_u24 v254, 256, v254
    v_add_u32 v12, v12, v254
    v_bfe_u32 v254, v1, 2, 1
    v_mul_u32_u24 v254, 128, v254
    v_add_u32 v12, v12, v254
    v_bfe_u32 v254, v1, 0, 2
    v_mul_u32_u24 v254, 16, v254
    v_add_u32 v12, v12, v254
    v_bfe_u32 v254, v1, 4, 1
    v_mul_u32_u24 v254, 512, v254
    v_add_u32 v12, v12, v254
    v_add_u32 v12, 14080, v12
    v_bfe_u32 v254, v1, 2, 2
    v_mul_u32_u24 v14, 128, v254
    v_bfe_u32 v254, v1, 0, 2
    v_mul_u32_u24 v254, 16, v254
    v_add_u32 v14, v14, v254
    v_bfe_u32 v254, v1, 4, 2
    v_mul_u32_u24 v254, 4, v254
    v_add_u32 v14, v14, v254
    v_add_u32 v14, 18688, v14
    v_bfe_u32 v254, v1, 0, 6
    v_mul_u32_u24 v15, 16, v254
    v_add_u32 v15, s101, v15
    v_bfe_u32 v254, v1, 2, 2
    v_mul_u32_u24 v16, 128, v254
    v_bfe_u32 v254, v1, 0, 2
    v_mul_u32_u24 v254, 16, v254
    v_add_u32 v16, v16, v254
    v_bfe_u32 v254, v1, 4, 2
    v_mul_u32_u24 v254, 4, v254
    v_add_u32 v16, v16, v254
    v_add_u32 v16, 135168, v16
    v_add_u32 v16, s58, v16
    s_lshl_b32 s4, s56, 9
    s_add_u32 s4, s4, 92291072
    v_bfe_u32 v254, v1, 0, 2
    v_mul_u32_u24 v13, 128, v254
    v_bfe_u32 v254, v1, 2, 1
    v_mul_u32_u24 v254, 16384, v254
    v_add_u32 v13, v13, v254
    v_add_u32 v13, s4, v13
    s_lshl_b32 s4, s56, 9
    s_lshl_b32 s5, s53, 7
    s_add_u32 s4, s4, s5
    s_add_u32 s4, s4, 92274688
    v_mov_b32 v174, s4
    v_bfe_u32 v254, v1, 0, 6
    v_mul_u32_u24 v175, 16, v254
    v_add_u32 v175, 18176, v175
    s_mov_b32 exec_hi, 0
    v_xor_b32 v244, 1024, v244
    s_mov_b32 exec_hi, -1
    buffer_load_dwordx4 v[24:27], v246, s[8:11], s33 offen sc1
    buffer_load_dwordx4 v[28:31], v245, s[8:11], s33 offen sc1
    buffer_load_dword v32, v237, s[8:11], s33 offen sc1
    s_waitcnt vmcnt(0)
    ds_read_b64_tr_b16 a[192:193], v242 offset:16384
    ds_read_b64_tr_b16 a[194:195], v242 offset:16896
    ds_read_b64_tr_b16 a[196:197], v242 offset:18432
    ds_read_b64_tr_b16 a[198:199], v242 offset:18944
    ds_read_b64_tr_b16 a[200:201], v242 offset:20480
    ds_read_b64_tr_b16 a[202:203], v242 offset:20992
    ds_read_b64_tr_b16 a[204:205], v242 offset:22528
    ds_read_b64_tr_b16 a[206:207], v242 offset:23040
    ds_read_b64_tr_b16 a[208:209], v242 offset:24576
    ds_read_b64_tr_b16 a[210:211], v242 offset:25088
    ds_read_b64_tr_b16 a[212:213], v242 offset:26624
    ds_read_b64_tr_b16 a[214:215], v242 offset:27136
    ds_read_b64_tr_b16 a[216:217], v242 offset:28672
    ds_read_b64_tr_b16 a[218:219], v242 offset:29184
    ds_read_b64_tr_b16 a[220:221], v242 offset:30720
    ds_read_b64_tr_b16 a[222:223], v242 offset:31232
    ds_read_b64_tr_b16 a[224:225], v243 offset:16384
    ds_read_b64_tr_b16 a[226:227], v243 offset:16896
    ds_read_b64_tr_b16 a[228:229], v243 offset:18432
    ds_read_b64_tr_b16 a[230:231], v243 offset:18944
    ds_read_b64_tr_b16 a[232:233], v243 offset:20480
    ds_read_b64_tr_b16 a[234:235], v243 offset:20992
    ds_read_b64_tr_b16 a[236:237], v243 offset:22528
    ds_read_b64_tr_b16 a[238:239], v243 offset:23040
    ds_read_b64_tr_b16 a[240:241], v243 offset:24576
    ds_read_b64_tr_b16 a[242:243], v243 offset:25088
    ds_read_b64_tr_b16 a[244:245], v243 offset:26624
    ds_read_b64_tr_b16 a[246:247], v243 offset:27136
    ds_read_b64_tr_b16 a[248:249], v243 offset:28672
    ds_read_b64_tr_b16 a[250:251], v243 offset:29184
    ds_read_b64_tr_b16 a[252:253], v243 offset:30720
    ds_read_b64_tr_b16 a[254:255], v243 offset:31232
    s_waitcnt lgkmcnt(0)
    s_cmp_ge_u32 s46, 1
    s_cbranch_scc1 .kvd_65
    s_mov_b32 s62, 0
.kv_64:
    buffer_load_dword v18, v13, s[8:11], 0 offen sc1
    s_add_u32 s62, s62, 1
    s_cmp_gt_u32 s62, 0x100000
    s_cbranch_scc1 .mg_end_1
    s_waitcnt vmcnt(0)
    v_min_u32_dpp v18, v18, v18 quad_perm:[1,0,3,2] row_mask:0xf bank_mask:0xf
    s_nop 1
    v_min_u32_dpp v18, v18, v18 quad_perm:[2,3,0,1] row_mask:0xf bank_mask:0xf
    s_nop 1
    v_min_u32_dpp v18, v18, v18 row_half_mirror row_mask:0xf bank_mask:0xf
    s_nop 0
    v_readfirstlane_b32 s46, v18
    s_cmp_lt_u32 s46, 1
    s_cbranch_scc1 .kv_64
.kvd_65:
    s_barrier
.p2align 6
.step_66:
    s_barrier
    s_setprio 3
    buffer_load_dwordx4 v[24:27], v3, s[8:11], s30 offen offset:0 sc1
    s_setprio 2
    buffer_load_dwordx4 v[28:31], v3, s[8:11], s30 offen offset:1024 sc1
    s_setprio 1
    buffer_load_dwordx4 v[32:35], v3, s[8:11], s30 offen offset:2048 sc1
    s_setprio 0
    buffer_load_dwordx4 v[36:39], v3, s[8:11], s30 offen offset:3072 sc1
    s_call_b64 s[98:99], .gm_24
    v_pk_add_f32 v[40:41], v[40:41], v[42:43]
    v_pk_add_f32 v[42:43], v[44:45], v[46:47]
    ds_write2_b32 v5, v40, v41 offset0:0 offset1:36
    ds_write2_b32 v5, v42, v43 offset0:16 offset1:52
    s_nop 1
    v_pk_add_f32 v[48:49], v[48:49], v[50:51]
    v_pk_add_f32 v[50:51], v[52:53], v[54:55]
    ds_write2_b32 v6, v48, v49 offset0:0 offset1:36
    ds_write2_b32 v6, v50, v51 offset0:16 offset1:52
    s_waitcnt lgkmcnt(2)
    s_barrier
    s_waitcnt lgkmcnt(0)
    s_barrier
    v_smfmac_f32_16x16x64_bf16 v[56:59], v[24:27], a[128:135], v2
    v_smfmac_f32_16x16x64_bf16 v[60:63], v[24:27], a[160:167], v2
    v_smfmac_f32_16x16x64_bf16 v[56:59], v[28:31], a[136:143], v2
    v_smfmac_f32_16x16x64_bf16 v[60:63], v[28:31], a[168:175], v2
    v_smfmac_f32_16x16x64_bf16 v[56:59], v[32:35], a[144:151], v2
    v_smfmac_f32_16x16x64_bf16 v[60:63], v[32:35], a[176:183], v2
    v_smfmac_f32_16x16x64_bf16 v[56:59], v[36:39], a[152:159], v2
    v_smfmac_f32_16x16x64_bf16 v[60:63], v[36:39], a[184:191], v2
    ds_read_b64 v[72:73], v9 offset:0
    ds_read_b64 v[74:75], v9 offset:1152
    ds_read_b64 v[76:77], v9 offset:2304
    ds_read_b64 v[78:79], v9 offset:3456
    s_waitcnt lgkmcnt(0)
    v_pk_add_f32 v[72:73], v[72:73], v[74:75]
    v_pk_add_f32 v[76:77], v[76:77], v[78:79]
    v_pk_add_f32 v[72:73], v[72:73], v[76:77]
    v_cvt_pk_bf16_f32 v72, v72, v73
    ds_write_b32 v11, v72
    v_mov_b32 v40, 0
    v_mov_b32 v41, 0
    v_mov_b32 v42, 0
    v_mov_b32 v43, 0
    v_mov_b32 v44, 0
    v_mov_b32 v45, 0
    v_mov_b32 v46, 0
    v_mov_b32 v47, 0
    v_pk_add_f32 v[56:57], v[56:57], v[58:59]
    v_pk_add_f32 v[58:59], v[60:61], v[62:63]
    v_cvt_pk_bf16_f32 v60, v56, v57
    v_cvt_pk_bf16_f32 v61, v58, v59
    ds_write2_b32 v255, v60, v61 offset0:0 offset1:32
    ds_write_b128 v8, v[56:59]
    s_waitcnt lgkmcnt(0)
    s_barrier
    ds_read_b64 v[72:73], v12 offset:0
    ds_read_b64 v[74:75], v12 offset:1024
    ds_read_b64 v[76:77], v12 offset:2048
    ds_read_b64 v[78:79], v12 offset:3072
    ds_read_b64 v[80:81], v12 offset:64
    ds_read_b64 v[82:83], v12 offset:1088
    ds_read_b64 v[84:85], v12 offset:2112
    ds_read_b64 v[86:87], v12 offset:3136
    s_waitcnt lgkmcnt(4)
    v_add_f32 v72, v72, v74
    v_add_f32 v73, v73, v75
    v_add_f32 v76, v76, v78
    v_add_f32 v77, v77, v79
    v_add_f32 v72, v72, v76
    v_add_f32 v73, v73, v77
    v_cvt_pk_bf16_f32 v72, v72, v73
    s_waitcnt lgkmcnt(0)
    v_add_f32 v80, v80, v82
    v_add_f32 v81, v81, v83
    v_add_f32 v84, v84, v86
    v_add_f32 v85, v85, v87
    v_add_f32 v80, v80, v84
    v_add_f32 v81, v81, v85
    v_cvt_pk_bf16_f32 v80, v80, v81
    ds_write_b32 v14, v72
    ds_write_b32 v14, v80 offset:64
    s_waitcnt lgkmcnt(0)
    s_cmp_ge_u32 s28, 62
    s_cbranch_scc1 .ke_68
.kb_69:
    s_cmp_eq_u32 s28, 63
    s_cbranch_scc1 .fin_67
    s_add_u32 s37, s28, 0
    s_bitcmp1_b32 s37, 0
    s_cselect_b32 s4, 0x84000, 0
    s_xor_b32 s34, s35, s4
    s_bitcmp1_b32 s37, 1
    s_cselect_b32 s4, 0x101000, 0
    s_xor_b32 s34, s34, s4
    s_lshr_b32 s37, s37, 2
    s_bitcmp1_b32 s63, s37
    s_cselect_b32 s4, 0x2000, 0
    s_xor_b32 s34, s34, s4
    s_lshl_b32 s37, s37, 21
    s_add_u32 s34, s34, s37
    buffer_store_dwordx4 v[20:23], v246, s[8:11], s32 offen
    buffer_store_dwordx4 v[20:23], v245, s[8:11], s32 offen
    buffer_store_dword v20, v237, s[8:11], s32 offen
    s_add_u32 s5, s28, 2
    s_cmp_ge_u32 s46, s5
    s_cbranch_scc1 .kvd_73
    s_mov_b32 s62, 0
.kv_72:
    buffer_load_dword v18, v13, s[8:11], 0 offen sc1
    s_add_u32 s62, s62, 1
    s_cmp_gt_u32 s62, 0x100000
    s_cbranch_scc1 .mg_end_1
    s_waitcnt vmcnt(0)
    v_min_u32_dpp v18, v18, v18 quad_perm:[1,0,3,2] row_mask:0xf bank_mask:0xf
    s_nop 1
    v_min_u32_dpp v18, v18, v18 quad_perm:[2,3,0,1] row_mask:0xf bank_mask:0xf
    s_nop 1
    v_min_u32_dpp v18, v18, v18 row_half_mirror row_mask:0xf bank_mask:0xf
    s_nop 0
    v_readfirstlane_b32 s46, v18
    s_cmp_lt_u32 s46, s5
    s_cbranch_scc1 .kv_72
.kvd_73:
    v_mov_b32 v48, 0
    v_mov_b32 v49, 0
    v_mov_b32 v50, 0
    v_mov_b32 v51, 0
    v_mov_b32 v52, 0
    v_mov_b32 v53, 0
    v_mov_b32 v54, 0
    v_mov_b32 v55, 0
    v_mov_b32 v56, 0
    v_mov_b32 v57, 0
    v_mov_b32 v58, 0
    v_mov_b32 v59, 0
    v_mov_b32 v60, 0
    v_mov_b32 v61, 0
    v_mov_b32 v62, 0
    v_mov_b32 v63, 0
    s_cmp_ge_u32 s28, 62
    s_cbranch_scc1 .kf_70
.kg_71:
    s_barrier
    s_setprio 3
    buffer_load_dwordx4 v[24:27], v4, s[8:11], s30 offen offset:0 sc1
    s_setprio 2
    buffer_load_dwordx4 v[28:31], v4, s[8:11], s30 offen offset:1024 sc1
    s_setprio 1
    buffer_load_dwordx4 v[32:35], v4, s[8:11], s30 offen offset:2048 sc1
    s_setprio 0
    buffer_load_dwordx4 v[36:39], v4, s[8:11], s30 offen offset:3072 sc1
    s_call_b64 s[98:99], .gm_25
    s_nop 4
    v_pk_add_f32 v[64:65], v[64:65], v[66:67]
    v_cvt_pk_bf16_f32 v66, v64, v65
    v_pk_add_f32 v[68:69], v[68:69], v[70:71]
    v_cvt_pk_bf16_f32 v67, v68, v69
    v_min_u32 v67, 0xfffffffe, v67
    buffer_store_dwordx2 v[66:67], v168, s[8:11], s34 offen sc1
    ds_write2_b32 v7, v64, v65 offset0:0 offset1:36
    ds_write2_b32 v7, v68, v69 offset0:16 offset1:52
    s_waitcnt lgkmcnt(0)
    s_barrier
    s_add_u32 s5, s28, 3
    s_min_u32 s5, s5, 64
    s_cmp_ge_u32 s46, s5
    s_cbranch_scc1 .kvd_75
    s_mov_b32 s62, 0
.kv_74:
    buffer_load_dword v18, v13, s[8:11], 0 offen sc1
    s_add_u32 s62, s62, 1
    s_cmp_gt_u32 s62, 0x100000
    s_cbranch_scc1 .mg_end_1
    s_waitcnt vmcnt(0)
    v_min_u32_dpp v18, v18, v18 quad_perm:[1,0,3,2] row_mask:0xf bank_mask:0xf
    s_nop 1
    v_min_u32_dpp v18, v18, v18 quad_perm:[2,3,0,1] row_mask:0xf bank_mask:0xf
    s_nop 1
    v_min_u32_dpp v18, v18, v18 row_half_mirror row_mask:0xf bank_mask:0xf
    s_nop 0
    v_readfirstlane_b32 s46, v18
.kvd_75:
    v_mov_b32 v64, 0
    v_mov_b32 v65, 0
    v_mov_b32 v66, 0
    v_mov_b32 v67, 0
    v_mov_b32 v68, 0
    v_mov_b32 v69, 0
    v_mov_b32 v70, 0
    v_mov_b32 v71, 0
    s_mov_b32 s4, s30
    s_mov_b32 s30, s31
    s_mov_b32 s31, s32
    s_mov_b32 s32, s33
    s_mov_b32 s33, s4
    s_add_u32 s28, s28, 1
    s_mov_b32 s62, 0
    s_add_u32 s41, s41, 0x20000
    s_branch .step_66
.fin_67:
    s_barrier
    s_add_u32 s4, s28, 1
    v_mov_b32 v18, s4
    s_mov_b64 exec, 1
    s_waitcnt vmcnt(0)
    buffer_store_dword v18, v174, s[8:11], 0 offen sc1
    s_mov_b64 exec, -1
    s_endpgm
.ke_68:
    ds_read_b128 v[72:75], v175
    s_waitcnt lgkmcnt(0)
    buffer_store_dwordx4 v[72:75], v244, s[8:11], s41 offen sc1
    s_branch .kb_69
.kf_70:
    s_add_u32 s4, s28, 1
    v_mov_b32 v18, s4
    s_mov_b64 exec, 1
    s_waitcnt vmcnt(0)
    buffer_store_dword v18, v174, s[8:11], 0 offen sc1
    s_mov_b64 exec, -1
    s_branch .kg_71
.p2align 6
.gm_24:
    s_waitcnt vmcnt(3)
    v_max_u32 v18, v25, v27
    v_cmp_eq_u32 vcc, -1, v18
    s_cbranch_vccnz .nk_76
.ok_77:
    v_smfmac_f32_16x16x64_bf16 v[40:43], v[24:27], a[0:7], v2
    v_smfmac_f32_16x16x64_bf16 v[44:47], v[24:27], a[32:39], v2
    s_waitcnt vmcnt(2)
    v_max_u32 v18, v29, v31
    v_cmp_eq_u32 vcc, -1, v18
    v_smfmac_f32_16x16x64_bf16 v[48:51], v[24:27], a[64:71], v2
    v_smfmac_f32_16x16x64_bf16 v[52:55], v[24:27], a[96:103], v2
    s_cbranch_vccnz .nk_78
.ok_79:
    v_smfmac_f32_16x16x64_bf16 v[40:43], v[28:31], a[8:15], v2
    v_smfmac_f32_16x16x64_bf16 v[44:47], v[28:31], a[40:47], v2
    s_waitcnt vmcnt(1)
    v_max_u32 v18, v33, v35
    v_cmp_eq_u32 vcc, -1, v18
    v_smfmac_f32_16x16x64_bf16 v[48:51], v[28:31], a[72:79], v2
    v_smfmac_f32_16x16x64_bf16 v[52:55], v[28:31], a[104:111], v2
    s_cbranch_vccnz .nk_80
.ok_81:
    v_smfmac_f32_16x16x64_bf16 v[40:43], v[32:35], a[16:23], v2
    v_smfmac_f32_16x16x64_bf16 v[44:47], v[32:35], a[48:55], v2
    s_waitcnt vmcnt(0)
    v_max_u32 v18, v37, v39
    v_cmp_eq_u32 vcc, -1, v18
    v_smfmac_f32_16x16x64_bf16 v[48:51], v[32:35], a[80:87], v2
    v_smfmac_f32_16x16x64_bf16 v[52:55], v[32:35], a[112:119], v2
    s_cbranch_vccnz .nk_82
.ok_83:
    v_smfmac_f32_16x16x64_bf16 v[40:43], v[36:39], a[24:31], v2
    v_smfmac_f32_16x16x64_bf16 v[44:47], v[36:39], a[56:63], v2
    v_smfmac_f32_16x16x64_bf16 v[48:51], v[36:39], a[88:95], v2
    v_smfmac_f32_16x16x64_bf16 v[52:55], v[36:39], a[120:127], v2
    s_setpc_b64 s[98:99]
.nk_76:
    buffer_load_dwordx4 v[24:27], v3, s[8:11], s30 offen offset:0 sc1
    s_add_u32 s62, s62, 1
    s_cmp_gt_u32 s62, 0x100000
    s_cbranch_scc1 .mg_end_1
    s_waitcnt vmcnt(3)
    v_max_u32 v18, v29, v31
    v_cmp_eq_u32 vcc, -1, v18
    s_cbranch_vccnz .nk_84
.ok_85:
    v_smfmac_f32_16x16x64_bf16 v[40:43], v[28:31], a[8:15], v2
    v_smfmac_f32_16x16x64_bf16 v[44:47], v[28:31], a[40:47], v2
    s_waitcnt vmcnt(2)
    v_max_u32 v18, v33, v35
    v_cmp_eq_u32 vcc, -1, v18
    v_smfmac_f32_16x16x64_bf16 v[48:51], v[28:31], a[72:79], v2
    v_smfmac_f32_16x16x64_bf16 v[52:55], v[28:31], a[104:111], v2
    s_cbranch_vccnz .nk_86
.ok_87:
    v_smfmac_f32_16x16x64_bf16 v[40:43], v[32:35], a[16:23], v2
    v_smfmac_f32_16x16x64_bf16 v[44:47], v[32:35], a[48:55], v2
    s_waitcnt vmcnt(1)
    v_max_u32 v18, v37, v39
    v_cmp_eq_u32 vcc, -1, v18
    v_smfmac_f32_16x16x64_bf16 v[48:51], v[32:35], a[80:87], v2
    v_smfmac_f32_16x16x64_bf16 v[52:55], v[32:35], a[112:119], v2
    s_cbranch_vccnz .nk_88
.ok_89:
    v_smfmac_f32_16x16x64_bf16 v[40:43], v[36:39], a[24:31], v2
    v_smfmac_f32_16x16x64_bf16 v[44:47], v[36:39], a[56:63], v2
    s_waitcnt vmcnt(0)
    v_max_u32 v18, v25, v27
    v_cmp_eq_u32 vcc, -1, v18
    v_smfmac_f32_16x16x64_bf16 v[48:51], v[36:39], a[88:95], v2
    v_smfmac_f32_16x16x64_bf16 v[52:55], v[36:39], a[120:127], v2
    s_cbranch_vccnz .nk_90
.ok_91:
    v_smfmac_f32_16x16x64_bf16 v[40:43], v[24:27], a[0:7], v2
    v_smfmac_f32_16x16x64_bf16 v[44:47], v[24:27], a[32:39], v2
    v_smfmac_f32_16x16x64_bf16 v[48:51], v[24:27], a[64:71], v2
    v_smfmac_f32_16x16x64_bf16 v[52:55], v[24:27], a[96:103], v2
    s_setpc_b64 s[98:99]
.nk_78:
    buffer_load_dwordx4 v[28:31], v3, s[8:11], s30 offen offset:1024 sc1
    s_add_u32 s62, s62, 1
    s_cmp_gt_u32 s62, 0x100000
    s_cbranch_scc1 .mg_end_1
    s_waitcnt vmcnt(2)
    v_max_u32 v18, v33, v35
    v_cmp_eq_u32 vcc, -1, v18
    s_cbranch_vccnz .nk_92
.ok_93:
    v_smfmac_f32_16x16x64_bf16 v[40:43], v[32:35], a[16:23], v2
    v_smfmac_f32_16x16x64_bf16 v[44:47], v[32:35], a[48:55], v2
    s_waitcnt vmcnt(1)
    v_max_u32 v18, v37, v39
    v_cmp_eq_u32 vcc, -1, v18
    v_smfmac_f32_16x16x64_bf16 v[48:51], v[32:35], a[80:87], v2
    v_smfmac_f32_16x16x64_bf16 v[52:55], v[32:35], a[112:119], v2
    s_cbranch_vccnz .nk_94
.ok_95:
    v_smfmac_f32_16x16x64_bf16 v[40:43], v[36:39], a[24:31], v2
    v_smfmac_f32_16x16x64_bf16 v[44:47], v[36:39], a[56:63], v2
    s_waitcnt vmcnt(0)
    v_max_u32 v18, v29, v31
    v_cmp_eq_u32 vcc, -1, v18
    v_smfmac_f32_16x16x64_bf16 v[48:51], v[36:39], a[88:95], v2
    v_smfmac_f32_16x16x64_bf16 v[52:55], v[36:39], a[120:127], v2
    s_cbranch_vccnz .nk_96
.ok_97:
    v_smfmac_f32_16x16x64_bf16 v[40:43], v[28:31], a[8:15], v2
    v_smfmac_f32_16x16x64_bf16 v[44:47], v[28:31], a[40:47], v2
    v_smfmac_f32_16x16x64_bf16 v[48:51], v[28:31], a[72:79], v2
    v_smfmac_f32_16x16x64_bf16 v[52:55], v[28:31], a[104:111], v2
    s_setpc_b64 s[98:99]
.nk_80:
    buffer_load_dwordx4 v[32:35], v3, s[8:11], s30 offen offset:2048 sc1
    s_add_u32 s62, s62, 1
    s_cmp_gt_u32 s62, 0x100000
    s_cbranch_scc1 .mg_end_1
    s_waitcnt vmcnt(1)
    v_max_u32 v18, v37, v39
    v_cmp_eq_u32 vcc, -1, v18
    s_cbranch_vccnz .nk_98
.ok_99:
    v_smfmac_f32_16x16x64_bf16 v[40:43], v[36:39], a[24:31], v2
    v_smfmac_f32_16x16x64_bf16 v[44:47], v[36:39], a[56:63], v2
    s_waitcnt vmcnt(0)
    v_max_u32 v18, v33, v35
    v_cmp_eq_u32 vcc, -1, v18
    v_smfmac_f32_16x16x64_bf16 v[48:51], v[36:39], a[88:95], v2
    v_smfmac_f32_16x16x64_bf16 v[52:55], v[36:39], a[120:127], v2
    s_cbranch_vccnz .nk_100
.ok_101:
    v_smfmac_f32_16x16x64_bf16 v[40:43], v[32:35], a[16:23], v2
    v_smfmac_f32_16x16x64_bf16 v[44:47], v[32:35], a[48:55], v2
    v_smfmac_f32_16x16x64_bf16 v[48:51], v[32:35], a[80:87], v2
    v_smfmac_f32_16x16x64_bf16 v[52:55], v[32:35], a[112:119], v2
    s_setpc_b64 s[98:99]
.nk_82:
    buffer_load_dwordx4 v[36:39], v3, s[8:11], s30 offen offset:3072 sc1
    s_add_u32 s62, s62, 1
    s_cmp_gt_u32 s62, 0x100000
    s_cbranch_scc1 .mg_end_1
    s_waitcnt vmcnt(0)
    v_max_u32 v18, v37, v39
    v_cmp_eq_u32 vcc, -1, v18
    s_cbranch_vccnz .nk_82
    s_branch .ok_83
.nk_84:
    buffer_load_dwordx4 v[28:31], v3, s[8:11], s30 offen offset:1024 sc1
    s_add_u32 s62, s62, 1
    s_cmp_gt_u32 s62, 0x100000
    s_cbranch_scc1 .mg_end_1
    s_waitcnt vmcnt(3)
    v_max_u32 v18, v33, v35
    v_cmp_eq_u32 vcc, -1, v18
    s_cbranch_vccnz .nk_102
.ok_103:
    v_smfmac_f32_16x16x64_bf16 v[40:43], v[32:35], a[16:23], v2
    v_smfmac_f32_16x16x64_bf16 v[44:47], v[32:35], a[48:55], v2
    s_waitcnt vmcnt(2)
    v_max_u32 v18, v37, v39
    v_cmp_eq_u32 vcc, -1, v18
    v_smfmac_f32_16x16x64_bf16 v[48:51], v[32:35], a[80:87], v2
    v_smfmac_f32_16x16x64_bf16 v[52:55], v[32:35], a[112:119], v2
    s_cbranch_vccnz .nk_104
.ok_105:
    v_smfmac_f32_16x16x64_bf16 v[40:43], v[36:39], a[24:31], v2
    v_smfmac_f32_16x16x64_bf16 v[44:47], v[36:39], a[56:63], v2
    s_waitcnt vmcnt(1)
    v_max_u32 v18, v25, v27
    v_cmp_eq_u32 vcc, -1, v18
    v_smfmac_f32_16x16x64_bf16 v[48:51], v[36:39], a[88:95], v2
    v_smfmac_f32_16x16x64_bf16 v[52:55], v[36:39], a[120:127], v2
    s_cbranch_vccnz .nk_106
.ok_107:
    v_smfmac_f32_16x16x64_bf16 v[40:43], v[24:27], a[0:7], v2
    v_smfmac_f32_16x16x64_bf16 v[44:47], v[24:27], a[32:39], v2
    s_waitcnt vmcnt(0)
    v_max_u32 v18, v29, v31
    v_cmp_eq_u32 vcc, -1, v18
    v_smfmac_f32_16x16x64_bf16 v[48:51], v[24:27], a[64:71], v2
    v_smfmac_f32_16x16x64_bf16 v[52:55], v[24:27], a[96:103], v2
    s_cbranch_vccnz .nk_96
    s_branch .ok_97
.nk_86:
    buffer_load_dwordx4 v[32:35], v3, s[8:11], s30 offen offset:2048 sc1
    s_add_u32 s62, s62, 1
    s_cmp_gt_u32 s62, 0x100000
    s_cbranch_scc1 .mg_end_1
    s_waitcnt vmcnt(2)
    v_max_u32 v18, v37, v39
    v_cmp_eq_u32 vcc, -1, v18
    s_cbranch_vccnz .nk_108
.ok_109:
    v_smfmac_f32_16x16x64_bf16 v[40:43], v[36:39], a[24:31], v2
    v_smfmac_f32_16x16x64_bf16 v[44:47], v[36:39], a[56:63], v2
    s_waitcnt vmcnt(1)
    v_max_u32 v18, v25, v27
    v_cmp_eq_u32 vcc, -1, v18
    v_smfmac_f32_16x16x64_bf16 v[48:51], v[36:39], a[88:95], v2
    v_smfmac_f32_16x16x64_bf16 v[52:55], v[36:39], a[120:127], v2
    s_cbranch_vccnz .nk_110
.ok_111:
    v_smfmac_f32_16x16x64_bf16 v[40:43], v[24:27], a[0:7], v2
    v_smfmac_f32_16x16x64_bf16 v[44:47], v[24:27], a[32:39], v2
    s_waitcnt vmcnt(0)
    v_max_u32 v18, v33, v35
    v_cmp_eq_u32 vcc, -1, v18
    v_smfmac_f32_16x16x64_bf16 v[48:51], v[24:27], a[64:71], v2
    v_smfmac_f32_16x16x64_bf16 v[52:55], v[24:27], a[96:103], v2
    s_cbranch_vccnz .nk_100
    s_branch .ok_101
.nk_88:
    buffer_load_dwordx4 v[36:39], v3, s[8:11], s30 offen offset:3072 sc1
    s_add_u32 s62, s62, 1
    s_cmp_gt_u32 s62, 0x100000
    s_cbranch_scc1 .mg_end_1
    s_waitcnt vmcnt(1)
    v_max_u32 v18, v25, v27
    v_cmp_eq_u32 vcc, -1, v18
    s_cbranch_vccnz .nk_112
.ok_113:
    v_smfmac_f32_16x16x64_bf16 v[40:43], v[24:27], a[0:7], v2
    v_smfmac_f32_16x16x64_bf16 v[44:47], v[24:27], a[32:39], v2
    s_waitcnt vmcnt(0)
    v_max_u32 v18, v37, v39
    v_cmp_eq_u32 vcc, -1, v18
    v_smfmac_f32_16x16x64_bf16 v[48:51], v[24:27], a[64:71], v2
    v_smfmac_f32_16x16x64_bf16 v[52:55], v[24:27], a[96:103], v2
    s_cbranch_vccnz .nk_82
    s_branch .ok_83
.nk_90:
    buffer_load_dwordx4 v[24:27], v3, s[8:11], s30 offen offset:0 sc1
    s_add_u32 s62, s62, 1
    s_cmp_gt_u32 s62, 0x100000
    s_cbranch_scc1 .mg_end_1
    s_waitcnt vmcnt(0)
    v_max_u32 v18, v25, v27
    v_cmp_eq_u32 vcc, -1, v18
    s_cbranch_vccnz .nk_90
    s_branch .ok_91
.nk_92:
    buffer_load_dwordx4 v[32:35], v3, s[8:11], s30 offen offset:2048 sc1
    s_add_u32 s62, s62, 1
    s_cmp_gt_u32 s62, 0x100000
    s_cbranch_scc1 .mg_end_1
    s_waitcnt vmcnt(2)
    v_max_u32 v18, v37, v39
    v_cmp_eq_u32 vcc, -1, v18
    s_cbranch_vccnz .nk_114
.ok_115:
    v_smfmac_f32_16x16x64_bf16 v[40:43], v[36:39], a[24:31], v2
    v_smfmac_f32_16x16x64_bf16 v[44:47], v[36:39], a[56:63], v2
    s_waitcnt vmcnt(1)
    v_max_u32 v18, v29, v31
    v_cmp_eq_u32 vcc, -1, v18
    v_smfmac_f32_16x16x64_bf16 v[48:51], v[36:39], a[88:95], v2
    v_smfmac_f32_16x16x64_bf16 v[52:55], v[36:39], a[120:127], v2
    s_cbranch_vccnz .nk_116
.ok_117:
    v_smfmac_f32_16x16x64_bf16 v[40:43], v[28:31], a[8:15], v2
    v_smfmac_f32_16x16x64_bf16 v[44:47], v[28:31], a[40:47], v2
    s_waitcnt vmcnt(0)
    v_max_u32 v18, v33, v35
    v_cmp_eq_u32 vcc, -1, v18
    v_smfmac_f32_16x16x64_bf16 v[48:51], v[28:31], a[72:79], v2
    v_smfmac_f32_16x16x64_bf16 v[52:55], v[28:31], a[104:111], v2
    s_cbranch_vccnz .nk_100
    s_branch .ok_101
.nk_94:
    buffer_load_dwordx4 v[36:39], v3, s[8:11], s30 offen offset:3072 sc1
    s_add_u32 s62, s62, 1
    s_cmp_gt_u32 s62, 0x100000
    s_cbranch_scc1 .mg_end_1
    s_waitcnt vmcnt(1)
    v_max_u32 v18, v29, v31
    v_cmp_eq_u32 vcc, -1, v18
    s_cbranch_vccnz .nk_118
.ok_119:
    v_smfmac_f32_16x16x64_bf16 v[40:43], v[28:31], a[8:15], v2
    v_smfmac_f32_16x16x64_bf16 v[44:47], v[28:31], a[40:47], v2
    s_waitcnt vmcnt(0)
    v_max_u32 v18, v37, v39
    v_cmp_eq_u32 vcc, -1, v18
    v_smfmac_f32_16x16x64_bf16 v[48:51], v[28:31], a[72:79], v2
    v_smfmac_f32_16x16x64_bf16 v[52:55], v[28:31], a[104:111], v2
    s_cbranch_vccnz .nk_82
    s_branch .ok_83
.nk_96:
    buffer_load_dwordx4 v[28:31], v3, s[8:11], s30 offen offset:1024 sc1
    s_add_u32 s62, s62, 1
    s_cmp_gt_u32 s62, 0x100000
    s_cbranch_scc1 .mg_end_1
    s_waitcnt vmcnt(0)
    v_max_u32 v18, v29, v31
    v_cmp_eq_u32 vcc, -1, v18
    s_cbranch_vccnz .nk_96
    s_branch .ok_97
.nk_98:
    buffer_load_dwordx4 v[36:39], v3, s[8:11], s30 offen offset:3072 sc1
    s_add_u32 s62, s62, 1
    s_cmp_gt_u32 s62, 0x100000
    s_cbranch_scc1 .mg_end_1
    s_waitcnt vmcnt(1)
    v_max_u32 v18, v33, v35
    v_cmp_eq_u32 vcc, -1, v18
    s_cbranch_vccnz .nk_80
    s_branch .ok_81
.nk_100:
    buffer_load_dwordx4 v[32:35], v3, s[8:11], s30 offen offset:2048 sc1
    s_add_u32 s62, s62, 1
    s_cmp_gt_u32 s62, 0x100000
    s_cbranch_scc1 .mg_end_1
    s_waitcnt vmcnt(0)
    v_max_u32 v18, v33, v35
    v_cmp_eq_u32 vcc, -1, v18
    s_cbranch_vccnz .nk_100
    s_branch .ok_101
.nk_102:
    buffer_load_dwordx4 v[32:35], v3, s[8:11], s30 offen offset:2048 sc1
    s_add_u32 s62, s62, 1
    s_cmp_gt_u32 s62, 0x100000
    s_cbranch_scc1 .mg_end_1
    s_waitcnt vmcnt(3)
    v_max_u32 v18, v37, v39
    v_cmp_eq_u32 vcc, -1, v18
    s_cbranch_vccnz .nk_120
.ok_121:
    v_smfmac_f32_16x16x64_bf16 v[40:43], v[36:39], a[24:31], v2
    v_smfmac_f32_16x16x64_bf16 v[44:47], v[36:39], a[56:63], v2
    s_waitcnt vmcnt(2)
    v_max_u32 v18, v25, v27
    v_cmp_eq_u32 vcc, -1, v18
    v_smfmac_f32_16x16x64_bf16 v[48:51], v[36:39], a[88:95], v2
    v_smfmac_f32_16x16x64_bf16 v[52:55], v[36:39], a[120:127], v2
    s_cbranch_vccnz .nk_122
.ok_123:
    v_smfmac_f32_16x16x64_bf16 v[40:43], v[24:27], a[0:7], v2
    v_smfmac_f32_16x16x64_bf16 v[44:47], v[24:27], a[32:39], v2
    s_waitcnt vmcnt(1)
    v_max_u32 v18, v29, v31
    v_cmp_eq_u32 vcc, -1, v18
    v_smfmac_f32_16x16x64_bf16 v[48:51], v[24:27], a[64:71], v2
    v_smfmac_f32_16x16x64_bf16 v[52:55], v[24:27], a[96:103], v2
    s_cbranch_vccnz .nk_116
    s_branch .ok_117
.nk_104:
    buffer_load_dwordx4 v[36:39], v3, s[8:11], s30 offen offset:3072 sc1
    s_add_u32 s62, s62, 1
    s_cmp_gt_u32 s62, 0x100000
    s_cbranch_scc1 .mg_end_1
    s_waitcnt vmcnt(2)
    v_max_u32 v18, v25, v27
    v_cmp_eq_u32 vcc, -1, v18
    s_cbranch_vccnz .nk_124
.ok_125:
    v_smfmac_f32_16x16x64_bf16 v[40:43], v[24:27], a[0:7], v2
    v_smfmac_f32_16x16x64_bf16 v[44:47], v[24:27], a[32:39], v2
    s_waitcnt vmcnt(1)
    v_max_u32 v18, v29, v31
    v_cmp_eq_u32 vcc, -1, v18
    v_smfmac_f32_16x16x64_bf16 v[48:51], v[24:27], a[64:71], v2
    v_smfmac_f32_16x16x64_bf16 v[52:55], v[24:27], a[96:103], v2
    s_cbranch_vccnz .nk_118
    s_branch .ok_119
.nk_106:
    buffer_load_dwordx4 v[24:27], v3, s[8:11], s30 offen offset:0 sc1
    s_add_u32 s62, s62, 1
    s_cmp_gt_u32 s62, 0x100000
    s_cbranch_scc1 .mg_end_1
    s_waitcnt vmcnt(1)
    v_max_u32 v18, v29, v31
    v_cmp_eq_u32 vcc, -1, v18
    s_cbranch_vccnz .nk_126
.ok_127:
    v_smfmac_f32_16x16x64_bf16 v[40:43], v[28:31], a[8:15], v2
    v_smfmac_f32_16x16x64_bf16 v[44:47], v[28:31], a[40:47], v2
    s_waitcnt vmcnt(0)
    v_max_u32 v18, v25, v27
    v_cmp_eq_u32 vcc, -1, v18
    v_smfmac_f32_16x16x64_bf16 v[48:51], v[28:31], a[72:79], v2
    v_smfmac_f32_16x16x64_bf16 v[52:55], v[28:31], a[104:111], v2
    s_cbranch_vccnz .nk_90
    s_branch .ok_91
.nk_108:
    buffer_load_dwordx4 v[36:39], v3, s[8:11], s30 offen offset:3072 sc1
    s_add_u32 s62, s62, 1
    s_cmp_gt_u32 s62, 0x100000
    s_cbranch_scc1 .mg_end_1
    s_waitcnt vmcnt(2)
    v_max_u32 v18, v25, v27
    v_cmp_eq_u32 vcc, -1, v18
    s_cbranch_vccnz .nk_128
.ok_129:
    v_smfmac_f32_16x16x64_bf16 v[40:43], v[24:27], a[0:7], v2
    v_smfmac_f32_16x16x64_bf16 v[44:47], v[24:27], a[32:39], v2
    s_waitcnt vmcnt(1)
    v_max_u32 v18, v33, v35
    v_cmp_eq_u32 vcc, -1, v18
    v_smfmac_f32_16x16x64_bf16 v[48:51], v[24:27], a[64:71], v2
    v_smfmac_f32_16x16x64_bf16 v[52:55], v[24:27], a[96:103], v2
    s_cbranch_vccnz .nk_80
    s_branch .ok_81
.nk_110:
    buffer_load_dwordx4 v[24:27], v3, s[8:11], s30 offen offset:0 sc1
    s_add_u32 s62, s62, 1
    s_cmp_gt_u32 s62, 0x100000
    s_cbranch_scc1 .mg_end_1
    s_waitcnt vmcnt(1)
    v_max_u32 v18, v33, v35
    v_cmp_eq_u32 vcc, -1, v18
    s_cbranch_vccnz .nk_130
.ok_131:
    v_smfmac_f32_16x16x64_bf16 v[40:43], v[32:35], a[16:23], v2
    v_smfmac_f32_16x16x64_bf16 v[44:47], v[32:35], a[48:55], v2
    s_waitcnt vmcnt(0)
    v_max_u32 v18, v25, v27
    v_cmp_eq_u32 vcc, -1, v18
    v_smfmac_f32_16x16x64_bf16 v[48:51], v[32:35], a[80:87], v2
    v_smfmac_f32_16x16x64_bf16 v[52:55], v[32:35], a[112:119], v2
    s_cbranch_vccnz .nk_90
    s_branch .ok_91
.nk_112:
    buffer_load_dwordx4 v[24:27], v3, s[8:11], s30 offen offset:0 sc1
    s_add_u32 s62, s62, 1
    s_cmp_gt_u32 s62, 0x100000
    s_cbranch_scc1 .mg_end_1
    s_waitcnt vmcnt(1)
    v_max_u32 v18, v37, v39
    v_cmp_eq_u32 vcc, -1, v18
    s_cbranch_vccnz .nk_88
    s_branch .ok_89
.nk_114:
    buffer_load_dwordx4 v[36:39], v3, s[8:11], s30 offen offset:3072 sc1
    s_add_u32 s62, s62, 1
    s_cmp_gt_u32 s62, 0x100000
    s_cbranch_scc1 .mg_end_1
    s_waitcnt vmcnt(2)
    v_max_u32 v18, v29, v31
    v_cmp_eq_u32 vcc, -1, v18
    s_cbranch_vccnz .nk_78
    s_branch .ok_79
.nk_116:
    buffer_load_dwordx4 v[28:31], v3, s[8:11], s30 offen offset:1024 sc1
    s_add_u32 s62, s62, 1
    s_cmp_gt_u32 s62, 0x100000
    s_cbranch_scc1 .mg_end_1
    s_waitcnt vmcnt(1)
    v_max_u32 v18, v33, v35
    v_cmp_eq_u32 vcc, -1, v18
    s_cbranch_vccnz .nk_132
.ok_133:
    v_smfmac_f32_16x16x64_bf16 v[40:43], v[32:35], a[16:23], v2
    v_smfmac_f32_16x16x64_bf16 v[44:47], v[32:35], a[48:55], v2
    s_waitcnt vmcnt(0)
    v_max_u32 v18, v29, v31
    v_cmp_eq_u32 vcc, -1, v18
    v_smfmac_f32_16x16x64_bf16 v[48:51], v[32:35], a[80:87], v2
    v_smfmac_f32_16x16x64_bf16 v[52:55], v[32:35], a[112:119], v2
    s_cbranch_vccnz .nk_96
    s_branch .ok_97
.nk_118:
    buffer_load_dwordx4 v[28:31], v3, s[8:11], s30 offen offset:1024 sc1
    s_add_u32 s62, s62, 1
    s_cmp_gt_u32 s62, 0x100000
    s_cbranch_scc1 .mg_end_1
    s_waitcnt vmcnt(1)
    v_max_u32 v18, v37, v39
    v_cmp_eq_u32 vcc, -1, v18
    s_cbranch_vccnz .nk_94
    s_branch .ok_95
.nk_120:
    buffer_load_dwordx4 v[36:39], v3, s[8:11], s30 offen offset:3072 sc1
    s_add_u32 s62, s62, 1
    s_cmp_gt_u32 s62, 0x100000
    s_cbranch_scc1 .mg_end_1
    s_waitcnt vmcnt(3)
    v_max_u32 v18, v25, v27
    v_cmp_eq_u32 vcc, -1, v18
    s_cbranch_vccnz .nk_76
    s_branch .ok_77
.nk_122:
    buffer_load_dwordx4 v[24:27], v3, s[8:11], s30 offen offset:0 sc1
    s_add_u32 s62, s62, 1
    s_cmp_gt_u32 s62, 0x100000
    s_cbranch_scc1 .mg_end_1
    s_waitcnt vmcnt(2)
    v_max_u32 v18, v29, v31
    v_cmp_eq_u32 vcc, -1, v18
    s_cbranch_vccnz .nk_134
.ok_135:
    v_smfmac_f32_16x16x64_bf16 v[40:43], v[28:31], a[8:15], v2
    v_smfmac_f32_16x16x64_bf16 v[44:47], v[28:31], a[40:47], v2
    s_waitcnt vmcnt(1)
    v_max_u32 v18, v33, v35
    v_cmp_eq_u32 vcc, -1, v18
    v_smfmac_f32_16x16x64_bf16 v[48:51], v[28:31], a[72:79], v2
    v_smfmac_f32_16x16x64_bf16 v[52:55], v[28:31], a[104:111], v2
    s_cbranch_vccnz .nk_130
    s_branch .ok_131
.nk_124:
    buffer_load_dwordx4 v[24:27], v3, s[8:11], s30 offen offset:0 sc1
    s_add_u32 s62, s62, 1
    s_cmp_gt_u32 s62, 0x100000
    s_cbranch_scc1 .mg_end_1
    s_waitcnt vmcnt(2)
    v_max_u32 v18, v29, v31
    v_cmp_eq_u32 vcc, -1, v18
    s_cbranch_vccnz .nk_136
.ok_137:
    v_smfmac_f32_16x16x64_bf16 v[40:43], v[28:31], a[8:15], v2
    v_smfmac_f32_16x16x64_bf16 v[44:47], v[28:31], a[40:47], v2
    s_waitcnt vmcnt(1)
    v_max_u32 v18, v37, v39
    v_cmp_eq_u32 vcc, -1, v18
    v_smfmac_f32_16x16x64_bf16 v[48:51], v[28:31], a[72:79], v2
    v_smfmac_f32_16x16x64_bf16 v[52:55], v[28:31], a[104:111], v2
    s_cbranch_vccnz .nk_88
    s_branch .ok_89
.nk_126:
    buffer_load_dwordx4 v[28:31], v3, s[8:11], s30 offen offset:1024 sc1
    s_add_u32 s62, s62, 1
    s_cmp_gt_u32 s62, 0x100000
    s_cbranch_scc1 .mg_end_1
    s_waitcnt vmcnt(1)
    v_max_u32 v18, v25, v27
    v_cmp_eq_u32 vcc, -1, v18
    s_cbranch_vccnz .nk_106
    s_branch .ok_107
.nk_128:
    buffer_load_dwordx4 v[24:27], v3, s[8:11], s30 offen offset:0 sc1
    s_add_u32 s62, s62, 1
    s_cmp_gt_u32 s62, 0x100000
    s_cbranch_scc1 .mg_end_1
    s_waitcnt vmcnt(2)
    v_max_u32 v18, v33, v35
    v_cmp_eq_u32 vcc, -1, v18
    s_cbranch_vccnz .nk_86
    s_branch .ok_87
.nk_130:
    buffer_load_dwordx4 v[32:35], v3, s[8:11], s30 offen offset:2048 sc1
    s_add_u32 s62, s62, 1
    s_cmp_gt_u32 s62, 0x100000
    s_cbranch_scc1 .mg_end_1
    s_waitcnt vmcnt(1)
    v_max_u32 v18, v25, v27
    v_cmp_eq_u32 vcc, -1, v18
    s_cbranch_vccnz .nk_110
    s_branch .ok_111
.nk_132:
    buffer_load_dwordx4 v[32:35], v3, s[8:11], s30 offen offset:2048 sc1
    s_add_u32 s62, s62, 1
    s_cmp_gt_u32 s62, 0x100000
    s_cbranch_scc1 .mg_end_1
    s_waitcnt vmcnt(1)
    v_max_u32 v18, v29, v31
    v_cmp_eq_u32 vcc, -1, v18
    s_cbranch_vccnz .nk_116
    s_branch .ok_117
.nk_134:
    buffer_load_dwordx4 v[28:31], v3, s[8:11], s30 offen offset:1024 sc1
    s_add_u32 s62, s62, 1
    s_cmp_gt_u32 s62, 0x100000
    s_cbranch_scc1 .mg_end_1
    s_waitcnt vmcnt(2)
    v_max_u32 v18, v33, v35
    v_cmp_eq_u32 vcc, -1, v18
    s_cbranch_vccnz .nk_138
.ok_139:
    v_smfmac_f32_16x16x64_bf16 v[40:43], v[32:35], a[16:23], v2
    v_smfmac_f32_16x16x64_bf16 v[44:47], v[32:35], a[48:55], v2
    s_waitcnt vmcnt(1)
    v_max_u32 v18, v25, v27
    v_cmp_eq_u32 vcc, -1, v18
    v_smfmac_f32_16x16x64_bf16 v[48:51], v[32:35], a[80:87], v2
    v_smfmac_f32_16x16x64_bf16 v[52:55], v[32:35], a[112:119], v2
    s_cbranch_vccnz .nk_106
    s_branch .ok_107
.nk_136:
    buffer_load_dwordx4 v[28:31], v3, s[8:11], s30 offen offset:1024 sc1
    s_add_u32 s62, s62, 1
    s_cmp_gt_u32 s62, 0x100000
    s_cbranch_scc1 .mg_end_1
    s_waitcnt vmcnt(2)
    v_max_u32 v18, v37, v39
    v_cmp_eq_u32 vcc, -1, v18
    s_cbranch_vccnz .nk_104
    s_branch .ok_105
.nk_138:
    buffer_load_dwordx4 v[32:35], v3, s[8:11], s30 offen offset:2048 sc1
    s_add_u32 s62, s62, 1
    s_cmp_gt_u32 s62, 0x100000
    s_cbranch_scc1 .mg_end_1
    s_waitcnt vmcnt(2)
    v_max_u32 v18, v25, v27
    v_cmp_eq_u32 vcc, -1, v18
    s_cbranch_vccnz .nk_122
    s_branch .ok_123
.p2align 6
.gm_25:
    s_waitcnt vmcnt(3)
    v_cmp_eq_u32 vcc, -1, v27
    s_cbranch_vccnz .nk_140
.ok_141:
    v_smfmac_f32_16x16x64_bf16 v[64:67], v[24:27], a[192:199], v2
    s_waitcnt vmcnt(2)
    v_cmp_eq_u32 vcc, -1, v31
    v_smfmac_f32_16x16x64_bf16 v[68:71], v[24:27], a[224:231], v2
    s_cbranch_vccnz .nk_142
.ok_143:
    v_smfmac_f32_16x16x64_bf16 v[64:67], v[28:31], a[200:207], v2
    s_waitcnt vmcnt(1)
    v_cmp_eq_u32 vcc, -1, v35
    v_smfmac_f32_16x16x64_bf16 v[68:71], v[28:31], a[232:239], v2
    s_cbranch_vccnz .nk_144
.ok_145:
    v_smfmac_f32_16x16x64_bf16 v[64:67], v[32:35], a[208:215], v2
    s_waitcnt vmcnt(0)
    v_cmp_eq_u32 vcc, -1, v39
    v_smfmac_f32_16x16x64_bf16 v[68:71], v[32:35], a[240:247], v2
    s_cbranch_vccnz .nk_146
.ok_147:
    v_smfmac_f32_16x16x64_bf16 v[64:67], v[36:39], a[216:223], v2
    v_smfmac_f32_16x16x64_bf16 v[68:71], v[36:39], a[248:255], v2
    s_setpc_b64 s[98:99]
.nk_140:
    buffer_load_dwordx4 v[24:27], v4, s[8:11], s30 offen offset:0 sc1
    s_add_u32 s62, s62, 1
    s_cmp_gt_u32 s62, 0x100000
    s_cbranch_scc1 .mg_end_1
    s_waitcnt vmcnt(3)
    v_cmp_eq_u32 vcc, -1, v31
    s_cbranch_vccnz .nk_148
.ok_149:
    v_smfmac_f32_16x16x64_bf16 v[64:67], v[28:31], a[200:207], v2
    s_waitcnt vmcnt(2)
    v_cmp_eq_u32 vcc, -1, v35
    v_smfmac_f32_16x16x64_bf16 v[68:71], v[28:31], a[232:239], v2
    s_cbranch_vccnz .nk_150
.ok_151:
    v_smfmac_f32_16x16x64_bf16 v[64:67], v[32:35], a[208:215], v2
    s_waitcnt vmcnt(1)
    v_cmp_eq_u32 vcc, -1, v39
    v_smfmac_f32_16x16x64_bf16 v[68:71], v[32:35], a[240:247], v2
    s_cbranch_vccnz .nk_152
.ok_153:
    v_smfmac_f32_16x16x64_bf16 v[64:67], v[36:39], a[216:223], v2
    s_waitcnt vmcnt(0)
    v_cmp_eq_u32 vcc, -1, v27
    v_smfmac_f32_16x16x64_bf16 v[68:71], v[36:39], a[248:255], v2
    s_cbranch_vccnz .nk_154
.ok_155:
    v_smfmac_f32_16x16x64_bf16 v[64:67], v[24:27], a[192:199], v2
    v_smfmac_f32_16x16x64_bf16 v[68:71], v[24:27], a[224:231], v2
    s_setpc_b64 s[98:99]
.nk_142:
    buffer_load_dwordx4 v[28:31], v4, s[8:11], s30 offen offset:1024 sc1
    s_add_u32 s62, s62, 1
    s_cmp_gt_u32 s62, 0x100000
    s_cbranch_scc1 .mg_end_1
    s_waitcnt vmcnt(2)
    v_cmp_eq_u32 vcc, -1, v35
    s_cbranch_vccnz .nk_156
.ok_157:
    v_smfmac_f32_16x16x64_bf16 v[64:67], v[32:35], a[208:215], v2
    s_waitcnt vmcnt(1)
    v_cmp_eq_u32 vcc, -1, v39
    v_smfmac_f32_16x16x64_bf16 v[68:71], v[32:35], a[240:247], v2
    s_cbranch_vccnz .nk_158
.ok_159:
    v_smfmac_f32_16x16x64_bf16 v[64:67], v[36:39], a[216:223], v2
    s_waitcnt vmcnt(0)
    v_cmp_eq_u32 vcc, -1, v31
    v_smfmac_f32_16x16x64_bf16 v[68:71], v[36:39], a[248:255], v2
    s_cbranch_vccnz .nk_160
.ok_161:
    v_smfmac_f32_16x16x64_bf16 v[64:67], v[28:31], a[200:207], v2
    v_smfmac_f32_16x16x64_bf16 v[68:71], v[28:31], a[232:239], v2
    s_setpc_b64 s[98:99]
.nk_144:
    buffer_load_dwordx4 v[32:35], v4, s[8:11], s30 offen offset:2048 sc1
    s_add_u32 s62, s62, 1
    s_cmp_gt_u32 s62, 0x100000
    s_cbranch_scc1 .mg_end_1
    s_waitcnt vmcnt(1)
    v_cmp_eq_u32 vcc, -1, v39
    s_cbranch_vccnz .nk_162
.ok_163:
    v_smfmac_f32_16x16x64_bf16 v[64:67], v[36:39], a[216:223], v2
    s_waitcnt vmcnt(0)
    v_cmp_eq_u32 vcc, -1, v35
    v_smfmac_f32_16x16x64_bf16 v[68:71], v[36:39], a[248:255], v2
    s_cbranch_vccnz .nk_164
.ok_165:
    v_smfmac_f32_16x16x64_bf16 v[64:67], v[32:35], a[208:215], v2
    v_smfmac_f32_16x16x64_bf16 v[68:71], v[32:35], a[240:247], v2
    s_setpc_b64 s[98:99]
.nk_146:
    buffer_load_dwordx4 v[36:39], v4, s[8:11], s30 offen offset:3072 sc1
    s_add_u32 s62, s62, 1
    s_cmp_gt_u32 s62, 0x100000
    s_cbranch_scc1 .mg_end_1
    s_waitcnt vmcnt(0)
    v_cmp_eq_u32 vcc, -1, v39
    s_cbranch_vccnz .nk_146
    s_branch .ok_147
.nk_148:
    buffer_load_dwordx4 v[28:31], v4, s[8:11], s30 offen offset:1024 sc1
    s_add_u32 s62, s62, 1
    s_cmp_gt_u32 s62, 0x100000
    s_cbranch_scc1 .mg_end_1
    s_waitcnt vmcnt(3)
    v_cmp_eq_u32 vcc, -1, v35
    s_cbranch_vccnz .nk_166
.ok_167:
    v_smfmac_f32_16x16x64_bf16 v[64:67], v[32:35], a[208:215], v2
    s_waitcnt vmcnt(2)
    v_cmp_eq_u32 vcc, -1, v39
    v_smfmac_f32_16x16x64_bf16 v[68:71], v[32:35], a[240:247], v2
    s_cbranch_vccnz .nk_168
.ok_169:
    v_smfmac_f32_16x16x64_bf16 v[64:67], v[36:39], a[216:223], v2
    s_waitcnt vmcnt(1)
    v_cmp_eq_u32 vcc, -1, v27
    v_smfmac_f32_16x16x64_bf16 v[68:71], v[36:39], a[248:255], v2
    s_cbranch_vccnz .nk_170
.ok_171:
    v_smfmac_f32_16x16x64_bf16 v[64:67], v[24:27], a[192:199], v2
    s_waitcnt vmcnt(0)
    v_cmp_eq_u32 vcc, -1, v31
    v_smfmac_f32_16x16x64_bf16 v[68:71], v[24:27], a[224:231], v2
    s_cbranch_vccnz .nk_160
    s_branch .ok_161
.nk_150:
    buffer_load_dwordx4 v[32:35], v4, s[8:11], s30 offen offset:2048 sc1
    s_add_u32 s62, s62, 1
    s_cmp_gt_u32 s62, 0x100000
    s_cbranch_scc1 .mg_end_1
    s_waitcnt vmcnt(2)
    v_cmp_eq_u32 vcc, -1, v39
    s_cbranch_vccnz .nk_172
.ok_173:
    v_smfmac_f32_16x16x64_bf16 v[64:67], v[36:39], a[216:223], v2
    s_waitcnt vmcnt(1)
    v_cmp_eq_u32 vcc, -1, v27
    v_smfmac_f32_16x16x64_bf16 v[68:71], v[36:39], a[248:255], v2
    s_cbranch_vccnz .nk_174
.ok_175:
    v_smfmac_f32_16x16x64_bf16 v[64:67], v[24:27], a[192:199], v2
    s_waitcnt vmcnt(0)
    v_cmp_eq_u32 vcc, -1, v35
    v_smfmac_f32_16x16x64_bf16 v[68:71], v[24:27], a[224:231], v2
    s_cbranch_vccnz .nk_164
    s_branch .ok_165
.nk_152:
    buffer_load_dwordx4 v[36:39], v4, s[8:11], s30 offen offset:3072 sc1
    s_add_u32 s62, s62, 1
    s_cmp_gt_u32 s62, 0x100000
    s_cbranch_scc1 .mg_end_1
    s_waitcnt vmcnt(1)
    v_cmp_eq_u32 vcc, -1, v27
    s_cbranch_vccnz .nk_176
.ok_177:
    v_smfmac_f32_16x16x64_bf16 v[64:67], v[24:27], a[192:199], v2
    s_waitcnt vmcnt(0)
    v_cmp_eq_u32 vcc, -1, v39
    v_smfmac_f32_16x16x64_bf16 v[68:71], v[24:27], a[224:231], v2
    s_cbranch_vccnz .nk_146
    s_branch .ok_147
.nk_154:
    buffer_load_dwordx4 v[24:27], v4, s[8:11], s30 offen offset:0 sc1
    s_add_u32 s62, s62, 1
    s_cmp_gt_u32 s62, 0x100000
    s_cbranch_scc1 .mg_end_1
    s_waitcnt vmcnt(0)
    v_cmp_eq_u32 vcc, -1, v27
    s_cbranch_vccnz .nk_154
    s_branch .ok_155
.nk_156:
    buffer_load_dwordx4 v[32:35], v4, s[8:11], s30 offen offset:2048 sc1
    s_add_u32 s62, s62, 1
    s_cmp_gt_u32 s62, 0x100000
    s_cbranch_scc1 .mg_end_1
    s_waitcnt vmcnt(2)
    v_cmp_eq_u32 vcc, -1, v39
    s_cbranch_vccnz .nk_178
.ok_179:
    v_smfmac_f32_16x16x64_bf16 v[64:67], v[36:39], a[216:223], v2
    s_waitcnt vmcnt(1)
    v_cmp_eq_u32 vcc, -1, v31
    v_smfmac_f32_16x16x64_bf16 v[68:71], v[36:39], a[248:255], v2
    s_cbranch_vccnz .nk_180
.ok_181:
    v_smfmac_f32_16x16x64_bf16 v[64:67], v[28:31], a[200:207], v2
    s_waitcnt vmcnt(0)
    v_cmp_eq_u32 vcc, -1, v35
    v_smfmac_f32_16x16x64_bf16 v[68:71], v[28:31], a[232:239], v2
    s_cbranch_vccnz .nk_164
    s_branch .ok_165
.nk_158:
    buffer_load_dwordx4 v[36:39], v4, s[8:11], s30 offen offset:3072 sc1
    s_add_u32 s62, s62, 1
    s_cmp_gt_u32 s62, 0x100000
    s_cbranch_scc1 .mg_end_1
    s_waitcnt vmcnt(1)
    v_cmp_eq_u32 vcc, -1, v31
    s_cbranch_vccnz .nk_182
.ok_183:
    v_smfmac_f32_16x16x64_bf16 v[64:67], v[28:31], a[200:207], v2
    s_waitcnt vmcnt(0)
    v_cmp_eq_u32 vcc, -1, v39
    v_smfmac_f32_16x16x64_bf16 v[68:71], v[28:31], a[232:239], v2
    s_cbranch_vccnz .nk_146
    s_branch .ok_147
.nk_160:
    buffer_load_dwordx4 v[28:31], v4, s[8:11], s30 offen offset:1024 sc1
    s_add_u32 s62, s62, 1
    s_cmp_gt_u32 s62, 0x100000
    s_cbranch_scc1 .mg_end_1
    s_waitcnt vmcnt(0)
    v_cmp_eq_u32 vcc, -1, v31
    s_cbranch_vccnz .nk_160
    s_branch .ok_161
.nk_162:
    buffer_load_dwordx4 v[36:39], v4, s[8:11], s30 offen offset:3072 sc1
    s_add_u32 s62, s62, 1
    s_cmp_gt_u32 s62, 0x100000
    s_cbranch_scc1 .mg_end_1
    s_waitcnt vmcnt(1)
    v_cmp_eq_u32 vcc, -1, v35
    s_cbranch_vccnz .nk_144
    s_branch .ok_145
.nk_164:
    buffer_load_dwordx4 v[32:35], v4, s[8:11], s30 offen offset:2048 sc1
    s_add_u32 s62, s62, 1
    s_cmp_gt_u32 s62, 0x100000
    s_cbranch_scc1 .mg_end_1
    s_waitcnt vmcnt(0)
    v_cmp_eq_u32 vcc, -1, v35
    s_cbranch_vccnz .nk_164
    s_branch .ok_165
.nk_166:
    buffer_load_dwordx4 v[32:35], v4, s[8:11], s30 offen offset:2048 sc1
    s_add_u32 s62, s62, 1
    s_cmp_gt_u32 s62, 0x100000
    s_cbranch_scc1 .mg_end_1
    s_waitcnt vmcnt(3)
    v_cmp_eq_u32 vcc, -1, v39
    s_cbranch_vccnz .nk_184
.ok_185:
    v_smfmac_f32_16x16x64_bf16 v[64:67], v[36:39], a[216:223], v2
    s_waitcnt vmcnt(2)
    v_cmp_eq_u32 vcc, -1, v27
    v_smfmac_f32_16x16x64_bf16 v[68:71], v[36:39], a[248:255], v2
    s_cbranch_vccnz .nk_186
.ok_187:
    v_smfmac_f32_16x16x64_bf16 v[64:67], v[24:27], a[192:199], v2
    s_waitcnt vmcnt(1)
    v_cmp_eq_u32 vcc, -1, v31
    v_smfmac_f32_16x16x64_bf16 v[68:71], v[24:27], a[224:231], v2
    s_cbranch_vccnz .nk_180
    s_branch .ok_181
.nk_168:
    buffer_load_dwordx4 v[36:39], v4, s[8:11], s30 offen offset:3072 sc1
    s_add_u32 s62, s62, 1
    s_cmp_gt_u32 s62, 0x100000
    s_cbranch_scc1 .mg_end_1
    s_waitcnt vmcnt(2)
    v_cmp_eq_u32 vcc, -1, v27
    s_cbranch_vccnz .nk_188
.ok_189:
    v_smfmac_f32_16x16x64_bf16 v[64:67], v[24:27], a[192:199], v2
    s_waitcnt vmcnt(1)
    v_cmp_eq_u32 vcc, -1, v31
    v_smfmac_f32_16x16x64_bf16 v[68:71], v[24:27], a[224:231], v2
    s_cbranch_vccnz .nk_182
    s_branch .ok_183
.nk_170:
    buffer_load_dwordx4 v[24:27], v4, s[8:11], s30 offen offset:0 sc1
    s_add_u32 s62, s62, 1
    s_cmp_gt_u32 s62, 0x100000
    s_cbranch_scc1 .mg_end_1
    s_waitcnt vmcnt(1)
    v_cmp_eq_u32 vcc, -1, v31
    s_cbranch_vccnz .nk_190
.ok_191:
    v_smfmac_f32_16x16x64_bf16 v[64:67], v[28:31], a[200:207], v2
    s_waitcnt vmcnt(0)
    v_cmp_eq_u32 vcc, -1, v27
    v_smfmac_f32_16x16x64_bf16 v[68:71], v[28:31], a[232:239], v2
    s_cbranch_vccnz .nk_154
    s_branch .ok_155
.nk_172:
    buffer_load_dwordx4 v[36:39], v4, s[8:11], s30 offen offset:3072 sc1
    s_add_u32 s62, s62, 1
    s_cmp_gt_u32 s62, 0x100000
    s_cbranch_scc1 .mg_end_1
    s_waitcnt vmcnt(2)
    v_cmp_eq_u32 vcc, -1, v27
    s_cbranch_vccnz .nk_192
.ok_193:
    v_smfmac_f32_16x16x64_bf16 v[64:67], v[24:27], a[192:199], v2
    s_waitcnt vmcnt(1)
    v_cmp_eq_u32 vcc, -1, v35
    v_smfmac_f32_16x16x64_bf16 v[68:71], v[24:27], a[224:231], v2
    s_cbranch_vccnz .nk_144
    s_branch .ok_145
.nk_174:
    buffer_load_dwordx4 v[24:27], v4, s[8:11], s30 offen offset:0 sc1
    s_add_u32 s62, s62, 1
    s_cmp_gt_u32 s62, 0x100000
    s_cbranch_scc1 .mg_end_1
    s_waitcnt vmcnt(1)
    v_cmp_eq_u32 vcc, -1, v35
    s_cbranch_vccnz .nk_194
.ok_195:
    v_smfmac_f32_16x16x64_bf16 v[64:67], v[32:35], a[208:215], v2
    s_waitcnt vmcnt(0)
    v_cmp_eq_u32 vcc, -1, v27
    v_smfmac_f32_16x16x64_bf16 v[68:71], v[32:35], a[240:247], v2
    s_cbranch_vccnz .nk_154
    s_branch .ok_155
.nk_176:
    buffer_load_dwordx4 v[24:27], v4, s[8:11], s30 offen offset:0 sc1
    s_add_u32 s62, s62, 1
    s_cmp_gt_u32 s62, 0x100000
    s_cbranch_scc1 .mg_end_1
    s_waitcnt vmcnt(1)
    v_cmp_eq_u32 vcc, -1, v39
    s_cbranch_vccnz .nk_152
    s_branch .ok_153
.nk_178:
    buffer_load_dwordx4 v[36:39], v4, s[8:11], s30 offen offset:3072 sc1
    s_add_u32 s62, s62, 1
    s_cmp_gt_u32 s62, 0x100000
    s_cbranch_scc1 .mg_end_1
    s_waitcnt vmcnt(2)
    v_cmp_eq_u32 vcc, -1, v31
    s_cbranch_vccnz .nk_142
    s_branch .ok_143
.nk_180:
    buffer_load_dwordx4 v[28:31], v4, s[8:11], s30 offen offset:1024 sc1
    s_add_u32 s62, s62, 1
    s_cmp_gt_u32 s62, 0x100000
    s_cbranch_scc1 .mg_end_1
    s_waitcnt vmcnt(1)
    v_cmp_eq_u32 vcc, -1, v35
    s_cbranch_vccnz .nk_196
.ok_197:
    v_smfmac_f32_16x16x64_bf16 v[64:67], v[32:35], a[208:215], v2
    s_waitcnt vmcnt(0)
    v_cmp_eq_u32 vcc, -1, v31
    v_smfmac_f32_16x16x64_bf16 v[68:71], v[32:35], a[240:247], v2
    s_cbranch_vccnz .nk_160
    s_branch .ok_161
.nk_182:
    buffer_load_dwordx4 v[28:31], v4, s[8:11], s30 offen offset:1024 sc1
    s_add_u32 s62, s62, 1
    s_cmp_gt_u32 s62, 0x100000
    s_cbranch_scc1 .mg_end_1
    s_waitcnt vmcnt(1)
    v_cmp_eq_u32 vcc, -1, v39
    s_cbranch_vccnz .nk_158
    s_branch .ok_159
.nk_184:
    buffer_load_dwordx4 v[36:39], v4, s[8:11], s30 offen offset:3072 sc1
    s_add_u32 s62, s62, 1
    s_cmp_gt_u32 s62, 0x100000
    s_cbranch_scc1 .mg_end_1
    s_waitcnt vmcnt(3)
    v_cmp_eq_u32 vcc, -1, v27
    s_cbranch_vccnz .nk_140
    s_branch .ok_141
.nk_186:
    buffer_load_dwordx4 v[24:27], v4, s[8:11], s30 offen offset:0 sc1
    s_add_u32 s62, s62, 1
    s_cmp_gt_u32 s62, 0x100000
    s_cbranch_scc1 .mg_end_1
    s_waitcnt vmcnt(2)
    v_cmp_eq_u32 vcc, -1, v31
    s_cbranch_vccnz .nk_198
.ok_199:
    v_smfmac_f32_16x16x64_bf16 v[64:67], v[28:31], a[200:207], v2
    s_waitcnt vmcnt(1)
    v_cmp_eq_u32 vcc, -1, v35
    v_smfmac_f32_16x16x64_bf16 v[68:71], v[28:31], a[232:239], v2
    s_cbranch_vccnz .nk_194
    s_branch .ok_195
.nk_188:
    buffer_load_dwordx4 v[24:27], v4, s[8:11], s30 offen offset:0 sc1
    s_add_u32 s62, s62, 1
    s_cmp_gt_u32 s62, 0x100000
    s_cbranch_scc1 .mg_end_1
    s_waitcnt vmcnt(2)
    v_cmp_eq_u32 vcc, -1, v31
    s_cbranch_vccnz .nk_200
.ok_201:
    v_smfmac_f32_16x16x64_bf16 v[64:67], v[28:31], a[200:207], v2
    s_waitcnt vmcnt(1)
    v_cmp_eq_u32 vcc, -1, v39
    v_smfmac_f32_16x16x64_bf16 v[68:71], v[28:31], a[232:239], v2
    s_cbranch_vccnz .nk_152
    s_branch .ok_153
.nk_190:
    buffer_load_dwordx4 v[28:31], v4, s[8:11], s30 offen offset:1024 sc1
    s_add_u32 s62, s62, 1
    s_cmp_gt_u32 s62, 0x100000
    s_cbranch_scc1 .mg_end_1
    s_waitcnt vmcnt(1)
    v_cmp_eq_u32 vcc, -1, v27
    s_cbranch_vccnz .nk_170
    s_branch .ok_171
.nk_192:
    buffer_load_dwordx4 v[24:27], v4, s[8:11], s30 offen offset:0 sc1
    s_add_u32 s62, s62, 1
    s_cmp_gt_u32 s62, 0x100000
    s_cbranch_scc1 .mg_end_1
    s_waitcnt vmcnt(2)
    v_cmp_eq_u32 vcc, -1, v35
    s_cbranch_vccnz .nk_150
    s_branch .ok_151
.nk_194:
    buffer_load_dwordx4 v[32:35], v4, s[8:11], s30 offen offset:2048 sc1
    s_add_u32 s62, s62, 1
    s_cmp_gt_u32 s62, 0x100000
    s_cbranch_scc1 .mg_end_1
    s_waitcnt vmcnt(1)
    v_cmp_eq_u32 vcc, -1, v27
    s_cbranch_vccnz .nk_174
    s_branch .ok_175
.nk_196:
    buffer_load_dwordx4 v[32:35], v4, s[8:11], s30 offen offset:2048 sc1
    s_add_u32 s62, s62, 1
    s_cmp_gt_u32 s62, 0x100000
    s_cbranch_scc1 .mg_end_1
    s_waitcnt vmcnt(1)
    v_cmp_eq_u32 vcc, -1, v31
    s_cbranch_vccnz .nk_180
    s_branch .ok_181
.nk_198:
    buffer_load_dwordx4 v[28:31], v4, s[8:11], s30 offen offset:1024 sc1
    s_add_u32 s62, s62, 1
    s_cmp_gt_u32 s62, 0x100000
    s_cbranch_scc1 .mg_end_1
    s_waitcnt vmcnt(2)
    v_cmp_eq_u32 vcc, -1, v35
    s_cbranch_vccnz .nk_202
.ok_203:
    v_smfmac_f32_16x16x64_bf16 v[64:67], v[32:35], a[208:215], v2
    s_waitcnt vmcnt(1)
    v_cmp_eq_u32 vcc, -1, v27
    v_smfmac_f32_16x16x64_bf16 v[68:71], v[32:35], a[240:247], v2
    s_cbranch_vccnz .nk_170
    s_branch .ok_171
.nk_200:
    buffer_load_dwordx4 v[28:31], v4, s[8:11], s30 offen offset:1024 sc1
    s_add_u32 s62, s62, 1
    s_cmp_gt_u32 s62, 0x100000
    s_cbranch_scc1 .mg_end_1
    s_waitcnt vmcnt(2)
    v_cmp_eq_u32 vcc, -1, v39
    s_cbranch_vccnz .nk_168
    s_branch .ok_169
.nk_202:
    buffer_load_dwordx4 v[32:35], v4, s[8:11], s30 offen offset:2048 sc1
    s_add_u32 s62, s62, 1
    s_cmp_gt_u32 s62, 0x100000
    s_cbranch_scc1 .mg_end_1
    s_waitcnt vmcnt(2)
    v_cmp_eq_u32 vcc, -1, v27
    s_cbranch_vccnz .nk_186
    s_branch .ok_187
.slowv_19:
    s_mov_b32 s28, 0
    s_mov_b32 s30, 83886080
    s_mov_b32 s31, 84180992
    s_mov_b32 s32, 84475904
    s_mov_b32 s33, 84770816
    s_mov_b32 s41, 66977792
    s_lshl_b32 s42, s56, 13
    s_lshl_b32 s4, s53, 11
    s_add_u32 s44, s42, s4
    s_add_u32 s44, s44, 33554432
    s_add_u32 s42, s42, 16777216
    s_xor_b32 s4, s53, 2
    s_lshl_b32 s4, s4, 10
    s_add_u32 s42, s42, s4
    s_add_u32 s43, s42, 4096
    s_add_u32 s96, s44, 524288
    s_sub_u32 s95, s96, 16777216
    s_mov_b32 s62, 0
    s_mov_b32 s45, 0x3e0293ee
    s_mov_b32 s46, 0
    s_and_b32 s4, s25, 1
    s_lshl_b32 s4, s4, 14
    s_lshr_b32 s5, s25, 1
    s_lshl_b32 s5, s5, 12
    s_or_b32 s4, s4, s5
    s_xor_b32 s47, s47, s4
    s_and_b32 s5, s26, 1
    s_lshl_b32 s5, s5, 11
    s_lshr_b32 s4, s26, 1
    s_lshl_b32 s4, s4, 15
    s_or_b32 s5, s5, s4
    s_bfe_u32 s4, s26, 0x10004
    s_lshl_b32 s4, s4, 11
    s_xor_b32 s5, s5, s4
    s_xor_b32 s34, s5, s47
    s_xor_b32 s35, s34, 0x84000
    s_xor_b32 s36, s34, 0x101000
    s_xor_b32 s37, s34, 0x185000
    s_and_b32 s4, s25, 1
    s_lshl_b32 s35, s4, 14
    s_lshr_b32 s4, s25, 1
    s_lshl_b32 s4, s4, 12
    s_or_b32 s35, s35, s4
    s_and_b32 s4, s26, 1
    s_lshl_b32 s4, s4, 11
    s_or_b32 s35, s35, s4
    s_lshr_b32 s4, s26, 1
    s_lshl_b32 s4, s4, 15
    s_or_b32 s35, s35, s4
    s_cmp_eq_u32 s24, 1
    s_cbranch_scc1 .w1_205
    s_cmp_eq_u32 s24, 2
    s_cbranch_scc1 .w2_206
    s_cmp_eq_u32 s24, 3
    s_cbranch_scc1 .w3_207
.w0_204:
    v_bfe_u32 v254, v1, 4, 1
    v_mul_u32_u24 v168, 1024, v254
    v_bfe_u32 v254, v1, 5, 1
    v_mul_u32_u24 v254, 128, v254
    v_add_u32 v168, v168, v254
    v_bfe_u32 v254, v1, 3, 1
    v_mul_u32_u24 v254, 64, v254
    v_add_u32 v168, v168, v254
    v_bfe_u32 v254, v1, 0, 2
    v_mul_u32_u24 v254, 16, v254
    v_add_u32 v168, v168, v254
    v_bfe_u32 v254, v1, 2, 1
    v_mul_u32_u24 v254, 8, v254
    v_add_u32 v168, v168, v254
    v_add_u32 v168, s101, v168
    v_bfe_u32 v254, v1, 0, 1
    v_mul_u32_u24 v9, 144, v254
    v_bfe_u32 v254, v1, 1, 1
    v_mul_u32_u24 v254, 576, v254
    v_add_u32 v9, v9, v254
    v_bfe_u32 v254, v1, 2, 1
    v_mul_u32_u24 v254, 288, v254
    v_add_u32 v9, v9, v254
    v_bfe_u32 v254, v1, 3, 1
    v_mul_u32_u24 v254, 1152, v254
    v_add_u32 v9, v9, v254
    v_bfe_u32 v254, v1, 4, 2
    v_mul_u32_u24 v254, 32, v254
    v_add_u32 v9, v9, v254
    s_lshl_b32 s4, s56, 10
    v_bfe_u32 v254, v1, 0, 6
    v_mul_u32_u24 v13, 16, v254
    v_add_u32 v13, 262144, v13
    v_add_u32 v13, s4, v13
    v_xor_b32 v156, 1024, v246
    v_xor_b32 v157, 2048, v246
    v_xor_b32 v158, 3072, v246
    v_bfe_u32 v254, v1, 0, 1
    v_mul_u32_u24 v14, 16, v254
    v_bfe_u32 v254, v1, 4, 1
    v_mul_u32_u24 v254, 32, v254
    v_add_u32 v14, v14, v254
    v_bfe_u32 v254, v1, 1, 2
    v_mul_u32_u24 v254, 64, v254
    v_add_u32 v14, v14, v254
    v_bfe_u32 v254, v1, 5, 1
    v_mul_u32_u24 v254, 256, v254
    v_add_u32 v14, v14, v254
    v_add_u32 v14, 65536, v14
    v_add_u32 v14, s55, v14
    v_bfe_u32 v254, v1, 0, 6
    v_mul_u32_u24 v15, 16, v254
    v_bfe_u32 v254, v1, 2, 2
    v_mul_u32_u24 v16, 128, v254
    v_bfe_u32 v254, v1, 0, 2
    v_mul_u32_u24 v254, 16, v254
    v_add_u32 v16, v16, v254
    v_bfe_u32 v254, v1, 4, 2
    v_mul_u32_u24 v254, 4, v254
    v_add_u32 v16, v16, v254
    v_add_u32 v16, 18688, v16
    v_mov_b32 v208, 0
    v_mov_b32 v209, 0
    v_mov_b32 v210, 0
    v_mov_b32 v211, 0
    v_mov_b32 v212, 0
    v_mov_b32 v213, 0
    v_mov_b32 v214, 0
    v_mov_b32 v215, 0
    v_mov_b32 v216, 0
    v_mov_b32 v217, 0
    v_mov_b32 v218, 0
    v_mov_b32 v219, 0
    s_mov_b64 s[50:51], s[48:49]
    v_mov_b32 v164, 0
    v_mov_b32 v165, 0
    v_mov_b32 v166, 0
    v_mov_b32 v167, 0
    v_mov_b32 v164, 0x3f803f80
    v_mov_b32 v200, s45
    v_mov_b32 v220, 0x3f803f80
    v_mov_b32 v201, s45
    v_mov_b32 v221, 0x3f803f80
    v_mov_b32 v202, s45
    v_mov_b32 v222, 0x3f803f80
    v_mov_b32 v203, s45
    v_mov_b32 v223, 0x3f803f80
    s_waitcnt vmcnt(0)
    ds_read_b64_tr_b16 a[192:193], v242 offset:16384
    ds_read_b64_tr_b16 a[194:195], v242 offset:16896
    ds_read_b64_tr_b16 a[196:197], v242 offset:18432
    ds_read_b64_tr_b16 a[198:199], v242 offset:18944
    ds_read_b64_tr_b16 a[200:201], v242 offset:20480
    ds_read_b64_tr_b16 a[202:203], v242 offset:20992
    ds_read_b64_tr_b16 a[204:205], v242 offset:22528
    ds_read_b64_tr_b16 a[206:207], v242 offset:23040
    ds_read_b64_tr_b16 a[208:209], v242 offset:24576
    ds_read_b64_tr_b16 a[210:211], v242 offset:25088
    ds_read_b64_tr_b16 a[212:213], v242 offset:26624
    ds_read_b64_tr_b16 a[214:215], v242 offset:27136
    ds_read_b64_tr_b16 a[216:217], v242 offset:28672
    ds_read_b64_tr_b16 a[218:219], v242 offset:29184
    ds_read_b64_tr_b16 a[220:221], v242 offset:30720
    ds_read_b64_tr_b16 a[222:223], v242 offset:31232
    ds_read_b64_tr_b16 a[224:225], v243 offset:16384
    ds_read_b64_tr_b16 a[226:227], v243 offset:16896
    ds_read_b64_tr_b16 a[228:229], v243 offset:18432
    ds_read_b64_tr_b16 a[230:231], v243 offset:18944
    ds_read_b64_tr_b16 a[232:233], v243 offset:20480
    ds_read_b64_tr_b16 a[234:235], v243 offset:20992
    ds_read_b64_tr_b16 a[236:237], v243 offset:22528
    ds_read_b64_tr_b16 a[238:239], v243 offset:23040
    ds_read_b64_tr_b16 a[240:241], v243 offset:24576
    ds_read_b64_tr_b16 a[242:243], v243 offset:25088
    ds_read_b64_tr_b16 a[244:245], v243 offset:26624
    ds_read_b64_tr_b16 a[246:247], v243 offset:27136
    ds_read_b64_tr_b16 a[248:249], v243 offset:28672
    ds_read_b64_tr_b16 a[250:251], v243 offset:29184
    ds_read_b64_tr_b16 a[252:253], v243 offset:30720
    ds_read_b64_tr_b16 a[254:255], v243 offset:31232
    s_waitcnt lgkmcnt(0)
    s_barrier
    buffer_load_dwordx4 v[104:107], v15, s[8:11], s42 offen offset:0
    buffer_load_dwordx4 v[120:123], v15, s[8:11], s43 offen offset:0
    buffer_load_dwordx4 v[136:139], v15, s[8:11], s44 offen offset:0
    buffer_load_dwordx4 v[140:143], v15, s[8:11], s44 offen offset:1024
    s_add_u32 s37, s28, 0
    s_bitcmp1_b32 s37, 0
    s_cselect_b32 s4, 0x84000, 0
    s_xor_b32 s34, s35, s4
    s_bitcmp1_b32 s37, 1
    s_cselect_b32 s4, 0x101000, 0
    s_xor_b32 s34, s34, s4
    s_lshr_b32 s37, s37, 2
    s_bitcmp1_b32 s63, s37
    s_cselect_b32 s4, 0x2000, 0
    s_xor_b32 s34, s34, s4
    s_lshl_b32 s37, s37, 21
    s_add_u32 s34, s34, s37
.p2align 6
.step_210:
    s_barrier
    s_setprio 3
    buffer_load_dwordx4 v[24:27], v3, s[8:11], s30 offen offset:0 sc1
    s_setprio 2
    buffer_load_dwordx4 v[28:31], v3, s[8:11], s30 offen offset:1024 sc1
    s_setprio 1
    buffer_load_dwordx4 v[32:35], v3, s[8:11], s30 offen offset:2048 sc1
    s_setprio 0
    buffer_load_dwordx4 v[36:39], v3, s[8:11], s30 offen offset:3072 sc1
    s_call_b64 s[98:99], .gm_208
    v_pk_add_f32 v[40:41], v[40:41], v[42:43]
    v_pk_add_f32 v[42:43], v[44:45], v[46:47]
    ds_write2_b32 v5, v40, v41 offset0:0 offset1:36
    ds_write2_b32 v5, v42, v43 offset0:16 offset1:52
    s_nop 1
    v_pk_add_f32 v[48:49], v[48:49], v[50:51]
    v_pk_add_f32 v[50:51], v[52:53], v[54:55]
    ds_write2_b32 v6, v48, v49 offset0:0 offset1:36
    ds_write2_b32 v6, v50, v51 offset0:16 offset1:52
    s_waitcnt lgkmcnt(2)
    s_barrier
    ds_read_b128 v[72:75], v9 offset:0
    ds_read_b128 v[76:79], v9 offset:2304
    ds_read_b128 v[80:83], v9 offset:16
    ds_read_b128 v[84:87], v9 offset:2320
    v_smfmac_f32_16x16x64_bf16 v[56:59], v[24:27], a[128:135], v2
    v_smfmac_f32_16x16x64_bf16 v[60:63], v[24:27], a[160:167], v2
    s_waitcnt lgkmcnt(4)
    s_barrier
    v_smfmac_f32_16x16x64_bf16 v[56:59], v[28:31], a[136:143], v2
    s_waitcnt lgkmcnt(2)
    v_pk_add_f32 v[72:73], v[72:73], v[76:77]
    v_pk_add_f32 v[74:75], v[74:75], v[78:79]
    v_cvt_pk_bf16_f32 v144, v72, v73
    v_cvt_pk_bf16_f32 v145, v74, v75
    s_waitcnt lgkmcnt(0)
    v_pk_add_f32 v[80:81], v[80:81], v[84:85]
    v_pk_add_f32 v[82:83], v[82:83], v[86:87]
    v_cvt_pk_bf16_f32 v146, v80, v81
    v_cvt_pk_bf16_f32 v147, v82, v83
    s_nop 1
    v_mfma_f32_16x16x32_bf16 v[192:195], v[104:107], v[144:147], 0
    v_mfma_f32_16x16x32_bf16 v[160:163], v[120:123], v[144:147], 0
    v_smfmac_f32_16x16x64_bf16 v[60:63], v[28:31], a[168:175], v2
    v_add_f32_dpp v151, v195, v195 row_ror:8 row_mask:0xf bank_mask:0x3
    v_add_f32_dpp v148, v192, v192 row_ror:8 row_mask:0xf bank_mask:0x3
    v_add_f32_dpp v149, v193, v193 row_ror:8 row_mask:0xf bank_mask:0x3
    v_add_f32_dpp v150, v194, v194 row_ror:8 row_mask:0xf bank_mask:0x3
    v_add_f32_dpp v151, v163, v163 row_ror:8 row_mask:0xf bank_mask:0xc
    v_add_f32_dpp v148, v160, v160 row_ror:8 row_mask:0xf bank_mask:0xc
    v_add_f32_dpp v149, v161, v161 row_ror:8 row_mask:0xf bank_mask:0xc
    v_add_f32_dpp v150, v162, v162 row_ror:8 row_mask:0xf bank_mask:0xc
    v_min_u32 v151, 0xfffffffe, v151
    buffer_store_dwordx4 v[148:151], v246, s[8:11], s30 offen sc1
    v_smfmac_f32_16x16x64_bf16 v[56:59], v[32:35], a[144:151], v2
    v_smfmac_f32_16x16x64_bf16 v[60:63], v[32:35], a[176:183], v2
    v_smfmac_f32_16x16x64_bf16 v[56:59], v[36:39], a[152:159], v2
    v_smfmac_f32_16x16x64_bf16 v[60:63], v[36:39], a[184:191], v2
    v_mov_b32 v40, 0
    v_mov_b32 v41, 0
    v_mov_b32 v42, 0
    v_mov_b32 v43, 0
    v_mov_b32 v44, 0
    v_mov_b32 v45, 0
    v_mov_b32 v46, 0
    v_mov_b32 v47, 0
    v_pk_add_f32 v[56:57], v[56:57], v[58:59]
    v_pk_add_f32 v[58:59], v[60:61], v[62:63]
    v_cvt_pk_bf16_f32 v60, v56, v57
    v_cvt_pk_bf16_f32 v61, v58, v59
    ds_write2_b32 v255, v60, v61 offset0:0 offset1:32
    ds_write_b128 v8, v[56:59]
    s_cmp_eq_u32 s28, 63
    s_cbranch_scc1 .fin_211
    s_waitcnt lgkmcnt(0)
    buffer_load_dwordx4 v[176:179], v13, s[8:11], s30 offen sc1
    buffer_load_dwordx4 v[180:183], v156, s[8:11], s30 offen sc1
    buffer_load_dwordx4 v[184:187], v157, s[8:11], s30 offen sc1
    buffer_load_dwordx4 v[188:191], v158, s[8:11], s30 offen sc1
    s_waitcnt lgkmcnt(0)
    s_barrier
    ds_read_b128 v[212:215], v15 offset:20224
    ds_read_b128 v[216:219], v15 offset:21248
    v_mov_b32 v48, 0
    v_mov_b32 v49, 0
    v_mov_b32 v50, 0
    v_mov_b32 v51, 0
    v_mov_b32 v52, 0
    v_mov_b32 v53, 0
    v_mov_b32 v54, 0
    v_mov_b32 v55, 0
    v_mov_b32 v56, 0
    v_mov_b32 v57, 0
    v_mov_b32 v58, 0
    v_mov_b32 v59, 0
    v_mov_b32 v60, 0
    v_mov_b32 v61, 0
    v_mov_b32 v62, 0
    v_mov_b32 v63, 0
    buffer_load_dwordx4 v[72:75], v13, s[8:11], s30 offen sc1
    buffer_load_dwordx4 v[76:79], v156, s[8:11], s30 offen sc1
    buffer_load_dwordx4 v[80:83], v157, s[8:11], s30 offen sc1
    buffer_load_dwordx4 v[84:87], v158, s[8:11], s30 offen sc1
.mf_212:
    s_waitcnt vmcnt(7)
    v_max3_u32 v18, v176, v177, v178
    v_pk_add_f32 v[196:197], v[176:177], v[178:179]
    s_waitcnt vmcnt(6)
    v_max3_u32 v18, v18, v179, v183
    v_pk_add_f32 v[192:193], v[148:149], v[180:181]
    v_pk_add_f32 v[194:195], v[150:151], v[182:183]
    v_add_f32 v196, v196, v197
    s_waitcnt vmcnt(5)
    v_pk_add_f32 v[192:193], v[192:193], v[184:185]
    v_pk_add_f32 v[194:195], v[194:195], v[186:187]
    s_waitcnt vmcnt(4)
    v_max3_u32 v18, v18, v187, v191
    v_pk_add_f32 v[192:193], v[192:193], v[188:189]
    v_pk_add_f32 v[194:195], v[194:195], v[190:191]
    v_cmp_eq_u32 vcc, -1, v18
    v_max3_f32 v19, v192, v193, v196
    v_max3_f32 v19, v19, v194, v195
    s_cbranch_vccnz .re_213
.sj_214:
    s_nop 0
    v_max_f32_dpp v18, v19, v19 row_ror:8 row_mask:0xf bank_mask:0xf
    v_max_f32_dpp v17, v19, v19 row_ror:8 row_mask:0xf bank_mask:0xf
    s_nop 1
    v_permlane16_swap_b32 v18, v17
    v_max_f32 v19, v18, v17
    v_max_f32 v18, v18, v17
    s_nop 1
    v_permlane32_swap_b32 v18, v19
    v_max_f32 v18, v18, v19
    v_mul_f32 v18, s45, v18
    v_fma_f32 v244, v196, s45, -v18
    v_pk_fma_f32 v[240:241], v[192:193], v[200:201], v[18:19] op_sel_hi:[1,1,0] neg_lo:[0,0,1] neg_hi:[0,0,1]
    v_exp_f32 v244, v244
    v_pk_fma_f32 v[242:243], v[194:195], v[200:201], v[18:19] op_sel_hi:[1,1,0] neg_lo:[0,0,1] neg_hi:[0,0,1]
    v_exp_f32 v240, v240
    v_mov_b32_dpp v245, v244 row_ror:8 row_mask:0xf bank_mask:0xf
    v_cvt_pk_bf16_f32 v208, v244, v245
    v_cvt_pk_bf16_f32 v209, v244, v245
    v_pk_mov_b32 v[210:211], v[208:209], v[208:209] op_sel:[0,1]
    v_exp_f32 v241, v241
    s_waitcnt lgkmcnt(0)
    v_mfma_f32_16x16x32_bf16 v[228:231], v[212:215], v[208:211], 0
    v_exp_f32 v242, v242
    v_mfma_f32_16x16x32_bf16 v[224:227], v[164:167], v[208:211], 0
    v_exp_f32 v243, v243
    v_cvt_pk_bf16_f32 v204, v240, v241
    v_cvt_pk_bf16_f32 v205, v242, v243
    v_mfma_f32_16x16x32_bf16 v[232:235], v[216:219], v[208:211], 0
    v_mov_b32_dpp v206, v204 row_ror:8 row_mask:0xf bank_mask:0xf
    v_mov_b32_dpp v207, v205 row_ror:8 row_mask:0xf bank_mask:0xf
    s_nop 1
    v_mfma_f32_16x16x32_bf16 v[224:227], v[220:223], v[204:207], v[224:227]
    v_mfma_f32_16x16x32_bf16 v[228:231], v[136:139], v[204:207], v[228:231]
    v_mfma_f32_16x16x32_bf16 v[232:235], v[140:143], v[204:207], v[232:235]
    s_mov_b64 exec, s[50:51]
    v_rcp_f32 v18, v224
    s_nop 1
    v_mul_f32 v228, v18, v228
    v_mul_f32 v229, v18, v229
    v_mul_f32 v230, v18, v230
    v_mul_f32 v231, v18, v231
    v_pk_mul_f32 v[232:233], v[18:19], v[232:233] op_sel_hi:[0,1]
    v_pk_mul_f32 v[234:235], v[18:19], v[234:235] op_sel_hi:[0,1]
    v_cvt_pk_bf16_f32 v236, v228, v229
    v_cvt_pk_bf16_f32 v239, v234, v235
    v_cvt_pk_bf16_f32 v237, v230, v231
    v_cvt_pk_bf16_f32 v238, v232, v233
    v_min_u32 v239, 0xfffffffe, v239
    buffer_store_dwordx4 v[236:239], v14, s[8:11], s30 offen sc1
    s_mov_b64 exec, -1
    s_add_u32 s37, s28, 0
    s_bitcmp1_b32 s37, 0
    s_cselect_b32 s4, 0x84000, 0
    s_xor_b32 s34, s35, s4
    s_bitcmp1_b32 s37, 1
    s_cselect_b32 s4, 0x101000, 0
    s_xor_b32 s34, s34, s4
    s_lshr_b32 s37, s37, 2
    s_bitcmp1_b32 s63, s37
    s_cselect_b32 s4, 0x2000, 0
    s_xor_b32 s34, s34, s4
    s_lshl_b32 s37, s37, 21
    s_add_u32 s34, s34, s37
    s_add_u32 s42, s42, 262144
    s_add_u32 s43, s43, 262144
    s_add_u32 s44, s44, 262144
    v_mov_b32 v64, 0
    v_mov_b32 v65, 0
    v_mov_b32 v66, 0
    v_mov_b32 v67, 0
    v_mov_b32 v68, 0
    v_mov_b32 v69, 0
    v_mov_b32 v70, 0
    v_mov_b32 v71, 0
    s_barrier
    s_setprio 3
    buffer_load_dwordx4 v[24:27], v4, s[8:11], s30 offen offset:0 sc1
    s_setprio 2
    buffer_load_dwordx4 v[28:31], v4, s[8:11], s30 offen offset:1024 sc1
    s_setprio 1
    buffer_load_dwordx4 v[32:35], v4, s[8:11], s30 offen offset:2048 sc1
    s_setprio 0
    buffer_load_dwordx4 v[36:39], v4, s[8:11], s30 offen offset:3072 sc1
    s_call_b64 s[98:99], .gm_209
    s_nop 4
    v_pk_add_f32 v[64:65], v[64:65], v[66:67]
    v_cvt_pk_bf16_f32 v66, v64, v65
    v_pk_add_f32 v[68:69], v[68:69], v[70:71]
    v_cvt_pk_bf16_f32 v67, v68, v69
    v_min_u32 v67, 0xfffffffe, v67
    buffer_store_dwordx2 v[66:67], v168, s[8:11], s34 offen sc1
    ds_write2_b32 v7, v64, v65 offset0:0 offset1:36
    ds_write2_b32 v7, v68, v69 offset0:16 offset1:52
    s_waitcnt lgkmcnt(0)
    s_barrier
    buffer_load_dwordx4 v[104:107], v15, s[8:11], s42 offen offset:0
    buffer_load_dwordx4 v[120:123], v15, s[8:11], s43 offen offset:0
    buffer_load_dwordx4 v[136:139], v15, s[8:11], s44 offen offset:0
    buffer_load_dwordx4 v[140:143], v15, s[8:11], s44 offen offset:1024
    s_mov_b32 s4, s30
    s_mov_b32 s30, s31
    s_mov_b32 s31, s32
    s_mov_b32 s32, s33
    s_mov_b32 s33, s4
    s_add_u32 s28, s28, 1
    s_mov_b32 s62, 0
    s_branch .step_210
.fin_211:
    s_waitcnt lgkmcnt(0)
    s_barrier
    s_barrier
    s_endpgm
.re_213:
    buffer_load_dwordx4 v[176:179], v13, s[8:11], s30 offen sc1
    buffer_load_dwordx4 v[180:183], v156, s[8:11], s30 offen sc1
    buffer_load_dwordx4 v[184:187], v157, s[8:11], s30 offen sc1
    buffer_load_dwordx4 v[188:191], v158, s[8:11], s30 offen sc1
    s_waitcnt vmcnt(7)
    v_max3_u32 v18, v72, v73, v74
    v_pk_add_f32 v[196:197], v[72:73], v[74:75]
    s_waitcnt vmcnt(6)
    v_max3_u32 v18, v18, v75, v79
    v_pk_add_f32 v[192:193], v[148:149], v[76:77]
    v_pk_add_f32 v[194:195], v[150:151], v[78:79]
    v_add_f32 v196, v196, v197
    s_waitcnt vmcnt(5)
    v_pk_add_f32 v[192:193], v[192:193], v[80:81]
    v_pk_add_f32 v[194:195], v[194:195], v[82:83]
    s_waitcnt vmcnt(4)
    v_max3_u32 v18, v18, v83, v87
    v_pk_add_f32 v[192:193], v[192:193], v[84:85]
    v_pk_add_f32 v[194:195], v[194:195], v[86:87]
    v_cmp_eq_u32 vcc, -1, v18
    v_max3_f32 v19, v192, v193, v196
    v_max3_f32 v19, v19, v194, v195
    s_cbranch_vccnz .re_215
    s_branch .sj_214
.re_215:
    buffer_load_dwordx4 v[72:75], v13, s[8:11], s30 offen sc1
    buffer_load_dwordx4 v[76:79], v156, s[8:11], s30 offen sc1
    buffer_load_dwordx4 v[80:83], v157, s[8:11], s30 offen sc1
    buffer_load_dwordx4 v[84:87], v158, s[8:11], s30 offen sc1
    s_add_u32 s62, s62, 1
    s_cmp_gt_u32 s62, 0x100000
    s_cbranch_scc1 .mg_end_1
    s_branch .mf_212
.w1_205:
    v_bfe_u32 v254, v1, 4, 1
    v_mul_u32_u24 v168, 1024, v254
    v_bfe_u32 v254, v1, 5, 1
    v_mul_u32_u24 v254, 128, v254
    v_add_u32 v168, v168, v254
    v_bfe_u32 v254, v1, 3, 1
    v_mul_u32_u24 v254, 64, v254
    v_add_u32 v168, v168, v254
    v_bfe_u32 v254, v1, 0, 2
    v_mul_u32_u24 v254, 16, v254
    v_add_u32 v168, v168, v254
    v_bfe_u32 v254, v1, 2, 1
    v_mul_u32_u24 v254, 8, v254
    v_add_u32 v168, v168, v254
    v_add_u32 v168, 256, v168
    v_add_u32 v168, s101, v168
    v_bfe_u32 v254, v1, 0, 1
    v_mul_u32_u24 v17, 2, v254
    v_bfe_u32 v254, v1, 2, 1
    v_mul_u32_u24 v254, 1, v254
    v_add_u32 v17, v17, v254
    v_bfe_u32 v254, v1, 3, 1
    v_mul_u32_u24 v254, 4, v254
    v_add_u32 v17, v17, v254
    v_bfe_u32 v254, v1, 1, 1
    v_mul_u32_u24 v18, 16, v254
    v_mov_b32 v19, 0x3f80
    v_lshlrev_b32 v18, v18, v19
    v_cmp_eq_u32 vcc, 0, v17
    s_nop 1
    v_cndmask_b32 v124, 0, v18, vcc
    v_cmp_eq_u32 vcc, 1, v17
    s_nop 1
    v_cndmask_b32 v125, 0, v18, vcc
    v_cmp_eq_u32 vcc, 2, v17
    s_nop 1
    v_cndmask_b32 v126, 0, v18, vcc
    v_cmp_eq_u32 vcc, 3, v17
    s_nop 1
    v_cndmask_b32 v127, 0, v18, vcc
    v_cmp_eq_u32 vcc, 4, v17
    s_nop 1
    v_cndmask_b32 v128, 0, v18, vcc
    v_cmp_eq_u32 vcc, 5, v17
    s_nop 1
    v_cndmask_b32 v129, 0, v18, vcc
    v_cmp_eq_u32 vcc, 6, v17
    s_nop 1
    v_cndmask_b32 v130, 0, v18, vcc
    v_cmp_eq_u32 vcc, 7, v17
    s_nop 1
    v_cndmask_b32 v131, 0, v18, vcc
    v_bfe_u32 v254, v1, 0, 1
    v_mul_u32_u24 v9, 144, v254
    v_bfe_u32 v254, v1, 1, 1
    v_mul_u32_u24 v254, 576, v254
    v_add_u32 v9, v9, v254
    v_bfe_u32 v254, v1, 2, 1
    v_mul_u32_u24 v254, 288, v254
    v_add_u32 v9, v9, v254
    v_bfe_u32 v254, v1, 3, 1
    v_mul_u32_u24 v254, 1152, v254
    v_add_u32 v9, v9, v254
    v_bfe_u32 v254, v1, 4, 2
    v_mul_u32_u24 v254, 32, v254
    v_add_u32 v9, v9, v254
    v_bfe_u32 v254, v1, 0, 1
    v_mul_u32_u24 v11, 144, v254
    v_bfe_u32 v254, v1, 2, 2
    v_mul_u32_u24 v254, 288, v254
    v_add_u32 v11, v11, v254
    v_bfe_u32 v254, v1, 1, 1
    v_mul_u32_u24 v254, 1152, v254
    v_add_u32 v11, v11, v254
    v_bfe_u32 v254, v1, 4, 2
    v_mul_u32_u24 v254, 32, v254
    v_add_u32 v11, v11, v254
    v_add_u32 v11, 4736, v11
    s_lshl_b32 s4, s56, 10
    s_lshl_b32 s5, s53, 2
    v_bfe_u32 v254, v1, 0, 6
    v_mul_u32_u24 v10, 16, v254
    v_add_u32 v10, 262144, v10
    v_add_u32 v10, s4, v10
    v_add_u32 v10, s5, v10
    v_bfe_u32 v254, v1, 1, 1
    v_mul_u32_u24 v12, 144, v254
    v_bfe_u32 v254, v1, 5, 1
    v_mul_u32_u24 v254, 288, v254
    v_add_u32 v12, v12, v254
    v_bfe_u32 v254, v1, 3, 1
    v_mul_u32_u24 v254, 576, v254
    v_add_u32 v12, v12, v254
    v_bfe_u32 v254, v1, 4, 1
    v_mul_u32_u24 v254, 32, v254
    v_add_u32 v12, v12, v254
    v_bfe_u32 v254, v1, 2, 1
    v_mul_u32_u24 v254, 64, v254
    v_add_u32 v12, v12, v254
    v_bfe_u32 v254, v1, 0, 1
    v_mul_u32_u24 v254, 16, v254
    v_add_u32 v12, v12, v254
    v_add_u32 v12, 9472, v12
    v_bfe_u32 v254, v1, 0, 6
    v_mul_u32_u24 v13, 16, v254
    v_add_u32 v13, s101, v13
    v_bfe_u32 v254, v1, 0, 2
    v_mul_u32_u24 v14, 8, v254
    v_bfe_u32 v254, v1, 4, 1
    v_mul_u32_u24 v254, 32, v254
    v_add_u32 v14, v14, v254
    v_bfe_u32 v254, v1, 3, 1
    v_mul_u32_u24 v254, 64, v254
    v_add_u32 v14, v14, v254
    v_bfe_u32 v254, v1, 5, 1
    v_mul_u32_u24 v254, 128, v254
    v_add_u32 v14, v14, v254
    v_bfe_u32 v254, v1, 2, 1
    v_mul_u32_u24 v254, 256, v254
    v_add_u32 v14, v14, v254
    v_add_u32 v14, s55, v14
    v_xor_b32 v14, 2048, v14
    v_min_u32 v249, 0xfffffffe, v249
    buffer_store_dwordx2 v[248:249], v14, s[8:11], s30 offen sc1
    v_bfe_u32 v254, v1, 0, 6
    v_mul_u32_u24 v15, 16, v254
    s_add_u32 s42, s42, 262144
    s_add_u32 s43, s43, 262144
    s_add_u32 s44, s44, 262144
    s_waitcnt vmcnt(0)
    ds_read_b64_tr_b16 a[192:193], v242 offset:16384
    ds_read_b64_tr_b16 a[194:195], v242 offset:16896
    ds_read_b64_tr_b16 a[196:197], v242 offset:18432
    ds_read_b64_tr_b16 a[198:199], v242 offset:18944
    ds_read_b64_tr_b16 a[200:201], v242 offset:20480
    ds_read_b64_tr_b16 a[202:203], v242 offset:20992
    ds_read_b64_tr_b16 a[204:205], v242 offset:22528
    ds_read_b64_tr_b16 a[206:207], v242 offset:23040
    ds_read_b64_tr_b16 a[208:209], v242 offset:24576
    ds_read_b64_tr_b16 a[210:211], v242 offset:25088
    ds_read_b64_tr_b16 a[212:213], v242 offset:26624
    ds_read_b64_tr_b16 a[214:215], v242 offset:27136
    ds_read_b64_tr_b16 a[216:217], v242 offset:28672
    ds_read_b64_tr_b16 a[218:219], v242 offset:29184
    ds_read_b64_tr_b16 a[220:221], v242 offset:30720
    ds_read_b64_tr_b16 a[222:223], v242 offset:31232
    ds_read_b64_tr_b16 a[224:225], v243 offset:16384
    ds_read_b64_tr_b16 a[226:227], v243 offset:16896
    ds_read_b64_tr_b16 a[228:229], v243 offset:18432
    ds_read_b64_tr_b16 a[230:231], v243 offset:18944
    ds_read_b64_tr_b16 a[232:233], v243 offset:20480
    ds_read_b64_tr_b16 a[234:235], v243 offset:20992
    ds_read_b64_tr_b16 a[236:237], v243 offset:22528
    ds_read_b64_tr_b16 a[238:239], v243 offset:23040
    ds_read_b64_tr_b16 a[240:241], v243 offset:24576
    ds_read_b64_tr_b16 a[242:243], v243 offset:25088
    ds_read_b64_tr_b16 a[244:245], v243 offset:26624
    ds_read_b64_tr_b16 a[246:247], v243 offset:27136
    ds_read_b64_tr_b16 a[248:249], v243 offset:28672
    ds_read_b64_tr_b16 a[250:251], v243 offset:29184
    ds_read_b64_tr_b16 a[252:253], v243 offset:30720
    ds_read_b64_tr_b16 a[254:255], v243 offset:31232
    s_waitcnt lgkmcnt(0)
    s_barrier
    s_add_u32 s37, s28, 0
    s_bitcmp1_b32 s37, 0
    s_cselect_b32 s4, 0x84000, 0
    s_xor_b32 s34, s35, s4
    s_bitcmp1_b32 s37, 1
    s_cselect_b32 s4, 0x101000, 0
    s_xor_b32 s34, s34, s4
    s_lshr_b32 s37, s37, 2
    s_bitcmp1_b32 s63, s37
    s_cselect_b32 s4, 0x2000, 0
    s_xor_b32 s34, s34, s4
    s_lshl_b32 s37, s37, 21
    s_add_u32 s34, s34, s37
.p2align 6
.step_216:
    s_barrier
    s_setprio 3
    buffer_load_dwordx4 v[24:27], v3, s[8:11], s30 offen offset:0 sc1
    s_setprio 2
    buffer_load_dwordx4 v[28:31], v3, s[8:11], s30 offen offset:1024 sc1
    s_setprio 1
    buffer_load_dwordx4 v[32:35], v3, s[8:11], s30 offen offset:2048 sc1
    s_setprio 0
    buffer_load_dwordx4 v[36:39], v3, s[8:11], s30 offen offset:3072 sc1
    s_call_b64 s[98:99], .gm_208
    v_pk_add_f32 v[40:41], v[40:41], v[42:43]
    v_pk_add_f32 v[42:43], v[44:45], v[46:47]
    ds_write2_b32 v5, v40, v41 offset0:0 offset1:36
    ds_write2_b32 v5, v42, v43 offset0:16 offset1:52
    s_nop 1
    v_pk_add_f32 v[48:49], v[48:49], v[50:51]
    v_pk_add_f32 v[50:51], v[52:53], v[54:55]
    ds_write2_b32 v6, v48, v49 offset0:0 offset1:36
    ds_write2_b32 v6, v50, v51 offset0:16 offset1:52
    s_waitcnt lgkmcnt(2)
    s_barrier
    ds_read_b128 v[72:75], v9 offset:0
    ds_read_b128 v[76:79], v9 offset:2304
    ds_read_b128 v[80:83], v9 offset:16
    ds_read_b128 v[84:87], v9 offset:2320
    v_smfmac_f32_16x16x64_bf16 v[56:59], v[24:27], a[128:135], v2
    v_smfmac_f32_16x16x64_bf16 v[60:63], v[24:27], a[160:167], v2
    s_waitcnt lgkmcnt(4)
    s_barrier
    ds_read_b128 v[88:91], v11 offset:0
    ds_read_b128 v[92:95], v11 offset:2304
    ds_read_b128 v[96:99], v11 offset:16
    ds_read_b128 v[100:103], v11 offset:2320
    v_smfmac_f32_16x16x64_bf16 v[56:59], v[28:31], a[136:143], v2
    s_waitcnt lgkmcnt(6)
    v_pk_add_f32 v[72:73], v[72:73], v[76:77]
    v_pk_add_f32 v[74:75], v[74:75], v[78:79]
    v_cvt_pk_bf16_f32 v144, v72, v73
    v_cvt_pk_bf16_f32 v145, v74, v75
    s_waitcnt lgkmcnt(4)
    v_pk_add_f32 v[80:81], v[80:81], v[84:85]
    v_pk_add_f32 v[82:83], v[82:83], v[86:87]
    v_cvt_pk_bf16_f32 v146, v80, v81
    v_cvt_pk_bf16_f32 v147, v82, v83
    s_waitcnt lgkmcnt(2)
    v_pk_add_f32 v[88:89], v[88:89], v[92:93]
    v_pk_add_f32 v[90:91], v[90:91], v[94:95]
    v_cvt_pk_bf16_f32 v148, v88, v89
    v_cvt_pk_bf16_f32 v149, v90, v91
    s_waitcnt lgkmcnt(0)
    v_pk_add_f32 v[96:97], v[96:97], v[100:101]
    v_pk_add_f32 v[98:99], v[98:99], v[102:103]
    v_cvt_pk_bf16_f32 v150, v96, v97
    v_cvt_pk_bf16_f32 v151, v98, v99
    s_nop 1
    v_mfma_f32_16x16x32_bf16 v[196:199], v[148:151], v[144:147], 0
    v_smfmac_f32_16x16x64_bf16 v[60:63], v[28:31], a[168:175], v2
    v_smfmac_f32_16x16x64_bf16 v[56:59], v[32:35], a[144:151], v2
    v_pk_add_f32 v[196:197], v[196:197], v[198:199]
    s_nop 1
    v_add_f32_dpp v198, v196, v196 row_ror:8 row_mask:0xf bank_mask:0xf
    v_add_f32_dpp v199, v197, v197 row_ror:8 row_mask:0xf bank_mask:0xf
    v_cndmask_b32 v198, v199, v198, s[48:49]
    v_min_u32 v198, 0xfffffffe, v198
    buffer_store_dword v198, v10, s[8:11], s30 offen sc1
    v_smfmac_f32_16x16x64_bf16 v[60:63], v[32:35], a[176:183], v2
    v_smfmac_f32_16x16x64_bf16 v[56:59], v[36:39], a[152:159], v2
    v_smfmac_f32_16x16x64_bf16 v[60:63], v[36:39], a[184:191], v2
    v_mov_b32 v40, 0
    v_mov_b32 v41, 0
    v_mov_b32 v42, 0
    v_mov_b32 v43, 0
    v_mov_b32 v44, 0
    v_mov_b32 v45, 0
    v_mov_b32 v46, 0
    v_mov_b32 v47, 0
    v_pk_add_f32 v[56:57], v[56:57], v[58:59]
    v_pk_add_f32 v[58:59], v[60:61], v[62:63]
    v_cvt_pk_bf16_f32 v60, v56, v57
    v_cvt_pk_bf16_f32 v61, v58, v59
    ds_write2_b32 v255, v60, v61 offset0:0 offset1:32
    ds_write_b128 v8, v[56:59]
    s_waitcnt lgkmcnt(0)
    s_barrier
    s_cmp_eq_u32 s28, 63
    s_cbranch_scc1 .fin_217
    s_barrier
    s_setprio 3
    buffer_load_dwordx4 v[24:27], v4, s[8:11], s30 offen offset:0 sc1
    s_setprio 2
    buffer_load_dwordx4 v[28:31], v4, s[8:11], s30 offen offset:1024 sc1
    s_setprio 1
    buffer_load_dwordx4 v[32:35], v4, s[8:11], s30 offen offset:2048 sc1
    s_setprio 0
    buffer_load_dwordx4 v[36:39], v4, s[8:11], s30 offen offset:3072 sc1
    s_call_b64 s[98:99], .gm_209
    s_nop 4
    v_pk_add_f32 v[64:65], v[64:65], v[66:67]
    v_cvt_pk_bf16_f32 v66, v64, v65
    v_pk_add_f32 v[68:69], v[68:69], v[70:71]
    v_cvt_pk_bf16_f32 v67, v68, v69
    v_min_u32 v67, 0xfffffffe, v67
    buffer_store_dwordx2 v[66:67], v168, s[8:11], s34 offen sc1
    ds_write2_b32 v7, v64, v65 offset0:0 offset1:36
    ds_write2_b32 v7, v68, v69 offset0:16 offset1:52
    s_waitcnt lgkmcnt(0)
    s_barrier
    ds_read_b128 v[72:75], v12 offset:0
    ds_read_b128 v[76:79], v12 offset:1152
    ds_read_b128 v[80:83], v12 offset:2304
    ds_read_b128 v[84:87], v12 offset:3456
    s_waitcnt lgkmcnt(2)
    v_pk_add_f32 v[72:73], v[72:73], v[76:77]
    v_pk_add_f32 v[74:75], v[74:75], v[78:79]
    s_waitcnt lgkmcnt(0)
    v_pk_add_f32 v[80:81], v[80:81], v[84:85]
    v_pk_add_f32 v[82:83], v[82:83], v[86:87]
    v_pk_add_f32 v[72:73], v[72:73], v[80:81]
    v_pk_add_f32 v[74:75], v[74:75], v[82:83]
    v_mov_b32 v64, 0
    v_mov_b32 v65, 0
    v_mov_b32 v66, 0
    v_mov_b32 v67, 0
    v_mov_b32 v68, 0
    v_mov_b32 v69, 0
    v_mov_b32 v70, 0
    v_mov_b32 v71, 0
    s_xor_b32 s38, s34, 0x4000
    s_xor_b32 s39, s34, 0x1000
    s_xor_b32 s40, s34, 0x5000
    s_add_u32 s37, s28, 1
    s_bitcmp1_b32 s37, 0
    s_cselect_b32 s4, 0x84000, 0
    s_xor_b32 s34, s35, s4
    s_bitcmp1_b32 s37, 1
    s_cselect_b32 s4, 0x101000, 0
    s_xor_b32 s34, s34, s4
    s_lshr_b32 s37, s37, 2
    s_bitcmp1_b32 s63, s37
    s_cselect_b32 s4, 0x2000, 0
    s_xor_b32 s34, s34, s4
    s_lshl_b32 s37, s37, 21
    s_add_u32 s34, s34, s37
    v_mov_b32 v48, 0
    v_mov_b32 v49, 0
    v_mov_b32 v50, 0
    v_mov_b32 v51, 0
    v_mov_b32 v52, 0
    v_mov_b32 v53, 0
    v_mov_b32 v54, 0
    v_mov_b32 v55, 0
    v_mov_b32 v56, 0
    v_mov_b32 v57, 0
    v_mov_b32 v58, 0
    v_mov_b32 v59, 0
    v_mov_b32 v60, 0
    v_mov_b32 v61, 0
    v_mov_b32 v62, 0
    v_mov_b32 v63, 0
.pl_218:
    buffer_load_dwordx4 v[76:79], v13, s[8:11], s38 offen offset:0 sc1
    buffer_load_dwordx4 v[80:83], v13, s[8:11], s38 offen offset:1024 sc1
    buffer_load_dwordx4 v[84:87], v13, s[8:11], s39 offen offset:0 sc1
    buffer_load_dwordx4 v[88:91], v13, s[8:11], s39 offen offset:1024 sc1
    buffer_load_dwordx4 v[92:95], v13, s[8:11], s40 offen offset:0 sc1
    buffer_load_dwordx4 v[96:99], v13, s[8:11], s40 offen offset:1024 sc1
.pk_221:
    s_waitcnt vmcnt(5)
    v_mfma_f32_16x16x32_bf16 v[108:111], v[76:79], v[124:127], v[72:75]
    v_max_u32 v18, v77, v79
    s_waitcnt vmcnt(4)
    v_mfma_f32_16x16x32_bf16 v[108:111], v[80:83], v[128:131], v[108:111]
    v_max3_u32 v18, v18, v81, v83
    v_cmp_eq_u32 vcc, -1, v18
    s_cbranch_vccnz .pf_222
.pk_223:
    s_waitcnt vmcnt(3)
    v_mfma_f32_16x16x32_bf16 v[112:115], v[84:87], v[124:127], v[108:111]
    v_max_u32 v18, v85, v87
    s_waitcnt vmcnt(2)
    v_mfma_f32_16x16x32_bf16 v[112:115], v[88:91], v[128:131], v[112:115]
    v_max3_u32 v18, v18, v89, v91
    v_cmp_eq_u32 vcc, -1, v18
    s_cbranch_vccnz .pf_224
.pk_225:
    s_waitcnt vmcnt(1)
    v_mfma_f32_16x16x32_bf16 v[100:103], v[92:95], v[124:127], v[112:115]
    v_max_u32 v18, v93, v95
    s_waitcnt vmcnt(0)
    v_mfma_f32_16x16x32_bf16 v[100:103], v[96:99], v[128:131], v[100:103]
    v_max3_u32 v18, v18, v97, v99
    v_cmp_eq_u32 vcc, -1, v18
    s_cbranch_vccnz .pf_226
.pd_220:
    s_nop 4
    v_cvt_pk_bf16_f32 v105, v102, v103
    v_cvt_pk_bf16_f32 v104, v100, v101
    v_min_u32 v105, 0xfffffffe, v105
    buffer_store_dwordx2 v[104:105], v14, s[8:11], s31 offen sc1
    s_mov_b32 s4, s30
    s_mov_b32 s30, s31
    s_mov_b32 s31, s32
    s_mov_b32 s32, s33
    s_mov_b32 s33, s4
    s_add_u32 s28, s28, 1
    s_mov_b32 s62, 0
    s_branch .step_216
.fin_217:
    s_barrier
    s_waitcnt vmcnt(0)
    s_endpgm
.pf_222:
    buffer_load_dwordx4 v[76:79], v13, s[8:11], s38 offen offset:0 sc1
    buffer_load_dwordx4 v[80:83], v13, s[8:11], s38 offen offset:1024 sc1
    s_add_u32 s62, s62, 1
    s_cmp_gt_u32 s62, 0x100000
    s_cbranch_scc1 .mg_end_1
.pk_227:
    s_waitcnt vmcnt(5)
    v_mfma_f32_16x16x32_bf16 v[108:111], v[84:87], v[124:127], v[72:75]
    v_max_u32 v18, v85, v87
    s_waitcnt vmcnt(4)
    v_mfma_f32_16x16x32_bf16 v[108:111], v[88:91], v[128:131], v[108:111]
    v_max3_u32 v18, v18, v89, v91
    v_cmp_eq_u32 vcc, -1, v18
    s_cbranch_vccnz .pf_228
.pk_229:
    s_waitcnt vmcnt(3)
    v_mfma_f32_16x16x32_bf16 v[112:115], v[92:95], v[124:127], v[108:111]
    v_max_u32 v18, v93, v95
    s_waitcnt vmcnt(2)
    v_mfma_f32_16x16x32_bf16 v[112:115], v[96:99], v[128:131], v[112:115]
    v_max3_u32 v18, v18, v97, v99
    v_cmp_eq_u32 vcc, -1, v18
    s_cbranch_vccnz .pf_230
.pk_231:
    s_waitcnt vmcnt(1)
    v_mfma_f32_16x16x32_bf16 v[100:103], v[76:79], v[124:127], v[112:115]
    v_max_u32 v18, v77, v79
    s_waitcnt vmcnt(0)
    v_mfma_f32_16x16x32_bf16 v[100:103], v[80:83], v[128:131], v[100:103]
    v_max3_u32 v18, v18, v81, v83
    v_cmp_eq_u32 vcc, -1, v18
    s_cbranch_vccnz .pf_232
    s_branch .pd_220
.pf_224:
    buffer_load_dwordx4 v[84:87], v13, s[8:11], s39 offen offset:0 sc1
    buffer_load_dwordx4 v[88:91], v13, s[8:11], s39 offen offset:1024 sc1
    s_add_u32 s62, s62, 1
    s_cmp_gt_u32 s62, 0x100000
    s_cbranch_scc1 .mg_end_1
.pk_233:
    s_waitcnt vmcnt(3)
    v_mfma_f32_16x16x32_bf16 v[112:115], v[92:95], v[124:127], v[108:111]
    v_max_u32 v18, v93, v95
    s_waitcnt vmcnt(2)
    v_mfma_f32_16x16x32_bf16 v[112:115], v[96:99], v[128:131], v[112:115]
    v_max3_u32 v18, v18, v97, v99
    v_cmp_eq_u32 vcc, -1, v18
    s_cbranch_vccnz .pf_234
.pk_235:
    s_waitcnt vmcnt(1)
    v_mfma_f32_16x16x32_bf16 v[100:103], v[84:87], v[124:127], v[112:115]
    v_max_u32 v18, v85, v87
    s_waitcnt vmcnt(0)
    v_mfma_f32_16x16x32_bf16 v[100:103], v[88:91], v[128:131], v[100:103]
    v_max3_u32 v18, v18, v89, v91
    v_cmp_eq_u32 vcc, -1, v18
    s_cbranch_vccnz .pf_236
    s_branch .pd_220
.pf_226:
    buffer_load_dwordx4 v[92:95], v13, s[8:11], s40 offen offset:0 sc1
    buffer_load_dwordx4 v[96:99], v13, s[8:11], s40 offen offset:1024 sc1
    s_add_u32 s62, s62, 1
    s_cmp_gt_u32 s62, 0x100000
    s_cbranch_scc1 .mg_end_1
    s_branch .pk_225
.pf_228:
    buffer_load_dwordx4 v[84:87], v13, s[8:11], s39 offen offset:0 sc1
    buffer_load_dwordx4 v[88:91], v13, s[8:11], s39 offen offset:1024 sc1
    s_add_u32 s62, s62, 1
    s_cmp_gt_u32 s62, 0x100000
    s_cbranch_scc1 .mg_end_1
.pk_237:
    s_waitcnt vmcnt(5)
    v_mfma_f32_16x16x32_bf16 v[108:111], v[92:95], v[124:127], v[72:75]
    v_max_u32 v18, v93, v95
    s_waitcnt vmcnt(4)
    v_mfma_f32_16x16x32_bf16 v[108:111], v[96:99], v[128:131], v[108:111]
    v_max3_u32 v18, v18, v97, v99
    v_cmp_eq_u32 vcc, -1, v18
    s_cbranch_vccnz .pf_238
.pk_239:
    s_waitcnt vmcnt(3)
    v_mfma_f32_16x16x32_bf16 v[112:115], v[76:79], v[124:127], v[108:111]
    v_max_u32 v18, v77, v79
    s_waitcnt vmcnt(2)
    v_mfma_f32_16x16x32_bf16 v[112:115], v[80:83], v[128:131], v[112:115]
    v_max3_u32 v18, v18, v81, v83
    v_cmp_eq_u32 vcc, -1, v18
    s_cbranch_vccnz .pf_240
    s_branch .pk_235
.pf_230:
    buffer_load_dwordx4 v[92:95], v13, s[8:11], s40 offen offset:0 sc1
    buffer_load_dwordx4 v[96:99], v13, s[8:11], s40 offen offset:1024 sc1
    s_add_u32 s62, s62, 1
    s_cmp_gt_u32 s62, 0x100000
    s_cbranch_scc1 .mg_end_1
.pk_241:
    s_waitcnt vmcnt(3)
    v_mfma_f32_16x16x32_bf16 v[112:115], v[76:79], v[124:127], v[108:111]
    v_max_u32 v18, v77, v79
    s_waitcnt vmcnt(2)
    v_mfma_f32_16x16x32_bf16 v[112:115], v[80:83], v[128:131], v[112:115]
    v_max3_u32 v18, v18, v81, v83
    v_cmp_eq_u32 vcc, -1, v18
    s_cbranch_vccnz .pf_242
    s_branch .pk_225
.pf_232:
    buffer_load_dwordx4 v[76:79], v13, s[8:11], s38 offen offset:0 sc1
    buffer_load_dwordx4 v[80:83], v13, s[8:11], s38 offen offset:1024 sc1
    s_add_u32 s62, s62, 1
    s_cmp_gt_u32 s62, 0x100000
    s_cbranch_scc1 .mg_end_1
    s_branch .pk_231
.pf_234:
    buffer_load_dwordx4 v[92:95], v13, s[8:11], s40 offen offset:0 sc1
    buffer_load_dwordx4 v[96:99], v13, s[8:11], s40 offen offset:1024 sc1
    s_add_u32 s62, s62, 1
    s_cmp_gt_u32 s62, 0x100000
    s_cbranch_scc1 .mg_end_1
    s_branch .pk_223
.pf_236:
    buffer_load_dwordx4 v[84:87], v13, s[8:11], s39 offen offset:0 sc1
    buffer_load_dwordx4 v[88:91], v13, s[8:11], s39 offen offset:1024 sc1
    s_add_u32 s62, s62, 1
    s_cmp_gt_u32 s62, 0x100000
    s_cbranch_scc1 .mg_end_1
    s_branch .pk_235
.pf_238:
    buffer_load_dwordx4 v[92:95], v13, s[8:11], s40 offen offset:0 sc1
    buffer_load_dwordx4 v[96:99], v13, s[8:11], s40 offen offset:1024 sc1
    s_add_u32 s62, s62, 1
    s_cmp_gt_u32 s62, 0x100000
    s_cbranch_scc1 .mg_end_1
    s_branch .pk_221
.pf_240:
    buffer_load_dwordx4 v[76:79], v13, s[8:11], s38 offen offset:0 sc1
    buffer_load_dwordx4 v[80:83], v13, s[8:11], s38 offen offset:1024 sc1
    s_add_u32 s62, s62, 1
    s_cmp_gt_u32 s62, 0x100000
    s_cbranch_scc1 .mg_end_1
.pk_243:
    s_waitcnt vmcnt(3)
    v_mfma_f32_16x16x32_bf16 v[112:115], v[84:87], v[124:127], v[108:111]
    v_max_u32 v18, v85, v87
    s_waitcnt vmcnt(2)
    v_mfma_f32_16x16x32_bf16 v[112:115], v[88:91], v[128:131], v[112:115]
    v_max3_u32 v18, v18, v89, v91
    v_cmp_eq_u32 vcc, -1, v18
    s_cbranch_vccnz .pf_244
    s_branch .pk_231
.pf_242:
    buffer_load_dwordx4 v[76:79], v13, s[8:11], s38 offen offset:0 sc1
    buffer_load_dwordx4 v[80:83], v13, s[8:11], s38 offen offset:1024 sc1
    s_add_u32 s62, s62, 1
    s_cmp_gt_u32 s62, 0x100000
    s_cbranch_scc1 .mg_end_1
    s_branch .pk_229
.pf_244:
    buffer_load_dwordx4 v[84:87], v13, s[8:11], s39 offen offset:0 sc1
    buffer_load_dwordx4 v[88:91], v13, s[8:11], s39 offen offset:1024 sc1
    s_add_u32 s62, s62, 1
    s_cmp_gt_u32 s62, 0x100000
    s_cbranch_scc1 .mg_end_1
    s_branch .pk_239
.pr_219:
    s_add_u32 s62, s62, 1
    s_cmp_gt_u32 s62, 0x100000
    s_cbranch_scc1 .mg_end_1
    s_branch .pl_218
.w2_206:
    v_bfe_u32 v254, v1, 4, 1
    v_mul_u32_u24 v168, 1024, v254
    v_bfe_u32 v254, v1, 5, 1
    v_mul_u32_u24 v254, 128, v254
    v_add_u32 v168, v168, v254
    v_bfe_u32 v254, v1, 3, 1
    v_mul_u32_u24 v254, 64, v254
    v_add_u32 v168, v168, v254
    v_bfe_u32 v254, v1, 0, 2
    v_mul_u32_u24 v254, 16, v254
    v_add_u32 v168, v168, v254
    v_bfe_u32 v254, v1, 2, 1
    v_mul_u32_u24 v254, 8, v254
    v_add_u32 v168, v168, v254
    v_add_u32 v168, 512, v168
    v_add_u32 v168, s101, v168
    s_lshl_b32 s4, s56, 9
    s_lshl_b32 s5, s53, 7
    s_add_u32 s4, s4, s5
    s_add_u32 s4, s4, 92274688
    v_mov_b32 v14, s4
    v_bfe_u32 v254, v1, 0, 6
    v_mul_u32_u24 v12, 16, v254
    v_add_u32 v12, 18176, v12
    v_bfe_u32 v254, v1, 0, 6
    v_mul_u32_u24 v15, 16, v254
    s_add_u32 s42, s42, 262144
    s_add_u32 s43, s43, 262144
    s_add_u32 s44, s44, 262144
    s_mov_b32 exec_hi, 0
    v_xor_b32 v244, 1024, v244
    s_mov_b32 exec_hi, -1
    s_waitcnt vmcnt(0)
    ds_read_b64_tr_b16 a[192:193], v242 offset:16384
    ds_read_b64_tr_b16 a[194:195], v242 offset:16896
    ds_read_b64_tr_b16 a[196:197], v242 offset:18432
    ds_read_b64_tr_b16 a[198:199], v242 offset:18944
    ds_read_b64_tr_b16 a[200:201], v242 offset:20480
    ds_read_b64_tr_b16 a[202:203], v242 offset:20992
    ds_read_b64_tr_b16 a[204:205], v242 offset:22528
    ds_read_b64_tr_b16 a[206:207], v242 offset:23040
    ds_read_b64_tr_b16 a[208:209], v242 offset:24576
    ds_read_b64_tr_b16 a[210:211], v242 offset:25088
    ds_read_b64_tr_b16 a[212:213], v242 offset:26624
    ds_read_b64_tr_b16 a[214:215], v242 offset:27136
    ds_read_b64_tr_b16 a[216:217], v242 offset:28672
    ds_read_b64_tr_b16 a[218:219], v242 offset:29184
    ds_read_b64_tr_b16 a[220:221], v242 offset:30720
    ds_read_b64_tr_b16 a[222:223], v242 offset:31232
    ds_read_b64_tr_b16 a[224:225], v243 offset:16384
    ds_read_b64_tr_b16 a[226:227], v243 offset:16896
    ds_read_b64_tr_b16 a[228:229], v243 offset:18432
    ds_read_b64_tr_b16 a[230:231], v243 offset:18944
    ds_read_b64_tr_b16 a[232:233], v243 offset:20480
    ds_read_b64_tr_b16 a[234:235], v243 offset:20992
    ds_read_b64_tr_b16 a[236:237], v243 offset:22528
    ds_read_b64_tr_b16 a[238:239], v243 offset:23040
    ds_read_b64_tr_b16 a[240:241], v243 offset:24576
    ds_read_b64_tr_b16 a[242:243], v243 offset:25088
    ds_read_b64_tr_b16 a[244:245], v243 offset:26624
    ds_read_b64_tr_b16 a[246:247], v243 offset:27136
    ds_read_b64_tr_b16 a[248:249], v243 offset:28672
    ds_read_b64_tr_b16 a[250:251], v243 offset:29184
    ds_read_b64_tr_b16 a[252:253], v243 offset:30720
    ds_read_b64_tr_b16 a[254:255], v243 offset:31232
    s_waitcnt lgkmcnt(0)
    s_barrier
.p2align 6
.step_245:
    s_barrier
    s_setprio 3
    buffer_load_dwordx4 v[24:27], v3, s[8:11], s30 offen offset:0 sc1
    s_setprio 2
    buffer_load_dwordx4 v[28:31], v3, s[8:11], s30 offen offset:1024 sc1
    s_setprio 1
    buffer_load_dwordx4 v[32:35], v3, s[8:11], s30 offen offset:2048 sc1
    s_setprio 0
    buffer_load_dwordx4 v[36:39], v3, s[8:11], s30 offen offset:3072 sc1
    s_call_b64 s[98:99], .gm_208
    v_pk_add_f32 v[40:41], v[40:41], v[42:43]
    v_pk_add_f32 v[42:43], v[44:45], v[46:47]
    ds_write2_b32 v5, v40, v41 offset0:0 offset1:36
    ds_write2_b32 v5, v42, v43 offset0:16 offset1:52
    s_nop 1
    v_pk_add_f32 v[48:49], v[48:49], v[50:51]
    v_pk_add_f32 v[50:51], v[52:53], v[54:55]
    ds_write2_b32 v6, v48, v49 offset0:0 offset1:36
    ds_write2_b32 v6, v50, v51 offset0:16 offset1:52
    s_waitcnt lgkmcnt(2)
    s_barrier
    s_waitcnt lgkmcnt(0)
    s_barrier
    v_smfmac_f32_16x16x64_bf16 v[56:59], v[24:27], a[128:135], v2
    v_smfmac_f32_16x16x64_bf16 v[60:63], v[24:27], a[160:167], v2
    v_smfmac_f32_16x16x64_bf16 v[56:59], v[28:31], a[136:143], v2
    v_smfmac_f32_16x16x64_bf16 v[60:63], v[28:31], a[168:175], v2
    v_smfmac_f32_16x16x64_bf16 v[56:59], v[32:35], a[144:151], v2
    v_smfmac_f32_16x16x64_bf16 v[60:63], v[32:35], a[176:183], v2
    v_smfmac_f32_16x16x64_bf16 v[56:59], v[36:39], a[152:159], v2
    v_smfmac_f32_16x16x64_bf16 v[60:63], v[36:39], a[184:191], v2
    ds_read_b64 v[72:73], v9 offset:0
    ds_read_b64 v[74:75], v9 offset:1152
    ds_read_b64 v[76:77], v9 offset:2304
    ds_read_b64 v[78:79], v9 offset:3456
    s_waitcnt lgkmcnt(0)
    v_pk_add_f32 v[72:73], v[72:73], v[74:75]
    v_pk_add_f32 v[76:77], v[76:77], v[78:79]
    v_pk_add_f32 v[72:73], v[72:73], v[76:77]
    v_cvt_pk_bf16_f32 v72, v72, v73
    ds_write_b32 v11, v72
    v_mov_b32 v40, 0
    v_mov_b32 v41, 0
    v_mov_b32 v42, 0
    v_mov_b32 v43, 0
    v_mov_b32 v44, 0
    v_mov_b32 v45, 0
    v_mov_b32 v46, 0
    v_mov_b32 v47, 0
    v_pk_add_f32 v[56:57], v[56:57], v[58:59]
    v_pk_add_f32 v[58:59], v[60:61], v[62:63]
    v_cvt_pk_bf16_f32 v60, v56, v57
    v_cvt_pk_bf16_f32 v61, v58, v59
    ds_write2_b32 v255, v60, v61 offset0:0 offset1:32
    ds_write_b128 v8, v[56:59]
    s_waitcnt lgkmcnt(0)
    s_barrier
    s_cmp_eq_u32 s28, 63
    s_cbranch_scc1 .fin_246
    s_add_u32 s37, s28, 0
    s_bitcmp1_b32 s37, 0
    s_cselect_b32 s4, 0x84000, 0
    s_xor_b32 s34, s35, s4
    s_bitcmp1_b32 s37, 1
    s_cselect_b32 s4, 0x101000, 0
    s_xor_b32 s34, s34, s4
    s_lshr_b32 s37, s37, 2
    s_bitcmp1_b32 s63, s37
    s_cselect_b32 s4, 0x2000, 0
    s_xor_b32 s34, s34, s4
    s_lshl_b32 s37, s37, 21
    s_add_u32 s34, s34, s37
    s_waitcnt lgkmcnt(0)
    v_mov_b32 v48, 0
    v_mov_b32 v49, 0
    v_mov_b32 v50, 0
    v_mov_b32 v51, 0
    v_mov_b32 v52, 0
    v_mov_b32 v53, 0
    v_mov_b32 v54, 0
    v_mov_b32 v55, 0
    v_mov_b32 v56, 0
    v_mov_b32 v57, 0
    v_mov_b32 v58, 0
    v_mov_b32 v59, 0
    v_mov_b32 v60, 0
    v_mov_b32 v61, 0
    v_mov_b32 v62, 0
    v_mov_b32 v63, 0
    s_barrier
    ds_read_b128 v[72:75], v12
    s_setprio 3
    buffer_load_dwordx4 v[24:27], v4, s[8:11], s30 offen offset:0 sc1
    s_setprio 2
    buffer_load_dwordx4 v[28:31], v4, s[8:11], s30 offen offset:1024 sc1
    s_setprio 1
    buffer_load_dwordx4 v[32:35], v4, s[8:11], s30 offen offset:2048 sc1
    s_setprio 0
    buffer_load_dwordx4 v[36:39], v4, s[8:11], s30 offen offset:3072 sc1
    s_call_b64 s[98:99], .gm_209
    s_waitcnt lgkmcnt(0)
    buffer_store_dwordx4 v[72:75], v244, s[8:11], s41 offen sc1
    s_nop 3
    v_pk_add_f32 v[64:65], v[64:65], v[66:67]
    v_cvt_pk_bf16_f32 v66, v64, v65
    v_pk_add_f32 v[68:69], v[68:69], v[70:71]
    v_cvt_pk_bf16_f32 v67, v68, v69
    v_min_u32 v67, 0xfffffffe, v67
    buffer_store_dwordx2 v[66:67], v168, s[8:11], s34 offen sc1
    ds_write2_b32 v7, v64, v65 offset0:0 offset1:36
    ds_write2_b32 v7, v68, v69 offset0:16 offset1:52
    s_waitcnt lgkmcnt(0)
    s_barrier
    s_cmp_lt_u32 s28, 52
    s_cselect_b32 s4, 1, 0
    s_andn2_b32 s4, s4, s28
    s_cbranch_scc1 .nl_247
    v_mov_b32 v18, s28
    v_add_u32 v18, 1, v18
    s_mov_b64 exec, 1
    s_waitcnt vmcnt(0)
    buffer_store_dword v18, v14, s[8:11], 0 offen sc1
    s_mov_b64 exec, -1
.nl_247:
    v_mov_b32 v64, 0
    v_mov_b32 v65, 0
    v_mov_b32 v66, 0
    v_mov_b32 v67, 0
    v_mov_b32 v68, 0
    v_mov_b32 v69, 0
    v_mov_b32 v70, 0
    v_mov_b32 v71, 0
    s_mov_b32 s4, s30
    s_mov_b32 s30, s31
    s_mov_b32 s31, s32
    s_mov_b32 s32, s33
    s_mov_b32 s33, s4
    s_add_u32 s28, s28, 1
    s_mov_b32 s62, 0
    s_add_u32 s41, s41, 0x20000
    s_branch .step_245
.fin_246:
    s_barrier
    s_endpgm
.w3_207:
    v_bfe_u32 v254, v1, 4, 1
    v_mul_u32_u24 v168, 1024, v254
    v_bfe_u32 v254, v1, 5, 1
    v_mul_u32_u24 v254, 128, v254
    v_add_u32 v168, v168, v254
    v_bfe_u32 v254, v1, 3, 1
    v_mul_u32_u24 v254, 64, v254
    v_add_u32 v168, v168, v254
    v_bfe_u32 v254, v1, 0, 2
    v_mul_u32_u24 v254, 16, v254
    v_add_u32 v168, v168, v254
    v_bfe_u32 v254, v1, 2, 1
    v_mul_u32_u24 v254, 8, v254
    v_add_u32 v168, v168, v254
    v_add_u32 v168, 768, v168
    v_add_u32 v168, s101, v168
    v_bfe_u32 v254, v1, 3, 1
    v_mul_u32_u24 v12, 8, v254
    v_bfe_u32 v254, v1, 5, 1
    v_mul_u32_u24 v254, 256, v254
    v_add_u32 v12, v12, v254
    v_bfe_u32 v254, v1, 2, 1
    v_mul_u32_u24 v254, 128, v254
    v_add_u32 v12, v12, v254
    v_bfe_u32 v254, v1, 0, 2
    v_mul_u32_u24 v254, 16, v254
    v_add_u32 v12, v12, v254
    v_bfe_u32 v254, v1, 4, 1
    v_mul_u32_u24 v254, 512, v254
    v_add_u32 v12, v12, v254
    v_add_u32 v12, 14080, v12
    v_bfe_u32 v254, v1, 2, 2
    v_mul_u32_u24 v14, 128, v254
    v_bfe_u32 v254, v1, 0, 2
    v_mul_u32_u24 v254, 16, v254
    v_add_u32 v14, v14, v254
    v_bfe_u32 v254, v1, 4, 2
    v_mul_u32_u24 v254, 4, v254
    v_add_u32 v14, v14, v254
    v_add_u32 v14, 18688, v14
    v_bfe_u32 v254, v1, 0, 6
    v_mul_u32_u24 v15, 16, v254
    v_add_u32 v15, s101, v15
    v_bfe_u32 v254, v1, 2, 2
    v_mul_u32_u24 v16, 128, v254
    v_bfe_u32 v254, v1, 0, 2
    v_mul_u32_u24 v254, 16, v254
    v_add_u32 v16, v16, v254
    v_bfe_u32 v254, v1, 4, 2
    v_mul_u32_u24 v254, 4, v254
    v_add_u32 v16, v16, v254
    v_add_u32 v16, 135168, v16
    v_add_u32 v16, s58, v16
    s_lshl_b32 s4, s56, 9
    s_add_u32 s4, s4, 92291072
    v_bfe_u32 v254, v1, 0, 2
    v_mul_u32_u24 v13, 128, v254
    v_bfe_u32 v254, v1, 2, 1
    v_mul_u32_u24 v254, 16384, v254
    v_add_u32 v13, v13, v254
    v_add_u32 v13, s4, v13
    s_lshl_b32 s4, s56, 9
    s_lshl_b32 s5, s53, 7
    s_add_u32 s4, s4, s5
    s_add_u32 s4, s4, 92274688
    v_mov_b32 v174, s4
    v_bfe_u32 v254, v1, 0, 6
    v_mul_u32_u24 v175, 16, v254
    v_add_u32 v175, 18176, v175
    s_mov_b32 exec_hi, 0
    v_xor_b32 v244, 1024, v244
    s_mov_b32 exec_hi, -1
    s_waitcnt vmcnt(0)
    ds_read_b64_tr_b16 a[192:193], v242 offset:16384
    ds_read_b64_tr_b16 a[194:195], v242 offset:16896
    ds_read_b64_tr_b16 a[196:197], v242 offset:18432
    ds_read_b64_tr_b16 a[198:199], v242 offset:18944
    ds_read_b64_tr_b16 a[200:201], v242 offset:20480
    ds_read_b64_tr_b16 a[202:203], v242 offset:20992
    ds_read_b64_tr_b16 a[204:205], v242 offset:22528
    ds_read_b64_tr_b16 a[206:207], v242 offset:23040
    ds_read_b64_tr_b16 a[208:209], v242 offset:24576
    ds_read_b64_tr_b16 a[210:211], v242 offset:25088
    ds_read_b64_tr_b16 a[212:213], v242 offset:26624
    ds_read_b64_tr_b16 a[214:215], v242 offset:27136
    ds_read_b64_tr_b16 a[216:217], v242 offset:28672
    ds_read_b64_tr_b16 a[218:219], v242 offset:29184
    ds_read_b64_tr_b16 a[220:221], v242 offset:30720
    ds_read_b64_tr_b16 a[222:223], v242 offset:31232
    ds_read_b64_tr_b16 a[224:225], v243 offset:16384
    ds_read_b64_tr_b16 a[226:227], v243 offset:16896
    ds_read_b64_tr_b16 a[228:229], v243 offset:18432
    ds_read_b64_tr_b16 a[230:231], v243 offset:18944
    ds_read_b64_tr_b16 a[232:233], v243 offset:20480
    ds_read_b64_tr_b16 a[234:235], v243 offset:20992
    ds_read_b64_tr_b16 a[236:237], v243 offset:22528
    ds_read_b64_tr_b16 a[238:239], v243 offset:23040
    ds_read_b64_tr_b16 a[240:241], v243 offset:24576
    ds_read_b64_tr_b16 a[242:243], v243 offset:25088
    ds_read_b64_tr_b16 a[244:245], v243 offset:26624
    ds_read_b64_tr_b16 a[246:247], v243 offset:27136
    ds_read_b64_tr_b16 a[248:249], v243 offset:28672
    ds_read_b64_tr_b16 a[250:251], v243 offset:29184
    ds_read_b64_tr_b16 a[252:253], v243 offset:30720
    ds_read_b64_tr_b16 a[254:255], v243 offset:31232
    s_waitcnt lgkmcnt(0)
    s_cmp_ge_u32 s46, 1
    s_cbranch_scc1 .kvd_249
    s_mov_b32 s62, 0
.kv_248:
    buffer_load_dword v18, v13, s[8:11], 0 offen sc1
    s_add_u32 s62, s62, 1
    s_cmp_gt_u32 s62, 0x100000
    s_cbranch_scc1 .mg_end_1
    s_waitcnt vmcnt(0)
    v_min_u32_dpp v18, v18, v18 quad_perm:[1,0,3,2] row_mask:0xf bank_mask:0xf
    s_nop 1
    v_min_u32_dpp v18, v18, v18 quad_perm:[2,3,0,1] row_mask:0xf bank_mask:0xf
    s_nop 1
    v_min_u32_dpp v18, v18, v18 row_half_mirror row_mask:0xf bank_mask:0xf
    s_nop 0
    v_readfirstlane_b32 s46, v18
    s_cmp_lt_u32 s46, 1
    s_cbranch_scc1 .kv_248
.kvd_249:
    s_barrier
.p2align 6
.step_250:
    s_barrier
    s_setprio 3
    buffer_load_dwordx4 v[24:27], v3, s[8:11], s30 offen offset:0 sc1
    s_setprio 2
    buffer_load_dwordx4 v[28:31], v3, s[8:11], s30 offen offset:1024 sc1
    s_setprio 1
    buffer_load_dwordx4 v[32:35], v3, s[8:11], s30 offen offset:2048 sc1
    s_setprio 0
    buffer_load_dwordx4 v[36:39], v3, s[8:11], s30 offen offset:3072 sc1
    s_call_b64 s[98:99], .gm_208
    v_pk_add_f32 v[40:41], v[40:41], v[42:43]
    v_pk_add_f32 v[42:43], v[44:45], v[46:47]
    ds_write2_b32 v5, v40, v41 offset0:0 offset1:36
    ds_write2_b32 v5, v42, v43 offset0:16 offset1:52
    s_nop 1
    v_pk_add_f32 v[48:49], v[48:49], v[50:51]
    v_pk_add_f32 v[50:51], v[52:53], v[54:55]
    ds_write2_b32 v6, v48, v49 offset0:0 offset1:36
    ds_write2_b32 v6, v50, v51 offset0:16 offset1:52
    s_waitcnt lgkmcnt(2)
    s_barrier
    s_waitcnt lgkmcnt(0)
    s_barrier
    v_smfmac_f32_16x16x64_bf16 v[56:59], v[24:27], a[128:135], v2
    v_smfmac_f32_16x16x64_bf16 v[60:63], v[24:27], a[160:167], v2
    v_smfmac_f32_16x16x64_bf16 v[56:59], v[28:31], a[136:143], v2
    v_smfmac_f32_16x16x64_bf16 v[60:63], v[28:31], a[168:175], v2
    v_smfmac_f32_16x16x64_bf16 v[56:59], v[32:35], a[144:151], v2
    v_smfmac_f32_16x16x64_bf16 v[60:63], v[32:35], a[176:183], v2
    v_smfmac_f32_16x16x64_bf16 v[56:59], v[36:39], a[152:159], v2
    v_smfmac_f32_16x16x64_bf16 v[60:63], v[36:39], a[184:191], v2
    ds_read_b64 v[72:73], v9 offset:0
    ds_read_b64 v[74:75], v9 offset:1152
    ds_read_b64 v[76:77], v9 offset:2304
    ds_read_b64 v[78:79], v9 offset:3456
    s_waitcnt lgkmcnt(0)
    v_pk_add_f32 v[72:73], v[72:73], v[74:75]
    v_pk_add_f32 v[76:77], v[76:77], v[78:79]
    v_pk_add_f32 v[72:73], v[72:73], v[76:77]
    v_cvt_pk_bf16_f32 v72, v72, v73
    ds_write_b32 v11, v72
    v_mov_b32 v40, 0
    v_mov_b32 v41, 0
    v_mov_b32 v42, 0
    v_mov_b32 v43, 0
    v_mov_b32 v44, 0
    v_mov_b32 v45, 0
    v_mov_b32 v46, 0
    v_mov_b32 v47, 0
    v_pk_add_f32 v[56:57], v[56:57], v[58:59]
    v_pk_add_f32 v[58:59], v[60:61], v[62:63]
    v_cvt_pk_bf16_f32 v60, v56, v57
    v_cvt_pk_bf16_f32 v61, v58, v59
    ds_write2_b32 v255, v60, v61 offset0:0 offset1:32
    ds_write_b128 v8, v[56:59]
    s_waitcnt lgkmcnt(0)
    s_barrier
    ds_read_b64 v[72:73], v12 offset:0
    ds_read_b64 v[74:75], v12 offset:1024
    ds_read_b64 v[76:77], v12 offset:2048
    ds_read_b64 v[78:79], v12 offset:3072
    ds_read_b64 v[80:81], v12 offset:64
    ds_read_b64 v[82:83], v12 offset:1088
    ds_read_b64 v[84:85], v12 offset:2112
    ds_read_b64 v[86:87], v12 offset:3136
    s_waitcnt lgkmcnt(4)
    v_add_f32 v72, v72, v74
    v_add_f32 v73, v73, v75
    v_add_f32 v76, v76, v78
    v_add_f32 v77, v77, v79
    v_add_f32 v72, v72, v76
    v_add_f32 v73, v73, v77
    v_cvt_pk_bf16_f32 v72, v72, v73
    s_waitcnt lgkmcnt(0)
    v_add_f32 v80, v80, v82
    v_add_f32 v81, v81, v83
    v_add_f32 v84, v84, v86
    v_add_f32 v85, v85, v87
    v_add_f32 v80, v80, v84
    v_add_f32 v81, v81, v85
    v_cvt_pk_bf16_f32 v80, v80, v81
    ds_write_b32 v14, v72
    ds_write_b32 v14, v80 offset:64
    s_waitcnt lgkmcnt(0)
    s_cmp_ge_u32 s28, 62
    s_cbranch_scc1 .ke_252
.kb_253:
    s_cmp_eq_u32 s28, 63
    s_cbranch_scc1 .fin_251
    s_add_u32 s37, s28, 0
    s_bitcmp1_b32 s37, 0
    s_cselect_b32 s4, 0x84000, 0
    s_xor_b32 s34, s35, s4
    s_bitcmp1_b32 s37, 1
    s_cselect_b32 s4, 0x101000, 0
    s_xor_b32 s34, s34, s4
    s_lshr_b32 s37, s37, 2
    s_bitcmp1_b32 s63, s37
    s_cselect_b32 s4, 0x2000, 0
    s_xor_b32 s34, s34, s4
    s_lshl_b32 s37, s37, 21
    s_add_u32 s34, s34, s37
    buffer_store_dwordx4 v[20:23], v246, s[8:11], s32 offen sc1
    buffer_store_dwordx4 v[20:23], v245, s[8:11], s32 offen sc1
    buffer_store_dword v20, v237, s[8:11], s32 offen sc1
    s_add_u32 s5, s28, 2
    s_cmp_ge_u32 s46, s5
    s_cbranch_scc1 .kvd_257
    s_mov_b32 s62, 0
.kv_256:
    buffer_load_dword v18, v13, s[8:11], 0 offen sc1
    s_add_u32 s62, s62, 1
    s_cmp_gt_u32 s62, 0x100000
    s_cbranch_scc1 .mg_end_1
    s_waitcnt vmcnt(0)
    v_min_u32_dpp v18, v18, v18 quad_perm:[1,0,3,2] row_mask:0xf bank_mask:0xf
    s_nop 1
    v_min_u32_dpp v18, v18, v18 quad_perm:[2,3,0,1] row_mask:0xf bank_mask:0xf
    s_nop 1
    v_min_u32_dpp v18, v18, v18 row_half_mirror row_mask:0xf bank_mask:0xf
    s_nop 0
    v_readfirstlane_b32 s46, v18
    s_cmp_lt_u32 s46, s5
    s_cbranch_scc1 .kv_256
.kvd_257:
    v_mov_b32 v48, 0
    v_mov_b32 v49, 0
    v_mov_b32 v50, 0
    v_mov_b32 v51, 0
    v_mov_b32 v52, 0
    v_mov_b32 v53, 0
    v_mov_b32 v54, 0
    v_mov_b32 v55, 0
    v_mov_b32 v56, 0
    v_mov_b32 v57, 0
    v_mov_b32 v58, 0
    v_mov_b32 v59, 0
    v_mov_b32 v60, 0
    v_mov_b32 v61, 0
    v_mov_b32 v62, 0
    v_mov_b32 v63, 0
    s_cmp_ge_u32 s28, 62
    s_cbranch_scc1 .kf_254
.kg_255:
    s_barrier
    s_setprio 3
    buffer_load_dwordx4 v[24:27], v4, s[8:11], s30 offen offset:0 sc1
    s_setprio 2
    buffer_load_dwordx4 v[28:31], v4, s[8:11], s30 offen offset:1024 sc1
    s_setprio 1
    buffer_load_dwordx4 v[32:35], v4, s[8:11], s30 offen offset:2048 sc1
    s_setprio 0
    buffer_load_dwordx4 v[36:39], v4, s[8:11], s30 offen offset:3072 sc1
    s_call_b64 s[98:99], .gm_209
    s_nop 4
    v_pk_add_f32 v[64:65], v[64:65], v[66:67]
    v_cvt_pk_bf16_f32 v66, v64, v65
    v_pk_add_f32 v[68:69], v[68:69], v[70:71]
    v_cvt_pk_bf16_f32 v67, v68, v69
    v_min_u32 v67, 0xfffffffe, v67
    buffer_store_dwordx2 v[66:67], v168, s[8:11], s34 offen sc1
    ds_write2_b32 v7, v64, v65 offset0:0 offset1:36
    ds_write2_b32 v7, v68, v69 offset0:16 offset1:52
    s_waitcnt lgkmcnt(0)
    s_barrier
    s_add_u32 s5, s28, 3
    s_min_u32 s5, s5, 64
    s_cmp_ge_u32 s46, s5
    s_cbranch_scc1 .kvd_259
    s_mov_b32 s62, 0
.kv_258:
    buffer_load_dword v18, v13, s[8:11], 0 offen sc1
    s_add_u32 s62, s62, 1
    s_cmp_gt_u32 s62, 0x100000
    s_cbranch_scc1 .mg_end_1
    s_waitcnt vmcnt(0)
    v_min_u32_dpp v18, v18, v18 quad_perm:[1,0,3,2] row_mask:0xf bank_mask:0xf
    s_nop 1
    v_min_u32_dpp v18, v18, v18 quad_perm:[2,3,0,1] row_mask:0xf bank_mask:0xf
    s_nop 1
    v_min_u32_dpp v18, v18, v18 row_half_mirror row_mask:0xf bank_mask:0xf
    s_nop 0
    v_readfirstlane_b32 s46, v18
.kvd_259:
    v_mov_b32 v64, 0
    v_mov_b32 v65, 0
    v_mov_b32 v66, 0
    v_mov_b32 v67, 0
    v_mov_b32 v68, 0
    v_mov_b32 v69, 0
    v_mov_b32 v70, 0
    v_mov_b32 v71, 0
    s_mov_b32 s4, s30
    s_mov_b32 s30, s31
    s_mov_b32 s31, s32
    s_mov_b32 s32, s33
    s_mov_b32 s33, s4
    s_add_u32 s28, s28, 1
    s_mov_b32 s62, 0
    s_add_u32 s41, s41, 0x20000
    s_branch .step_250
.fin_251:
    s_barrier
    s_add_u32 s4, s28, 1
    v_mov_b32 v18, s4
    s_mov_b64 exec, 1
    s_waitcnt vmcnt(0)
    buffer_store_dword v18, v174, s[8:11], 0 offen sc1
    s_mov_b64 exec, -1
    s_endpgm
.ke_252:
    ds_read_b128 v[72:75], v175
    s_waitcnt lgkmcnt(0)
    buffer_store_dwordx4 v[72:75], v244, s[8:11], s41 offen sc1
    s_branch .kb_253
.kf_254:
    s_add_u32 s4, s28, 1
    v_mov_b32 v18, s4
    s_mov_b64 exec, 1
    s_waitcnt vmcnt(0)
    buffer_store_dword v18, v174, s[8:11], 0 offen sc1
    s_mov_b64 exec, -1
    s_branch .kg_255
.p2align 6
.gm_208:
    s_waitcnt vmcnt(3)
    v_max_u32 v18, v25, v27
    v_cmp_eq_u32 vcc, -1, v18
    s_cbranch_vccnz .nk_260
.ok_261:
    v_smfmac_f32_16x16x64_bf16 v[40:43], v[24:27], a[0:7], v2
    v_smfmac_f32_16x16x64_bf16 v[44:47], v[24:27], a[32:39], v2
    s_waitcnt vmcnt(2)
    v_max_u32 v18, v29, v31
    v_cmp_eq_u32 vcc, -1, v18
    v_smfmac_f32_16x16x64_bf16 v[48:51], v[24:27], a[64:71], v2
    v_smfmac_f32_16x16x64_bf16 v[52:55], v[24:27], a[96:103], v2
    s_cbranch_vccnz .nk_262
.ok_263:
    v_smfmac_f32_16x16x64_bf16 v[40:43], v[28:31], a[8:15], v2
    v_smfmac_f32_16x16x64_bf16 v[44:47], v[28:31], a[40:47], v2
    s_waitcnt vmcnt(1)
    v_max_u32 v18, v33, v35
    v_cmp_eq_u32 vcc, -1, v18
    v_smfmac_f32_16x16x64_bf16 v[48:51], v[28:31], a[72:79], v2
    v_smfmac_f32_16x16x64_bf16 v[52:55], v[28:31], a[104:111], v2
    s_cbranch_vccnz .nk_264
.ok_265:
    v_smfmac_f32_16x16x64_bf16 v[40:43], v[32:35], a[16:23], v2
    v_smfmac_f32_16x16x64_bf16 v[44:47], v[32:35], a[48:55], v2
    s_waitcnt vmcnt(0)
    v_max_u32 v18, v37, v39
    v_cmp_eq_u32 vcc, -1, v18
    v_smfmac_f32_16x16x64_bf16 v[48:51], v[32:35], a[80:87], v2
    v_smfmac_f32_16x16x64_bf16 v[52:55], v[32:35], a[112:119], v2
    s_cbranch_vccnz .nk_266
.ok_267:
    v_smfmac_f32_16x16x64_bf16 v[40:43], v[36:39], a[24:31], v2
    v_smfmac_f32_16x16x64_bf16 v[44:47], v[36:39], a[56:63], v2
    v_smfmac_f32_16x16x64_bf16 v[48:51], v[36:39], a[88:95], v2
    v_smfmac_f32_16x16x64_bf16 v[52:55], v[36:39], a[120:127], v2
    s_setpc_b64 s[98:99]
.nk_260:
    buffer_load_dwordx4 v[24:27], v3, s[8:11], s30 offen offset:0 sc1
    s_add_u32 s62, s62, 1
    s_cmp_gt_u32 s62, 0x100000
    s_cbranch_scc1 .mg_end_1
    s_waitcnt vmcnt(3)
    v_max_u32 v18, v29, v31
    v_cmp_eq_u32 vcc, -1, v18
    s_cbranch_vccnz .nk_268
.ok_269:
    v_smfmac_f32_16x16x64_bf16 v[40:43], v[28:31], a[8:15], v2
    v_smfmac_f32_16x16x64_bf16 v[44:47], v[28:31], a[40:47], v2
    s_waitcnt vmcnt(2)
    v_max_u32 v18, v33, v35
    v_cmp_eq_u32 vcc, -1, v18
    v_smfmac_f32_16x16x64_bf16 v[48:51], v[28:31], a[72:79], v2
    v_smfmac_f32_16x16x64_bf16 v[52:55], v[28:31], a[104:111], v2
    s_cbranch_vccnz .nk_270
.ok_271:
    v_smfmac_f32_16x16x64_bf16 v[40:43], v[32:35], a[16:23], v2
    v_smfmac_f32_16x16x64_bf16 v[44:47], v[32:35], a[48:55], v2
    s_waitcnt vmcnt(1)
    v_max_u32 v18, v37, v39
    v_cmp_eq_u32 vcc, -1, v18
    v_smfmac_f32_16x16x64_bf16 v[48:51], v[32:35], a[80:87], v2
    v_smfmac_f32_16x16x64_bf16 v[52:55], v[32:35], a[112:119], v2
    s_cbranch_vccnz .nk_272
.ok_273:
    v_smfmac_f32_16x16x64_bf16 v[40:43], v[36:39], a[24:31], v2
    v_smfmac_f32_16x16x64_bf16 v[44:47], v[36:39], a[56:63], v2
    s_waitcnt vmcnt(0)
    v_max_u32 v18, v25, v27
    v_cmp_eq_u32 vcc, -1, v18
    v_smfmac_f32_16x16x64_bf16 v[48:51], v[36:39], a[88:95], v2
    v_smfmac_f32_16x16x64_bf16 v[52:55], v[36:39], a[120:127], v2
    s_cbranch_vccnz .nk_274
.ok_275:
    v_smfmac_f32_16x16x64_bf16 v[40:43], v[24:27], a[0:7], v2
    v_smfmac_f32_16x16x64_bf16 v[44:47], v[24:27], a[32:39], v2
    v_smfmac_f32_16x16x64_bf16 v[48:51], v[24:27], a[64:71], v2
    v_smfmac_f32_16x16x64_bf16 v[52:55], v[24:27], a[96:103], v2
    s_setpc_b64 s[98:99]
.nk_262:
    buffer_load_dwordx4 v[28:31], v3, s[8:11], s30 offen offset:1024 sc1
    s_add_u32 s62, s62, 1
    s_cmp_gt_u32 s62, 0x100000
    s_cbranch_scc1 .mg_end_1
    s_waitcnt vmcnt(2)
    v_max_u32 v18, v33, v35
    v_cmp_eq_u32 vcc, -1, v18
    s_cbranch_vccnz .nk_276
.ok_277:
    v_smfmac_f32_16x16x64_bf16 v[40:43], v[32:35], a[16:23], v2
    v_smfmac_f32_16x16x64_bf16 v[44:47], v[32:35], a[48:55], v2
    s_waitcnt vmcnt(1)
    v_max_u32 v18, v37, v39
    v_cmp_eq_u32 vcc, -1, v18
    v_smfmac_f32_16x16x64_bf16 v[48:51], v[32:35], a[80:87], v2
    v_smfmac_f32_16x16x64_bf16 v[52:55], v[32:35], a[112:119], v2
    s_cbranch_vccnz .nk_278
.ok_279:
    v_smfmac_f32_16x16x64_bf16 v[40:43], v[36:39], a[24:31], v2
    v_smfmac_f32_16x16x64_bf16 v[44:47], v[36:39], a[56:63], v2
    s_waitcnt vmcnt(0)
    v_max_u32 v18, v29, v31
    v_cmp_eq_u32 vcc, -1, v18
    v_smfmac_f32_16x16x64_bf16 v[48:51], v[36:39], a[88:95], v2
    v_smfmac_f32_16x16x64_bf16 v[52:55], v[36:39], a[120:127], v2
    s_cbranch_vccnz .nk_280
.ok_281:
    v_smfmac_f32_16x16x64_bf16 v[40:43], v[28:31], a[8:15], v2
    v_smfmac_f32_16x16x64_bf16 v[44:47], v[28:31], a[40:47], v2
    v_smfmac_f32_16x16x64_bf16 v[48:51], v[28:31], a[72:79], v2
    v_smfmac_f32_16x16x64_bf16 v[52:55], v[28:31], a[104:111], v2
    s_setpc_b64 s[98:99]
.nk_264:
    buffer_load_dwordx4 v[32:35], v3, s[8:11], s30 offen offset:2048 sc1
    s_add_u32 s62, s62, 1
    s_cmp_gt_u32 s62, 0x100000
    s_cbranch_scc1 .mg_end_1
    s_waitcnt vmcnt(1)
    v_max_u32 v18, v37, v39
    v_cmp_eq_u32 vcc, -1, v18
    s_cbranch_vccnz .nk_282
.ok_283:
    v_smfmac_f32_16x16x64_bf16 v[40:43], v[36:39], a[24:31], v2
    v_smfmac_f32_16x16x64_bf16 v[44:47], v[36:39], a[56:63], v2
    s_waitcnt vmcnt(0)
    v_max_u32 v18, v33, v35
    v_cmp_eq_u32 vcc, -1, v18
    v_smfmac_f32_16x16x64_bf16 v[48:51], v[36:39], a[88:95], v2
    v_smfmac_f32_16x16x64_bf16 v[52:55], v[36:39], a[120:127], v2
    s_cbranch_vccnz .nk_284
.ok_285:
    v_smfmac_f32_16x16x64_bf16 v[40:43], v[32:35], a[16:23], v2
    v_smfmac_f32_16x16x64_bf16 v[44:47], v[32:35], a[48:55], v2
    v_smfmac_f32_16x16x64_bf16 v[48:51], v[32:35], a[80:87], v2
    v_smfmac_f32_16x16x64_bf16 v[52:55], v[32:35], a[112:119], v2
    s_setpc_b64 s[98:99]
.nk_266:
    buffer_load_dwordx4 v[36:39], v3, s[8:11], s30 offen offset:3072 sc1
    s_add_u32 s62, s62, 1
    s_cmp_gt_u32 s62, 0x100000
    s_cbranch_scc1 .mg_end_1
    s_waitcnt vmcnt(0)
    v_max_u32 v18, v37, v39
    v_cmp_eq_u32 vcc, -1, v18
    s_cbranch_vccnz .nk_266
    s_branch .ok_267
.nk_268:
    buffer_load_dwordx4 v[28:31], v3, s[8:11], s30 offen offset:1024 sc1
    s_add_u32 s62, s62, 1
    s_cmp_gt_u32 s62, 0x100000
    s_cbranch_scc1 .mg_end_1
    s_waitcnt vmcnt(3)
    v_max_u32 v18, v33, v35
    v_cmp_eq_u32 vcc, -1, v18
    s_cbranch_vccnz .nk_286
.ok_287:
    v_smfmac_f32_16x16x64_bf16 v[40:43], v[32:35], a[16:23], v2
    v_smfmac_f32_16x16x64_bf16 v[44:47], v[32:35], a[48:55], v2
    s_waitcnt vmcnt(2)
    v_max_u32 v18, v37, v39
    v_cmp_eq_u32 vcc, -1, v18
    v_smfmac_f32_16x16x64_bf16 v[48:51], v[32:35], a[80:87], v2
    v_smfmac_f32_16x16x64_bf16 v[52:55], v[32:35], a[112:119], v2
    s_cbranch_vccnz .nk_288
.ok_289:
    v_smfmac_f32_16x16x64_bf16 v[40:43], v[36:39], a[24:31], v2
    v_smfmac_f32_16x16x64_bf16 v[44:47], v[36:39], a[56:63], v2
    s_waitcnt vmcnt(1)
    v_max_u32 v18, v25, v27
    v_cmp_eq_u32 vcc, -1, v18
    v_smfmac_f32_16x16x64_bf16 v[48:51], v[36:39], a[88:95], v2
    v_smfmac_f32_16x16x64_bf16 v[52:55], v[36:39], a[120:127], v2
    s_cbranch_vccnz .nk_290
.ok_291:
    v_smfmac_f32_16x16x64_bf16 v[40:43], v[24:27], a[0:7], v2
    v_smfmac_f32_16x16x64_bf16 v[44:47], v[24:27], a[32:39], v2
    s_waitcnt vmcnt(0)
    v_max_u32 v18, v29, v31
    v_cmp_eq_u32 vcc, -1, v18
    v_smfmac_f32_16x16x64_bf16 v[48:51], v[24:27], a[64:71], v2
    v_smfmac_f32_16x16x64_bf16 v[52:55], v[24:27], a[96:103], v2
    s_cbranch_vccnz .nk_280
    s_branch .ok_281
.nk_270:
    buffer_load_dwordx4 v[32:35], v3, s[8:11], s30 offen offset:2048 sc1
    s_add_u32 s62, s62, 1
    s_cmp_gt_u32 s62, 0x100000
    s_cbranch_scc1 .mg_end_1
    s_waitcnt vmcnt(2)
    v_max_u32 v18, v37, v39
    v_cmp_eq_u32 vcc, -1, v18
    s_cbranch_vccnz .nk_292
.ok_293:
    v_smfmac_f32_16x16x64_bf16 v[40:43], v[36:39], a[24:31], v2
    v_smfmac_f32_16x16x64_bf16 v[44:47], v[36:39], a[56:63], v2
    s_waitcnt vmcnt(1)
    v_max_u32 v18, v25, v27
    v_cmp_eq_u32 vcc, -1, v18
    v_smfmac_f32_16x16x64_bf16 v[48:51], v[36:39], a[88:95], v2
    v_smfmac_f32_16x16x64_bf16 v[52:55], v[36:39], a[120:127], v2
    s_cbranch_vccnz .nk_294
.ok_295:
    v_smfmac_f32_16x16x64_bf16 v[40:43], v[24:27], a[0:7], v2
    v_smfmac_f32_16x16x64_bf16 v[44:47], v[24:27], a[32:39], v2
    s_waitcnt vmcnt(0)
    v_max_u32 v18, v33, v35
    v_cmp_eq_u32 vcc, -1, v18
    v_smfmac_f32_16x16x64_bf16 v[48:51], v[24:27], a[64:71], v2
    v_smfmac_f32_16x16x64_bf16 v[52:55], v[24:27], a[96:103], v2
    s_cbranch_vccnz .nk_284
    s_branch .ok_285
.nk_272:
    buffer_load_dwordx4 v[36:39], v3, s[8:11], s30 offen offset:3072 sc1
    s_add_u32 s62, s62, 1
    s_cmp_gt_u32 s62, 0x100000
    s_cbranch_scc1 .mg_end_1
    s_waitcnt vmcnt(1)
    v_max_u32 v18, v25, v27
    v_cmp_eq_u32 vcc, -1, v18
    s_cbranch_vccnz .nk_296
.ok_297:
    v_smfmac_f32_16x16x64_bf16 v[40:43], v[24:27], a[0:7], v2
    v_smfmac_f32_16x16x64_bf16 v[44:47], v[24:27], a[32:39], v2
    s_waitcnt vmcnt(0)
    v_max_u32 v18, v37, v39
    v_cmp_eq_u32 vcc, -1, v18
    v_smfmac_f32_16x16x64_bf16 v[48:51], v[24:27], a[64:71], v2
    v_smfmac_f32_16x16x64_bf16 v[52:55], v[24:27], a[96:103], v2
    s_cbranch_vccnz .nk_266
    s_branch .ok_267
.nk_274:
    buffer_load_dwordx4 v[24:27], v3, s[8:11], s30 offen offset:0 sc1
    s_add_u32 s62, s62, 1
    s_cmp_gt_u32 s62, 0x100000
    s_cbranch_scc1 .mg_end_1
    s_waitcnt vmcnt(0)
    v_max_u32 v18, v25, v27
    v_cmp_eq_u32 vcc, -1, v18
    s_cbranch_vccnz .nk_274
    s_branch .ok_275
.nk_276:
    buffer_load_dwordx4 v[32:35], v3, s[8:11], s30 offen offset:2048 sc1
    s_add_u32 s62, s62, 1
    s_cmp_gt_u32 s62, 0x100000
    s_cbranch_scc1 .mg_end_1
    s_waitcnt vmcnt(2)
    v_max_u32 v18, v37, v39
    v_cmp_eq_u32 vcc, -1, v18
    s_cbranch_vccnz .nk_298
.ok_299:
    v_smfmac_f32_16x16x64_bf16 v[40:43], v[36:39], a[24:31], v2
    v_smfmac_f32_16x16x64_bf16 v[44:47], v[36:39], a[56:63], v2
    s_waitcnt vmcnt(1)
    v_max_u32 v18, v29, v31
    v_cmp_eq_u32 vcc, -1, v18
    v_smfmac_f32_16x16x64_bf16 v[48:51], v[36:39], a[88:95], v2
    v_smfmac_f32_16x16x64_bf16 v[52:55], v[36:39], a[120:127], v2
    s_cbranch_vccnz .nk_300
.ok_301:
    v_smfmac_f32_16x16x64_bf16 v[40:43], v[28:31], a[8:15], v2
    v_smfmac_f32_16x16x64_bf16 v[44:47], v[28:31], a[40:47], v2
    s_waitcnt vmcnt(0)
    v_max_u32 v18, v33, v35
    v_cmp_eq_u32 vcc, -1, v18
    v_smfmac_f32_16x16x64_bf16 v[48:51], v[28:31], a[72:79], v2
    v_smfmac_f32_16x16x64_bf16 v[52:55], v[28:31], a[104:111], v2
    s_cbranch_vccnz .nk_284
    s_branch .ok_285
.nk_278:
    buffer_load_dwordx4 v[36:39], v3, s[8:11], s30 offen offset:3072 sc1
    s_add_u32 s62, s62, 1
    s_cmp_gt_u32 s62, 0x100000
    s_cbranch_scc1 .mg_end_1
    s_waitcnt vmcnt(1)
    v_max_u32 v18, v29, v31
    v_cmp_eq_u32 vcc, -1, v18
    s_cbranch_vccnz .nk_302
.ok_303:
    v_smfmac_f32_16x16x64_bf16 v[40:43], v[28:31], a[8:15], v2
    v_smfmac_f32_16x16x64_bf16 v[44:47], v[28:31], a[40:47], v2
    s_waitcnt vmcnt(0)
    v_max_u32 v18, v37, v39
    v_cmp_eq_u32 vcc, -1, v18
    v_smfmac_f32_16x16x64_bf16 v[48:51], v[28:31], a[72:79], v2
    v_smfmac_f32_16x16x64_bf16 v[52:55], v[28:31], a[104:111], v2
    s_cbranch_vccnz .nk_266
    s_branch .ok_267
.nk_280:
    buffer_load_dwordx4 v[28:31], v3, s[8:11], s30 offen offset:1024 sc1
    s_add_u32 s62, s62, 1
    s_cmp_gt_u32 s62, 0x100000
    s_cbranch_scc1 .mg_end_1
    s_waitcnt vmcnt(0)
    v_max_u32 v18, v29, v31
    v_cmp_eq_u32 vcc, -1, v18
    s_cbranch_vccnz .nk_280
    s_branch .ok_281
.nk_282:
    buffer_load_dwordx4 v[36:39], v3, s[8:11], s30 offen offset:3072 sc1
    s_add_u32 s62, s62, 1
    s_cmp_gt_u32 s62, 0x100000
    s_cbranch_scc1 .mg_end_1
    s_waitcnt vmcnt(1)
    v_max_u32 v18, v33, v35
    v_cmp_eq_u32 vcc, -1, v18
    s_cbranch_vccnz .nk_264
    s_branch .ok_265
.nk_284:
    buffer_load_dwordx4 v[32:35], v3, s[8:11], s30 offen offset:2048 sc1
    s_add_u32 s62, s62, 1
    s_cmp_gt_u32 s62, 0x100000
    s_cbranch_scc1 .mg_end_1
    s_waitcnt vmcnt(0)
    v_max_u32 v18, v33, v35
    v_cmp_eq_u32 vcc, -1, v18
    s_cbranch_vccnz .nk_284
    s_branch .ok_285
.nk_286:
    buffer_load_dwordx4 v[32:35], v3, s[8:11], s30 offen offset:2048 sc1
    s_add_u32 s62, s62, 1
    s_cmp_gt_u32 s62, 0x100000
    s_cbranch_scc1 .mg_end_1
    s_waitcnt vmcnt(3)
    v_max_u32 v18, v37, v39
    v_cmp_eq_u32 vcc, -1, v18
    s_cbranch_vccnz .nk_304
.ok_305:
    v_smfmac_f32_16x16x64_bf16 v[40:43], v[36:39], a[24:31], v2
    v_smfmac_f32_16x16x64_bf16 v[44:47], v[36:39], a[56:63], v2
    s_waitcnt vmcnt(2)
    v_max_u32 v18, v25, v27
    v_cmp_eq_u32 vcc, -1, v18
    v_smfmac_f32_16x16x64_bf16 v[48:51], v[36:39], a[88:95], v2
    v_smfmac_f32_16x16x64_bf16 v[52:55], v[36:39], a[120:127], v2
    s_cbranch_vccnz .nk_306
.ok_307:
    v_smfmac_f32_16x16x64_bf16 v[40:43], v[24:27], a[0:7], v2
    v_smfmac_f32_16x16x64_bf16 v[44:47], v[24:27], a[32:39], v2
    s_waitcnt vmcnt(1)
    v_max_u32 v18, v29, v31
    v_cmp_eq_u32 vcc, -1, v18
    v_smfmac_f32_16x16x64_bf16 v[48:51], v[24:27], a[64:71], v2
    v_smfmac_f32_16x16x64_bf16 v[52:55], v[24:27], a[96:103], v2
    s_cbranch_vccnz .nk_300
    s_branch .ok_301
.nk_288:
    buffer_load_dwordx4 v[36:39], v3, s[8:11], s30 offen offset:3072 sc1
    s_add_u32 s62, s62, 1
    s_cmp_gt_u32 s62, 0x100000
    s_cbranch_scc1 .mg_end_1
    s_waitcnt vmcnt(2)
    v_max_u32 v18, v25, v27
    v_cmp_eq_u32 vcc, -1, v18
    s_cbranch_vccnz .nk_308
.ok_309:
    v_smfmac_f32_16x16x64_bf16 v[40:43], v[24:27], a[0:7], v2
    v_smfmac_f32_16x16x64_bf16 v[44:47], v[24:27], a[32:39], v2
    s_waitcnt vmcnt(1)
    v_max_u32 v18, v29, v31
    v_cmp_eq_u32 vcc, -1, v18
    v_smfmac_f32_16x16x64_bf16 v[48:51], v[24:27], a[64:71], v2
    v_smfmac_f32_16x16x64_bf16 v[52:55], v[24:27], a[96:103], v2
    s_cbranch_vccnz .nk_302
    s_branch .ok_303
.nk_290:
    buffer_load_dwordx4 v[24:27], v3, s[8:11], s30 offen offset:0 sc1
    s_add_u32 s62, s62, 1
    s_cmp_gt_u32 s62, 0x100000
    s_cbranch_scc1 .mg_end_1
    s_waitcnt vmcnt(1)
    v_max_u32 v18, v29, v31
    v_cmp_eq_u32 vcc, -1, v18
    s_cbranch_vccnz .nk_310
.ok_311:
    v_smfmac_f32_16x16x64_bf16 v[40:43], v[28:31], a[8:15], v2
    v_smfmac_f32_16x16x64_bf16 v[44:47], v[28:31], a[40:47], v2
    s_waitcnt vmcnt(0)
    v_max_u32 v18, v25, v27
    v_cmp_eq_u32 vcc, -1, v18
    v_smfmac_f32_16x16x64_bf16 v[48:51], v[28:31], a[72:79], v2
    v_smfmac_f32_16x16x64_bf16 v[52:55], v[28:31], a[104:111], v2
    s_cbranch_vccnz .nk_274
    s_branch .ok_275
.nk_292:
    buffer_load_dwordx4 v[36:39], v3, s[8:11], s30 offen offset:3072 sc1
    s_add_u32 s62, s62, 1
    s_cmp_gt_u32 s62, 0x100000
    s_cbranch_scc1 .mg_end_1
    s_waitcnt vmcnt(2)
    v_max_u32 v18, v25, v27
    v_cmp_eq_u32 vcc, -1, v18
    s_cbranch_vccnz .nk_312
.ok_313:
    v_smfmac_f32_16x16x64_bf16 v[40:43], v[24:27], a[0:7], v2
    v_smfmac_f32_16x16x64_bf16 v[44:47], v[24:27], a[32:39], v2
    s_waitcnt vmcnt(1)
    v_max_u32 v18, v33, v35
    v_cmp_eq_u32 vcc, -1, v18
    v_smfmac_f32_16x16x64_bf16 v[48:51], v[24:27], a[64:71], v2
    v_smfmac_f32_16x16x64_bf16 v[52:55], v[24:27], a[96:103], v2
    s_cbranch_vccnz .nk_264
    s_branch .ok_265
.nk_294:
    buffer_load_dwordx4 v[24:27], v3, s[8:11], s30 offen offset:0 sc1
    s_add_u32 s62, s62, 1
    s_cmp_gt_u32 s62, 0x100000
    s_cbranch_scc1 .mg_end_1
    s_waitcnt vmcnt(1)
    v_max_u32 v18, v33, v35
    v_cmp_eq_u32 vcc, -1, v18
    s_cbranch_vccnz .nk_314
.ok_315:
    v_smfmac_f32_16x16x64_bf16 v[40:43], v[32:35], a[16:23], v2
    v_smfmac_f32_16x16x64_bf16 v[44:47], v[32:35], a[48:55], v2
    s_waitcnt vmcnt(0)
    v_max_u32 v18, v25, v27
    v_cmp_eq_u32 vcc, -1, v18
    v_smfmac_f32_16x16x64_bf16 v[48:51], v[32:35], a[80:87], v2
    v_smfmac_f32_16x16x64_bf16 v[52:55], v[32:35], a[112:119], v2
    s_cbranch_vccnz .nk_274
    s_branch .ok_275
.nk_296:
    buffer_load_dwordx4 v[24:27], v3, s[8:11], s30 offen offset:0 sc1
    s_add_u32 s62, s62, 1
    s_cmp_gt_u32 s62, 0x100000
    s_cbranch_scc1 .mg_end_1
    s_waitcnt vmcnt(1)
    v_max_u32 v18, v37, v39
    v_cmp_eq_u32 vcc, -1, v18
    s_cbranch_vccnz .nk_272
    s_branch .ok_273
.nk_298:
    buffer_load_dwordx4 v[36:39], v3, s[8:11], s30 offen offset:3072 sc1
    s_add_u32 s62, s62, 1
    s_cmp_gt_u32 s62, 0x100000
    s_cbranch_scc1 .mg_end_1
    s_waitcnt vmcnt(2)
    v_max_u32 v18, v29, v31
    v_cmp_eq_u32 vcc, -1, v18
    s_cbranch_vccnz .nk_262
    s_branch .ok_263
.nk_300:
    buffer_load_dwordx4 v[28:31], v3, s[8:11], s30 offen offset:1024 sc1
    s_add_u32 s62, s62, 1
    s_cmp_gt_u32 s62, 0x100000
    s_cbranch_scc1 .mg_end_1
    s_waitcnt vmcnt(1)
    v_max_u32 v18, v33, v35
    v_cmp_eq_u32 vcc, -1, v18
    s_cbranch_vccnz .nk_316
.ok_317:
    v_smfmac_f32_16x16x64_bf16 v[40:43], v[32:35], a[16:23], v2
    v_smfmac_f32_16x16x64_bf16 v[44:47], v[32:35], a[48:55], v2
    s_waitcnt vmcnt(0)
    v_max_u32 v18, v29, v31
    v_cmp_eq_u32 vcc, -1, v18
    v_smfmac_f32_16x16x64_bf16 v[48:51], v[32:35], a[80:87], v2
    v_smfmac_f32_16x16x64_bf16 v[52:55], v[32:35], a[112:119], v2
    s_cbranch_vccnz .nk_280
    s_branch .ok_281
.nk_302:
    buffer_load_dwordx4 v[28:31], v3, s[8:11], s30 offen offset:1024 sc1
    s_add_u32 s62, s62, 1
    s_cmp_gt_u32 s62, 0x100000
    s_cbranch_scc1 .mg_end_1
    s_waitcnt vmcnt(1)
    v_max_u32 v18, v37, v39
    v_cmp_eq_u32 vcc, -1, v18
    s_cbranch_vccnz .nk_278
    s_branch .ok_279
.nk_304:
    buffer_load_dwordx4 v[36:39], v3, s[8:11], s30 offen offset:3072 sc1
    s_add_u32 s62, s62, 1
    s_cmp_gt_u32 s62, 0x100000
    s_cbranch_scc1 .mg_end_1
    s_waitcnt vmcnt(3)
    v_max_u32 v18, v25, v27
    v_cmp_eq_u32 vcc, -1, v18
    s_cbranch_vccnz .nk_260
    s_branch .ok_261
.nk_306:
    buffer_load_dwordx4 v[24:27], v3, s[8:11], s30 offen offset:0 sc1
    s_add_u32 s62, s62, 1
    s_cmp_gt_u32 s62, 0x100000
    s_cbranch_scc1 .mg_end_1
    s_waitcnt vmcnt(2)
    v_max_u32 v18, v29, v31
    v_cmp_eq_u32 vcc, -1, v18
    s_cbranch_vccnz .nk_318
.ok_319:
    v_smfmac_f32_16x16x64_bf16 v[40:43], v[28:31], a[8:15], v2
    v_smfmac_f32_16x16x64_bf16 v[44:47], v[28:31], a[40:47], v2
    s_waitcnt vmcnt(1)
    v_max_u32 v18, v33, v35
    v_cmp_eq_u32 vcc, -1, v18
    v_smfmac_f32_16x16x64_bf16 v[48:51], v[28:31], a[72:79], v2
    v_smfmac_f32_16x16x64_bf16 v[52:55], v[28:31], a[104:111], v2
    s_cbranch_vccnz .nk_314
    s_branch .ok_315
.nk_308:
    buffer_load_dwordx4 v[24:27], v3, s[8:11], s30 offen offset:0 sc1
    s_add_u32 s62, s62, 1
    s_cmp_gt_u32 s62, 0x100000
    s_cbranch_scc1 .mg_end_1
    s_waitcnt vmcnt(2)
    v_max_u32 v18, v29, v31
    v_cmp_eq_u32 vcc, -1, v18
    s_cbranch_vccnz .nk_320
.ok_321:
    v_smfmac_f32_16x16x64_bf16 v[40:43], v[28:31], a[8:15], v2
    v_smfmac_f32_16x16x64_bf16 v[44:47], v[28:31], a[40:47], v2
    s_waitcnt vmcnt(1)
    v_max_u32 v18, v37, v39
    v_cmp_eq_u32 vcc, -1, v18
    v_smfmac_f32_16x16x64_bf16 v[48:51], v[28:31], a[72:79], v2
    v_smfmac_f32_16x16x64_bf16 v[52:55], v[28:31], a[104:111], v2
    s_cbranch_vccnz .nk_272
    s_branch .ok_273
.nk_310:
    buffer_load_dwordx4 v[28:31], v3, s[8:11], s30 offen offset:1024 sc1
    s_add_u32 s62, s62, 1
    s_cmp_gt_u32 s62, 0x100000
    s_cbranch_scc1 .mg_end_1
    s_waitcnt vmcnt(1)
    v_max_u32 v18, v25, v27
    v_cmp_eq_u32 vcc, -1, v18
    s_cbranch_vccnz .nk_290
    s_branch .ok_291
.nk_312:
    buffer_load_dwordx4 v[24:27], v3, s[8:11], s30 offen offset:0 sc1
    s_add_u32 s62, s62, 1
    s_cmp_gt_u32 s62, 0x100000
    s_cbranch_scc1 .mg_end_1
    s_waitcnt vmcnt(2)
    v_max_u32 v18, v33, v35
    v_cmp_eq_u32 vcc, -1, v18
    s_cbranch_vccnz .nk_270
    s_branch .ok_271
.nk_314:
    buffer_load_dwordx4 v[32:35], v3, s[8:11], s30 offen offset:2048 sc1
    s_add_u32 s62, s62, 1
    s_cmp_gt_u32 s62, 0x100000
    s_cbranch_scc1 .mg_end_1
    s_waitcnt vmcnt(1)
    v_max_u32 v18, v25, v27
    v_cmp_eq_u32 vcc, -1, v18
    s_cbranch_vccnz .nk_294
    s_branch .ok_295
.nk_316:
    buffer_load_dwordx4 v[32:35], v3, s[8:11], s30 offen offset:2048 sc1
    s_add_u32 s62, s62, 1
    s_cmp_gt_u32 s62, 0x100000
    s_cbranch_scc1 .mg_end_1
    s_waitcnt vmcnt(1)
    v_max_u32 v18, v29, v31
    v_cmp_eq_u32 vcc, -1, v18
    s_cbranch_vccnz .nk_300
    s_branch .ok_301
.nk_318:
    buffer_load_dwordx4 v[28:31], v3, s[8:11], s30 offen offset:1024 sc1
    s_add_u32 s62, s62, 1
    s_cmp_gt_u32 s62, 0x100000
    s_cbranch_scc1 .mg_end_1
    s_waitcnt vmcnt(2)
    v_max_u32 v18, v33, v35
    v_cmp_eq_u32 vcc, -1, v18
    s_cbranch_vccnz .nk_322
.ok_323:
    v_smfmac_f32_16x16x64_bf16 v[40:43], v[32:35], a[16:23], v2
    v_smfmac_f32_16x16x64_bf16 v[44:47], v[32:35], a[48:55], v2
    s_waitcnt vmcnt(1)
    v_max_u32 v18, v25, v27
    v_cmp_eq_u32 vcc, -1, v18
    v_smfmac_f32_16x16x64_bf16 v[48:51], v[32:35], a[80:87], v2
    v_smfmac_f32_16x16x64_bf16 v[52:55], v[32:35], a[112:119], v2
    s_cbranch_vccnz .nk_290
    s_branch .ok_291
.nk_320:
    buffer_load_dwordx4 v[28:31], v3, s[8:11], s30 offen offset:1024 sc1
    s_add_u32 s62, s62, 1
    s_cmp_gt_u32 s62, 0x100000
    s_cbranch_scc1 .mg_end_1
    s_waitcnt vmcnt(2)
    v_max_u32 v18, v37, v39
    v_cmp_eq_u32 vcc, -1, v18
    s_cbranch_vccnz .nk_288
    s_branch .ok_289
.nk_322:
    buffer_load_dwordx4 v[32:35], v3, s[8:11], s30 offen offset:2048 sc1
    s_add_u32 s62, s62, 1
    s_cmp_gt_u32 s62, 0x100000
    s_cbranch_scc1 .mg_end_1
    s_waitcnt vmcnt(2)
    v_max_u32 v18, v25, v27
    v_cmp_eq_u32 vcc, -1, v18
    s_cbranch_vccnz .nk_306
    s_branch .ok_307
.p2align 6
.gm_209:
    s_waitcnt vmcnt(3)
    v_cmp_eq_u32 vcc, -1, v27
    s_cbranch_vccnz .nk_324
.ok_325:
    v_smfmac_f32_16x16x64_bf16 v[64:67], v[24:27], a[192:199], v2
    s_waitcnt vmcnt(2)
    v_cmp_eq_u32 vcc, -1, v31
    v_smfmac_f32_16x16x64_bf16 v[68:71], v[24:27], a[224:231], v2
    s_cbranch_vccnz .nk_326
.ok_327:
    v_smfmac_f32_16x16x64_bf16 v[64:67], v[28:31], a[200:207], v2
    s_waitcnt vmcnt(1)
    v_cmp_eq_u32 vcc, -1, v35
    v_smfmac_f32_16x16x64_bf16 v[68:71], v[28:31], a[232:239], v2
    s_cbranch_vccnz .nk_328
.ok_329:
    v_smfmac_f32_16x16x64_bf16 v[64:67], v[32:35], a[208:215], v2
    s_waitcnt vmcnt(0)
    v_cmp_eq_u32 vcc, -1, v39
    v_smfmac_f32_16x16x64_bf16 v[68:71], v[32:35], a[240:247], v2
    s_cbranch_vccnz .nk_330
.ok_331:
    v_smfmac_f32_16x16x64_bf16 v[64:67], v[36:39], a[216:223], v2
    v_smfmac_f32_16x16x64_bf16 v[68:71], v[36:39], a[248:255], v2
    s_setpc_b64 s[98:99]
.nk_324:
    buffer_load_dwordx4 v[24:27], v4, s[8:11], s30 offen offset:0 sc1
    s_add_u32 s62, s62, 1
    s_cmp_gt_u32 s62, 0x100000
    s_cbranch_scc1 .mg_end_1
    s_waitcnt vmcnt(3)
    v_cmp_eq_u32 vcc, -1, v31
    s_cbranch_vccnz .nk_332
.ok_333:
    v_smfmac_f32_16x16x64_bf16 v[64:67], v[28:31], a[200:207], v2
    s_waitcnt vmcnt(2)
    v_cmp_eq_u32 vcc, -1, v35
    v_smfmac_f32_16x16x64_bf16 v[68:71], v[28:31], a[232:239], v2
    s_cbranch_vccnz .nk_334
.ok_335:
    v_smfmac_f32_16x16x64_bf16 v[64:67], v[32:35], a[208:215], v2
    s_waitcnt vmcnt(1)
    v_cmp_eq_u32 vcc, -1, v39
    v_smfmac_f32_16x16x64_bf16 v[68:71], v[32:35], a[240:247], v2
    s_cbranch_vccnz .nk_336
.ok_337:
    v_smfmac_f32_16x16x64_bf16 v[64:67], v[36:39], a[216:223], v2
    s_waitcnt vmcnt(0)
    v_cmp_eq_u32 vcc, -1, v27
    v_smfmac_f32_16x16x64_bf16 v[68:71], v[36:39], a[248:255], v2
    s_cbranch_vccnz .nk_338
.ok_339:
    v_smfmac_f32_16x16x64_bf16 v[64:67], v[24:27], a[192:199], v2
    v_smfmac_f32_16x16x64_bf16 v[68:71], v[24:27], a[224:231], v2
    s_setpc_b64 s[98:99]
.nk_326:
    buffer_load_dwordx4 v[28:31], v4, s[8:11], s30 offen offset:1024 sc1
    s_add_u32 s62, s62, 1
    s_cmp_gt_u32 s62, 0x100000
    s_cbranch_scc1 .mg_end_1
    s_waitcnt vmcnt(2)
    v_cmp_eq_u32 vcc, -1, v35
    s_cbranch_vccnz .nk_340
.ok_341:
    v_smfmac_f32_16x16x64_bf16 v[64:67], v[32:35], a[208:215], v2
    s_waitcnt vmcnt(1)
    v_cmp_eq_u32 vcc, -1, v39
    v_smfmac_f32_16x16x64_bf16 v[68:71], v[32:35], a[240:247], v2
    s_cbranch_vccnz .nk_342
.ok_343:
    v_smfmac_f32_16x16x64_bf16 v[64:67], v[36:39], a[216:223], v2
    s_waitcnt vmcnt(0)
    v_cmp_eq_u32 vcc, -1, v31
    v_smfmac_f32_16x16x64_bf16 v[68:71], v[36:39], a[248:255], v2
    s_cbranch_vccnz .nk_344
.ok_345:
    v_smfmac_f32_16x16x64_bf16 v[64:67], v[28:31], a[200:207], v2
    v_smfmac_f32_16x16x64_bf16 v[68:71], v[28:31], a[232:239], v2
    s_setpc_b64 s[98:99]
.nk_328:
    buffer_load_dwordx4 v[32:35], v4, s[8:11], s30 offen offset:2048 sc1
    s_add_u32 s62, s62, 1
    s_cmp_gt_u32 s62, 0x100000
    s_cbranch_scc1 .mg_end_1
    s_waitcnt vmcnt(1)
    v_cmp_eq_u32 vcc, -1, v39
    s_cbranch_vccnz .nk_346
.ok_347:
    v_smfmac_f32_16x16x64_bf16 v[64:67], v[36:39], a[216:223], v2
    s_waitcnt vmcnt(0)
    v_cmp_eq_u32 vcc, -1, v35
    v_smfmac_f32_16x16x64_bf16 v[68:71], v[36:39], a[248:255], v2
    s_cbranch_vccnz .nk_348
.ok_349:
    v_smfmac_f32_16x16x64_bf16 v[64:67], v[32:35], a[208:215], v2
    v_smfmac_f32_16x16x64_bf16 v[68:71], v[32:35], a[240:247], v2
    s_setpc_b64 s[98:99]
.nk_330:
    buffer_load_dwordx4 v[36:39], v4, s[8:11], s30 offen offset:3072 sc1
    s_add_u32 s62, s62, 1
    s_cmp_gt_u32 s62, 0x100000
    s_cbranch_scc1 .mg_end_1
    s_waitcnt vmcnt(0)
    v_cmp_eq_u32 vcc, -1, v39
    s_cbranch_vccnz .nk_330
    s_branch .ok_331
.nk_332:
    buffer_load_dwordx4 v[28:31], v4, s[8:11], s30 offen offset:1024 sc1
    s_add_u32 s62, s62, 1
    s_cmp_gt_u32 s62, 0x100000
    s_cbranch_scc1 .mg_end_1
    s_waitcnt vmcnt(3)
    v_cmp_eq_u32 vcc, -1, v35
    s_cbranch_vccnz .nk_350
.ok_351:
    v_smfmac_f32_16x16x64_bf16 v[64:67], v[32:35], a[208:215], v2
    s_waitcnt vmcnt(2)
    v_cmp_eq_u32 vcc, -1, v39
    v_smfmac_f32_16x16x64_bf16 v[68:71], v[32:35], a[240:247], v2
    s_cbranch_vccnz .nk_352
.ok_353:
    v_smfmac_f32_16x16x64_bf16 v[64:67], v[36:39], a[216:223], v2
    s_waitcnt vmcnt(1)
    v_cmp_eq_u32 vcc, -1, v27
    v_smfmac_f32_16x16x64_bf16 v[68:71], v[36:39], a[248:255], v2
    s_cbranch_vccnz .nk_354
.ok_355:
    v_smfmac_f32_16x16x64_bf16 v[64:67], v[24:27], a[192:199], v2
    s_waitcnt vmcnt(0)
    v_cmp_eq_u32 vcc, -1, v31
    v_smfmac_f32_16x16x64_bf16 v[68:71], v[24:27], a[224:231], v2
    s_cbranch_vccnz .nk_344
    s_branch .ok_345
.nk_334:
    buffer_load_dwordx4 v[32:35], v4, s[8:11], s30 offen offset:2048 sc1
    s_add_u32 s62, s62, 1
    s_cmp_gt_u32 s62, 0x100000
    s_cbranch_scc1 .mg_end_1
    s_waitcnt vmcnt(2)
    v_cmp_eq_u32 vcc, -1, v39
    s_cbranch_vccnz .nk_356
.ok_357:
    v_smfmac_f32_16x16x64_bf16 v[64:67], v[36:39], a[216:223], v2
    s_waitcnt vmcnt(1)
    v_cmp_eq_u32 vcc, -1, v27
    v_smfmac_f32_16x16x64_bf16 v[68:71], v[36:39], a[248:255], v2
    s_cbranch_vccnz .nk_358
.ok_359:
    v_smfmac_f32_16x16x64_bf16 v[64:67], v[24:27], a[192:199], v2
    s_waitcnt vmcnt(0)
    v_cmp_eq_u32 vcc, -1, v35
    v_smfmac_f32_16x16x64_bf16 v[68:71], v[24:27], a[224:231], v2
    s_cbranch_vccnz .nk_348
    s_branch .ok_349
.nk_336:
    buffer_load_dwordx4 v[36:39], v4, s[8:11], s30 offen offset:3072 sc1
    s_add_u32 s62, s62, 1
    s_cmp_gt_u32 s62, 0x100000
    s_cbranch_scc1 .mg_end_1
    s_waitcnt vmcnt(1)
    v_cmp_eq_u32 vcc, -1, v27
    s_cbranch_vccnz .nk_360
.ok_361:
    v_smfmac_f32_16x16x64_bf16 v[64:67], v[24:27], a[192:199], v2
    s_waitcnt vmcnt(0)
    v_cmp_eq_u32 vcc, -1, v39
    v_smfmac_f32_16x16x64_bf16 v[68:71], v[24:27], a[224:231], v2
    s_cbranch_vccnz .nk_330
    s_branch .ok_331
.nk_338:
    buffer_load_dwordx4 v[24:27], v4, s[8:11], s30 offen offset:0 sc1
    s_add_u32 s62, s62, 1
    s_cmp_gt_u32 s62, 0x100000
    s_cbranch_scc1 .mg_end_1
    s_waitcnt vmcnt(0)
    v_cmp_eq_u32 vcc, -1, v27
    s_cbranch_vccnz .nk_338
    s_branch .ok_339
.nk_340:
    buffer_load_dwordx4 v[32:35], v4, s[8:11], s30 offen offset:2048 sc1
    s_add_u32 s62, s62, 1
    s_cmp_gt_u32 s62, 0x100000
    s_cbranch_scc1 .mg_end_1
    s_waitcnt vmcnt(2)
    v_cmp_eq_u32 vcc, -1, v39
    s_cbranch_vccnz .nk_362
.ok_363:
    v_smfmac_f32_16x16x64_bf16 v[64:67], v[36:39], a[216:223], v2
    s_waitcnt vmcnt(1)
    v_cmp_eq_u32 vcc, -1, v31
    v_smfmac_f32_16x16x64_bf16 v[68:71], v[36:39], a[248:255], v2
    s_cbranch_vccnz .nk_364
.ok_365:
    v_smfmac_f32_16x16x64_bf16 v[64:67], v[28:31], a[200:207], v2
    s_waitcnt vmcnt(0)
    v_cmp_eq_u32 vcc, -1, v35
    v_smfmac_f32_16x16x64_bf16 v[68:71], v[28:31], a[232:239], v2
    s_cbranch_vccnz .nk_348
    s_branch .ok_349
.nk_342:
    buffer_load_dwordx4 v[36:39], v4, s[8:11], s30 offen offset:3072 sc1
    s_add_u32 s62, s62, 1
    s_cmp_gt_u32 s62, 0x100000
    s_cbranch_scc1 .mg_end_1
    s_waitcnt vmcnt(1)
    v_cmp_eq_u32 vcc, -1, v31
    s_cbranch_vccnz .nk_366
.ok_367:
    v_smfmac_f32_16x16x64_bf16 v[64:67], v[28:31], a[200:207], v2
    s_waitcnt vmcnt(0)
    v_cmp_eq_u32 vcc, -1, v39
    v_smfmac_f32_16x16x64_bf16 v[68:71], v[28:31], a[232:239], v2
    s_cbranch_vccnz .nk_330
    s_branch .ok_331
.nk_344:
    buffer_load_dwordx4 v[28:31], v4, s[8:11], s30 offen offset:1024 sc1
    s_add_u32 s62, s62, 1
    s_cmp_gt_u32 s62, 0x100000
    s_cbranch_scc1 .mg_end_1
    s_waitcnt vmcnt(0)
    v_cmp_eq_u32 vcc, -1, v31
    s_cbranch_vccnz .nk_344
    s_branch .ok_345
.nk_346:
    buffer_load_dwordx4 v[36:39], v4, s[8:11], s30 offen offset:3072 sc1
    s_add_u32 s62, s62, 1
    s_cmp_gt_u32 s62, 0x100000
    s_cbranch_scc1 .mg_end_1
    s_waitcnt vmcnt(1)
    v_cmp_eq_u32 vcc, -1, v35
    s_cbranch_vccnz .nk_328
    s_branch .ok_329
.nk_348:
    buffer_load_dwordx4 v[32:35], v4, s[8:11], s30 offen offset:2048 sc1
    s_add_u32 s62, s62, 1
    s_cmp_gt_u32 s62, 0x100000
    s_cbranch_scc1 .mg_end_1
    s_waitcnt vmcnt(0)
    v_cmp_eq_u32 vcc, -1, v35
    s_cbranch_vccnz .nk_348
    s_branch .ok_349
.nk_350:
    buffer_load_dwordx4 v[32:35], v4, s[8:11], s30 offen offset:2048 sc1
    s_add_u32 s62, s62, 1
    s_cmp_gt_u32 s62, 0x100000
    s_cbranch_scc1 .mg_end_1
    s_waitcnt vmcnt(3)
    v_cmp_eq_u32 vcc, -1, v39
    s_cbranch_vccnz .nk_368
.ok_369:
    v_smfmac_f32_16x16x64_bf16 v[64:67], v[36:39], a[216:223], v2
    s_waitcnt vmcnt(2)
    v_cmp_eq_u32 vcc, -1, v27
    v_smfmac_f32_16x16x64_bf16 v[68:71], v[36:39], a[248:255], v2
    s_cbranch_vccnz .nk_370
.ok_371:
    v_smfmac_f32_16x16x64_bf16 v[64:67], v[24:27], a[192:199], v2
    s_waitcnt vmcnt(1)
    v_cmp_eq_u32 vcc, -1, v31
    v_smfmac_f32_16x16x64_bf16 v[68:71], v[24:27], a[224:231], v2
    s_cbranch_vccnz .nk_364
    s_branch .ok_365
.nk_352:
    buffer_load_dwordx4 v[36:39], v4, s[8:11], s30 offen offset:3072 sc1
    s_add_u32 s62, s62, 1
    s_cmp_gt_u32 s62, 0x100000
    s_cbranch_scc1 .mg_end_1
    s_waitcnt vmcnt(2)
    v_cmp_eq_u32 vcc, -1, v27
    s_cbranch_vccnz .nk_372
.ok_373:
    v_smfmac_f32_16x16x64_bf16 v[64:67], v[24:27], a[192:199], v2
    s_waitcnt vmcnt(1)
    v_cmp_eq_u32 vcc, -1, v31
    v_smfmac_f32_16x16x64_bf16 v[68:71], v[24:27], a[224:231], v2
    s_cbranch_vccnz .nk_366
    s_branch .ok_367
.nk_354:
    buffer_load_dwordx4 v[24:27], v4, s[8:11], s30 offen offset:0 sc1
    s_add_u32 s62, s62, 1
    s_cmp_gt_u32 s62, 0x100000
    s_cbranch_scc1 .mg_end_1
    s_waitcnt vmcnt(1)
    v_cmp_eq_u32 vcc, -1, v31
    s_cbranch_vccnz .nk_374
.ok_375:
    v_smfmac_f32_16x16x64_bf16 v[64:67], v[28:31], a[200:207], v2
    s_waitcnt vmcnt(0)
    v_cmp_eq_u32 vcc, -1, v27
    v_smfmac_f32_16x16x64_bf16 v[68:71], v[28:31], a[232:239], v2
    s_cbranch_vccnz .nk_338
    s_branch .ok_339
.nk_356:
    buffer_load_dwordx4 v[36:39], v4, s[8:11], s30 offen offset:3072 sc1
    s_add_u32 s62, s62, 1
    s_cmp_gt_u32 s62, 0x100000
    s_cbranch_scc1 .mg_end_1
    s_waitcnt vmcnt(2)
    v_cmp_eq_u32 vcc, -1, v27
    s_cbranch_vccnz .nk_376
.ok_377:
    v_smfmac_f32_16x16x64_bf16 v[64:67], v[24:27], a[192:199], v2
    s_waitcnt vmcnt(1)
    v_cmp_eq_u32 vcc, -1, v35
    v_smfmac_f32_16x16x64_bf16 v[68:71], v[24:27], a[224:231], v2
    s_cbranch_vccnz .nk_328
    s_branch .ok_329
.nk_358:
    buffer_load_dwordx4 v[24:27], v4, s[8:11], s30 offen offset:0 sc1
    s_add_u32 s62, s62, 1
    s_cmp_gt_u32 s62, 0x100000
    s_cbranch_scc1 .mg_end_1
    s_waitcnt vmcnt(1)
    v_cmp_eq_u32 vcc, -1, v35
    s_cbranch_vccnz .nk_378
.ok_379:
    v_smfmac_f32_16x16x64_bf16 v[64:67], v[32:35], a[208:215], v2
    s_waitcnt vmcnt(0)
    v_cmp_eq_u32 vcc, -1, v27
    v_smfmac_f32_16x16x64_bf16 v[68:71], v[32:35], a[240:247], v2
    s_cbranch_vccnz .nk_338
    s_branch .ok_339
.nk_360:
    buffer_load_dwordx4 v[24:27], v4, s[8:11], s30 offen offset:0 sc1
    s_add_u32 s62, s62, 1
    s_cmp_gt_u32 s62, 0x100000
    s_cbranch_scc1 .mg_end_1
    s_waitcnt vmcnt(1)
    v_cmp_eq_u32 vcc, -1, v39
    s_cbranch_vccnz .nk_336
    s_branch .ok_337
.nk_362:
    buffer_load_dwordx4 v[36:39], v4, s[8:11], s30 offen offset:3072 sc1
    s_add_u32 s62, s62, 1
    s_cmp_gt_u32 s62, 0x100000
    s_cbranch_scc1 .mg_end_1
    s_waitcnt vmcnt(2)
    v_cmp_eq_u32 vcc, -1, v31
    s_cbranch_vccnz .nk_326
    s_branch .ok_327
.nk_364:
    buffer_load_dwordx4 v[28:31], v4, s[8:11], s30 offen offset:1024 sc1
    s_add_u32 s62, s62, 1
    s_cmp_gt_u32 s62, 0x100000
    s_cbranch_scc1 .mg_end_1
    s_waitcnt vmcnt(1)
    v_cmp_eq_u32 vcc, -1, v35
    s_cbranch_vccnz .nk_380
.ok_381:
    v_smfmac_f32_16x16x64_bf16 v[64:67], v[32:35], a[208:215], v2
    s_waitcnt vmcnt(0)
    v_cmp_eq_u32 vcc, -1, v31
    v_smfmac_f32_16x16x64_bf16 v[68:71], v[32:35], a[240:247], v2
    s_cbranch_vccnz .nk_344
    s_branch .ok_345
.nk_366:
    buffer_load_dwordx4 v[28:31], v4, s[8:11], s30 offen offset:1024 sc1
    s_add_u32 s62, s62, 1
    s_cmp_gt_u32 s62, 0x100000
    s_cbranch_scc1 .mg_end_1
    s_waitcnt vmcnt(1)
    v_cmp_eq_u32 vcc, -1, v39
    s_cbranch_vccnz .nk_342
    s_branch .ok_343
.nk_368:
    buffer_load_dwordx4 v[36:39], v4, s[8:11], s30 offen offset:3072 sc1
    s_add_u32 s62, s62, 1
    s_cmp_gt_u32 s62, 0x100000
    s_cbranch_scc1 .mg_end_1
    s_waitcnt vmcnt(3)
    v_cmp_eq_u32 vcc, -1, v27
    s_cbranch_vccnz .nk_324
    s_branch .ok_325
.nk_370:
    buffer_load_dwordx4 v[24:27], v4, s[8:11], s30 offen offset:0 sc1
    s_add_u32 s62, s62, 1
    s_cmp_gt_u32 s62, 0x100000
    s_cbranch_scc1 .mg_end_1
    s_waitcnt vmcnt(2)
    v_cmp_eq_u32 vcc, -1, v31
    s_cbranch_vccnz .nk_382
.ok_383:
    v_smfmac_f32_16x16x64_bf16 v[64:67], v[28:31], a[200:207], v2
    s_waitcnt vmcnt(1)
    v_cmp_eq_u32 vcc, -1, v35
    v_smfmac_f32_16x16x64_bf16 v[68:71], v[28:31], a[232:239], v2
    s_cbranch_vccnz .nk_378
    s_branch .ok_379
.nk_372:
    buffer_load_dwordx4 v[24:27], v4, s[8:11], s30 offen offset:0 sc1
    s_add_u32 s62, s62, 1
    s_cmp_gt_u32 s62, 0x100000
    s_cbranch_scc1 .mg_end_1
    s_waitcnt vmcnt(2)
    v_cmp_eq_u32 vcc, -1, v31
    s_cbranch_vccnz .nk_384
.ok_385:
    v_smfmac_f32_16x16x64_bf16 v[64:67], v[28:31], a[200:207], v2
    s_waitcnt vmcnt(1)
    v_cmp_eq_u32 vcc, -1, v39
    v_smfmac_f32_16x16x64_bf16 v[68:71], v[28:31], a[232:239], v2
    s_cbranch_vccnz .nk_336
    s_branch .ok_337
.nk_374:
    buffer_load_dwordx4 v[28:31], v4, s[8:11], s30 offen offset:1024 sc1
    s_add_u32 s62, s62, 1
    s_cmp_gt_u32 s62, 0x100000
    s_cbranch_scc1 .mg_end_1
    s_waitcnt vmcnt(1)
    v_cmp_eq_u32 vcc, -1, v27
    s_cbranch_vccnz .nk_354
    s_branch .ok_355
.nk_376:
    buffer_load_dwordx4 v[24:27], v4, s[8:11], s30 offen offset:0 sc1
    s_add_u32 s62, s62, 1
    s_cmp_gt_u32 s62, 0x100000
    s_cbranch_scc1 .mg_end_1
    s_waitcnt vmcnt(2)
    v_cmp_eq_u32 vcc, -1, v35
    s_cbranch_vccnz .nk_334
    s_branch .ok_335
.nk_378:
    buffer_load_dwordx4 v[32:35], v4, s[8:11], s30 offen offset:2048 sc1
    s_add_u32 s62, s62, 1
    s_cmp_gt_u32 s62, 0x100000
    s_cbranch_scc1 .mg_end_1
    s_waitcnt vmcnt(1)
    v_cmp_eq_u32 vcc, -1, v27
    s_cbranch_vccnz .nk_358
    s_branch .ok_359
.nk_380:
    buffer_load_dwordx4 v[32:35], v4, s[8:11], s30 offen offset:2048 sc1
    s_add_u32 s62, s62, 1
    s_cmp_gt_u32 s62, 0x100000
    s_cbranch_scc1 .mg_end_1
    s_waitcnt vmcnt(1)
    v_cmp_eq_u32 vcc, -1, v31
    s_cbranch_vccnz .nk_364
    s_branch .ok_365
.nk_382:
    buffer_load_dwordx4 v[28:31], v4, s[8:11], s30 offen offset:1024 sc1
    s_add_u32 s62, s62, 1
    s_cmp_gt_u32 s62, 0x100000
    s_cbranch_scc1 .mg_end_1
    s_waitcnt vmcnt(2)
    v_cmp_eq_u32 vcc, -1, v35
    s_cbranch_vccnz .nk_386
.ok_387:
    v_smfmac_f32_16x16x64_bf16 v[64:67], v[32:35], a[208:215], v2
    s_waitcnt vmcnt(1)
    v_cmp_eq_u32 vcc, -1, v27
    v_smfmac_f32_16x16x64_bf16 v[68:71], v[32:35], a[240:247], v2
    s_cbranch_vccnz .nk_354
    s_branch .ok_355
.nk_384:
    buffer_load_dwordx4 v[28:31], v4, s[8:11], s30 offen offset:1024 sc1
    s_add_u32 s62, s62, 1
    s_cmp_gt_u32 s62, 0x100000
    s_cbranch_scc1 .mg_end_1
    s_waitcnt vmcnt(2)
    v_cmp_eq_u32 vcc, -1, v39
    s_cbranch_vccnz .nk_352
    s_branch .ok_353
.nk_386:
    buffer_load_dwordx4 v[32:35], v4, s[8:11], s30 offen offset:2048 sc1
    s_add_u32 s62, s62, 1
    s_cmp_gt_u32 s62, 0x100000
    s_cbranch_scc1 .mg_end_1
    s_waitcnt vmcnt(2)
    v_cmp_eq_u32 vcc, -1, v27
    s_cbranch_vccnz .nk_370
    s_branch .ok_371
.mg_bg_2:
    s_and_b32 s4, s25, 2
    s_xor_b32 s5, s26, 24
    s_and_b32 s5, s5, 24
    s_or_b32 s4, s4, s27
    s_or_b32 s4, s4, s5
    s_cbranch_scc1 .nocal_388
    s_cmp_lg_u32 s24, 3
    s_cbranch_scc1 .calb_389
    s_lshl_b32 s4, s25, 3
    s_and_b32 s4, s4, 8
    s_and_b32 s5, s26, 7
    s_or_b32 s4, s4, s5
    s_lshl_b32 s5, s4, 21
    s_add_u32 s5, s5, s101
    s_mov_b64 exec, 1
    v_mov_b32 v4, -1
    v_mov_b32 v5, 0
    s_mov_b32 s7, 0xffff
    s_mov_b32 s6, 0xffff
    s_memtime s[72:73]
    s_waitcnt lgkmcnt(0)
    buffer_store_dword v4, v5, s[8:11], s5 offen sc1
    s_waitcnt vmcnt(0)
    s_memtime s[74:75]
    s_waitcnt lgkmcnt(0)
    s_sub_u32 s74, s74, s72
    s_min_u32 s7, s7, s74
    v_xor_b32 v5, 0x2000, v5
    s_memtime s[72:73]
    s_waitcnt lgkmcnt(0)
    buffer_store_dword v4, v5, s[8:11], s5 offen sc1
    s_waitcnt vmcnt(0)
    s_memtime s[74:75]
    s_waitcnt lgkmcnt(0)
    s_sub_u32 s74, s74, s72
    s_min_u32 s6, s6, s74
    v_xor_b32 v5, 0x2000, v5
    s_memtime s[72:73]
    s_waitcnt lgkmcnt(0)
    buffer_store_dword v4, v5, s[8:11], s5 offen sc1
    s_waitcnt vmcnt(0)
    s_memtime s[74:75]
    s_waitcnt lgkmcnt(0)
    s_sub_u32 s74, s74, s72
    s_min_u32 s7, s7, s74
    v_xor_b32 v5, 0x2000, v5
    s_memtime s[72:73]
    s_waitcnt lgkmcnt(0)
    buffer_store_dword v4, v5, s[8:11], s5 offen sc1
    s_waitcnt vmcnt(0)
    s_memtime s[74:75]
    s_waitcnt lgkmcnt(0)
    s_sub_u32 s74, s74, s72
    s_min_u32 s6, s6, s74
    v_xor_b32 v5, 0x2000, v5
    s_memtime s[72:73]
    s_waitcnt lgkmcnt(0)
    buffer_store_dword v4, v5, s[8:11], s5 offen sc1
    s_waitcnt vmcnt(0)
    s_memtime s[74:75]
    s_waitcnt lgkmcnt(0)
    s_sub_u32 s74, s74, s72
    s_min_u32 s7, s7, s74
    v_xor_b32 v5, 0x2000, v5
    s_cmp_lt_u32 s6, s7
    s_cselect_b32 s7, 1, 2
    v_mov_b32 v5, 0
    s_lshr_b32 s5, s4, 3
    s_and_b32 s4, s4, 7
    s_lshl_b32 s4, s4, 1
    s_or_b32 s4, s4, s5
    s_lshl_b32 s5, s4, 1
    s_add_u32 s5, s5, 160
    v_mov_b32 v4, s7
    buffer_store_short v4, v5, s[20:23], s5 offen sc1
    s_mov_b64 exec, -1
.calb_389:
    s_barrier
.nocal_388:
    s_lshr_b32 s98, s26, 3
    s_add_u32 s98, s98, 1
    s_and_b32 s98, s98, 3
    s_and_b32 s99, s25, 3
    s_lshl_b32 s99, s99, 3
    s_and_b32 s4, s26, 7
    s_add_u32 s99, s99, s4
    s_mov_b32 s96, 0
    v_and_b32 v1, 63, v0
    v_mov_b32 v250, 0
    v_mov_b32 v251, 0
    s_bitcmp0_b32 s26, 4
    s_cbranch_scc1 .qkv_391
    s_bfe_u32 s95, s26, 0x10003
    s_load_dwordx2 s[40:41], s[0:1], 0
    s_lshl_b32 s4, s95, 3
    s_add_u32 s4, s4, 72
    s_load_dwordx2 s[42:43], s[0:1], s4
    s_lshl_b32 s4, s99, 8
    s_lshl_b32 s6, s24, 14
    s_mul_i32 s5, s24, 524288
    s_add_u32 s4, s4, s5
    v_bfe_u32 v2, v1, 4, 1
    v_lshlrev_b32 v2, 2, v2
    v_and_b32 v3, 7, v1
    v_xor_b32 v2, v2, v3
    v_lshlrev_b32 v2, 4, v2
    v_bfe_u32 v254, v1, 3, 2
    v_mul_u32_u24 v240, 8192, v254
    v_bfe_u32 v254, v1, 5, 1
    v_mul_u32_u24 v254, 128, v254
    v_add_u32 v240, v240, v254
    v_add_u32 v240, s4, v240
    v_add_u32 v240, v2, v240
    s_lshr_b32 s5, s24, 1
    s_lshl_b32 s5, s5, 9
    v_bfe_u32 v2, v1, 3, 1
    v_xor_b32 v2, s24, v2
    v_and_b32 v2, 1, v2
    v_lshlrev_b32 v2, 6, v2
    v_bfe_u32 v254, v1, 4, 2
    v_mul_u32_u24 v242, 2048, v254
    v_bfe_u32 v254, v1, 2, 2
    v_mul_u32_u24 v254, 128, v254
    v_add_u32 v242, v242, v254
    v_bfe_u32 v254, v1, 0, 2
    v_mul_u32_u24 v254, 16, v254
    v_add_u32 v242, v242, v254
    v_add_u32 v242, s5, v242
    v_add_u32 v242, v2, v242
    v_add_u32 v243, 0x10000, v242
    s_waitcnt lgkmcnt(0)
    s_mov_b32 s16, s42
    s_and_b32 s17, s43, 0xffff
    s_mov_b32 s18, 0x800000
    s_mov_b32 s19, 0x00020000
    s_add_u32 m0, s6, 0
    s_mov_b32 s5, 4194304
    buffer_load_dwordx4 v240, s[16:19], s5 offen  lds
    s_add_u32 m0, s6, 1024
    s_mov_b32 s5, 4227072
    buffer_load_dwordx4 v240, s[16:19], s5 offen  lds
    s_add_u32 m0, s6, 2048
    s_mov_b32 s5, 4259840
    buffer_load_dwordx4 v240, s[16:19], s5 offen  lds
    s_add_u32 m0, s6, 3072
    s_mov_b32 s5, 4292608
    buffer_load_dwordx4 v240, s[16:19], s5 offen  lds
    s_add_u32 m0, s6, 4096
    s_mov_b32 s5, 4325376
    buffer_load_dwordx4 v240, s[16:19], s5 offen  lds
    s_add_u32 m0, s6, 5120
    s_mov_b32 s5, 4358144
    buffer_load_dwordx4 v240, s[16:19], s5 offen  lds
    s_add_u32 m0, s6, 6144
    s_mov_b32 s5, 4390912
    buffer_load_dwordx4 v240, s[16:19], s5 offen  lds
    s_add_u32 m0, s6, 7168
    s_mov_b32 s5, 4423680
    buffer_load_dwordx4 v240, s[16:19], s5 offen  lds
    s_add_u32 m0, s6, 8192
    s_mov_b32 s5, 4456448
    buffer_load_dwordx4 v240, s[16:19], s5 offen  lds
    s_add_u32 m0, s6, 9216
    s_mov_b32 s5, 4489216
    buffer_load_dwordx4 v240, s[16:19], s5 offen  lds
    s_add_u32 m0, s6, 10240
    s_mov_b32 s5, 4521984
    buffer_load_dwordx4 v240, s[16:19], s5 offen  lds
    s_add_u32 m0, s6, 11264
    s_mov_b32 s5, 4554752
    buffer_load_dwordx4 v240, s[16:19], s5 offen  lds
    s_add_u32 m0, s6, 12288
    s_mov_b32 s5, 4587520
    buffer_load_dwordx4 v240, s[16:19], s5 offen  lds
    s_add_u32 m0, s6, 13312
    s_mov_b32 s5, 4620288
    buffer_load_dwordx4 v240, s[16:19], s5 offen  lds
    s_add_u32 m0, s6, 14336
    s_mov_b32 s5, 4653056
    buffer_load_dwordx4 v240, s[16:19], s5 offen  lds
    s_add_u32 m0, s6, 15360
    s_mov_b32 s5, 4685824
    buffer_load_dwordx4 v240, s[16:19], s5 offen  lds
    s_waitcnt vmcnt(16)
    s_barrier
    s_cmp_lg_u32 s24, 1
    s_cbranch_scc1 .ns_392
    s_mov_b64 exec, 1
    v_mov_b32 v238, s3
    v_mov_b32 v239, 0
    buffer_atomic_add v238, v239, s[20:23], 0 offen offset:196 sc1
    s_mov_b64 exec, -1
.ns_392:
    s_and_b32 s4, s26, 15
    s_lshl_b32 s4, s4, 2
    s_add_u32 s4, s4, s24
    s_lshl_b32 s5, s4, 13
    v_lshlrev_b32 v6, 7, v1
    s_waitcnt lgkmcnt(0)
    s_mov_b32 s12, s40
    s_and_b32 s13, s41, 0xffff
    s_mov_b32 s14, 0x400000
    s_mov_b32 s15, 0x00020000
    buffer_load_dword v7, v6, s[12:15], s5 offen
    s_and_b32 s5, s25, 3
    s_lshl_b32 s5, s5, 6
    s_add_u32 s4, s4, s5
    s_lshl_b32 s4, s4, 14
    s_add_u32 s4, s4, 0x80000
    v_add_u32 v6, s4, v6
    v_add_u32 v8, 0x2000, v6
    s_add_u32 m0, s6, 65536
    s_mov_b32 s5, 6291456
    buffer_load_dwordx4 v240, s[16:19], s5 offen  lds
    s_add_u32 m0, s6, 66560
    s_mov_b32 s5, 6324224
    buffer_load_dwordx4 v240, s[16:19], s5 offen  lds
    s_add_u32 m0, s6, 67584
    s_mov_b32 s5, 6356992
    buffer_load_dwordx4 v240, s[16:19], s5 offen  lds
    s_add_u32 m0, s6, 68608
    s_mov_b32 s5, 6389760
    buffer_load_dwordx4 v240, s[16:19], s5 offen  lds
    s_add_u32 m0, s6, 69632
    s_mov_b32 s5, 6422528
    buffer_load_dwordx4 v240, s[16:19], s5 offen  lds
    s_add_u32 m0, s6, 70656
    s_mov_b32 s5, 6455296
    buffer_load_dwordx4 v240, s[16:19], s5 offen  lds
    s_add_u32 m0, s6, 71680
    s_mov_b32 s5, 6488064
    buffer_load_dwordx4 v240, s[16:19], s5 offen  lds
    s_add_u32 m0, s6, 72704
    s_mov_b32 s5, 6520832
    buffer_load_dwordx4 v240, s[16:19], s5 offen  lds
    s_add_u32 m0, s6, 73728
    s_mov_b32 s5, 6553600
    buffer_load_dwordx4 v240, s[16:19], s5 offen  lds
    s_add_u32 m0, s6, 74752
    s_mov_b32 s5, 6586368
    buffer_load_dwordx4 v240, s[16:19], s5 offen  lds
    s_add_u32 m0, s6, 75776
    s_mov_b32 s5, 6619136
    buffer_load_dwordx4 v240, s[16:19], s5 offen  lds
    s_add_u32 m0, s6, 76800
    s_mov_b32 s5, 6651904
    buffer_load_dwordx4 v240, s[16:19], s5 offen  lds
    s_add_u32 m0, s6, 77824
    s_mov_b32 s5, 6684672
    buffer_load_dwordx4 v240, s[16:19], s5 offen  lds
    s_add_u32 m0, s6, 78848
    s_mov_b32 s5, 6717440
    buffer_load_dwordx4 v240, s[16:19], s5 offen  lds
    s_add_u32 m0, s6, 79872
    s_mov_b32 s5, 6750208
    buffer_load_dwordx4 v240, s[16:19], s5 offen  lds
    s_add_u32 m0, s6, 80896
    s_mov_b32 s5, 6782976
    buffer_load_dwordx4 v240, s[16:19], s5 offen  lds
    s_cmp_lg_u32 s24, 0
    s_cbranch_scc1 .aw_393
    s_mov_b32 s62, 0
.aw_394:
    s_sleep 64
    s_add_u32 s62, s62, 1
    s_cmp_gt_u32 s62, 0x200000
    s_cbranch_scc1 .mg_end_1
    v_or_b32 v239, 32, v1
    v_lshlrev_b32 v239, 2, v239
    buffer_load_dword v238, v239, s[20:23], 0 offen sc1
    s_waitcnt vmcnt(0)
    v_readlane_b32 s4, v238, 49
    s_and_b32 s5, s4, 0xffff
    s_cmp_lt_u32 s5, 256
    s_cbranch_scc1 .aw_394
    s_lshr_b32 s4, s4, 16
    s_cbranch_scc1 .aw_393
    s_and_b32 s4, s99, 30
    s_lshl_b32 s4, s4, 9
    s_lshl_b32 s5, s95, 14
    s_add_u32 s4, s4, s5
    s_and_b32 s5, s99, 1
    s_lshl_b32 s5, s5, 7
    s_add_u32 s4, s4, s5
    s_lshl_b32 s4, s99, 9
    s_add_u32 s4, s4, 92291072
    v_mov_b32 v5, 0
    s_mov_b32 s62, 0
.aw_395:
    buffer_load_dword v4, v5, s[8:11], s4 offen sc1
    s_add_u32 s62, s62, 1
    s_cmp_gt_u32 s62, 0x200000
    s_cbranch_scc1 .mg_end_1
    s_waitcnt vmcnt(0)
    v_readfirstlane_b32 s5, v4
    s_mul_i32 s7, s95, 5
    s_add_u32 s5, s5, s7
    s_cmp_ge_u32 s5, 5
    s_cbranch_scc1 .aw_393
    s_sleep 16
    s_branch .aw_395
.aw_393:
    s_barrier
    v_or_b32 v239, 32, v1
    v_lshlrev_b32 v239, 2, v239
    buffer_load_dword v238, v239, s[20:23], 0 offen sc1
    s_waitcnt vmcnt(0)
    s_cmp_lg_u32 s27, 0
    s_cbranch_scc1 .vd_397
    s_mov_b32 s62, 0
.vp_396:
    v_readlane_b32 s4, v238, 49
    s_and_b32 s5, s4, 0xffff
    s_cmp_ge_u32 s5, 256
    s_cbranch_scc1 .va_398
    s_add_u32 s62, s62, 1
    s_cmp_gt_u32 s62, 0x100000
    s_cbranch_scc1 .mg_end_1
    s_sleep 16
    buffer_load_dword v238, v239, s[20:23], 0 offen sc1
    s_waitcnt vmcnt(0)
    s_branch .vp_396
.va_398:
    s_lshr_b32 s4, s4, 16
    s_cbranch_scc0 .vd_397
    s_lshr_b32 s25, s2, 5
    s_and_b32 s26, s2, 31
    s_mov_b32 s27, 1
    s_waitcnt vmcnt(0) lgkmcnt(0)
    s_barrier
    s_branch .mg_role_3
.vd_397:
    s_cmp_eq_u32 s98, 3
    s_cbranch_scc1 .ph2_390
.qkv_391:
    s_lshl_b32 s4, s98, 3
    s_add_u32 s4, s4, 64
    s_load_dwordx2 s[40:41], s[0:1], 0
    s_load_dwordx2 s[42:43], s[0:1], s4
    s_lshl_b32 s4, s99, 8
    s_lshl_b32 s6, s24, 14
    s_mul_i32 s5, s24, 524288
    s_add_u32 s4, s4, s5
    v_bfe_u32 v2, v1, 4, 1
    v_lshlrev_b32 v2, 2, v2
    v_and_b32 v3, 7, v1
    v_xor_b32 v2, v2, v3
    v_lshlrev_b32 v2, 4, v2
    v_bfe_u32 v254, v1, 3, 2
    v_mul_u32_u24 v240, 8192, v254
    v_bfe_u32 v254, v1, 5, 1
    v_mul_u32_u24 v254, 128, v254
    v_add_u32 v240, v240, v254
    v_add_u32 v240, s4, v240
    v_add_u32 v240, v2, v240
    s_lshr_b32 s5, s24, 1
    s_lshl_b32 s5, s5, 9
    v_bfe_u32 v2, v1, 3, 1
    v_xor_b32 v2, s24, v2
    v_and_b32 v2, 1, v2
    v_lshlrev_b32 v2, 6, v2
    v_bfe_u32 v254, v1, 4, 2
    v_mul_u32_u24 v242, 2048, v254
    v_bfe_u32 v254, v1, 2, 2
    v_mul_u32_u24 v254, 128, v254
    v_add_u32 v242, v242, v254
    v_bfe_u32 v254, v1, 0, 2
    v_mul_u32_u24 v254, 16, v254
    v_add_u32 v242, v242, v254
    v_add_u32 v242, s5, v242
    v_add_u32 v242, v2, v242
    v_add_u32 v243, 0x10000, v242
    s_waitcnt lgkmcnt(0)
    s_mov_b32 s12, s40
    s_and_b32 s13, s41, 0xffff
    s_mov_b32 s14, 0x400000
    s_mov_b32 s15, 0x00020000
    s_mov_b32 s16, s42
    s_and_b32 s17, s43, 0xffff
    s_mov_b32 s18, 0x800000
    s_mov_b32 s19, 0x00020000
    s_add_u32 m0, s6, 0
    s_mov_b32 s5, 0
    buffer_load_dwordx4 v240, s[16:19], s5 offen nt lds
    s_add_u32 m0, s6, 1024
    s_mov_b32 s5, 32768
    buffer_load_dwordx4 v240, s[16:19], s5 offen nt lds
    s_add_u32 m0, s6, 2048
    s_mov_b32 s5, 65536
    buffer_load_dwordx4 v240, s[16:19], s5 offen nt lds
    s_add_u32 m0, s6, 3072
    s_mov_b32 s5, 98304
    buffer_load_dwordx4 v240, s[16:19], s5 offen nt lds
    s_add_u32 m0, s6, 4096
    s_mov_b32 s5, 131072
    buffer_load_dwordx4 v240, s[16:19], s5 offen nt lds
    s_add_u32 m0, s6, 5120
    s_mov_b32 s5, 163840
    buffer_load_dwordx4 v240, s[16:19], s5 offen nt lds
    s_add_u32 m0, s6, 6144
    s_mov_b32 s5, 196608
    buffer_load_dwordx4 v240, s[16:19], s5 offen nt lds
    s_add_u32 m0, s6, 7168
    s_mov_b32 s5, 229376
    buffer_load_dwordx4 v240, s[16:19], s5 offen nt lds
    s_add_u32 m0, s6, 8192
    s_mov_b32 s5, 262144
    buffer_load_dwordx4 v240, s[16:19], s5 offen nt lds
    s_add_u32 m0, s6, 9216
    s_mov_b32 s5, 294912
    buffer_load_dwordx4 v240, s[16:19], s5 offen nt lds
    s_add_u32 m0, s6, 10240
    s_mov_b32 s5, 327680
    buffer_load_dwordx4 v240, s[16:19], s5 offen nt lds
    s_add_u32 m0, s6, 11264
    s_mov_b32 s5, 360448
    buffer_load_dwordx4 v240, s[16:19], s5 offen nt lds
    s_add_u32 m0, s6, 12288
    s_mov_b32 s5, 393216
    buffer_load_dwordx4 v240, s[16:19], s5 offen nt lds
    s_add_u32 m0, s6, 13312
    s_mov_b32 s5, 425984
    buffer_load_dwordx4 v240, s[16:19], s5 offen nt lds
    s_add_u32 m0, s6, 14336
    s_mov_b32 s5, 458752
    buffer_load_dwordx4 v240, s[16:19], s5 offen nt lds
    s_add_u32 m0, s6, 15360
    s_mov_b32 s5, 491520
    buffer_load_dwordx4 v240, s[16:19], s5 offen nt lds
    s_waitcnt vmcnt(16)
    s_barrier
    s_cmp_lg_u32 s24, 1
    s_cbranch_scc1 .ns_399
    s_mov_b64 exec, 1
    v_mov_b32 v238, s3
    v_mov_b32 v239, 0
    buffer_atomic_add v238, v239, s[20:23], 0 offen offset:196 sc1
    s_mov_b64 exec, -1
.ns_399:
    s_add_u32 m0, s6, 65536
    s_mov_b32 s5, 2097152
    buffer_load_dwordx4 v240, s[16:19], s5 offen nt lds
    s_add_u32 m0, s6, 66560
    s_mov_b32 s5, 2129920
    buffer_load_dwordx4 v240, s[16:19], s5 offen nt lds
    s_add_u32 m0, s6, 67584
    s_mov_b32 s5, 2162688
    buffer_load_dwordx4 v240, s[16:19], s5 offen nt lds
    s_add_u32 m0, s6, 68608
    s_mov_b32 s5, 2195456
    buffer_load_dwordx4 v240, s[16:19], s5 offen nt lds
    s_add_u32 m0, s6, 69632
    s_mov_b32 s5, 2228224
    buffer_load_dwordx4 v240, s[16:19], s5 offen nt lds
    s_add_u32 m0, s6, 70656
    s_mov_b32 s5, 2260992
    buffer_load_dwordx4 v240, s[16:19], s5 offen nt lds
    s_add_u32 m0, s6, 71680
    s_mov_b32 s5, 2293760
    buffer_load_dwordx4 v240, s[16:19], s5 offen nt lds
    s_add_u32 m0, s6, 72704
    s_mov_b32 s5, 2326528
    buffer_load_dwordx4 v240, s[16:19], s5 offen nt lds
    s_add_u32 m0, s6, 73728
    s_mov_b32 s5, 2359296
    buffer_load_dwordx4 v240, s[16:19], s5 offen nt lds
    s_add_u32 m0, s6, 74752
    s_mov_b32 s5, 2392064
    buffer_load_dwordx4 v240, s[16:19], s5 offen nt lds
    s_add_u32 m0, s6, 75776
    s_mov_b32 s5, 2424832
    buffer_load_dwordx4 v240, s[16:19], s5 offen nt lds
    s_add_u32 m0, s6, 76800
    s_mov_b32 s5, 2457600
    buffer_load_dwordx4 v240, s[16:19], s5 offen nt lds
    s_add_u32 m0, s6, 77824
    s_mov_b32 s5, 2490368
    buffer_load_dwordx4 v240, s[16:19], s5 offen nt lds
    s_add_u32 m0, s6, 78848
    s_mov_b32 s5, 2523136
    buffer_load_dwordx4 v240, s[16:19], s5 offen nt lds
    s_add_u32 m0, s6, 79872
    s_mov_b32 s5, 2555904
    buffer_load_dwordx4 v240, s[16:19], s5 offen nt lds
    s_add_u32 m0, s6, 80896
    s_mov_b32 s5, 2588672
    buffer_load_dwordx4 v240, s[16:19], s5 offen nt lds
    s_cmp_lg_u32 s98, 0
    s_cbranch_scc1 .xt_400
    s_and_b32 s4, s99, 7
    s_lshl_b32 s4, s4, 2
    s_add_u32 s4, s4, s24
    s_mul_i32 s4, s4, 4096
    s_add_u32 s4, s4, 4063232
    v_lshlrev_b32 v30, 7, v1
    v_add_u32 v30, s4, v30
    buffer_load_dword v31, v30, s[12:15], 0 offen
.xt_400:
    v_and_b32 v2, 15, v1
    v_lshrrev_b32 v3, 4, v1
    v_lshlrev_b32 v4, 11, v2
    v_add_u32 v5, 0, v3
    v_xor_b32 v5, v5, v2
    v_lshl_add_u32 v8, v5, 4, v4
    v_add_u32 v12, 0x10000, v8
    v_add_u32 v5, 4, v3
    v_xor_b32 v5, v5, v2
    v_lshl_add_u32 v9, v5, 4, v4
    v_add_u32 v13, 0x10000, v9
    v_add_u32 v5, 8, v3
    v_xor_b32 v5, v5, v2
    v_lshl_add_u32 v10, v5, 4, v4
    v_add_u32 v14, 0x10000, v10
    v_add_u32 v5, 12, v3
    v_xor_b32 v5, v5, v2
    v_lshl_add_u32 v11, v5, 4, v4
    v_add_u32 v15, 0x10000, v11
    s_lshl_b32 s4, s24, 3
    s_and_b32 s4, s4, 8
    s_add_u32 s5, s4, 0
    v_xor_b32 v5, s5, v1
    s_add_u32 s5, s6, 0
    v_lshlrev_b32 v5, 4, v5
    v_add_u32 v16, s5, v5
    s_add_u32 s5, s4, 1
    v_xor_b32 v5, s5, v1
    s_add_u32 s5, s6, 0
    v_lshlrev_b32 v5, 4, v5
    v_add_u32 v17, s5, v5
    s_add_u32 s5, s4, 2
    v_xor_b32 v5, s5, v1
    s_add_u32 s5, s6, 4096
    v_lshlrev_b32 v5, 4, v5
    v_add_u32 v18, s5, v5
    s_add_u32 s5, s4, 3
    v_xor_b32 v5, s5, v1
    s_add_u32 s5, s6, 4096
    v_lshlrev_b32 v5, 4, v5
    v_add_u32 v19, s5, v5
    s_add_u32 s5, s4, 4
    v_xor_b32 v5, s5, v1
    s_add_u32 s5, s6, 8192
    v_lshlrev_b32 v5, 4, v5
    v_add_u32 v20, s5, v5
    s_add_u32 s5, s4, 5
    v_xor_b32 v5, s5, v1
    s_add_u32 s5, s6, 8192
    v_lshlrev_b32 v5, 4, v5
    v_add_u32 v21, s5, v5
    s_add_u32 s5, s4, 6
    v_xor_b32 v5, s5, v1
    s_add_u32 s5, s6, 12288
    v_lshlrev_b32 v5, 4, v5
    v_add_u32 v22, s5, v5
    s_add_u32 s5, s4, 7
    v_xor_b32 v5, s5, v1
    s_add_u32 s5, s6, 12288
    v_lshlrev_b32 v5, 4, v5
    v_add_u32 v23, s5, v5
    s_cmp_eq_u32 s98, 2
    s_cselect_b32 s4, 11, 10
    s_cselect_b32 s5, 1, 4
    s_lshl_b32 s5, s5, 10
    s_lshl_b32 s4, s24, s4
    v_lshlrev_b32 v24, 4, v1
    v_add_u32 v24, s4, v24
    v_add_u32 v25, s5, v24
    v_mov_b32 v26, 0
    s_and_b32 s4, s99, 7
    s_lshl_b32 s4, s4, 13
    s_lshl_b32 s5, s24, 11
    s_add_u32 s4, s4, s5
    s_add_u32 s4, s4, 196608
    v_lshlrev_b32 v28, 5, v1
    v_add_u32 v28, s4, v28
    s_lshl_b32 s31, s98, 24
    s_lshl_b32 s4, s99, 13
    s_add_u32 s31, s31, s4
    s_mov_b32 s30, 75497472
    s_cmp_eq_u32 s98, 0
    s_cselect_b32 s28, 62, 0
    s_lshl_b32 s29, s28, 16
    s_waitcnt vmcnt(16)
    s_barrier
    ds_read_b64_tr_b16 a[0:1], v242 offset:0
    ds_read_b64_tr_b16 a[2:3], v242 offset:1024
    ds_read_b64_tr_b16 a[4:5], v242 offset:8
    ds_read_b64_tr_b16 a[6:7], v242 offset:1032
    ds_read_b64_tr_b16 a[8:9], v242 offset:8192
    ds_read_b64_tr_b16 a[10:11], v242 offset:9216
    ds_read_b64_tr_b16 a[12:13], v242 offset:8200
    ds_read_b64_tr_b16 a[14:15], v242 offset:9224
    ds_read_b64_tr_b16 a[16:17], v242 offset:16384
    ds_read_b64_tr_b16 a[18:19], v242 offset:17408
    ds_read_b64_tr_b16 a[20:21], v242 offset:16392
    ds_read_b64_tr_b16 a[22:23], v242 offset:17416
    ds_read_b64_tr_b16 a[24:25], v242 offset:24576
    ds_read_b64_tr_b16 a[26:27], v242 offset:25600
    ds_read_b64_tr_b16 a[28:29], v242 offset:24584
    ds_read_b64_tr_b16 a[30:31], v242 offset:25608
    ds_read_b64_tr_b16 a[32:33], v242 offset:32768
    ds_read_b64_tr_b16 a[34:35], v242 offset:33792
    ds_read_b64_tr_b16 a[36:37], v242 offset:32776
    ds_read_b64_tr_b16 a[38:39], v242 offset:33800
    ds_read_b64_tr_b16 a[40:41], v242 offset:40960
    ds_read_b64_tr_b16 a[42:43], v242 offset:41984
    ds_read_b64_tr_b16 a[44:45], v242 offset:40968
    ds_read_b64_tr_b16 a[46:47], v242 offset:41992
    ds_read_b64_tr_b16 a[48:49], v242 offset:49152
    ds_read_b64_tr_b16 a[50:51], v242 offset:50176
    ds_read_b64_tr_b16 a[52:53], v242 offset:49160
    ds_read_b64_tr_b16 a[54:55], v242 offset:50184
    ds_read_b64_tr_b16 a[56:57], v242 offset:57344
    ds_read_b64_tr_b16 a[58:59], v242 offset:58368
    ds_read_b64_tr_b16 a[60:61], v242 offset:57352
    ds_read_b64_tr_b16 a[62:63], v242 offset:58376
    s_waitcnt lgkmcnt(0)
    s_barrier
    s_add_u32 m0, s6, 0
    s_mov_b32 s5, 4194304
    buffer_load_dwordx4 v240, s[16:19], s5 offen nt lds
    s_add_u32 m0, s6, 1024
    s_mov_b32 s5, 4227072
    buffer_load_dwordx4 v240, s[16:19], s5 offen nt lds
    s_add_u32 m0, s6, 2048
    s_mov_b32 s5, 4259840
    buffer_load_dwordx4 v240, s[16:19], s5 offen nt lds
    s_add_u32 m0, s6, 3072
    s_mov_b32 s5, 4292608
    buffer_load_dwordx4 v240, s[16:19], s5 offen nt lds
    s_add_u32 m0, s6, 4096
    s_mov_b32 s5, 4325376
    buffer_load_dwordx4 v240, s[16:19], s5 offen nt lds
    s_add_u32 m0, s6, 5120
    s_mov_b32 s5, 4358144
    buffer_load_dwordx4 v240, s[16:19], s5 offen nt lds
    s_add_u32 m0, s6, 6144
    s_mov_b32 s5, 4390912
    buffer_load_dwordx4 v240, s[16:19], s5 offen nt lds
    s_add_u32 m0, s6, 7168
    s_mov_b32 s5, 4423680
    buffer_load_dwordx4 v240, s[16:19], s5 offen nt lds
    s_add_u32 m0, s6, 8192
    s_mov_b32 s5, 4456448
    buffer_load_dwordx4 v240, s[16:19], s5 offen nt lds
    s_add_u32 m0, s6, 9216
    s_mov_b32 s5, 4489216
    buffer_load_dwordx4 v240, s[16:19], s5 offen nt lds
    s_add_u32 m0, s6, 10240
    s_mov_b32 s5, 4521984
    buffer_load_dwordx4 v240, s[16:19], s5 offen nt lds
    s_add_u32 m0, s6, 11264
    s_mov_b32 s5, 4554752
    buffer_load_dwordx4 v240, s[16:19], s5 offen nt lds
    s_add_u32 m0, s6, 12288
    s_mov_b32 s5, 4587520
    buffer_load_dwordx4 v240, s[16:19], s5 offen nt lds
    s_add_u32 m0, s6, 13312
    s_mov_b32 s5, 4620288
    buffer_load_dwordx4 v240, s[16:19], s5 offen nt lds
    s_add_u32 m0, s6, 14336
    s_mov_b32 s5, 4653056
    buffer_load_dwordx4 v240, s[16:19], s5 offen nt lds
    s_add_u32 m0, s6, 15360
    s_mov_b32 s5, 4685824
    buffer_load_dwordx4 v240, s[16:19], s5 offen nt lds
    s_waitcnt vmcnt(16)
    s_lshl_b32 s4, s99, 9
    s_lshl_b32 s5, s24, 7
    s_add_u32 s4, s4, s5
    s_lshl_b32 s5, s98, 14
    s_add_u32 s4, s4, s5
    s_add_u32 s94, s4, 92274688
    s_add_u32 s4, s4, 76546048
    s_cmp_eq_u32 s98, 0
    s_cselect_b32 s94, s4, s94
    s_barrier
    ds_read_b64_tr_b16 a[64:65], v243 offset:0
    ds_read_b64_tr_b16 a[66:67], v243 offset:1024
    ds_read_b64_tr_b16 a[68:69], v243 offset:8
    ds_read_b64_tr_b16 a[70:71], v243 offset:1032
    ds_read_b64_tr_b16 a[72:73], v243 offset:8192
    ds_read_b64_tr_b16 a[74:75], v243 offset:9216
    ds_read_b64_tr_b16 a[76:77], v243 offset:8200
    ds_read_b64_tr_b16 a[78:79], v243 offset:9224
    ds_read_b64_tr_b16 a[80:81], v243 offset:16384
    ds_read_b64_tr_b16 a[82:83], v243 offset:17408
    ds_read_b64_tr_b16 a[84:85], v243 offset:16392
    ds_read_b64_tr_b16 a[86:87], v243 offset:17416
    ds_read_b64_tr_b16 a[88:89], v243 offset:24576
    ds_read_b64_tr_b16 a[90:91], v243 offset:25600
    ds_read_b64_tr_b16 a[92:93], v243 offset:24584
    ds_read_b64_tr_b16 a[94:95], v243 offset:25608
    ds_read_b64_tr_b16 a[96:97], v243 offset:32768
    ds_read_b64_tr_b16 a[98:99], v243 offset:33792
    ds_read_b64_tr_b16 a[100:101], v243 offset:32776
    ds_read_b64_tr_b16 a[102:103], v243 offset:33800
    ds_read_b64_tr_b16 a[104:105], v243 offset:40960
    ds_read_b64_tr_b16 a[106:107], v243 offset:41984
    ds_read_b64_tr_b16 a[108:109], v243 offset:40968
    ds_read_b64_tr_b16 a[110:111], v243 offset:41992
    ds_read_b64_tr_b16 a[112:113], v243 offset:49152
    ds_read_b64_tr_b16 a[114:115], v243 offset:50176
    ds_read_b64_tr_b16 a[116:117], v243 offset:49160
    ds_read_b64_tr_b16 a[118:119], v243 offset:50184
    ds_read_b64_tr_b16 a[120:121], v243 offset:57344
    ds_read_b64_tr_b16 a[122:123], v243 offset:58368
    ds_read_b64_tr_b16 a[124:125], v243 offset:57352
    ds_read_b64_tr_b16 a[126:127], v243 offset:58376
    s_waitcnt lgkmcnt(0)
    s_barrier
    v_or_b32 v239, 32, v1
    v_lshlrev_b32 v239, 2, v239
    buffer_load_dword v238, v239, s[20:23], 0 offen sc1
    s_add_u32 m0, s6, 65536
    s_mov_b32 s5, 6291456
    buffer_load_dwordx4 v240, s[16:19], s5 offen nt lds
    s_add_u32 m0, s6, 66560
    s_mov_b32 s5, 6324224
    buffer_load_dwordx4 v240, s[16:19], s5 offen nt lds
    s_add_u32 m0, s6, 67584
    s_mov_b32 s5, 6356992
    buffer_load_dwordx4 v240, s[16:19], s5 offen nt lds
    s_add_u32 m0, s6, 68608
    s_mov_b32 s5, 6389760
    buffer_load_dwordx4 v240, s[16:19], s5 offen nt lds
    s_add_u32 m0, s6, 69632
    s_mov_b32 s5, 6422528
    buffer_load_dwordx4 v240, s[16:19], s5 offen nt lds
    s_add_u32 m0, s6, 70656
    s_mov_b32 s5, 6455296
    buffer_load_dwordx4 v240, s[16:19], s5 offen nt lds
    s_add_u32 m0, s6, 71680
    s_mov_b32 s5, 6488064
    buffer_load_dwordx4 v240, s[16:19], s5 offen nt lds
    s_add_u32 m0, s6, 72704
    s_mov_b32 s5, 6520832
    buffer_load_dwordx4 v240, s[16:19], s5 offen nt lds
    s_add_u32 m0, s6, 73728
    s_mov_b32 s5, 6553600
    buffer_load_dwordx4 v240, s[16:19], s5 offen nt lds
    s_add_u32 m0, s6, 74752
    s_mov_b32 s5, 6586368
    buffer_load_dwordx4 v240, s[16:19], s5 offen nt lds
    s_add_u32 m0, s6, 75776
    s_mov_b32 s5, 6619136
    buffer_load_dwordx4 v240, s[16:19], s5 offen nt lds
    s_add_u32 m0, s6, 76800
    s_mov_b32 s5, 6651904
    buffer_load_dwordx4 v240, s[16:19], s5 offen nt lds
    s_add_u32 m0, s6, 77824
    s_mov_b32 s5, 6684672
    buffer_load_dwordx4 v240, s[16:19], s5 offen nt lds
    s_add_u32 m0, s6, 78848
    s_mov_b32 s5, 6717440
    buffer_load_dwordx4 v240, s[16:19], s5 offen nt lds
    s_add_u32 m0, s6, 79872
    s_mov_b32 s5, 6750208
    buffer_load_dwordx4 v240, s[16:19], s5 offen nt lds
    s_add_u32 m0, s6, 80896
    s_mov_b32 s5, 6782976
    buffer_load_dwordx4 v240, s[16:19], s5 offen nt lds
    s_cmp_lg_u32 s98, 0
    s_cbranch_scc1 .xt_401
    s_and_b32 s4, s99, 7
    s_lshl_b32 s4, s4, 2
    s_add_u32 s4, s4, s24
    s_mul_i32 s4, s4, 6144
    s_add_u32 s4, s4, 0
    v_lshlrev_b32 v30, 7, v1
    v_add_u32 v30, s4, v30
    buffer_load_dword v31, v30, s[12:15], 0 offen
.xt_401:
    s_waitcnt vmcnt(16)
    s_cmp_lg_u32 s27, 0
    s_cbranch_scc1 .vd_403
    s_mov_b32 s62, 0
.vp_402:
    v_readlane_b32 s4, v238, 49
    s_and_b32 s5, s4, 0xffff
    s_cmp_ge_u32 s5, 256
    s_cbranch_scc1 .va_404
    s_add_u32 s62, s62, 1
    s_cmp_gt_u32 s62, 0x100000
    s_cbranch_scc1 .mg_end_1
    s_sleep 16
    buffer_load_dword v238, v239, s[20:23], 0 offen sc1
    s_waitcnt vmcnt(0)
    s_branch .vp_402
.va_404:
    s_lshr_b32 s4, s4, 16
    s_cbranch_scc0 .vd_403
    s_lshr_b32 s25, s2, 5
    s_and_b32 s26, s2, 31
    s_mov_b32 s27, 1
    s_waitcnt vmcnt(0) lgkmcnt(0)
    s_barrier
    s_branch .mg_role_3
.vd_403:
    s_mov_b32 s63, 0
    s_cmp_lg_u32 s27, 0
    s_cbranch_scc1 .cd_406
    s_mov_b32 s62, 0
.cp_405:
    v_and_b32 v33, 0xffff, v238
    v_lshrrev_b32 v34, 16, v238
    v_min_u32 v32, v33, v34
    v_cmp_eq_u32 vcc, 0, v32
    s_and_b32 s4, vcc_hi, 65280
    s_cbranch_scc0 .cg_407
    s_add_u32 s62, s62, 1
    s_cmp_gt_u32 s62, 0x100000
    s_cbranch_scc1 .mg_end_1
    s_sleep 16
    buffer_load_dword v238, v239, s[20:23], 0 offen sc1
    s_waitcnt vmcnt(0)
    s_branch .cp_405
.cg_407:
    v_cmp_eq_u32 vcc, 2, v33
    s_bfe_u32 s63, vcc_hi, 524296
    v_cmp_eq_u32 vcc, 2, v34
    s_bfe_u32 s4, vcc_hi, 524296
    s_lshl_b32 s4, s4, 8
    s_or_b32 s63, s63, s4
    s_xor_b32 s4, s63, 0xaaaa
    s_bcnt1_i32_b32 s4, s4
    s_cmp_le_u32 s4, 3
    s_cselect_b32 s63, 0xaaaa, s63
    s_cmp_ge_u32 s4, 13
    s_cselect_b32 s63, 0x5555, s63
.cd_406:
    s_lshr_b32 s36, s99, 3
    s_and_b32 s37, s99, 7
    s_lshl_b32 s37, s37, 2
    s_add_u32 s37, s37, s24
    s_and_b32 s4, s36, 1
    s_lshl_b32 s35, s4, 14
    s_lshr_b32 s4, s36, 1
    s_lshl_b32 s4, s4, 12
    s_or_b32 s35, s35, s4
    s_and_b32 s4, s37, 1
    s_lshl_b32 s4, s4, 11
    s_or_b32 s35, s35, s4
    s_lshr_b32 s4, s37, 1
    s_lshl_b32 s4, s4, 15
    s_or_b32 s35, s35, s4
    s_and_b32 s4, s98, 1
    s_lshl_b32 s4, s4, 10
    s_add_u32 s4, s4, s101
    v_lshlrev_b32 v36, 4, v1
    v_add_u32 v36, s4, v36
    v_mov_b32 v32, -1
    v_mov_b32 v33, -1
    v_mov_b32 v34, -1
    v_mov_b32 v35, -1
    s_add_u32 s37, s28, 4
    s_bitcmp1_b32 s37, 0
    s_cselect_b32 s4, 0x84000, 0
    s_xor_b32 s34, s35, s4
    s_bitcmp1_b32 s37, 1
    s_cselect_b32 s4, 0x101000, 0
    s_xor_b32 s34, s34, s4
    s_lshr_b32 s37, s37, 2
    s_bitcmp1_b32 s63, s37
    s_cselect_b32 s4, 0x2000, 0
    s_xor_b32 s34, s34, s4
    s_lshl_b32 s37, s37, 21
    s_add_u32 s34, s34, s37
    s_barrier
    ds_read_b64_tr_b16 a[128:129], v242 offset:0
    ds_read_b64_tr_b16 a[130:131], v242 offset:1024
    ds_read_b64_tr_b16 a[132:133], v242 offset:8
    ds_read_b64_tr_b16 a[134:135], v242 offset:1032
    ds_read_b64_tr_b16 a[136:137], v242 offset:8192
    ds_read_b64_tr_b16 a[138:139], v242 offset:9216
    ds_read_b64_tr_b16 a[140:141], v242 offset:8200
    ds_read_b64_tr_b16 a[142:143], v242 offset:9224
    ds_read_b64_tr_b16 a[144:145], v242 offset:16384
    ds_read_b64_tr_b16 a[146:147], v242 offset:17408
    ds_read_b64_tr_b16 a[148:149], v242 offset:16392
    ds_read_b64_tr_b16 a[150:151], v242 offset:17416
    ds_read_b64_tr_b16 a[152:153], v242 offset:24576
    ds_read_b64_tr_b16 a[154:155], v242 offset:25600
    ds_read_b64_tr_b16 a[156:157], v242 offset:24584
    ds_read_b64_tr_b16 a[158:159], v242 offset:25608
    ds_read_b64_tr_b16 a[160:161], v242 offset:32768
    ds_read_b64_tr_b16 a[162:163], v242 offset:33792
    ds_read_b64_tr_b16 a[164:165], v242 offset:32776
    ds_read_b64_tr_b16 a[166:167], v242 offset:33800
    ds_read_b64_tr_b16 a[168:169], v242 offset:40960
    ds_read_b64_tr_b16 a[170:171], v242 offset:41984
    ds_read_b64_tr_b16 a[172:173], v242 offset:40968
    ds_read_b64_tr_b16 a[174:175], v242 offset:41992
    ds_read_b64_tr_b16 a[176:177], v242 offset:49152
    ds_read_b64_tr_b16 a[178:179], v242 offset:50176
    ds_read_b64_tr_b16 a[180:181], v242 offset:49160
    ds_read_b64_tr_b16 a[182:183], v242 offset:50184
    ds_read_b64_tr_b16 a[184:185], v242 offset:57344
    ds_read_b64_tr_b16 a[186:187], v242 offset:58368
    ds_read_b64_tr_b16 a[188:189], v242 offset:57352
    ds_read_b64_tr_b16 a[190:191], v242 offset:58376
    s_waitcnt lgkmcnt(0)
    s_barrier
    s_add_u32 m0, s6, 0
    s_nop 0
    buffer_load_dwordx4 v16, s[12:15], s29 offen offset:0 lds
    buffer_load_dwordx4 v16, s[12:15], s29 offen offset:1024 lds
    buffer_load_dwordx4 v17, s[12:15], s29 offen offset:2048 lds
    buffer_load_dwordx4 v17, s[12:15], s29 offen offset:3072 lds
    s_add_u32 m0, s6, 4096
    s_nop 0
    buffer_load_dwordx4 v18, s[12:15], s29 offen offset:0 lds
    buffer_load_dwordx4 v18, s[12:15], s29 offen offset:1024 lds
    buffer_load_dwordx4 v19, s[12:15], s29 offen offset:2048 lds
    buffer_load_dwordx4 v19, s[12:15], s29 offen offset:3072 lds
    s_add_u32 m0, s6, 8192
    s_nop 0
    buffer_load_dwordx4 v20, s[12:15], s29 offen offset:0 lds
    buffer_load_dwordx4 v20, s[12:15], s29 offen offset:1024 lds
    buffer_load_dwordx4 v21, s[12:15], s29 offen offset:2048 lds
    buffer_load_dwordx4 v21, s[12:15], s29 offen offset:3072 lds
    s_add_u32 m0, s6, 12288
    s_nop 0
    buffer_load_dwordx4 v22, s[12:15], s29 offen offset:0 lds
    buffer_load_dwordx4 v22, s[12:15], s29 offen offset:1024 lds
    buffer_load_dwordx4 v23, s[12:15], s29 offen offset:2048 lds
    buffer_load_dwordx4 v23, s[12:15], s29 offen offset:3072 lds
    s_waitcnt vmcnt(16)
    s_barrier
    ds_read_b64_tr_b16 a[192:193], v243 offset:0
    ds_read_b64_tr_b16 a[194:195], v243 offset:1024
    ds_read_b64_tr_b16 a[196:197], v243 offset:8
    ds_read_b64_tr_b16 a[198:199], v243 offset:1032
    ds_read_b64_tr_b16 a[200:201], v243 offset:8192
    ds_read_b64_tr_b16 a[202:203], v243 offset:9216
    ds_read_b64_tr_b16 a[204:205], v243 offset:8200
    ds_read_b64_tr_b16 a[206:207], v243 offset:9224
    ds_read_b64_tr_b16 a[208:209], v243 offset:16384
    ds_read_b64_tr_b16 a[210:211], v243 offset:17408
    ds_read_b64_tr_b16 a[212:213], v243 offset:16392
    ds_read_b64_tr_b16 a[214:215], v243 offset:17416
    ds_read_b64_tr_b16 a[216:217], v243 offset:24576
    ds_read_b64_tr_b16 a[218:219], v243 offset:25600
    ds_read_b64_tr_b16 a[220:221], v243 offset:24584
    ds_read_b64_tr_b16 a[222:223], v243 offset:25608
    ds_read_b64_tr_b16 a[224:225], v243 offset:32768
    ds_read_b64_tr_b16 a[226:227], v243 offset:33792
    ds_read_b64_tr_b16 a[228:229], v243 offset:32776
    ds_read_b64_tr_b16 a[230:231], v243 offset:33800
    ds_read_b64_tr_b16 a[232:233], v243 offset:40960
    ds_read_b64_tr_b16 a[234:235], v243 offset:41984
    ds_read_b64_tr_b16 a[236:237], v243 offset:40968
    ds_read_b64_tr_b16 a[238:239], v243 offset:41992
    ds_read_b64_tr_b16 a[240:241], v243 offset:49152
    ds_read_b64_tr_b16 a[242:243], v243 offset:50176
    ds_read_b64_tr_b16 a[244:245], v243 offset:49160
    ds_read_b64_tr_b16 a[246:247], v243 offset:50184
    ds_read_b64_tr_b16 a[248:249], v243 offset:57344
    ds_read_b64_tr_b16 a[250:251], v243 offset:58368
    ds_read_b64_tr_b16 a[252:253], v243 offset:57352
    ds_read_b64_tr_b16 a[254:255], v243 offset:58376
    s_waitcnt lgkmcnt(0)
    s_barrier
    s_waitcnt vmcnt(0)
    s_barrier
    s_add_u32 s29, s29, 0x10000
    ds_read_b128 v[64:67], v8 offset:0
    ds_read_b128 v[68:71], v8 offset:32768
    ds_read_b128 v[72:75], v9 offset:0
    ds_read_b128 v[76:79], v9 offset:32768
    ds_read_b128 v[80:83], v10 offset:0
    ds_read_b128 v[84:87], v10 offset:32768
    ds_read_b128 v[88:91], v11 offset:0
    ds_read_b128 v[92:95], v11 offset:32768
    ds_read_b128 v[96:99], v8 offset:256
    ds_read_b128 v[100:103], v8 offset:33024
    ds_read_b128 v[104:107], v9 offset:256
    ds_read_b128 v[108:111], v9 offset:33024
    ds_read_b128 v[112:115], v10 offset:256
    ds_read_b128 v[116:119], v10 offset:33024
    ds_read_b128 v[120:123], v11 offset:256
    ds_read_b128 v[124:127], v11 offset:33024
    s_add_u32 m0, s6, 65536
    s_nop 0
    buffer_load_dwordx4 v16, s[12:15], s29 offen offset:0 lds
    buffer_load_dwordx4 v16, s[12:15], s29 offen offset:1024 lds
    buffer_load_dwordx4 v17, s[12:15], s29 offen offset:2048 lds
    buffer_load_dwordx4 v17, s[12:15], s29 offen offset:3072 lds
    s_add_u32 m0, s6, 69632
    s_nop 0
    buffer_load_dwordx4 v18, s[12:15], s29 offen offset:0 lds
    buffer_load_dwordx4 v18, s[12:15], s29 offen offset:1024 lds
    s_cmp_eq_u32 s98, 2
    s_cbranch_scc1 .vt_409
.p2align 6
.ql_411:
    s_waitcnt lgkmcnt(12)
    v_mfma_f32_16x16x32_bf16 v[192:195], a[0:3], v[64:67], 0
    ds_read_b128 v[128:131], v8 offset:512
    v_mfma_f32_16x16x32_bf16 v[196:199], a[4:7], v[64:67], 0
    v_mfma_f32_16x16x32_bf16 v[200:203], a[0:3], v[68:71], 0
    ds_read_b128 v[132:135], v8 offset:33280
    v_mfma_f32_16x16x32_bf16 v[204:207], a[4:7], v[68:71], 0
    buffer_load_dwordx4 v19, s[12:15], s29 offen offset:2048 lds
    v_mfma_f32_16x16x32_bf16 v[192:195], a[8:11], v[72:75], v[192:195]
    ds_read_b128 v[136:139], v9 offset:512
    v_mfma_f32_16x16x32_bf16 v[196:199], a[12:15], v[72:75], v[196:199]
    v_cvt_pk_bf16_f32 v224, v208, v209
    v_cvt_pk_bf16_f32 v225, v210, v211
    v_mfma_f32_16x16x32_bf16 v[200:203], a[8:11], v[76:79], v[200:203]
    ds_read_b128 v[140:143], v9 offset:33280
    v_mfma_f32_16x16x32_bf16 v[204:207], a[12:15], v[76:79], v[204:207]
    buffer_load_dwordx4 v19, s[12:15], s29 offen offset:3072 lds
    s_waitcnt lgkmcnt(12)
    v_mfma_f32_16x16x32_bf16 v[192:195], a[16:19], v[80:83], v[192:195]
    ds_read_b128 v[144:147], v10 offset:512
    v_mfma_f32_16x16x32_bf16 v[196:199], a[20:23], v[80:83], v[196:199]
    s_add_u32 m0, s6, 73728
    v_cvt_pk_bf16_f32 v226, v212, v213
    v_cvt_pk_bf16_f32 v227, v214, v215
    v_mfma_f32_16x16x32_bf16 v[200:203], a[16:19], v[84:87], v[200:203]
    ds_read_b128 v[148:151], v10 offset:33280
    v_mfma_f32_16x16x32_bf16 v[204:207], a[20:23], v[84:87], v[204:207]
    buffer_load_dwordx4 v20, s[12:15], s29 offen offset:0 lds
    v_mfma_f32_16x16x32_bf16 v[192:195], a[24:27], v[88:91], v[192:195]
    ds_read_b128 v[152:155], v11 offset:512
    v_cvt_pk_bf16_f32 v228, v216, v217
    v_mfma_f32_16x16x32_bf16 v[196:199], a[28:31], v[88:91], v[196:199]
    buffer_store_dwordx4 v[224:227], v24, s[8:11], s30 offen sc1
    v_mfma_f32_16x16x32_bf16 v[200:203], a[24:27], v[92:95], v[200:203]
    ds_read_b128 v[156:159], v11 offset:33280
    v_cvt_pk_bf16_f32 v229, v218, v219
    v_mfma_f32_16x16x32_bf16 v[204:207], a[28:31], v[92:95], v[204:207]
    buffer_load_dwordx4 v20, s[12:15], s29 offen offset:1024 lds
    s_waitcnt lgkmcnt(12)
    v_mfma_f32_16x16x32_bf16 v[192:195], a[32:35], v[96:99], v[192:195]
    ds_read_b128 v[160:163], v8 offset:768
    v_mfma_f32_16x16x32_bf16 v[196:199], a[36:39], v[96:99], v[196:199]
    v_cvt_pk_bf16_f32 v230, v220, v221
    v_cvt_pk_bf16_f32 v231, v222, v223
    v_mfma_f32_16x16x32_bf16 v[200:203], a[32:35], v[100:103], v[200:203]
    ds_read_b128 v[164:167], v8 offset:33536
    v_mfma_f32_16x16x32_bf16 v[204:207], a[36:39], v[100:103], v[204:207]
    buffer_load_dwordx4 v21, s[12:15], s29 offen offset:2048 lds
    v_mfma_f32_16x16x32_bf16 v[192:195], a[40:43], v[104:107], v[192:195]
    ds_read_b128 v[168:171], v9 offset:768
    v_mfma_f32_16x16x32_bf16 v[196:199], a[44:47], v[104:107], v[196:199]
    buffer_store_dwordx4 v[228:231], v25, s[8:11], s30 offen sc1
    v_mfma_f32_16x16x32_bf16 v[200:203], a[40:43], v[108:111], v[200:203]
    ds_read_b128 v[172:175], v9 offset:33536
    v_mfma_f32_16x16x32_bf16 v[204:207], a[44:47], v[108:111], v[204:207]
    buffer_load_dwordx4 v21, s[12:15], s29 offen offset:3072 lds
    s_waitcnt lgkmcnt(12)
    v_mfma_f32_16x16x32_bf16 v[192:195], a[48:51], v[112:115], v[192:195]
    ds_read_b128 v[176:179], v10 offset:768
    v_mfma_f32_16x16x32_bf16 v[196:199], a[52:55], v[112:115], v[196:199]
    s_add_u32 m0, s6, 77824
    s_mov_b32 s30, s31
    v_mfma_f32_16x16x32_bf16 v[200:203], a[48:51], v[116:119], v[200:203]
    ds_read_b128 v[180:183], v10 offset:33536
    v_mfma_f32_16x16x32_bf16 v[204:207], a[52:55], v[116:119], v[204:207]
    buffer_load_dwordx4 v22, s[12:15], s29 offen offset:0 lds
    v_mfma_f32_16x16x32_bf16 v[192:195], a[56:59], v[120:123], v[192:195]
    ds_read_b128 v[184:187], v11 offset:768
    v_mfma_f32_16x16x32_bf16 v[196:199], a[60:63], v[120:123], v[196:199]
    s_add_u32 s31, s31, 262144
    v_mfma_f32_16x16x32_bf16 v[200:203], a[56:59], v[124:127], v[200:203]
    ds_read_b128 v[188:191], v11 offset:33536
    v_mfma_f32_16x16x32_bf16 v[204:207], a[60:63], v[124:127], v[204:207]
    buffer_load_dwordx4 v22, s[12:15], s29 offen offset:1024 lds
    s_waitcnt lgkmcnt(12)
    v_mfma_f32_16x16x32_bf16 v[192:195], a[64:67], v[128:131], v[192:195]
    ds_read_b128 v[64:67], v8 offset:1024
    v_mfma_f32_16x16x32_bf16 v[196:199], a[68:71], v[128:131], v[196:199]
    v_mfma_f32_16x16x32_bf16 v[200:203], a[64:67], v[132:135], v[200:203]
    ds_read_b128 v[68:71], v8 offset:33792
    v_mfma_f32_16x16x32_bf16 v[204:207], a[68:71], v[132:135], v[204:207]
    buffer_load_dwordx4 v23, s[12:15], s29 offen offset:2048 lds
    v_mfma_f32_16x16x32_bf16 v[192:195], a[72:75], v[136:139], v[192:195]
    ds_read_b128 v[72:75], v9 offset:1024
    v_mfma_f32_16x16x32_bf16 v[196:199], a[76:79], v[136:139], v[196:199]
    v_mfma_f32_16x16x32_bf16 v[200:203], a[72:75], v[140:143], v[200:203]
    ds_read_b128 v[76:79], v9 offset:33792
    v_mfma_f32_16x16x32_bf16 v[204:207], a[76:79], v[140:143], v[204:207]
    buffer_load_dwordx4 v23, s[12:15], s29 offen offset:3072 lds
    s_waitcnt lgkmcnt(12)
    v_mfma_f32_16x16x32_bf16 v[192:195], a[80:83], v[144:147], v[192:195]
    ds_read_b128 v[80:83], v10 offset:1024
    v_mfma_f32_16x16x32_bf16 v[196:199], a[84:87], v[144:147], v[196:199]
    v_mfma_f32_16x16x32_bf16 v[200:203], a[80:83], v[148:151], v[200:203]
    ds_read_b128 v[84:87], v10 offset:33792
    v_mfma_f32_16x16x32_bf16 v[204:207], a[84:87], v[148:151], v[204:207]
    buffer_load_dword v29, v28, s[12:15], s29 offen
    v_mfma_f32_16x16x32_bf16 v[192:195], a[88:91], v[152:155], v[192:195]
    ds_read_b128 v[88:91], v11 offset:1024
    v_mfma_f32_16x16x32_bf16 v[196:199], a[92:95], v[152:155], v[196:199]
    v_mfma_f32_16x16x32_bf16 v[200:203], a[88:91], v[156:159], v[200:203]
    ds_read_b128 v[92:95], v11 offset:33792
    v_mfma_f32_16x16x32_bf16 v[204:207], a[92:95], v[156:159], v[204:207]
    buffer_store_dwordx4 v[32:35], v36, s[8:11], s34 offen sc1
    s_waitcnt lgkmcnt(12)
    v_mfma_f32_16x16x32_bf16 v[192:195], a[96:99], v[160:163], v[192:195]
    ds_read_b128 v[96:99], v8 offset:1280
    v_mfma_f32_16x16x32_bf16 v[196:199], a[100:103], v[160:163], v[196:199]
    v_mfma_f32_16x16x32_bf16 v[200:203], a[96:99], v[164:167], v[200:203]
    ds_read_b128 v[100:103], v8 offset:34048
    v_mfma_f32_16x16x32_bf16 v[204:207], a[100:103], v[164:167], v[204:207]
    v_mfma_f32_16x16x32_bf16 v[192:195], a[104:107], v[168:171], v[192:195]
    ds_read_b128 v[104:107], v9 offset:1280
    v_mfma_f32_16x16x32_bf16 v[196:199], a[108:111], v[168:171], v[196:199]
    v_mfma_f32_16x16x32_bf16 v[200:203], a[104:107], v[172:175], v[200:203]
    ds_read_b128 v[108:111], v9 offset:34048
    v_mfma_f32_16x16x32_bf16 v[204:207], a[108:111], v[172:175], v[204:207]
    s_waitcnt lgkmcnt(12)
    v_mfma_f32_16x16x32_bf16 v[192:195], a[112:115], v[176:179], v[192:195]
    ds_read_b128 v[112:115], v10 offset:1280
    v_mfma_f32_16x16x32_bf16 v[196:199], a[116:119], v[176:179], v[196:199]
    v_mfma_f32_16x16x32_bf16 v[200:203], a[112:115], v[180:183], v[200:203]
    ds_read_b128 v[116:119], v10 offset:34048
    v_mfma_f32_16x16x32_bf16 v[204:207], a[116:119], v[180:183], v[204:207]
    v_mfma_f32_16x16x32_bf16 v[192:195], a[120:123], v[184:187], v[192:195]
    ds_read_b128 v[120:123], v11 offset:1280
    v_mfma_f32_16x16x32_bf16 v[196:199], a[124:127], v[184:187], v[196:199]
    v_mfma_f32_16x16x32_bf16 v[200:203], a[120:123], v[188:191], v[200:203]
    ds_read_b128 v[124:127], v11 offset:34048
    v_mfma_f32_16x16x32_bf16 v[204:207], a[124:127], v[188:191], v[204:207]
    s_waitcnt lgkmcnt(12)
    v_mfma_f32_16x16x32_bf16 v[192:195], a[128:131], v[64:67], v[192:195]
    ds_read_b128 v[128:131], v8 offset:1536
    v_mfma_f32_16x16x32_bf16 v[196:199], a[132:135], v[64:67], v[196:199]
    v_mfma_f32_16x16x32_bf16 v[200:203], a[128:131], v[68:71], v[200:203]
    ds_read_b128 v[132:135], v8 offset:34304
    v_mfma_f32_16x16x32_bf16 v[204:207], a[132:135], v[68:71], v[204:207]
    v_mfma_f32_16x16x32_bf16 v[192:195], a[136:139], v[72:75], v[192:195]
    ds_read_b128 v[136:139], v9 offset:1536
    v_mfma_f32_16x16x32_bf16 v[196:199], a[140:143], v[72:75], v[196:199]
    s_add_u32 s37, s28, 5
    v_mfma_f32_16x16x32_bf16 v[200:203], a[136:139], v[76:79], v[200:203]
    ds_read_b128 v[140:143], v9 offset:34304
    v_mfma_f32_16x16x32_bf16 v[204:207], a[140:143], v[76:79], v[204:207]
    s_bitcmp1_b32 s37, 0
    s_cselect_b32 s4, 0x84000, 0
    s_waitcnt lgkmcnt(12)
    v_mfma_f32_16x16x32_bf16 v[192:195], a[144:147], v[80:83], v[192:195]
    ds_read_b128 v[144:147], v10 offset:1536
    v_mfma_f32_16x16x32_bf16 v[196:199], a[148:151], v[80:83], v[196:199]
    s_xor_b32 s34, s35, s4
    v_mfma_f32_16x16x32_bf16 v[200:203], a[144:147], v[84:87], v[200:203]
    ds_read_b128 v[148:151], v10 offset:34304
    v_mfma_f32_16x16x32_bf16 v[204:207], a[148:151], v[84:87], v[204:207]
    s_bitcmp1_b32 s37, 1
    s_cselect_b32 s4, 0x101000, 0
    v_mfma_f32_16x16x32_bf16 v[192:195], a[152:155], v[88:91], v[192:195]
    ds_read_b128 v[152:155], v11 offset:1536
    v_mfma_f32_16x16x32_bf16 v[196:199], a[156:159], v[88:91], v[196:199]
    s_xor_b32 s34, s34, s4
    s_lshr_b32 s37, s37, 2
    v_mfma_f32_16x16x32_bf16 v[200:203], a[152:155], v[92:95], v[200:203]
    ds_read_b128 v[156:159], v11 offset:34304
    v_mfma_f32_16x16x32_bf16 v[204:207], a[156:159], v[92:95], v[204:207]
    s_bitcmp1_b32 s63, s37
    s_cselect_b32 s4, 0x2000, 0
    s_waitcnt lgkmcnt(12)
    v_mfma_f32_16x16x32_bf16 v[192:195], a[160:163], v[96:99], v[192:195]
    ds_read_b128 v[160:163], v8 offset:1792
    v_mfma_f32_16x16x32_bf16 v[196:199], a[164:167], v[96:99], v[196:199]
    s_xor_b32 s34, s34, s4
    s_lshl_b32 s37, s37, 21
    v_mfma_f32_16x16x32_bf16 v[200:203], a[160:163], v[100:103], v[200:203]
    ds_read_b128 v[164:167], v8 offset:34560
    v_mfma_f32_16x16x32_bf16 v[204:207], a[164:167], v[100:103], v[204:207]
    s_add_u32 s34, s34, s37
    v_mfma_f32_16x16x32_bf16 v[192:195], a[168:171], v[104:107], v[192:195]
    ds_read_b128 v[168:171], v9 offset:1792
    v_mfma_f32_16x16x32_bf16 v[196:199], a[172:175], v[104:107], v[196:199]
    v_mfma_f32_16x16x32_bf16 v[200:203], a[168:171], v[108:111], v[200:203]
    ds_read_b128 v[172:175], v9 offset:34560
    v_mfma_f32_16x16x32_bf16 v[204:207], a[172:175], v[108:111], v[204:207]
    s_waitcnt lgkmcnt(12)
    v_mfma_f32_16x16x32_bf16 v[192:195], a[176:179], v[112:115], v[192:195]
    ds_read_b128 v[176:179], v10 offset:1792
    v_mfma_f32_16x16x32_bf16 v[196:199], a[180:183], v[112:115], v[196:199]
    s_waitcnt vmcnt(7)
    v_mov_b32 v27, s28
    s_mov_b64 exec, 1
    buffer_store_dword v27, v26, s[8:11], s94 offen sc1
    s_mov_b64 exec, -1
    v_mfma_f32_16x16x32_bf16 v[200:203], a[176:179], v[116:119], v[200:203]
    ds_read_b128 v[180:183], v10 offset:34560
    v_mfma_f32_16x16x32_bf16 v[204:207], a[180:183], v[116:119], v[204:207]
    v_mfma_f32_16x16x32_bf16 v[192:195], a[184:187], v[120:123], v[192:195]
    ds_read_b128 v[184:187], v11 offset:1792
    v_mfma_f32_16x16x32_bf16 v[196:199], a[188:191], v[120:123], v[196:199]
    s_add_u32 s28, s28, 1
    v_mfma_f32_16x16x32_bf16 v[200:203], a[184:187], v[124:127], v[200:203]
    ds_read_b128 v[188:191], v11 offset:34560
    v_mfma_f32_16x16x32_bf16 v[204:207], a[188:191], v[124:127], v[204:207]
    s_waitcnt lgkmcnt(12)
    v_mfma_f32_16x16x32_bf16 v[192:195], a[192:195], v[128:131], v[192:195]
    v_mfma_f32_16x16x32_bf16 v[196:199], a[196:199], v[128:131], v[196:199]
    v_mfma_f32_16x16x32_bf16 v[200:203], a[192:195], v[132:135], v[200:203]
    v_mfma_f32_16x16x32_bf16 v[204:207], a[196:199], v[132:135], v[204:207]
    v_mfma_f32_16x16x32_bf16 v[192:195], a[200:203], v[136:139], v[192:195]
    v_mfma_f32_16x16x32_bf16 v[196:199], a[204:207], v[136:139], v[196:199]
    s_add_u32 s29, s29, 0x10000
    s_and_b32 s29, s29, 0x3fffff
    v_mfma_f32_16x16x32_bf16 v[200:203], a[200:203], v[140:143], v[200:203]
    v_mfma_f32_16x16x32_bf16 v[204:207], a[204:207], v[140:143], v[204:207]
    s_waitcnt vmcnt(3) lgkmcnt(0)
    s_barrier
    v_mfma_f32_16x16x32_bf16 v[192:195], a[208:211], v[144:147], v[192:195]
    ds_read_b128 v[64:67], v12 offset:0
    ds_read_b128 v[68:71], v12 offset:32768
    v_mfma_f32_16x16x32_bf16 v[196:199], a[212:215], v[144:147], v[196:199]
    s_add_u32 m0, s6, 0
    v_mfma_f32_16x16x32_bf16 v[200:203], a[208:211], v[148:151], v[200:203]
    ds_read_b128 v[72:75], v13 offset:0
    ds_read_b128 v[76:79], v13 offset:32768
    v_mfma_f32_16x16x32_bf16 v[204:207], a[212:215], v[148:151], v[204:207]
    buffer_load_dwordx4 v16, s[12:15], s29 offen offset:0 lds
    v_mfma_f32_16x16x32_bf16 v[192:195], a[216:219], v[152:155], v[192:195]
    ds_read_b128 v[80:83], v14 offset:0
    ds_read_b128 v[84:87], v14 offset:32768
    v_mfma_f32_16x16x32_bf16 v[196:199], a[220:223], v[152:155], v[196:199]
    v_mfma_f32_16x16x32_bf16 v[200:203], a[216:219], v[156:159], v[200:203]
    ds_read_b128 v[88:91], v15 offset:0
    ds_read_b128 v[92:95], v15 offset:32768
    v_mfma_f32_16x16x32_bf16 v[204:207], a[220:223], v[156:159], v[204:207]
    buffer_load_dwordx4 v16, s[12:15], s29 offen offset:1024 lds
    v_mfma_f32_16x16x32_bf16 v[192:195], a[224:227], v[160:163], v[192:195]
    ds_read_b128 v[96:99], v12 offset:256
    v_mfma_f32_16x16x32_bf16 v[196:199], a[228:231], v[160:163], v[196:199]
    v_mfma_f32_16x16x32_bf16 v[200:203], a[224:227], v[164:167], v[200:203]
    ds_read_b128 v[100:103], v12 offset:33024
    v_mfma_f32_16x16x32_bf16 v[204:207], a[228:231], v[164:167], v[204:207]
    buffer_load_dwordx4 v17, s[12:15], s29 offen offset:2048 lds
    v_mfma_f32_16x16x32_bf16 v[192:195], a[232:235], v[168:171], v[192:195]
    ds_read_b128 v[104:107], v13 offset:256
    v_mfma_f32_16x16x32_bf16 v[196:199], a[236:239], v[168:171], v[196:199]
    v_mfma_f32_16x16x32_bf16 v[200:203], a[232:235], v[172:175], v[200:203]
    ds_read_b128 v[108:111], v13 offset:33024
    v_mfma_f32_16x16x32_bf16 v[204:207], a[236:239], v[172:175], v[204:207]
    buffer_load_dwordx4 v17, s[12:15], s29 offen offset:3072 lds
    v_mfma_f32_16x16x32_bf16 v[192:195], a[240:243], v[176:179], v[192:195]
    ds_read_b128 v[112:115], v14 offset:256
    v_mfma_f32_16x16x32_bf16 v[196:199], a[244:247], v[176:179], v[196:199]
    s_add_u32 m0, s6, 4096
    v_mfma_f32_16x16x32_bf16 v[200:203], a[240:243], v[180:183], v[200:203]
    ds_read_b128 v[116:119], v14 offset:33024
    v_mfma_f32_16x16x32_bf16 v[204:207], a[244:247], v[180:183], v[204:207]
    buffer_load_dwordx4 v18, s[12:15], s29 offen offset:0 lds
    v_mfma_f32_16x16x32_bf16 v[192:195], a[248:251], v[184:187], v[192:195]
    ds_read_b128 v[120:123], v15 offset:256
    v_mfma_f32_16x16x32_bf16 v[196:199], a[252:255], v[184:187], v[196:199]
    v_mfma_f32_16x16x32_bf16 v[200:203], a[248:251], v[188:191], v[200:203]
    ds_read_b128 v[124:127], v15 offset:33024
    v_mfma_f32_16x16x32_bf16 v[204:207], a[252:255], v[188:191], v[204:207]
    buffer_load_dwordx4 v18, s[12:15], s29 offen offset:1024 lds
    s_waitcnt lgkmcnt(12)
    v_mfma_f32_16x16x32_bf16 v[208:211], a[0:3], v[64:67], 0
    ds_read_b128 v[128:131], v12 offset:512
    v_mfma_f32_16x16x32_bf16 v[212:215], a[4:7], v[64:67], 0
    v_mfma_f32_16x16x32_bf16 v[216:219], a[0:3], v[68:71], 0
    ds_read_b128 v[132:135], v12 offset:33280
    v_mfma_f32_16x16x32_bf16 v[220:223], a[4:7], v[68:71], 0
    buffer_load_dwordx4 v19, s[12:15], s29 offen offset:2048 lds
    v_mfma_f32_16x16x32_bf16 v[208:211], a[8:11], v[72:75], v[208:211]
    ds_read_b128 v[136:139], v13 offset:512
    v_mfma_f32_16x16x32_bf16 v[212:215], a[12:15], v[72:75], v[212:215]
    v_cvt_pk_bf16_f32 v224, v192, v193
    v_cvt_pk_bf16_f32 v225, v194, v195
    v_mfma_f32_16x16x32_bf16 v[216:219], a[8:11], v[76:79], v[216:219]
    ds_read_b128 v[140:143], v13 offset:33280
    v_mfma_f32_16x16x32_bf16 v[220:223], a[12:15], v[76:79], v[220:223]
    buffer_load_dwordx4 v19, s[12:15], s29 offen offset:3072 lds
    s_waitcnt lgkmcnt(12)
    v_mfma_f32_16x16x32_bf16 v[208:211], a[16:19], v[80:83], v[208:211]
    ds_read_b128 v[144:147], v14 offset:512
    v_mfma_f32_16x16x32_bf16 v[212:215], a[20:23], v[80:83], v[212:215]
    s_add_u32 m0, s6, 8192
    v_cvt_pk_bf16_f32 v226, v196, v197
    v_cvt_pk_bf16_f32 v227, v198, v199
    v_mfma_f32_16x16x32_bf16 v[216:219], a[16:19], v[84:87], v[216:219]
    ds_read_b128 v[148:151], v14 offset:33280
    v_mfma_f32_16x16x32_bf16 v[220:223], a[20:23], v[84:87], v[220:223]
    buffer_load_dwordx4 v20, s[12:15], s29 offen offset:0 lds
    v_mfma_f32_16x16x32_bf16 v[208:211], a[24:27], v[88:91], v[208:211]
    ds_read_b128 v[152:155], v15 offset:512
    v_cvt_pk_bf16_f32 v228, v200, v201
    v_mfma_f32_16x16x32_bf16 v[212:215], a[28:31], v[88:91], v[212:215]
    buffer_store_dwordx4 v[224:227], v24, s[8:11], s30 offen sc1
    v_mfma_f32_16x16x32_bf16 v[216:219], a[24:27], v[92:95], v[216:219]
    ds_read_b128 v[156:159], v15 offset:33280
    v_cvt_pk_bf16_f32 v229, v202, v203
    v_mfma_f32_16x16x32_bf16 v[220:223], a[28:31], v[92:95], v[220:223]
    buffer_load_dwordx4 v20, s[12:15], s29 offen offset:1024 lds
    s_waitcnt lgkmcnt(12)
    v_mfma_f32_16x16x32_bf16 v[208:211], a[32:35], v[96:99], v[208:211]
    ds_read_b128 v[160:163], v12 offset:768
    v_mfma_f32_16x16x32_bf16 v[212:215], a[36:39], v[96:99], v[212:215]
    v_cvt_pk_bf16_f32 v230, v204, v205
    v_cvt_pk_bf16_f32 v231, v206, v207
    v_mfma_f32_16x16x32_bf16 v[216:219], a[32:35], v[100:103], v[216:219]
    ds_read_b128 v[164:167], v12 offset:33536
    v_mfma_f32_16x16x32_bf16 v[220:223], a[36:39], v[100:103], v[220:223]
    buffer_load_dwordx4 v21, s[12:15], s29 offen offset:2048 lds
    v_mfma_f32_16x16x32_bf16 v[208:211], a[40:43], v[104:107], v[208:211]
    ds_read_b128 v[168:171], v13 offset:768
    v_mfma_f32_16x16x32_bf16 v[212:215], a[44:47], v[104:107], v[212:215]
    buffer_store_dwordx4 v[228:231], v25, s[8:11], s30 offen sc1
    v_mfma_f32_16x16x32_bf16 v[216:219], a[40:43], v[108:111], v[216:219]
    ds_read_b128 v[172:175], v13 offset:33536
    v_mfma_f32_16x16x32_bf16 v[220:223], a[44:47], v[108:111], v[220:223]
    buffer_load_dwordx4 v21, s[12:15], s29 offen offset:3072 lds
    s_waitcnt lgkmcnt(12)
    v_mfma_f32_16x16x32_bf16 v[208:211], a[48:51], v[112:115], v[208:211]
    ds_read_b128 v[176:179], v14 offset:768
    v_mfma_f32_16x16x32_bf16 v[212:215], a[52:55], v[112:115], v[212:215]
    s_add_u32 m0, s6, 12288
    s_mov_b32 s30, s31
    v_mfma_f32_16x16x32_bf16 v[216:219], a[48:51], v[116:119], v[216:219]
    ds_read_b128 v[180:183], v14 offset:33536
    v_mfma_f32_16x16x32_bf16 v[220:223], a[52:55], v[116:119], v[220:223]
    buffer_load_dwordx4 v22, s[12:15], s29 offen offset:0 lds
    v_mfma_f32_16x16x32_bf16 v[208:211], a[56:59], v[120:123], v[208:211]
    ds_read_b128 v[184:187], v15 offset:768
    v_mfma_f32_16x16x32_bf16 v[212:215], a[60:63], v[120:123], v[212:215]
    s_add_u32 s31, s31, 262144
    v_mfma_f32_16x16x32_bf16 v[216:219], a[56:59], v[124:127], v[216:219]
    ds_read_b128 v[188:191], v15 offset:33536
    v_mfma_f32_16x16x32_bf16 v[220:223], a[60:63], v[124:127], v[220:223]
    buffer_load_dwordx4 v22, s[12:15], s29 offen offset:1024 lds
    s_waitcnt lgkmcnt(12)
    v_mfma_f32_16x16x32_bf16 v[208:211], a[64:67], v[128:131], v[208:211]
    ds_read_b128 v[64:67], v12 offset:1024
    v_mfma_f32_16x16x32_bf16 v[212:215], a[68:71], v[128:131], v[212:215]
    v_mfma_f32_16x16x32_bf16 v[216:219], a[64:67], v[132:135], v[216:219]
    ds_read_b128 v[68:71], v12 offset:33792
    v_mfma_f32_16x16x32_bf16 v[220:223], a[68:71], v[132:135], v[220:223]
    buffer_load_dwordx4 v23, s[12:15], s29 offen offset:2048 lds
    v_mfma_f32_16x16x32_bf16 v[208:211], a[72:75], v[136:139], v[208:211]
    ds_read_b128 v[72:75], v13 offset:1024
    v_mfma_f32_16x16x32_bf16 v[212:215], a[76:79], v[136:139], v[212:215]
    v_mfma_f32_16x16x32_bf16 v[216:219], a[72:75], v[140:143], v[216:219]
    ds_read_b128 v[76:79], v13 offset:33792
    v_mfma_f32_16x16x32_bf16 v[220:223], a[76:79], v[140:143], v[220:223]
    buffer_load_dwordx4 v23, s[12:15], s29 offen offset:3072 lds
    s_waitcnt lgkmcnt(12)
    v_mfma_f32_16x16x32_bf16 v[208:211], a[80:83], v[144:147], v[208:211]
    ds_read_b128 v[80:83], v14 offset:1024
    v_mfma_f32_16x16x32_bf16 v[212:215], a[84:87], v[144:147], v[212:215]
    v_mfma_f32_16x16x32_bf16 v[216:219], a[80:83], v[148:151], v[216:219]
    ds_read_b128 v[84:87], v14 offset:33792
    v_mfma_f32_16x16x32_bf16 v[220:223], a[84:87], v[148:151], v[220:223]
    buffer_load_dword v29, v28, s[12:15], s29 offen
    v_mfma_f32_16x16x32_bf16 v[208:211], a[88:91], v[152:155], v[208:211]
    ds_read_b128 v[88:91], v15 offset:1024
    v_mfma_f32_16x16x32_bf16 v[212:215], a[92:95], v[152:155], v[212:215]
    v_mfma_f32_16x16x32_bf16 v[216:219], a[88:91], v[156:159], v[216:219]
    ds_read_b128 v[92:95], v15 offset:33792
    v_mfma_f32_16x16x32_bf16 v[220:223], a[92:95], v[156:159], v[220:223]
    buffer_store_dwordx4 v[32:35], v36, s[8:11], s34 offen sc1
    s_waitcnt lgkmcnt(12)
    v_mfma_f32_16x16x32_bf16 v[208:211], a[96:99], v[160:163], v[208:211]
    ds_read_b128 v[96:99], v12 offset:1280
    v_mfma_f32_16x16x32_bf16 v[212:215], a[100:103], v[160:163], v[212:215]
    v_mfma_f32_16x16x32_bf16 v[216:219], a[96:99], v[164:167], v[216:219]
    ds_read_b128 v[100:103], v12 offset:34048
    v_mfma_f32_16x16x32_bf16 v[220:223], a[100:103], v[164:167], v[220:223]
    v_mfma_f32_16x16x32_bf16 v[208:211], a[104:107], v[168:171], v[208:211]
    ds_read_b128 v[104:107], v13 offset:1280
    v_mfma_f32_16x16x32_bf16 v[212:215], a[108:111], v[168:171], v[212:215]
    v_mfma_f32_16x16x32_bf16 v[216:219], a[104:107], v[172:175], v[216:219]
    ds_read_b128 v[108:111], v13 offset:34048
    v_mfma_f32_16x16x32_bf16 v[220:223], a[108:111], v[172:175], v[220:223]
    s_waitcnt lgkmcnt(12)
    v_mfma_f32_16x16x32_bf16 v[208:211], a[112:115], v[176:179], v[208:211]
    ds_read_b128 v[112:115], v14 offset:1280
    v_mfma_f32_16x16x32_bf16 v[212:215], a[116:119], v[176:179], v[212:215]
    v_mfma_f32_16x16x32_bf16 v[216:219], a[112:115], v[180:183], v[216:219]
    ds_read_b128 v[116:119], v14 offset:34048
    v_mfma_f32_16x16x32_bf16 v[220:223], a[116:119], v[180:183], v[220:223]
    v_mfma_f32_16x16x32_bf16 v[208:211], a[120:123], v[184:187], v[208:211]
    ds_read_b128 v[120:123], v15 offset:1280
    v_mfma_f32_16x16x32_bf16 v[212:215], a[124:127], v[184:187], v[212:215]
    v_mfma_f32_16x16x32_bf16 v[216:219], a[120:123], v[188:191], v[216:219]
    ds_read_b128 v[124:127], v15 offset:34048
    v_mfma_f32_16x16x32_bf16 v[220:223], a[124:127], v[188:191], v[220:223]
    s_waitcnt lgkmcnt(12)
    v_mfma_f32_16x16x32_bf16 v[208:211], a[128:131], v[64:67], v[208:211]
    ds_read_b128 v[128:131], v12 offset:1536
    v_mfma_f32_16x16x32_bf16 v[212:215], a[132:135], v[64:67], v[212:215]
    v_mfma_f32_16x16x32_bf16 v[216:219], a[128:131], v[68:71], v[216:219]
    ds_read_b128 v[132:135], v12 offset:34304
    v_mfma_f32_16x16x32_bf16 v[220:223], a[132:135], v[68:71], v[220:223]
    v_mfma_f32_16x16x32_bf16 v[208:211], a[136:139], v[72:75], v[208:211]
    ds_read_b128 v[136:139], v13 offset:1536
    v_mfma_f32_16x16x32_bf16 v[212:215], a[140:143], v[72:75], v[212:215]
    s_add_u32 s37, s28, 5
    v_mfma_f32_16x16x32_bf16 v[216:219], a[136:139], v[76:79], v[216:219]
    ds_read_b128 v[140:143], v13 offset:34304
    v_mfma_f32_16x16x32_bf16 v[220:223], a[140:143], v[76:79], v[220:223]
    s_bitcmp1_b32 s37, 0
    s_cselect_b32 s4, 0x84000, 0
    s_waitcnt lgkmcnt(12)
    v_mfma_f32_16x16x32_bf16 v[208:211], a[144:147], v[80:83], v[208:211]
    ds_read_b128 v[144:147], v14 offset:1536
    v_mfma_f32_16x16x32_bf16 v[212:215], a[148:151], v[80:83], v[212:215]
    s_xor_b32 s34, s35, s4
    v_mfma_f32_16x16x32_bf16 v[216:219], a[144:147], v[84:87], v[216:219]
    ds_read_b128 v[148:151], v14 offset:34304
    v_mfma_f32_16x16x32_bf16 v[220:223], a[148:151], v[84:87], v[220:223]
    s_bitcmp1_b32 s37, 1
    s_cselect_b32 s4, 0x101000, 0
    v_mfma_f32_16x16x32_bf16 v[208:211], a[152:155], v[88:91], v[208:211]
    ds_read_b128 v[152:155], v15 offset:1536
    v_mfma_f32_16x16x32_bf16 v[212:215], a[156:159], v[88:91], v[212:215]
    s_xor_b32 s34, s34, s4
    s_lshr_b32 s37, s37, 2
    v_mfma_f32_16x16x32_bf16 v[216:219], a[152:155], v[92:95], v[216:219]
    ds_read_b128 v[156:159], v15 offset:34304
    v_mfma_f32_16x16x32_bf16 v[220:223], a[156:159], v[92:95], v[220:223]
    s_bitcmp1_b32 s63, s37
    s_cselect_b32 s4, 0x2000, 0
    s_waitcnt lgkmcnt(12)
    v_mfma_f32_16x16x32_bf16 v[208:211], a[160:163], v[96:99], v[208:211]
    ds_read_b128 v[160:163], v12 offset:1792
    v_mfma_f32_16x16x32_bf16 v[212:215], a[164:167], v[96:99], v[212:215]
    s_xor_b32 s34, s34, s4
    s_lshl_b32 s37, s37, 21
    v_mfma_f32_16x16x32_bf16 v[216:219], a[160:163], v[100:103], v[216:219]
    ds_read_b128 v[164:167], v12 offset:34560
    v_mfma_f32_16x16x32_bf16 v[220:223], a[164:167], v[100:103], v[220:223]
    s_add_u32 s34, s34, s37
    v_mfma_f32_16x16x32_bf16 v[208:211], a[168:171], v[104:107], v[208:211]
    ds_read_b128 v[168:171], v13 offset:1792
    v_mfma_f32_16x16x32_bf16 v[212:215], a[172:175], v[104:107], v[212:215]
    v_mfma_f32_16x16x32_bf16 v[216:219], a[168:171], v[108:111], v[216:219]
    ds_read_b128 v[172:175], v13 offset:34560
    v_mfma_f32_16x16x32_bf16 v[220:223], a[172:175], v[108:111], v[220:223]
    s_waitcnt lgkmcnt(12)
    v_mfma_f32_16x16x32_bf16 v[208:211], a[176:179], v[112:115], v[208:211]
    ds_read_b128 v[176:179], v14 offset:1792
    v_mfma_f32_16x16x32_bf16 v[212:215], a[180:183], v[112:115], v[212:215]
    s_waitcnt vmcnt(7)
    v_mov_b32 v27, s28
    s_mov_b64 exec, 1
    buffer_store_dword v27, v26, s[8:11], s94 offen sc1
    s_mov_b64 exec, -1
    v_mfma_f32_16x16x32_bf16 v[216:219], a[176:179], v[116:119], v[216:219]
    ds_read_b128 v[180:183], v14 offset:34560
    v_mfma_f32_16x16x32_bf16 v[220:223], a[180:183], v[116:119], v[220:223]
    v_mfma_f32_16x16x32_bf16 v[208:211], a[184:187], v[120:123], v[208:211]
    ds_read_b128 v[184:187], v15 offset:1792
    v_mfma_f32_16x16x32_bf16 v[212:215], a[188:191], v[120:123], v[212:215]
    s_add_u32 s28, s28, 1
    v_mfma_f32_16x16x32_bf16 v[216:219], a[184:187], v[124:127], v[216:219]
    ds_read_b128 v[188:191], v15 offset:34560
    v_mfma_f32_16x16x32_bf16 v[220:223], a[188:191], v[124:127], v[220:223]
    s_waitcnt lgkmcnt(12)
    v_mfma_f32_16x16x32_bf16 v[208:211], a[192:195], v[128:131], v[208:211]
    v_mfma_f32_16x16x32_bf16 v[212:215], a[196:199], v[128:131], v[212:215]
    v_mfma_f32_16x16x32_bf16 v[216:219], a[192:195], v[132:135], v[216:219]
    v_mfma_f32_16x16x32_bf16 v[220:223], a[196:199], v[132:135], v[220:223]
    v_mfma_f32_16x16x32_bf16 v[208:211], a[200:203], v[136:139], v[208:211]
    v_mfma_f32_16x16x32_bf16 v[212:215], a[204:207], v[136:139], v[212:215]
    s_add_u32 s29, s29, 0x10000
    s_and_b32 s29, s29, 0x3fffff
    v_mfma_f32_16x16x32_bf16 v[216:219], a[200:203], v[140:143], v[216:219]
    v_mfma_f32_16x16x32_bf16 v[220:223], a[204:207], v[140:143], v[220:223]
    s_waitcnt vmcnt(3) lgkmcnt(0)
    s_barrier
    v_mfma_f32_16x16x32_bf16 v[208:211], a[208:211], v[144:147], v[208:211]
    ds_read_b128 v[64:67], v8 offset:0
    ds_read_b128 v[68:71], v8 offset:32768
    v_mfma_f32_16x16x32_bf16 v[212:215], a[212:215], v[144:147], v[212:215]
    s_add_u32 m0, s6, 65536
    v_mfma_f32_16x16x32_bf16 v[216:219], a[208:211], v[148:151], v[216:219]
    ds_read_b128 v[72:75], v9 offset:0
    ds_read_b128 v[76:79], v9 offset:32768
    v_mfma_f32_16x16x32_bf16 v[220:223], a[212:215], v[148:151], v[220:223]
    buffer_load_dwordx4 v16, s[12:15], s29 offen offset:0 lds
    v_mfma_f32_16x16x32_bf16 v[208:211], a[216:219], v[152:155], v[208:211]
    ds_read_b128 v[80:83], v10 offset:0
    ds_read_b128 v[84:87], v10 offset:32768
    v_mfma_f32_16x16x32_bf16 v[212:215], a[220:223], v[152:155], v[212:215]
    v_mfma_f32_16x16x32_bf16 v[216:219], a[216:219], v[156:159], v[216:219]
    ds_read_b128 v[88:91], v11 offset:0
    ds_read_b128 v[92:95], v11 offset:32768
    v_mfma_f32_16x16x32_bf16 v[220:223], a[220:223], v[156:159], v[220:223]
    buffer_load_dwordx4 v16, s[12:15], s29 offen offset:1024 lds
    v_mfma_f32_16x16x32_bf16 v[208:211], a[224:227], v[160:163], v[208:211]
    ds_read_b128 v[96:99], v8 offset:256
    v_mfma_f32_16x16x32_bf16 v[212:215], a[228:231], v[160:163], v[212:215]
    v_mfma_f32_16x16x32_bf16 v[216:219], a[224:227], v[164:167], v[216:219]
    ds_read_b128 v[100:103], v8 offset:33024
    v_mfma_f32_16x16x32_bf16 v[220:223], a[228:231], v[164:167], v[220:223]
    buffer_load_dwordx4 v17, s[12:15], s29 offen offset:2048 lds
    v_mfma_f32_16x16x32_bf16 v[208:211], a[232:235], v[168:171], v[208:211]
    ds_read_b128 v[104:107], v9 offset:256
    v_mfma_f32_16x16x32_bf16 v[212:215], a[236:239], v[168:171], v[212:215]
    v_mfma_f32_16x16x32_bf16 v[216:219], a[232:235], v[172:175], v[216:219]
    ds_read_b128 v[108:111], v9 offset:33024
    v_mfma_f32_16x16x32_bf16 v[220:223], a[236:239], v[172:175], v[220:223]
    buffer_load_dwordx4 v17, s[12:15], s29 offen offset:3072 lds
    v_mfma_f32_16x16x32_bf16 v[208:211], a[240:243], v[176:179], v[208:211]
    ds_read_b128 v[112:115], v10 offset:256
    v_mfma_f32_16x16x32_bf16 v[212:215], a[244:247], v[176:179], v[212:215]
    s_add_u32 m0, s6, 69632
    v_mfma_f32_16x16x32_bf16 v[216:219], a[240:243], v[180:183], v[216:219]
    ds_read_b128 v[116:119], v10 offset:33024
    v_mfma_f32_16x16x32_bf16 v[220:223], a[244:247], v[180:183], v[220:223]
    buffer_load_dwordx4 v18, s[12:15], s29 offen offset:0 lds
    v_mfma_f32_16x16x32_bf16 v[208:211], a[248:251], v[184:187], v[208:211]
    ds_read_b128 v[120:123], v11 offset:256
    v_mfma_f32_16x16x32_bf16 v[212:215], a[252:255], v[184:187], v[212:215]
    v_mfma_f32_16x16x32_bf16 v[216:219], a[248:251], v[188:191], v[216:219]
    ds_read_b128 v[124:127], v11 offset:33024
    v_mfma_f32_16x16x32_bf16 v[220:223], a[252:255], v[188:191], v[220:223]
    buffer_load_dwordx4 v18, s[12:15], s29 offen offset:1024 lds
    s_cmp_lt_u32 s28, 64
    s_cbranch_scc1 .ql_411
    s_branch .qe_410
.vt_409:
.p2align 6
.ql_412:
    s_waitcnt lgkmcnt(12)
    v_mfma_f32_16x16x32_bf16 v[192:195], v[64:67], a[0:3], 0
    ds_read_b128 v[128:131], v8 offset:512
    v_mfma_f32_16x16x32_bf16 v[200:203], v[64:67], a[4:7], 0
    v_mfma_f32_16x16x32_bf16 v[196:199], v[68:71], a[0:3], 0
    ds_read_b128 v[132:135], v8 offset:33280
    v_mfma_f32_16x16x32_bf16 v[204:207], v[68:71], a[4:7], 0
    buffer_load_dwordx4 v19, s[12:15], s29 offen offset:2048 lds
    v_mfma_f32_16x16x32_bf16 v[192:195], v[72:75], a[8:11], v[192:195]
    ds_read_b128 v[136:139], v9 offset:512
    v_mfma_f32_16x16x32_bf16 v[200:203], v[72:75], a[12:15], v[200:203]
    v_cvt_pk_bf16_f32 v224, v208, v209
    v_cvt_pk_bf16_f32 v225, v210, v211
    v_mfma_f32_16x16x32_bf16 v[196:199], v[76:79], a[8:11], v[196:199]
    ds_read_b128 v[140:143], v9 offset:33280
    v_mfma_f32_16x16x32_bf16 v[204:207], v[76:79], a[12:15], v[204:207]
    buffer_load_dwordx4 v19, s[12:15], s29 offen offset:3072 lds
    s_waitcnt lgkmcnt(12)
    v_mfma_f32_16x16x32_bf16 v[192:195], v[80:83], a[16:19], v[192:195]
    ds_read_b128 v[144:147], v10 offset:512
    v_mfma_f32_16x16x32_bf16 v[200:203], v[80:83], a[20:23], v[200:203]
    s_add_u32 m0, s6, 73728
    v_cvt_pk_bf16_f32 v226, v212, v213
    v_cvt_pk_bf16_f32 v227, v214, v215
    v_mfma_f32_16x16x32_bf16 v[196:199], v[84:87], a[16:19], v[196:199]
    ds_read_b128 v[148:151], v10 offset:33280
    v_mfma_f32_16x16x32_bf16 v[204:207], v[84:87], a[20:23], v[204:207]
    buffer_load_dwordx4 v20, s[12:15], s29 offen offset:0 lds
    v_mfma_f32_16x16x32_bf16 v[192:195], v[88:91], a[24:27], v[192:195]
    ds_read_b128 v[152:155], v11 offset:512
    v_cvt_pk_bf16_f32 v228, v216, v217
    v_mfma_f32_16x16x32_bf16 v[200:203], v[88:91], a[28:31], v[200:203]
    buffer_store_dwordx4 v[224:227], v24, s[8:11], s30 offen sc1
    v_mfma_f32_16x16x32_bf16 v[196:199], v[92:95], a[24:27], v[196:199]
    ds_read_b128 v[156:159], v11 offset:33280
    v_cvt_pk_bf16_f32 v229, v218, v219
    v_mfma_f32_16x16x32_bf16 v[204:207], v[92:95], a[28:31], v[204:207]
    buffer_load_dwordx4 v20, s[12:15], s29 offen offset:1024 lds
    s_waitcnt lgkmcnt(12)
    v_mfma_f32_16x16x32_bf16 v[192:195], v[96:99], a[32:35], v[192:195]
    ds_read_b128 v[160:163], v8 offset:768
    v_mfma_f32_16x16x32_bf16 v[200:203], v[96:99], a[36:39], v[200:203]
    v_cvt_pk_bf16_f32 v230, v220, v221
    v_cvt_pk_bf16_f32 v231, v222, v223
    v_mfma_f32_16x16x32_bf16 v[196:199], v[100:103], a[32:35], v[196:199]
    ds_read_b128 v[164:167], v8 offset:33536
    v_mfma_f32_16x16x32_bf16 v[204:207], v[100:103], a[36:39], v[204:207]
    buffer_load_dwordx4 v21, s[12:15], s29 offen offset:2048 lds
    v_mfma_f32_16x16x32_bf16 v[192:195], v[104:107], a[40:43], v[192:195]
    ds_read_b128 v[168:171], v9 offset:768
    v_mfma_f32_16x16x32_bf16 v[200:203], v[104:107], a[44:47], v[200:203]
    buffer_store_dwordx4 v[228:231], v25, s[8:11], s30 offen sc1
    v_mfma_f32_16x16x32_bf16 v[196:199], v[108:111], a[40:43], v[196:199]
    ds_read_b128 v[172:175], v9 offset:33536
    v_mfma_f32_16x16x32_bf16 v[204:207], v[108:111], a[44:47], v[204:207]
    buffer_load_dwordx4 v21, s[12:15], s29 offen offset:3072 lds
    s_waitcnt lgkmcnt(12)
    v_mfma_f32_16x16x32_bf16 v[192:195], v[112:115], a[48:51], v[192:195]
    ds_read_b128 v[176:179], v10 offset:768
    v_mfma_f32_16x16x32_bf16 v[200:203], v[112:115], a[52:55], v[200:203]
    s_add_u32 m0, s6, 77824
    s_mov_b32 s30, s31
    v_mfma_f32_16x16x32_bf16 v[196:199], v[116:119], a[48:51], v[196:199]
    ds_read_b128 v[180:183], v10 offset:33536
    v_mfma_f32_16x16x32_bf16 v[204:207], v[116:119], a[52:55], v[204:207]
    buffer_load_dwordx4 v22, s[12:15], s29 offen offset:0 lds
    v_mfma_f32_16x16x32_bf16 v[192:195], v[120:123], a[56:59], v[192:195]
    ds_read_b128 v[184:187], v11 offset:768
    v_mfma_f32_16x16x32_bf16 v[200:203], v[120:123], a[60:63], v[200:203]
    s_add_u32 s31, s31, 262144
    v_mfma_f32_16x16x32_bf16 v[196:199], v[124:127], a[56:59], v[196:199]
    ds_read_b128 v[188:191], v11 offset:33536
    v_mfma_f32_16x16x32_bf16 v[204:207], v[124:127], a[60:63], v[204:207]
    buffer_load_dwordx4 v22, s[12:15], s29 offen offset:1024 lds
    s_waitcnt lgkmcnt(12)
    v_mfma_f32_16x16x32_bf16 v[192:195], v[128:131], a[64:67], v[192:195]
    ds_read_b128 v[64:67], v8 offset:1024
    v_mfma_f32_16x16x32_bf16 v[200:203], v[128:131], a[68:71], v[200:203]
    v_mfma_f32_16x16x32_bf16 v[196:199], v[132:135], a[64:67], v[196:199]
    ds_read_b128 v[68:71], v8 offset:33792
    v_mfma_f32_16x16x32_bf16 v[204:207], v[132:135], a[68:71], v[204:207]
    buffer_load_dwordx4 v23, s[12:15], s29 offen offset:2048 lds
    v_mfma_f32_16x16x32_bf16 v[192:195], v[136:139], a[72:75], v[192:195]
    ds_read_b128 v[72:75], v9 offset:1024
    v_mfma_f32_16x16x32_bf16 v[200:203], v[136:139], a[76:79], v[200:203]
    v_mfma_f32_16x16x32_bf16 v[196:199], v[140:143], a[72:75], v[196:199]
    ds_read_b128 v[76:79], v9 offset:33792
    v_mfma_f32_16x16x32_bf16 v[204:207], v[140:143], a[76:79], v[204:207]
    buffer_load_dwordx4 v23, s[12:15], s29 offen offset:3072 lds
    s_waitcnt lgkmcnt(12)
    v_mfma_f32_16x16x32_bf16 v[192:195], v[144:147], a[80:83], v[192:195]
    ds_read_b128 v[80:83], v10 offset:1024
    v_mfma_f32_16x16x32_bf16 v[200:203], v[144:147], a[84:87], v[200:203]
    v_mfma_f32_16x16x32_bf16 v[196:199], v[148:151], a[80:83], v[196:199]
    ds_read_b128 v[84:87], v10 offset:33792
    v_mfma_f32_16x16x32_bf16 v[204:207], v[148:151], a[84:87], v[204:207]
    buffer_load_dword v29, v28, s[12:15], s29 offen
    v_mfma_f32_16x16x32_bf16 v[192:195], v[152:155], a[88:91], v[192:195]
    ds_read_b128 v[88:91], v11 offset:1024
    v_mfma_f32_16x16x32_bf16 v[200:203], v[152:155], a[92:95], v[200:203]
    v_mfma_f32_16x16x32_bf16 v[196:199], v[156:159], a[88:91], v[196:199]
    ds_read_b128 v[92:95], v11 offset:33792
    v_mfma_f32_16x16x32_bf16 v[204:207], v[156:159], a[92:95], v[204:207]
    buffer_store_dwordx4 v[32:35], v36, s[8:11], s34 offen sc1
    s_waitcnt lgkmcnt(12)
    v_mfma_f32_16x16x32_bf16 v[192:195], v[160:163], a[96:99], v[192:195]
    ds_read_b128 v[96:99], v8 offset:1280
    v_mfma_f32_16x16x32_bf16 v[200:203], v[160:163], a[100:103], v[200:203]
    v_mfma_f32_16x16x32_bf16 v[196:199], v[164:167], a[96:99], v[196:199]
    ds_read_b128 v[100:103], v8 offset:34048
    v_mfma_f32_16x16x32_bf16 v[204:207], v[164:167], a[100:103], v[204:207]
    v_mfma_f32_16x16x32_bf16 v[192:195], v[168:171], a[104:107], v[192:195]
    ds_read_b128 v[104:107], v9 offset:1280
    v_mfma_f32_16x16x32_bf16 v[200:203], v[168:171], a[108:111], v[200:203]
    v_mfma_f32_16x16x32_bf16 v[196:199], v[172:175], a[104:107], v[196:199]
    ds_read_b128 v[108:111], v9 offset:34048
    v_mfma_f32_16x16x32_bf16 v[204:207], v[172:175], a[108:111], v[204:207]
    s_waitcnt lgkmcnt(12)
    v_mfma_f32_16x16x32_bf16 v[192:195], v[176:179], a[112:115], v[192:195]
    ds_read_b128 v[112:115], v10 offset:1280
    v_mfma_f32_16x16x32_bf16 v[200:203], v[176:179], a[116:119], v[200:203]
    v_mfma_f32_16x16x32_bf16 v[196:199], v[180:183], a[112:115], v[196:199]
    ds_read_b128 v[116:119], v10 offset:34048
    v_mfma_f32_16x16x32_bf16 v[204:207], v[180:183], a[116:119], v[204:207]
    v_mfma_f32_16x16x32_bf16 v[192:195], v[184:187], a[120:123], v[192:195]
    ds_read_b128 v[120:123], v11 offset:1280
    v_mfma_f32_16x16x32_bf16 v[200:203], v[184:187], a[124:127], v[200:203]
    v_mfma_f32_16x16x32_bf16 v[196:199], v[188:191], a[120:123], v[196:199]
    ds_read_b128 v[124:127], v11 offset:34048
    v_mfma_f32_16x16x32_bf16 v[204:207], v[188:191], a[124:127], v[204:207]
    s_waitcnt lgkmcnt(12)
    v_mfma_f32_16x16x32_bf16 v[192:195], v[64:67], a[128:131], v[192:195]
    ds_read_b128 v[128:131], v8 offset:1536
    v_mfma_f32_16x16x32_bf16 v[200:203], v[64:67], a[132:135], v[200:203]
    v_mfma_f32_16x16x32_bf16 v[196:199], v[68:71], a[128:131], v[196:199]
    ds_read_b128 v[132:135], v8 offset:34304
    v_mfma_f32_16x16x32_bf16 v[204:207], v[68:71], a[132:135], v[204:207]
    v_mfma_f32_16x16x32_bf16 v[192:195], v[72:75], a[136:139], v[192:195]
    ds_read_b128 v[136:139], v9 offset:1536
    v_mfma_f32_16x16x32_bf16 v[200:203], v[72:75], a[140:143], v[200:203]
    s_add_u32 s37, s28, 5
    v_mfma_f32_16x16x32_bf16 v[196:199], v[76:79], a[136:139], v[196:199]
    ds_read_b128 v[140:143], v9 offset:34304
    v_mfma_f32_16x16x32_bf16 v[204:207], v[76:79], a[140:143], v[204:207]
    s_bitcmp1_b32 s37, 0
    s_cselect_b32 s4, 0x84000, 0
    s_waitcnt lgkmcnt(12)
    v_mfma_f32_16x16x32_bf16 v[192:195], v[80:83], a[144:147], v[192:195]
    ds_read_b128 v[144:147], v10 offset:1536
    v_mfma_f32_16x16x32_bf16 v[200:203], v[80:83], a[148:151], v[200:203]
    s_xor_b32 s34, s35, s4
    v_mfma_f32_16x16x32_bf16 v[196:199], v[84:87], a[144:147], v[196:199]
    ds_read_b128 v[148:151], v10 offset:34304
    v_mfma_f32_16x16x32_bf16 v[204:207], v[84:87], a[148:151], v[204:207]
    s_bitcmp1_b32 s37, 1
    s_cselect_b32 s4, 0x101000, 0
    v_mfma_f32_16x16x32_bf16 v[192:195], v[88:91], a[152:155], v[192:195]
    ds_read_b128 v[152:155], v11 offset:1536
    v_mfma_f32_16x16x32_bf16 v[200:203], v[88:91], a[156:159], v[200:203]
    s_xor_b32 s34, s34, s4
    s_lshr_b32 s37, s37, 2
    v_mfma_f32_16x16x32_bf16 v[196:199], v[92:95], a[152:155], v[196:199]
    ds_read_b128 v[156:159], v11 offset:34304
    v_mfma_f32_16x16x32_bf16 v[204:207], v[92:95], a[156:159], v[204:207]
    s_bitcmp1_b32 s63, s37
    s_cselect_b32 s4, 0x2000, 0
    s_waitcnt lgkmcnt(12)
    v_mfma_f32_16x16x32_bf16 v[192:195], v[96:99], a[160:163], v[192:195]
    ds_read_b128 v[160:163], v8 offset:1792
    v_mfma_f32_16x16x32_bf16 v[200:203], v[96:99], a[164:167], v[200:203]
    s_xor_b32 s34, s34, s4
    s_lshl_b32 s37, s37, 21
    v_mfma_f32_16x16x32_bf16 v[196:199], v[100:103], a[160:163], v[196:199]
    ds_read_b128 v[164:167], v8 offset:34560
    v_mfma_f32_16x16x32_bf16 v[204:207], v[100:103], a[164:167], v[204:207]
    s_add_u32 s34, s34, s37
    v_mfma_f32_16x16x32_bf16 v[192:195], v[104:107], a[168:171], v[192:195]
    ds_read_b128 v[168:171], v9 offset:1792
    v_mfma_f32_16x16x32_bf16 v[200:203], v[104:107], a[172:175], v[200:203]
    v_mfma_f32_16x16x32_bf16 v[196:199], v[108:111], a[168:171], v[196:199]
    ds_read_b128 v[172:175], v9 offset:34560
    v_mfma_f32_16x16x32_bf16 v[204:207], v[108:111], a[172:175], v[204:207]
    s_waitcnt lgkmcnt(12)
    v_mfma_f32_16x16x32_bf16 v[192:195], v[112:115], a[176:179], v[192:195]
    ds_read_b128 v[176:179], v10 offset:1792
    v_mfma_f32_16x16x32_bf16 v[200:203], v[112:115], a[180:183], v[200:203]
    s_waitcnt vmcnt(7)
    v_mov_b32 v27, s28
    s_mov_b64 exec, 1
    buffer_store_dword v27, v26, s[8:11], s94 offen sc1
    s_mov_b64 exec, -1
    v_mfma_f32_16x16x32_bf16 v[196:199], v[116:119], a[176:179], v[196:199]
    ds_read_b128 v[180:183], v10 offset:34560
    v_mfma_f32_16x16x32_bf16 v[204:207], v[116:119], a[180:183], v[204:207]
    v_mfma_f32_16x16x32_bf16 v[192:195], v[120:123], a[184:187], v[192:195]
    ds_read_b128 v[184:187], v11 offset:1792
    v_mfma_f32_16x16x32_bf16 v[200:203], v[120:123], a[188:191], v[200:203]
    s_add_u32 s28, s28, 1
    v_mfma_f32_16x16x32_bf16 v[196:199], v[124:127], a[184:187], v[196:199]
    ds_read_b128 v[188:191], v11 offset:34560
    v_mfma_f32_16x16x32_bf16 v[204:207], v[124:127], a[188:191], v[204:207]
    s_waitcnt lgkmcnt(12)
    v_mfma_f32_16x16x32_bf16 v[192:195], v[128:131], a[192:195], v[192:195]
    v_mfma_f32_16x16x32_bf16 v[200:203], v[128:131], a[196:199], v[200:203]
    v_mfma_f32_16x16x32_bf16 v[196:199], v[132:135], a[192:195], v[196:199]
    v_mfma_f32_16x16x32_bf16 v[204:207], v[132:135], a[196:199], v[204:207]
    v_mfma_f32_16x16x32_bf16 v[192:195], v[136:139], a[200:203], v[192:195]
    v_mfma_f32_16x16x32_bf16 v[200:203], v[136:139], a[204:207], v[200:203]
    s_add_u32 s29, s29, 0x10000
    s_and_b32 s29, s29, 0x3fffff
    v_mfma_f32_16x16x32_bf16 v[196:199], v[140:143], a[200:203], v[196:199]
    v_mfma_f32_16x16x32_bf16 v[204:207], v[140:143], a[204:207], v[204:207]
    s_waitcnt vmcnt(3) lgkmcnt(0)
    s_barrier
    v_mfma_f32_16x16x32_bf16 v[192:195], v[144:147], a[208:211], v[192:195]
    ds_read_b128 v[64:67], v12 offset:0
    ds_read_b128 v[68:71], v12 offset:32768
    v_mfma_f32_16x16x32_bf16 v[200:203], v[144:147], a[212:215], v[200:203]
    s_add_u32 m0, s6, 0
    v_mfma_f32_16x16x32_bf16 v[196:199], v[148:151], a[208:211], v[196:199]
    ds_read_b128 v[72:75], v13 offset:0
    ds_read_b128 v[76:79], v13 offset:32768
    v_mfma_f32_16x16x32_bf16 v[204:207], v[148:151], a[212:215], v[204:207]
    buffer_load_dwordx4 v16, s[12:15], s29 offen offset:0 lds
    v_mfma_f32_16x16x32_bf16 v[192:195], v[152:155], a[216:219], v[192:195]
    ds_read_b128 v[80:83], v14 offset:0
    ds_read_b128 v[84:87], v14 offset:32768
    v_mfma_f32_16x16x32_bf16 v[200:203], v[152:155], a[220:223], v[200:203]
    v_mfma_f32_16x16x32_bf16 v[196:199], v[156:159], a[216:219], v[196:199]
    ds_read_b128 v[88:91], v15 offset:0
    ds_read_b128 v[92:95], v15 offset:32768
    v_mfma_f32_16x16x32_bf16 v[204:207], v[156:159], a[220:223], v[204:207]
    buffer_load_dwordx4 v16, s[12:15], s29 offen offset:1024 lds
    v_mfma_f32_16x16x32_bf16 v[192:195], v[160:163], a[224:227], v[192:195]
    ds_read_b128 v[96:99], v12 offset:256
    v_mfma_f32_16x16x32_bf16 v[200:203], v[160:163], a[228:231], v[200:203]
    v_mfma_f32_16x16x32_bf16 v[196:199], v[164:167], a[224:227], v[196:199]
    ds_read_b128 v[100:103], v12 offset:33024
    v_mfma_f32_16x16x32_bf16 v[204:207], v[164:167], a[228:231], v[204:207]
    buffer_load_dwordx4 v17, s[12:15], s29 offen offset:2048 lds
    v_mfma_f32_16x16x32_bf16 v[192:195], v[168:171], a[232:235], v[192:195]
    ds_read_b128 v[104:107], v13 offset:256
    v_mfma_f32_16x16x32_bf16 v[200:203], v[168:171], a[236:239], v[200:203]
    v_mfma_f32_16x16x32_bf16 v[196:199], v[172:175], a[232:235], v[196:199]
    ds_read_b128 v[108:111], v13 offset:33024
    v_mfma_f32_16x16x32_bf16 v[204:207], v[172:175], a[236:239], v[204:207]
    buffer_load_dwordx4 v17, s[12:15], s29 offen offset:3072 lds
    v_mfma_f32_16x16x32_bf16 v[192:195], v[176:179], a[240:243], v[192:195]
    ds_read_b128 v[112:115], v14 offset:256
    v_mfma_f32_16x16x32_bf16 v[200:203], v[176:179], a[244:247], v[200:203]
    s_add_u32 m0, s6, 4096
    v_mfma_f32_16x16x32_bf16 v[196:199], v[180:183], a[240:243], v[196:199]
    ds_read_b128 v[116:119], v14 offset:33024
    v_mfma_f32_16x16x32_bf16 v[204:207], v[180:183], a[244:247], v[204:207]
    buffer_load_dwordx4 v18, s[12:15], s29 offen offset:0 lds
    v_mfma_f32_16x16x32_bf16 v[192:195], v[184:187], a[248:251], v[192:195]
    ds_read_b128 v[120:123], v15 offset:256
    v_mfma_f32_16x16x32_bf16 v[200:203], v[184:187], a[252:255], v[200:203]
    v_mfma_f32_16x16x32_bf16 v[196:199], v[188:191], a[248:251], v[196:199]
    ds_read_b128 v[124:127], v15 offset:33024
    v_mfma_f32_16x16x32_bf16 v[204:207], v[188:191], a[252:255], v[204:207]
    buffer_load_dwordx4 v18, s[12:15], s29 offen offset:1024 lds
    s_waitcnt lgkmcnt(12)
    v_mfma_f32_16x16x32_bf16 v[208:211], v[64:67], a[0:3], 0
    ds_read_b128 v[128:131], v12 offset:512
    v_mfma_f32_16x16x32_bf16 v[216:219], v[64:67], a[4:7], 0
    v_mfma_f32_16x16x32_bf16 v[212:215], v[68:71], a[0:3], 0
    ds_read_b128 v[132:135], v12 offset:33280
    v_mfma_f32_16x16x32_bf16 v[220:223], v[68:71], a[4:7], 0
    buffer_load_dwordx4 v19, s[12:15], s29 offen offset:2048 lds
    v_mfma_f32_16x16x32_bf16 v[208:211], v[72:75], a[8:11], v[208:211]
    ds_read_b128 v[136:139], v13 offset:512
    v_mfma_f32_16x16x32_bf16 v[216:219], v[72:75], a[12:15], v[216:219]
    v_cvt_pk_bf16_f32 v224, v192, v193
    v_cvt_pk_bf16_f32 v225, v194, v195
    v_mfma_f32_16x16x32_bf16 v[212:215], v[76:79], a[8:11], v[212:215]
    ds_read_b128 v[140:143], v13 offset:33280
    v_mfma_f32_16x16x32_bf16 v[220:223], v[76:79], a[12:15], v[220:223]
    buffer_load_dwordx4 v19, s[12:15], s29 offen offset:3072 lds
    s_waitcnt lgkmcnt(12)
    v_mfma_f32_16x16x32_bf16 v[208:211], v[80:83], a[16:19], v[208:211]
    ds_read_b128 v[144:147], v14 offset:512
    v_mfma_f32_16x16x32_bf16 v[216:219], v[80:83], a[20:23], v[216:219]
    s_add_u32 m0, s6, 8192
    v_cvt_pk_bf16_f32 v226, v196, v197
    v_cvt_pk_bf16_f32 v227, v198, v199
    v_mfma_f32_16x16x32_bf16 v[212:215], v[84:87], a[16:19], v[212:215]
    ds_read_b128 v[148:151], v14 offset:33280
    v_mfma_f32_16x16x32_bf16 v[220:223], v[84:87], a[20:23], v[220:223]
    buffer_load_dwordx4 v20, s[12:15], s29 offen offset:0 lds
    v_mfma_f32_16x16x32_bf16 v[208:211], v[88:91], a[24:27], v[208:211]
    ds_read_b128 v[152:155], v15 offset:512
    v_cvt_pk_bf16_f32 v228, v200, v201
    v_mfma_f32_16x16x32_bf16 v[216:219], v[88:91], a[28:31], v[216:219]
    buffer_store_dwordx4 v[224:227], v24, s[8:11], s30 offen sc1
    v_mfma_f32_16x16x32_bf16 v[212:215], v[92:95], a[24:27], v[212:215]
    ds_read_b128 v[156:159], v15 offset:33280
    v_cvt_pk_bf16_f32 v229, v202, v203
    v_mfma_f32_16x16x32_bf16 v[220:223], v[92:95], a[28:31], v[220:223]
    buffer_load_dwordx4 v20, s[12:15], s29 offen offset:1024 lds
    s_waitcnt lgkmcnt(12)
    v_mfma_f32_16x16x32_bf16 v[208:211], v[96:99], a[32:35], v[208:211]
    ds_read_b128 v[160:163], v12 offset:768
    v_mfma_f32_16x16x32_bf16 v[216:219], v[96:99], a[36:39], v[216:219]
    v_cvt_pk_bf16_f32 v230, v204, v205
    v_cvt_pk_bf16_f32 v231, v206, v207
    v_mfma_f32_16x16x32_bf16 v[212:215], v[100:103], a[32:35], v[212:215]
    ds_read_b128 v[164:167], v12 offset:33536
    v_mfma_f32_16x16x32_bf16 v[220:223], v[100:103], a[36:39], v[220:223]
    buffer_load_dwordx4 v21, s[12:15], s29 offen offset:2048 lds
    v_mfma_f32_16x16x32_bf16 v[208:211], v[104:107], a[40:43], v[208:211]
    ds_read_b128 v[168:171], v13 offset:768
    v_mfma_f32_16x16x32_bf16 v[216:219], v[104:107], a[44:47], v[216:219]
    buffer_store_dwordx4 v[228:231], v25, s[8:11], s30 offen sc1
    v_mfma_f32_16x16x32_bf16 v[212:215], v[108:111], a[40:43], v[212:215]
    ds_read_b128 v[172:175], v13 offset:33536
    v_mfma_f32_16x16x32_bf16 v[220:223], v[108:111], a[44:47], v[220:223]
    buffer_load_dwordx4 v21, s[12:15], s29 offen offset:3072 lds
    s_waitcnt lgkmcnt(12)
    v_mfma_f32_16x16x32_bf16 v[208:211], v[112:115], a[48:51], v[208:211]
    ds_read_b128 v[176:179], v14 offset:768
    v_mfma_f32_16x16x32_bf16 v[216:219], v[112:115], a[52:55], v[216:219]
    s_add_u32 m0, s6, 12288
    s_mov_b32 s30, s31
    v_mfma_f32_16x16x32_bf16 v[212:215], v[116:119], a[48:51], v[212:215]
    ds_read_b128 v[180:183], v14 offset:33536
    v_mfma_f32_16x16x32_bf16 v[220:223], v[116:119], a[52:55], v[220:223]
    buffer_load_dwordx4 v22, s[12:15], s29 offen offset:0 lds
    v_mfma_f32_16x16x32_bf16 v[208:211], v[120:123], a[56:59], v[208:211]
    ds_read_b128 v[184:187], v15 offset:768
    v_mfma_f32_16x16x32_bf16 v[216:219], v[120:123], a[60:63], v[216:219]
    s_add_u32 s31, s31, 262144
    v_mfma_f32_16x16x32_bf16 v[212:215], v[124:127], a[56:59], v[212:215]
    ds_read_b128 v[188:191], v15 offset:33536
    v_mfma_f32_16x16x32_bf16 v[220:223], v[124:127], a[60:63], v[220:223]
    buffer_load_dwordx4 v22, s[12:15], s29 offen offset:1024 lds
    s_waitcnt lgkmcnt(12)
    v_mfma_f32_16x16x32_bf16 v[208:211], v[128:131], a[64:67], v[208:211]
    ds_read_b128 v[64:67], v12 offset:1024
    v_mfma_f32_16x16x32_bf16 v[216:219], v[128:131], a[68:71], v[216:219]
    v_mfma_f32_16x16x32_bf16 v[212:215], v[132:135], a[64:67], v[212:215]
    ds_read_b128 v[68:71], v12 offset:33792
    v_mfma_f32_16x16x32_bf16 v[220:223], v[132:135], a[68:71], v[220:223]
    buffer_load_dwordx4 v23, s[12:15], s29 offen offset:2048 lds
    v_mfma_f32_16x16x32_bf16 v[208:211], v[136:139], a[72:75], v[208:211]
    ds_read_b128 v[72:75], v13 offset:1024
    v_mfma_f32_16x16x32_bf16 v[216:219], v[136:139], a[76:79], v[216:219]
    v_mfma_f32_16x16x32_bf16 v[212:215], v[140:143], a[72:75], v[212:215]
    ds_read_b128 v[76:79], v13 offset:33792
    v_mfma_f32_16x16x32_bf16 v[220:223], v[140:143], a[76:79], v[220:223]
    buffer_load_dwordx4 v23, s[12:15], s29 offen offset:3072 lds
    s_waitcnt lgkmcnt(12)
    v_mfma_f32_16x16x32_bf16 v[208:211], v[144:147], a[80:83], v[208:211]
    ds_read_b128 v[80:83], v14 offset:1024
    v_mfma_f32_16x16x32_bf16 v[216:219], v[144:147], a[84:87], v[216:219]
    v_mfma_f32_16x16x32_bf16 v[212:215], v[148:151], a[80:83], v[212:215]
    ds_read_b128 v[84:87], v14 offset:33792
    v_mfma_f32_16x16x32_bf16 v[220:223], v[148:151], a[84:87], v[220:223]
    buffer_load_dword v29, v28, s[12:15], s29 offen
    v_mfma_f32_16x16x32_bf16 v[208:211], v[152:155], a[88:91], v[208:211]
    ds_read_b128 v[88:91], v15 offset:1024
    v_mfma_f32_16x16x32_bf16 v[216:219], v[152:155], a[92:95], v[216:219]
    v_mfma_f32_16x16x32_bf16 v[212:215], v[156:159], a[88:91], v[212:215]
    ds_read_b128 v[92:95], v15 offset:33792
    v_mfma_f32_16x16x32_bf16 v[220:223], v[156:159], a[92:95], v[220:223]
    buffer_store_dwordx4 v[32:35], v36, s[8:11], s34 offen sc1
    s_waitcnt lgkmcnt(12)
    v_mfma_f32_16x16x32_bf16 v[208:211], v[160:163], a[96:99], v[208:211]
    ds_read_b128 v[96:99], v12 offset:1280
    v_mfma_f32_16x16x32_bf16 v[216:219], v[160:163], a[100:103], v[216:219]
    v_mfma_f32_16x16x32_bf16 v[212:215], v[164:167], a[96:99], v[212:215]
    ds_read_b128 v[100:103], v12 offset:34048
    v_mfma_f32_16x16x32_bf16 v[220:223], v[164:167], a[100:103], v[220:223]
    v_mfma_f32_16x16x32_bf16 v[208:211], v[168:171], a[104:107], v[208:211]
    ds_read_b128 v[104:107], v13 offset:1280
    v_mfma_f32_16x16x32_bf16 v[216:219], v[168:171], a[108:111], v[216:219]
    v_mfma_f32_16x16x32_bf16 v[212:215], v[172:175], a[104:107], v[212:215]
    ds_read_b128 v[108:111], v13 offset:34048
    v_mfma_f32_16x16x32_bf16 v[220:223], v[172:175], a[108:111], v[220:223]
    s_waitcnt lgkmcnt(12)
    v_mfma_f32_16x16x32_bf16 v[208:211], v[176:179], a[112:115], v[208:211]
    ds_read_b128 v[112:115], v14 offset:1280
    v_mfma_f32_16x16x32_bf16 v[216:219], v[176:179], a[116:119], v[216:219]
    v_mfma_f32_16x16x32_bf16 v[212:215], v[180:183], a[112:115], v[212:215]
    ds_read_b128 v[116:119], v14 offset:34048
    v_mfma_f32_16x16x32_bf16 v[220:223], v[180:183], a[116:119], v[220:223]
    v_mfma_f32_16x16x32_bf16 v[208:211], v[184:187], a[120:123], v[208:211]
    ds_read_b128 v[120:123], v15 offset:1280
    v_mfma_f32_16x16x32_bf16 v[216:219], v[184:187], a[124:127], v[216:219]
    v_mfma_f32_16x16x32_bf16 v[212:215], v[188:191], a[120:123], v[212:215]
    ds_read_b128 v[124:127], v15 offset:34048
    v_mfma_f32_16x16x32_bf16 v[220:223], v[188:191], a[124:127], v[220:223]
    s_waitcnt lgkmcnt(12)
    v_mfma_f32_16x16x32_bf16 v[208:211], v[64:67], a[128:131], v[208:211]
    ds_read_b128 v[128:131], v12 offset:1536
    v_mfma_f32_16x16x32_bf16 v[216:219], v[64:67], a[132:135], v[216:219]
    v_mfma_f32_16x16x32_bf16 v[212:215], v[68:71], a[128:131], v[212:215]
    ds_read_b128 v[132:135], v12 offset:34304
    v_mfma_f32_16x16x32_bf16 v[220:223], v[68:71], a[132:135], v[220:223]
    v_mfma_f32_16x16x32_bf16 v[208:211], v[72:75], a[136:139], v[208:211]
    ds_read_b128 v[136:139], v13 offset:1536
    v_mfma_f32_16x16x32_bf16 v[216:219], v[72:75], a[140:143], v[216:219]
    s_add_u32 s37, s28, 5
    v_mfma_f32_16x16x32_bf16 v[212:215], v[76:79], a[136:139], v[212:215]
    ds_read_b128 v[140:143], v13 offset:34304
    v_mfma_f32_16x16x32_bf16 v[220:223], v[76:79], a[140:143], v[220:223]
    s_bitcmp1_b32 s37, 0
    s_cselect_b32 s4, 0x84000, 0
    s_waitcnt lgkmcnt(12)
    v_mfma_f32_16x16x32_bf16 v[208:211], v[80:83], a[144:147], v[208:211]
    ds_read_b128 v[144:147], v14 offset:1536
    v_mfma_f32_16x16x32_bf16 v[216:219], v[80:83], a[148:151], v[216:219]
    s_xor_b32 s34, s35, s4
    v_mfma_f32_16x16x32_bf16 v[212:215], v[84:87], a[144:147], v[212:215]
    ds_read_b128 v[148:151], v14 offset:34304
    v_mfma_f32_16x16x32_bf16 v[220:223], v[84:87], a[148:151], v[220:223]
    s_bitcmp1_b32 s37, 1
    s_cselect_b32 s4, 0x101000, 0
    v_mfma_f32_16x16x32_bf16 v[208:211], v[88:91], a[152:155], v[208:211]
    ds_read_b128 v[152:155], v15 offset:1536
    v_mfma_f32_16x16x32_bf16 v[216:219], v[88:91], a[156:159], v[216:219]
    s_xor_b32 s34, s34, s4
    s_lshr_b32 s37, s37, 2
    v_mfma_f32_16x16x32_bf16 v[212:215], v[92:95], a[152:155], v[212:215]
    ds_read_b128 v[156:159], v15 offset:34304
    v_mfma_f32_16x16x32_bf16 v[220:223], v[92:95], a[156:159], v[220:223]
    s_bitcmp1_b32 s63, s37
    s_cselect_b32 s4, 0x2000, 0
    s_waitcnt lgkmcnt(12)
    v_mfma_f32_16x16x32_bf16 v[208:211], v[96:99], a[160:163], v[208:211]
    ds_read_b128 v[160:163], v12 offset:1792
    v_mfma_f32_16x16x32_bf16 v[216:219], v[96:99], a[164:167], v[216:219]
    s_xor_b32 s34, s34, s4
    s_lshl_b32 s37, s37, 21
    v_mfma_f32_16x16x32_bf16 v[212:215], v[100:103], a[160:163], v[212:215]
    ds_read_b128 v[164:167], v12 offset:34560
    v_mfma_f32_16x16x32_bf16 v[220:223], v[100:103], a[164:167], v[220:223]
    s_add_u32 s34, s34, s37
    v_mfma_f32_16x16x32_bf16 v[208:211], v[104:107], a[168:171], v[208:211]
    ds_read_b128 v[168:171], v13 offset:1792
    v_mfma_f32_16x16x32_bf16 v[216:219], v[104:107], a[172:175], v[216:219]
    v_mfma_f32_16x16x32_bf16 v[212:215], v[108:111], a[168:171], v[212:215]
    ds_read_b128 v[172:175], v13 offset:34560
    v_mfma_f32_16x16x32_bf16 v[220:223], v[108:111], a[172:175], v[220:223]
    s_waitcnt lgkmcnt(12)
    v_mfma_f32_16x16x32_bf16 v[208:211], v[112:115], a[176:179], v[208:211]
    ds_read_b128 v[176:179], v14 offset:1792
    v_mfma_f32_16x16x32_bf16 v[216:219], v[112:115], a[180:183], v[216:219]
    s_waitcnt vmcnt(7)
    v_mov_b32 v27, s28
    s_mov_b64 exec, 1
    buffer_store_dword v27, v26, s[8:11], s94 offen sc1
    s_mov_b64 exec, -1
    v_mfma_f32_16x16x32_bf16 v[212:215], v[116:119], a[176:179], v[212:215]
    ds_read_b128 v[180:183], v14 offset:34560
    v_mfma_f32_16x16x32_bf16 v[220:223], v[116:119], a[180:183], v[220:223]
    v_mfma_f32_16x16x32_bf16 v[208:211], v[120:123], a[184:187], v[208:211]
    ds_read_b128 v[184:187], v15 offset:1792
    v_mfma_f32_16x16x32_bf16 v[216:219], v[120:123], a[188:191], v[216:219]
    s_add_u32 s28, s28, 1
    v_mfma_f32_16x16x32_bf16 v[212:215], v[124:127], a[184:187], v[212:215]
    ds_read_b128 v[188:191], v15 offset:34560
    v_mfma_f32_16x16x32_bf16 v[220:223], v[124:127], a[188:191], v[220:223]
    s_waitcnt lgkmcnt(12)
    v_mfma_f32_16x16x32_bf16 v[208:211], v[128:131], a[192:195], v[208:211]
    v_mfma_f32_16x16x32_bf16 v[216:219], v[128:131], a[196:199], v[216:219]
    v_mfma_f32_16x16x32_bf16 v[212:215], v[132:135], a[192:195], v[212:215]
    v_mfma_f32_16x16x32_bf16 v[220:223], v[132:135], a[196:199], v[220:223]
    v_mfma_f32_16x16x32_bf16 v[208:211], v[136:139], a[200:203], v[208:211]
    v_mfma_f32_16x16x32_bf16 v[216:219], v[136:139], a[204:207], v[216:219]
    s_add_u32 s29, s29, 0x10000
    s_and_b32 s29, s29, 0x3fffff
    v_mfma_f32_16x16x32_bf16 v[212:215], v[140:143], a[200:203], v[212:215]
    v_mfma_f32_16x16x32_bf16 v[220:223], v[140:143], a[204:207], v[220:223]
    s_waitcnt vmcnt(3) lgkmcnt(0)
    s_barrier
    v_mfma_f32_16x16x32_bf16 v[208:211], v[144:147], a[208:211], v[208:211]
    ds_read_b128 v[64:67], v8 offset:0
    ds_read_b128 v[68:71], v8 offset:32768
    v_mfma_f32_16x16x32_bf16 v[216:219], v[144:147], a[212:215], v[216:219]
    s_add_u32 m0, s6, 65536
    v_mfma_f32_16x16x32_bf16 v[212:215], v[148:151], a[208:211], v[212:215]
    ds_read_b128 v[72:75], v9 offset:0
    ds_read_b128 v[76:79], v9 offset:32768
    v_mfma_f32_16x16x32_bf16 v[220:223], v[148:151], a[212:215], v[220:223]
    buffer_load_dwordx4 v16, s[12:15], s29 offen offset:0 lds
    v_mfma_f32_16x16x32_bf16 v[208:211], v[152:155], a[216:219], v[208:211]
    ds_read_b128 v[80:83], v10 offset:0
    ds_read_b128 v[84:87], v10 offset:32768
    v_mfma_f32_16x16x32_bf16 v[216:219], v[152:155], a[220:223], v[216:219]
    v_mfma_f32_16x16x32_bf16 v[212:215], v[156:159], a[216:219], v[212:215]
    ds_read_b128 v[88:91], v11 offset:0
    ds_read_b128 v[92:95], v11 offset:32768
    v_mfma_f32_16x16x32_bf16 v[220:223], v[156:159], a[220:223], v[220:223]
    buffer_load_dwordx4 v16, s[12:15], s29 offen offset:1024 lds
    v_mfma_f32_16x16x32_bf16 v[208:211], v[160:163], a[224:227], v[208:211]
    ds_read_b128 v[96:99], v8 offset:256
    v_mfma_f32_16x16x32_bf16 v[216:219], v[160:163], a[228:231], v[216:219]
    v_mfma_f32_16x16x32_bf16 v[212:215], v[164:167], a[224:227], v[212:215]
    ds_read_b128 v[100:103], v8 offset:33024
    v_mfma_f32_16x16x32_bf16 v[220:223], v[164:167], a[228:231], v[220:223]
    buffer_load_dwordx4 v17, s[12:15], s29 offen offset:2048 lds
    v_mfma_f32_16x16x32_bf16 v[208:211], v[168:171], a[232:235], v[208:211]
    ds_read_b128 v[104:107], v9 offset:256
    v_mfma_f32_16x16x32_bf16 v[216:219], v[168:171], a[236:239], v[216:219]
    v_mfma_f32_16x16x32_bf16 v[212:215], v[172:175], a[232:235], v[212:215]
    ds_read_b128 v[108:111], v9 offset:33024
    v_mfma_f32_16x16x32_bf16 v[220:223], v[172:175], a[236:239], v[220:223]
    buffer_load_dwordx4 v17, s[12:15], s29 offen offset:3072 lds
    v_mfma_f32_16x16x32_bf16 v[208:211], v[176:179], a[240:243], v[208:211]
    ds_read_b128 v[112:115], v10 offset:256
    v_mfma_f32_16x16x32_bf16 v[216:219], v[176:179], a[244:247], v[216:219]
    s_add_u32 m0, s6, 69632
    v_mfma_f32_16x16x32_bf16 v[212:215], v[180:183], a[240:243], v[212:215]
    ds_read_b128 v[116:119], v10 offset:33024
    v_mfma_f32_16x16x32_bf16 v[220:223], v[180:183], a[244:247], v[220:223]
    buffer_load_dwordx4 v18, s[12:15], s29 offen offset:0 lds
    v_mfma_f32_16x16x32_bf16 v[208:211], v[184:187], a[248:251], v[208:211]
    ds_read_b128 v[120:123], v11 offset:256
    v_mfma_f32_16x16x32_bf16 v[216:219], v[184:187], a[252:255], v[216:219]
    v_mfma_f32_16x16x32_bf16 v[212:215], v[188:191], a[248:251], v[212:215]
    ds_read_b128 v[124:127], v11 offset:33024
    v_mfma_f32_16x16x32_bf16 v[220:223], v[188:191], a[252:255], v[220:223]
    buffer_load_dwordx4 v18, s[12:15], s29 offen offset:1024 lds
    s_cmp_lt_u32 s28, 64
    s_cbranch_scc1 .ql_412
.qe_410:
    s_nop 7
    v_cvt_pk_bf16_f32 v224, v208, v209
    v_cvt_pk_bf16_f32 v225, v210, v211
    v_cvt_pk_bf16_f32 v226, v212, v213
    v_cvt_pk_bf16_f32 v227, v214, v215
    v_cvt_pk_bf16_f32 v228, v216, v217
    v_cvt_pk_bf16_f32 v229, v218, v219
    v_cvt_pk_bf16_f32 v230, v220, v221
    v_cvt_pk_bf16_f32 v231, v222, v223
    buffer_store_dwordx4 v[224:227], v24, s[8:11], s30 offen sc1
    buffer_store_dwordx4 v[228:231], v25, s[8:11], s30 offen sc1
    s_cmp_eq_u32 s98, 0
    s_cbranch_scc1 .qa_408
    s_waitcnt vmcnt(0) lgkmcnt(0)
    v_mov_b32 v27, s28
    s_mov_b64 exec, 1
    buffer_store_dword v27, v26, s[8:11], s94 offen sc1
    s_mov_b64 exec, -1
    s_barrier
    s_sub_u32 s95, s98, 1
    s_load_dwordx8 s[40:47], s[0:1], 0
    s_load_dwordx4 s[48:51], s[0:1], 32
    s_load_dwordx2 s[52:53], s[0:1], 104
    s_mul_i32 s6, s24, 8320
    s_add_u32 s6, s6, 122880
    s_lshl_b32 s97, s95, 4
    s_and_b32 s4, s99, 16
    s_add_u32 s97, s97, s4
    s_add_u32 s97, s97, s99
    s_lshl1_add_u32 s97, s99, s95
    s_lshl_b32 s4, s97, 16
    s_lshl_b32 s5, s24, 14
    s_add_u32 s4, s4, s5
    v_lshlrev_b32 v2, 4, v1
    v_bfe_u32 v254, v1, 0, 3
    v_mul_u32_u24 v3, 2048, v254
    v_bfe_u32 v254, v1, 4, 2
    v_mul_u32_u24 v254, 16, v254
    v_add_u32 v3, v3, v254
    v_add_u32 v3, s4, v3
    v_bfe_u32 v254, v1, 4, 2
    v_mul_u32_u24 v4, 16, v254
    v_add_u32 v4, s6, v4
    s_waitcnt lgkmcnt(0)
    s_mov_b32 s12, s40
    s_and_b32 s13, s41, 0xffff
    s_mov_b32 s14, 0x400000
    s_mov_b32 s15, 0x00020000
    s_mov_b32 s16, s42
    s_and_b32 s17, s43, 0xffff
    s_mov_b32 s18, 0x400000
    s_mov_b32 s19, 0x00020000
    s_mov_b32 s28, s44
    s_and_b32 s29, s45, 0xffff
    s_mov_b32 s30, 0x400000
    s_mov_b32 s31, 0x00020000
    s_mov_b32 s32, s46
    s_and_b32 s33, s47, 0xffff
    s_mov_b32 s34, 0x2000
    s_mov_b32 s35, 0x00020000
    s_mov_b32 s36, s48
    s_and_b32 s37, s49, 0xffff
    s_mov_b32 s38, 0x400000
    s_mov_b32 s39, 0x00020000
    s_mov_b32 s56, s52
    s_and_b32 s57, s53, 0xffff
    s_mov_b32 s58, 0x800
    s_mov_b32 s59, 0x00020000
    s_lshr_b32 s4, s97, 4
    s_lshl_b32 s4, s4, 2
    s_add_u32 s4, s4, 92344320
    v_bfe_u32 v254, v1, 0, 5
    v_mul_u32_u24 v8, 128, v254
    v_add_u32 v8, s4, v8
    s_lshl_b32 s4, s97, 16
    s_lshr_b32 s5, s24, 1
    s_lshl_b32 s5, s5, 15
    s_add_u32 s4, s4, s5
    s_and_b32 s5, s24, 1
    s_lshl_b32 s5, s5, 10
    s_add_u32 s4, s4, s5
    s_add_u32 s4, s4, 125829120
    v_add_u32 v7, s4, v2
    s_mov_b32 s62, 0
.kw_413:
    buffer_load_dword v12, v8, s[8:11], 0 offen sc1
    s_add_u32 s62, s62, 1
    s_cmp_gt_u32 s62, 0x100000
    s_cbranch_scc1 .mg_end_1
    s_waitcnt vmcnt(0)
    v_cmp_eq_u32 vcc, 0, v12
    s_cbranch_vccz .kw_414
    s_sleep 16
    s_branch .kw_413
.kw_414:
    s_mov_b32 m0, s6
    s_lshl_b32 s60, s97, 4
    buffer_load_dwordx4 v2, s[56:59], 0 offen lds
    buffer_load_dwordx4 v2, s[56:59], 0 offen offset:1024 lds
    s_add_u32 s61, s60, s24
    v_subrev_u32 v5, 4, v2
    buffer_load_dwordx4 a[0:3], v3, s[12:15], 0 offen offset:0
    buffer_load_dwordx4 a[4:7], v3, s[12:15], 0 offen offset:64
    buffer_load_dwordx4 a[8:11], v3, s[12:15], 0 offen offset:128
    buffer_load_dwordx4 a[12:15], v3, s[12:15], 0 offen offset:192
    buffer_load_dwordx4 a[16:19], v3, s[12:15], 0 offen offset:256
    buffer_load_dwordx4 a[20:23], v3, s[12:15], 0 offen offset:320
    buffer_load_dwordx4 a[24:27], v3, s[12:15], 0 offen offset:384
    buffer_load_dwordx4 a[28:31], v3, s[12:15], 0 offen offset:448
    buffer_load_dwordx4 a[32:35], v3, s[12:15], 0 offen offset:512
    buffer_load_dwordx4 a[36:39], v3, s[12:15], 0 offen offset:576
    buffer_load_dwordx4 a[40:43], v3, s[12:15], 0 offen offset:640
    buffer_load_dwordx4 a[44:47], v3, s[12:15], 0 offen offset:704
    buffer_load_dwordx4 a[48:51], v3, s[12:15], 0 offen offset:768
    buffer_load_dwordx4 a[52:55], v3, s[12:15], 0 offen offset:832
    buffer_load_dwordx4 a[56:59], v3, s[12:15], 0 offen offset:896
    buffer_load_dwordx4 a[60:63], v3, s[12:15], 0 offen offset:960
    buffer_load_dwordx4 a[64:67], v3, s[12:15], 0 offen offset:1024
    buffer_load_dwordx4 a[68:71], v3, s[12:15], 0 offen offset:1088
    buffer_load_dwordx4 a[72:75], v3, s[12:15], 0 offen offset:1152
    buffer_load_dwordx4 a[76:79], v3, s[12:15], 0 offen offset:1216
    buffer_load_dwordx4 a[80:83], v3, s[12:15], 0 offen offset:1280
    buffer_load_dwordx4 a[84:87], v3, s[12:15], 0 offen offset:1344
    buffer_load_dwordx4 a[88:91], v3, s[12:15], 0 offen offset:1408
    buffer_load_dwordx4 a[92:95], v3, s[12:15], 0 offen offset:1472
    buffer_load_dwordx4 a[96:99], v3, s[12:15], 0 offen offset:1536
    buffer_load_dwordx4 a[100:103], v3, s[12:15], 0 offen offset:1600
    buffer_load_dwordx4 a[104:107], v3, s[12:15], 0 offen offset:1664
    buffer_load_dwordx4 a[108:111], v3, s[12:15], 0 offen offset:1728
    buffer_load_dwordx4 a[112:115], v3, s[12:15], 0 offen offset:1792
    buffer_load_dwordx4 a[116:119], v3, s[12:15], 0 offen offset:1856
    buffer_load_dwordx4 a[120:123], v3, s[12:15], 0 offen offset:1920
    buffer_load_dwordx4 a[124:127], v3, s[12:15], 0 offen offset:1984
    s_waitcnt vmcnt(32)
    ds_read_b128 a[128:131], v4 offset:0
    ds_read_b128 a[132:135], v4 offset:64
    ds_read_b128 a[136:139], v4 offset:128
    ds_read_b128 a[140:143], v4 offset:192
    ds_read_b128 a[144:147], v4 offset:256
    ds_read_b128 a[148:151], v4 offset:320
    ds_read_b128 a[152:155], v4 offset:384
    ds_read_b128 a[156:159], v4 offset:448
    ds_read_b128 a[160:163], v4 offset:512
    ds_read_b128 a[164:167], v4 offset:576
    ds_read_b128 a[168:171], v4 offset:640
    ds_read_b128 a[172:175], v4 offset:704
    ds_read_b128 a[176:179], v4 offset:768
    ds_read_b128 a[180:183], v4 offset:832
    ds_read_b128 a[184:187], v4 offset:896
    ds_read_b128 a[188:191], v4 offset:960
    ds_read_b128 a[192:195], v4 offset:1024
    ds_read_b128 a[196:199], v4 offset:1088
    ds_read_b128 a[200:203], v4 offset:1152
    ds_read_b128 a[204:207], v4 offset:1216
    ds_read_b128 a[208:211], v4 offset:1280
    ds_read_b128 a[212:215], v4 offset:1344
    ds_read_b128 a[216:219], v4 offset:1408
    ds_read_b128 a[220:223], v4 offset:1472
    ds_read_b128 a[224:227], v4 offset:1536
    ds_read_b128 a[228:231], v4 offset:1600
    ds_read_b128 a[232:235], v4 offset:1664
    ds_read_b128 a[236:239], v4 offset:1728
    ds_read_b128 a[240:243], v4 offset:1792
    ds_read_b128 a[244:247], v4 offset:1856
    ds_read_b128 a[248:251], v4 offset:1920
    ds_read_b128 a[252:255], v4 offset:1984
    s_mov_b32 s4, 0
    buffer_load_dwordx4 v[32:35], v7, s[8:11], s4 offen offset:0
    buffer_load_dwordx4 v[36:39], v7, s[8:11], s4 offen offset:2048
    s_mov_b32 s4, 4096
    buffer_load_dwordx4 v[40:43], v7, s[8:11], s4 offen offset:0
    buffer_load_dwordx4 v[44:47], v7, s[8:11], s4 offen offset:2048
    s_mov_b32 s4, 8192
    buffer_load_dwordx4 v[48:51], v7, s[8:11], s4 offen offset:0
    buffer_load_dwordx4 v[52:55], v7, s[8:11], s4 offen offset:2048
    s_mov_b32 s4, 12288
    buffer_load_dwordx4 v[56:59], v7, s[8:11], s4 offen offset:0
    buffer_load_dwordx4 v[60:63], v7, s[8:11], s4 offen offset:2048
    s_mov_b32 s4, 16384
    buffer_load_dwordx4 v[64:67], v7, s[8:11], s4 offen offset:0
    buffer_load_dwordx4 v[68:71], v7, s[8:11], s4 offen offset:2048
    s_mov_b32 s4, 20480
    buffer_load_dwordx4 v[72:75], v7, s[8:11], s4 offen offset:0
    buffer_load_dwordx4 v[76:79], v7, s[8:11], s4 offen offset:2048
    s_mov_b32 s4, 24576
    buffer_load_dwordx4 v[80:83], v7, s[8:11], s4 offen offset:0
    buffer_load_dwordx4 v[84:87], v7, s[8:11], s4 offen offset:2048
    s_mov_b32 s4, 28672
    buffer_load_dwordx4 v[88:91], v7, s[8:11], s4 offen offset:0
    buffer_load_dwordx4 v[92:95], v7, s[8:11], s4 offen offset:2048
    v_add_u32 v9, s6, v2
    v_and_b32 v12, 31, v1
    v_lshrrev_b32 v13, 5, v1
    v_lshlrev_b32 v14, 3, v13
    v_sub_u32 v14, v12, v14
    v_add_u32 v15, 10, v14
    v_and_b32 v10, 1, v15
    v_xor_b32 v10, 1, v10
    v_mul_u32_u24 v10, 4160, v10
    v_lshrrev_b32 v15, 1, v15
    v_lshl_add_u32 v10, v15, 2, v10
    v_add_u32 v10, s6, v10
    v_mul_u32_u24 v11, 80, v12
    v_lshl_add_u32 v11, v13, 4, v11
    s_mul_i32 s4, s24, 7680
    s_sub_u32 s4, s4, 2480
    v_add_u32 v11, s4, v11
    v_cmp_eq_u32 vcc, 7, v14
    v_mov_b32 v15, 0xffff
    s_nop 0
    v_cndmask_b32 v24, 0, v15, vcc
    v_cmp_eq_u32 vcc, 6, v14
    v_mov_b32 v15, 0xffff0000
    s_nop 0
    v_cndmask_b32 v24, v24, v15, vcc
    v_cmp_eq_u32 vcc, 5, v14
    v_mov_b32 v15, 0xffff
    s_nop 0
    v_cndmask_b32 v25, 0, v15, vcc
    v_cmp_eq_u32 vcc, 4, v14
    v_mov_b32 v15, 0xffff0000
    s_nop 0
    v_cndmask_b32 v25, v25, v15, vcc
    v_cmp_eq_u32 vcc, 3, v14
    v_mov_b32 v15, 0xffff
    s_nop 0
    v_cndmask_b32 v26, 0, v15, vcc
    v_cmp_eq_u32 vcc, 2, v14
    v_mov_b32 v15, 0xffff0000
    s_nop 0
    v_cndmask_b32 v26, v26, v15, vcc
    v_cmp_eq_u32 vcc, 1, v14
    v_mov_b32 v15, 0xffff
    s_nop 0
    v_cndmask_b32 v27, 0, v15, vcc
    v_cmp_eq_u32 vcc, 0, v14
    v_mov_b32 v15, 0xffff0000
    s_nop 0
    v_cndmask_b32 v27, v27, v15, vcc
    v_cmp_eq_u32 vcc, 23, v14
    v_mov_b32 v15, 0xffff
    s_nop 0
    v_cndmask_b32 v28, 0, v15, vcc
    v_cmp_eq_u32 vcc, 22, v14
    v_mov_b32 v15, 0xffff0000
    s_nop 0
    v_cndmask_b32 v28, v28, v15, vcc
    v_cmp_eq_u32 vcc, 21, v14
    v_mov_b32 v15, 0xffff
    s_nop 0
    v_cndmask_b32 v29, 0, v15, vcc
    v_cmp_eq_u32 vcc, 20, v14
    v_mov_b32 v15, 0xffff0000
    s_nop 0
    v_cndmask_b32 v29, v29, v15, vcc
    v_cmp_eq_u32 vcc, 19, v14
    v_mov_b32 v15, 0xffff
    s_nop 0
    v_cndmask_b32 v30, 0, v15, vcc
    v_cmp_eq_u32 vcc, 18, v14
    v_mov_b32 v15, 0xffff0000
    s_nop 0
    v_cndmask_b32 v30, v30, v15, vcc
    v_cmp_eq_u32 vcc, 17, v14
    v_mov_b32 v15, 0xffff
    s_nop 0
    v_cndmask_b32 v31, 0, v15, vcc
    v_cmp_eq_u32 vcc, 16, v14
    v_mov_b32 v15, 0xffff0000
    s_nop 0
    v_cndmask_b32 v31, v31, v15, vcc
    s_waitcnt lgkmcnt(0)
    s_waitcnt vmcnt(47)
    v_mfma_f32_16x16x32_bf16 v[216:219], a[128:131], a[0:3], 0
    s_waitcnt vmcnt(46)
    v_mfma_f32_16x16x32_bf16 v[216:219], a[132:135], a[4:7], v[216:219]
    s_waitcnt vmcnt(45)
    v_mfma_f32_16x16x32_bf16 v[216:219], a[136:139], a[8:11], v[216:219]
    s_waitcnt vmcnt(44)
    v_mfma_f32_16x16x32_bf16 v[216:219], a[140:143], a[12:15], v[216:219]
    s_waitcnt vmcnt(43)
    v_mfma_f32_16x16x32_bf16 v[216:219], a[144:147], a[16:19], v[216:219]
    s_waitcnt vmcnt(42)
    v_mfma_f32_16x16x32_bf16 v[216:219], a[148:151], a[20:23], v[216:219]
    s_waitcnt vmcnt(41)
    v_mfma_f32_16x16x32_bf16 v[216:219], a[152:155], a[24:27], v[216:219]
    s_waitcnt vmcnt(40)
    v_mfma_f32_16x16x32_bf16 v[216:219], a[156:159], a[28:31], v[216:219]
    s_waitcnt vmcnt(39)
    v_mfma_f32_16x16x32_bf16 v[216:219], a[160:163], a[32:35], v[216:219]
    s_waitcnt vmcnt(38)
    v_mfma_f32_16x16x32_bf16 v[216:219], a[164:167], a[36:39], v[216:219]
    s_waitcnt vmcnt(37)
    v_mfma_f32_16x16x32_bf16 v[216:219], a[168:171], a[40:43], v[216:219]
    s_waitcnt vmcnt(36)
    v_mfma_f32_16x16x32_bf16 v[216:219], a[172:175], a[44:47], v[216:219]
    s_waitcnt vmcnt(35)
    v_mfma_f32_16x16x32_bf16 v[216:219], a[176:179], a[48:51], v[216:219]
    s_waitcnt vmcnt(34)
    v_mfma_f32_16x16x32_bf16 v[216:219], a[180:183], a[52:55], v[216:219]
    s_waitcnt vmcnt(33)
    v_mfma_f32_16x16x32_bf16 v[216:219], a[184:187], a[56:59], v[216:219]
    s_waitcnt vmcnt(32)
    v_mfma_f32_16x16x32_bf16 v[216:219], a[188:191], a[60:63], v[216:219]
    s_waitcnt vmcnt(31)
    v_mfma_f32_16x16x32_bf16 v[216:219], a[192:195], a[64:67], v[216:219]
    s_waitcnt vmcnt(30)
    v_mfma_f32_16x16x32_bf16 v[216:219], a[196:199], a[68:71], v[216:219]
    s_waitcnt vmcnt(29)
    v_mfma_f32_16x16x32_bf16 v[216:219], a[200:203], a[72:75], v[216:219]
    s_waitcnt vmcnt(28)
    v_mfma_f32_16x16x32_bf16 v[216:219], a[204:207], a[76:79], v[216:219]
    s_waitcnt vmcnt(27)
    v_mfma_f32_16x16x32_bf16 v[216:219], a[208:211], a[80:83], v[216:219]
    s_waitcnt vmcnt(26)
    v_mfma_f32_16x16x32_bf16 v[216:219], a[212:215], a[84:87], v[216:219]
    s_waitcnt vmcnt(25)
    v_mfma_f32_16x16x32_bf16 v[216:219], a[216:219], a[88:91], v[216:219]
    s_waitcnt vmcnt(24)
    v_mfma_f32_16x16x32_bf16 v[216:219], a[220:223], a[92:95], v[216:219]
    s_waitcnt vmcnt(23)
    v_mfma_f32_16x16x32_bf16 v[216:219], a[224:227], a[96:99], v[216:219]
    s_waitcnt vmcnt(22)
    v_mfma_f32_16x16x32_bf16 v[216:219], a[228:231], a[100:103], v[216:219]
    s_waitcnt vmcnt(21)
    v_mfma_f32_16x16x32_bf16 v[216:219], a[232:235], a[104:107], v[216:219]
    s_waitcnt vmcnt(20)
    v_mfma_f32_16x16x32_bf16 v[216:219], a[236:239], a[108:111], v[216:219]
    s_waitcnt vmcnt(19)
    v_mfma_f32_16x16x32_bf16 v[216:219], a[240:243], a[112:115], v[216:219]
    s_waitcnt vmcnt(18)
    v_mfma_f32_16x16x32_bf16 v[216:219], a[244:247], a[116:119], v[216:219]
    s_waitcnt vmcnt(17)
    v_mfma_f32_16x16x32_bf16 v[216:219], a[248:251], a[120:123], v[216:219]
    s_waitcnt vmcnt(16)
    v_mfma_f32_16x16x32_bf16 v[216:219], a[252:255], a[124:127], v[216:219]
    s_lshl_b32 s4, s61, 12
    v_add_u32 v6, s4, v5
    buffer_load_dwordx4 v[184:187], v2, s[36:39], s4 offen offset:0
    buffer_load_dwordx4 v[188:191], v2, s[36:39], s4 offen offset:1024
    buffer_load_dwordx4 v[192:195], v2, s[36:39], s4 offen offset:2048
    buffer_load_dwordx4 v[196:199], v2, s[36:39], s4 offen offset:3072
    buffer_load_dword v200, v6, s[36:39], 0 offen
    buffer_load_dword v201, v2, s[36:39], s4 offen offset:1020
    buffer_load_dword v202, v2, s[36:39], s4 offen offset:2044
    buffer_load_dword v203, v2, s[36:39], s4 offen offset:3068
    v_cvt_pk_bf16_f32 v216, v216, v216
    v_lshlrev_b32 v216, 16, v216
    v_mul_f32 v216, 0xbfb8aa3b, v216
    v_exp_f32 v216, v216
    s_lshl_b32 s4, s97, 7
    v_add_f32 v216, 1.0, v216
    v_rcp_f32 v216, v216
    s_lshl_b32 s5, s24, 5
    v_cvt_pk_bf16_f32 v216, v216, v216
    v_lshlrev_b32 v216, 16, v216
    s_add_u32 s4, s4, s5
    s_add_u32 s4, s4, 121634816
    v_lshlrev_b32 v15, 2, v1
    s_mov_b64 exec, 0xff
    buffer_store_dword v216, v15, s[8:11], s4 offen sc1
    s_mov_b64 exec, -1
    v_mov_b32 v220, 0
    v_mov_b32 v221, 0
    v_mov_b32 v222, 0
    v_mov_b32 v223, 0
    s_mul_i32 s4, s24, 7680
    v_add_u32 v15, s4, v2
    ds_write_b128 v15, v[220:223] offset:0
    ds_write_b128 v15, v[220:223] offset:1024
    ds_write_b128 v15, v[220:223] offset:1536
    v_add_u32 v15, 30720, v15
    ds_write_b128 v15, v[220:223] offset:0
    ds_write_b128 v15, v[220:223] offset:1024
    ds_write_b128 v15, v[220:223] offset:1536
    v_add_u32 v15, 30720, v15
    ds_write_b128 v15, v[220:223] offset:0
    ds_write_b128 v15, v[220:223] offset:1024
    ds_write_b128 v15, v[220:223] offset:1536
    v_add_u32 v15, 30720, v15
    ds_write_b128 v15, v[220:223] offset:0
    ds_write_b128 v15, v[220:223] offset:1024
    ds_write_b128 v15, v[220:223] offset:1536
    v_add_u32 v15, 30720, v15
    s_mov_b64 exec, 0xf
    ds_write_b128 v9, v[220:223]
    ds_write_b128 v9, v[220:223] offset:4160
    s_mov_b64 exec, -1
    s_mul_i32 s4, s24, 640
    s_add_u32 s4, s4, 2560
    v_bfe_u32 v254, v1, 0, 1
    v_mul_u32_u24 v12, 61440, v254
    v_bfe_u32 v254, v1, 3, 3
    v_mul_u32_u24 v254, 80, v254
    v_add_u32 v12, v12, v254
    v_bfe_u32 v254, v1, 1, 2
    v_mul_u32_u24 v254, 16, v254
    v_add_u32 v12, v12, v254
    v_add_u32 v12, s4, v12
    s_lshl_b32 s4, s97, 7
    v_bfe_u32 v254, v1, 0, 1
    v_mul_u32_u24 v13, 64, v254
    v_add_u32 v13, s4, v13
    s_and_b32 s4, s97, 3
    s_lshl1_add_u32 s4, s4, s24
    s_and_b32 s5, s24, 2
    s_sub_u32 s4, s4, s5
    v_xor_b32 v13, s4, v1
    v_bfe_u32 v14, v13, 2, 1
    v_and_b32 v13, 3, v13
    v_lshlrev_b32 v13, 4, v13
    v_mul_u32_u24 v14, 80, v14
    v_add_u32 v13, v13, v14
    s_mul_i32 s5, s5, 1280
    s_and_b32 s4, s24, 1
    s_mul_i32 s4, s4, 61440
    s_add_u32 s4, s4, s5
    s_add_u32 s4, s4, 2560
    v_bfe_u32 v254, v1, 3, 3
    v_mul_u32_u24 v12, 7680, v254
    v_add_u32 v12, s4, v12
    v_add_u32 v12, v13, v12
    s_waitcnt vmcnt(0)
    ds_write_b128 v12, v[32:35] offset:0
    ds_write_b128 v12, v[36:39] offset:160
    ds_write_b128 v12, v[40:43] offset:320
    ds_write_b128 v12, v[44:47] offset:480
    ds_write_b128 v12, v[48:51] offset:640
    ds_write_b128 v12, v[52:55] offset:800
    ds_write_b128 v12, v[56:59] offset:960
    ds_write_b128 v12, v[60:63] offset:1120
    ds_write_b128 v12, v[64:67] offset:1280
    ds_write_b128 v12, v[68:71] offset:1440
    ds_write_b128 v12, v[72:75] offset:1600
    ds_write_b128 v12, v[76:79] offset:1760
    ds_write_b128 v12, v[80:83] offset:1920
    ds_write_b128 v12, v[84:87] offset:2080
    ds_write_b128 v12, v[88:91] offset:2240
    ds_write_b128 v12, v[92:95] offset:2400
    s_waitcnt vmcnt(0)
    s_waitcnt lgkmcnt(0)
    s_barrier
    s_mov_b32 s64, 0
    s_cmp_lg_u32 s24, 0
    s_cbranch_scc1 .sg_418
    s_mov_b64 exec, 1
    v_mov_b32 v4, 1
    v_mov_b32 v3, 0
    buffer_atomic_add v4, v3, s[20:23], 0 offen offset:192 sc1
    s_mov_b64 exec, -1
.sg_418:
.chan_416:
    s_lshr_b32 s4, s61, 1
    s_lshl_b32 s4, s4, 2
    s_load_dword s65, s[50:51], s4
    s_lshl_b32 s7, s61, 12
    s_add_u32 s7, s7, 130023424
    v_writelane_b32 v200, 0, 0
    ds_write_b128 v9, v[184:187] offset:64
    v_alignbit_b32 v204, v184, v200, 16
    v_alignbit_b32 v205, v185, v184, 16
    v_alignbit_b32 v206, v186, v185, 16
    v_alignbit_b32 v207, v187, v186, 16
    ds_write_b128 v9, v[204:207] offset:4224
    ds_write_b128 v9, v[188:191] offset:1088
    v_alignbit_b32 v208, v188, v201, 16
    v_alignbit_b32 v209, v189, v188, 16
    v_alignbit_b32 v210, v190, v189, 16
    v_alignbit_b32 v211, v191, v190, 16
    ds_write_b128 v9, v[208:211] offset:5248
    ds_write_b128 v9, v[192:195] offset:2112
    v_alignbit_b32 v212, v192, v202, 16
    v_alignbit_b32 v213, v193, v192, 16
    v_alignbit_b32 v214, v194, v193, 16
    v_alignbit_b32 v215, v195, v194, 16
    ds_write_b128 v9, v[212:215] offset:6272
    ds_write_b128 v9, v[196:199] offset:3136
    v_alignbit_b32 v216, v196, v203, 16
    v_alignbit_b32 v217, v197, v196, 16
    v_alignbit_b32 v218, v198, v197, 16
    v_alignbit_b32 v219, v199, v198, 16
    ds_write_b128 v9, v[216:219] offset:7296
    s_and_b32 s4, s61, 1
    s_lshl_b32 s4, s4, 4
    s_waitcnt lgkmcnt(0)
    s_lshr_b32 s65, s65, s4
    s_pack_ll_b32_b16 s65, s65, s65
    s_add_u32 s61, s61, 4
    s_cmp_eq_u32 s64, 3
    s_cbranch_scc1 .chan_416_ns
    s_lshl_b32 s4, s61, 12
    v_add_u32 v6, s4, v5
    buffer_load_dwordx4 v[184:187], v2, s[36:39], s4 offen offset:0
    buffer_load_dwordx4 v[188:191], v2, s[36:39], s4 offen offset:1024
    buffer_load_dwordx4 v[192:195], v2, s[36:39], s4 offen offset:2048
    buffer_load_dwordx4 v[196:199], v2, s[36:39], s4 offen offset:3072
    buffer_load_dword v200, v6, s[36:39], 0 offen
    buffer_load_dword v201, v2, s[36:39], s4 offen offset:1020
    buffer_load_dword v202, v2, s[36:39], s4 offen offset:2044
    buffer_load_dword v203, v2, s[36:39], s4 offen offset:3068
.chan_416_ns:
    v_and_b32 v16, s65, v24
    v_and_b32 v17, s65, v25
    v_and_b32 v18, s65, v26
    v_and_b32 v19, s65, v27
    v_and_b32 v20, s65, v28
    v_and_b32 v21, s65, v29
    v_and_b32 v22, s65, v30
    v_and_b32 v23, s65, v31
    v_mov_b32 v14, v10
    ds_read2_b32 a[32:33], v14 offset0:0 offset1:1
    ds_read2_b32 a[34:35], v14 offset0:2 offset1:3
    ds_read_b128 a[56:59], v11 offset:7632
    ds_read_b128 a[60:63], v11 offset:5072
    ds_read2_b32 a[36:37], v14 offset0:8 offset1:9
    ds_read2_b32 a[38:39], v14 offset0:10 offset1:11
    ds_read_b128 a[64:67], v11 offset:7600
    ds_read_b128 a[68:71], v11 offset:5040
    ds_read2_b32 a[40:41], v14 offset0:16 offset1:17
    ds_read2_b32 a[42:43], v14 offset0:18 offset1:19
    ds_read_b128 a[72:75], v11 offset:7552
    ds_read_b128 a[76:79], v11 offset:4992
    s_waitcnt lgkmcnt(9)
    v_mfma_f32_32x32x16_bf16 a[16:31], a[32:35], a[56:59], 0
    v_mfma_f32_32x32x16_bf16 a[16:31], v[20:23], a[56:59], a[16:31]
    ds_read2_b32 a[44:45], v14 offset0:24 offset1:25
    ds_read2_b32 a[46:47], v14 offset0:26 offset1:27
    s_waitcnt lgkmcnt(10)
    v_mfma_f32_32x32x16_bf16 a[0:15], a[32:35], a[60:63], 0
    v_mfma_f32_32x32x16_bf16 a[0:15], v[20:23], a[60:63], a[0:15]
    ds_read_b128 a[80:83], v11 offset:7520
    ds_read_b128 a[84:87], v11 offset:4960
    s_waitcnt lgkmcnt(9)
    v_mfma_f32_32x32x16_bf16 a[16:31], a[36:39], a[64:67], a[16:31]
    v_mfma_f32_32x32x16_bf16 a[16:31], v[16:19], a[64:67], a[16:31]
    ds_read2_b32 a[48:49], v14 offset0:32 offset1:33
    ds_read2_b32 a[50:51], v14 offset0:34 offset1:35
    s_waitcnt lgkmcnt(10)
    v_mfma_f32_32x32x16_bf16 a[0:15], a[36:39], a[68:71], a[0:15]
    v_mfma_f32_32x32x16_bf16 a[0:15], v[16:19], a[68:71], a[0:15]
    ds_read_b128 a[56:59], v11 offset:7472
    ds_read_b128 a[60:63], v11 offset:4912
    s_waitcnt lgkmcnt(9)
    v_mfma_f32_32x32x16_bf16 a[16:31], a[40:43], a[72:75], a[16:31]
    ds_read2_b32 a[52:53], v14 offset0:40 offset1:41
    ds_read2_b32 a[54:55], v14 offset0:42 offset1:43
    s_waitcnt lgkmcnt(10)
    v_mfma_f32_32x32x16_bf16 a[0:15], a[40:43], a[76:79], a[0:15]
    ds_read_b128 a[64:67], v11 offset:7440
    ds_read_b128 a[68:71], v11 offset:4880
    s_waitcnt lgkmcnt(9)
    v_mfma_f32_32x32x16_bf16 a[16:31], a[44:47], a[80:83], a[16:31]
    ds_read2_b32 a[32:33], v14 offset0:48 offset1:49
    ds_read2_b32 a[34:35], v14 offset0:50 offset1:51
    s_waitcnt lgkmcnt(10)
    v_mfma_f32_32x32x16_bf16 a[0:15], a[44:47], a[84:87], a[0:15]
    ds_read_b128 a[72:75], v11 offset:7392
    ds_read_b128 a[76:79], v11 offset:4832
    s_waitcnt lgkmcnt(9)
    v_mfma_f32_32x32x16_bf16 a[16:31], a[48:51], a[56:59], a[16:31]
    ds_read2_b32 a[36:37], v14 offset0:56 offset1:57
    ds_read2_b32 a[38:39], v14 offset0:58 offset1:59
    s_waitcnt lgkmcnt(10)
    v_mfma_f32_32x32x16_bf16 a[0:15], a[48:51], a[60:63], a[0:15]
    ds_read_b128 a[80:83], v11 offset:7360
    ds_read_b128 a[84:87], v11 offset:4800
    s_waitcnt lgkmcnt(9)
    v_mfma_f32_32x32x16_bf16 a[16:31], a[52:55], a[64:67], a[16:31]
    ds_read2_b32 a[40:41], v14 offset0:64 offset1:65
    ds_read2_b32 a[42:43], v14 offset0:66 offset1:67
    s_waitcnt lgkmcnt(10)
    v_mfma_f32_32x32x16_bf16 a[0:15], a[52:55], a[68:71], a[0:15]
    ds_read_b128 a[56:59], v11 offset:7312
    ds_read_b128 a[60:63], v11 offset:4752
    s_waitcnt lgkmcnt(9)
    v_mfma_f32_32x32x16_bf16 a[16:31], a[32:35], a[72:75], a[16:31]
    ds_read2_b32 a[44:45], v14 offset0:72 offset1:73
    ds_read2_b32 a[46:47], v14 offset0:74 offset1:75
    s_waitcnt lgkmcnt(10)
    v_mfma_f32_32x32x16_bf16 a[0:15], a[32:35], a[76:79], a[0:15]
    ds_read_b128 a[64:67], v11 offset:7280
    ds_read_b128 a[68:71], v11 offset:4720
    s_waitcnt lgkmcnt(9)
    v_mfma_f32_32x32x16_bf16 a[16:31], a[36:39], a[80:83], a[16:31]
    ds_read2_b32 a[48:49], v14 offset0:80 offset1:81
    ds_read2_b32 a[50:51], v14 offset0:82 offset1:83
    s_waitcnt lgkmcnt(10)
    v_mfma_f32_32x32x16_bf16 a[0:15], a[36:39], a[84:87], a[0:15]
    ds_read_b128 a[72:75], v11 offset:7232
    ds_read_b128 a[76:79], v11 offset:4672
    s_waitcnt lgkmcnt(9)
    v_mfma_f32_32x32x16_bf16 a[16:31], a[40:43], a[56:59], a[16:31]
    ds_read2_b32 a[52:53], v14 offset0:88 offset1:89
    ds_read2_b32 a[54:55], v14 offset0:90 offset1:91
    s_waitcnt lgkmcnt(10)
    v_mfma_f32_32x32x16_bf16 a[0:15], a[40:43], a[60:63], a[0:15]
    ds_read_b128 a[80:83], v11 offset:7200
    ds_read_b128 a[84:87], v11 offset:4640
    s_waitcnt lgkmcnt(9)
    v_mfma_f32_32x32x16_bf16 a[16:31], a[44:47], a[64:67], a[16:31]
    ds_read2_b32 a[32:33], v14 offset0:96 offset1:97
    ds_read2_b32 a[34:35], v14 offset0:98 offset1:99
    s_waitcnt lgkmcnt(10)
    v_mfma_f32_32x32x16_bf16 a[0:15], a[44:47], a[68:71], a[0:15]
    ds_read_b128 a[56:59], v11 offset:7152
    ds_read_b128 a[60:63], v11 offset:4592
    s_waitcnt lgkmcnt(9)
    v_mfma_f32_32x32x16_bf16 a[16:31], a[48:51], a[72:75], a[16:31]
    ds_read2_b32 a[36:37], v14 offset0:104 offset1:105
    ds_read2_b32 a[38:39], v14 offset0:106 offset1:107
    s_waitcnt lgkmcnt(10)
    v_mfma_f32_32x32x16_bf16 a[0:15], a[48:51], a[76:79], a[0:15]
    ds_read_b128 a[64:67], v11 offset:7120
    ds_read_b128 a[68:71], v11 offset:4560
    s_waitcnt lgkmcnt(9)
    v_mfma_f32_32x32x16_bf16 a[16:31], a[52:55], a[80:83], a[16:31]
    ds_read2_b32 a[40:41], v14 offset0:112 offset1:113
    ds_read2_b32 a[42:43], v14 offset0:114 offset1:115
    s_waitcnt lgkmcnt(10)
    v_mfma_f32_32x32x16_bf16 a[0:15], a[52:55], a[84:87], a[0:15]
    ds_read_b128 a[72:75], v11 offset:7072
    ds_read_b128 a[76:79], v11 offset:4512
    s_waitcnt lgkmcnt(9)
    v_mfma_f32_32x32x16_bf16 a[16:31], a[32:35], a[56:59], a[16:31]
    ds_read2_b32 a[44:45], v14 offset0:120 offset1:121
    ds_read2_b32 a[46:47], v14 offset0:122 offset1:123
    s_waitcnt lgkmcnt(10)
    v_mfma_f32_32x32x16_bf16 a[0:15], a[32:35], a[60:63], a[0:15]
    ds_read_b128 a[80:83], v11 offset:7040
    ds_read_b128 a[84:87], v11 offset:4480
    s_waitcnt lgkmcnt(9)
    v_mfma_f32_32x32x16_bf16 a[16:31], a[36:39], a[64:67], a[16:31]
    ds_read2_b32 a[48:49], v14 offset0:128 offset1:129
    ds_read2_b32 a[50:51], v14 offset0:130 offset1:131
    s_waitcnt lgkmcnt(10)
    v_mfma_f32_32x32x16_bf16 a[0:15], a[36:39], a[68:71], a[0:15]
    ds_read_b128 a[56:59], v11 offset:6992
    ds_read_b128 a[60:63], v11 offset:4432
    s_waitcnt lgkmcnt(9)
    v_mfma_f32_32x32x16_bf16 a[16:31], a[40:43], a[72:75], a[16:31]
    ds_read2_b32 a[52:53], v14 offset0:136 offset1:137
    ds_read2_b32 a[54:55], v14 offset0:138 offset1:139
    s_waitcnt lgkmcnt(10)
    v_mfma_f32_32x32x16_bf16 a[0:15], a[40:43], a[76:79], a[0:15]
    ds_read_b128 a[64:67], v11 offset:6960
    ds_read_b128 a[68:71], v11 offset:4400
    s_waitcnt lgkmcnt(9)
    v_mfma_f32_32x32x16_bf16 a[16:31], a[44:47], a[80:83], a[16:31]
    ds_read2_b32 a[32:33], v14 offset0:144 offset1:145
    ds_read2_b32 a[34:35], v14 offset0:146 offset1:147
    s_waitcnt lgkmcnt(10)
    v_mfma_f32_32x32x16_bf16 a[0:15], a[44:47], a[84:87], a[0:15]
    ds_read_b128 a[72:75], v11 offset:6912
    ds_read_b128 a[76:79], v11 offset:4352
    s_waitcnt lgkmcnt(9)
    v_mfma_f32_32x32x16_bf16 a[16:31], a[48:51], a[56:59], a[16:31]
    ds_read2_b32 a[36:37], v14 offset0:152 offset1:153
    ds_read2_b32 a[38:39], v14 offset0:154 offset1:155
    s_waitcnt lgkmcnt(10)
    v_mfma_f32_32x32x16_bf16 a[0:15], a[48:51], a[60:63], a[0:15]
    ds_read_b128 a[80:83], v11 offset:6880
    ds_read_b128 a[84:87], v11 offset:4320
    s_waitcnt lgkmcnt(9)
    v_mfma_f32_32x32x16_bf16 a[16:31], a[52:55], a[64:67], a[16:31]
    ds_read2_b32 a[40:41], v14 offset0:160 offset1:161
    ds_read2_b32 a[42:43], v14 offset0:162 offset1:163
    s_waitcnt lgkmcnt(10)
    v_mfma_f32_32x32x16_bf16 a[0:15], a[52:55], a[68:71], a[0:15]
    ds_read_b128 a[56:59], v11 offset:6832
    ds_read_b128 a[60:63], v11 offset:4272
    s_waitcnt lgkmcnt(9)
    v_mfma_f32_32x32x16_bf16 a[16:31], a[32:35], a[72:75], a[16:31]
    ds_read2_b32 a[44:45], v14 offset0:168 offset1:169
    ds_read2_b32 a[46:47], v14 offset0:170 offset1:171
    s_waitcnt lgkmcnt(10)
    v_mfma_f32_32x32x16_bf16 a[0:15], a[32:35], a[76:79], a[0:15]
    ds_read_b128 a[64:67], v11 offset:6800
    ds_read_b128 a[68:71], v11 offset:4240
    s_waitcnt lgkmcnt(9)
    v_mfma_f32_32x32x16_bf16 a[16:31], a[36:39], a[80:83], a[16:31]
    ds_read2_b32 a[48:49], v14 offset0:176 offset1:177
    ds_read2_b32 a[50:51], v14 offset0:178 offset1:179
    s_waitcnt lgkmcnt(10)
    v_mfma_f32_32x32x16_bf16 a[0:15], a[36:39], a[84:87], a[0:15]
    ds_read_b128 a[72:75], v11 offset:6752
    ds_read_b128 a[76:79], v11 offset:4192
    s_waitcnt lgkmcnt(9)
    v_mfma_f32_32x32x16_bf16 a[16:31], a[40:43], a[56:59], a[16:31]
    ds_read2_b32 a[52:53], v14 offset0:184 offset1:185
    ds_read2_b32 a[54:55], v14 offset0:186 offset1:187
    s_waitcnt lgkmcnt(10)
    v_mfma_f32_32x32x16_bf16 a[0:15], a[40:43], a[60:63], a[0:15]
    ds_read_b128 a[80:83], v11 offset:6720
    ds_read_b128 a[84:87], v11 offset:4160
    s_waitcnt lgkmcnt(9)
    v_mfma_f32_32x32x16_bf16 a[16:31], a[44:47], a[64:67], a[16:31]
    ds_read2_b32 a[32:33], v14 offset0:192 offset1:193
    ds_read2_b32 a[34:35], v14 offset0:194 offset1:195
    s_waitcnt lgkmcnt(10)
    v_mfma_f32_32x32x16_bf16 a[0:15], a[44:47], a[68:71], a[0:15]
    ds_read_b128 a[56:59], v11 offset:6672
    ds_read_b128 a[60:63], v11 offset:4112
    s_waitcnt lgkmcnt(9)
    v_mfma_f32_32x32x16_bf16 a[16:31], a[48:51], a[72:75], a[16:31]
    ds_read2_b32 a[36:37], v14 offset0:200 offset1:201
    ds_read2_b32 a[38:39], v14 offset0:202 offset1:203
    s_waitcnt lgkmcnt(10)
    v_mfma_f32_32x32x16_bf16 a[0:15], a[48:51], a[76:79], a[0:15]
    ds_read_b128 a[64:67], v11 offset:6640
    ds_read_b128 a[68:71], v11 offset:4080
    s_waitcnt lgkmcnt(9)
    v_mfma_f32_32x32x16_bf16 a[16:31], a[52:55], a[80:83], a[16:31]
    ds_read2_b32 a[40:41], v14 offset0:208 offset1:209
    ds_read2_b32 a[42:43], v14 offset0:210 offset1:211
    s_waitcnt lgkmcnt(10)
    v_mfma_f32_32x32x16_bf16 a[0:15], a[52:55], a[84:87], a[0:15]
    ds_read_b128 a[72:75], v11 offset:6592
    ds_read_b128 a[76:79], v11 offset:4032
    s_waitcnt lgkmcnt(9)
    v_mfma_f32_32x32x16_bf16 a[16:31], a[32:35], a[56:59], a[16:31]
    ds_read2_b32 a[44:45], v14 offset0:216 offset1:217
    ds_read2_b32 a[46:47], v14 offset0:218 offset1:219
    s_waitcnt lgkmcnt(10)
    v_mfma_f32_32x32x16_bf16 a[0:15], a[32:35], a[60:63], a[0:15]
    ds_read_b128 a[80:83], v11 offset:6560
    ds_read_b128 a[84:87], v11 offset:4000
    s_waitcnt lgkmcnt(9)
    v_mfma_f32_32x32x16_bf16 a[16:31], a[36:39], a[64:67], a[16:31]
    ds_read2_b32 a[48:49], v14 offset0:224 offset1:225
    ds_read2_b32 a[50:51], v14 offset0:226 offset1:227
    s_waitcnt lgkmcnt(10)
    v_mfma_f32_32x32x16_bf16 a[0:15], a[36:39], a[68:71], a[0:15]
    ds_read_b128 a[56:59], v11 offset:6512
    ds_read_b128 a[60:63], v11 offset:3952
    s_waitcnt lgkmcnt(9)
    v_mfma_f32_32x32x16_bf16 a[16:31], a[40:43], a[72:75], a[16:31]
    ds_read2_b32 a[52:53], v14 offset0:232 offset1:233
    ds_read2_b32 a[54:55], v14 offset0:234 offset1:235
    s_waitcnt lgkmcnt(10)
    v_mfma_f32_32x32x16_bf16 a[0:15], a[40:43], a[76:79], a[0:15]
    ds_read_b128 a[64:67], v11 offset:6480
    ds_read_b128 a[68:71], v11 offset:3920
    s_waitcnt lgkmcnt(9)
    v_mfma_f32_32x32x16_bf16 a[16:31], a[44:47], a[80:83], a[16:31]
    ds_read2_b32 a[32:33], v14 offset0:240 offset1:241
    ds_read2_b32 a[34:35], v14 offset0:242 offset1:243
    s_waitcnt lgkmcnt(10)
    v_mfma_f32_32x32x16_bf16 a[0:15], a[44:47], a[84:87], a[0:15]
    ds_read_b128 a[72:75], v11 offset:6432
    ds_read_b128 a[76:79], v11 offset:3872
    s_waitcnt lgkmcnt(9)
    v_mfma_f32_32x32x16_bf16 a[16:31], a[48:51], a[56:59], a[16:31]
    ds_read2_b32 a[36:37], v14 offset0:248 offset1:249
    ds_read2_b32 a[38:39], v14 offset0:250 offset1:251
    v_add_u32 v14, 1024, v14
    s_waitcnt lgkmcnt(10)
    v_mfma_f32_32x32x16_bf16 a[0:15], a[48:51], a[60:63], a[0:15]
    ds_read_b128 a[80:83], v11 offset:6400
    ds_read_b128 a[84:87], v11 offset:3840
    s_waitcnt lgkmcnt(9)
    v_mfma_f32_32x32x16_bf16 a[16:31], a[52:55], a[64:67], a[16:31]
    ds_read2_b32 a[40:41], v14 offset0:0 offset1:1
    ds_read2_b32 a[42:43], v14 offset0:2 offset1:3
    s_waitcnt lgkmcnt(10)
    v_mfma_f32_32x32x16_bf16 a[0:15], a[52:55], a[68:71], a[0:15]
    ds_read_b128 a[56:59], v11 offset:6352
    ds_read_b128 a[60:63], v11 offset:3792
    s_waitcnt lgkmcnt(9)
    v_mfma_f32_32x32x16_bf16 a[16:31], a[32:35], a[72:75], a[16:31]
    ds_read2_b32 a[44:45], v14 offset0:8 offset1:9
    ds_read2_b32 a[46:47], v14 offset0:10 offset1:11
    s_waitcnt lgkmcnt(10)
    v_mfma_f32_32x32x16_bf16 a[0:15], a[32:35], a[76:79], a[0:15]
    ds_read_b128 a[64:67], v11 offset:6320
    ds_read_b128 a[68:71], v11 offset:3760
    s_waitcnt lgkmcnt(9)
    v_mfma_f32_32x32x16_bf16 a[16:31], a[36:39], a[80:83], a[16:31]
    ds_read2_b32 a[48:49], v14 offset0:16 offset1:17
    ds_read2_b32 a[50:51], v14 offset0:18 offset1:19
    s_waitcnt lgkmcnt(10)
    v_mfma_f32_32x32x16_bf16 a[0:15], a[36:39], a[84:87], a[0:15]
    ds_read_b128 a[72:75], v11 offset:6272
    ds_read_b128 a[76:79], v11 offset:3712
    s_waitcnt lgkmcnt(9)
    v_mfma_f32_32x32x16_bf16 a[16:31], a[40:43], a[56:59], a[16:31]
    ds_read2_b32 a[52:53], v14 offset0:24 offset1:25
    ds_read2_b32 a[54:55], v14 offset0:26 offset1:27
    s_waitcnt lgkmcnt(10)
    v_mfma_f32_32x32x16_bf16 a[0:15], a[40:43], a[60:63], a[0:15]
    ds_read_b128 a[80:83], v11 offset:6240
    ds_read_b128 a[84:87], v11 offset:3680
    s_waitcnt lgkmcnt(9)
    v_mfma_f32_32x32x16_bf16 a[16:31], a[44:47], a[64:67], a[16:31]
    ds_read2_b32 a[32:33], v14 offset0:32 offset1:33
    ds_read2_b32 a[34:35], v14 offset0:34 offset1:35
    s_waitcnt lgkmcnt(10)
    v_mfma_f32_32x32x16_bf16 a[0:15], a[44:47], a[68:71], a[0:15]
    ds_read_b128 a[56:59], v11 offset:6192
    ds_read_b128 a[60:63], v11 offset:3632
    s_waitcnt lgkmcnt(9)
    v_mfma_f32_32x32x16_bf16 a[16:31], a[48:51], a[72:75], a[16:31]
    ds_read2_b32 a[36:37], v14 offset0:40 offset1:41
    ds_read2_b32 a[38:39], v14 offset0:42 offset1:43
    s_waitcnt lgkmcnt(10)
    v_mfma_f32_32x32x16_bf16 a[0:15], a[48:51], a[76:79], a[0:15]
    ds_read_b128 a[64:67], v11 offset:6160
    ds_read_b128 a[68:71], v11 offset:3600
    s_waitcnt lgkmcnt(9)
    v_mfma_f32_32x32x16_bf16 a[16:31], a[52:55], a[80:83], a[16:31]
    ds_read2_b32 a[40:41], v14 offset0:48 offset1:49
    ds_read2_b32 a[42:43], v14 offset0:50 offset1:51
    s_waitcnt lgkmcnt(10)
    v_mfma_f32_32x32x16_bf16 a[0:15], a[52:55], a[84:87], a[0:15]
    ds_read_b128 a[72:75], v11 offset:6112
    ds_read_b128 a[76:79], v11 offset:3552
    s_waitcnt lgkmcnt(9)
    v_mfma_f32_32x32x16_bf16 a[16:31], a[32:35], a[56:59], a[16:31]
    ds_read2_b32 a[44:45], v14 offset0:56 offset1:57
    ds_read2_b32 a[46:47], v14 offset0:58 offset1:59
    s_waitcnt lgkmcnt(10)
    v_mfma_f32_32x32x16_bf16 a[0:15], a[32:35], a[60:63], a[0:15]
    ds_read_b128 a[80:83], v11 offset:6080
    ds_read_b128 a[84:87], v11 offset:3520
    s_waitcnt lgkmcnt(9)
    v_mfma_f32_32x32x16_bf16 a[16:31], a[36:39], a[64:67], a[16:31]
    ds_read2_b32 a[48:49], v14 offset0:64 offset1:65
    ds_read2_b32 a[50:51], v14 offset0:66 offset1:67
    s_waitcnt lgkmcnt(10)
    v_mfma_f32_32x32x16_bf16 a[0:15], a[36:39], a[68:71], a[0:15]
    ds_read_b128 a[56:59], v11 offset:6032
    ds_read_b128 a[60:63], v11 offset:3472
    s_waitcnt lgkmcnt(9)
    v_mfma_f32_32x32x16_bf16 a[16:31], a[40:43], a[72:75], a[16:31]
    ds_read2_b32 a[52:53], v14 offset0:72 offset1:73
    ds_read2_b32 a[54:55], v14 offset0:74 offset1:75
    s_waitcnt lgkmcnt(10)
    v_mfma_f32_32x32x16_bf16 a[0:15], a[40:43], a[76:79], a[0:15]
    ds_read_b128 a[64:67], v11 offset:6000
    ds_read_b128 a[68:71], v11 offset:3440
    s_waitcnt lgkmcnt(9)
    v_mfma_f32_32x32x16_bf16 a[16:31], a[44:47], a[80:83], a[16:31]
    ds_read2_b32 a[32:33], v14 offset0:80 offset1:81
    ds_read2_b32 a[34:35], v14 offset0:82 offset1:83
    s_waitcnt lgkmcnt(10)
    v_mfma_f32_32x32x16_bf16 a[0:15], a[44:47], a[84:87], a[0:15]
    ds_read_b128 a[72:75], v11 offset:5952
    ds_read_b128 a[76:79], v11 offset:3392
    s_waitcnt lgkmcnt(9)
    v_mfma_f32_32x32x16_bf16 a[16:31], a[48:51], a[56:59], a[16:31]
    ds_read2_b32 a[36:37], v14 offset0:88 offset1:89
    ds_read2_b32 a[38:39], v14 offset0:90 offset1:91
    s_waitcnt lgkmcnt(10)
    v_mfma_f32_32x32x16_bf16 a[0:15], a[48:51], a[60:63], a[0:15]
    ds_read_b128 a[80:83], v11 offset:5920
    ds_read_b128 a[84:87], v11 offset:3360
    s_waitcnt lgkmcnt(9)
    v_mfma_f32_32x32x16_bf16 a[16:31], a[52:55], a[64:67], a[16:31]
    ds_read2_b32 a[40:41], v14 offset0:96 offset1:97
    ds_read2_b32 a[42:43], v14 offset0:98 offset1:99
    s_waitcnt lgkmcnt(10)
    v_mfma_f32_32x32x16_bf16 a[0:15], a[52:55], a[68:71], a[0:15]
    ds_read_b128 a[56:59], v11 offset:5872
    ds_read_b128 a[60:63], v11 offset:3312
    s_waitcnt lgkmcnt(9)
    v_mfma_f32_32x32x16_bf16 a[16:31], a[32:35], a[72:75], a[16:31]
    ds_read2_b32 a[44:45], v14 offset0:104 offset1:105
    ds_read2_b32 a[46:47], v14 offset0:106 offset1:107
    s_waitcnt lgkmcnt(10)
    v_mfma_f32_32x32x16_bf16 a[0:15], a[32:35], a[76:79], a[0:15]
    ds_read_b128 a[64:67], v11 offset:5840
    ds_read_b128 a[68:71], v11 offset:3280
    s_waitcnt lgkmcnt(9)
    v_mfma_f32_32x32x16_bf16 a[16:31], a[36:39], a[80:83], a[16:31]
    ds_read2_b32 a[48:49], v14 offset0:112 offset1:113
    ds_read2_b32 a[50:51], v14 offset0:114 offset1:115
    s_waitcnt lgkmcnt(10)
    v_mfma_f32_32x32x16_bf16 a[0:15], a[36:39], a[84:87], a[0:15]
    ds_read_b128 a[72:75], v11 offset:5792
    ds_read_b128 a[76:79], v11 offset:3232
    s_waitcnt lgkmcnt(9)
    v_mfma_f32_32x32x16_bf16 a[16:31], a[40:43], a[56:59], a[16:31]
    ds_read2_b32 a[52:53], v14 offset0:120 offset1:121
    ds_read2_b32 a[54:55], v14 offset0:122 offset1:123
    s_waitcnt lgkmcnt(10)
    v_mfma_f32_32x32x16_bf16 a[0:15], a[40:43], a[60:63], a[0:15]
    ds_read_b128 a[80:83], v11 offset:5760
    ds_read_b128 a[84:87], v11 offset:3200
    s_waitcnt lgkmcnt(9)
    v_mfma_f32_32x32x16_bf16 a[16:31], a[44:47], a[64:67], a[16:31]
    ds_read2_b32 a[32:33], v14 offset0:128 offset1:129
    ds_read2_b32 a[34:35], v14 offset0:130 offset1:131
    s_waitcnt lgkmcnt(10)
    v_mfma_f32_32x32x16_bf16 a[0:15], a[44:47], a[68:71], a[0:15]
    ds_read_b128 a[56:59], v11 offset:5712
    ds_read_b128 a[60:63], v11 offset:3152
    s_waitcnt lgkmcnt(9)
    v_mfma_f32_32x32x16_bf16 a[16:31], a[48:51], a[72:75], a[16:31]
    ds_read2_b32 a[36:37], v14 offset0:136 offset1:137
    ds_read2_b32 a[38:39], v14 offset0:138 offset1:139
    s_waitcnt lgkmcnt(10)
    v_mfma_f32_32x32x16_bf16 a[0:15], a[48:51], a[76:79], a[0:15]
    ds_read_b128 a[64:67], v11 offset:5680
    ds_read_b128 a[68:71], v11 offset:3120
    s_waitcnt lgkmcnt(9)
    v_mfma_f32_32x32x16_bf16 a[16:31], a[52:55], a[80:83], a[16:31]
    ds_read2_b32 a[40:41], v14 offset0:144 offset1:145
    ds_read2_b32 a[42:43], v14 offset0:146 offset1:147
    s_waitcnt lgkmcnt(10)
    v_mfma_f32_32x32x16_bf16 a[0:15], a[52:55], a[84:87], a[0:15]
    ds_read_b128 a[72:75], v11 offset:5632
    ds_read_b128 a[76:79], v11 offset:3072
    s_waitcnt lgkmcnt(9)
    v_mfma_f32_32x32x16_bf16 a[16:31], a[32:35], a[56:59], a[16:31]
    ds_read2_b32 a[44:45], v14 offset0:152 offset1:153
    ds_read2_b32 a[46:47], v14 offset0:154 offset1:155
    s_waitcnt lgkmcnt(10)
    v_mfma_f32_32x32x16_bf16 a[0:15], a[32:35], a[60:63], a[0:15]
    ds_read_b128 a[80:83], v11 offset:5600
    ds_read_b128 a[84:87], v11 offset:3040
    s_waitcnt lgkmcnt(9)
    v_mfma_f32_32x32x16_bf16 a[16:31], a[36:39], a[64:67], a[16:31]
    ds_read2_b32 a[48:49], v14 offset0:160 offset1:161
    ds_read2_b32 a[50:51], v14 offset0:162 offset1:163
    s_waitcnt lgkmcnt(10)
    v_mfma_f32_32x32x16_bf16 a[0:15], a[36:39], a[68:71], a[0:15]
    ds_read_b128 a[56:59], v11 offset:5552
    ds_read_b128 a[60:63], v11 offset:2992
    s_waitcnt lgkmcnt(9)
    v_mfma_f32_32x32x16_bf16 a[16:31], a[40:43], a[72:75], a[16:31]
    ds_read2_b32 a[52:53], v14 offset0:168 offset1:169
    ds_read2_b32 a[54:55], v14 offset0:170 offset1:171
    s_waitcnt lgkmcnt(10)
    v_mfma_f32_32x32x16_bf16 a[0:15], a[40:43], a[76:79], a[0:15]
    ds_read_b128 a[64:67], v11 offset:5520
    ds_read_b128 a[68:71], v11 offset:2960
    s_waitcnt lgkmcnt(9)
    v_mfma_f32_32x32x16_bf16 a[16:31], a[44:47], a[80:83], a[16:31]
    ds_read2_b32 a[32:33], v14 offset0:176 offset1:177
    ds_read2_b32 a[34:35], v14 offset0:178 offset1:179
    s_waitcnt lgkmcnt(10)
    v_mfma_f32_32x32x16_bf16 a[0:15], a[44:47], a[84:87], a[0:15]
    ds_read_b128 a[72:75], v11 offset:5472
    ds_read_b128 a[76:79], v11 offset:2912
    s_waitcnt lgkmcnt(9)
    v_mfma_f32_32x32x16_bf16 a[16:31], a[48:51], a[56:59], a[16:31]
    ds_read2_b32 a[36:37], v14 offset0:184 offset1:185
    ds_read2_b32 a[38:39], v14 offset0:186 offset1:187
    s_waitcnt lgkmcnt(10)
    v_mfma_f32_32x32x16_bf16 a[0:15], a[48:51], a[60:63], a[0:15]
    ds_read_b128 a[80:83], v11 offset:5440
    ds_read_b128 a[84:87], v11 offset:2880
    s_waitcnt lgkmcnt(9)
    v_mfma_f32_32x32x16_bf16 a[16:31], a[52:55], a[64:67], a[16:31]
    ds_read2_b32 a[40:41], v14 offset0:192 offset1:193
    ds_read2_b32 a[42:43], v14 offset0:194 offset1:195
    s_waitcnt lgkmcnt(10)
    v_mfma_f32_32x32x16_bf16 a[0:15], a[52:55], a[68:71], a[0:15]
    ds_read_b128 a[56:59], v11 offset:5392
    ds_read_b128 a[60:63], v11 offset:2832
    s_waitcnt lgkmcnt(9)
    v_mfma_f32_32x32x16_bf16 a[16:31], a[32:35], a[72:75], a[16:31]
    ds_read2_b32 a[44:45], v14 offset0:200 offset1:201
    ds_read2_b32 a[46:47], v14 offset0:202 offset1:203
    s_waitcnt lgkmcnt(10)
    v_mfma_f32_32x32x16_bf16 a[0:15], a[32:35], a[76:79], a[0:15]
    ds_read_b128 a[64:67], v11 offset:5360
    ds_read_b128 a[68:71], v11 offset:2800
    s_waitcnt lgkmcnt(9)
    v_mfma_f32_32x32x16_bf16 a[16:31], a[36:39], a[80:83], a[16:31]
    ds_read2_b32 a[48:49], v14 offset0:208 offset1:209
    ds_read2_b32 a[50:51], v14 offset0:210 offset1:211
    s_waitcnt lgkmcnt(10)
    v_mfma_f32_32x32x16_bf16 a[0:15], a[36:39], a[84:87], a[0:15]
    ds_read_b128 a[72:75], v11 offset:5312
    ds_read_b128 a[76:79], v11 offset:2752
    s_waitcnt lgkmcnt(9)
    v_mfma_f32_32x32x16_bf16 a[16:31], a[40:43], a[56:59], a[16:31]
    ds_read2_b32 a[52:53], v14 offset0:216 offset1:217
    ds_read2_b32 a[54:55], v14 offset0:218 offset1:219
    s_waitcnt lgkmcnt(10)
    v_mfma_f32_32x32x16_bf16 a[0:15], a[40:43], a[60:63], a[0:15]
    ds_read_b128 a[80:83], v11 offset:5280
    ds_read_b128 a[84:87], v11 offset:2720
    s_waitcnt lgkmcnt(9)
    v_mfma_f32_32x32x16_bf16 a[16:31], a[44:47], a[64:67], a[16:31]
    ds_read2_b32 a[32:33], v14 offset0:224 offset1:225
    ds_read2_b32 a[34:35], v14 offset0:226 offset1:227
    s_waitcnt lgkmcnt(10)
    v_mfma_f32_32x32x16_bf16 a[0:15], a[44:47], a[68:71], a[0:15]
    ds_read_b128 a[56:59], v11 offset:5232
    ds_read_b128 a[60:63], v11 offset:2672
    s_waitcnt lgkmcnt(9)
    v_mfma_f32_32x32x16_bf16 a[16:31], a[48:51], a[72:75], a[16:31]
    ds_read2_b32 a[36:37], v14 offset0:232 offset1:233
    ds_read2_b32 a[38:39], v14 offset0:234 offset1:235
    s_waitcnt lgkmcnt(10)
    v_mfma_f32_32x32x16_bf16 a[0:15], a[48:51], a[76:79], a[0:15]
    ds_read_b128 a[64:67], v11 offset:5200
    ds_read_b128 a[68:71], v11 offset:2640
    s_waitcnt lgkmcnt(9)
    v_mfma_f32_32x32x16_bf16 a[16:31], a[52:55], a[80:83], a[16:31]
    ds_read2_b32 a[40:41], v14 offset0:240 offset1:241
    ds_read2_b32 a[42:43], v14 offset0:242 offset1:243
    s_waitcnt lgkmcnt(10)
    v_mfma_f32_32x32x16_bf16 a[0:15], a[52:55], a[84:87], a[0:15]
    ds_read_b128 a[72:75], v11 offset:5152
    ds_read_b128 a[76:79], v11 offset:2592
    s_waitcnt lgkmcnt(9)
    v_mfma_f32_32x32x16_bf16 a[16:31], a[32:35], a[56:59], a[16:31]
    ds_read2_b32 a[44:45], v14 offset0:248 offset1:249
    ds_read2_b32 a[46:47], v14 offset0:250 offset1:251
    v_add_u32 v14, 1024, v14
    s_waitcnt lgkmcnt(10)
    v_mfma_f32_32x32x16_bf16 a[0:15], a[32:35], a[60:63], a[0:15]
    ds_read_b128 a[80:83], v11 offset:5120
    ds_read_b128 a[84:87], v11 offset:2560
    s_waitcnt lgkmcnt(9)
    v_mfma_f32_32x32x16_bf16 a[16:31], a[36:39], a[64:67], a[16:31]
    ds_read2_b32 a[48:49], v14 offset0:0 offset1:1
    ds_read2_b32 a[50:51], v14 offset0:2 offset1:3
    s_waitcnt lgkmcnt(10)
    v_mfma_f32_32x32x16_bf16 a[0:15], a[36:39], a[68:71], a[0:15]
    ds_read_b128 a[56:59], v11 offset:5072
    ds_read2_b32 a[52:53], v14 offset0:8 offset1:9
    ds_read2_b32 a[54:55], v14 offset0:10 offset1:11
    s_waitcnt lgkmcnt(10)
    v_mfma_f32_32x32x16_bf16 a[16:31], a[40:43], a[72:75], a[16:31]
    ds_read_b128 a[60:63], v11 offset:5040
    s_waitcnt lgkmcnt(10)
    v_mfma_f32_32x32x16_bf16 a[0:15], a[40:43], a[76:79], a[0:15]
    ds_read2_b32 a[32:33], v14 offset0:16 offset1:17
    ds_read2_b32 a[34:35], v14 offset0:18 offset1:19
    ds_read_b128 a[64:67], v11 offset:4992
    s_waitcnt lgkmcnt(10)
    v_mfma_f32_32x32x16_bf16 a[16:31], a[44:47], a[80:83], a[16:31]
    ds_read2_b32 a[36:37], v14 offset0:24 offset1:25
    ds_read2_b32 a[38:39], v14 offset0:26 offset1:27
    s_waitcnt lgkmcnt(11)
    v_mfma_f32_32x32x16_bf16 a[0:15], a[44:47], a[84:87], a[0:15]
    ds_read_b128 a[68:71], v11 offset:4960
    ds_read2_b32 a[40:41], v14 offset0:32 offset1:33
    ds_read2_b32 a[42:43], v14 offset0:34 offset1:35
    s_waitcnt lgkmcnt(11)
    v_mfma_f32_32x32x16_bf16 a[16:31], a[48:51], a[56:59], a[16:31]
    ds_read_b128 a[72:75], v11 offset:4912
    ds_read2_b32 a[44:45], v14 offset0:40 offset1:41
    ds_read2_b32 a[46:47], v14 offset0:42 offset1:43
    s_waitcnt lgkmcnt(11)
    v_mfma_f32_32x32x16_bf16 a[16:31], a[52:55], a[60:63], a[16:31]
    ds_read_b128 a[76:79], v11 offset:4880
    ds_read2_b32 a[48:49], v14 offset0:48 offset1:49
    ds_read2_b32 a[50:51], v14 offset0:50 offset1:51
    s_waitcnt lgkmcnt(11)
    v_mfma_f32_32x32x16_bf16 a[16:31], a[32:35], a[64:67], a[16:31]
    ds_read_b128 a[80:83], v11 offset:4832
    ds_read2_b32 a[52:53], v14 offset0:56 offset1:57
    ds_read2_b32 a[54:55], v14 offset0:58 offset1:59
    s_waitcnt lgkmcnt(11)
    v_mfma_f32_32x32x16_bf16 a[16:31], a[36:39], a[68:71], a[16:31]
    ds_read_b128 a[84:87], v11 offset:4800
    ds_read2_b32 a[32:33], v14 offset0:64 offset1:65
    ds_read2_b32 a[34:35], v14 offset0:66 offset1:67
    s_waitcnt lgkmcnt(11)
    v_mfma_f32_32x32x16_bf16 a[16:31], a[40:43], a[72:75], a[16:31]
    ds_read_b128 a[56:59], v11 offset:4752
    ds_read2_b32 a[36:37], v14 offset0:72 offset1:73
    ds_read2_b32 a[38:39], v14 offset0:74 offset1:75
    s_waitcnt lgkmcnt(11)
    v_mfma_f32_32x32x16_bf16 a[16:31], a[44:47], a[76:79], a[16:31]
    ds_read_b128 a[60:63], v11 offset:4720
    ds_read2_b32 a[40:41], v14 offset0:80 offset1:81
    ds_read2_b32 a[42:43], v14 offset0:82 offset1:83
    s_waitcnt lgkmcnt(11)
    v_mfma_f32_32x32x16_bf16 a[16:31], a[48:51], a[80:83], a[16:31]
    ds_read_b128 a[64:67], v11 offset:4672
    ds_read2_b32 a[44:45], v14 offset0:88 offset1:89
    ds_read2_b32 a[46:47], v14 offset0:90 offset1:91
    s_waitcnt lgkmcnt(11)
    v_mfma_f32_32x32x16_bf16 a[16:31], a[52:55], a[84:87], a[16:31]
    ds_read_b128 a[68:71], v11 offset:4640
    ds_read2_b32 a[48:49], v14 offset0:96 offset1:97
    ds_read2_b32 a[50:51], v14 offset0:98 offset1:99
    s_waitcnt lgkmcnt(11)
    v_mfma_f32_32x32x16_bf16 a[16:31], a[32:35], a[56:59], a[16:31]
    ds_read_b128 a[72:75], v11 offset:4592
    ds_read2_b32 a[52:53], v14 offset0:104 offset1:105
    ds_read2_b32 a[54:55], v14 offset0:106 offset1:107
    s_waitcnt lgkmcnt(11)
    v_mfma_f32_32x32x16_bf16 a[16:31], a[36:39], a[60:63], a[16:31]
    ds_read_b128 a[76:79], v11 offset:4560
    ds_read2_b32 a[32:33], v14 offset0:112 offset1:113
    ds_read2_b32 a[34:35], v14 offset0:114 offset1:115
    s_waitcnt lgkmcnt(11)
    v_mfma_f32_32x32x16_bf16 a[16:31], a[40:43], a[64:67], a[16:31]
    ds_read_b128 a[80:83], v11 offset:4512
    ds_read2_b32 a[36:37], v14 offset0:120 offset1:121
    ds_read2_b32 a[38:39], v14 offset0:122 offset1:123
    s_waitcnt lgkmcnt(11)
    v_mfma_f32_32x32x16_bf16 a[16:31], a[44:47], a[68:71], a[16:31]
    ds_read_b128 a[84:87], v11 offset:4480
    ds_read2_b32 a[40:41], v14 offset0:128 offset1:129
    ds_read2_b32 a[42:43], v14 offset0:130 offset1:131
    s_waitcnt lgkmcnt(11)
    v_mfma_f32_32x32x16_bf16 a[16:31], a[48:51], a[72:75], a[16:31]
    ds_read_b128 a[56:59], v11 offset:4432
    ds_read2_b32 a[44:45], v14 offset0:136 offset1:137
    ds_read2_b32 a[46:47], v14 offset0:138 offset1:139
    s_waitcnt lgkmcnt(11)
    v_mfma_f32_32x32x16_bf16 a[16:31], a[52:55], a[76:79], a[16:31]
    ds_read_b128 a[60:63], v11 offset:4400
    ds_read2_b32 a[48:49], v14 offset0:144 offset1:145
    ds_read2_b32 a[50:51], v14 offset0:146 offset1:147
    s_waitcnt lgkmcnt(11)
    v_mfma_f32_32x32x16_bf16 a[16:31], a[32:35], a[80:83], a[16:31]
    ds_read_b128 a[64:67], v11 offset:4352
    ds_read2_b32 a[52:53], v14 offset0:152 offset1:153
    ds_read2_b32 a[54:55], v14 offset0:154 offset1:155
    s_waitcnt lgkmcnt(11)
    v_mfma_f32_32x32x16_bf16 a[16:31], a[36:39], a[84:87], a[16:31]
    ds_read_b128 a[68:71], v11 offset:4320
    ds_read2_b32 a[32:33], v14 offset0:160 offset1:161
    ds_read2_b32 a[34:35], v14 offset0:162 offset1:163
    s_waitcnt lgkmcnt(11)
    v_mfma_f32_32x32x16_bf16 a[16:31], a[40:43], a[56:59], a[16:31]
    ds_read_b128 a[72:75], v11 offset:4272
    ds_read2_b32 a[36:37], v14 offset0:168 offset1:169
    ds_read2_b32 a[38:39], v14 offset0:170 offset1:171
    s_waitcnt lgkmcnt(11)
    v_mfma_f32_32x32x16_bf16 a[16:31], a[44:47], a[60:63], a[16:31]
    ds_read_b128 a[76:79], v11 offset:4240
    ds_read2_b32 a[40:41], v14 offset0:176 offset1:177
    ds_read2_b32 a[42:43], v14 offset0:178 offset1:179
    s_waitcnt lgkmcnt(11)
    v_mfma_f32_32x32x16_bf16 a[16:31], a[48:51], a[64:67], a[16:31]
    ds_read_b128 a[80:83], v11 offset:4192
    ds_read2_b32 a[44:45], v14 offset0:184 offset1:185
    ds_read2_b32 a[46:47], v14 offset0:186 offset1:187
    s_waitcnt lgkmcnt(11)
    v_mfma_f32_32x32x16_bf16 a[16:31], a[52:55], a[68:71], a[16:31]
    ds_read_b128 a[84:87], v11 offset:4160
    ds_read2_b32 a[48:49], v14 offset0:192 offset1:193
    ds_read2_b32 a[50:51], v14 offset0:194 offset1:195
    s_waitcnt lgkmcnt(11)
    v_mfma_f32_32x32x16_bf16 a[16:31], a[32:35], a[72:75], a[16:31]
    ds_read_b128 a[56:59], v11 offset:4112
    ds_read2_b32 a[52:53], v14 offset0:200 offset1:201
    ds_read2_b32 a[54:55], v14 offset0:202 offset1:203
    s_waitcnt lgkmcnt(11)
    v_mfma_f32_32x32x16_bf16 a[16:31], a[36:39], a[76:79], a[16:31]
    ds_read_b128 a[60:63], v11 offset:4080
    ds_read2_b32 a[32:33], v14 offset0:208 offset1:209
    ds_read2_b32 a[34:35], v14 offset0:210 offset1:211
    s_waitcnt lgkmcnt(11)
    v_mfma_f32_32x32x16_bf16 a[16:31], a[40:43], a[80:83], a[16:31]
    ds_read_b128 a[64:67], v11 offset:4032
    ds_read2_b32 a[36:37], v14 offset0:216 offset1:217
    ds_read2_b32 a[38:39], v14 offset0:218 offset1:219
    s_waitcnt lgkmcnt(11)
    v_mfma_f32_32x32x16_bf16 a[16:31], a[44:47], a[84:87], a[16:31]
    ds_read_b128 a[68:71], v11 offset:4000
    ds_read2_b32 a[40:41], v14 offset0:224 offset1:225
    ds_read2_b32 a[42:43], v14 offset0:226 offset1:227
    s_waitcnt lgkmcnt(11)
    v_mfma_f32_32x32x16_bf16 a[16:31], a[48:51], a[56:59], a[16:31]
    ds_read_b128 a[72:75], v11 offset:3952
    ds_read2_b32 a[44:45], v14 offset0:232 offset1:233
    ds_read2_b32 a[46:47], v14 offset0:234 offset1:235
    s_waitcnt lgkmcnt(11)
    v_mfma_f32_32x32x16_bf16 a[16:31], a[52:55], a[60:63], a[16:31]
    ds_read_b128 a[76:79], v11 offset:3920
    ds_read2_b32 a[48:49], v14 offset0:240 offset1:241
    ds_read2_b32 a[50:51], v14 offset0:242 offset1:243
    s_waitcnt lgkmcnt(11)
    v_mfma_f32_32x32x16_bf16 a[16:31], a[32:35], a[64:67], a[16:31]
    ds_read_b128 a[80:83], v11 offset:3872
    ds_read2_b32 a[52:53], v14 offset0:248 offset1:249
    ds_read2_b32 a[54:55], v14 offset0:250 offset1:251
    v_add_u32 v14, 1024, v14
    s_waitcnt lgkmcnt(11)
    v_mfma_f32_32x32x16_bf16 a[16:31], a[36:39], a[68:71], a[16:31]
    ds_read_b128 a[84:87], v11 offset:3840
    ds_read2_b32 a[32:33], v14 offset0:0 offset1:1
    ds_read2_b32 a[34:35], v14 offset0:2 offset1:3
    s_waitcnt lgkmcnt(11)
    v_mfma_f32_32x32x16_bf16 a[16:31], a[40:43], a[72:75], a[16:31]
    ds_read_b128 a[56:59], v11 offset:3792
    ds_read2_b32 a[36:37], v14 offset0:8 offset1:9
    ds_read2_b32 a[38:39], v14 offset0:10 offset1:11
    s_waitcnt lgkmcnt(11)
    v_mfma_f32_32x32x16_bf16 a[16:31], a[44:47], a[76:79], a[16:31]
    ds_read_b128 a[60:63], v11 offset:3760
    ds_read2_b32 a[40:41], v14 offset0:16 offset1:17
    ds_read2_b32 a[42:43], v14 offset0:18 offset1:19
    s_waitcnt lgkmcnt(11)
    v_mfma_f32_32x32x16_bf16 a[16:31], a[48:51], a[80:83], a[16:31]
    ds_read_b128 a[64:67], v11 offset:3712
    ds_read2_b32 a[44:45], v14 offset0:24 offset1:25
    ds_read2_b32 a[46:47], v14 offset0:26 offset1:27
    s_waitcnt lgkmcnt(11)
    v_mfma_f32_32x32x16_bf16 a[16:31], a[52:55], a[84:87], a[16:31]
    ds_read_b128 a[68:71], v11 offset:3680
    ds_read2_b32 a[48:49], v14 offset0:32 offset1:33
    ds_read2_b32 a[50:51], v14 offset0:34 offset1:35
    s_waitcnt lgkmcnt(11)
    v_mfma_f32_32x32x16_bf16 a[16:31], a[32:35], a[56:59], a[16:31]
    ds_read_b128 a[72:75], v11 offset:3632
    ds_read2_b32 a[52:53], v14 offset0:40 offset1:41
    ds_read2_b32 a[54:55], v14 offset0:42 offset1:43
    s_waitcnt lgkmcnt(11)
    v_mfma_f32_32x32x16_bf16 a[16:31], a[36:39], a[60:63], a[16:31]
    ds_read_b128 a[76:79], v11 offset:3600
    ds_read2_b32 a[32:33], v14 offset0:48 offset1:49
    ds_read2_b32 a[34:35], v14 offset0:50 offset1:51
    s_waitcnt lgkmcnt(11)
    v_mfma_f32_32x32x16_bf16 a[16:31], a[40:43], a[64:67], a[16:31]
    ds_read_b128 a[80:83], v11 offset:3552
    ds_read2_b32 a[36:37], v14 offset0:56 offset1:57
    ds_read2_b32 a[38:39], v14 offset0:58 offset1:59
    s_waitcnt lgkmcnt(11)
    v_mfma_f32_32x32x16_bf16 a[16:31], a[44:47], a[68:71], a[16:31]
    ds_read_b128 a[84:87], v11 offset:3520
    ds_read2_b32 a[40:41], v14 offset0:64 offset1:65
    ds_read2_b32 a[42:43], v14 offset0:66 offset1:67
    s_waitcnt lgkmcnt(11)
    v_mfma_f32_32x32x16_bf16 a[16:31], a[48:51], a[72:75], a[16:31]
    ds_read_b128 a[56:59], v11 offset:3472
    ds_read2_b32 a[44:45], v14 offset0:72 offset1:73
    ds_read2_b32 a[46:47], v14 offset0:74 offset1:75
    s_waitcnt lgkmcnt(11)
    v_mfma_f32_32x32x16_bf16 a[16:31], a[52:55], a[76:79], a[16:31]
    ds_read_b128 a[60:63], v11 offset:3440
    ds_read2_b32 a[48:49], v14 offset0:80 offset1:81
    ds_read2_b32 a[50:51], v14 offset0:82 offset1:83
    s_waitcnt lgkmcnt(11)
    v_mfma_f32_32x32x16_bf16 a[16:31], a[32:35], a[80:83], a[16:31]
    ds_read_b128 a[64:67], v11 offset:3392
    ds_read2_b32 a[52:53], v14 offset0:88 offset1:89
    ds_read2_b32 a[54:55], v14 offset0:90 offset1:91
    s_waitcnt lgkmcnt(11)
    v_mfma_f32_32x32x16_bf16 a[16:31], a[36:39], a[84:87], a[16:31]
    ds_read_b128 a[68:71], v11 offset:3360
    ds_read2_b32 a[32:33], v14 offset0:96 offset1:97
    ds_read2_b32 a[34:35], v14 offset0:98 offset1:99
    s_waitcnt lgkmcnt(11)
    v_mfma_f32_32x32x16_bf16 a[16:31], a[40:43], a[56:59], a[16:31]
    ds_read_b128 a[72:75], v11 offset:3312
    ds_read2_b32 a[36:37], v14 offset0:104 offset1:105
    ds_read2_b32 a[38:39], v14 offset0:106 offset1:107
    s_waitcnt lgkmcnt(11)
    v_mfma_f32_32x32x16_bf16 a[16:31], a[44:47], a[60:63], a[16:31]
    ds_read_b128 a[76:79], v11 offset:3280
    ds_read2_b32 a[40:41], v14 offset0:112 offset1:113
    ds_read2_b32 a[42:43], v14 offset0:114 offset1:115
    s_waitcnt lgkmcnt(11)
    v_mfma_f32_32x32x16_bf16 a[16:31], a[48:51], a[64:67], a[16:31]
    ds_read_b128 a[80:83], v11 offset:3232
    ds_read2_b32 a[44:45], v14 offset0:120 offset1:121
    ds_read2_b32 a[46:47], v14 offset0:122 offset1:123
    s_waitcnt lgkmcnt(11)
    v_mfma_f32_32x32x16_bf16 a[16:31], a[52:55], a[68:71], a[16:31]
    ds_read_b128 a[84:87], v11 offset:3200
    ds_read2_b32 a[48:49], v14 offset0:128 offset1:129
    ds_read2_b32 a[50:51], v14 offset0:130 offset1:131
    s_waitcnt lgkmcnt(11)
    v_mfma_f32_32x32x16_bf16 a[16:31], a[32:35], a[72:75], a[16:31]
    ds_read_b128 a[56:59], v11 offset:3152
    ds_read2_b32 a[52:53], v14 offset0:136 offset1:137
    ds_read2_b32 a[54:55], v14 offset0:138 offset1:139
    s_waitcnt lgkmcnt(11)
    v_mfma_f32_32x32x16_bf16 a[16:31], a[36:39], a[76:79], a[16:31]
    ds_read_b128 a[60:63], v11 offset:3120
    ds_read2_b32 a[32:33], v14 offset0:144 offset1:145
    ds_read2_b32 a[34:35], v14 offset0:146 offset1:147
    s_waitcnt lgkmcnt(11)
    v_mfma_f32_32x32x16_bf16 a[16:31], a[40:43], a[80:83], a[16:31]
    ds_read_b128 a[64:67], v11 offset:3072
    ds_read2_b32 a[36:37], v14 offset0:152 offset1:153
    ds_read2_b32 a[38:39], v14 offset0:154 offset1:155
    s_waitcnt lgkmcnt(11)
    v_mfma_f32_32x32x16_bf16 a[16:31], a[44:47], a[84:87], a[16:31]
    ds_read_b128 a[68:71], v11 offset:3040
    ds_read2_b32 a[40:41], v14 offset0:160 offset1:161
    ds_read2_b32 a[42:43], v14 offset0:162 offset1:163
    s_waitcnt lgkmcnt(11)
    v_mfma_f32_32x32x16_bf16 a[16:31], a[48:51], a[56:59], a[16:31]
    ds_read_b128 a[72:75], v11 offset:2992
    ds_read2_b32 a[44:45], v14 offset0:168 offset1:169
    ds_read2_b32 a[46:47], v14 offset0:170 offset1:171
    s_waitcnt lgkmcnt(11)
    v_mfma_f32_32x32x16_bf16 a[16:31], a[52:55], a[60:63], a[16:31]
    ds_read_b128 a[76:79], v11 offset:2960
    ds_read2_b32 a[48:49], v14 offset0:176 offset1:177
    ds_read2_b32 a[50:51], v14 offset0:178 offset1:179
    s_waitcnt lgkmcnt(11)
    v_mfma_f32_32x32x16_bf16 a[16:31], a[32:35], a[64:67], a[16:31]
    ds_read_b128 a[80:83], v11 offset:2912
    ds_read2_b32 a[52:53], v14 offset0:184 offset1:185
    ds_read2_b32 a[54:55], v14 offset0:186 offset1:187
    s_waitcnt lgkmcnt(11)
    v_mfma_f32_32x32x16_bf16 a[16:31], a[36:39], a[68:71], a[16:31]
    ds_read_b128 a[84:87], v11 offset:2880
    ds_read2_b32 a[32:33], v14 offset0:192 offset1:193
    ds_read2_b32 a[34:35], v14 offset0:194 offset1:195
    s_waitcnt lgkmcnt(11)
    v_mfma_f32_32x32x16_bf16 a[16:31], a[40:43], a[72:75], a[16:31]
    ds_read_b128 a[56:59], v11 offset:2832
    ds_read2_b32 a[36:37], v14 offset0:200 offset1:201
    ds_read2_b32 a[38:39], v14 offset0:202 offset1:203
    s_waitcnt lgkmcnt(11)
    v_mfma_f32_32x32x16_bf16 a[16:31], a[44:47], a[76:79], a[16:31]
    ds_read_b128 a[60:63], v11 offset:2800
    ds_read2_b32 a[40:41], v14 offset0:208 offset1:209
    ds_read2_b32 a[42:43], v14 offset0:210 offset1:211
    s_waitcnt lgkmcnt(11)
    v_mfma_f32_32x32x16_bf16 a[16:31], a[48:51], a[80:83], a[16:31]
    ds_read_b128 a[64:67], v11 offset:2752
    ds_read2_b32 a[44:45], v14 offset0:216 offset1:217
    ds_read2_b32 a[46:47], v14 offset0:218 offset1:219
    s_waitcnt lgkmcnt(11)
    v_mfma_f32_32x32x16_bf16 a[16:31], a[52:55], a[84:87], a[16:31]
    ds_read_b128 a[68:71], v11 offset:2720
    ds_read2_b32 a[48:49], v14 offset0:224 offset1:225
    ds_read2_b32 a[50:51], v14 offset0:226 offset1:227
    s_waitcnt lgkmcnt(11)
    v_mfma_f32_32x32x16_bf16 a[16:31], a[32:35], a[56:59], a[16:31]
    ds_read_b128 a[72:75], v11 offset:2672
    ds_read2_b32 a[52:53], v14 offset0:232 offset1:233
    ds_read2_b32 a[54:55], v14 offset0:234 offset1:235
    s_waitcnt lgkmcnt(11)
    v_mfma_f32_32x32x16_bf16 a[16:31], a[36:39], a[60:63], a[16:31]
    ds_read_b128 a[76:79], v11 offset:2640
    ds_read2_b32 a[32:33], v14 offset0:240 offset1:241
    ds_read2_b32 a[34:35], v14 offset0:242 offset1:243
    s_waitcnt lgkmcnt(11)
    v_mfma_f32_32x32x16_bf16 a[16:31], a[40:43], a[64:67], a[16:31]
    ds_read_b128 a[80:83], v11 offset:2592
    ds_read2_b32 a[36:37], v14 offset0:248 offset1:249
    ds_read2_b32 a[38:39], v14 offset0:250 offset1:251
    v_add_u32 v14, 1024, v14
    s_waitcnt lgkmcnt(11)
    v_mfma_f32_32x32x16_bf16 a[16:31], a[44:47], a[68:71], a[16:31]
    ds_read_b128 a[84:87], v11 offset:2560
    s_waitcnt lgkmcnt(9)
    v_mfma_f32_32x32x16_bf16 a[16:31], a[48:51], a[72:75], a[16:31]
    s_waitcnt lgkmcnt(6)
    v_mfma_f32_32x32x16_bf16 a[16:31], a[52:55], a[76:79], a[16:31]
    s_waitcnt lgkmcnt(3)
    v_mfma_f32_32x32x16_bf16 a[16:31], a[32:35], a[80:83], a[16:31]
    s_waitcnt lgkmcnt(0)
    v_mfma_f32_32x32x16_bf16 a[16:31], a[36:39], a[84:87], a[16:31]
    v_accvgpr_read_b32 v220, a0
    v_accvgpr_read_b32 v221, a1
    v_accvgpr_read_b32 v222, a2
    v_accvgpr_read_b32 v223, a3
    v_accvgpr_read_b32 v224, a4
    v_accvgpr_read_b32 v225, a5
    v_accvgpr_read_b32 v226, a6
    v_accvgpr_read_b32 v227, a7
    v_accvgpr_read_b32 v228, a8
    v_accvgpr_read_b32 v229, a9
    v_accvgpr_read_b32 v230, a10
    v_accvgpr_read_b32 v231, a11
    v_accvgpr_read_b32 v232, a12
    v_accvgpr_read_b32 v233, a13
    v_accvgpr_read_b32 v234, a14
    v_accvgpr_read_b32 v235, a15
    v_cvt_pk_bf16_f32 v236, v220, v221
    v_cvt_pk_bf16_f32 v237, v222, v223
    v_cvt_pk_bf16_f32 v238, v224, v225
    v_cvt_pk_bf16_f32 v239, v226, v227
    v_cvt_pk_bf16_f32 v240, v228, v229
    v_cvt_pk_bf16_f32 v241, v230, v231
    v_cvt_pk_bf16_f32 v242, v232, v233
    v_cvt_pk_bf16_f32 v243, v234, v235
    s_nop 0
    v_permlane32_swap_b32 v236, v238
    v_permlane32_swap_b32 v237, v239
    v_permlane32_swap_b32 v240, v242
    v_permlane32_swap_b32 v241, v243
    buffer_store_dwordx4 v[236:239], v2, s[8:11], s7 offen offset:0 sc1
    buffer_store_dwordx4 v[240:243], v2, s[8:11], s7 offen offset:1024 sc1
    v_accvgpr_read_b32 v220, a16
    v_accvgpr_read_b32 v221, a17
    v_accvgpr_read_b32 v222, a18
    v_accvgpr_read_b32 v223, a19
    v_accvgpr_read_b32 v224, a20
    v_accvgpr_read_b32 v225, a21
    v_accvgpr_read_b32 v226, a22
    v_accvgpr_read_b32 v227, a23
    v_accvgpr_read_b32 v228, a24
    v_accvgpr_read_b32 v229, a25
    v_accvgpr_read_b32 v230, a26
    v_accvgpr_read_b32 v231, a27
    v_accvgpr_read_b32 v232, a28
    v_accvgpr_read_b32 v233, a29
    v_accvgpr_read_b32 v234, a30
    v_accvgpr_read_b32 v235, a31
    v_cvt_pk_bf16_f32 v236, v220, v221
    v_cvt_pk_bf16_f32 v237, v222, v223
    v_cvt_pk_bf16_f32 v238, v224, v225
    v_cvt_pk_bf16_f32 v239, v226, v227
    v_cvt_pk_bf16_f32 v240, v228, v229
    v_cvt_pk_bf16_f32 v241, v230, v231
    v_cvt_pk_bf16_f32 v242, v232, v233
    v_cvt_pk_bf16_f32 v243, v234, v235
    s_nop 0
    v_permlane32_swap_b32 v236, v238
    v_permlane32_swap_b32 v237, v239
    v_permlane32_swap_b32 v240, v242
    v_permlane32_swap_b32 v241, v243
    buffer_store_dwordx4 v[236:239], v2, s[8:11], s7 offen offset:2048 sc1
    buffer_store_dwordx4 v[240:243], v2, s[8:11], s7 offen offset:3072 sc1
    v_add_u32 v11, 30720, v11
    s_add_u32 s64, s64, 1
    s_cmp_lt_u32 s64, 4
    s_waitcnt vmcnt(4)
    s_cbranch_scc1 .chan_416
    s_waitcnt vmcnt(0)
    s_barrier
    v_mov_b32 v4, 1
    v_mov_b32 v5, 0
    s_mov_b64 exec, 1
    buffer_store_dword v4, v5, s[8:11], s94 offen offset:4 sc1
    s_mov_b64 exec, -1
    s_branch .fin_419
.qa_408:
    s_and_b32 s34, s24, 1
    s_lshr_b32 s35, s24, 1
    s_lshl_b32 s4, s35, 10
    s_add_u32 s4, s4, 2048
    v_lshlrev_b32 v2, 4, v1
    s_lshl_b32 s5, s24, 10
    s_add_u32 s5, s5, 131072
    v_add_u32 v24, s5, v2
    s_lshl_b32 s5, s34, 12
    s_add_u32 s5, s5, 131072
    v_add_u32 v25, s5, v2
    v_add_u32 v31, 139264, v2
    s_lshl_b32 s5, s35, 12
    v_add_u32 v5, s5, v31
    s_lshl_b32 s43, s24, 11
    v_bfe_u32 v254, v1, 4, 2
    v_mul_u32_u24 v3, 128, v254
    v_bfe_u32 v254, v1, 2, 2
    v_mul_u32_u24 v254, 32, v254
    v_add_u32 v3, v3, v254
    v_bfe_u32 v254, v1, 0, 1
    v_mul_u32_u24 v254, 16, v254
    v_add_u32 v3, v3, v254
    v_add_u32 v3, 155648, v3
    v_bfe_u32 v254, v1, 2, 2
    v_mul_u32_u24 v6, 128, v254
    v_bfe_u32 v254, v1, 0, 2
    v_mul_u32_u24 v254, 16, v254
    v_add_u32 v6, v6, v254
    v_bfe_u32 v254, v1, 4, 2
    v_mul_u32_u24 v254, 4, v254
    v_add_u32 v6, v6, v254
    v_add_u32 v6, 155648, v6
    v_add_u32 v6, s4, v6
    s_lshl_b32 s4, s99, 9
    s_add_u32 s4, s4, 92274688
    v_bfe_u32 v254, v1, 0, 2
    v_mul_u32_u24 v7, 128, v254
    v_add_u32 v7, s4, v7
    v_mov_b32 v232, 0
    v_mov_b32 v233, 0
    v_mov_b32 v234, 0
    v_mov_b32 v235, 0
    v_mov_b32 v236, 0
    v_mov_b32 v237, 0
    v_mov_b32 v238, 0
    v_mov_b32 v239, 0
    v_mov_b32 v240, 0
    v_mov_b32 v241, 0
    v_mov_b32 v40, 0
    v_mov_b32 v44, 0x3f803f80
    v_mov_b32 v41, 0
    v_mov_b32 v45, 0x3f803f80
    v_mov_b32 v42, 0
    v_mov_b32 v46, 0x3f803f80
    v_mov_b32 v43, 0
    v_mov_b32 v47, 0x3f803f80
    s_lshl_b32 s4, s34, 4
    v_and_b32 v48, 15, v1
    v_add_u32 v48, s4, v48
    v_lshrrev_b32 v49, 4, v1
    v_lshlrev_b32 v49, 2, v49
    v_mov_b32 v51, 0xff800000
    v_add_u32 v50, 0, v49
    v_cmp_le_u32 vcc, v50, v48
    s_nop 1
    v_cndmask_b32 v32, v51, v40, vcc
    v_add_u32 v50, 1, v49
    v_cmp_le_u32 vcc, v50, v48
    s_nop 1
    v_cndmask_b32 v33, v51, v40, vcc
    v_add_u32 v50, 2, v49
    v_cmp_le_u32 vcc, v50, v48
    s_nop 1
    v_cndmask_b32 v34, v51, v40, vcc
    v_add_u32 v50, 3, v49
    v_cmp_le_u32 vcc, v50, v48
    s_nop 1
    v_cndmask_b32 v35, v51, v40, vcc
    v_add_u32 v50, 16, v49
    v_cmp_le_u32 vcc, v50, v48
    s_nop 1
    v_cndmask_b32 v36, v51, v40, vcc
    v_add_u32 v50, 17, v49
    v_cmp_le_u32 vcc, v50, v48
    s_nop 1
    v_cndmask_b32 v37, v51, v40, vcc
    v_add_u32 v50, 18, v49
    v_cmp_le_u32 vcc, v50, v48
    s_nop 1
    v_cndmask_b32 v38, v51, v40, vcc
    v_add_u32 v50, 19, v49
    v_cmp_le_u32 vcc, v50, v48
    s_nop 1
    v_cndmask_b32 v39, v51, v40, vcc
    s_lshl_b32 s4, s99, 7
    s_lshl_b32 s5, s24, 2
    s_add_u32 s4, s4, s5
    s_add_u32 s94, s4, 92340224
    s_mov_b32 s46, 16384
    s_mov_b32 s47, 32768
    s_mov_b32 s30, -1
    s_mov_b32 s32, 0
    s_mov_b32 s33, 0
    s_mov_b32 s42, 0
    s_mov_b32 s53, 75497472
    s_mov_b32 s45, 0x3e0293ee
    s_lshl_b32 s36, s99, 13
    s_add_u32 s36, s36, s43
    s_add_u32 s36, s36, 16777216
    s_add_u32 s43, s43, 139264
    s_sub_u32 s37, s36, 0x40000
    v_and_b32 v255, 15, v1
    v_bfe_u32 v254, v1, 4, 1
    v_lshlrev_b32 v255, 7, v255
    v_lshl_add_u32 v255, v254, 24, v255
    s_lshl_b32 s39, s99, 12
    s_lshl_b32 s4, s34, 12
    s_lshl_b32 s40, s99, 13
    s_add_u32 s40, s40, s4
    s_lshl_b32 s4, s35, 11
    s_add_u32 s40, s40, s4
    s_add_u32 s53, s40, 77594624
    s_add_u32 s40, s40, 16777216
    s_add_u32 s39, s39, 67108864
    s_lshl_b32 s52, s24, 10
    s_add_u32 s39, s39, s52
    s_add_u32 s52, s52, 155648
    s_mov_b32 s31, 1
    s_mov_b32 s54, s53
    s_sub_u32 s48, s39, 0x20000
    s_mov_b32 s49, s37
    s_mov_b32 vcc_lo, s27
    s_mov_b32 vcc_hi, 0
    s_cmp_gt_u32 s32, 0
    s_cbranch_scc1 .ndd_435
    s_mov_b32 s62, 0
.nd_434:
    buffer_load_dword v29, v7, s[8:11], s46 offen sc1
    buffer_load_dword v30, v7, s[8:11], s47 offen sc1
    s_add_u32 s62, s62, 1
    s_cmp_gt_u32 s62, 0x200000
    s_cbranch_scc1 .mg_end_1
    s_waitcnt vmcnt(0)
    v_min_u32 v29, v29, v30
    s_nop 1
    v_min_u32_dpp v29, v29, v29 quad_perm:[1,0,3,2] row_mask:0xf bank_mask:0xf
    s_nop 1
    v_min_u32_dpp v29, v29, v29 quad_perm:[2,3,0,1] row_mask:0xf bank_mask:0xf
    s_nop 1
    v_readfirstlane_b32 s32, v29
    s_lshl_b32 s55, s32, 18
    s_add_u32 s55, s55, s37
    s_cmp_gt_u32 s32, 0
    s_cbranch_scc1 .ndd_435
    s_sleep 2
    s_branch .nd_434
.ndd_435:
    s_waitcnt lgkmcnt(0)
    s_mov_b32 s14, 4063232
.p2align 6
.ql_436:
    s_waitcnt lgkmcnt(8)
    v_mfma_f32_16x16x32_bf16 v[192:195], a[0:3], v[64:67], 0
    buffer_load_dwordx4 v19, s[12:15], s29 offen offset:2048 lds
    v_mfma_f32_16x16x32_bf16 v[196:199], a[4:7], v[64:67], 0
    ds_read_b128 v[112:115], v10 offset:256
    ds_read_b128 v[116:119], v10 offset:33024
    v_mfma_f32_16x16x32_bf16 v[200:203], a[0:3], v[68:71], 0
    ds_read_b128 v[120:123], v11 offset:256
    ds_read_b128 v[124:127], v11 offset:33024
    v_mfma_f32_16x16x32_bf16 v[204:207], a[4:7], v[68:71], 0
    ds_read_b128 v[64:67], v8 offset:512
    ds_read_b128 v[68:71], v8 offset:33280
    v_mfma_f32_16x16x32_bf16 v[192:195], a[8:11], v[72:75], v[192:195]
    buffer_load_dwordx4 v19, s[12:15], s29 offen offset:3072 lds
    v_mfma_f32_16x16x32_bf16 v[196:199], a[12:15], v[72:75], v[196:199]
    v_cvt_pk_bf16_f32 v224, v208, v209
    v_cvt_pk_bf16_f32 v225, v210, v211
    v_mfma_f32_16x16x32_bf16 v[200:203], a[8:11], v[76:79], v[200:203]
    v_cvt_pk_bf16_f32 v226, v212, v213
    v_cvt_pk_bf16_f32 v227, v214, v215
    v_mfma_f32_16x16x32_bf16 v[204:207], a[12:15], v[76:79], v[204:207]
    ds_write_b128 v24, v[224:227] offset:0
    s_waitcnt lgkmcnt(11)
    v_mfma_f32_16x16x32_bf16 v[192:195], a[16:19], v[80:83], v[192:195]
    s_add_u32 m0, s6, 73728
    v_cvt_pk_bf16_f32 v228, v216, v217
    v_mfma_f32_16x16x32_bf16 v[196:199], a[20:23], v[80:83], v[196:199]
    buffer_load_dwordx4 v20, s[12:15], s29 offen offset:0 lds
    v_mfma_f32_16x16x32_bf16 v[200:203], a[16:19], v[84:87], v[200:203]
    v_cvt_pk_bf16_f32 v229, v218, v219
    v_cvt_pk_bf16_f32 v230, v220, v221
    v_mfma_f32_16x16x32_bf16 v[204:207], a[20:23], v[84:87], v[204:207]
    v_cvt_pk_bf16_f32 v231, v222, v223
    ds_write_b128 v24, v[228:231] offset:4096
    v_mfma_f32_16x16x32_bf16 v[192:195], a[24:27], v[88:91], v[192:195]
    ds_read_b128 v[72:75], v9 offset:512
    ds_read_b128 v[76:79], v9 offset:33280
    v_mfma_f32_16x16x32_bf16 v[196:199], a[28:31], v[88:91], v[196:199]
    buffer_load_dwordx4 v20, s[12:15], s29 offen offset:1024 lds
    v_mfma_f32_16x16x32_bf16 v[200:203], a[24:27], v[92:95], v[200:203]
    ds_read_b128 v[80:83], v10 offset:512
    ds_read_b128 v[84:87], v10 offset:33280
    v_mfma_f32_16x16x32_bf16 v[204:207], a[28:31], v[92:95], v[204:207]
    ds_read_b128 v[88:91], v11 offset:512
    s_waitcnt lgkmcnt(13)
    v_mfma_f32_16x16x32_bf16 v[192:195], a[32:35], v[96:99], v[192:195]
    s_waitcnt vmcnt(12) lgkmcnt(5)
    s_barrier
    v_mfma_f32_16x16x32_bf16 v[196:199], a[36:39], v[96:99], v[196:199]
    buffer_load_dwordx4 v21, s[12:15], s29 offen offset:2048 lds
    v_mfma_f32_16x16x32_bf16 v[200:203], a[32:35], v[100:103], v[200:203]
    ds_read_b128 v[208:211], v25 offset:0
    ds_read_b128 v[128:131], v31 offset:0
    v_mfma_f32_16x16x32_bf16 v[204:207], a[36:39], v[100:103], v[204:207]
    ds_read_b128 v[144:147], v31 offset:4096
    ds_read_b128 v[212:215], v25 offset:1024
    v_mfma_f32_16x16x32_bf16 v[192:195], a[40:43], v[104:107], v[192:195]
    ds_read_b128 v[132:135], v31 offset:1024
    ds_read_b128 v[148:151], v31 offset:5120
    v_mfma_f32_16x16x32_bf16 v[196:199], a[44:47], v[104:107], v[196:199]
    buffer_load_dwordx4 v21, s[12:15], s29 offen offset:3072 lds
    v_mfma_f32_16x16x32_bf16 v[200:203], a[40:43], v[108:111], v[200:203]
    ds_read_b128 v[92:95], v11 offset:33280
    ds_read_b128 v[216:219], v25 offset:2048
    v_mfma_f32_16x16x32_bf16 v[204:207], a[44:47], v[108:111], v[204:207]
    ds_read_b128 v[136:139], v31 offset:2048
    ds_read_b128 v[152:155], v31 offset:6144
    v_mfma_f32_16x16x32_bf16 v[192:195], a[48:51], v[112:115], v[192:195]
    ds_read_b128 v[220:223], v25 offset:3072
    ds_read_b128 v[140:143], v31 offset:3072
    v_mfma_f32_16x16x32_bf16 v[196:199], a[52:55], v[112:115], v[196:199]
    s_add_u32 m0, s6, 77824
    s_waitcnt lgkmcnt(9)
    v_mfma_f32_16x16x32_bf16 v[48:51], v[128:131], v[208:211], v[32:35]
    buffer_load_dwordx4 v22, s[12:15], s29 offen offset:0 lds
    v_mfma_f32_16x16x32_bf16 v[52:55], v[144:147], v[208:211], v[36:39]
    ds_read_b128 v[156:159], v31 offset:7168
    s_waitcnt lgkmcnt(7)
    v_mfma_f32_16x16x32_bf16 v[48:51], v[132:135], v[212:215], v[48:51]
    ds_read_b128 v[160:163], v5 offset:8192
    ds_read_b128 v[164:167], v5 offset:9216
    v_mfma_f32_16x16x32_bf16 v[52:55], v[148:151], v[212:215], v[52:55]
    ds_read_b128 v[96:99], v8 offset:768
    s_waitcnt lgkmcnt(6)
    v_mfma_f32_16x16x32_bf16 v[48:51], v[136:139], v[216:219], v[48:51]
    buffer_load_dwordx4 v22, s[12:15], s29 offen offset:1024 lds
    v_mfma_f32_16x16x32_bf16 v[52:55], v[152:155], v[216:219], v[52:55]
    ds_read_b128 v[100:103], v8 offset:33536
    ds_read_b128 v[104:107], v9 offset:768
    v_mfma_f32_16x16x32_bf16 v[200:203], a[48:51], v[116:119], v[200:203]
    ds_read_b128 v[108:111], v9 offset:33536
    ds_read_b128 v[168:171], v5 offset:10240
    v_mfma_f32_16x16x32_bf16 v[204:207], a[52:55], v[116:119], v[204:207]
    ds_read_b128 v[172:175], v5 offset:11264
    s_waitcnt lgkmcnt(8)
    v_mfma_f32_16x16x32_bf16 v[48:51], v[140:143], v[220:223], v[48:51]
    buffer_load_dwordx4 v23, s[12:15], s29 offen offset:2048 lds
    v_mfma_f32_16x16x32_bf16 v[52:55], v[156:159], v[220:223], v[52:55]
    v_max_i32 v27, s30, v26
    ds_read_b128 v[112:115], v10 offset:768
    v_mfma_f32_16x16x32_bf16 v[192:195], a[56:59], v[120:123], v[192:195]
    s_waitcnt vmcnt(12)
    s_cbranch_vccnz .cp_442
    buffer_store_dword v27, v26, s[8:11], s94 offen
.cb_443:
    v_mfma_f32_16x16x32_bf16 v[196:199], a[60:63], v[120:123], v[196:199]
    ds_read_b128 v[116:119], v10 offset:33536
    ds_read_b128 v[120:123], v11 offset:768
    v_mfma_f32_16x16x32_bf16 v[200:203], a[56:59], v[124:127], v[200:203]
    buffer_load_dwordx4 v23, s[12:15], s29 offen offset:3072 lds
    v_mfma_f32_16x16x32_bf16 v[204:207], a[60:63], v[124:127], v[204:207]
    s_cmp_eq_u32 s31, 0
    s_cbranch_scc1 .cp_446
.cb_447:
    v_mfma_f32_16x16x32_bf16 v[192:195], a[64:67], v[64:67], v[192:195]
    buffer_load_dword v29, v28, s[12:15], s29 offen
    ds_read_b128 v[124:127], v11 offset:33536
    v_mfma_f32_16x16x32_bf16 v[196:199], a[68:71], v[64:67], v[196:199]
    s_waitcnt lgkmcnt(4)
    s_barrier
    v_mfma_f32_16x16x32_bf16 v[200:203], a[64:67], v[68:71], v[200:203]
    ds_read_b128 v[176:179], v3 offset:0
    ds_read_b128 v[180:183], v3 offset:512
    v_mfma_f32_16x16x32_bf16 v[204:207], a[68:71], v[68:71], v[204:207]
    ds_read_b128 v[184:187], v3 offset:1024
    ds_read_b128 v[188:191], v3 offset:1536
    v_mfma_f32_16x16x32_bf16 v[192:195], a[72:75], v[72:75], v[192:195]
    s_add_u32 m0, s52, 4096
    s_add_u32 s48, s48, 0x20000
    v_mfma_f32_16x16x32_bf16 v[196:199], a[76:79], v[72:75], v[196:199]
    s_cmp_gt_u32 s33, s42
    s_cselect_b32 s31, 1, 0
    s_cselect_b32 s4, s48, s54
    v_mfma_f32_16x16x32_bf16 v[200:203], a[72:75], v[76:79], v[200:203]
    buffer_load_dwordx4 v2, s[8:11], s4 offen lds
    v_mfma_f32_16x16x32_bf16 v[204:207], a[76:79], v[76:79], v[204:207]
    buffer_load_dword v4, v7, s[8:11], 0 offen sc1
    ds_read_b128 v[64:67], v8 offset:1024
    v_mfma_f32_16x16x32_bf16 v[192:195], a[80:83], v[80:83], v[192:195]
    ds_read_b128 v[68:71], v8 offset:33792
    ds_read_b128 v[72:75], v9 offset:1024
    v_mfma_f32_16x16x32_bf16 v[196:199], a[84:87], v[80:83], v[196:199]
    ds_read_b128 v[76:79], v9 offset:33792
    v_max3_f32 v248, v48, v49, v50
    v_mfma_f32_16x16x32_bf16 v[200:203], a[80:83], v[84:87], v[200:203]
    v_max3_f32 v248, v248, v51, v52
    v_max3_f32 v249, v53, v54, v55
    s_waitcnt lgkmcnt(4)
    v_mfma_f32_16x16x32_bf16 v[56:59], v[176:179], v[208:211], 0
    ds_read_b128 v[80:83], v10 offset:1024
    s_add_u32 s29, s29, 0x10000
    v_mfma_f32_16x16x32_bf16 v[56:59], v[180:183], v[212:215], v[56:59]
    s_cmp_gt_u32 s32, s42
    s_cbranch_scc0 .cp_444
.cb_445:
    v_mfma_f32_16x16x32_bf16 v[56:59], v[184:187], v[216:219], v[56:59]
    ds_read_b32 v232, v6 offset:0
    ds_read_b32 v234, v6 offset:64
    v_mfma_f32_16x16x32_bf16 v[56:59], v[188:191], v[220:223], v[56:59]
    ds_read_b32 v236, v6 offset:512
    ds_read_b32 v238, v6 offset:576
    v_mfma_f32_16x16x32_bf16 v[204:207], a[84:87], v[84:87], v[204:207]
    s_add_u32 s5, s49, 0x80000
    s_min_u32 s5, s5, s55
    v_mfma_f32_16x16x32_bf16 v[192:195], a[88:91], v[88:91], v[192:195]
    buffer_load_dword v29, v255, s[8:11], s5 offen
    s_mov_b32 m0, s43
    v_mfma_f32_16x16x32_bf16 v[196:199], a[92:95], v[88:91], v[196:199]
    s_add_u32 s49, s49, 0x40000
    ds_read_b128 v[84:87], v10 offset:33792
    v_mfma_f32_16x16x32_bf16 v[200:203], a[88:91], v[92:95], v[200:203]
    buffer_load_dwordx4 v2, s[8:11], s49 offen lds
    v_mfma_f32_16x16x32_bf16 v[204:207], a[92:95], v[92:95], v[204:207]
    s_add_u32 s50, s49, 16777216
    ds_read_b128 v[88:91], v11 offset:1024
    v_mfma_f32_16x16x32_bf16 v[192:195], a[96:99], v[96:99], v[192:195]
    ds_read_b128 v[92:95], v11 offset:33792
    v_max3_f32 v248, v248, v56, v57
    v_mfma_f32_16x16x32_bf16 v[196:199], a[100:103], v[96:99], v[196:199]
    v_max_f32 v30, v248, v249
    v_max_f32 v249, v248, v249
    v_mfma_f32_16x16x32_bf16 v[200:203], a[96:99], v[100:103], v[200:203]
    buffer_load_dwordx4 v2, s[8:11], s49 offen offset:1024 lds
    v_mfma_f32_16x16x32_bf16 v[204:207], a[100:103], v[100:103], v[204:207]
    s_add_u32 m0, s43, 8192
    v_permlane16_swap_b32 v249, v30
    v_mfma_f32_16x16x32_bf16 v[192:195], a[104:107], v[104:107], v[192:195]
    v_max_f32 v248, v249, v30
    v_max_f32 v249, v249, v30
    v_mfma_f32_16x16x32_bf16 v[196:199], a[108:111], v[104:107], v[196:199]
    ds_read_b128 v[96:99], v8 offset:1280
    ds_read_b128 v[100:103], v8 offset:34048
    v_mfma_f32_16x16x32_bf16 v[200:203], a[104:107], v[108:111], v[200:203]
    buffer_load_dwordx4 v2, s[8:11], s50 offen lds
    v_mfma_f32_16x16x32_bf16 v[204:207], a[108:111], v[108:111], v[204:207]
    v_permlane32_swap_b32 v248, v249
    v_max_f32 v248, v248, v249
    v_mfma_f32_16x16x32_bf16 v[192:195], a[112:115], v[112:115], v[192:195]
    v_mul_f32 v248, s45, v248
    ds_read_b128 v[104:107], v9 offset:1280
    v_mfma_f32_16x16x32_bf16 v[196:199], a[116:119], v[112:115], v[196:199]
    ds_read_b128 v[108:111], v9 offset:34048
    v_fma_f32 v60, v48, s45, -v248
    v_mfma_f32_16x16x32_bf16 v[200:203], a[112:115], v[116:119], v[200:203]
    buffer_load_dwordx4 v2, s[8:11], s50 offen offset:1024 lds
    v_mfma_f32_16x16x32_bf16 v[204:207], a[116:119], v[116:119], v[204:207]
    v_fma_f32 v61, v49, s45, -v248
    v_fma_f32 v62, v50, s45, -v248
    v_mfma_f32_16x16x32_bf16 v[192:195], a[120:123], v[120:123], v[192:195]
    v_fma_f32 v63, v51, s45, -v248
    v_fma_f32 v242, v52, s45, -v248
    v_mfma_f32_16x16x32_bf16 v[196:199], a[124:127], v[120:123], v[196:199]
    v_fma_f32 v243, v53, s45, -v248
    v_fma_f32 v244, v54, s45, -v248
    v_mfma_f32_16x16x32_bf16 v[200:203], a[120:123], v[124:127], v[200:203]
    v_fma_f32 v245, v55, s45, -v248
    v_fma_f32 v246, v56, s45, -v248
    v_mfma_f32_16x16x32_bf16 v[204:207], a[124:127], v[124:127], v[204:207]
    v_fma_f32 v247, v57, s45, -v248
    s_waitcnt lgkmcnt(12)
    v_mfma_f32_16x16x32_bf16 v[192:195], a[128:131], v[64:67], v[192:195]
    ds_read_b128 v[112:115], v10 offset:1280
    ds_read_b128 v[116:119], v10 offset:34048
    v_mfma_f32_16x16x32_bf16 v[196:199], a[132:135], v[64:67], v[196:199]
    ds_read_b128 v[120:123], v11 offset:1280
    ds_read_b128 v[124:127], v11 offset:34048
    v_mfma_f32_16x16x32_bf16 v[200:203], a[128:131], v[68:71], v[200:203]
    v_exp_f32 v60, v60
    v_mfma_f32_16x16x32_bf16 v[204:207], a[132:135], v[68:71], v[204:207]
    v_exp_f32 v61, v61
    v_mfma_f32_16x16x32_bf16 v[192:195], a[136:139], v[72:75], v[192:195]
    v_exp_f32 v62, v62
    v_mfma_f32_16x16x32_bf16 v[196:199], a[140:143], v[72:75], v[196:199]
    v_exp_f32 v63, v63
    v_mfma_f32_16x16x32_bf16 v[200:203], a[136:139], v[76:79], v[200:203]
    v_exp_f32 v242, v242
    v_mfma_f32_16x16x32_bf16 v[204:207], a[140:143], v[76:79], v[204:207]
    ds_read_b128 v[64:67], v8 offset:1536
    s_waitcnt lgkmcnt(9)
    v_mfma_f32_16x16x32_bf16 v[192:195], a[144:147], v[80:83], v[192:195]
    v_exp_f32 v243, v243
    v_mfma_f32_16x16x32_bf16 v[196:199], a[148:151], v[80:83], v[196:199]
    v_exp_f32 v244, v244
    v_mfma_f32_16x16x32_bf16 v[200:203], a[144:147], v[84:87], v[200:203]
    v_exp_f32 v245, v245
    v_mfma_f32_16x16x32_bf16 v[204:207], a[148:151], v[84:87], v[204:207]
    v_exp_f32 v246, v246
    v_mfma_f32_16x16x32_bf16 v[192:195], a[152:155], v[88:91], v[192:195]
    v_exp_f32 v247, v247
    v_mfma_f32_16x16x32_bf16 v[196:199], a[156:159], v[88:91], v[196:199]
    ds_read_b128 v[68:71], v8 offset:34304
    ds_read_b128 v[72:75], v9 offset:1536
    v_mfma_f32_16x16x32_bf16 v[200:203], a[152:155], v[92:95], v[200:203]
    ds_read_b128 v[76:79], v9 offset:34304
    v_cvt_pk_bf16_f32 v48, v60, v61
    v_mfma_f32_16x16x32_bf16 v[204:207], a[156:159], v[92:95], v[204:207]
    v_cvt_pk_bf16_f32 v49, v62, v63
    s_waitcnt lgkmcnt(8)
    v_mfma_f32_16x16x32_bf16 v[192:195], a[160:163], v[96:99], v[192:195]
    v_cvt_pk_bf16_f32 v50, v242, v243
    v_cvt_pk_bf16_f32 v51, v244, v245
    v_mfma_f32_16x16x32_bf16 v[196:199], a[164:167], v[96:99], v[196:199]
    v_cvt_pk_bf16_f32 v40, v246, v247
    ds_read_b128 v[80:83], v10 offset:1536
    v_mfma_f32_16x16x32_bf16 v[200:203], a[160:163], v[100:103], v[200:203]
    ds_read_b128 v[84:87], v10 offset:34304
    ds_read_b128 v[88:91], v11 offset:1536
    v_mfma_f32_16x16x32_bf16 v[52:55], v[44:47], v[48:51], 0
    ds_read_b128 v[92:95], v11 offset:34304
    ds_read_b128 v[96:99], v8 offset:1792
    v_mfma_f32_16x16x32_bf16 v[52:55], v[44:47], v[40:43], v[52:55]
    v_mfma_f32_16x16x32_bf16 v[208:211], v[160:163], v[48:51], 0
    v_mfma_f32_16x16x32_bf16 v[208:211], v[232:235], v[40:43], v[208:211]
    v_mfma_f32_16x16x32_bf16 v[212:215], v[164:167], v[48:51], 0
    v_mfma_f32_16x16x32_bf16 v[212:215], v[234:237], v[40:43], v[212:215]
    v_mfma_f32_16x16x32_bf16 v[216:219], v[168:171], v[48:51], 0
    v_mfma_f32_16x16x32_bf16 v[216:219], v[236:239], v[40:43], v[216:219]
    v_mfma_f32_16x16x32_bf16 v[220:223], v[172:175], v[48:51], 0
    v_mfma_f32_16x16x32_bf16 v[220:223], v[238:241], v[40:43], v[220:223]
    v_rcp_f32 v248, v52
    v_mfma_f32_16x16x32_bf16 v[204:207], a[164:167], v[100:103], v[204:207]
    ds_read_b128 v[100:103], v8 offset:34560
    v_mul_f32 v208, v248, v208
    v_mfma_f32_16x16x32_bf16 v[192:195], a[168:171], v[104:107], v[192:195]
    v_mul_f32 v209, v248, v209
    v_mul_f32 v210, v248, v210
    v_mfma_f32_16x16x32_bf16 v[196:199], a[172:175], v[104:107], v[196:199]
    ds_read_b128 v[104:107], v9 offset:1792
    v_mul_f32 v211, v248, v211
    v_mfma_f32_16x16x32_bf16 v[200:203], a[168:171], v[108:111], v[200:203]
    v_cvt_pk_bf16_f32 v224, v208, v209
    v_cvt_pk_bf16_f32 v225, v210, v211
    v_mfma_f32_16x16x32_bf16 v[204:207], a[172:175], v[108:111], v[204:207]
    ds_read_b128 v[108:111], v9 offset:34560
    s_waitcnt lgkmcnt(12)
    v_mfma_f32_16x16x32_bf16 v[192:195], a[176:179], v[112:115], v[192:195]
    v_mul_f32 v212, v248, v212
    v_mul_f32 v213, v248, v213
    v_mfma_f32_16x16x32_bf16 v[196:199], a[180:183], v[112:115], v[196:199]
    ds_read_b128 v[112:115], v10 offset:1792
    v_mul_f32 v214, v248, v214
    v_mfma_f32_16x16x32_bf16 v[200:203], a[176:179], v[116:119], v[200:203]
    v_mul_f32 v215, v248, v215
    v_cvt_pk_bf16_f32 v226, v212, v213
    v_mfma_f32_16x16x32_bf16 v[204:207], a[180:183], v[116:119], v[204:207]
    s_waitcnt vmcnt(5)
    v_min_u32_dpp v4, v4, v4 quad_perm:[1,0,3,2] row_mask:0xf bank_mask:0xf
    v_mfma_f32_16x16x32_bf16 v[192:195], a[184:187], v[120:123], v[192:195]
    ds_read_b128 v[116:119], v10 offset:34560
    v_cvt_pk_bf16_f32 v227, v214, v215
    v_mfma_f32_16x16x32_bf16 v[196:199], a[188:191], v[120:123], v[196:199]
    v_min_u32_dpp v4, v4, v4 quad_perm:[2,3,0,1] row_mask:0xf bank_mask:0xf
    ds_read_b128 v[120:123], v11 offset:1792
    v_mfma_f32_16x16x32_bf16 v[200:203], a[184:187], v[124:127], v[200:203]
    v_readfirstlane_b32 s33, v4
    v_mfma_f32_16x16x32_bf16 v[204:207], a[188:191], v[124:127], v[204:207]
    ds_read_b128 v[124:127], v11 offset:34560
    s_waitcnt lgkmcnt(12)
    v_mfma_f32_16x16x32_bf16 v[192:195], a[192:195], v[64:67], v[192:195]
    s_cmp_eq_u32 s31, 0
    s_cbranch_scc1 .cp_450
.cb_451:
    v_mfma_f32_16x16x32_bf16 v[196:199], a[196:199], v[64:67], v[196:199]
    s_cbranch_vccnz .cp_438
    buffer_store_dwordx4 v[224:227], v2, s[8:11], s53 offen offset:0
.cb_439:
    v_mfma_f32_16x16x32_bf16 v[200:203], a[192:195], v[68:71], v[200:203]
    v_mul_f32 v216, v248, v216
    v_mul_f32 v217, v248, v217
    v_mfma_f32_16x16x32_bf16 v[204:207], a[196:199], v[68:71], v[204:207]
    v_mul_f32 v218, v248, v218
    v_mul_f32 v219, v248, v219
    v_mfma_f32_16x16x32_bf16 v[192:195], a[200:203], v[72:75], v[192:195]
    s_waitcnt lgkmcnt(0)
    s_barrier
    v_mfma_f32_16x16x32_bf16 v[196:199], a[204:207], v[72:75], v[196:199]
    s_add_u32 m0, s6, 0
    ds_read_b128 v[64:67], v12 offset:0
    v_mfma_f32_16x16x32_bf16 v[200:203], a[200:203], v[76:79], v[200:203]
    buffer_load_dwordx4 v16, s[12:15], s29 offen offset:0 lds
    v_mfma_f32_16x16x32_bf16 v[204:207], a[204:207], v[76:79], v[204:207]
    ds_read_b128 v[68:71], v12 offset:32768
    ds_read_b128 v[72:75], v13 offset:0
    v_mfma_f32_16x16x32_bf16 v[192:195], a[208:211], v[80:83], v[192:195]
    ds_read_b128 v[76:79], v13 offset:32768
    v_cvt_pk_bf16_f32 v228, v216, v217
    v_mfma_f32_16x16x32_bf16 v[196:199], a[212:215], v[80:83], v[196:199]
    v_cvt_pk_bf16_f32 v229, v218, v219
    v_mul_f32 v220, v248, v220
    v_mfma_f32_16x16x32_bf16 v[200:203], a[208:211], v[84:87], v[200:203]
    buffer_load_dwordx4 v16, s[12:15], s29 offen offset:1024 lds
    v_mfma_f32_16x16x32_bf16 v[204:207], a[212:215], v[84:87], v[204:207]
    v_mul_f32 v221, v248, v221
    v_mul_f32 v222, v248, v222
    v_mfma_f32_16x16x32_bf16 v[192:195], a[216:219], v[88:91], v[192:195]
    v_mul_f32 v223, v248, v223
    v_cvt_pk_bf16_f32 v230, v220, v221
    v_mfma_f32_16x16x32_bf16 v[196:199], a[220:223], v[88:91], v[196:199]
    v_cvt_pk_bf16_f32 v231, v222, v223
    ds_read_b128 v[80:83], v14 offset:0
    v_mfma_f32_16x16x32_bf16 v[200:203], a[216:219], v[92:95], v[200:203]
    buffer_load_dwordx4 v17, s[12:15], s29 offen offset:2048 lds
    v_mfma_f32_16x16x32_bf16 v[204:207], a[220:223], v[92:95], v[204:207]
    s_cbranch_vccnz .cp_440
    buffer_store_dwordx4 v[228:231], v2, s[8:11], s53 offen offset:1024
.cb_441:
    v_mfma_f32_16x16x32_bf16 v[192:195], a[224:227], v[96:99], v[192:195]
    ds_read_b128 v[84:87], v14 offset:32768
    ds_read_b128 v[88:91], v15 offset:0
    v_mfma_f32_16x16x32_bf16 v[196:199], a[228:231], v[96:99], v[196:199]
    ds_read_b128 v[92:95], v15 offset:32768
    ds_read_b128 v[96:99], v12 offset:256
    v_mfma_f32_16x16x32_bf16 v[200:203], a[224:227], v[100:103], v[200:203]
    buffer_load_dwordx4 v17, s[12:15], s29 offen offset:3072 lds
    v_mfma_f32_16x16x32_bf16 v[204:207], a[228:231], v[100:103], v[204:207]
    ds_read_b128 v[100:103], v12 offset:33024
    s_mov_b32 s53, s40
    v_mfma_f32_16x16x32_bf16 v[192:195], a[232:235], v[104:107], v[192:195]
    s_add_u32 s40, s40, 0x40000
    s_mov_b32 s30, s42
    v_mfma_f32_16x16x32_bf16 v[196:199], a[236:239], v[104:107], v[196:199]
    ds_read_b128 v[104:107], v13 offset:256
    s_add_u32 s42, s42, 1
    v_mfma_f32_16x16x32_bf16 v[200:203], a[232:235], v[108:111], v[200:203]
    s_add_u32 m0, s6, 4096
    v_mfma_f32_16x16x32_bf16 v[204:207], a[236:239], v[108:111], v[204:207]
    buffer_load_dwordx4 v18, s[12:15], s29 offen offset:0 lds
    v_mfma_f32_16x16x32_bf16 v[192:195], a[240:243], v[112:115], v[192:195]
    ds_read_b128 v[108:111], v13 offset:33024
    v_mfma_f32_16x16x32_bf16 v[196:199], a[244:247], v[112:115], v[196:199]
    v_mfma_f32_16x16x32_bf16 v[200:203], a[240:243], v[116:119], v[200:203]
    v_mfma_f32_16x16x32_bf16 v[204:207], a[244:247], v[116:119], v[204:207]
    buffer_load_dwordx4 v18, s[12:15], s29 offen offset:1024 lds
    v_mfma_f32_16x16x32_bf16 v[192:195], a[248:251], v[120:123], v[192:195]
    v_mfma_f32_16x16x32_bf16 v[196:199], a[252:255], v[120:123], v[196:199]
    v_mfma_f32_16x16x32_bf16 v[200:203], a[248:251], v[124:127], v[200:203]
    v_mfma_f32_16x16x32_bf16 v[204:207], a[252:255], v[124:127], v[204:207]
    s_waitcnt lgkmcnt(8)
    v_mfma_f32_16x16x32_bf16 v[208:211], a[0:3], v[64:67], 0
    buffer_load_dwordx4 v19, s[12:15], s29 offen offset:2048 lds
    v_mfma_f32_16x16x32_bf16 v[212:215], a[4:7], v[64:67], 0
    ds_read_b128 v[112:115], v14 offset:256
    ds_read_b128 v[116:119], v14 offset:33024
    v_mfma_f32_16x16x32_bf16 v[216:219], a[0:3], v[68:71], 0
    ds_read_b128 v[120:123], v15 offset:256
    ds_read_b128 v[124:127], v15 offset:33024
    v_mfma_f32_16x16x32_bf16 v[220:223], a[4:7], v[68:71], 0
    ds_read_b128 v[64:67], v12 offset:512
    ds_read_b128 v[68:71], v12 offset:33280
    v_mfma_f32_16x16x32_bf16 v[208:211], a[8:11], v[72:75], v[208:211]
    buffer_load_dwordx4 v19, s[12:15], s29 offen offset:3072 lds
    v_mfma_f32_16x16x32_bf16 v[212:215], a[12:15], v[72:75], v[212:215]
    v_cvt_pk_bf16_f32 v224, v192, v193
    v_cvt_pk_bf16_f32 v225, v194, v195
    v_mfma_f32_16x16x32_bf16 v[216:219], a[8:11], v[76:79], v[216:219]
    v_cvt_pk_bf16_f32 v226, v196, v197
    v_cvt_pk_bf16_f32 v227, v198, v199
    v_mfma_f32_16x16x32_bf16 v[220:223], a[12:15], v[76:79], v[220:223]
    ds_write_b128 v24, v[224:227] offset:0
    s_waitcnt lgkmcnt(11)
    v_mfma_f32_16x16x32_bf16 v[208:211], a[16:19], v[80:83], v[208:211]
    s_add_u32 m0, s6, 8192
    v_cvt_pk_bf16_f32 v228, v200, v201
    v_mfma_f32_16x16x32_bf16 v[212:215], a[20:23], v[80:83], v[212:215]
    buffer_load_dwordx4 v20, s[12:15], s29 offen offset:0 lds
    v_mfma_f32_16x16x32_bf16 v[216:219], a[16:19], v[84:87], v[216:219]
    v_cvt_pk_bf16_f32 v229, v202, v203
    v_cvt_pk_bf16_f32 v230, v204, v205
    v_mfma_f32_16x16x32_bf16 v[220:223], a[20:23], v[84:87], v[220:223]
    v_cvt_pk_bf16_f32 v231, v206, v207
    ds_write_b128 v24, v[228:231] offset:4096
    v_mfma_f32_16x16x32_bf16 v[208:211], a[24:27], v[88:91], v[208:211]
    ds_read_b128 v[72:75], v13 offset:512
    ds_read_b128 v[76:79], v13 offset:33280
    v_mfma_f32_16x16x32_bf16 v[212:215], a[28:31], v[88:91], v[212:215]
    buffer_load_dwordx4 v20, s[12:15], s29 offen offset:1024 lds
    v_mfma_f32_16x16x32_bf16 v[216:219], a[24:27], v[92:95], v[216:219]
    ds_read_b128 v[80:83], v14 offset:512
    ds_read_b128 v[84:87], v14 offset:33280
    v_mfma_f32_16x16x32_bf16 v[220:223], a[28:31], v[92:95], v[220:223]
    ds_read_b128 v[88:91], v15 offset:512
    s_waitcnt lgkmcnt(13)
    v_mfma_f32_16x16x32_bf16 v[208:211], a[32:35], v[96:99], v[208:211]
    s_waitcnt vmcnt(12) lgkmcnt(5)
    s_barrier
    v_mfma_f32_16x16x32_bf16 v[212:215], a[36:39], v[96:99], v[212:215]
    buffer_load_dwordx4 v21, s[12:15], s29 offen offset:2048 lds
    v_mfma_f32_16x16x32_bf16 v[216:219], a[32:35], v[100:103], v[216:219]
    ds_read_b128 v[192:195], v25 offset:0
    ds_read_b128 v[128:131], v31 offset:0
    v_mfma_f32_16x16x32_bf16 v[220:223], a[36:39], v[100:103], v[220:223]
    ds_read_b128 v[144:147], v31 offset:4096
    ds_read_b128 v[196:199], v25 offset:1024
    v_mfma_f32_16x16x32_bf16 v[208:211], a[40:43], v[104:107], v[208:211]
    ds_read_b128 v[132:135], v31 offset:1024
    ds_read_b128 v[148:151], v31 offset:5120
    v_mfma_f32_16x16x32_bf16 v[212:215], a[44:47], v[104:107], v[212:215]
    buffer_load_dwordx4 v21, s[12:15], s29 offen offset:3072 lds
    v_mfma_f32_16x16x32_bf16 v[216:219], a[40:43], v[108:111], v[216:219]
    ds_read_b128 v[92:95], v15 offset:33280
    ds_read_b128 v[200:203], v25 offset:2048
    v_mfma_f32_16x16x32_bf16 v[220:223], a[44:47], v[108:111], v[220:223]
    ds_read_b128 v[136:139], v31 offset:2048
    ds_read_b128 v[152:155], v31 offset:6144
    v_mfma_f32_16x16x32_bf16 v[208:211], a[48:51], v[112:115], v[208:211]
    ds_read_b128 v[204:207], v25 offset:3072
    ds_read_b128 v[140:143], v31 offset:3072
    v_mfma_f32_16x16x32_bf16 v[212:215], a[52:55], v[112:115], v[212:215]
    s_add_u32 m0, s6, 12288
    s_waitcnt lgkmcnt(9)
    v_mfma_f32_16x16x32_bf16 v[48:51], v[128:131], v[192:195], v[32:35]
    buffer_load_dwordx4 v22, s[12:15], s29 offen offset:0 lds
    v_mfma_f32_16x16x32_bf16 v[52:55], v[144:147], v[192:195], v[36:39]
    ds_read_b128 v[156:159], v31 offset:7168
    s_waitcnt lgkmcnt(7)
    v_mfma_f32_16x16x32_bf16 v[48:51], v[132:135], v[196:199], v[48:51]
    ds_read_b128 v[160:163], v5 offset:8192
    ds_read_b128 v[164:167], v5 offset:9216
    v_mfma_f32_16x16x32_bf16 v[52:55], v[148:151], v[196:199], v[52:55]
    ds_read_b128 v[96:99], v12 offset:768
    s_waitcnt lgkmcnt(6)
    v_mfma_f32_16x16x32_bf16 v[48:51], v[136:139], v[200:203], v[48:51]
    buffer_load_dwordx4 v22, s[12:15], s29 offen offset:1024 lds
    v_mfma_f32_16x16x32_bf16 v[52:55], v[152:155], v[200:203], v[52:55]
    ds_read_b128 v[100:103], v12 offset:33536
    ds_read_b128 v[104:107], v13 offset:768
    v_mfma_f32_16x16x32_bf16 v[216:219], a[48:51], v[116:119], v[216:219]
    ds_read_b128 v[108:111], v13 offset:33536
    ds_read_b128 v[168:171], v5 offset:10240
    v_mfma_f32_16x16x32_bf16 v[220:223], a[52:55], v[116:119], v[220:223]
    ds_read_b128 v[172:175], v5 offset:11264
    s_waitcnt lgkmcnt(8)
    v_mfma_f32_16x16x32_bf16 v[48:51], v[140:143], v[204:207], v[48:51]
    buffer_load_dwordx4 v23, s[12:15], s29 offen offset:2048 lds
    v_mfma_f32_16x16x32_bf16 v[52:55], v[156:159], v[204:207], v[52:55]
    v_max_i32 v27, s30, v26
    ds_read_b128 v[112:115], v14 offset:768
    v_mfma_f32_16x16x32_bf16 v[208:211], a[56:59], v[120:123], v[208:211]
    s_waitcnt vmcnt(12)
    s_cbranch_vccnz .cp_456
    buffer_store_dword v27, v26, s[8:11], s94 offen
.cb_457:
    v_mfma_f32_16x16x32_bf16 v[212:215], a[60:63], v[120:123], v[212:215]
    ds_read_b128 v[116:119], v14 offset:33536
    ds_read_b128 v[120:123], v15 offset:768
    v_mfma_f32_16x16x32_bf16 v[216:219], a[56:59], v[124:127], v[216:219]
    buffer_load_dwordx4 v23, s[12:15], s29 offen offset:3072 lds
    v_mfma_f32_16x16x32_bf16 v[220:223], a[60:63], v[124:127], v[220:223]
    s_cmp_eq_u32 s31, 0
    s_cbranch_scc1 .cp_460
.cb_461:
    v_mfma_f32_16x16x32_bf16 v[208:211], a[64:67], v[64:67], v[208:211]
    buffer_load_dword v29, v28, s[12:15], s29 offen
    ds_read_b128 v[124:127], v15 offset:33536
    v_mfma_f32_16x16x32_bf16 v[212:215], a[68:71], v[64:67], v[212:215]
    s_waitcnt lgkmcnt(4)
    s_barrier
    v_mfma_f32_16x16x32_bf16 v[216:219], a[64:67], v[68:71], v[216:219]
    ds_read_b128 v[176:179], v3 offset:4096
    ds_read_b128 v[180:183], v3 offset:4608
    v_mfma_f32_16x16x32_bf16 v[220:223], a[68:71], v[68:71], v[220:223]
    ds_read_b128 v[184:187], v3 offset:5120
    ds_read_b128 v[188:191], v3 offset:5632
    v_mfma_f32_16x16x32_bf16 v[208:211], a[72:75], v[72:75], v[208:211]
    s_add_u32 m0, s52, 0
    s_add_u32 s48, s48, 0x20000
    v_mfma_f32_16x16x32_bf16 v[212:215], a[76:79], v[72:75], v[212:215]
    s_cmp_gt_u32 s33, s42
    s_cselect_b32 s31, 1, 0
    s_cselect_b32 s4, s48, s54
    v_mfma_f32_16x16x32_bf16 v[216:219], a[72:75], v[76:79], v[216:219]
    buffer_load_dwordx4 v2, s[8:11], s4 offen lds
    v_mfma_f32_16x16x32_bf16 v[220:223], a[76:79], v[76:79], v[220:223]
    buffer_load_dword v4, v7, s[8:11], 0 offen sc1
    ds_read_b128 v[64:67], v12 offset:1024
    v_mfma_f32_16x16x32_bf16 v[208:211], a[80:83], v[80:83], v[208:211]
    ds_read_b128 v[68:71], v12 offset:33792
    ds_read_b128 v[72:75], v13 offset:1024
    v_mfma_f32_16x16x32_bf16 v[212:215], a[84:87], v[80:83], v[212:215]
    ds_read_b128 v[76:79], v13 offset:33792
    v_max3_f32 v248, v48, v49, v50
    v_mfma_f32_16x16x32_bf16 v[216:219], a[80:83], v[84:87], v[216:219]
    v_max3_f32 v248, v248, v51, v52
    v_max3_f32 v249, v53, v54, v55
    s_waitcnt lgkmcnt(4)
    v_mfma_f32_16x16x32_bf16 v[56:59], v[176:179], v[192:195], 0
    ds_read_b128 v[80:83], v14 offset:1024
    s_add_u32 s29, s29, 0x10000
    v_mfma_f32_16x16x32_bf16 v[56:59], v[180:183], v[196:199], v[56:59]
    s_cmp_gt_u32 s32, s42
    s_cbranch_scc0 .cp_458
.cb_459:
    v_mfma_f32_16x16x32_bf16 v[56:59], v[184:187], v[200:203], v[56:59]
    ds_read_b32 v232, v6 offset:4096
    ds_read_b32 v234, v6 offset:4160
    v_mfma_f32_16x16x32_bf16 v[56:59], v[188:191], v[204:207], v[56:59]
    ds_read_b32 v236, v6 offset:4608
    ds_read_b32 v238, v6 offset:4672
    v_mfma_f32_16x16x32_bf16 v[220:223], a[84:87], v[84:87], v[220:223]
    s_add_u32 s5, s49, 0x80000
    s_min_u32 s5, s5, s55
    v_mfma_f32_16x16x32_bf16 v[208:211], a[88:91], v[88:91], v[208:211]
    buffer_load_dword v29, v255, s[8:11], s5 offen
    s_mov_b32 m0, s43
    v_mfma_f32_16x16x32_bf16 v[212:215], a[92:95], v[88:91], v[212:215]
    s_add_u32 s49, s49, 0x40000
    ds_read_b128 v[84:87], v14 offset:33792
    v_mfma_f32_16x16x32_bf16 v[216:219], a[88:91], v[92:95], v[216:219]
    buffer_load_dwordx4 v2, s[8:11], s49 offen lds
    v_mfma_f32_16x16x32_bf16 v[220:223], a[92:95], v[92:95], v[220:223]
    s_add_u32 s50, s49, 16777216
    ds_read_b128 v[88:91], v15 offset:1024
    v_mfma_f32_16x16x32_bf16 v[208:211], a[96:99], v[96:99], v[208:211]
    ds_read_b128 v[92:95], v15 offset:33792
    v_max3_f32 v248, v248, v56, v57
    v_mfma_f32_16x16x32_bf16 v[212:215], a[100:103], v[96:99], v[212:215]
    v_max_f32 v30, v248, v249
    v_max_f32 v249, v248, v249
    v_mfma_f32_16x16x32_bf16 v[216:219], a[96:99], v[100:103], v[216:219]
    buffer_load_dwordx4 v2, s[8:11], s49 offen offset:1024 lds
    v_mfma_f32_16x16x32_bf16 v[220:223], a[100:103], v[100:103], v[220:223]
    s_add_u32 m0, s43, 8192
    v_permlane16_swap_b32 v249, v30
    v_mfma_f32_16x16x32_bf16 v[208:211], a[104:107], v[104:107], v[208:211]
    v_max_f32 v248, v249, v30
    v_max_f32 v249, v249, v30
    v_mfma_f32_16x16x32_bf16 v[212:215], a[108:111], v[104:107], v[212:215]
    ds_read_b128 v[96:99], v12 offset:1280
    ds_read_b128 v[100:103], v12 offset:34048
    v_mfma_f32_16x16x32_bf16 v[216:219], a[104:107], v[108:111], v[216:219]
    buffer_load_dwordx4 v2, s[8:11], s50 offen lds
    v_mfma_f32_16x16x32_bf16 v[220:223], a[108:111], v[108:111], v[220:223]
    v_permlane32_swap_b32 v248, v249
    v_max_f32 v248, v248, v249
    v_mfma_f32_16x16x32_bf16 v[208:211], a[112:115], v[112:115], v[208:211]
    v_mul_f32 v248, s45, v248
    ds_read_b128 v[104:107], v13 offset:1280
    v_mfma_f32_16x16x32_bf16 v[212:215], a[116:119], v[112:115], v[212:215]
    ds_read_b128 v[108:111], v13 offset:34048
    v_fma_f32 v60, v48, s45, -v248
    v_mfma_f32_16x16x32_bf16 v[216:219], a[112:115], v[116:119], v[216:219]
    buffer_load_dwordx4 v2, s[8:11], s50 offen offset:1024 lds
    v_mfma_f32_16x16x32_bf16 v[220:223], a[116:119], v[116:119], v[220:223]
    v_fma_f32 v61, v49, s45, -v248
    v_fma_f32 v62, v50, s45, -v248
    v_mfma_f32_16x16x32_bf16 v[208:211], a[120:123], v[120:123], v[208:211]
    v_fma_f32 v63, v51, s45, -v248
    v_fma_f32 v242, v52, s45, -v248
    v_mfma_f32_16x16x32_bf16 v[212:215], a[124:127], v[120:123], v[212:215]
    v_fma_f32 v243, v53, s45, -v248
    v_fma_f32 v244, v54, s45, -v248
    v_mfma_f32_16x16x32_bf16 v[216:219], a[120:123], v[124:127], v[216:219]
    v_fma_f32 v245, v55, s45, -v248
    v_fma_f32 v246, v56, s45, -v248
    v_mfma_f32_16x16x32_bf16 v[220:223], a[124:127], v[124:127], v[220:223]
    v_fma_f32 v247, v57, s45, -v248
    s_waitcnt lgkmcnt(12)
    v_mfma_f32_16x16x32_bf16 v[208:211], a[128:131], v[64:67], v[208:211]
    ds_read_b128 v[112:115], v14 offset:1280
    ds_read_b128 v[116:119], v14 offset:34048
    v_mfma_f32_16x16x32_bf16 v[212:215], a[132:135], v[64:67], v[212:215]
    ds_read_b128 v[120:123], v15 offset:1280
    ds_read_b128 v[124:127], v15 offset:34048
    v_mfma_f32_16x16x32_bf16 v[216:219], a[128:131], v[68:71], v[216:219]
    v_exp_f32 v60, v60
    v_mfma_f32_16x16x32_bf16 v[220:223], a[132:135], v[68:71], v[220:223]
    v_exp_f32 v61, v61
    v_mfma_f32_16x16x32_bf16 v[208:211], a[136:139], v[72:75], v[208:211]
    v_exp_f32 v62, v62
    v_mfma_f32_16x16x32_bf16 v[212:215], a[140:143], v[72:75], v[212:215]
    v_exp_f32 v63, v63
    v_mfma_f32_16x16x32_bf16 v[216:219], a[136:139], v[76:79], v[216:219]
    v_exp_f32 v242, v242
    v_mfma_f32_16x16x32_bf16 v[220:223], a[140:143], v[76:79], v[220:223]
    ds_read_b128 v[64:67], v12 offset:1536
    s_waitcnt lgkmcnt(9)
    v_mfma_f32_16x16x32_bf16 v[208:211], a[144:147], v[80:83], v[208:211]
    v_exp_f32 v243, v243
    v_mfma_f32_16x16x32_bf16 v[212:215], a[148:151], v[80:83], v[212:215]
    v_exp_f32 v244, v244
    v_mfma_f32_16x16x32_bf16 v[216:219], a[144:147], v[84:87], v[216:219]
    v_exp_f32 v245, v245
    v_mfma_f32_16x16x32_bf16 v[220:223], a[148:151], v[84:87], v[220:223]
    v_exp_f32 v246, v246
    v_mfma_f32_16x16x32_bf16 v[208:211], a[152:155], v[88:91], v[208:211]
    v_exp_f32 v247, v247
    v_mfma_f32_16x16x32_bf16 v[212:215], a[156:159], v[88:91], v[212:215]
    ds_read_b128 v[68:71], v12 offset:34304
    ds_read_b128 v[72:75], v13 offset:1536
    v_mfma_f32_16x16x32_bf16 v[216:219], a[152:155], v[92:95], v[216:219]
    ds_read_b128 v[76:79], v13 offset:34304
    v_cvt_pk_bf16_f32 v48, v60, v61
    v_mfma_f32_16x16x32_bf16 v[220:223], a[156:159], v[92:95], v[220:223]
    v_cvt_pk_bf16_f32 v49, v62, v63
    s_waitcnt lgkmcnt(8)
    v_mfma_f32_16x16x32_bf16 v[208:211], a[160:163], v[96:99], v[208:211]
    v_cvt_pk_bf16_f32 v50, v242, v243
    v_cvt_pk_bf16_f32 v51, v244, v245
    v_mfma_f32_16x16x32_bf16 v[212:215], a[164:167], v[96:99], v[212:215]
    v_cvt_pk_bf16_f32 v40, v246, v247
    ds_read_b128 v[80:83], v14 offset:1536
    v_mfma_f32_16x16x32_bf16 v[216:219], a[160:163], v[100:103], v[216:219]
    ds_read_b128 v[84:87], v14 offset:34304
    ds_read_b128 v[88:91], v15 offset:1536
    v_mfma_f32_16x16x32_bf16 v[52:55], v[44:47], v[48:51], 0
    ds_read_b128 v[92:95], v15 offset:34304
    ds_read_b128 v[96:99], v12 offset:1792
    v_mfma_f32_16x16x32_bf16 v[52:55], v[44:47], v[40:43], v[52:55]
    v_mfma_f32_16x16x32_bf16 v[192:195], v[160:163], v[48:51], 0
    v_mfma_f32_16x16x32_bf16 v[192:195], v[232:235], v[40:43], v[192:195]
    v_mfma_f32_16x16x32_bf16 v[196:199], v[164:167], v[48:51], 0
    v_mfma_f32_16x16x32_bf16 v[196:199], v[234:237], v[40:43], v[196:199]
    v_mfma_f32_16x16x32_bf16 v[200:203], v[168:171], v[48:51], 0
    v_mfma_f32_16x16x32_bf16 v[200:203], v[236:239], v[40:43], v[200:203]
    v_mfma_f32_16x16x32_bf16 v[204:207], v[172:175], v[48:51], 0
    v_mfma_f32_16x16x32_bf16 v[204:207], v[238:241], v[40:43], v[204:207]
    v_rcp_f32 v248, v52
    v_mfma_f32_16x16x32_bf16 v[220:223], a[164:167], v[100:103], v[220:223]
    ds_read_b128 v[100:103], v12 offset:34560
    v_mul_f32 v192, v248, v192
    v_mfma_f32_16x16x32_bf16 v[208:211], a[168:171], v[104:107], v[208:211]
    v_mul_f32 v193, v248, v193
    v_mul_f32 v194, v248, v194
    v_mfma_f32_16x16x32_bf16 v[212:215], a[172:175], v[104:107], v[212:215]
    ds_read_b128 v[104:107], v13 offset:1792
    v_mul_f32 v195, v248, v195
    v_mfma_f32_16x16x32_bf16 v[216:219], a[168:171], v[108:111], v[216:219]
    v_cvt_pk_bf16_f32 v224, v192, v193
    v_cvt_pk_bf16_f32 v225, v194, v195
    v_mfma_f32_16x16x32_bf16 v[220:223], a[172:175], v[108:111], v[220:223]
    ds_read_b128 v[108:111], v13 offset:34560
    s_waitcnt lgkmcnt(12)
    v_mfma_f32_16x16x32_bf16 v[208:211], a[176:179], v[112:115], v[208:211]
    v_mul_f32 v196, v248, v196
    v_mul_f32 v197, v248, v197
    v_mfma_f32_16x16x32_bf16 v[212:215], a[180:183], v[112:115], v[212:215]
    ds_read_b128 v[112:115], v14 offset:1792
    v_mul_f32 v198, v248, v198
    v_mfma_f32_16x16x32_bf16 v[216:219], a[176:179], v[116:119], v[216:219]
    v_mul_f32 v199, v248, v199
    v_cvt_pk_bf16_f32 v226, v196, v197
    v_mfma_f32_16x16x32_bf16 v[220:223], a[180:183], v[116:119], v[220:223]
    s_waitcnt vmcnt(5)
    v_min_u32_dpp v4, v4, v4 quad_perm:[1,0,3,2] row_mask:0xf bank_mask:0xf
    v_mfma_f32_16x16x32_bf16 v[208:211], a[184:187], v[120:123], v[208:211]
    ds_read_b128 v[116:119], v14 offset:34560
    v_cvt_pk_bf16_f32 v227, v198, v199
    v_mfma_f32_16x16x32_bf16 v[212:215], a[188:191], v[120:123], v[212:215]
    v_min_u32_dpp v4, v4, v4 quad_perm:[2,3,0,1] row_mask:0xf bank_mask:0xf
    ds_read_b128 v[120:123], v15 offset:1792
    v_mfma_f32_16x16x32_bf16 v[216:219], a[184:187], v[124:127], v[216:219]
    v_readfirstlane_b32 s33, v4
    v_mfma_f32_16x16x32_bf16 v[220:223], a[188:191], v[124:127], v[220:223]
    ds_read_b128 v[124:127], v15 offset:34560
    s_waitcnt lgkmcnt(12)
    v_mfma_f32_16x16x32_bf16 v[208:211], a[192:195], v[64:67], v[208:211]
    s_cmp_eq_u32 s31, 0
    s_cbranch_scc1 .cp_464
.cb_465:
    v_mfma_f32_16x16x32_bf16 v[212:215], a[196:199], v[64:67], v[212:215]
    s_cbranch_vccnz .cp_452
    buffer_store_dwordx4 v[224:227], v2, s[8:11], s53 offen offset:0
.cb_453:
    v_mfma_f32_16x16x32_bf16 v[216:219], a[192:195], v[68:71], v[216:219]
    v_mul_f32 v200, v248, v200
    v_mul_f32 v201, v248, v201
    v_mfma_f32_16x16x32_bf16 v[220:223], a[196:199], v[68:71], v[220:223]
    v_mul_f32 v202, v248, v202
    v_mul_f32 v203, v248, v203
    v_mfma_f32_16x16x32_bf16 v[208:211], a[200:203], v[72:75], v[208:211]
    s_waitcnt lgkmcnt(0)
    s_barrier
    v_mfma_f32_16x16x32_bf16 v[212:215], a[204:207], v[72:75], v[212:215]
    s_add_u32 m0, s6, 65536
    ds_read_b128 v[64:67], v8 offset:0
    v_mfma_f32_16x16x32_bf16 v[216:219], a[200:203], v[76:79], v[216:219]
    buffer_load_dwordx4 v16, s[12:15], s29 offen offset:0 lds
    v_mfma_f32_16x16x32_bf16 v[220:223], a[204:207], v[76:79], v[220:223]
    ds_read_b128 v[68:71], v8 offset:32768
    ds_read_b128 v[72:75], v9 offset:0
    v_mfma_f32_16x16x32_bf16 v[208:211], a[208:211], v[80:83], v[208:211]
    ds_read_b128 v[76:79], v9 offset:32768
    v_cvt_pk_bf16_f32 v228, v200, v201
    v_mfma_f32_16x16x32_bf16 v[212:215], a[212:215], v[80:83], v[212:215]
    v_cvt_pk_bf16_f32 v229, v202, v203
    v_mul_f32 v204, v248, v204
    v_mfma_f32_16x16x32_bf16 v[216:219], a[208:211], v[84:87], v[216:219]
    buffer_load_dwordx4 v16, s[12:15], s29 offen offset:1024 lds
    v_mfma_f32_16x16x32_bf16 v[220:223], a[212:215], v[84:87], v[220:223]
    v_mul_f32 v205, v248, v205
    v_mul_f32 v206, v248, v206
    v_mfma_f32_16x16x32_bf16 v[208:211], a[216:219], v[88:91], v[208:211]
    v_mul_f32 v207, v248, v207
    v_cvt_pk_bf16_f32 v230, v204, v205
    v_mfma_f32_16x16x32_bf16 v[212:215], a[220:223], v[88:91], v[212:215]
    v_cvt_pk_bf16_f32 v231, v206, v207
    ds_read_b128 v[80:83], v10 offset:0
    v_mfma_f32_16x16x32_bf16 v[216:219], a[216:219], v[92:95], v[216:219]
    buffer_load_dwordx4 v17, s[12:15], s29 offen offset:2048 lds
    v_mfma_f32_16x16x32_bf16 v[220:223], a[220:223], v[92:95], v[220:223]
    s_cbranch_vccnz .cp_454
    buffer_store_dwordx4 v[228:231], v2, s[8:11], s53 offen offset:1024
.cb_455:
    v_mfma_f32_16x16x32_bf16 v[208:211], a[224:227], v[96:99], v[208:211]
    ds_read_b128 v[84:87], v10 offset:32768
    ds_read_b128 v[88:91], v11 offset:0
    v_mfma_f32_16x16x32_bf16 v[212:215], a[228:231], v[96:99], v[212:215]
    ds_read_b128 v[92:95], v11 offset:32768
    ds_read_b128 v[96:99], v8 offset:256
    v_mfma_f32_16x16x32_bf16 v[216:219], a[224:227], v[100:103], v[216:219]
    buffer_load_dwordx4 v17, s[12:15], s29 offen offset:3072 lds
    v_mfma_f32_16x16x32_bf16 v[220:223], a[228:231], v[100:103], v[220:223]
    ds_read_b128 v[100:103], v8 offset:33024
    s_mov_b32 s53, s40
    v_mfma_f32_16x16x32_bf16 v[208:211], a[232:235], v[104:107], v[208:211]
    s_add_u32 s40, s40, 0x40000
    s_mov_b32 s30, s42
    v_mfma_f32_16x16x32_bf16 v[212:215], a[236:239], v[104:107], v[212:215]
    ds_read_b128 v[104:107], v9 offset:256
    s_add_u32 s42, s42, 1
    v_mfma_f32_16x16x32_bf16 v[216:219], a[232:235], v[108:111], v[216:219]
    s_add_u32 m0, s6, 69632
    v_mfma_f32_16x16x32_bf16 v[220:223], a[236:239], v[108:111], v[220:223]
    buffer_load_dwordx4 v18, s[12:15], s29 offen offset:0 lds
    v_mfma_f32_16x16x32_bf16 v[208:211], a[240:243], v[112:115], v[208:211]
    ds_read_b128 v[108:111], v9 offset:33024
    v_mfma_f32_16x16x32_bf16 v[212:215], a[244:247], v[112:115], v[212:215]
    v_mfma_f32_16x16x32_bf16 v[216:219], a[240:243], v[116:119], v[216:219]
    v_mfma_f32_16x16x32_bf16 v[220:223], a[244:247], v[116:119], v[220:223]
    buffer_load_dwordx4 v18, s[12:15], s29 offen offset:1024 lds
    v_mfma_f32_16x16x32_bf16 v[208:211], a[248:251], v[120:123], v[208:211]
    v_mfma_f32_16x16x32_bf16 v[212:215], a[252:255], v[120:123], v[212:215]
    v_mfma_f32_16x16x32_bf16 v[216:219], a[248:251], v[124:127], v[216:219]
    v_mfma_f32_16x16x32_bf16 v[220:223], a[252:255], v[124:127], v[220:223]
    s_cmp_lg_u32 s42, 62
    s_cbranch_scc1 .ql_436
    s_nop 5
    v_cvt_pk_bf16_f32 v224, v208, v209
    v_cvt_pk_bf16_f32 v225, v210, v211
    v_cvt_pk_bf16_f32 v226, v212, v213
    v_cvt_pk_bf16_f32 v227, v214, v215
    v_cvt_pk_bf16_f32 v228, v216, v217
    v_cvt_pk_bf16_f32 v229, v218, v219
    v_cvt_pk_bf16_f32 v230, v220, v221
    v_cvt_pk_bf16_f32 v231, v222, v223
    ds_write_b128 v24, v[224:227] offset:0
    ds_write_b128 v24, v[228:231] offset:4096
    s_waitcnt vmcnt(0)
    v_max_i32 v27, s30, v26
    s_cbranch_vccnz .cp_466
    buffer_store_dword v27, v26, s[8:11], s94 offen
.cb_467:
    s_waitcnt lgkmcnt(0)
    s_barrier
    ds_read_b128 v[208:211], v25 offset:0
    ds_read_b128 v[128:131], v31 offset:0
    ds_read_b128 v[144:147], v31 offset:4096
    ds_read_b128 v[212:215], v25 offset:1024
    ds_read_b128 v[132:135], v31 offset:1024
    ds_read_b128 v[148:151], v31 offset:5120
    ds_read_b128 v[216:219], v25 offset:2048
    ds_read_b128 v[136:139], v31 offset:2048
    ds_read_b128 v[152:155], v31 offset:6144
    ds_read_b128 v[220:223], v25 offset:3072
    ds_read_b128 v[140:143], v31 offset:3072
    ds_read_b128 v[156:159], v31 offset:7168
    ds_read_b128 v[160:163], v5 offset:8192
    ds_read_b128 v[164:167], v5 offset:9216
    ds_read_b128 v[168:171], v5 offset:10240
    ds_read_b128 v[172:175], v5 offset:11264
    s_waitcnt lgkmcnt(4)
    v_mfma_f32_16x16x32_bf16 v[48:51], v[128:131], v[208:211], v[32:35]
    v_mfma_f32_16x16x32_bf16 v[52:55], v[144:147], v[208:211], v[36:39]
    v_mfma_f32_16x16x32_bf16 v[48:51], v[132:135], v[212:215], v[48:51]
    v_mfma_f32_16x16x32_bf16 v[52:55], v[148:151], v[212:215], v[52:55]
    v_mfma_f32_16x16x32_bf16 v[48:51], v[136:139], v[216:219], v[48:51]
    v_mfma_f32_16x16x32_bf16 v[52:55], v[152:155], v[216:219], v[52:55]
    v_mfma_f32_16x16x32_bf16 v[48:51], v[140:143], v[220:223], v[48:51]
    v_mfma_f32_16x16x32_bf16 v[52:55], v[156:159], v[220:223], v[52:55]
    s_cmp_eq_u32 s31, 0
    s_cbranch_scc1 .cp_476
.cb_477:
    s_waitcnt vmcnt(0)
    s_barrier
    ds_read_b128 v[176:179], v3 offset:0
    ds_read_b128 v[180:183], v3 offset:512
    ds_read_b128 v[184:187], v3 offset:1024
    ds_read_b128 v[188:191], v3 offset:1536
    ds_read_b32 v232, v6 offset:0
    ds_read_b32 v234, v6 offset:64
    ds_read_b32 v236, v6 offset:512
    ds_read_b32 v238, v6 offset:576
    v_max3_f32 v248, v48, v49, v50
    v_max3_f32 v248, v248, v51, v52
    v_max3_f32 v249, v53, v54, v55
    s_waitcnt lgkmcnt(4)
    v_mfma_f32_16x16x32_bf16 v[56:59], v[176:179], v[208:211], 0
    v_mfma_f32_16x16x32_bf16 v[56:59], v[180:183], v[212:215], v[56:59]
    v_mfma_f32_16x16x32_bf16 v[56:59], v[184:187], v[216:219], v[56:59]
    v_mfma_f32_16x16x32_bf16 v[56:59], v[188:191], v[220:223], v[56:59]
    s_nop 7
    v_max3_f32 v248, v248, v56, v57
    v_max_f32 v30, v248, v249
    v_max_f32 v249, v248, v249
    s_nop 1
    v_permlane16_swap_b32 v249, v30
    v_max_f32 v248, v249, v30
    v_max_f32 v249, v249, v30
    s_nop 1
    v_permlane32_swap_b32 v248, v249
    v_max_f32 v248, v248, v249
    v_mul_f32 v248, s45, v248
    v_fma_f32 v60, v48, s45, -v248
    v_fma_f32 v61, v49, s45, -v248
    v_fma_f32 v62, v50, s45, -v248
    v_fma_f32 v63, v51, s45, -v248
    v_fma_f32 v242, v52, s45, -v248
    v_fma_f32 v243, v53, s45, -v248
    v_fma_f32 v244, v54, s45, -v248
    v_fma_f32 v245, v55, s45, -v248
    v_fma_f32 v246, v56, s45, -v248
    v_fma_f32 v247, v57, s45, -v248
    v_exp_f32 v60, v60
    v_exp_f32 v61, v61
    v_exp_f32 v62, v62
    v_exp_f32 v63, v63
    v_exp_f32 v242, v242
    v_exp_f32 v243, v243
    v_exp_f32 v244, v244
    v_exp_f32 v245, v245
    v_exp_f32 v246, v246
    v_exp_f32 v247, v247
    v_cvt_pk_bf16_f32 v48, v60, v61
    v_cvt_pk_bf16_f32 v49, v62, v63
    v_cvt_pk_bf16_f32 v50, v242, v243
    v_cvt_pk_bf16_f32 v51, v244, v245
    v_cvt_pk_bf16_f32 v40, v246, v247
    s_waitcnt lgkmcnt(0)
    v_mfma_f32_16x16x32_bf16 v[52:55], v[44:47], v[48:51], 0
    v_mfma_f32_16x16x32_bf16 v[52:55], v[44:47], v[40:43], v[52:55]
    v_mfma_f32_16x16x32_bf16 v[208:211], v[160:163], v[48:51], 0
    v_mfma_f32_16x16x32_bf16 v[208:211], v[232:235], v[40:43], v[208:211]
    v_mfma_f32_16x16x32_bf16 v[212:215], v[164:167], v[48:51], 0
    v_mfma_f32_16x16x32_bf16 v[212:215], v[234:237], v[40:43], v[212:215]
    v_mfma_f32_16x16x32_bf16 v[216:219], v[168:171], v[48:51], 0
    v_mfma_f32_16x16x32_bf16 v[216:219], v[236:239], v[40:43], v[216:219]
    v_mfma_f32_16x16x32_bf16 v[220:223], v[172:175], v[48:51], 0
    v_mfma_f32_16x16x32_bf16 v[220:223], v[238:241], v[40:43], v[220:223]
    v_rcp_f32 v248, v52
    s_nop 0
    v_mul_f32 v208, v248, v208
    v_mul_f32 v209, v248, v209
    v_mul_f32 v210, v248, v210
    v_mul_f32 v211, v248, v211
    v_cvt_pk_bf16_f32 v224, v208, v209
    v_cvt_pk_bf16_f32 v225, v210, v211
    v_mul_f32 v212, v248, v212
    v_mul_f32 v213, v248, v213
    v_mul_f32 v214, v248, v214
    v_mul_f32 v215, v248, v215
    v_cvt_pk_bf16_f32 v226, v212, v213
    v_cvt_pk_bf16_f32 v227, v214, v215
    s_cbranch_vccnz .cp_472
    buffer_store_dwordx4 v[224:227], v2, s[8:11], s53 offen offset:0
.cb_473:
    v_mul_f32 v216, v248, v216
    v_mul_f32 v217, v248, v217
    v_mul_f32 v218, v248, v218
    v_mul_f32 v219, v248, v219
    v_cvt_pk_bf16_f32 v228, v216, v217
    v_cvt_pk_bf16_f32 v229, v218, v219
    v_mul_f32 v220, v248, v220
    v_mul_f32 v221, v248, v221
    v_mul_f32 v222, v248, v222
    v_mul_f32 v223, v248, v223
    v_cvt_pk_bf16_f32 v230, v220, v221
    v_cvt_pk_bf16_f32 v231, v222, v223
    s_cbranch_vccnz .cp_474
    buffer_store_dwordx4 v[228:231], v2, s[8:11], s53 offen offset:1024
.cb_475:
    s_add_u32 s30, s30, 1
    s_mov_b32 s53, s40
    s_waitcnt vmcnt(0)
    v_max_i32 v27, s30, v26
    s_cbranch_vccnz .cp_478
    buffer_store_dword v27, v26, s[8:11], s94 offen
.cb_479:
    s_cmp_gt_u32 s32, 63
    s_cbranch_scc1 .ndd_481
    s_mov_b32 s62, 0
.nd_480:
    buffer_load_dword v29, v7, s[8:11], s46 offen sc1
    buffer_load_dword v30, v7, s[8:11], s47 offen sc1
    s_add_u32 s62, s62, 1
    s_cmp_gt_u32 s62, 0x200000
    s_cbranch_scc1 .mg_end_1
    s_waitcnt vmcnt(0)
    v_min_u32 v29, v29, v30
    s_nop 1
    v_min_u32_dpp v29, v29, v29 quad_perm:[1,0,3,2] row_mask:0xf bank_mask:0xf
    s_nop 1
    v_min_u32_dpp v29, v29, v29 quad_perm:[2,3,0,1] row_mask:0xf bank_mask:0xf
    s_nop 1
    v_readfirstlane_b32 s32, v29
    s_lshl_b32 s55, s32, 18
    s_add_u32 s55, s55, s37
    s_cmp_gt_u32 s32, 63
    s_cbranch_scc1 .ndd_481
    s_sleep 2
    s_branch .nd_480
.ndd_481:
    s_sub_u32 s4, s36, 16777216
    s_sub_u32 s5, s43, 139264
    s_add_u32 s49, s49, 0x40000
    s_add_u32 s50, s49, 16777216
    s_add_u32 m0, s5, 0
    s_nop 0
    buffer_load_dwordx4 v2, s[8:11], s4 offen lds
    buffer_load_dwordx4 v2, s[8:11], s4 offen offset:1024 lds
    s_add_u32 m0, s5, 8192
    s_nop 0
    buffer_load_dwordx4 v2, s[8:11], s49 offen lds
    buffer_load_dwordx4 v2, s[8:11], s49 offen offset:1024 lds
    s_add_u32 m0, s5, 16384
    s_nop 0
    buffer_load_dwordx4 v2, s[8:11], s50 offen lds
    buffer_load_dwordx4 v2, s[8:11], s50 offen offset:1024 lds
    s_add_u32 s4, s4, 0x40000
    s_add_u32 s49, s49, 0x40000
    s_add_u32 s50, s49, 16777216
    s_add_u32 m0, s5, 32768
    s_nop 0
    buffer_load_dwordx4 v2, s[8:11], s4 offen lds
    buffer_load_dwordx4 v2, s[8:11], s4 offen offset:1024 lds
    s_add_u32 m0, s5, 40960
    s_nop 0
    buffer_load_dwordx4 v2, s[8:11], s49 offen lds
    buffer_load_dwordx4 v2, s[8:11], s49 offen offset:1024 lds
    s_add_u32 m0, s5, 49152
    s_nop 0
    buffer_load_dwordx4 v2, s[8:11], s50 offen lds
    buffer_load_dwordx4 v2, s[8:11], s50 offen offset:1024 lds
    s_add_u32 s4, s4, 0x40000
    buffer_load_dword v4, v7, s[8:11], 0 offen sc1
    v_subrev_u32 v25, 131072, v25
    v_subrev_u32 v31, 131072, v31
    v_subrev_u32 v5, 131072, v5
    s_add_u32 s48, s48, 0x20000
    s_mov_b32 s31, 0
    s_add_u32 s40, s40, 0x40000
    s_waitcnt vmcnt(7)
    s_barrier
    ds_read_b128 v[192:195], v25 offset:0
    ds_read_b128 v[128:131], v31 offset:0
    ds_read_b128 v[144:147], v31 offset:4096
    ds_read_b128 v[196:199], v25 offset:1024
    ds_read_b128 v[132:135], v31 offset:1024
    ds_read_b128 v[148:151], v31 offset:5120
    ds_read_b128 v[200:203], v25 offset:2048
    ds_read_b128 v[136:139], v31 offset:2048
    ds_read_b128 v[152:155], v31 offset:6144
    ds_read_b128 v[204:207], v25 offset:3072
    ds_read_b128 v[140:143], v31 offset:3072
    ds_read_b128 v[156:159], v31 offset:7168
    ds_read_b128 v[160:163], v5 offset:8192
    ds_read_b128 v[164:167], v5 offset:9216
    ds_read_b128 v[168:171], v5 offset:10240
    ds_read_b128 v[172:175], v5 offset:11264
    s_waitcnt lgkmcnt(4)
    v_mfma_f32_16x16x32_bf16 v[48:51], v[128:131], v[192:195], v[32:35]
    v_mfma_f32_16x16x32_bf16 v[52:55], v[144:147], v[192:195], v[36:39]
    v_mfma_f32_16x16x32_bf16 v[48:51], v[132:135], v[196:199], v[48:51]
    v_mfma_f32_16x16x32_bf16 v[52:55], v[148:151], v[196:199], v[52:55]
    v_mfma_f32_16x16x32_bf16 v[48:51], v[136:139], v[200:203], v[48:51]
    v_mfma_f32_16x16x32_bf16 v[52:55], v[152:155], v[200:203], v[52:55]
    v_mfma_f32_16x16x32_bf16 v[48:51], v[140:143], v[204:207], v[48:51]
    v_mfma_f32_16x16x32_bf16 v[52:55], v[156:159], v[204:207], v[52:55]
    s_waitcnt vmcnt(0)
    v_min_u32_dpp v4, v4, v4 quad_perm:[1,0,3,2] row_mask:0xf bank_mask:0xf
    s_nop 1
    v_min_u32_dpp v4, v4, v4 quad_perm:[2,3,0,1] row_mask:0xf bank_mask:0xf
    s_nop 1
    v_readfirstlane_b32 s33, v4
    s_cmp_eq_u32 s31, 0
    s_cbranch_scc1 .cp_491
.cb_492:
    s_waitcnt vmcnt(0)
    s_barrier
    ds_read_b128 v[176:179], v3 offset:4096
    ds_read_b128 v[180:183], v3 offset:4608
    ds_read_b128 v[184:187], v3 offset:5120
    ds_read_b128 v[188:191], v3 offset:5632
    ds_read_b32 v232, v6 offset:4096
    ds_read_b32 v234, v6 offset:4160
    ds_read_b32 v236, v6 offset:4608
    ds_read_b32 v238, v6 offset:4672
    v_max3_f32 v248, v48, v49, v50
    v_max3_f32 v248, v248, v51, v52
    v_max3_f32 v249, v53, v54, v55
    s_waitcnt lgkmcnt(4)
    v_mfma_f32_16x16x32_bf16 v[56:59], v[176:179], v[192:195], 0
    v_mfma_f32_16x16x32_bf16 v[56:59], v[180:183], v[196:199], v[56:59]
    v_mfma_f32_16x16x32_bf16 v[56:59], v[184:187], v[200:203], v[56:59]
    v_mfma_f32_16x16x32_bf16 v[56:59], v[188:191], v[204:207], v[56:59]
    s_nop 7
    v_max3_f32 v248, v248, v56, v57
    v_max_f32 v30, v248, v249
    v_max_f32 v249, v248, v249
    s_nop 1
    v_permlane16_swap_b32 v249, v30
    v_max_f32 v248, v249, v30
    v_max_f32 v249, v249, v30
    s_nop 1
    v_permlane32_swap_b32 v248, v249
    v_max_f32 v248, v248, v249
    v_mul_f32 v248, s45, v248
    v_fma_f32 v60, v48, s45, -v248
    v_fma_f32 v61, v49, s45, -v248
    v_fma_f32 v62, v50, s45, -v248
    v_fma_f32 v63, v51, s45, -v248
    v_fma_f32 v242, v52, s45, -v248
    v_fma_f32 v243, v53, s45, -v248
    v_fma_f32 v244, v54, s45, -v248
    v_fma_f32 v245, v55, s45, -v248
    v_fma_f32 v246, v56, s45, -v248
    v_fma_f32 v247, v57, s45, -v248
    v_exp_f32 v60, v60
    v_exp_f32 v61, v61
    v_exp_f32 v62, v62
    v_exp_f32 v63, v63
    v_exp_f32 v242, v242
    v_exp_f32 v243, v243
    v_exp_f32 v244, v244
    v_exp_f32 v245, v245
    v_exp_f32 v246, v246
    v_exp_f32 v247, v247
    v_cvt_pk_bf16_f32 v48, v60, v61
    v_cvt_pk_bf16_f32 v49, v62, v63
    v_cvt_pk_bf16_f32 v50, v242, v243
    v_cvt_pk_bf16_f32 v51, v244, v245
    v_cvt_pk_bf16_f32 v40, v246, v247
    s_waitcnt lgkmcnt(0)
    v_mfma_f32_16x16x32_bf16 v[52:55], v[44:47], v[48:51], 0
    v_mfma_f32_16x16x32_bf16 v[52:55], v[44:47], v[40:43], v[52:55]
    v_mfma_f32_16x16x32_bf16 v[192:195], v[160:163], v[48:51], 0
    v_mfma_f32_16x16x32_bf16 v[192:195], v[232:235], v[40:43], v[192:195]
    v_mfma_f32_16x16x32_bf16 v[196:199], v[164:167], v[48:51], 0
    v_mfma_f32_16x16x32_bf16 v[196:199], v[234:237], v[40:43], v[196:199]
    v_mfma_f32_16x16x32_bf16 v[200:203], v[168:171], v[48:51], 0
    v_mfma_f32_16x16x32_bf16 v[200:203], v[236:239], v[40:43], v[200:203]
    v_mfma_f32_16x16x32_bf16 v[204:207], v[172:175], v[48:51], 0
    v_mfma_f32_16x16x32_bf16 v[204:207], v[238:241], v[40:43], v[204:207]
    v_rcp_f32 v248, v52
    s_nop 0
    v_mul_f32 v192, v248, v192
    v_mul_f32 v193, v248, v193
    v_mul_f32 v194, v248, v194
    v_mul_f32 v195, v248, v195
    v_cvt_pk_bf16_f32 v224, v192, v193
    v_cvt_pk_bf16_f32 v225, v194, v195
    v_mul_f32 v196, v248, v196
    v_mul_f32 v197, v248, v197
    v_mul_f32 v198, v248, v198
    v_mul_f32 v199, v248, v199
    v_cvt_pk_bf16_f32 v226, v196, v197
    v_cvt_pk_bf16_f32 v227, v198, v199
    s_cbranch_vccnz .cp_487
    buffer_store_dwordx4 v[224:227], v2, s[8:11], s53 offen offset:0
.cb_488:
    v_mul_f32 v200, v248, v200
    v_mul_f32 v201, v248, v201
    v_mul_f32 v202, v248, v202
    v_mul_f32 v203, v248, v203
    v_cvt_pk_bf16_f32 v228, v200, v201
    v_cvt_pk_bf16_f32 v229, v202, v203
    v_mul_f32 v204, v248, v204
    v_mul_f32 v205, v248, v205
    v_mul_f32 v206, v248, v206
    v_mul_f32 v207, v248, v207
    v_cvt_pk_bf16_f32 v230, v204, v205
    v_cvt_pk_bf16_f32 v231, v206, v207
    s_cbranch_vccnz .cp_489
    buffer_store_dwordx4 v[228:231], v2, s[8:11], s53 offen offset:1024
.cb_490:
    buffer_load_dword v4, v7, s[8:11], 0 offen sc1
    s_add_u32 s30, s30, 1
    s_mov_b32 s53, s40
    s_waitcnt vmcnt(1)
    v_max_i32 v27, s30, v26
    s_cbranch_vccnz .cp_493
    buffer_store_dword v27, v26, s[8:11], s94 offen
.cb_494:
    v_add_u32 v25, 32768, v25
    v_add_u32 v31, 32768, v31
    v_add_u32 v5, 32768, v5
    s_add_u32 s48, s48, 0x20000
    s_mov_b32 s31, 0
    s_add_u32 s40, s40, 0x40000
    ds_read_b128 v[208:211], v25 offset:0
    ds_read_b128 v[128:131], v31 offset:0
    ds_read_b128 v[144:147], v31 offset:4096
    ds_read_b128 v[212:215], v25 offset:1024
    ds_read_b128 v[132:135], v31 offset:1024
    ds_read_b128 v[148:151], v31 offset:5120
    ds_read_b128 v[216:219], v25 offset:2048
    ds_read_b128 v[136:139], v31 offset:2048
    ds_read_b128 v[152:155], v31 offset:6144
    ds_read_b128 v[220:223], v25 offset:3072
    ds_read_b128 v[140:143], v31 offset:3072
    ds_read_b128 v[156:159], v31 offset:7168
    ds_read_b128 v[160:163], v5 offset:8192
    ds_read_b128 v[164:167], v5 offset:9216
    ds_read_b128 v[168:171], v5 offset:10240
    ds_read_b128 v[172:175], v5 offset:11264
    s_waitcnt lgkmcnt(4)
    v_mfma_f32_16x16x32_bf16 v[48:51], v[128:131], v[208:211], v[32:35]
    v_mfma_f32_16x16x32_bf16 v[52:55], v[144:147], v[208:211], v[36:39]
    v_mfma_f32_16x16x32_bf16 v[48:51], v[132:135], v[212:215], v[48:51]
    v_mfma_f32_16x16x32_bf16 v[52:55], v[148:151], v[212:215], v[52:55]
    v_mfma_f32_16x16x32_bf16 v[48:51], v[136:139], v[216:219], v[48:51]
    v_mfma_f32_16x16x32_bf16 v[52:55], v[152:155], v[216:219], v[52:55]
    v_mfma_f32_16x16x32_bf16 v[48:51], v[140:143], v[220:223], v[48:51]
    v_mfma_f32_16x16x32_bf16 v[52:55], v[156:159], v[220:223], v[52:55]
    s_waitcnt vmcnt(1)
    v_min_u32_dpp v4, v4, v4 quad_perm:[1,0,3,2] row_mask:0xf bank_mask:0xf
    s_nop 1
    v_min_u32_dpp v4, v4, v4 quad_perm:[2,3,0,1] row_mask:0xf bank_mask:0xf
    s_nop 1
    v_readfirstlane_b32 s33, v4
    s_cmp_eq_u32 s31, 0
    s_cbranch_scc1 .cp_504
.cb_505:
    s_waitcnt vmcnt(0)
    s_barrier
    ds_read_b128 v[176:179], v3 offset:0
    ds_read_b128 v[180:183], v3 offset:512
    ds_read_b128 v[184:187], v3 offset:1024
    ds_read_b128 v[188:191], v3 offset:1536
    ds_read_b32 v232, v6 offset:0
    ds_read_b32 v234, v6 offset:64
    ds_read_b32 v236, v6 offset:512
    ds_read_b32 v238, v6 offset:576
    v_max3_f32 v248, v48, v49, v50
    v_max3_f32 v248, v248, v51, v52
    v_max3_f32 v249, v53, v54, v55
    s_waitcnt lgkmcnt(4)
    v_mfma_f32_16x16x32_bf16 v[56:59], v[176:179], v[208:211], 0
    v_mfma_f32_16x16x32_bf16 v[56:59], v[180:183], v[212:215], v[56:59]
    v_mfma_f32_16x16x32_bf16 v[56:59], v[184:187], v[216:219], v[56:59]
    v_mfma_f32_16x16x32_bf16 v[56:59], v[188:191], v[220:223], v[56:59]
    s_nop 7
    v_max3_f32 v248, v248, v56, v57
    v_max_f32 v30, v248, v249
    v_max_f32 v249, v248, v249
    s_nop 1
    v_permlane16_swap_b32 v249, v30
    v_max_f32 v248, v249, v30
    v_max_f32 v249, v249, v30
    s_nop 1
    v_permlane32_swap_b32 v248, v249
    v_max_f32 v248, v248, v249
    v_mul_f32 v248, s45, v248
    v_fma_f32 v60, v48, s45, -v248
    v_fma_f32 v61, v49, s45, -v248
    v_fma_f32 v62, v50, s45, -v248
    v_fma_f32 v63, v51, s45, -v248
    v_fma_f32 v242, v52, s45, -v248
    v_fma_f32 v243, v53, s45, -v248
    v_fma_f32 v244, v54, s45, -v248
    v_fma_f32 v245, v55, s45, -v248
    v_fma_f32 v246, v56, s45, -v248
    v_fma_f32 v247, v57, s45, -v248
    v_exp_f32 v60, v60
    v_exp_f32 v61, v61
    v_exp_f32 v62, v62
    v_exp_f32 v63, v63
    v_exp_f32 v242, v242
    v_exp_f32 v243, v243
    v_exp_f32 v244, v244
    v_exp_f32 v245, v245
    v_exp_f32 v246, v246
    v_exp_f32 v247, v247
    v_cvt_pk_bf16_f32 v48, v60, v61
    v_cvt_pk_bf16_f32 v49, v62, v63
    v_cvt_pk_bf16_f32 v50, v242, v243
    v_cvt_pk_bf16_f32 v51, v244, v245
    v_cvt_pk_bf16_f32 v40, v246, v247
    s_waitcnt lgkmcnt(0)
    v_mfma_f32_16x16x32_bf16 v[52:55], v[44:47], v[48:51], 0
    v_mfma_f32_16x16x32_bf16 v[52:55], v[44:47], v[40:43], v[52:55]
    v_mfma_f32_16x16x32_bf16 v[208:211], v[160:163], v[48:51], 0
    v_mfma_f32_16x16x32_bf16 v[208:211], v[232:235], v[40:43], v[208:211]
    v_mfma_f32_16x16x32_bf16 v[212:215], v[164:167], v[48:51], 0
    v_mfma_f32_16x16x32_bf16 v[212:215], v[234:237], v[40:43], v[212:215]
    v_mfma_f32_16x16x32_bf16 v[216:219], v[168:171], v[48:51], 0
    v_mfma_f32_16x16x32_bf16 v[216:219], v[236:239], v[40:43], v[216:219]
    v_mfma_f32_16x16x32_bf16 v[220:223], v[172:175], v[48:51], 0
    v_mfma_f32_16x16x32_bf16 v[220:223], v[238:241], v[40:43], v[220:223]
    v_rcp_f32 v248, v52
    s_nop 0
    v_mul_f32 v208, v248, v208
    v_mul_f32 v209, v248, v209
    v_mul_f32 v210, v248, v210
    v_mul_f32 v211, v248, v211
    v_cvt_pk_bf16_f32 v224, v208, v209
    v_cvt_pk_bf16_f32 v225, v210, v211
    v_mul_f32 v212, v248, v212
    v_mul_f32 v213, v248, v213
    v_mul_f32 v214, v248, v214
    v_mul_f32 v215, v248, v215
    v_cvt_pk_bf16_f32 v226, v212, v213
    v_cvt_pk_bf16_f32 v227, v214, v215
    s_cbranch_vccnz .cp_500
    buffer_store_dwordx4 v[224:227], v2, s[8:11], s53 offen offset:0
.cb_501:
    v_mul_f32 v216, v248, v216
    v_mul_f32 v217, v248, v217
    v_mul_f32 v218, v248, v218
    v_mul_f32 v219, v248, v219
    v_cvt_pk_bf16_f32 v228, v216, v217
    v_cvt_pk_bf16_f32 v229, v218, v219
    v_mul_f32 v220, v248, v220
    v_mul_f32 v221, v248, v221
    v_mul_f32 v222, v248, v222
    v_mul_f32 v223, v248, v223
    v_cvt_pk_bf16_f32 v230, v220, v221
    v_cvt_pk_bf16_f32 v231, v222, v223
    s_cbranch_vccnz .cp_502
    buffer_store_dwordx4 v[228:231], v2, s[8:11], s53 offen offset:1024
.cb_503:
    s_add_u32 s30, s30, 1
    s_mov_b32 s53, s40
    s_waitcnt vmcnt(0)
    v_max_i32 v27, s30, v26
    s_cbranch_vccnz .cp_506
    buffer_store_dword v27, v26, s[8:11], s94 offen
.cb_507:
    s_endpgm
.cp_438:
    buffer_store_dwordx4 v[224:227], v2, s[8:11], s53 offen offset:0 sc1
    s_branch .cb_439
.cp_440:
    buffer_store_dwordx4 v[228:231], v2, s[8:11], s53 offen offset:1024 sc1
    s_branch .cb_441
.cp_442:
    buffer_store_dword v27, v26, s[8:11], s94 offen sc1
    s_branch .cb_443
.cp_444:
    s_cmp_gt_u32 s32, s42
    s_cbranch_scc1 .ndd_509
    s_mov_b32 s62, 0
.nd_508:
    buffer_load_dword v29, v7, s[8:11], s46 offen sc1
    buffer_load_dword v30, v7, s[8:11], s47 offen sc1
    s_add_u32 s62, s62, 1
    s_cmp_gt_u32 s62, 0x200000
    s_cbranch_scc1 .mg_end_1
    s_waitcnt vmcnt(0)
    v_min_u32 v29, v29, v30
    s_nop 1
    v_min_u32_dpp v29, v29, v29 quad_perm:[1,0,3,2] row_mask:0xf bank_mask:0xf
    s_nop 1
    v_min_u32_dpp v29, v29, v29 quad_perm:[2,3,0,1] row_mask:0xf bank_mask:0xf
    s_nop 1
    v_readfirstlane_b32 s32, v29
    s_lshl_b32 s55, s32, 18
    s_add_u32 s55, s55, s37
    s_cmp_gt_u32 s32, s42
    s_cbranch_scc1 .ndd_509
    s_sleep 2
    s_branch .nd_508
.ndd_509:
    s_branch .cb_445
.cp_446:
    s_cmp_gt_u32 s33, s30
    s_cbranch_scc1 .ndd_511
    s_mov_b32 s62, 0
.nd_510:
    buffer_load_dword v4, v7, s[8:11], 0 offen sc1
    s_add_u32 s62, s62, 1
    s_cmp_gt_u32 s62, 0x200000
    s_cbranch_scc1 .mg_end_1
    s_waitcnt vmcnt(0)
    v_min_u32_dpp v4, v4, v4 quad_perm:[1,0,3,2] row_mask:0xf bank_mask:0xf
    s_nop 1
    v_min_u32_dpp v4, v4, v4 quad_perm:[2,3,0,1] row_mask:0xf bank_mask:0xf
    s_nop 1
    v_readfirstlane_b32 s33, v4
    s_cmp_gt_u32 s33, s30
    s_cbranch_scc1 .ndd_511
    s_sleep 2
    s_branch .nd_510
.ndd_511:
    s_add_u32 m0, s52, 0
    s_nop 0
    buffer_load_dwordx4 v2, s[8:11], s48 offen lds
    s_waitcnt vmcnt(0)
    s_branch .cb_447
.cp_450:
    s_cmp_gt_u32 s33, s42
    s_cbranch_scc0 .cb_451
    s_mov_b32 s31, 1
    s_add_u32 m0, s52, 4096
    s_nop 0
    buffer_load_dwordx4 v2, s[8:11], s48 offen lds
    s_branch .cb_451
.cp_452:
    buffer_store_dwordx4 v[224:227], v2, s[8:11], s53 offen offset:0 sc1
    s_branch .cb_453
.cp_454:
    buffer_store_dwordx4 v[228:231], v2, s[8:11], s53 offen offset:1024 sc1
    s_branch .cb_455
.cp_456:
    buffer_store_dword v27, v26, s[8:11], s94 offen sc1
    s_branch .cb_457
.cp_458:
    s_cmp_gt_u32 s32, s42
    s_cbranch_scc1 .ndd_513
    s_mov_b32 s62, 0
.nd_512:
    buffer_load_dword v29, v7, s[8:11], s46 offen sc1
    buffer_load_dword v30, v7, s[8:11], s47 offen sc1
    s_add_u32 s62, s62, 1
    s_cmp_gt_u32 s62, 0x200000
    s_cbranch_scc1 .mg_end_1
    s_waitcnt vmcnt(0)
    v_min_u32 v29, v29, v30
    s_nop 1
    v_min_u32_dpp v29, v29, v29 quad_perm:[1,0,3,2] row_mask:0xf bank_mask:0xf
    s_nop 1
    v_min_u32_dpp v29, v29, v29 quad_perm:[2,3,0,1] row_mask:0xf bank_mask:0xf
    s_nop 1
    v_readfirstlane_b32 s32, v29
    s_lshl_b32 s55, s32, 18
    s_add_u32 s55, s55, s37
    s_cmp_gt_u32 s32, s42
    s_cbranch_scc1 .ndd_513
    s_sleep 2
    s_branch .nd_512
.ndd_513:
    s_branch .cb_459
.cp_460:
    s_cmp_gt_u32 s33, s30
    s_cbranch_scc1 .ndd_515
    s_mov_b32 s62, 0
.nd_514:
    buffer_load_dword v4, v7, s[8:11], 0 offen sc1
    s_add_u32 s62, s62, 1
    s_cmp_gt_u32 s62, 0x200000
    s_cbranch_scc1 .mg_end_1
    s_waitcnt vmcnt(0)
    v_min_u32_dpp v4, v4, v4 quad_perm:[1,0,3,2] row_mask:0xf bank_mask:0xf
    s_nop 1
    v_min_u32_dpp v4, v4, v4 quad_perm:[2,3,0,1] row_mask:0xf bank_mask:0xf
    s_nop 1
    v_readfirstlane_b32 s33, v4
    s_cmp_gt_u32 s33, s30
    s_cbranch_scc1 .ndd_515
    s_sleep 2
    s_branch .nd_514
.ndd_515:
    s_add_u32 m0, s52, 4096
    s_nop 0
    buffer_load_dwordx4 v2, s[8:11], s48 offen lds
    s_waitcnt vmcnt(0)
    s_branch .cb_461
.cp_464:
    s_cmp_gt_u32 s33, s42
    s_cbranch_scc0 .cb_465
    s_mov_b32 s31, 1
    s_add_u32 m0, s52, 0
    s_nop 0
    buffer_load_dwordx4 v2, s[8:11], s48 offen lds
    s_branch .cb_465
.cp_466:
    buffer_store_dword v27, v26, s[8:11], s94 offen sc1
    s_branch .cb_467
.cp_472:
    buffer_store_dwordx4 v[224:227], v2, s[8:11], s53 offen offset:0 sc1
    s_branch .cb_473
.cp_474:
    buffer_store_dwordx4 v[228:231], v2, s[8:11], s53 offen offset:1024 sc1
    s_branch .cb_475
.cp_476:
    s_cmp_gt_u32 s33, s30
    s_cbranch_scc1 .ndd_517
    s_mov_b32 s62, 0
.nd_516:
    buffer_load_dword v4, v7, s[8:11], 0 offen sc1
    s_add_u32 s62, s62, 1
    s_cmp_gt_u32 s62, 0x200000
    s_cbranch_scc1 .mg_end_1
    s_waitcnt vmcnt(0)
    v_min_u32_dpp v4, v4, v4 quad_perm:[1,0,3,2] row_mask:0xf bank_mask:0xf
    s_nop 1
    v_min_u32_dpp v4, v4, v4 quad_perm:[2,3,0,1] row_mask:0xf bank_mask:0xf
    s_nop 1
    v_readfirstlane_b32 s33, v4
    s_cmp_gt_u32 s33, s30
    s_cbranch_scc1 .ndd_517
    s_sleep 2
    s_branch .nd_516
.ndd_517:
    s_add_u32 m0, s52, 0
    s_nop 0
    buffer_load_dwordx4 v2, s[8:11], s48 offen lds
    s_waitcnt vmcnt(0)
    s_branch .cb_477
.cp_478:
    buffer_store_dword v27, v26, s[8:11], s94 offen sc1
    s_branch .cb_479
.cp_487:
    buffer_store_dwordx4 v[224:227], v2, s[8:11], s53 offen offset:0 sc1
    s_branch .cb_488
.cp_489:
    buffer_store_dwordx4 v[228:231], v2, s[8:11], s53 offen offset:1024 sc1
    s_branch .cb_490
.cp_491:
    s_cmp_gt_u32 s33, s30
    s_cbranch_scc1 .ndd_519
    s_mov_b32 s62, 0
.nd_518:
    buffer_load_dword v4, v7, s[8:11], 0 offen sc1
    s_add_u32 s62, s62, 1
    s_cmp_gt_u32 s62, 0x200000
    s_cbranch_scc1 .mg_end_1
    s_waitcnt vmcnt(0)
    v_min_u32_dpp v4, v4, v4 quad_perm:[1,0,3,2] row_mask:0xf bank_mask:0xf
    s_nop 1
    v_min_u32_dpp v4, v4, v4 quad_perm:[2,3,0,1] row_mask:0xf bank_mask:0xf
    s_nop 1
    v_readfirstlane_b32 s33, v4
    s_cmp_gt_u32 s33, s30
    s_cbranch_scc1 .ndd_519
    s_sleep 2
    s_branch .nd_518
.ndd_519:
    s_add_u32 m0, s52, 4096
    s_nop 0
    buffer_load_dwordx4 v2, s[8:11], s48 offen lds
    s_waitcnt vmcnt(0)
    s_branch .cb_492
.cp_493:
    buffer_store_dword v27, v26, s[8:11], s94 offen sc1
    s_branch .cb_494
.cp_500:
    buffer_store_dwordx4 v[224:227], v2, s[8:11], s53 offen offset:0 sc1
    s_branch .cb_501
.cp_502:
    buffer_store_dwordx4 v[228:231], v2, s[8:11], s53 offen offset:1024 sc1
    s_branch .cb_503
.cp_504:
    s_cmp_gt_u32 s33, s30
    s_cbranch_scc1 .ndd_521
    s_mov_b32 s62, 0
.nd_520:
    buffer_load_dword v4, v7, s[8:11], 0 offen sc1
    s_add_u32 s62, s62, 1
    s_cmp_gt_u32 s62, 0x200000
    s_cbranch_scc1 .mg_end_1
    s_waitcnt vmcnt(0)
    v_min_u32_dpp v4, v4, v4 quad_perm:[1,0,3,2] row_mask:0xf bank_mask:0xf
    s_nop 1
    v_min_u32_dpp v4, v4, v4 quad_perm:[2,3,0,1] row_mask:0xf bank_mask:0xf
    s_nop 1
    v_readfirstlane_b32 s33, v4
    s_cmp_gt_u32 s33, s30
    s_cbranch_scc1 .ndd_521
    s_sleep 2
    s_branch .nd_520
.ndd_521:
    s_add_u32 m0, s52, 0
    s_nop 0
    buffer_load_dwordx4 v2, s[8:11], s48 offen lds
    s_waitcnt vmcnt(0)
    s_branch .cb_505
.cp_506:
    buffer_store_dword v27, v26, s[8:11], s94 offen sc1
    s_branch .cb_507
.ph2_390:
    s_load_dwordx2 s[42:43], s[0:1], 88
    s_lshr_b32 s34, s99, 3
    s_and_b32 s35, s99, 7
    s_lshl_b32 s4, s34, 21
    s_lshl_b32 s5, s35, 8
    s_add_u32 s4, s4, s5
    s_lshl_b32 s6, s24, 14
    s_mul_i32 s5, s24, 131072
    s_add_u32 s4, s4, s5
    v_bfe_u32 v2, v1, 4, 1
    v_lshlrev_b32 v2, 2, v2
    v_and_b32 v3, 7, v1
    v_xor_b32 v2, v2, v3
    v_lshlrev_b32 v2, 4, v2
    v_bfe_u32 v254, v1, 3, 2
    v_mul_u32_u24 v240, 2048, v254
    v_bfe_u32 v254, v1, 5, 1
    v_mul_u32_u24 v254, 128, v254
    v_add_u32 v240, v240, v254
    v_add_u32 v240, s4, v240
    v_add_u32 v240, v2, v240
    s_lshr_b32 s5, s24, 1
    s_lshl_b32 s5, s5, 9
    v_bfe_u32 v2, v1, 3, 1
    v_xor_b32 v2, s24, v2
    v_and_b32 v2, 1, v2
    v_lshlrev_b32 v2, 6, v2
    v_bfe_u32 v254, v1, 4, 2
    v_mul_u32_u24 v242, 2048, v254
    v_bfe_u32 v254, v1, 2, 2
    v_mul_u32_u24 v254, 128, v254
    v_add_u32 v242, v242, v254
    v_bfe_u32 v254, v1, 0, 2
    v_mul_u32_u24 v254, 16, v254
    v_add_u32 v242, v242, v254
    v_add_u32 v242, s5, v242
    v_add_u32 v242, v2, v242
    v_add_u32 v243, 0x10000, v242
    s_waitcnt lgkmcnt(0)
    s_mov_b32 s16, s42
    s_and_b32 s17, s43, 0xffff
    s_mov_b32 s18, 0x800000
    s_mov_b32 s19, 0x00020000
    s_add_u32 m0, s6, 0
    s_mov_b32 s5, 0
    buffer_load_dwordx4 v240, s[16:19], s5 offen nt lds
    s_add_u32 m0, s6, 1024
    s_mov_b32 s5, 8192
    buffer_load_dwordx4 v240, s[16:19], s5 offen nt lds
    s_add_u32 m0, s6, 2048
    s_mov_b32 s5, 16384
    buffer_load_dwordx4 v240, s[16:19], s5 offen nt lds
    s_add_u32 m0, s6, 3072
    s_mov_b32 s5, 24576
    buffer_load_dwordx4 v240, s[16:19], s5 offen nt lds
    s_add_u32 m0, s6, 4096
    s_mov_b32 s5, 32768
    buffer_load_dwordx4 v240, s[16:19], s5 offen nt lds
    s_add_u32 m0, s6, 5120
    s_mov_b32 s5, 40960
    buffer_load_dwordx4 v240, s[16:19], s5 offen nt lds
    s_add_u32 m0, s6, 6144
    s_mov_b32 s5, 49152
    buffer_load_dwordx4 v240, s[16:19], s5 offen nt lds
    s_add_u32 m0, s6, 7168
    s_mov_b32 s5, 57344
    buffer_load_dwordx4 v240, s[16:19], s5 offen nt lds
    s_add_u32 m0, s6, 8192
    s_mov_b32 s5, 65536
    buffer_load_dwordx4 v240, s[16:19], s5 offen nt lds
    s_add_u32 m0, s6, 9216
    s_mov_b32 s5, 73728
    buffer_load_dwordx4 v240, s[16:19], s5 offen nt lds
    s_add_u32 m0, s6, 10240
    s_mov_b32 s5, 81920
    buffer_load_dwordx4 v240, s[16:19], s5 offen nt lds
    s_add_u32 m0, s6, 11264
    s_mov_b32 s5, 90112
    buffer_load_dwordx4 v240, s[16:19], s5 offen nt lds
    s_add_u32 m0, s6, 12288
    s_mov_b32 s5, 98304
    buffer_load_dwordx4 v240, s[16:19], s5 offen nt lds
    s_add_u32 m0, s6, 13312
    s_mov_b32 s5, 106496
    buffer_load_dwordx4 v240, s[16:19], s5 offen nt lds
    s_add_u32 m0, s6, 14336
    s_mov_b32 s5, 114688
    buffer_load_dwordx4 v240, s[16:19], s5 offen nt lds
    s_add_u32 m0, s6, 15360
    s_mov_b32 s5, 122880
    buffer_load_dwordx4 v240, s[16:19], s5 offen nt lds
    s_add_u32 m0, s6, 65536
    s_mov_b32 s5, 524288
    buffer_load_dwordx4 v240, s[16:19], s5 offen nt lds
    s_add_u32 m0, s6, 66560
    s_mov_b32 s5, 532480
    buffer_load_dwordx4 v240, s[16:19], s5 offen nt lds
    s_add_u32 m0, s6, 67584
    s_mov_b32 s5, 540672
    buffer_load_dwordx4 v240, s[16:19], s5 offen nt lds
    s_add_u32 m0, s6, 68608
    s_mov_b32 s5, 548864
    buffer_load_dwordx4 v240, s[16:19], s5 offen nt lds
    s_add_u32 m0, s6, 69632
    s_mov_b32 s5, 557056
    buffer_load_dwordx4 v240, s[16:19], s5 offen nt lds
    s_add_u32 m0, s6, 70656
    s_mov_b32 s5, 565248
    buffer_load_dwordx4 v240, s[16:19], s5 offen nt lds
    s_add_u32 m0, s6, 71680
    s_mov_b32 s5, 573440
    buffer_load_dwordx4 v240, s[16:19], s5 offen nt lds
    s_add_u32 m0, s6, 72704
    s_mov_b32 s5, 581632
    buffer_load_dwordx4 v240, s[16:19], s5 offen nt lds
    s_add_u32 m0, s6, 73728
    s_mov_b32 s5, 589824
    buffer_load_dwordx4 v240, s[16:19], s5 offen nt lds
    s_add_u32 m0, s6, 74752
    s_mov_b32 s5, 598016
    buffer_load_dwordx4 v240, s[16:19], s5 offen nt lds
    s_add_u32 m0, s6, 75776
    s_mov_b32 s5, 606208
    buffer_load_dwordx4 v240, s[16:19], s5 offen nt lds
    s_add_u32 m0, s6, 76800
    s_mov_b32 s5, 614400
    buffer_load_dwordx4 v240, s[16:19], s5 offen nt lds
    s_add_u32 m0, s6, 77824
    s_mov_b32 s5, 622592
    buffer_load_dwordx4 v240, s[16:19], s5 offen nt lds
    s_add_u32 m0, s6, 78848
    s_mov_b32 s5, 630784
    buffer_load_dwordx4 v240, s[16:19], s5 offen nt lds
    s_add_u32 m0, s6, 79872
    s_mov_b32 s5, 638976
    buffer_load_dwordx4 v240, s[16:19], s5 offen nt lds
    s_add_u32 m0, s6, 80896
    s_mov_b32 s5, 647168
    buffer_load_dwordx4 v240, s[16:19], s5 offen nt lds
    v_lshlrev_b32 v2, 4, v1
    v_mov_b32 v8, v2
    s_lshl_b32 s36, s24, 12
    s_lshl_b32 s4, s34, 16
    s_add_u32 s4, s4, s36
    v_add_u32 v9, s4, v2
    s_lshl_b32 s4, s34, 10
    s_add_u32 s4, s4, 92340224
    v_bfe_u32 v254, v1, 0, 3
    v_mul_u32_u24 v7, 128, v254
    v_add_u32 v7, s4, v7
    s_lshl_b32 s4, s35, 2
    s_add_u32 s4, s4, s24
    s_lshl_b32 s5, s4, 9
    s_lshl_b32 s94, s34, 7
    s_add_u32 s94, s94, s5
    s_add_u32 s94, s94, 92323840
    s_lshl_b32 s38, s4, 1
    s_and_b32 s5, s34, 1
    s_or_b32 s38, s38, s5
    s_lshl_b32 s4, s35, 22
    s_lshl_b32 s37, s34, 20
    s_add_u32 s37, s37, s4
    s_lshl_b32 s4, s24, 18
    s_add_u32 s37, s37, s4
    s_add_u32 s37, s37, 150994944
    s_mov_b32 s29, 16777216
    s_mov_b32 s28, 0
    s_mov_b32 s33, 0
    s_mov_b32 s39, 0
    v_mov_b32 v26, 0
    s_waitcnt vmcnt(16)
    s_barrier
    ds_read_b64_tr_b16 a[0:1], v242 offset:0
    ds_read_b64_tr_b16 a[2:3], v242 offset:1024
    ds_read_b64_tr_b16 a[4:5], v242 offset:8
    ds_read_b64_tr_b16 a[6:7], v242 offset:1032
    ds_read_b64_tr_b16 a[8:9], v242 offset:8192
    ds_read_b64_tr_b16 a[10:11], v242 offset:9216
    ds_read_b64_tr_b16 a[12:13], v242 offset:8200
    ds_read_b64_tr_b16 a[14:15], v242 offset:9224
    ds_read_b64_tr_b16 a[16:17], v242 offset:16384
    ds_read_b64_tr_b16 a[18:19], v242 offset:17408
    ds_read_b64_tr_b16 a[20:21], v242 offset:16392
    ds_read_b64_tr_b16 a[22:23], v242 offset:17416
    ds_read_b64_tr_b16 a[24:25], v242 offset:24576
    ds_read_b64_tr_b16 a[26:27], v242 offset:25600
    ds_read_b64_tr_b16 a[28:29], v242 offset:24584
    ds_read_b64_tr_b16 a[30:31], v242 offset:25608
    ds_read_b64_tr_b16 a[32:33], v242 offset:32768
    ds_read_b64_tr_b16 a[34:35], v242 offset:33792
    ds_read_b64_tr_b16 a[36:37], v242 offset:32776
    ds_read_b64_tr_b16 a[38:39], v242 offset:33800
    ds_read_b64_tr_b16 a[40:41], v242 offset:40960
    ds_read_b64_tr_b16 a[42:43], v242 offset:41984
    ds_read_b64_tr_b16 a[44:45], v242 offset:40968
    ds_read_b64_tr_b16 a[46:47], v242 offset:41992
    ds_read_b64_tr_b16 a[48:49], v242 offset:49152
    ds_read_b64_tr_b16 a[50:51], v242 offset:50176
    ds_read_b64_tr_b16 a[52:53], v242 offset:49160
    ds_read_b64_tr_b16 a[54:55], v242 offset:50184
    ds_read_b64_tr_b16 a[56:57], v242 offset:57344
    ds_read_b64_tr_b16 a[58:59], v242 offset:58368
    ds_read_b64_tr_b16 a[60:61], v242 offset:57352
    ds_read_b64_tr_b16 a[62:63], v242 offset:58376
    s_waitcnt lgkmcnt(0)
    s_barrier
    s_add_u32 m0, s6, 0
    s_mov_b32 s5, 1048576
    buffer_load_dwordx4 v240, s[16:19], s5 offen nt lds
    s_add_u32 m0, s6, 1024
    s_mov_b32 s5, 1056768
    buffer_load_dwordx4 v240, s[16:19], s5 offen nt lds
    s_add_u32 m0, s6, 2048
    s_mov_b32 s5, 1064960
    buffer_load_dwordx4 v240, s[16:19], s5 offen nt lds
    s_add_u32 m0, s6, 3072
    s_mov_b32 s5, 1073152
    buffer_load_dwordx4 v240, s[16:19], s5 offen nt lds
    s_add_u32 m0, s6, 4096
    s_mov_b32 s5, 1081344
    buffer_load_dwordx4 v240, s[16:19], s5 offen nt lds
    s_add_u32 m0, s6, 5120
    s_mov_b32 s5, 1089536
    buffer_load_dwordx4 v240, s[16:19], s5 offen nt lds
    s_add_u32 m0, s6, 6144
    s_mov_b32 s5, 1097728
    buffer_load_dwordx4 v240, s[16:19], s5 offen nt lds
    s_add_u32 m0, s6, 7168
    s_mov_b32 s5, 1105920
    buffer_load_dwordx4 v240, s[16:19], s5 offen nt lds
    s_add_u32 m0, s6, 8192
    s_mov_b32 s5, 1114112
    buffer_load_dwordx4 v240, s[16:19], s5 offen nt lds
    s_add_u32 m0, s6, 9216
    s_mov_b32 s5, 1122304
    buffer_load_dwordx4 v240, s[16:19], s5 offen nt lds
    s_add_u32 m0, s6, 10240
    s_mov_b32 s5, 1130496
    buffer_load_dwordx4 v240, s[16:19], s5 offen nt lds
    s_add_u32 m0, s6, 11264
    s_mov_b32 s5, 1138688
    buffer_load_dwordx4 v240, s[16:19], s5 offen nt lds
    s_add_u32 m0, s6, 12288
    s_mov_b32 s5, 1146880
    buffer_load_dwordx4 v240, s[16:19], s5 offen nt lds
    s_add_u32 m0, s6, 13312
    s_mov_b32 s5, 1155072
    buffer_load_dwordx4 v240, s[16:19], s5 offen nt lds
    s_add_u32 m0, s6, 14336
    s_mov_b32 s5, 1163264
    buffer_load_dwordx4 v240, s[16:19], s5 offen nt lds
    s_add_u32 m0, s6, 15360
    s_mov_b32 s5, 1171456
    buffer_load_dwordx4 v240, s[16:19], s5 offen nt lds
    s_waitcnt vmcnt(16)
    s_barrier
    ds_read_b64_tr_b16 a[64:65], v243 offset:0
    ds_read_b64_tr_b16 a[66:67], v243 offset:1024
    ds_read_b64_tr_b16 a[68:69], v243 offset:8
    ds_read_b64_tr_b16 a[70:71], v243 offset:1032
    ds_read_b64_tr_b16 a[72:73], v243 offset:8192
    ds_read_b64_tr_b16 a[74:75], v243 offset:9216
    ds_read_b64_tr_b16 a[76:77], v243 offset:8200
    ds_read_b64_tr_b16 a[78:79], v243 offset:9224
    ds_read_b64_tr_b16 a[80:81], v243 offset:16384
    ds_read_b64_tr_b16 a[82:83], v243 offset:17408
    ds_read_b64_tr_b16 a[84:85], v243 offset:16392
    ds_read_b64_tr_b16 a[86:87], v243 offset:17416
    ds_read_b64_tr_b16 a[88:89], v243 offset:24576
    ds_read_b64_tr_b16 a[90:91], v243 offset:25600
    ds_read_b64_tr_b16 a[92:93], v243 offset:24584
    ds_read_b64_tr_b16 a[94:95], v243 offset:25608
    ds_read_b64_tr_b16 a[96:97], v243 offset:32768
    ds_read_b64_tr_b16 a[98:99], v243 offset:33792
    ds_read_b64_tr_b16 a[100:101], v243 offset:32776
    ds_read_b64_tr_b16 a[102:103], v243 offset:33800
    ds_read_b64_tr_b16 a[104:105], v243 offset:40960
    ds_read_b64_tr_b16 a[106:107], v243 offset:41984
    ds_read_b64_tr_b16 a[108:109], v243 offset:40968
    ds_read_b64_tr_b16 a[110:111], v243 offset:41992
    ds_read_b64_tr_b16 a[112:113], v243 offset:49152
    ds_read_b64_tr_b16 a[114:115], v243 offset:50176
    ds_read_b64_tr_b16 a[116:117], v243 offset:49160
    ds_read_b64_tr_b16 a[118:119], v243 offset:50184
    ds_read_b64_tr_b16 a[120:121], v243 offset:57344
    ds_read_b64_tr_b16 a[122:123], v243 offset:58368
    ds_read_b64_tr_b16 a[124:125], v243 offset:57352
    ds_read_b64_tr_b16 a[126:127], v243 offset:58376
    s_waitcnt lgkmcnt(0)
    s_barrier
    s_add_u32 m0, s6, 65536
    s_mov_b32 s5, 1572864
    buffer_load_dwordx4 v240, s[16:19], s5 offen nt lds
    s_add_u32 m0, s6, 66560
    s_mov_b32 s5, 1581056
    buffer_load_dwordx4 v240, s[16:19], s5 offen nt lds
    s_add_u32 m0, s6, 67584
    s_mov_b32 s5, 1589248
    buffer_load_dwordx4 v240, s[16:19], s5 offen nt lds
    s_add_u32 m0, s6, 68608
    s_mov_b32 s5, 1597440
    buffer_load_dwordx4 v240, s[16:19], s5 offen nt lds
    s_add_u32 m0, s6, 69632
    s_mov_b32 s5, 1605632
    buffer_load_dwordx4 v240, s[16:19], s5 offen nt lds
    s_add_u32 m0, s6, 70656
    s_mov_b32 s5, 1613824
    buffer_load_dwordx4 v240, s[16:19], s5 offen nt lds
    s_add_u32 m0, s6, 71680
    s_mov_b32 s5, 1622016
    buffer_load_dwordx4 v240, s[16:19], s5 offen nt lds
    s_add_u32 m0, s6, 72704
    s_mov_b32 s5, 1630208
    buffer_load_dwordx4 v240, s[16:19], s5 offen nt lds
    s_add_u32 m0, s6, 73728
    s_mov_b32 s5, 1638400
    buffer_load_dwordx4 v240, s[16:19], s5 offen nt lds
    s_add_u32 m0, s6, 74752
    s_mov_b32 s5, 1646592
    buffer_load_dwordx4 v240, s[16:19], s5 offen nt lds
    s_add_u32 m0, s6, 75776
    s_mov_b32 s5, 1654784
    buffer_load_dwordx4 v240, s[16:19], s5 offen nt lds
    s_add_u32 m0, s6, 76800
    s_mov_b32 s5, 1662976
    buffer_load_dwordx4 v240, s[16:19], s5 offen nt lds
    s_add_u32 m0, s6, 77824
    s_mov_b32 s5, 1671168
    buffer_load_dwordx4 v240, s[16:19], s5 offen nt lds
    s_add_u32 m0, s6, 78848
    s_mov_b32 s5, 1679360
    buffer_load_dwordx4 v240, s[16:19], s5 offen nt lds
    s_add_u32 m0, s6, 79872
    s_mov_b32 s5, 1687552
    buffer_load_dwordx4 v240, s[16:19], s5 offen nt lds
    s_add_u32 m0, s6, 80896
    s_mov_b32 s5, 1695744
    buffer_load_dwordx4 v240, s[16:19], s5 offen nt lds
    s_waitcnt vmcnt(16)
    s_load_dwordx4 s[56:59], s[0:1], 8
    s_load_dwordx2 s[60:61], s[0:1], 24
    s_lshl_b32 s4, s99, 17
    s_lshl_b32 s5, s24, 9
    s_add_u32 s4, s4, s5
    v_bfe_u32 v254, v1, 5, 1
    v_mul_u32_u24 v10, 65536, v254
    v_bfe_u32 v254, v1, 0, 5
    v_mul_u32_u24 v254, 16, v254
    v_add_u32 v10, v10, v254
    v_add_u32 v10, s4, v10
    s_lshl_b32 s4, s24, 11
    v_bfe_u32 v254, v1, 0, 5
    v_mul_u32_u24 v11, 64, v254
    v_add_u32 v11, s4, v11
    s_waitcnt lgkmcnt(0)
    s_mov_b32 s44, s56
    s_and_b32 s45, s57, 0xffff
    s_mov_b32 s46, 0x400000
    s_mov_b32 s47, 0x00020000
    s_mov_b32 s48, s58
    s_and_b32 s49, s59, 0xffff
    s_mov_b32 s50, 0x400000
    s_mov_b32 s51, 0x00020000
    s_mov_b32 s52, s60
    s_and_b32 s53, s61, 0xffff
    s_mov_b32 s54, 0x2000
    s_mov_b32 s55, 0x00020000
    buffer_load_dwordx4 v[216:219], v11, s[52:55], 0 offen offset:0
    buffer_load_dwordx4 v[220:223], v11, s[52:55], 0 offen offset:16
    buffer_load_dwordx4 v[224:227], v11, s[52:55], 0 offen offset:32
    buffer_load_dwordx4 v[228:231], v11, s[52:55], 0 offen offset:48
    v_subrev_u32 v11, 6144, v10
    buffer_load_dwordx4 v[32:35], v11, s[44:47], 0 offen nt
    v_subrev_u32 v11, 4096, v10
    buffer_load_dwordx4 v[36:39], v11, s[44:47], 0 offen nt
    v_subrev_u32 v11, 2048, v10
    buffer_load_dwordx4 v[40:43], v11, s[44:47], 0 offen nt
    s_mov_b32 s4, 0
    buffer_load_dwordx4 v[44:47], v10, s[44:47], s4 offen offset:0 nt
    buffer_load_dwordx4 v[76:79], v10, s[48:51], s4 offen offset:0 nt
    buffer_load_dwordx4 v[48:51], v10, s[44:47], s4 offen offset:2048 nt
    buffer_load_dwordx4 v[80:83], v10, s[48:51], s4 offen offset:2048 nt
    s_mov_b32 s4, 4096
    buffer_load_dwordx4 v[52:55], v10, s[44:47], s4 offen offset:0 nt
    buffer_load_dwordx4 v[84:87], v10, s[48:51], s4 offen offset:0 nt
    buffer_load_dwordx4 v[56:59], v10, s[44:47], s4 offen offset:2048 nt
    buffer_load_dwordx4 v[88:91], v10, s[48:51], s4 offen offset:2048 nt
    s_mov_b32 s4, 8192
    buffer_load_dwordx4 v[60:63], v10, s[44:47], s4 offen offset:0 nt
    buffer_load_dwordx4 v[92:95], v10, s[48:51], s4 offen offset:0 nt
    buffer_load_dwordx4 v[64:67], v10, s[44:47], s4 offen offset:2048 nt
    buffer_load_dwordx4 v[96:99], v10, s[48:51], s4 offen offset:2048 nt
    s_mov_b32 s4, 12288
    buffer_load_dwordx4 v[68:71], v10, s[44:47], s4 offen offset:0 nt
    buffer_load_dwordx4 v[100:103], v10, s[48:51], s4 offen offset:0 nt
    buffer_load_dwordx4 v[72:75], v10, s[44:47], s4 offen offset:2048 nt
    buffer_load_dwordx4 v[104:107], v10, s[48:51], s4 offen offset:2048 nt
    v_add_u32 v10, 16384, v10
    v_subrev_u32 v11, 6144, v10
    buffer_load_dwordx4 v[108:111], v11, s[44:47], 0 offen nt
    v_subrev_u32 v11, 4096, v10
    buffer_load_dwordx4 v[112:115], v11, s[44:47], 0 offen nt
    v_subrev_u32 v11, 2048, v10
    buffer_load_dwordx4 v[116:119], v11, s[44:47], 0 offen nt
    s_mov_b32 s4, 0
    buffer_load_dwordx4 v[120:123], v10, s[44:47], s4 offen offset:0 nt
    buffer_load_dwordx4 v[152:155], v10, s[48:51], s4 offen offset:0 nt
    buffer_load_dwordx4 v[124:127], v10, s[44:47], s4 offen offset:2048 nt
    buffer_load_dwordx4 v[156:159], v10, s[48:51], s4 offen offset:2048 nt
    s_mov_b32 s4, 4096
    buffer_load_dwordx4 v[128:131], v10, s[44:47], s4 offen offset:0 nt
    buffer_load_dwordx4 v[160:163], v10, s[48:51], s4 offen offset:0 nt
    buffer_load_dwordx4 v[132:135], v10, s[44:47], s4 offen offset:2048 nt
    buffer_load_dwordx4 v[164:167], v10, s[48:51], s4 offen offset:2048 nt
    s_mov_b32 s4, 8192
    buffer_load_dwordx4 v[136:139], v10, s[44:47], s4 offen offset:0 nt
    buffer_load_dwordx4 v[168:171], v10, s[48:51], s4 offen offset:0 nt
    buffer_load_dwordx4 v[140:143], v10, s[44:47], s4 offen offset:2048 nt
    buffer_load_dwordx4 v[172:175], v10, s[48:51], s4 offen offset:2048 nt
    s_mov_b32 s4, 12288
    buffer_load_dwordx4 v[144:147], v10, s[44:47], s4 offen offset:0 nt
    buffer_load_dwordx4 v[176:179], v10, s[48:51], s4 offen offset:0 nt
    buffer_load_dwordx4 v[148:151], v10, s[44:47], s4 offen offset:2048 nt
    buffer_load_dwordx4 v[180:183], v10, s[48:51], s4 offen offset:2048 nt
    v_add_u32 v10, 16384, v10
    s_barrier
    ds_read_b64_tr_b16 a[128:129], v242 offset:0
    ds_read_b64_tr_b16 a[130:131], v242 offset:1024
    ds_read_b64_tr_b16 a[132:133], v242 offset:8
    ds_read_b64_tr_b16 a[134:135], v242 offset:1032
    ds_read_b64_tr_b16 a[136:137], v242 offset:8192
    ds_read_b64_tr_b16 a[138:139], v242 offset:9216
    ds_read_b64_tr_b16 a[140:141], v242 offset:8200
    ds_read_b64_tr_b16 a[142:143], v242 offset:9224
    ds_read_b64_tr_b16 a[144:145], v242 offset:16384
    ds_read_b64_tr_b16 a[146:147], v242 offset:17408
    ds_read_b64_tr_b16 a[148:149], v242 offset:16392
    ds_read_b64_tr_b16 a[150:151], v242 offset:17416
    ds_read_b64_tr_b16 a[152:153], v242 offset:24576
    ds_read_b64_tr_b16 a[154:155], v242 offset:25600
    ds_read_b64_tr_b16 a[156:157], v242 offset:24584
    ds_read_b64_tr_b16 a[158:159], v242 offset:25608
    ds_read_b64_tr_b16 a[160:161], v242 offset:32768
    ds_read_b64_tr_b16 a[162:163], v242 offset:33792
    ds_read_b64_tr_b16 a[164:165], v242 offset:32776
    ds_read_b64_tr_b16 a[166:167], v242 offset:33800
    ds_read_b64_tr_b16 a[168:169], v242 offset:40960
    ds_read_b64_tr_b16 a[170:171], v242 offset:41984
    ds_read_b64_tr_b16 a[172:173], v242 offset:40968
    ds_read_b64_tr_b16 a[174:175], v242 offset:41992
    ds_read_b64_tr_b16 a[176:177], v242 offset:49152
    ds_read_b64_tr_b16 a[178:179], v242 offset:50176
    ds_read_b64_tr_b16 a[180:181], v242 offset:49160
    ds_read_b64_tr_b16 a[182:183], v242 offset:50184
    ds_read_b64_tr_b16 a[184:185], v242 offset:57344
    ds_read_b64_tr_b16 a[186:187], v242 offset:58368
    ds_read_b64_tr_b16 a[188:189], v242 offset:57352
    ds_read_b64_tr_b16 a[190:191], v242 offset:58376
    s_waitcnt lgkmcnt(0)
    s_barrier
    s_waitcnt vmcnt(42)
    s_barrier
    ds_read_b64_tr_b16 a[192:193], v243 offset:0
    ds_read_b64_tr_b16 a[194:195], v243 offset:1024
    ds_read_b64_tr_b16 a[196:197], v243 offset:8
    ds_read_b64_tr_b16 a[198:199], v243 offset:1032
    ds_read_b64_tr_b16 a[200:201], v243 offset:8192
    ds_read_b64_tr_b16 a[202:203], v243 offset:9216
    ds_read_b64_tr_b16 a[204:205], v243 offset:8200
    ds_read_b64_tr_b16 a[206:207], v243 offset:9224
    ds_read_b64_tr_b16 a[208:209], v243 offset:16384
    ds_read_b64_tr_b16 a[210:211], v243 offset:17408
    ds_read_b64_tr_b16 a[212:213], v243 offset:16392
    ds_read_b64_tr_b16 a[214:215], v243 offset:17416
    ds_read_b64_tr_b16 a[216:217], v243 offset:24576
    ds_read_b64_tr_b16 a[218:219], v243 offset:25600
    ds_read_b64_tr_b16 a[220:221], v243 offset:24584
    ds_read_b64_tr_b16 a[222:223], v243 offset:25608
    ds_read_b64_tr_b16 a[224:225], v243 offset:32768
    ds_read_b64_tr_b16 a[226:227], v243 offset:33792
    ds_read_b64_tr_b16 a[228:229], v243 offset:32776
    ds_read_b64_tr_b16 a[230:231], v243 offset:33800
    ds_read_b64_tr_b16 a[232:233], v243 offset:40960
    ds_read_b64_tr_b16 a[234:235], v243 offset:41984
    ds_read_b64_tr_b16 a[236:237], v243 offset:40968
    ds_read_b64_tr_b16 a[238:239], v243 offset:41992
    ds_read_b64_tr_b16 a[240:241], v243 offset:49152
    ds_read_b64_tr_b16 a[242:243], v243 offset:50176
    ds_read_b64_tr_b16 a[244:245], v243 offset:49160
    ds_read_b64_tr_b16 a[246:247], v243 offset:50184
    ds_read_b64_tr_b16 a[248:249], v243 offset:57344
    ds_read_b64_tr_b16 a[250:251], v243 offset:58368
    ds_read_b64_tr_b16 a[252:253], v243 offset:57352
    ds_read_b64_tr_b16 a[254:255], v243 offset:58376
    s_waitcnt lgkmcnt(0)
    s_barrier
    s_lshl_b32 s5, s24, 15
    v_bfe_u32 v254, v1, 0, 3
    v_mul_u32_u24 v12, 16, v254
    v_bfe_u32 v254, v1, 5, 1
    v_mul_u32_u24 v13, 64, v254
    v_xor_b32 v12, v12, v13
    v_bfe_u32 v254, v1, 0, 5
    v_mul_u32_u24 v13, 1024, v254
    v_add_u32 v13, s5, v13
    v_add_u32 v13, v12, v13
    s_waitcnt vmcnt(38)
    v_lshlrev_b32 v184, 16, v216
    v_lshlrev_b32 v185, 16, v218
    v_and_b32 v186, 0xffff0000, v216
    v_and_b32 v187, 0xffff0000, v218
    v_lshlrev_b32 v188, 16, v217
    v_lshlrev_b32 v189, 16, v219
    v_and_b32 v190, 0xffff0000, v217
    v_and_b32 v191, 0xffff0000, v219
    v_lshlrev_b32 v192, 16, v220
    v_lshlrev_b32 v193, 16, v222
    v_and_b32 v194, 0xffff0000, v220
    v_and_b32 v195, 0xffff0000, v222
    v_lshlrev_b32 v196, 16, v221
    v_lshlrev_b32 v197, 16, v223
    v_and_b32 v198, 0xffff0000, v221
    v_and_b32 v199, 0xffff0000, v223
    v_lshlrev_b32 v200, 16, v224
    v_lshlrev_b32 v201, 16, v226
    v_and_b32 v202, 0xffff0000, v224
    v_and_b32 v203, 0xffff0000, v226
    v_lshlrev_b32 v204, 16, v225
    v_lshlrev_b32 v205, 16, v227
    v_and_b32 v206, 0xffff0000, v225
    v_and_b32 v207, 0xffff0000, v227
    v_lshlrev_b32 v208, 16, v228
    v_lshlrev_b32 v209, 16, v230
    v_and_b32 v210, 0xffff0000, v228
    v_and_b32 v211, 0xffff0000, v230
    v_lshlrev_b32 v212, 16, v229
    v_lshlrev_b32 v213, 16, v231
    v_and_b32 v214, 0xffff0000, v229
    v_and_b32 v215, 0xffff0000, v231
    v_xor_b32 v12, 0, v13
    s_waitcnt vmcnt(19)
    v_lshlrev_b32 v216, 16, v32
    v_and_b32 v217, 0xffff0000, v32
    v_lshlrev_b32 v218, 16, v36
    v_and_b32 v219, 0xffff0000, v36
    v_lshlrev_b32 v220, 16, v40
    v_and_b32 v221, 0xffff0000, v40
    v_lshlrev_b32 v222, 16, v44
    v_and_b32 v223, 0xffff0000, v44
    v_lshlrev_b32 v224, 16, v48
    v_and_b32 v225, 0xffff0000, v48
    v_lshlrev_b32 v226, 16, v52
    v_and_b32 v227, 0xffff0000, v52
    v_lshlrev_b32 v228, 16, v56
    v_and_b32 v229, 0xffff0000, v56
    v_lshlrev_b32 v230, 16, v60
    v_and_b32 v231, 0xffff0000, v60
    v_lshlrev_b32 v232, 16, v64
    v_and_b32 v233, 0xffff0000, v64
    v_lshlrev_b32 v234, 16, v68
    v_and_b32 v235, 0xffff0000, v68
    v_lshlrev_b32 v236, 16, v72
    v_and_b32 v237, 0xffff0000, v72
    v_pk_mul_f32 v[216:217], v[216:217], v[190:191]
    v_lshlrev_b32 v238, 16, v76
    v_pk_fma_f32 v[216:217], v[218:219], v[188:189], v[216:217]
    v_and_b32 v239, 0xffff0000, v76
    v_pk_fma_f32 v[216:217], v[220:221], v[186:187], v[216:217]
    v_pk_fma_f32 v[216:217], v[222:223], v[184:185], v[216:217]
    v_pk_mul_f32 v[216:217], v[216:217], v[238:239]
    v_pk_mul_f32 v[218:219], v[218:219], v[190:191]
    v_lshlrev_b32 v240, 16, v80
    v_pk_fma_f32 v[218:219], v[220:221], v[188:189], v[218:219]
    v_and_b32 v241, 0xffff0000, v80
    v_pk_fma_f32 v[218:219], v[222:223], v[186:187], v[218:219]
    v_pk_fma_f32 v[218:219], v[224:225], v[184:185], v[218:219]
    v_pk_mul_f32 v[218:219], v[218:219], v[240:241]
    v_pk_mul_f32 v[220:221], v[220:221], v[190:191]
    v_lshlrev_b32 v238, 16, v84
    v_pk_fma_f32 v[220:221], v[222:223], v[188:189], v[220:221]
    v_and_b32 v239, 0xffff0000, v84
    v_pk_fma_f32 v[220:221], v[224:225], v[186:187], v[220:221]
    v_pk_fma_f32 v[220:221], v[226:227], v[184:185], v[220:221]
    v_pk_mul_f32 v[220:221], v[220:221], v[238:239]
    v_pk_mul_f32 v[222:223], v[222:223], v[190:191]
    v_lshlrev_b32 v240, 16, v88
    v_pk_fma_f32 v[222:223], v[224:225], v[188:189], v[222:223]
    v_and_b32 v241, 0xffff0000, v88
    v_pk_fma_f32 v[222:223], v[226:227], v[186:187], v[222:223]
    v_pk_fma_f32 v[222:223], v[228:229], v[184:185], v[222:223]
    v_pk_mul_f32 v[222:223], v[222:223], v[240:241]
    v_pk_mul_f32 v[224:225], v[224:225], v[190:191]
    v_lshlrev_b32 v238, 16, v92
    v_pk_fma_f32 v[224:225], v[226:227], v[188:189], v[224:225]
    v_and_b32 v239, 0xffff0000, v92
    v_pk_fma_f32 v[224:225], v[228:229], v[186:187], v[224:225]
    v_pk_fma_f32 v[224:225], v[230:231], v[184:185], v[224:225]
    v_pk_mul_f32 v[224:225], v[224:225], v[238:239]
    v_pk_mul_f32 v[226:227], v[226:227], v[190:191]
    v_lshlrev_b32 v240, 16, v96
    v_pk_fma_f32 v[226:227], v[228:229], v[188:189], v[226:227]
    v_and_b32 v241, 0xffff0000, v96
    v_pk_fma_f32 v[226:227], v[230:231], v[186:187], v[226:227]
    v_pk_fma_f32 v[226:227], v[232:233], v[184:185], v[226:227]
    v_pk_mul_f32 v[226:227], v[226:227], v[240:241]
    v_pk_mul_f32 v[228:229], v[228:229], v[190:191]
    v_lshlrev_b32 v238, 16, v100
    v_pk_fma_f32 v[228:229], v[230:231], v[188:189], v[228:229]
    v_and_b32 v239, 0xffff0000, v100
    v_pk_fma_f32 v[228:229], v[232:233], v[186:187], v[228:229]
    v_pk_fma_f32 v[228:229], v[234:235], v[184:185], v[228:229]
    v_pk_mul_f32 v[228:229], v[228:229], v[238:239]
    v_pk_mul_f32 v[230:231], v[230:231], v[190:191]
    v_lshlrev_b32 v240, 16, v104
    v_pk_fma_f32 v[230:231], v[232:233], v[188:189], v[230:231]
    v_and_b32 v241, 0xffff0000, v104
    v_pk_fma_f32 v[230:231], v[234:235], v[186:187], v[230:231]
    v_pk_fma_f32 v[230:231], v[236:237], v[184:185], v[230:231]
    v_pk_mul_f32 v[230:231], v[230:231], v[240:241]
    v_cvt_pk_bf16_f32 v242, v230, v228
    v_cvt_pk_bf16_f32 v243, v226, v224
    v_cvt_pk_bf16_f32 v244, v222, v220
    v_cvt_pk_bf16_f32 v245, v218, v216
    ds_write_b128 v12, v[242:245] offset:0
    v_cvt_pk_bf16_f32 v246, v231, v229
    v_cvt_pk_bf16_f32 v247, v227, v225
    v_cvt_pk_bf16_f32 v248, v223, v221
    v_cvt_pk_bf16_f32 v249, v219, v217
    ds_write_b128 v12, v[246:249] offset:128
    v_lshlrev_b32 v216, 16, v33
    v_and_b32 v217, 0xffff0000, v33
    v_lshlrev_b32 v218, 16, v37
    v_and_b32 v219, 0xffff0000, v37
    v_lshlrev_b32 v220, 16, v41
    v_and_b32 v221, 0xffff0000, v41
    v_lshlrev_b32 v222, 16, v45
    v_and_b32 v223, 0xffff0000, v45
    v_lshlrev_b32 v224, 16, v49
    v_and_b32 v225, 0xffff0000, v49
    v_lshlrev_b32 v226, 16, v53
    v_and_b32 v227, 0xffff0000, v53
    v_lshlrev_b32 v228, 16, v57
    v_and_b32 v229, 0xffff0000, v57
    v_lshlrev_b32 v230, 16, v61
    v_and_b32 v231, 0xffff0000, v61
    v_lshlrev_b32 v232, 16, v65
    v_and_b32 v233, 0xffff0000, v65
    v_lshlrev_b32 v234, 16, v69
    v_and_b32 v235, 0xffff0000, v69
    v_lshlrev_b32 v236, 16, v73
    v_and_b32 v237, 0xffff0000, v73
    v_pk_mul_f32 v[216:217], v[216:217], v[198:199]
    v_lshlrev_b32 v238, 16, v77
    v_pk_fma_f32 v[216:217], v[218:219], v[196:197], v[216:217]
    v_and_b32 v239, 0xffff0000, v77
    v_pk_fma_f32 v[216:217], v[220:221], v[194:195], v[216:217]
    v_pk_fma_f32 v[216:217], v[222:223], v[192:193], v[216:217]
    v_pk_mul_f32 v[216:217], v[216:217], v[238:239]
    v_pk_mul_f32 v[218:219], v[218:219], v[198:199]
    v_lshlrev_b32 v240, 16, v81
    v_pk_fma_f32 v[218:219], v[220:221], v[196:197], v[218:219]
    v_and_b32 v241, 0xffff0000, v81
    v_pk_fma_f32 v[218:219], v[222:223], v[194:195], v[218:219]
    v_pk_fma_f32 v[218:219], v[224:225], v[192:193], v[218:219]
    v_pk_mul_f32 v[218:219], v[218:219], v[240:241]
    v_pk_mul_f32 v[220:221], v[220:221], v[198:199]
    v_lshlrev_b32 v238, 16, v85
    v_pk_fma_f32 v[220:221], v[222:223], v[196:197], v[220:221]
    v_and_b32 v239, 0xffff0000, v85
    v_pk_fma_f32 v[220:221], v[224:225], v[194:195], v[220:221]
    v_pk_fma_f32 v[220:221], v[226:227], v[192:193], v[220:221]
    v_pk_mul_f32 v[220:221], v[220:221], v[238:239]
    v_pk_mul_f32 v[222:223], v[222:223], v[198:199]
    v_lshlrev_b32 v240, 16, v89
    v_pk_fma_f32 v[222:223], v[224:225], v[196:197], v[222:223]
    v_and_b32 v241, 0xffff0000, v89
    v_pk_fma_f32 v[222:223], v[226:227], v[194:195], v[222:223]
    v_pk_fma_f32 v[222:223], v[228:229], v[192:193], v[222:223]
    v_pk_mul_f32 v[222:223], v[222:223], v[240:241]
    v_pk_mul_f32 v[224:225], v[224:225], v[198:199]
    v_lshlrev_b32 v238, 16, v93
    v_pk_fma_f32 v[224:225], v[226:227], v[196:197], v[224:225]
    v_and_b32 v239, 0xffff0000, v93
    v_pk_fma_f32 v[224:225], v[228:229], v[194:195], v[224:225]
    v_pk_fma_f32 v[224:225], v[230:231], v[192:193], v[224:225]
    v_pk_mul_f32 v[224:225], v[224:225], v[238:239]
    v_pk_mul_f32 v[226:227], v[226:227], v[198:199]
    v_lshlrev_b32 v240, 16, v97
    v_pk_fma_f32 v[226:227], v[228:229], v[196:197], v[226:227]
    v_and_b32 v241, 0xffff0000, v97
    v_pk_fma_f32 v[226:227], v[230:231], v[194:195], v[226:227]
    v_pk_fma_f32 v[226:227], v[232:233], v[192:193], v[226:227]
    v_pk_mul_f32 v[226:227], v[226:227], v[240:241]
    v_pk_mul_f32 v[228:229], v[228:229], v[198:199]
    v_lshlrev_b32 v238, 16, v101
    v_pk_fma_f32 v[228:229], v[230:231], v[196:197], v[228:229]
    v_and_b32 v239, 0xffff0000, v101
    v_pk_fma_f32 v[228:229], v[232:233], v[194:195], v[228:229]
    v_pk_fma_f32 v[228:229], v[234:235], v[192:193], v[228:229]
    v_pk_mul_f32 v[228:229], v[228:229], v[238:239]
    v_pk_mul_f32 v[230:231], v[230:231], v[198:199]
    v_lshlrev_b32 v240, 16, v105
    v_pk_fma_f32 v[230:231], v[232:233], v[196:197], v[230:231]
    v_and_b32 v241, 0xffff0000, v105
    v_pk_fma_f32 v[230:231], v[234:235], v[194:195], v[230:231]
    v_pk_fma_f32 v[230:231], v[236:237], v[192:193], v[230:231]
    v_pk_mul_f32 v[230:231], v[230:231], v[240:241]
    v_cvt_pk_bf16_f32 v242, v230, v228
    v_cvt_pk_bf16_f32 v243, v226, v224
    v_cvt_pk_bf16_f32 v244, v222, v220
    v_cvt_pk_bf16_f32 v245, v218, v216
    ds_write_b128 v12, v[242:245] offset:256
    v_cvt_pk_bf16_f32 v246, v231, v229
    v_cvt_pk_bf16_f32 v247, v227, v225
    v_cvt_pk_bf16_f32 v248, v223, v221
    v_cvt_pk_bf16_f32 v249, v219, v217
    ds_write_b128 v12, v[246:249] offset:384
    v_lshlrev_b32 v216, 16, v34
    v_and_b32 v217, 0xffff0000, v34
    v_lshlrev_b32 v218, 16, v38
    v_and_b32 v219, 0xffff0000, v38
    v_lshlrev_b32 v220, 16, v42
    v_and_b32 v221, 0xffff0000, v42
    v_lshlrev_b32 v222, 16, v46
    v_and_b32 v223, 0xffff0000, v46
    v_lshlrev_b32 v224, 16, v50
    v_and_b32 v225, 0xffff0000, v50
    v_lshlrev_b32 v226, 16, v54
    v_and_b32 v227, 0xffff0000, v54
    v_lshlrev_b32 v228, 16, v58
    v_and_b32 v229, 0xffff0000, v58
    v_lshlrev_b32 v230, 16, v62
    v_and_b32 v231, 0xffff0000, v62
    v_lshlrev_b32 v232, 16, v66
    v_and_b32 v233, 0xffff0000, v66
    v_lshlrev_b32 v234, 16, v70
    v_and_b32 v235, 0xffff0000, v70
    v_lshlrev_b32 v236, 16, v74
    v_and_b32 v237, 0xffff0000, v74
    v_pk_mul_f32 v[216:217], v[216:217], v[206:207]
    v_lshlrev_b32 v238, 16, v78
    v_pk_fma_f32 v[216:217], v[218:219], v[204:205], v[216:217]
    v_and_b32 v239, 0xffff0000, v78
    v_pk_fma_f32 v[216:217], v[220:221], v[202:203], v[216:217]
    v_pk_fma_f32 v[216:217], v[222:223], v[200:201], v[216:217]
    v_pk_mul_f32 v[216:217], v[216:217], v[238:239]
    v_pk_mul_f32 v[218:219], v[218:219], v[206:207]
    v_lshlrev_b32 v240, 16, v82
    v_pk_fma_f32 v[218:219], v[220:221], v[204:205], v[218:219]
    v_and_b32 v241, 0xffff0000, v82
    v_pk_fma_f32 v[218:219], v[222:223], v[202:203], v[218:219]
    v_pk_fma_f32 v[218:219], v[224:225], v[200:201], v[218:219]
    v_pk_mul_f32 v[218:219], v[218:219], v[240:241]
    v_pk_mul_f32 v[220:221], v[220:221], v[206:207]
    v_lshlrev_b32 v238, 16, v86
    v_pk_fma_f32 v[220:221], v[222:223], v[204:205], v[220:221]
    v_and_b32 v239, 0xffff0000, v86
    v_pk_fma_f32 v[220:221], v[224:225], v[202:203], v[220:221]
    v_pk_fma_f32 v[220:221], v[226:227], v[200:201], v[220:221]
    v_pk_mul_f32 v[220:221], v[220:221], v[238:239]
    v_pk_mul_f32 v[222:223], v[222:223], v[206:207]
    v_lshlrev_b32 v240, 16, v90
    v_pk_fma_f32 v[222:223], v[224:225], v[204:205], v[222:223]
    v_and_b32 v241, 0xffff0000, v90
    v_pk_fma_f32 v[222:223], v[226:227], v[202:203], v[222:223]
    v_pk_fma_f32 v[222:223], v[228:229], v[200:201], v[222:223]
    v_pk_mul_f32 v[222:223], v[222:223], v[240:241]
    v_pk_mul_f32 v[224:225], v[224:225], v[206:207]
    v_lshlrev_b32 v238, 16, v94
    v_pk_fma_f32 v[224:225], v[226:227], v[204:205], v[224:225]
    v_and_b32 v239, 0xffff0000, v94
    v_pk_fma_f32 v[224:225], v[228:229], v[202:203], v[224:225]
    v_pk_fma_f32 v[224:225], v[230:231], v[200:201], v[224:225]
    v_pk_mul_f32 v[224:225], v[224:225], v[238:239]
    v_pk_mul_f32 v[226:227], v[226:227], v[206:207]
    v_lshlrev_b32 v240, 16, v98
    v_pk_fma_f32 v[226:227], v[228:229], v[204:205], v[226:227]
    v_and_b32 v241, 0xffff0000, v98
    v_pk_fma_f32 v[226:227], v[230:231], v[202:203], v[226:227]
    v_pk_fma_f32 v[226:227], v[232:233], v[200:201], v[226:227]
    v_pk_mul_f32 v[226:227], v[226:227], v[240:241]
    v_pk_mul_f32 v[228:229], v[228:229], v[206:207]
    v_lshlrev_b32 v238, 16, v102
    v_pk_fma_f32 v[228:229], v[230:231], v[204:205], v[228:229]
    v_and_b32 v239, 0xffff0000, v102
    v_pk_fma_f32 v[228:229], v[232:233], v[202:203], v[228:229]
    v_pk_fma_f32 v[228:229], v[234:235], v[200:201], v[228:229]
    v_pk_mul_f32 v[228:229], v[228:229], v[238:239]
    v_pk_mul_f32 v[230:231], v[230:231], v[206:207]
    v_lshlrev_b32 v240, 16, v106
    v_pk_fma_f32 v[230:231], v[232:233], v[204:205], v[230:231]
    v_and_b32 v241, 0xffff0000, v106
    v_pk_fma_f32 v[230:231], v[234:235], v[202:203], v[230:231]
    v_pk_fma_f32 v[230:231], v[236:237], v[200:201], v[230:231]
    v_pk_mul_f32 v[230:231], v[230:231], v[240:241]
    v_cvt_pk_bf16_f32 v242, v230, v228
    v_cvt_pk_bf16_f32 v243, v226, v224
    v_cvt_pk_bf16_f32 v244, v222, v220
    v_cvt_pk_bf16_f32 v245, v218, v216
    ds_write_b128 v12, v[242:245] offset:512
    v_cvt_pk_bf16_f32 v246, v231, v229
    v_cvt_pk_bf16_f32 v247, v227, v225
    v_cvt_pk_bf16_f32 v248, v223, v221
    v_cvt_pk_bf16_f32 v249, v219, v217
    ds_write_b128 v12, v[246:249] offset:640
    v_lshlrev_b32 v216, 16, v35
    v_and_b32 v217, 0xffff0000, v35
    v_lshlrev_b32 v218, 16, v39
    v_and_b32 v219, 0xffff0000, v39
    v_lshlrev_b32 v220, 16, v43
    v_and_b32 v221, 0xffff0000, v43
    v_lshlrev_b32 v222, 16, v47
    v_and_b32 v223, 0xffff0000, v47
    v_lshlrev_b32 v224, 16, v51
    v_and_b32 v225, 0xffff0000, v51
    v_lshlrev_b32 v226, 16, v55
    v_and_b32 v227, 0xffff0000, v55
    v_lshlrev_b32 v228, 16, v59
    v_and_b32 v229, 0xffff0000, v59
    v_lshlrev_b32 v230, 16, v63
    v_and_b32 v231, 0xffff0000, v63
    v_lshlrev_b32 v232, 16, v67
    v_and_b32 v233, 0xffff0000, v67
    v_lshlrev_b32 v234, 16, v71
    v_and_b32 v235, 0xffff0000, v71
    v_lshlrev_b32 v236, 16, v75
    v_and_b32 v237, 0xffff0000, v75
    v_pk_mul_f32 v[216:217], v[216:217], v[214:215]
    v_lshlrev_b32 v238, 16, v79
    v_pk_fma_f32 v[216:217], v[218:219], v[212:213], v[216:217]
    v_and_b32 v239, 0xffff0000, v79
    v_pk_fma_f32 v[216:217], v[220:221], v[210:211], v[216:217]
    v_pk_fma_f32 v[216:217], v[222:223], v[208:209], v[216:217]
    v_pk_mul_f32 v[216:217], v[216:217], v[238:239]
    v_pk_mul_f32 v[218:219], v[218:219], v[214:215]
    v_lshlrev_b32 v240, 16, v83
    v_pk_fma_f32 v[218:219], v[220:221], v[212:213], v[218:219]
    v_and_b32 v241, 0xffff0000, v83
    v_pk_fma_f32 v[218:219], v[222:223], v[210:211], v[218:219]
    v_pk_fma_f32 v[218:219], v[224:225], v[208:209], v[218:219]
    v_pk_mul_f32 v[218:219], v[218:219], v[240:241]
    v_pk_mul_f32 v[220:221], v[220:221], v[214:215]
    v_lshlrev_b32 v238, 16, v87
    v_pk_fma_f32 v[220:221], v[222:223], v[212:213], v[220:221]
    v_and_b32 v239, 0xffff0000, v87
    v_pk_fma_f32 v[220:221], v[224:225], v[210:211], v[220:221]
    v_pk_fma_f32 v[220:221], v[226:227], v[208:209], v[220:221]
    v_pk_mul_f32 v[220:221], v[220:221], v[238:239]
    v_pk_mul_f32 v[222:223], v[222:223], v[214:215]
    v_lshlrev_b32 v240, 16, v91
    v_pk_fma_f32 v[222:223], v[224:225], v[212:213], v[222:223]
    v_and_b32 v241, 0xffff0000, v91
    v_pk_fma_f32 v[222:223], v[226:227], v[210:211], v[222:223]
    v_pk_fma_f32 v[222:223], v[228:229], v[208:209], v[222:223]
    v_pk_mul_f32 v[222:223], v[222:223], v[240:241]
    v_pk_mul_f32 v[224:225], v[224:225], v[214:215]
    v_lshlrev_b32 v238, 16, v95
    v_pk_fma_f32 v[224:225], v[226:227], v[212:213], v[224:225]
    v_and_b32 v239, 0xffff0000, v95
    v_pk_fma_f32 v[224:225], v[228:229], v[210:211], v[224:225]
    v_pk_fma_f32 v[224:225], v[230:231], v[208:209], v[224:225]
    v_pk_mul_f32 v[224:225], v[224:225], v[238:239]
    v_pk_mul_f32 v[226:227], v[226:227], v[214:215]
    v_lshlrev_b32 v240, 16, v99
    v_pk_fma_f32 v[226:227], v[228:229], v[212:213], v[226:227]
    v_and_b32 v241, 0xffff0000, v99
    v_pk_fma_f32 v[226:227], v[230:231], v[210:211], v[226:227]
    v_pk_fma_f32 v[226:227], v[232:233], v[208:209], v[226:227]
    v_pk_mul_f32 v[226:227], v[226:227], v[240:241]
    v_pk_mul_f32 v[228:229], v[228:229], v[214:215]
    v_lshlrev_b32 v238, 16, v103
    v_pk_fma_f32 v[228:229], v[230:231], v[212:213], v[228:229]
    v_and_b32 v239, 0xffff0000, v103
    v_pk_fma_f32 v[228:229], v[232:233], v[210:211], v[228:229]
    v_pk_fma_f32 v[228:229], v[234:235], v[208:209], v[228:229]
    v_pk_mul_f32 v[228:229], v[228:229], v[238:239]
    v_pk_mul_f32 v[230:231], v[230:231], v[214:215]
    v_lshlrev_b32 v240, 16, v107
    v_pk_fma_f32 v[230:231], v[232:233], v[212:213], v[230:231]
    v_and_b32 v241, 0xffff0000, v107
    v_pk_fma_f32 v[230:231], v[234:235], v[210:211], v[230:231]
    v_pk_fma_f32 v[230:231], v[236:237], v[208:209], v[230:231]
    v_pk_mul_f32 v[230:231], v[230:231], v[240:241]
    v_cvt_pk_bf16_f32 v242, v230, v228
    v_cvt_pk_bf16_f32 v243, v226, v224
    v_cvt_pk_bf16_f32 v244, v222, v220
    v_cvt_pk_bf16_f32 v245, v218, v216
    ds_write_b128 v12, v[242:245] offset:768
    v_cvt_pk_bf16_f32 v246, v231, v229
    v_cvt_pk_bf16_f32 v247, v227, v225
    v_cvt_pk_bf16_f32 v248, v223, v221
    v_cvt_pk_bf16_f32 v249, v219, v217
    ds_write_b128 v12, v[246:249] offset:896
    v_subrev_u32 v11, 6144, v10
    buffer_load_dwordx4 v[32:35], v11, s[44:47], 0 offen nt
    v_subrev_u32 v11, 4096, v10
    buffer_load_dwordx4 v[36:39], v11, s[44:47], 0 offen nt
    v_subrev_u32 v11, 2048, v10
    buffer_load_dwordx4 v[40:43], v11, s[44:47], 0 offen nt
    s_mov_b32 s4, 0
    buffer_load_dwordx4 v[44:47], v10, s[44:47], s4 offen offset:0 nt
    buffer_load_dwordx4 v[76:79], v10, s[48:51], s4 offen offset:0 nt
    buffer_load_dwordx4 v[48:51], v10, s[44:47], s4 offen offset:2048 nt
    buffer_load_dwordx4 v[80:83], v10, s[48:51], s4 offen offset:2048 nt
    s_mov_b32 s4, 4096
    buffer_load_dwordx4 v[52:55], v10, s[44:47], s4 offen offset:0 nt
    buffer_load_dwordx4 v[84:87], v10, s[48:51], s4 offen offset:0 nt
    buffer_load_dwordx4 v[56:59], v10, s[44:47], s4 offen offset:2048 nt
    buffer_load_dwordx4 v[88:91], v10, s[48:51], s4 offen offset:2048 nt
    s_mov_b32 s4, 8192
    buffer_load_dwordx4 v[60:63], v10, s[44:47], s4 offen offset:0 nt
    buffer_load_dwordx4 v[92:95], v10, s[48:51], s4 offen offset:0 nt
    buffer_load_dwordx4 v[64:67], v10, s[44:47], s4 offen offset:2048 nt
    buffer_load_dwordx4 v[96:99], v10, s[48:51], s4 offen offset:2048 nt
    s_mov_b32 s4, 12288
    buffer_load_dwordx4 v[68:71], v10, s[44:47], s4 offen offset:0 nt
    buffer_load_dwordx4 v[100:103], v10, s[48:51], s4 offen offset:0 nt
    buffer_load_dwordx4 v[72:75], v10, s[44:47], s4 offen offset:2048 nt
    buffer_load_dwordx4 v[104:107], v10, s[48:51], s4 offen offset:2048 nt
    v_add_u32 v10, 16384, v10
    v_xor_b32 v12, 16, v13
    s_waitcnt vmcnt(19)
    v_lshlrev_b32 v216, 16, v108
    v_and_b32 v217, 0xffff0000, v108
    v_lshlrev_b32 v218, 16, v112
    v_and_b32 v219, 0xffff0000, v112
    v_lshlrev_b32 v220, 16, v116
    v_and_b32 v221, 0xffff0000, v116
    v_lshlrev_b32 v222, 16, v120
    v_and_b32 v223, 0xffff0000, v120
    v_lshlrev_b32 v224, 16, v124
    v_and_b32 v225, 0xffff0000, v124
    v_lshlrev_b32 v226, 16, v128
    v_and_b32 v227, 0xffff0000, v128
    v_lshlrev_b32 v228, 16, v132
    v_and_b32 v229, 0xffff0000, v132
    v_lshlrev_b32 v230, 16, v136
    v_and_b32 v231, 0xffff0000, v136
    v_lshlrev_b32 v232, 16, v140
    v_and_b32 v233, 0xffff0000, v140
    v_lshlrev_b32 v234, 16, v144
    v_and_b32 v235, 0xffff0000, v144
    v_lshlrev_b32 v236, 16, v148
    v_and_b32 v237, 0xffff0000, v148
    v_pk_mul_f32 v[216:217], v[216:217], v[190:191]
    v_lshlrev_b32 v238, 16, v152
    v_pk_fma_f32 v[216:217], v[218:219], v[188:189], v[216:217]
    v_and_b32 v239, 0xffff0000, v152
    v_pk_fma_f32 v[216:217], v[220:221], v[186:187], v[216:217]
    v_pk_fma_f32 v[216:217], v[222:223], v[184:185], v[216:217]
    v_pk_mul_f32 v[216:217], v[216:217], v[238:239]
    v_pk_mul_f32 v[218:219], v[218:219], v[190:191]
    v_lshlrev_b32 v240, 16, v156
    v_pk_fma_f32 v[218:219], v[220:221], v[188:189], v[218:219]
    v_and_b32 v241, 0xffff0000, v156
    v_pk_fma_f32 v[218:219], v[222:223], v[186:187], v[218:219]
    v_pk_fma_f32 v[218:219], v[224:225], v[184:185], v[218:219]
    v_pk_mul_f32 v[218:219], v[218:219], v[240:241]
    v_pk_mul_f32 v[220:221], v[220:221], v[190:191]
    v_lshlrev_b32 v238, 16, v160
    v_pk_fma_f32 v[220:221], v[222:223], v[188:189], v[220:221]
    v_and_b32 v239, 0xffff0000, v160
    v_pk_fma_f32 v[220:221], v[224:225], v[186:187], v[220:221]
    v_pk_fma_f32 v[220:221], v[226:227], v[184:185], v[220:221]
    v_pk_mul_f32 v[220:221], v[220:221], v[238:239]
    v_pk_mul_f32 v[222:223], v[222:223], v[190:191]
    v_lshlrev_b32 v240, 16, v164
    v_pk_fma_f32 v[222:223], v[224:225], v[188:189], v[222:223]
    v_and_b32 v241, 0xffff0000, v164
    v_pk_fma_f32 v[222:223], v[226:227], v[186:187], v[222:223]
    v_pk_fma_f32 v[222:223], v[228:229], v[184:185], v[222:223]
    v_pk_mul_f32 v[222:223], v[222:223], v[240:241]
    v_pk_mul_f32 v[224:225], v[224:225], v[190:191]
    v_lshlrev_b32 v238, 16, v168
    v_pk_fma_f32 v[224:225], v[226:227], v[188:189], v[224:225]
    v_and_b32 v239, 0xffff0000, v168
    v_pk_fma_f32 v[224:225], v[228:229], v[186:187], v[224:225]
    v_pk_fma_f32 v[224:225], v[230:231], v[184:185], v[224:225]
    v_pk_mul_f32 v[224:225], v[224:225], v[238:239]
    v_pk_mul_f32 v[226:227], v[226:227], v[190:191]
    v_lshlrev_b32 v240, 16, v172
    v_pk_fma_f32 v[226:227], v[228:229], v[188:189], v[226:227]
    v_and_b32 v241, 0xffff0000, v172
    v_pk_fma_f32 v[226:227], v[230:231], v[186:187], v[226:227]
    v_pk_fma_f32 v[226:227], v[232:233], v[184:185], v[226:227]
    v_pk_mul_f32 v[226:227], v[226:227], v[240:241]
    v_pk_mul_f32 v[228:229], v[228:229], v[190:191]
    v_lshlrev_b32 v238, 16, v176
    v_pk_fma_f32 v[228:229], v[230:231], v[188:189], v[228:229]
    v_and_b32 v239, 0xffff0000, v176
    v_pk_fma_f32 v[228:229], v[232:233], v[186:187], v[228:229]
    v_pk_fma_f32 v[228:229], v[234:235], v[184:185], v[228:229]
    v_pk_mul_f32 v[228:229], v[228:229], v[238:239]
    v_pk_mul_f32 v[230:231], v[230:231], v[190:191]
    v_lshlrev_b32 v240, 16, v180
    v_pk_fma_f32 v[230:231], v[232:233], v[188:189], v[230:231]
    v_and_b32 v241, 0xffff0000, v180
    v_pk_fma_f32 v[230:231], v[234:235], v[186:187], v[230:231]
    v_pk_fma_f32 v[230:231], v[236:237], v[184:185], v[230:231]
    v_pk_mul_f32 v[230:231], v[230:231], v[240:241]
    v_cvt_pk_bf16_f32 v242, v230, v228
    v_cvt_pk_bf16_f32 v243, v226, v224
    v_cvt_pk_bf16_f32 v244, v222, v220
    v_cvt_pk_bf16_f32 v245, v218, v216
    ds_write_b128 v12, v[242:245] offset:0
    v_cvt_pk_bf16_f32 v246, v231, v229
    v_cvt_pk_bf16_f32 v247, v227, v225
    v_cvt_pk_bf16_f32 v248, v223, v221
    v_cvt_pk_bf16_f32 v249, v219, v217
    ds_write_b128 v12, v[246:249] offset:128
    v_lshlrev_b32 v216, 16, v109
    v_and_b32 v217, 0xffff0000, v109
    v_lshlrev_b32 v218, 16, v113
    v_and_b32 v219, 0xffff0000, v113
    v_lshlrev_b32 v220, 16, v117
    v_and_b32 v221, 0xffff0000, v117
    v_lshlrev_b32 v222, 16, v121
    v_and_b32 v223, 0xffff0000, v121
    v_lshlrev_b32 v224, 16, v125
    v_and_b32 v225, 0xffff0000, v125
    v_lshlrev_b32 v226, 16, v129
    v_and_b32 v227, 0xffff0000, v129
    v_lshlrev_b32 v228, 16, v133
    v_and_b32 v229, 0xffff0000, v133
    v_lshlrev_b32 v230, 16, v137
    v_and_b32 v231, 0xffff0000, v137
    v_lshlrev_b32 v232, 16, v141
    v_and_b32 v233, 0xffff0000, v141
    v_lshlrev_b32 v234, 16, v145
    v_and_b32 v235, 0xffff0000, v145
    v_lshlrev_b32 v236, 16, v149
    v_and_b32 v237, 0xffff0000, v149
    v_pk_mul_f32 v[216:217], v[216:217], v[198:199]
    v_lshlrev_b32 v238, 16, v153
    v_pk_fma_f32 v[216:217], v[218:219], v[196:197], v[216:217]
    v_and_b32 v239, 0xffff0000, v153
    v_pk_fma_f32 v[216:217], v[220:221], v[194:195], v[216:217]
    v_pk_fma_f32 v[216:217], v[222:223], v[192:193], v[216:217]
    v_pk_mul_f32 v[216:217], v[216:217], v[238:239]
    v_pk_mul_f32 v[218:219], v[218:219], v[198:199]
    v_lshlrev_b32 v240, 16, v157
    v_pk_fma_f32 v[218:219], v[220:221], v[196:197], v[218:219]
    v_and_b32 v241, 0xffff0000, v157
    v_pk_fma_f32 v[218:219], v[222:223], v[194:195], v[218:219]
    v_pk_fma_f32 v[218:219], v[224:225], v[192:193], v[218:219]
    v_pk_mul_f32 v[218:219], v[218:219], v[240:241]
    v_pk_mul_f32 v[220:221], v[220:221], v[198:199]
    v_lshlrev_b32 v238, 16, v161
    v_pk_fma_f32 v[220:221], v[222:223], v[196:197], v[220:221]
    v_and_b32 v239, 0xffff0000, v161
    v_pk_fma_f32 v[220:221], v[224:225], v[194:195], v[220:221]
    v_pk_fma_f32 v[220:221], v[226:227], v[192:193], v[220:221]
    v_pk_mul_f32 v[220:221], v[220:221], v[238:239]
    v_pk_mul_f32 v[222:223], v[222:223], v[198:199]
    v_lshlrev_b32 v240, 16, v165
    v_pk_fma_f32 v[222:223], v[224:225], v[196:197], v[222:223]
    v_and_b32 v241, 0xffff0000, v165
    v_pk_fma_f32 v[222:223], v[226:227], v[194:195], v[222:223]
    v_pk_fma_f32 v[222:223], v[228:229], v[192:193], v[222:223]
    v_pk_mul_f32 v[222:223], v[222:223], v[240:241]
    v_pk_mul_f32 v[224:225], v[224:225], v[198:199]
    v_lshlrev_b32 v238, 16, v169
    v_pk_fma_f32 v[224:225], v[226:227], v[196:197], v[224:225]
    v_and_b32 v239, 0xffff0000, v169
    v_pk_fma_f32 v[224:225], v[228:229], v[194:195], v[224:225]
    v_pk_fma_f32 v[224:225], v[230:231], v[192:193], v[224:225]
    v_pk_mul_f32 v[224:225], v[224:225], v[238:239]
    v_pk_mul_f32 v[226:227], v[226:227], v[198:199]
    v_lshlrev_b32 v240, 16, v173
    v_pk_fma_f32 v[226:227], v[228:229], v[196:197], v[226:227]
    v_and_b32 v241, 0xffff0000, v173
    v_pk_fma_f32 v[226:227], v[230:231], v[194:195], v[226:227]
    v_pk_fma_f32 v[226:227], v[232:233], v[192:193], v[226:227]
    v_pk_mul_f32 v[226:227], v[226:227], v[240:241]
    v_pk_mul_f32 v[228:229], v[228:229], v[198:199]
    v_lshlrev_b32 v238, 16, v177
    v_pk_fma_f32 v[228:229], v[230:231], v[196:197], v[228:229]
    v_and_b32 v239, 0xffff0000, v177
    v_pk_fma_f32 v[228:229], v[232:233], v[194:195], v[228:229]
    v_pk_fma_f32 v[228:229], v[234:235], v[192:193], v[228:229]
    v_pk_mul_f32 v[228:229], v[228:229], v[238:239]
    v_pk_mul_f32 v[230:231], v[230:231], v[198:199]
    v_lshlrev_b32 v240, 16, v181
    v_pk_fma_f32 v[230:231], v[232:233], v[196:197], v[230:231]
    v_and_b32 v241, 0xffff0000, v181
    v_pk_fma_f32 v[230:231], v[234:235], v[194:195], v[230:231]
    v_pk_fma_f32 v[230:231], v[236:237], v[192:193], v[230:231]
    v_pk_mul_f32 v[230:231], v[230:231], v[240:241]
    v_cvt_pk_bf16_f32 v242, v230, v228
    v_cvt_pk_bf16_f32 v243, v226, v224
    v_cvt_pk_bf16_f32 v244, v222, v220
    v_cvt_pk_bf16_f32 v245, v218, v216
    ds_write_b128 v12, v[242:245] offset:256
    v_cvt_pk_bf16_f32 v246, v231, v229
    v_cvt_pk_bf16_f32 v247, v227, v225
    v_cvt_pk_bf16_f32 v248, v223, v221
    v_cvt_pk_bf16_f32 v249, v219, v217
    ds_write_b128 v12, v[246:249] offset:384
    v_lshlrev_b32 v216, 16, v110
    v_and_b32 v217, 0xffff0000, v110
    v_lshlrev_b32 v218, 16, v114
    v_and_b32 v219, 0xffff0000, v114
    v_lshlrev_b32 v220, 16, v118
    v_and_b32 v221, 0xffff0000, v118
    v_lshlrev_b32 v222, 16, v122
    v_and_b32 v223, 0xffff0000, v122
    v_lshlrev_b32 v224, 16, v126
    v_and_b32 v225, 0xffff0000, v126
    v_lshlrev_b32 v226, 16, v130
    v_and_b32 v227, 0xffff0000, v130
    v_lshlrev_b32 v228, 16, v134
    v_and_b32 v229, 0xffff0000, v134
    v_lshlrev_b32 v230, 16, v138
    v_and_b32 v231, 0xffff0000, v138
    v_lshlrev_b32 v232, 16, v142
    v_and_b32 v233, 0xffff0000, v142
    v_lshlrev_b32 v234, 16, v146
    v_and_b32 v235, 0xffff0000, v146
    v_lshlrev_b32 v236, 16, v150
    v_and_b32 v237, 0xffff0000, v150
    v_pk_mul_f32 v[216:217], v[216:217], v[206:207]
    v_lshlrev_b32 v238, 16, v154
    v_pk_fma_f32 v[216:217], v[218:219], v[204:205], v[216:217]
    v_and_b32 v239, 0xffff0000, v154
    v_pk_fma_f32 v[216:217], v[220:221], v[202:203], v[216:217]
    v_pk_fma_f32 v[216:217], v[222:223], v[200:201], v[216:217]
    v_pk_mul_f32 v[216:217], v[216:217], v[238:239]
    v_pk_mul_f32 v[218:219], v[218:219], v[206:207]
    v_lshlrev_b32 v240, 16, v158
    v_pk_fma_f32 v[218:219], v[220:221], v[204:205], v[218:219]
    v_and_b32 v241, 0xffff0000, v158
    v_pk_fma_f32 v[218:219], v[222:223], v[202:203], v[218:219]
    v_pk_fma_f32 v[218:219], v[224:225], v[200:201], v[218:219]
    v_pk_mul_f32 v[218:219], v[218:219], v[240:241]
    v_pk_mul_f32 v[220:221], v[220:221], v[206:207]
    v_lshlrev_b32 v238, 16, v162
    v_pk_fma_f32 v[220:221], v[222:223], v[204:205], v[220:221]
    v_and_b32 v239, 0xffff0000, v162
    v_pk_fma_f32 v[220:221], v[224:225], v[202:203], v[220:221]
    v_pk_fma_f32 v[220:221], v[226:227], v[200:201], v[220:221]
    v_pk_mul_f32 v[220:221], v[220:221], v[238:239]
    v_pk_mul_f32 v[222:223], v[222:223], v[206:207]
    v_lshlrev_b32 v240, 16, v166
    v_pk_fma_f32 v[222:223], v[224:225], v[204:205], v[222:223]
    v_and_b32 v241, 0xffff0000, v166
    v_pk_fma_f32 v[222:223], v[226:227], v[202:203], v[222:223]
    v_pk_fma_f32 v[222:223], v[228:229], v[200:201], v[222:223]
    v_pk_mul_f32 v[222:223], v[222:223], v[240:241]
    v_pk_mul_f32 v[224:225], v[224:225], v[206:207]
    v_lshlrev_b32 v238, 16, v170
    v_pk_fma_f32 v[224:225], v[226:227], v[204:205], v[224:225]
    v_and_b32 v239, 0xffff0000, v170
    v_pk_fma_f32 v[224:225], v[228:229], v[202:203], v[224:225]
    v_pk_fma_f32 v[224:225], v[230:231], v[200:201], v[224:225]
    v_pk_mul_f32 v[224:225], v[224:225], v[238:239]
    v_pk_mul_f32 v[226:227], v[226:227], v[206:207]
    v_lshlrev_b32 v240, 16, v174
    v_pk_fma_f32 v[226:227], v[228:229], v[204:205], v[226:227]
    v_and_b32 v241, 0xffff0000, v174
    v_pk_fma_f32 v[226:227], v[230:231], v[202:203], v[226:227]
    v_pk_fma_f32 v[226:227], v[232:233], v[200:201], v[226:227]
    v_pk_mul_f32 v[226:227], v[226:227], v[240:241]
    v_pk_mul_f32 v[228:229], v[228:229], v[206:207]
    v_lshlrev_b32 v238, 16, v178
    v_pk_fma_f32 v[228:229], v[230:231], v[204:205], v[228:229]
    v_and_b32 v239, 0xffff0000, v178
    v_pk_fma_f32 v[228:229], v[232:233], v[202:203], v[228:229]
    v_pk_fma_f32 v[228:229], v[234:235], v[200:201], v[228:229]
    v_pk_mul_f32 v[228:229], v[228:229], v[238:239]
    v_pk_mul_f32 v[230:231], v[230:231], v[206:207]
    v_lshlrev_b32 v240, 16, v182
    v_pk_fma_f32 v[230:231], v[232:233], v[204:205], v[230:231]
    v_and_b32 v241, 0xffff0000, v182
    v_pk_fma_f32 v[230:231], v[234:235], v[202:203], v[230:231]
    v_pk_fma_f32 v[230:231], v[236:237], v[200:201], v[230:231]
    v_pk_mul_f32 v[230:231], v[230:231], v[240:241]
    v_cvt_pk_bf16_f32 v242, v230, v228
    v_cvt_pk_bf16_f32 v243, v226, v224
    v_cvt_pk_bf16_f32 v244, v222, v220
    v_cvt_pk_bf16_f32 v245, v218, v216
    ds_write_b128 v12, v[242:245] offset:512
    v_cvt_pk_bf16_f32 v246, v231, v229
    v_cvt_pk_bf16_f32 v247, v227, v225
    v_cvt_pk_bf16_f32 v248, v223, v221
    v_cvt_pk_bf16_f32 v249, v219, v217
    ds_write_b128 v12, v[246:249] offset:640
    v_lshlrev_b32 v216, 16, v111
    v_and_b32 v217, 0xffff0000, v111
    v_lshlrev_b32 v218, 16, v115
    v_and_b32 v219, 0xffff0000, v115
    v_lshlrev_b32 v220, 16, v119
    v_and_b32 v221, 0xffff0000, v119
    v_lshlrev_b32 v222, 16, v123
    v_and_b32 v223, 0xffff0000, v123
    v_lshlrev_b32 v224, 16, v127
    v_and_b32 v225, 0xffff0000, v127
    v_lshlrev_b32 v226, 16, v131
    v_and_b32 v227, 0xffff0000, v131
    v_lshlrev_b32 v228, 16, v135
    v_and_b32 v229, 0xffff0000, v135
    v_lshlrev_b32 v230, 16, v139
    v_and_b32 v231, 0xffff0000, v139
    v_lshlrev_b32 v232, 16, v143
    v_and_b32 v233, 0xffff0000, v143
    v_lshlrev_b32 v234, 16, v147
    v_and_b32 v235, 0xffff0000, v147
    v_lshlrev_b32 v236, 16, v151
    v_and_b32 v237, 0xffff0000, v151
    v_pk_mul_f32 v[216:217], v[216:217], v[214:215]
    v_lshlrev_b32 v238, 16, v155
    v_pk_fma_f32 v[216:217], v[218:219], v[212:213], v[216:217]
    v_and_b32 v239, 0xffff0000, v155
    v_pk_fma_f32 v[216:217], v[220:221], v[210:211], v[216:217]
    v_pk_fma_f32 v[216:217], v[222:223], v[208:209], v[216:217]
    v_pk_mul_f32 v[216:217], v[216:217], v[238:239]
    v_pk_mul_f32 v[218:219], v[218:219], v[214:215]
    v_lshlrev_b32 v240, 16, v159
    v_pk_fma_f32 v[218:219], v[220:221], v[212:213], v[218:219]
    v_and_b32 v241, 0xffff0000, v159
    v_pk_fma_f32 v[218:219], v[222:223], v[210:211], v[218:219]
    v_pk_fma_f32 v[218:219], v[224:225], v[208:209], v[218:219]
    v_pk_mul_f32 v[218:219], v[218:219], v[240:241]
    v_pk_mul_f32 v[220:221], v[220:221], v[214:215]
    v_lshlrev_b32 v238, 16, v163
    v_pk_fma_f32 v[220:221], v[222:223], v[212:213], v[220:221]
    v_and_b32 v239, 0xffff0000, v163
    v_pk_fma_f32 v[220:221], v[224:225], v[210:211], v[220:221]
    v_pk_fma_f32 v[220:221], v[226:227], v[208:209], v[220:221]
    v_pk_mul_f32 v[220:221], v[220:221], v[238:239]
    v_pk_mul_f32 v[222:223], v[222:223], v[214:215]
    v_lshlrev_b32 v240, 16, v167
    v_pk_fma_f32 v[222:223], v[224:225], v[212:213], v[222:223]
    v_and_b32 v241, 0xffff0000, v167
    v_pk_fma_f32 v[222:223], v[226:227], v[210:211], v[222:223]
    v_pk_fma_f32 v[222:223], v[228:229], v[208:209], v[222:223]
    v_pk_mul_f32 v[222:223], v[222:223], v[240:241]
    v_pk_mul_f32 v[224:225], v[224:225], v[214:215]
    v_lshlrev_b32 v238, 16, v171
    v_pk_fma_f32 v[224:225], v[226:227], v[212:213], v[224:225]
    v_and_b32 v239, 0xffff0000, v171
    v_pk_fma_f32 v[224:225], v[228:229], v[210:211], v[224:225]
    v_pk_fma_f32 v[224:225], v[230:231], v[208:209], v[224:225]
    v_pk_mul_f32 v[224:225], v[224:225], v[238:239]
    v_pk_mul_f32 v[226:227], v[226:227], v[214:215]
    v_lshlrev_b32 v240, 16, v175
    v_pk_fma_f32 v[226:227], v[228:229], v[212:213], v[226:227]
    v_and_b32 v241, 0xffff0000, v175
    v_pk_fma_f32 v[226:227], v[230:231], v[210:211], v[226:227]
    v_pk_fma_f32 v[226:227], v[232:233], v[208:209], v[226:227]
    v_pk_mul_f32 v[226:227], v[226:227], v[240:241]
    v_pk_mul_f32 v[228:229], v[228:229], v[214:215]
    v_lshlrev_b32 v238, 16, v179
    v_pk_fma_f32 v[228:229], v[230:231], v[212:213], v[228:229]
    v_and_b32 v239, 0xffff0000, v179
    v_pk_fma_f32 v[228:229], v[232:233], v[210:211], v[228:229]
    v_pk_fma_f32 v[228:229], v[234:235], v[208:209], v[228:229]
    v_pk_mul_f32 v[228:229], v[228:229], v[238:239]
    v_pk_mul_f32 v[230:231], v[230:231], v[214:215]
    v_lshlrev_b32 v240, 16, v183
    v_pk_fma_f32 v[230:231], v[232:233], v[212:213], v[230:231]
    v_and_b32 v241, 0xffff0000, v183
    v_pk_fma_f32 v[230:231], v[234:235], v[210:211], v[230:231]
    v_pk_fma_f32 v[230:231], v[236:237], v[208:209], v[230:231]
    v_pk_mul_f32 v[230:231], v[230:231], v[240:241]
    v_cvt_pk_bf16_f32 v242, v230, v228
    v_cvt_pk_bf16_f32 v243, v226, v224
    v_cvt_pk_bf16_f32 v244, v222, v220
    v_cvt_pk_bf16_f32 v245, v218, v216
    ds_write_b128 v12, v[242:245] offset:768
    v_cvt_pk_bf16_f32 v246, v231, v229
    v_cvt_pk_bf16_f32 v247, v227, v225
    v_cvt_pk_bf16_f32 v248, v223, v221
    v_cvt_pk_bf16_f32 v249, v219, v217
    ds_write_b128 v12, v[246:249] offset:896
    v_subrev_u32 v11, 6144, v10
    buffer_load_dwordx4 v[108:111], v11, s[44:47], 0 offen nt
    v_subrev_u32 v11, 4096, v10
    buffer_load_dwordx4 v[112:115], v11, s[44:47], 0 offen nt
    v_subrev_u32 v11, 2048, v10
    buffer_load_dwordx4 v[116:119], v11, s[44:47], 0 offen nt
    s_mov_b32 s4, 0
    buffer_load_dwordx4 v[120:123], v10, s[44:47], s4 offen offset:0 nt
    buffer_load_dwordx4 v[152:155], v10, s[48:51], s4 offen offset:0 nt
    buffer_load_dwordx4 v[124:127], v10, s[44:47], s4 offen offset:2048 nt
    buffer_load_dwordx4 v[156:159], v10, s[48:51], s4 offen offset:2048 nt
    s_mov_b32 s4, 4096
    buffer_load_dwordx4 v[128:131], v10, s[44:47], s4 offen offset:0 nt
    buffer_load_dwordx4 v[160:163], v10, s[48:51], s4 offen offset:0 nt
    buffer_load_dwordx4 v[132:135], v10, s[44:47], s4 offen offset:2048 nt
    buffer_load_dwordx4 v[164:167], v10, s[48:51], s4 offen offset:2048 nt
    s_mov_b32 s4, 8192
    buffer_load_dwordx4 v[136:139], v10, s[44:47], s4 offen offset:0 nt
    buffer_load_dwordx4 v[168:171], v10, s[48:51], s4 offen offset:0 nt
    buffer_load_dwordx4 v[140:143], v10, s[44:47], s4 offen offset:2048 nt
    buffer_load_dwordx4 v[172:175], v10, s[48:51], s4 offen offset:2048 nt
    s_mov_b32 s4, 12288
    buffer_load_dwordx4 v[144:147], v10, s[44:47], s4 offen offset:0 nt
    buffer_load_dwordx4 v[176:179], v10, s[48:51], s4 offen offset:0 nt
    buffer_load_dwordx4 v[148:151], v10, s[44:47], s4 offen offset:2048 nt
    buffer_load_dwordx4 v[180:183], v10, s[48:51], s4 offen offset:2048 nt
    v_add_u32 v10, 16384, v10
    v_xor_b32 v12, 32, v13
    s_waitcnt vmcnt(19)
    v_lshlrev_b32 v216, 16, v32
    v_and_b32 v217, 0xffff0000, v32
    v_lshlrev_b32 v218, 16, v36
    v_and_b32 v219, 0xffff0000, v36
    v_lshlrev_b32 v220, 16, v40
    v_and_b32 v221, 0xffff0000, v40
    v_lshlrev_b32 v222, 16, v44
    v_and_b32 v223, 0xffff0000, v44
    v_lshlrev_b32 v224, 16, v48
    v_and_b32 v225, 0xffff0000, v48
    v_lshlrev_b32 v226, 16, v52
    v_and_b32 v227, 0xffff0000, v52
    v_lshlrev_b32 v228, 16, v56
    v_and_b32 v229, 0xffff0000, v56
    v_lshlrev_b32 v230, 16, v60
    v_and_b32 v231, 0xffff0000, v60
    v_lshlrev_b32 v232, 16, v64
    v_and_b32 v233, 0xffff0000, v64
    v_lshlrev_b32 v234, 16, v68
    v_and_b32 v235, 0xffff0000, v68
    v_lshlrev_b32 v236, 16, v72
    v_and_b32 v237, 0xffff0000, v72
    v_pk_mul_f32 v[216:217], v[216:217], v[190:191]
    v_lshlrev_b32 v238, 16, v76
    v_pk_fma_f32 v[216:217], v[218:219], v[188:189], v[216:217]
    v_and_b32 v239, 0xffff0000, v76
    v_pk_fma_f32 v[216:217], v[220:221], v[186:187], v[216:217]
    v_pk_fma_f32 v[216:217], v[222:223], v[184:185], v[216:217]
    v_pk_mul_f32 v[216:217], v[216:217], v[238:239]
    v_pk_mul_f32 v[218:219], v[218:219], v[190:191]
    v_lshlrev_b32 v240, 16, v80
    v_pk_fma_f32 v[218:219], v[220:221], v[188:189], v[218:219]
    v_and_b32 v241, 0xffff0000, v80
    v_pk_fma_f32 v[218:219], v[222:223], v[186:187], v[218:219]
    v_pk_fma_f32 v[218:219], v[224:225], v[184:185], v[218:219]
    v_pk_mul_f32 v[218:219], v[218:219], v[240:241]
    v_pk_mul_f32 v[220:221], v[220:221], v[190:191]
    v_lshlrev_b32 v238, 16, v84
    v_pk_fma_f32 v[220:221], v[222:223], v[188:189], v[220:221]
    v_and_b32 v239, 0xffff0000, v84
    v_pk_fma_f32 v[220:221], v[224:225], v[186:187], v[220:221]
    v_pk_fma_f32 v[220:221], v[226:227], v[184:185], v[220:221]
    v_pk_mul_f32 v[220:221], v[220:221], v[238:239]
    v_pk_mul_f32 v[222:223], v[222:223], v[190:191]
    v_lshlrev_b32 v240, 16, v88
    v_pk_fma_f32 v[222:223], v[224:225], v[188:189], v[222:223]
    v_and_b32 v241, 0xffff0000, v88
    v_pk_fma_f32 v[222:223], v[226:227], v[186:187], v[222:223]
    v_pk_fma_f32 v[222:223], v[228:229], v[184:185], v[222:223]
    v_pk_mul_f32 v[222:223], v[222:223], v[240:241]
    v_pk_mul_f32 v[224:225], v[224:225], v[190:191]
    v_lshlrev_b32 v238, 16, v92
    v_pk_fma_f32 v[224:225], v[226:227], v[188:189], v[224:225]
    v_and_b32 v239, 0xffff0000, v92
    v_pk_fma_f32 v[224:225], v[228:229], v[186:187], v[224:225]
    v_pk_fma_f32 v[224:225], v[230:231], v[184:185], v[224:225]
    v_pk_mul_f32 v[224:225], v[224:225], v[238:239]
    v_pk_mul_f32 v[226:227], v[226:227], v[190:191]
    v_lshlrev_b32 v240, 16, v96
    v_pk_fma_f32 v[226:227], v[228:229], v[188:189], v[226:227]
    v_and_b32 v241, 0xffff0000, v96
    v_pk_fma_f32 v[226:227], v[230:231], v[186:187], v[226:227]
    v_pk_fma_f32 v[226:227], v[232:233], v[184:185], v[226:227]
    v_pk_mul_f32 v[226:227], v[226:227], v[240:241]
    v_pk_mul_f32 v[228:229], v[228:229], v[190:191]
    v_lshlrev_b32 v238, 16, v100
    v_pk_fma_f32 v[228:229], v[230:231], v[188:189], v[228:229]
    v_and_b32 v239, 0xffff0000, v100
    v_pk_fma_f32 v[228:229], v[232:233], v[186:187], v[228:229]
    v_pk_fma_f32 v[228:229], v[234:235], v[184:185], v[228:229]
    v_pk_mul_f32 v[228:229], v[228:229], v[238:239]
    v_pk_mul_f32 v[230:231], v[230:231], v[190:191]
    v_lshlrev_b32 v240, 16, v104
    v_pk_fma_f32 v[230:231], v[232:233], v[188:189], v[230:231]
    v_and_b32 v241, 0xffff0000, v104
    v_pk_fma_f32 v[230:231], v[234:235], v[186:187], v[230:231]
    v_pk_fma_f32 v[230:231], v[236:237], v[184:185], v[230:231]
    v_pk_mul_f32 v[230:231], v[230:231], v[240:241]
    v_cvt_pk_bf16_f32 v242, v230, v228
    v_cvt_pk_bf16_f32 v243, v226, v224
    v_cvt_pk_bf16_f32 v244, v222, v220
    v_cvt_pk_bf16_f32 v245, v218, v216
    ds_write_b128 v12, v[242:245] offset:0
    v_cvt_pk_bf16_f32 v246, v231, v229
    v_cvt_pk_bf16_f32 v247, v227, v225
    v_cvt_pk_bf16_f32 v248, v223, v221
    v_cvt_pk_bf16_f32 v249, v219, v217
    ds_write_b128 v12, v[246:249] offset:128
    v_lshlrev_b32 v216, 16, v33
    v_and_b32 v217, 0xffff0000, v33
    v_lshlrev_b32 v218, 16, v37
    v_and_b32 v219, 0xffff0000, v37
    v_lshlrev_b32 v220, 16, v41
    v_and_b32 v221, 0xffff0000, v41
    v_lshlrev_b32 v222, 16, v45
    v_and_b32 v223, 0xffff0000, v45
    v_lshlrev_b32 v224, 16, v49
    v_and_b32 v225, 0xffff0000, v49
    v_lshlrev_b32 v226, 16, v53
    v_and_b32 v227, 0xffff0000, v53
    v_lshlrev_b32 v228, 16, v57
    v_and_b32 v229, 0xffff0000, v57
    v_lshlrev_b32 v230, 16, v61
    v_and_b32 v231, 0xffff0000, v61
    v_lshlrev_b32 v232, 16, v65
    v_and_b32 v233, 0xffff0000, v65
    v_lshlrev_b32 v234, 16, v69
    v_and_b32 v235, 0xffff0000, v69
    v_lshlrev_b32 v236, 16, v73
    v_and_b32 v237, 0xffff0000, v73
    v_pk_mul_f32 v[216:217], v[216:217], v[198:199]
    v_lshlrev_b32 v238, 16, v77
    v_pk_fma_f32 v[216:217], v[218:219], v[196:197], v[216:217]
    v_and_b32 v239, 0xffff0000, v77
    v_pk_fma_f32 v[216:217], v[220:221], v[194:195], v[216:217]
    v_pk_fma_f32 v[216:217], v[222:223], v[192:193], v[216:217]
    v_pk_mul_f32 v[216:217], v[216:217], v[238:239]
    v_pk_mul_f32 v[218:219], v[218:219], v[198:199]
    v_lshlrev_b32 v240, 16, v81
    v_pk_fma_f32 v[218:219], v[220:221], v[196:197], v[218:219]
    v_and_b32 v241, 0xffff0000, v81
    v_pk_fma_f32 v[218:219], v[222:223], v[194:195], v[218:219]
    v_pk_fma_f32 v[218:219], v[224:225], v[192:193], v[218:219]
    v_pk_mul_f32 v[218:219], v[218:219], v[240:241]
    v_pk_mul_f32 v[220:221], v[220:221], v[198:199]
    v_lshlrev_b32 v238, 16, v85
    v_pk_fma_f32 v[220:221], v[222:223], v[196:197], v[220:221]
    v_and_b32 v239, 0xffff0000, v85
    v_pk_fma_f32 v[220:221], v[224:225], v[194:195], v[220:221]
    v_pk_fma_f32 v[220:221], v[226:227], v[192:193], v[220:221]
    v_pk_mul_f32 v[220:221], v[220:221], v[238:239]
    v_pk_mul_f32 v[222:223], v[222:223], v[198:199]
    v_lshlrev_b32 v240, 16, v89
    v_pk_fma_f32 v[222:223], v[224:225], v[196:197], v[222:223]
    v_and_b32 v241, 0xffff0000, v89
    v_pk_fma_f32 v[222:223], v[226:227], v[194:195], v[222:223]
    v_pk_fma_f32 v[222:223], v[228:229], v[192:193], v[222:223]
    v_pk_mul_f32 v[222:223], v[222:223], v[240:241]
    v_pk_mul_f32 v[224:225], v[224:225], v[198:199]
    v_lshlrev_b32 v238, 16, v93
    v_pk_fma_f32 v[224:225], v[226:227], v[196:197], v[224:225]
    v_and_b32 v239, 0xffff0000, v93
    v_pk_fma_f32 v[224:225], v[228:229], v[194:195], v[224:225]
    v_pk_fma_f32 v[224:225], v[230:231], v[192:193], v[224:225]
    v_pk_mul_f32 v[224:225], v[224:225], v[238:239]
    v_pk_mul_f32 v[226:227], v[226:227], v[198:199]
    v_lshlrev_b32 v240, 16, v97
    v_pk_fma_f32 v[226:227], v[228:229], v[196:197], v[226:227]
    v_and_b32 v241, 0xffff0000, v97
    v_pk_fma_f32 v[226:227], v[230:231], v[194:195], v[226:227]
    v_pk_fma_f32 v[226:227], v[232:233], v[192:193], v[226:227]
    v_pk_mul_f32 v[226:227], v[226:227], v[240:241]
    v_pk_mul_f32 v[228:229], v[228:229], v[198:199]
    v_lshlrev_b32 v238, 16, v101
    v_pk_fma_f32 v[228:229], v[230:231], v[196:197], v[228:229]
    v_and_b32 v239, 0xffff0000, v101
    v_pk_fma_f32 v[228:229], v[232:233], v[194:195], v[228:229]
    v_pk_fma_f32 v[228:229], v[234:235], v[192:193], v[228:229]
    v_pk_mul_f32 v[228:229], v[228:229], v[238:239]
    v_pk_mul_f32 v[230:231], v[230:231], v[198:199]
    v_lshlrev_b32 v240, 16, v105
    v_pk_fma_f32 v[230:231], v[232:233], v[196:197], v[230:231]
    v_and_b32 v241, 0xffff0000, v105
    v_pk_fma_f32 v[230:231], v[234:235], v[194:195], v[230:231]
    v_pk_fma_f32 v[230:231], v[236:237], v[192:193], v[230:231]
    v_pk_mul_f32 v[230:231], v[230:231], v[240:241]
    v_cvt_pk_bf16_f32 v242, v230, v228
    v_cvt_pk_bf16_f32 v243, v226, v224
    v_cvt_pk_bf16_f32 v244, v222, v220
    v_cvt_pk_bf16_f32 v245, v218, v216
    ds_write_b128 v12, v[242:245] offset:256
    v_cvt_pk_bf16_f32 v246, v231, v229
    v_cvt_pk_bf16_f32 v247, v227, v225
    v_cvt_pk_bf16_f32 v248, v223, v221
    v_cvt_pk_bf16_f32 v249, v219, v217
    ds_write_b128 v12, v[246:249] offset:384
    v_lshlrev_b32 v216, 16, v34
    v_and_b32 v217, 0xffff0000, v34
    v_lshlrev_b32 v218, 16, v38
    v_and_b32 v219, 0xffff0000, v38
    v_lshlrev_b32 v220, 16, v42
    v_and_b32 v221, 0xffff0000, v42
    v_lshlrev_b32 v222, 16, v46
    v_and_b32 v223, 0xffff0000, v46
    v_lshlrev_b32 v224, 16, v50
    v_and_b32 v225, 0xffff0000, v50
    v_lshlrev_b32 v226, 16, v54
    v_and_b32 v227, 0xffff0000, v54
    v_lshlrev_b32 v228, 16, v58
    v_and_b32 v229, 0xffff0000, v58
    v_lshlrev_b32 v230, 16, v62
    v_and_b32 v231, 0xffff0000, v62
    v_lshlrev_b32 v232, 16, v66
    v_and_b32 v233, 0xffff0000, v66
    v_lshlrev_b32 v234, 16, v70
    v_and_b32 v235, 0xffff0000, v70
    v_lshlrev_b32 v236, 16, v74
    v_and_b32 v237, 0xffff0000, v74
    v_pk_mul_f32 v[216:217], v[216:217], v[206:207]
    v_lshlrev_b32 v238, 16, v78
    v_pk_fma_f32 v[216:217], v[218:219], v[204:205], v[216:217]
    v_and_b32 v239, 0xffff0000, v78
    v_pk_fma_f32 v[216:217], v[220:221], v[202:203], v[216:217]
    v_pk_fma_f32 v[216:217], v[222:223], v[200:201], v[216:217]
    v_pk_mul_f32 v[216:217], v[216:217], v[238:239]
    v_pk_mul_f32 v[218:219], v[218:219], v[206:207]
    v_lshlrev_b32 v240, 16, v82
    v_pk_fma_f32 v[218:219], v[220:221], v[204:205], v[218:219]
    v_and_b32 v241, 0xffff0000, v82
    v_pk_fma_f32 v[218:219], v[222:223], v[202:203], v[218:219]
    v_pk_fma_f32 v[218:219], v[224:225], v[200:201], v[218:219]
    v_pk_mul_f32 v[218:219], v[218:219], v[240:241]
    v_pk_mul_f32 v[220:221], v[220:221], v[206:207]
    v_lshlrev_b32 v238, 16, v86
    v_pk_fma_f32 v[220:221], v[222:223], v[204:205], v[220:221]
    v_and_b32 v239, 0xffff0000, v86
    v_pk_fma_f32 v[220:221], v[224:225], v[202:203], v[220:221]
    v_pk_fma_f32 v[220:221], v[226:227], v[200:201], v[220:221]
    v_pk_mul_f32 v[220:221], v[220:221], v[238:239]
    v_pk_mul_f32 v[222:223], v[222:223], v[206:207]
    v_lshlrev_b32 v240, 16, v90
    v_pk_fma_f32 v[222:223], v[224:225], v[204:205], v[222:223]
    v_and_b32 v241, 0xffff0000, v90
    v_pk_fma_f32 v[222:223], v[226:227], v[202:203], v[222:223]
    v_pk_fma_f32 v[222:223], v[228:229], v[200:201], v[222:223]
    v_pk_mul_f32 v[222:223], v[222:223], v[240:241]
    v_pk_mul_f32 v[224:225], v[224:225], v[206:207]
    v_lshlrev_b32 v238, 16, v94
    v_pk_fma_f32 v[224:225], v[226:227], v[204:205], v[224:225]
    v_and_b32 v239, 0xffff0000, v94
    v_pk_fma_f32 v[224:225], v[228:229], v[202:203], v[224:225]
    v_pk_fma_f32 v[224:225], v[230:231], v[200:201], v[224:225]
    v_pk_mul_f32 v[224:225], v[224:225], v[238:239]
    v_pk_mul_f32 v[226:227], v[226:227], v[206:207]
    v_lshlrev_b32 v240, 16, v98
    v_pk_fma_f32 v[226:227], v[228:229], v[204:205], v[226:227]
    v_and_b32 v241, 0xffff0000, v98
    v_pk_fma_f32 v[226:227], v[230:231], v[202:203], v[226:227]
    v_pk_fma_f32 v[226:227], v[232:233], v[200:201], v[226:227]
    v_pk_mul_f32 v[226:227], v[226:227], v[240:241]
    v_pk_mul_f32 v[228:229], v[228:229], v[206:207]
    v_lshlrev_b32 v238, 16, v102
    v_pk_fma_f32 v[228:229], v[230:231], v[204:205], v[228:229]
    v_and_b32 v239, 0xffff0000, v102
    v_pk_fma_f32 v[228:229], v[232:233], v[202:203], v[228:229]
    v_pk_fma_f32 v[228:229], v[234:235], v[200:201], v[228:229]
    v_pk_mul_f32 v[228:229], v[228:229], v[238:239]
    v_pk_mul_f32 v[230:231], v[230:231], v[206:207]
    v_lshlrev_b32 v240, 16, v106
    v_pk_fma_f32 v[230:231], v[232:233], v[204:205], v[230:231]
    v_and_b32 v241, 0xffff0000, v106
    v_pk_fma_f32 v[230:231], v[234:235], v[202:203], v[230:231]
    v_pk_fma_f32 v[230:231], v[236:237], v[200:201], v[230:231]
    v_pk_mul_f32 v[230:231], v[230:231], v[240:241]
    v_cvt_pk_bf16_f32 v242, v230, v228
    v_cvt_pk_bf16_f32 v243, v226, v224
    v_cvt_pk_bf16_f32 v244, v222, v220
    v_cvt_pk_bf16_f32 v245, v218, v216
    ds_write_b128 v12, v[242:245] offset:512
    v_cvt_pk_bf16_f32 v246, v231, v229
    v_cvt_pk_bf16_f32 v247, v227, v225
    v_cvt_pk_bf16_f32 v248, v223, v221
    v_cvt_pk_bf16_f32 v249, v219, v217
    ds_write_b128 v12, v[246:249] offset:640
    v_lshlrev_b32 v216, 16, v35
    v_and_b32 v217, 0xffff0000, v35
    v_lshlrev_b32 v218, 16, v39
    v_and_b32 v219, 0xffff0000, v39
    v_lshlrev_b32 v220, 16, v43
    v_and_b32 v221, 0xffff0000, v43
    v_lshlrev_b32 v222, 16, v47
    v_and_b32 v223, 0xffff0000, v47
    v_lshlrev_b32 v224, 16, v51
    v_and_b32 v225, 0xffff0000, v51
    v_lshlrev_b32 v226, 16, v55
    v_and_b32 v227, 0xffff0000, v55
    v_lshlrev_b32 v228, 16, v59
    v_and_b32 v229, 0xffff0000, v59
    v_lshlrev_b32 v230, 16, v63
    v_and_b32 v231, 0xffff0000, v63
    v_lshlrev_b32 v232, 16, v67
    v_and_b32 v233, 0xffff0000, v67
    v_lshlrev_b32 v234, 16, v71
    v_and_b32 v235, 0xffff0000, v71
    v_lshlrev_b32 v236, 16, v75
    v_and_b32 v237, 0xffff0000, v75
    v_pk_mul_f32 v[216:217], v[216:217], v[214:215]
    v_lshlrev_b32 v238, 16, v79
    v_pk_fma_f32 v[216:217], v[218:219], v[212:213], v[216:217]
    v_and_b32 v239, 0xffff0000, v79
    v_pk_fma_f32 v[216:217], v[220:221], v[210:211], v[216:217]
    v_pk_fma_f32 v[216:217], v[222:223], v[208:209], v[216:217]
    v_pk_mul_f32 v[216:217], v[216:217], v[238:239]
    v_pk_mul_f32 v[218:219], v[218:219], v[214:215]
    v_lshlrev_b32 v240, 16, v83
    v_pk_fma_f32 v[218:219], v[220:221], v[212:213], v[218:219]
    v_and_b32 v241, 0xffff0000, v83
    v_pk_fma_f32 v[218:219], v[222:223], v[210:211], v[218:219]
    v_pk_fma_f32 v[218:219], v[224:225], v[208:209], v[218:219]
    v_pk_mul_f32 v[218:219], v[218:219], v[240:241]
    v_pk_mul_f32 v[220:221], v[220:221], v[214:215]
    v_lshlrev_b32 v238, 16, v87
    v_pk_fma_f32 v[220:221], v[222:223], v[212:213], v[220:221]
    v_and_b32 v239, 0xffff0000, v87
    v_pk_fma_f32 v[220:221], v[224:225], v[210:211], v[220:221]
    v_pk_fma_f32 v[220:221], v[226:227], v[208:209], v[220:221]
    v_pk_mul_f32 v[220:221], v[220:221], v[238:239]
    v_pk_mul_f32 v[222:223], v[222:223], v[214:215]
    v_lshlrev_b32 v240, 16, v91
    v_pk_fma_f32 v[222:223], v[224:225], v[212:213], v[222:223]
    v_and_b32 v241, 0xffff0000, v91
    v_pk_fma_f32 v[222:223], v[226:227], v[210:211], v[222:223]
    v_pk_fma_f32 v[222:223], v[228:229], v[208:209], v[222:223]
    v_pk_mul_f32 v[222:223], v[222:223], v[240:241]
    v_pk_mul_f32 v[224:225], v[224:225], v[214:215]
    v_lshlrev_b32 v238, 16, v95
    v_pk_fma_f32 v[224:225], v[226:227], v[212:213], v[224:225]
    v_and_b32 v239, 0xffff0000, v95
    v_pk_fma_f32 v[224:225], v[228:229], v[210:211], v[224:225]
    v_pk_fma_f32 v[224:225], v[230:231], v[208:209], v[224:225]
    v_pk_mul_f32 v[224:225], v[224:225], v[238:239]
    v_pk_mul_f32 v[226:227], v[226:227], v[214:215]
    v_lshlrev_b32 v240, 16, v99
    v_pk_fma_f32 v[226:227], v[228:229], v[212:213], v[226:227]
    v_and_b32 v241, 0xffff0000, v99
    v_pk_fma_f32 v[226:227], v[230:231], v[210:211], v[226:227]
    v_pk_fma_f32 v[226:227], v[232:233], v[208:209], v[226:227]
    v_pk_mul_f32 v[226:227], v[226:227], v[240:241]
    v_pk_mul_f32 v[228:229], v[228:229], v[214:215]
    v_lshlrev_b32 v238, 16, v103
    v_pk_fma_f32 v[228:229], v[230:231], v[212:213], v[228:229]
    v_and_b32 v239, 0xffff0000, v103
    v_pk_fma_f32 v[228:229], v[232:233], v[210:211], v[228:229]
    v_pk_fma_f32 v[228:229], v[234:235], v[208:209], v[228:229]
    v_pk_mul_f32 v[228:229], v[228:229], v[238:239]
    v_pk_mul_f32 v[230:231], v[230:231], v[214:215]
    v_lshlrev_b32 v240, 16, v107
    v_pk_fma_f32 v[230:231], v[232:233], v[212:213], v[230:231]
    v_and_b32 v241, 0xffff0000, v107
    v_pk_fma_f32 v[230:231], v[234:235], v[210:211], v[230:231]
    v_pk_fma_f32 v[230:231], v[236:237], v[208:209], v[230:231]
    v_pk_mul_f32 v[230:231], v[230:231], v[240:241]
    v_cvt_pk_bf16_f32 v242, v230, v228
    v_cvt_pk_bf16_f32 v243, v226, v224
    v_cvt_pk_bf16_f32 v244, v222, v220
    v_cvt_pk_bf16_f32 v245, v218, v216
    ds_write_b128 v12, v[242:245] offset:768
    v_cvt_pk_bf16_f32 v246, v231, v229
    v_cvt_pk_bf16_f32 v247, v227, v225
    v_cvt_pk_bf16_f32 v248, v223, v221
    v_cvt_pk_bf16_f32 v249, v219, v217
    ds_write_b128 v12, v[246:249] offset:896
    v_xor_b32 v12, 48, v13
    s_waitcnt vmcnt(0)
    v_lshlrev_b32 v216, 16, v108
    v_and_b32 v217, 0xffff0000, v108
    v_lshlrev_b32 v218, 16, v112
    v_and_b32 v219, 0xffff0000, v112
    v_lshlrev_b32 v220, 16, v116
    v_and_b32 v221, 0xffff0000, v116
    v_lshlrev_b32 v222, 16, v120
    v_and_b32 v223, 0xffff0000, v120
    v_lshlrev_b32 v224, 16, v124
    v_and_b32 v225, 0xffff0000, v124
    v_lshlrev_b32 v226, 16, v128
    v_and_b32 v227, 0xffff0000, v128
    v_lshlrev_b32 v228, 16, v132
    v_and_b32 v229, 0xffff0000, v132
    v_lshlrev_b32 v230, 16, v136
    v_and_b32 v231, 0xffff0000, v136
    v_lshlrev_b32 v232, 16, v140
    v_and_b32 v233, 0xffff0000, v140
    v_lshlrev_b32 v234, 16, v144
    v_and_b32 v235, 0xffff0000, v144
    v_lshlrev_b32 v236, 16, v148
    v_and_b32 v237, 0xffff0000, v148
    v_pk_mul_f32 v[216:217], v[216:217], v[190:191]
    v_lshlrev_b32 v238, 16, v152
    v_pk_fma_f32 v[216:217], v[218:219], v[188:189], v[216:217]
    v_and_b32 v239, 0xffff0000, v152
    v_pk_fma_f32 v[216:217], v[220:221], v[186:187], v[216:217]
    v_pk_fma_f32 v[216:217], v[222:223], v[184:185], v[216:217]
    v_pk_mul_f32 v[216:217], v[216:217], v[238:239]
    v_pk_mul_f32 v[218:219], v[218:219], v[190:191]
    v_lshlrev_b32 v240, 16, v156
    v_pk_fma_f32 v[218:219], v[220:221], v[188:189], v[218:219]
    v_and_b32 v241, 0xffff0000, v156
    v_pk_fma_f32 v[218:219], v[222:223], v[186:187], v[218:219]
    v_pk_fma_f32 v[218:219], v[224:225], v[184:185], v[218:219]
    v_pk_mul_f32 v[218:219], v[218:219], v[240:241]
    v_pk_mul_f32 v[220:221], v[220:221], v[190:191]
    v_lshlrev_b32 v238, 16, v160
    v_pk_fma_f32 v[220:221], v[222:223], v[188:189], v[220:221]
    v_and_b32 v239, 0xffff0000, v160
    v_pk_fma_f32 v[220:221], v[224:225], v[186:187], v[220:221]
    v_pk_fma_f32 v[220:221], v[226:227], v[184:185], v[220:221]
    v_pk_mul_f32 v[220:221], v[220:221], v[238:239]
    v_pk_mul_f32 v[222:223], v[222:223], v[190:191]
    v_lshlrev_b32 v240, 16, v164
    v_pk_fma_f32 v[222:223], v[224:225], v[188:189], v[222:223]
    v_and_b32 v241, 0xffff0000, v164
    v_pk_fma_f32 v[222:223], v[226:227], v[186:187], v[222:223]
    v_pk_fma_f32 v[222:223], v[228:229], v[184:185], v[222:223]
    v_pk_mul_f32 v[222:223], v[222:223], v[240:241]
    v_pk_mul_f32 v[224:225], v[224:225], v[190:191]
    v_lshlrev_b32 v238, 16, v168
    v_pk_fma_f32 v[224:225], v[226:227], v[188:189], v[224:225]
    v_and_b32 v239, 0xffff0000, v168
    v_pk_fma_f32 v[224:225], v[228:229], v[186:187], v[224:225]
    v_pk_fma_f32 v[224:225], v[230:231], v[184:185], v[224:225]
    v_pk_mul_f32 v[224:225], v[224:225], v[238:239]
    v_pk_mul_f32 v[226:227], v[226:227], v[190:191]
    v_lshlrev_b32 v240, 16, v172
    v_pk_fma_f32 v[226:227], v[228:229], v[188:189], v[226:227]
    v_and_b32 v241, 0xffff0000, v172
    v_pk_fma_f32 v[226:227], v[230:231], v[186:187], v[226:227]
    v_pk_fma_f32 v[226:227], v[232:233], v[184:185], v[226:227]
    v_pk_mul_f32 v[226:227], v[226:227], v[240:241]
    v_pk_mul_f32 v[228:229], v[228:229], v[190:191]
    v_lshlrev_b32 v238, 16, v176
    v_pk_fma_f32 v[228:229], v[230:231], v[188:189], v[228:229]
    v_and_b32 v239, 0xffff0000, v176
    v_pk_fma_f32 v[228:229], v[232:233], v[186:187], v[228:229]
    v_pk_fma_f32 v[228:229], v[234:235], v[184:185], v[228:229]
    v_pk_mul_f32 v[228:229], v[228:229], v[238:239]
    v_pk_mul_f32 v[230:231], v[230:231], v[190:191]
    v_lshlrev_b32 v240, 16, v180
    v_pk_fma_f32 v[230:231], v[232:233], v[188:189], v[230:231]
    v_and_b32 v241, 0xffff0000, v180
    v_pk_fma_f32 v[230:231], v[234:235], v[186:187], v[230:231]
    v_pk_fma_f32 v[230:231], v[236:237], v[184:185], v[230:231]
    v_pk_mul_f32 v[230:231], v[230:231], v[240:241]
    v_cvt_pk_bf16_f32 v242, v230, v228
    v_cvt_pk_bf16_f32 v243, v226, v224
    v_cvt_pk_bf16_f32 v244, v222, v220
    v_cvt_pk_bf16_f32 v245, v218, v216
    ds_write_b128 v12, v[242:245] offset:0
    v_cvt_pk_bf16_f32 v246, v231, v229
    v_cvt_pk_bf16_f32 v247, v227, v225
    v_cvt_pk_bf16_f32 v248, v223, v221
    v_cvt_pk_bf16_f32 v249, v219, v217
    ds_write_b128 v12, v[246:249] offset:128
    v_lshlrev_b32 v216, 16, v109
    v_and_b32 v217, 0xffff0000, v109
    v_lshlrev_b32 v218, 16, v113
    v_and_b32 v219, 0xffff0000, v113
    v_lshlrev_b32 v220, 16, v117
    v_and_b32 v221, 0xffff0000, v117
    v_lshlrev_b32 v222, 16, v121
    v_and_b32 v223, 0xffff0000, v121
    v_lshlrev_b32 v224, 16, v125
    v_and_b32 v225, 0xffff0000, v125
    v_lshlrev_b32 v226, 16, v129
    v_and_b32 v227, 0xffff0000, v129
    v_lshlrev_b32 v228, 16, v133
    v_and_b32 v229, 0xffff0000, v133
    v_lshlrev_b32 v230, 16, v137
    v_and_b32 v231, 0xffff0000, v137
    v_lshlrev_b32 v232, 16, v141
    v_and_b32 v233, 0xffff0000, v141
    v_lshlrev_b32 v234, 16, v145
    v_and_b32 v235, 0xffff0000, v145
    v_lshlrev_b32 v236, 16, v149
    v_and_b32 v237, 0xffff0000, v149
    v_pk_mul_f32 v[216:217], v[216:217], v[198:199]
    v_lshlrev_b32 v238, 16, v153
    v_pk_fma_f32 v[216:217], v[218:219], v[196:197], v[216:217]
    v_and_b32 v239, 0xffff0000, v153
    v_pk_fma_f32 v[216:217], v[220:221], v[194:195], v[216:217]
    v_pk_fma_f32 v[216:217], v[222:223], v[192:193], v[216:217]
    v_pk_mul_f32 v[216:217], v[216:217], v[238:239]
    v_pk_mul_f32 v[218:219], v[218:219], v[198:199]
    v_lshlrev_b32 v240, 16, v157
    v_pk_fma_f32 v[218:219], v[220:221], v[196:197], v[218:219]
    v_and_b32 v241, 0xffff0000, v157
    v_pk_fma_f32 v[218:219], v[222:223], v[194:195], v[218:219]
    v_pk_fma_f32 v[218:219], v[224:225], v[192:193], v[218:219]
    v_pk_mul_f32 v[218:219], v[218:219], v[240:241]
    v_pk_mul_f32 v[220:221], v[220:221], v[198:199]
    v_lshlrev_b32 v238, 16, v161
    v_pk_fma_f32 v[220:221], v[222:223], v[196:197], v[220:221]
    v_and_b32 v239, 0xffff0000, v161
    v_pk_fma_f32 v[220:221], v[224:225], v[194:195], v[220:221]
    v_pk_fma_f32 v[220:221], v[226:227], v[192:193], v[220:221]
    v_pk_mul_f32 v[220:221], v[220:221], v[238:239]
    v_pk_mul_f32 v[222:223], v[222:223], v[198:199]
    v_lshlrev_b32 v240, 16, v165
    v_pk_fma_f32 v[222:223], v[224:225], v[196:197], v[222:223]
    v_and_b32 v241, 0xffff0000, v165
    v_pk_fma_f32 v[222:223], v[226:227], v[194:195], v[222:223]
    v_pk_fma_f32 v[222:223], v[228:229], v[192:193], v[222:223]
    v_pk_mul_f32 v[222:223], v[222:223], v[240:241]
    v_pk_mul_f32 v[224:225], v[224:225], v[198:199]
    v_lshlrev_b32 v238, 16, v169
    v_pk_fma_f32 v[224:225], v[226:227], v[196:197], v[224:225]
    v_and_b32 v239, 0xffff0000, v169
    v_pk_fma_f32 v[224:225], v[228:229], v[194:195], v[224:225]
    v_pk_fma_f32 v[224:225], v[230:231], v[192:193], v[224:225]
    v_pk_mul_f32 v[224:225], v[224:225], v[238:239]
    v_pk_mul_f32 v[226:227], v[226:227], v[198:199]
    v_lshlrev_b32 v240, 16, v173
    v_pk_fma_f32 v[226:227], v[228:229], v[196:197], v[226:227]
    v_and_b32 v241, 0xffff0000, v173
    v_pk_fma_f32 v[226:227], v[230:231], v[194:195], v[226:227]
    v_pk_fma_f32 v[226:227], v[232:233], v[192:193], v[226:227]
    v_pk_mul_f32 v[226:227], v[226:227], v[240:241]
    v_pk_mul_f32 v[228:229], v[228:229], v[198:199]
    v_lshlrev_b32 v238, 16, v177
    v_pk_fma_f32 v[228:229], v[230:231], v[196:197], v[228:229]
    v_and_b32 v239, 0xffff0000, v177
    v_pk_fma_f32 v[228:229], v[232:233], v[194:195], v[228:229]
    v_pk_fma_f32 v[228:229], v[234:235], v[192:193], v[228:229]
    v_pk_mul_f32 v[228:229], v[228:229], v[238:239]
    v_pk_mul_f32 v[230:231], v[230:231], v[198:199]
    v_lshlrev_b32 v240, 16, v181
    v_pk_fma_f32 v[230:231], v[232:233], v[196:197], v[230:231]
    v_and_b32 v241, 0xffff0000, v181
    v_pk_fma_f32 v[230:231], v[234:235], v[194:195], v[230:231]
    v_pk_fma_f32 v[230:231], v[236:237], v[192:193], v[230:231]
    v_pk_mul_f32 v[230:231], v[230:231], v[240:241]
    v_cvt_pk_bf16_f32 v242, v230, v228
    v_cvt_pk_bf16_f32 v243, v226, v224
    v_cvt_pk_bf16_f32 v244, v222, v220
    v_cvt_pk_bf16_f32 v245, v218, v216
    ds_write_b128 v12, v[242:245] offset:256
    v_cvt_pk_bf16_f32 v246, v231, v229
    v_cvt_pk_bf16_f32 v247, v227, v225
    v_cvt_pk_bf16_f32 v248, v223, v221
    v_cvt_pk_bf16_f32 v249, v219, v217
    ds_write_b128 v12, v[246:249] offset:384
    v_lshlrev_b32 v216, 16, v110
    v_and_b32 v217, 0xffff0000, v110
    v_lshlrev_b32 v218, 16, v114
    v_and_b32 v219, 0xffff0000, v114
    v_lshlrev_b32 v220, 16, v118
    v_and_b32 v221, 0xffff0000, v118
    v_lshlrev_b32 v222, 16, v122
    v_and_b32 v223, 0xffff0000, v122
    v_lshlrev_b32 v224, 16, v126
    v_and_b32 v225, 0xffff0000, v126
    v_lshlrev_b32 v226, 16, v130
    v_and_b32 v227, 0xffff0000, v130
    v_lshlrev_b32 v228, 16, v134
    v_and_b32 v229, 0xffff0000, v134
    v_lshlrev_b32 v230, 16, v138
    v_and_b32 v231, 0xffff0000, v138
    v_lshlrev_b32 v232, 16, v142
    v_and_b32 v233, 0xffff0000, v142
    v_lshlrev_b32 v234, 16, v146
    v_and_b32 v235, 0xffff0000, v146
    v_lshlrev_b32 v236, 16, v150
    v_and_b32 v237, 0xffff0000, v150
    v_pk_mul_f32 v[216:217], v[216:217], v[206:207]
    v_lshlrev_b32 v238, 16, v154
    v_pk_fma_f32 v[216:217], v[218:219], v[204:205], v[216:217]
    v_and_b32 v239, 0xffff0000, v154
    v_pk_fma_f32 v[216:217], v[220:221], v[202:203], v[216:217]
    v_pk_fma_f32 v[216:217], v[222:223], v[200:201], v[216:217]
    v_pk_mul_f32 v[216:217], v[216:217], v[238:239]
    v_pk_mul_f32 v[218:219], v[218:219], v[206:207]
    v_lshlrev_b32 v240, 16, v158
    v_pk_fma_f32 v[218:219], v[220:221], v[204:205], v[218:219]
    v_and_b32 v241, 0xffff0000, v158
    v_pk_fma_f32 v[218:219], v[222:223], v[202:203], v[218:219]
    v_pk_fma_f32 v[218:219], v[224:225], v[200:201], v[218:219]
    v_pk_mul_f32 v[218:219], v[218:219], v[240:241]
    v_pk_mul_f32 v[220:221], v[220:221], v[206:207]
    v_lshlrev_b32 v238, 16, v162
    v_pk_fma_f32 v[220:221], v[222:223], v[204:205], v[220:221]
    v_and_b32 v239, 0xffff0000, v162
    v_pk_fma_f32 v[220:221], v[224:225], v[202:203], v[220:221]
    v_pk_fma_f32 v[220:221], v[226:227], v[200:201], v[220:221]
    v_pk_mul_f32 v[220:221], v[220:221], v[238:239]
    v_pk_mul_f32 v[222:223], v[222:223], v[206:207]
    v_lshlrev_b32 v240, 16, v166
    v_pk_fma_f32 v[222:223], v[224:225], v[204:205], v[222:223]
    v_and_b32 v241, 0xffff0000, v166
    v_pk_fma_f32 v[222:223], v[226:227], v[202:203], v[222:223]
    v_pk_fma_f32 v[222:223], v[228:229], v[200:201], v[222:223]
    v_pk_mul_f32 v[222:223], v[222:223], v[240:241]
    v_pk_mul_f32 v[224:225], v[224:225], v[206:207]
    v_lshlrev_b32 v238, 16, v170
    v_pk_fma_f32 v[224:225], v[226:227], v[204:205], v[224:225]
    v_and_b32 v239, 0xffff0000, v170
    v_pk_fma_f32 v[224:225], v[228:229], v[202:203], v[224:225]
    v_pk_fma_f32 v[224:225], v[230:231], v[200:201], v[224:225]
    v_pk_mul_f32 v[224:225], v[224:225], v[238:239]
    v_pk_mul_f32 v[226:227], v[226:227], v[206:207]
    v_lshlrev_b32 v240, 16, v174
    v_pk_fma_f32 v[226:227], v[228:229], v[204:205], v[226:227]
    v_and_b32 v241, 0xffff0000, v174
    v_pk_fma_f32 v[226:227], v[230:231], v[202:203], v[226:227]
    v_pk_fma_f32 v[226:227], v[232:233], v[200:201], v[226:227]
    v_pk_mul_f32 v[226:227], v[226:227], v[240:241]
    v_pk_mul_f32 v[228:229], v[228:229], v[206:207]
    v_lshlrev_b32 v238, 16, v178
    v_pk_fma_f32 v[228:229], v[230:231], v[204:205], v[228:229]
    v_and_b32 v239, 0xffff0000, v178
    v_pk_fma_f32 v[228:229], v[232:233], v[202:203], v[228:229]
    v_pk_fma_f32 v[228:229], v[234:235], v[200:201], v[228:229]
    v_pk_mul_f32 v[228:229], v[228:229], v[238:239]
    v_pk_mul_f32 v[230:231], v[230:231], v[206:207]
    v_lshlrev_b32 v240, 16, v182
    v_pk_fma_f32 v[230:231], v[232:233], v[204:205], v[230:231]
    v_and_b32 v241, 0xffff0000, v182
    v_pk_fma_f32 v[230:231], v[234:235], v[202:203], v[230:231]
    v_pk_fma_f32 v[230:231], v[236:237], v[200:201], v[230:231]
    v_pk_mul_f32 v[230:231], v[230:231], v[240:241]
    v_cvt_pk_bf16_f32 v242, v230, v228
    v_cvt_pk_bf16_f32 v243, v226, v224
    v_cvt_pk_bf16_f32 v244, v222, v220
    v_cvt_pk_bf16_f32 v245, v218, v216
    ds_write_b128 v12, v[242:245] offset:512
    v_cvt_pk_bf16_f32 v246, v231, v229
    v_cvt_pk_bf16_f32 v247, v227, v225
    v_cvt_pk_bf16_f32 v248, v223, v221
    v_cvt_pk_bf16_f32 v249, v219, v217
    ds_write_b128 v12, v[246:249] offset:640
    v_lshlrev_b32 v216, 16, v111
    v_and_b32 v217, 0xffff0000, v111
    v_lshlrev_b32 v218, 16, v115
    v_and_b32 v219, 0xffff0000, v115
    v_lshlrev_b32 v220, 16, v119
    v_and_b32 v221, 0xffff0000, v119
    v_lshlrev_b32 v222, 16, v123
    v_and_b32 v223, 0xffff0000, v123
    v_lshlrev_b32 v224, 16, v127
    v_and_b32 v225, 0xffff0000, v127
    v_lshlrev_b32 v226, 16, v131
    v_and_b32 v227, 0xffff0000, v131
    v_lshlrev_b32 v228, 16, v135
    v_and_b32 v229, 0xffff0000, v135
    v_lshlrev_b32 v230, 16, v139
    v_and_b32 v231, 0xffff0000, v139
    v_lshlrev_b32 v232, 16, v143
    v_and_b32 v233, 0xffff0000, v143
    v_lshlrev_b32 v234, 16, v147
    v_and_b32 v235, 0xffff0000, v147
    v_lshlrev_b32 v236, 16, v151
    v_and_b32 v237, 0xffff0000, v151
    v_pk_mul_f32 v[216:217], v[216:217], v[214:215]
    v_lshlrev_b32 v238, 16, v155
    v_pk_fma_f32 v[216:217], v[218:219], v[212:213], v[216:217]
    v_and_b32 v239, 0xffff0000, v155
    v_pk_fma_f32 v[216:217], v[220:221], v[210:211], v[216:217]
    v_pk_fma_f32 v[216:217], v[222:223], v[208:209], v[216:217]
    v_pk_mul_f32 v[216:217], v[216:217], v[238:239]
    v_pk_mul_f32 v[218:219], v[218:219], v[214:215]
    v_lshlrev_b32 v240, 16, v159
    v_pk_fma_f32 v[218:219], v[220:221], v[212:213], v[218:219]
    v_and_b32 v241, 0xffff0000, v159
    v_pk_fma_f32 v[218:219], v[222:223], v[210:211], v[218:219]
    v_pk_fma_f32 v[218:219], v[224:225], v[208:209], v[218:219]
    v_pk_mul_f32 v[218:219], v[218:219], v[240:241]
    v_pk_mul_f32 v[220:221], v[220:221], v[214:215]
    v_lshlrev_b32 v238, 16, v163
    v_pk_fma_f32 v[220:221], v[222:223], v[212:213], v[220:221]
    v_and_b32 v239, 0xffff0000, v163
    v_pk_fma_f32 v[220:221], v[224:225], v[210:211], v[220:221]
    v_pk_fma_f32 v[220:221], v[226:227], v[208:209], v[220:221]
    v_pk_mul_f32 v[220:221], v[220:221], v[238:239]
    v_pk_mul_f32 v[222:223], v[222:223], v[214:215]
    v_lshlrev_b32 v240, 16, v167
    v_pk_fma_f32 v[222:223], v[224:225], v[212:213], v[222:223]
    v_and_b32 v241, 0xffff0000, v167
    v_pk_fma_f32 v[222:223], v[226:227], v[210:211], v[222:223]
    v_pk_fma_f32 v[222:223], v[228:229], v[208:209], v[222:223]
    v_pk_mul_f32 v[222:223], v[222:223], v[240:241]
    v_pk_mul_f32 v[224:225], v[224:225], v[214:215]
    v_lshlrev_b32 v238, 16, v171
    v_pk_fma_f32 v[224:225], v[226:227], v[212:213], v[224:225]
    v_and_b32 v239, 0xffff0000, v171
    v_pk_fma_f32 v[224:225], v[228:229], v[210:211], v[224:225]
    v_pk_fma_f32 v[224:225], v[230:231], v[208:209], v[224:225]
    v_pk_mul_f32 v[224:225], v[224:225], v[238:239]
    v_pk_mul_f32 v[226:227], v[226:227], v[214:215]
    v_lshlrev_b32 v240, 16, v175
    v_pk_fma_f32 v[226:227], v[228:229], v[212:213], v[226:227]
    v_and_b32 v241, 0xffff0000, v175
    v_pk_fma_f32 v[226:227], v[230:231], v[210:211], v[226:227]
    v_pk_fma_f32 v[226:227], v[232:233], v[208:209], v[226:227]
    v_pk_mul_f32 v[226:227], v[226:227], v[240:241]
    v_pk_mul_f32 v[228:229], v[228:229], v[214:215]
    v_lshlrev_b32 v238, 16, v179
    v_pk_fma_f32 v[228:229], v[230:231], v[212:213], v[228:229]
    v_and_b32 v239, 0xffff0000, v179
    v_pk_fma_f32 v[228:229], v[232:233], v[210:211], v[228:229]
    v_pk_fma_f32 v[228:229], v[234:235], v[208:209], v[228:229]
    v_pk_mul_f32 v[228:229], v[228:229], v[238:239]
    v_pk_mul_f32 v[230:231], v[230:231], v[214:215]
    v_lshlrev_b32 v240, 16, v183
    v_pk_fma_f32 v[230:231], v[232:233], v[212:213], v[230:231]
    v_and_b32 v241, 0xffff0000, v183
    v_pk_fma_f32 v[230:231], v[234:235], v[210:211], v[230:231]
    v_pk_fma_f32 v[230:231], v[236:237], v[208:209], v[230:231]
    v_pk_mul_f32 v[230:231], v[230:231], v[240:241]
    v_cvt_pk_bf16_f32 v242, v230, v228
    v_cvt_pk_bf16_f32 v243, v226, v224
    v_cvt_pk_bf16_f32 v244, v222, v220
    v_cvt_pk_bf16_f32 v245, v218, v216
    ds_write_b128 v12, v[242:245] offset:768
    v_cvt_pk_bf16_f32 v246, v231, v229
    v_cvt_pk_bf16_f32 v247, v227, v225
    v_cvt_pk_bf16_f32 v248, v223, v221
    v_cvt_pk_bf16_f32 v249, v219, v217
    ds_write_b128 v12, v[246:249] offset:896
    v_lshlrev_b32 v12, 4, v1
    v_add_u32 v13, s5, v12
    s_lshl_b32 s4, s24, 20
    s_lshl_b32 s5, s99, 11
    s_add_u32 s4, s4, s5
    s_add_u32 s4, s4, 125829120
    s_waitcnt lgkmcnt(0)
    ds_read_b128 v[32:35], v13 offset:0
    ds_read_b128 v[36:39], v13 offset:1024
    ds_read_b128 v[40:43], v13 offset:2048
    ds_read_b128 v[44:47], v13 offset:3072
    ds_read_b128 v[48:51], v13 offset:4096
    ds_read_b128 v[52:55], v13 offset:5120
    ds_read_b128 v[56:59], v13 offset:6144
    ds_read_b128 v[60:63], v13 offset:7168
    ds_read_b128 v[64:67], v13 offset:8192
    ds_read_b128 v[68:71], v13 offset:9216
    ds_read_b128 v[72:75], v13 offset:10240
    ds_read_b128 v[76:79], v13 offset:11264
    ds_read_b128 v[80:83], v13 offset:12288
    ds_read_b128 v[84:87], v13 offset:13312
    ds_read_b128 v[88:91], v13 offset:14336
    ds_read_b128 v[92:95], v13 offset:15360
    ds_read_b128 v[96:99], v13 offset:16384
    ds_read_b128 v[100:103], v13 offset:17408
    ds_read_b128 v[104:107], v13 offset:18432
    ds_read_b128 v[108:111], v13 offset:19456
    ds_read_b128 v[112:115], v13 offset:20480
    ds_read_b128 v[116:119], v13 offset:21504
    ds_read_b128 v[120:123], v13 offset:22528
    ds_read_b128 v[124:127], v13 offset:23552
    ds_read_b128 v[128:131], v13 offset:24576
    ds_read_b128 v[132:135], v13 offset:25600
    ds_read_b128 v[136:139], v13 offset:26624
    ds_read_b128 v[140:143], v13 offset:27648
    ds_read_b128 v[144:147], v13 offset:28672
    ds_read_b128 v[148:151], v13 offset:29696
    ds_read_b128 v[152:155], v13 offset:30720
    ds_read_b128 v[156:159], v13 offset:31744
    s_waitcnt lgkmcnt(15)
    buffer_store_dwordx4 v[32:35], v12, s[8:11], s4 offen offset:0 sc1
    buffer_store_dwordx4 v[36:39], v12, s[8:11], s4 offen offset:1024 sc1
    s_add_u32 s4, s4, 0x10000
    buffer_store_dwordx4 v[40:43], v12, s[8:11], s4 offen offset:0 sc1
    buffer_store_dwordx4 v[44:47], v12, s[8:11], s4 offen offset:1024 sc1
    s_add_u32 s4, s4, 0x10000
    buffer_store_dwordx4 v[48:51], v12, s[8:11], s4 offen offset:0 sc1
    buffer_store_dwordx4 v[52:55], v12, s[8:11], s4 offen offset:1024 sc1
    s_add_u32 s4, s4, 0x10000
    buffer_store_dwordx4 v[56:59], v12, s[8:11], s4 offen offset:0 sc1
    buffer_store_dwordx4 v[60:63], v12, s[8:11], s4 offen offset:1024 sc1
    s_add_u32 s4, s4, 0x10000
    buffer_store_dwordx4 v[64:67], v12, s[8:11], s4 offen offset:0 sc1
    buffer_store_dwordx4 v[68:71], v12, s[8:11], s4 offen offset:1024 sc1
    s_add_u32 s4, s4, 0x10000
    buffer_store_dwordx4 v[72:75], v12, s[8:11], s4 offen offset:0 sc1
    buffer_store_dwordx4 v[76:79], v12, s[8:11], s4 offen offset:1024 sc1
    s_add_u32 s4, s4, 0x10000
    buffer_store_dwordx4 v[80:83], v12, s[8:11], s4 offen offset:0 sc1
    buffer_store_dwordx4 v[84:87], v12, s[8:11], s4 offen offset:1024 sc1
    s_add_u32 s4, s4, 0x10000
    buffer_store_dwordx4 v[88:91], v12, s[8:11], s4 offen offset:0 sc1
    buffer_store_dwordx4 v[92:95], v12, s[8:11], s4 offen offset:1024 sc1
    s_add_u32 s4, s4, 0x10000
    s_waitcnt lgkmcnt(15)
    buffer_store_dwordx4 v[96:99], v12, s[8:11], s4 offen offset:0 sc1
    s_waitcnt lgkmcnt(14)
    buffer_store_dwordx4 v[100:103], v12, s[8:11], s4 offen offset:1024 sc1
    s_add_u32 s4, s4, 0x10000
    s_waitcnt lgkmcnt(13)
    buffer_store_dwordx4 v[104:107], v12, s[8:11], s4 offen offset:0 sc1
    s_waitcnt lgkmcnt(12)
    buffer_store_dwordx4 v[108:111], v12, s[8:11], s4 offen offset:1024 sc1
    s_add_u32 s4, s4, 0x10000
    s_waitcnt lgkmcnt(11)
    buffer_store_dwordx4 v[112:115], v12, s[8:11], s4 offen offset:0 sc1
    s_waitcnt lgkmcnt(10)
    buffer_store_dwordx4 v[116:119], v12, s[8:11], s4 offen offset:1024 sc1
    s_add_u32 s4, s4, 0x10000
    s_waitcnt lgkmcnt(9)
    buffer_store_dwordx4 v[120:123], v12, s[8:11], s4 offen offset:0 sc1
    s_waitcnt lgkmcnt(8)
    buffer_store_dwordx4 v[124:127], v12, s[8:11], s4 offen offset:1024 sc1
    s_add_u32 s4, s4, 0x10000
    s_waitcnt lgkmcnt(7)
    buffer_store_dwordx4 v[128:131], v12, s[8:11], s4 offen offset:0 sc1
    s_waitcnt lgkmcnt(6)
    buffer_store_dwordx4 v[132:135], v12, s[8:11], s4 offen offset:1024 sc1
    s_add_u32 s4, s4, 0x10000
    s_waitcnt lgkmcnt(5)
    buffer_store_dwordx4 v[136:139], v12, s[8:11], s4 offen offset:0 sc1
    s_waitcnt lgkmcnt(4)
    buffer_store_dwordx4 v[140:143], v12, s[8:11], s4 offen offset:1024 sc1
    s_add_u32 s4, s4, 0x10000
    s_waitcnt lgkmcnt(3)
    buffer_store_dwordx4 v[144:147], v12, s[8:11], s4 offen offset:0 sc1
    s_waitcnt lgkmcnt(2)
    buffer_store_dwordx4 v[148:151], v12, s[8:11], s4 offen offset:1024 sc1
    s_add_u32 s4, s4, 0x10000
    s_waitcnt lgkmcnt(1)
    buffer_store_dwordx4 v[152:155], v12, s[8:11], s4 offen offset:0 sc1
    s_waitcnt lgkmcnt(0)
    buffer_store_dwordx4 v[156:159], v12, s[8:11], s4 offen offset:1024 sc1
    s_add_u32 s4, s4, 0x10000
    s_lshl_b32 s4, s99, 7
    s_lshl_b32 s5, s24, 2
    s_add_u32 s4, s4, s5
    s_add_u32 s4, s4, 92344320
    v_mov_b32 v12, 1
    v_mov_b32 v13, 0
    s_waitcnt vmcnt(0)
    s_mov_b64 exec, 1
    buffer_store_dword v12, v13, s[8:11], s4 offen sc1
    s_mov_b64 exec, -1
    s_barrier
    s_lshl_b32 s30, s99, 14
    s_lshl_b32 s4, s24, 12
    s_add_u32 s30, s30, s4
    s_add_u32 s30, s30, 77070336
.cold_522:
    s_mov_b32 s62, 0
.gp_526:
    buffer_load_dwordx4 v[12:15], v7, s[8:11], 0 offen sc1
    s_add_u32 s62, s62, 1
    s_cmp_gt_u32 s62, 0x200000
    s_cbranch_scc1 .mg_end_1
    s_waitcnt vmcnt(0)
    v_min3_u32 v4, v12, v13, v14
    v_min_u32 v4, v4, v15
    s_nop 1
    v_min_u32_dpp v4, v4, v4 quad_perm:[1,0,3,2] row_mask:0xf bank_mask:0xf
    s_nop 1
    v_min_u32_dpp v4, v4, v4 quad_perm:[2,3,0,1] row_mask:0xf bank_mask:0xf
    s_nop 1
    v_min_u32_dpp v4, v4, v4 row_half_mirror row_mask:0xf bank_mask:0xf
    s_nop 1
    v_readfirstlane_b32 s33, v4
    s_cmp_gt_u32 s33, s28
    s_cbranch_scc1 .go_523
    s_sleep 1
    s_branch .gp_526
.go_523:
    s_add_u32 m0, s36, 0
    s_add_u32 s31, s29, 0
    buffer_load_dwordx4 v9, s[8:11], s31 offen offset:0 sc1 lds
    buffer_load_dwordx4 v9, s[8:11], s31 offen offset:1024 sc1 lds
    buffer_load_dwordx4 v9, s[8:11], s31 offen offset:2048 sc1 lds
    buffer_load_dwordx4 v9, s[8:11], s31 offen offset:3072 sc1 lds
    s_add_u32 m0, s36, 16384
    s_add_u32 s31, s29, 16384
    buffer_load_dwordx4 v9, s[8:11], s31 offen offset:0 sc1 lds
    buffer_load_dwordx4 v9, s[8:11], s31 offen offset:1024 sc1 lds
    buffer_load_dwordx4 v9, s[8:11], s31 offen offset:2048 sc1 lds
    buffer_load_dwordx4 v9, s[8:11], s31 offen offset:3072 sc1 lds
.body_524:
    s_waitcnt vmcnt(4)
    s_barrier
    ds_read_b128 v[64:67], v8 offset:0
    ds_read_b128 v[68:71], v8 offset:4096
    ds_read_b128 v[72:75], v8 offset:1024
    ds_read_b128 v[76:79], v8 offset:5120
    ds_read_b128 v[80:83], v8 offset:2048
    ds_read_b128 v[84:87], v8 offset:6144
    ds_read_b128 v[88:91], v8 offset:3072
    ds_read_b128 v[92:95], v8 offset:7168
    s_waitcnt lgkmcnt(6)
    v_mfma_f32_16x16x32_bf16 v[192:195], a[0:3], v[64:67], 0
    s_add_u32 m0, s36, 32768
    s_add_u32 s31, s29, 32768
    v_mfma_f32_16x16x32_bf16 v[196:199], a[4:7], v[64:67], 0
    buffer_load_dwordx4 v9, s[8:11], s31 offen offset:0 sc1 lds
    v_mfma_f32_16x16x32_bf16 v[200:203], a[0:3], v[68:71], 0
    ds_read_b128 v[96:99], v8 offset:8192
    ds_read_b128 v[100:103], v8 offset:12288
    v_mfma_f32_16x16x32_bf16 v[204:207], a[4:7], v[68:71], 0
    ds_read_b128 v[104:107], v8 offset:9216
    s_waitcnt lgkmcnt(7)
    v_mfma_f32_16x16x32_bf16 v[192:195], a[8:11], v[72:75], v[192:195]
    ds_read_b128 v[108:111], v8 offset:13312
    ds_read_b128 v[112:115], v8 offset:10240
    v_mfma_f32_16x16x32_bf16 v[196:199], a[12:15], v[72:75], v[196:199]
    buffer_load_dwordx4 v9, s[8:11], s31 offen offset:1024 sc1 lds
    v_mfma_f32_16x16x32_bf16 v[200:203], a[8:11], v[76:79], v[200:203]
    ds_read_b128 v[116:119], v8 offset:14336
    ds_read_b128 v[120:123], v8 offset:11264
    v_mfma_f32_16x16x32_bf16 v[204:207], a[12:15], v[76:79], v[204:207]
    ds_read_b128 v[124:127], v8 offset:15360
    s_waitcnt lgkmcnt(10)
    v_mfma_f32_16x16x32_bf16 v[192:195], a[16:19], v[80:83], v[192:195]
    buffer_load_dwordx4 v9, s[8:11], s31 offen offset:2048 sc1 lds
    v_mfma_f32_16x16x32_bf16 v[196:199], a[20:23], v[80:83], v[196:199]
    v_mfma_f32_16x16x32_bf16 v[200:203], a[16:19], v[84:87], v[200:203]
    v_mfma_f32_16x16x32_bf16 v[204:207], a[20:23], v[84:87], v[204:207]
    s_waitcnt lgkmcnt(8)
    v_mfma_f32_16x16x32_bf16 v[192:195], a[24:27], v[88:91], v[192:195]
    buffer_load_dwordx4 v9, s[8:11], s31 offen offset:3072 sc1 lds
    v_mfma_f32_16x16x32_bf16 v[196:199], a[28:31], v[88:91], v[196:199]
    v_mfma_f32_16x16x32_bf16 v[200:203], a[24:27], v[92:95], v[200:203]
    s_waitcnt vmcnt(4)
    s_barrier
    v_mfma_f32_16x16x32_bf16 v[204:207], a[28:31], v[92:95], v[204:207]
    ds_read_b128 v[128:131], v8 offset:16384
    s_waitcnt lgkmcnt(5)
    v_mfma_f32_16x16x32_bf16 v[192:195], a[32:35], v[96:99], v[192:195]
    s_add_u32 m0, s36, 49152
    s_add_u32 s31, s29, 49152
    v_mfma_f32_16x16x32_bf16 v[196:199], a[36:39], v[96:99], v[196:199]
    buffer_load_dwordx4 v9, s[8:11], s31 offen offset:0 sc1 lds
    v_mfma_f32_16x16x32_bf16 v[200:203], a[32:35], v[100:103], v[200:203]
    ds_read_b128 v[132:135], v8 offset:20480
    ds_read_b128 v[136:139], v8 offset:17408
    v_mfma_f32_16x16x32_bf16 v[204:207], a[36:39], v[100:103], v[204:207]
    ds_read_b128 v[140:143], v8 offset:21504
    ds_read_b128 v[144:147], v8 offset:18432
    v_mfma_f32_16x16x32_bf16 v[192:195], a[40:43], v[104:107], v[192:195]
    buffer_load_dwordx4 v9, s[8:11], s31 offen offset:1024 sc1 lds
    v_mfma_f32_16x16x32_bf16 v[196:199], a[44:47], v[104:107], v[196:199]
    ds_read_b128 v[148:151], v8 offset:22528
    ds_read_b128 v[152:155], v8 offset:19456
    v_mfma_f32_16x16x32_bf16 v[200:203], a[40:43], v[108:111], v[200:203]
    ds_read_b128 v[156:159], v8 offset:23552
    ds_read_b128 v[160:163], v8 offset:24576
    v_mfma_f32_16x16x32_bf16 v[204:207], a[44:47], v[108:111], v[204:207]
    ds_read_b128 v[164:167], v8 offset:28672
    s_waitcnt lgkmcnt(10)
    v_mfma_f32_16x16x32_bf16 v[192:195], a[48:51], v[112:115], v[192:195]
    buffer_load_dwordx4 v9, s[8:11], s31 offen offset:2048 sc1 lds
    v_mfma_f32_16x16x32_bf16 v[196:199], a[52:55], v[112:115], v[196:199]
    ds_read_b128 v[168:171], v8 offset:25600
    ds_read_b128 v[172:175], v8 offset:29696
    v_mfma_f32_16x16x32_bf16 v[200:203], a[48:51], v[116:119], v[200:203]
    ds_read_b128 v[176:179], v8 offset:26624
    ds_read_b128 v[180:183], v8 offset:30720
    v_mfma_f32_16x16x32_bf16 v[204:207], a[52:55], v[116:119], v[204:207]
    buffer_load_dwordx4 v9, s[8:11], s31 offen offset:3072 sc1 lds
    v_mfma_f32_16x16x32_bf16 v[192:195], a[56:59], v[120:123], v[192:195]
    ds_read_b128 v[184:187], v8 offset:27648
    ds_read_b128 v[188:191], v8 offset:31744
    v_mfma_f32_16x16x32_bf16 v[196:199], a[60:63], v[120:123], v[196:199]
    buffer_load_dwordx4 v[12:15], v7, s[8:11], 0 offen sc1
    s_xor_b32 s36, s36, 0x10000
    v_mfma_f32_16x16x32_bf16 v[200:203], a[56:59], v[124:127], v[200:203]
    s_add_u32 s29, s29, 0x40000
    v_mfma_f32_16x16x32_bf16 v[204:207], a[60:63], v[124:127], v[204:207]
    s_waitcnt lgkmcnt(12)
    v_mfma_f32_16x16x32_bf16 v[192:195], a[64:67], v[128:131], v[192:195]
    s_sub_u32 s4, s28, 1
    s_max_i32 s4, s4, 0
    v_mfma_f32_16x16x32_bf16 v[196:199], a[68:71], v[128:131], v[196:199]
    v_mov_b32 v27, s4
    v_mfma_f32_16x16x32_bf16 v[200:203], a[64:67], v[132:135], v[200:203]
    s_mov_b64 exec, 1
    buffer_store_dword v27, v26, s[8:11], s94 offen sc1
    s_mov_b64 exec, -1
    v_mfma_f32_16x16x32_bf16 v[204:207], a[68:71], v[132:135], v[204:207]
    v_mfma_f32_16x16x32_bf16 v[192:195], a[72:75], v[136:139], v[192:195]
    buffer_store_dwordx4 v[208:211], v2, s[8:11], s30 offen offset:0 sc1
    v_mfma_f32_16x16x32_bf16 v[196:199], a[76:79], v[136:139], v[196:199]
    v_mfma_f32_16x16x32_bf16 v[200:203], a[72:75], v[140:143], v[200:203]
    buffer_store_dwordx4 v[212:215], v2, s[8:11], s30 offen offset:1024 sc1
    v_mfma_f32_16x16x32_bf16 v[204:207], a[76:79], v[140:143], v[204:207]
    s_xor_b32 s30, s28, s38
    s_waitcnt lgkmcnt(8)
    v_mfma_f32_16x16x32_bf16 v[192:195], a[80:83], v[144:147], v[192:195]
    s_lshl_b32 s30, s30, 11
    s_add_u32 s30, s30, s37
    v_mfma_f32_16x16x32_bf16 v[196:199], a[84:87], v[144:147], v[196:199]
    s_add_u32 s28, s28, 1
    v_mfma_f32_16x16x32_bf16 v[200:203], a[80:83], v[148:151], v[200:203]
    v_mfma_f32_16x16x32_bf16 v[204:207], a[84:87], v[148:151], v[204:207]
    v_mfma_f32_16x16x32_bf16 v[192:195], a[88:91], v[152:155], v[192:195]
    v_mfma_f32_16x16x32_bf16 v[196:199], a[92:95], v[152:155], v[196:199]
    v_mfma_f32_16x16x32_bf16 v[200:203], a[88:91], v[156:159], v[200:203]
    v_mfma_f32_16x16x32_bf16 v[204:207], a[92:95], v[156:159], v[204:207]
    s_waitcnt lgkmcnt(4)
    v_mfma_f32_16x16x32_bf16 v[192:195], a[96:99], v[160:163], v[192:195]
    v_mfma_f32_16x16x32_bf16 v[196:199], a[100:103], v[160:163], v[196:199]
    v_mfma_f32_16x16x32_bf16 v[200:203], a[96:99], v[164:167], v[200:203]
    s_waitcnt vmcnt(3)
    s_barrier
    v_mfma_f32_16x16x32_bf16 v[204:207], a[100:103], v[164:167], v[204:207]
    ds_read_b128 v[64:67], v8 offset:32768
    ds_read_b128 v[68:71], v8 offset:36864
    v_mfma_f32_16x16x32_bf16 v[192:195], a[104:107], v[168:171], v[192:195]
    ds_read_b128 v[72:75], v8 offset:33792
    ds_read_b128 v[76:79], v8 offset:37888
    v_mfma_f32_16x16x32_bf16 v[196:199], a[108:111], v[168:171], v[196:199]
    ds_read_b128 v[80:83], v8 offset:34816
    ds_read_b128 v[84:87], v8 offset:38912
    v_mfma_f32_16x16x32_bf16 v[200:203], a[104:107], v[172:175], v[200:203]
    ds_read_b128 v[88:91], v8 offset:35840
    ds_read_b128 v[92:95], v8 offset:39936
    v_mfma_f32_16x16x32_bf16 v[204:207], a[108:111], v[172:175], v[204:207]
    ds_read_b128 v[96:99], v8 offset:40960
    s_waitcnt lgkmcnt(9)
    v_mfma_f32_16x16x32_bf16 v[192:195], a[112:115], v[176:179], v[192:195]
    v_min3_u32 v4, v12, v13, v14
    v_min_u32 v4, v4, v15
    v_mfma_f32_16x16x32_bf16 v[196:199], a[116:119], v[176:179], v[196:199]
    ds_read_b128 v[100:103], v8 offset:45056
    ds_read_b128 v[104:107], v8 offset:41984
    v_mfma_f32_16x16x32_bf16 v[200:203], a[112:115], v[180:183], v[200:203]
    v_min_u32_dpp v4, v4, v4 quad_perm:[1,0,3,2] row_mask:0xf bank_mask:0xf
    ds_read_b128 v[108:111], v8 offset:46080
    v_mfma_f32_16x16x32_bf16 v[204:207], a[116:119], v[180:183], v[204:207]
    ds_read_b128 v[112:115], v8 offset:43008
    ds_read_b128 v[116:119], v8 offset:47104
    v_mfma_f32_16x16x32_bf16 v[192:195], a[120:123], v[184:187], v[192:195]
    v_min_u32_dpp v4, v4, v4 quad_perm:[2,3,0,1] row_mask:0xf bank_mask:0xf
    ds_read_b128 v[120:123], v8 offset:44032
    v_mfma_f32_16x16x32_bf16 v[196:199], a[124:127], v[184:187], v[196:199]
    ds_read_b128 v[124:127], v8 offset:48128
    ds_read_b128 v[128:131], v8 offset:49152
    v_mfma_f32_16x16x32_bf16 v[200:203], a[120:123], v[188:191], v[200:203]
    v_min_u32_dpp v4, v4, v4 row_half_mirror row_mask:0xf bank_mask:0xf
    ds_read_b128 v[132:135], v8 offset:53248
    v_mfma_f32_16x16x32_bf16 v[204:207], a[124:127], v[188:191], v[204:207]
    ds_read_b128 v[136:139], v8 offset:50176
    s_waitcnt lgkmcnt(15)
    v_mfma_f32_16x16x32_bf16 v[192:195], a[128:131], v[64:67], v[192:195]
    v_readfirstlane_b32 s33, v4
    ds_read_b128 v[140:143], v8 offset:54272
    v_mfma_f32_16x16x32_bf16 v[196:199], a[132:135], v[64:67], v[196:199]
    s_cmp_gt_u32 s33, s28
    s_cbranch_scc1 .hot_525
    v_mfma_f32_16x16x32_bf16 v[200:203], a[128:131], v[68:71], v[200:203]
    ds_read_b128 v[144:147], v8 offset:51200
    ds_read_b128 v[148:151], v8 offset:55296
    v_mfma_f32_16x16x32_bf16 v[204:207], a[132:135], v[68:71], v[204:207]
    ds_read_b128 v[152:155], v8 offset:52224
    ds_read_b128 v[156:159], v8 offset:56320
    v_mfma_f32_16x16x32_bf16 v[192:195], a[136:139], v[72:75], v[192:195]
    ds_read_b128 v[160:163], v8 offset:57344
    ds_read_b128 v[164:167], v8 offset:61440
    v_mfma_f32_16x16x32_bf16 v[196:199], a[140:143], v[72:75], v[196:199]
    ds_read_b128 v[168:171], v8 offset:58368
    ds_read_b128 v[172:175], v8 offset:62464
    v_mfma_f32_16x16x32_bf16 v[200:203], a[136:139], v[76:79], v[200:203]
    ds_read_b128 v[176:179], v8 offset:59392
    ds_read_b128 v[180:183], v8 offset:63488
    v_mfma_f32_16x16x32_bf16 v[204:207], a[140:143], v[76:79], v[204:207]
    ds_read_b128 v[184:187], v8 offset:60416
    s_waitcnt lgkmcnt(15)
    v_mfma_f32_16x16x32_bf16 v[192:195], a[144:147], v[80:83], v[192:195]
    ds_read_b128 v[188:191], v8 offset:64512
    v_xor_b32 v8, 0x10000, v8
    v_mfma_f32_16x16x32_bf16 v[196:199], a[148:151], v[80:83], v[196:199]
    v_mfma_f32_16x16x32_bf16 v[200:203], a[144:147], v[84:87], v[200:203]
    v_mfma_f32_16x16x32_bf16 v[204:207], a[148:151], v[84:87], v[204:207]
    v_mfma_f32_16x16x32_bf16 v[192:195], a[152:155], v[88:91], v[192:195]
    v_mfma_f32_16x16x32_bf16 v[196:199], a[156:159], v[88:91], v[196:199]
    v_mfma_f32_16x16x32_bf16 v[200:203], a[152:155], v[92:95], v[200:203]
    v_mfma_f32_16x16x32_bf16 v[204:207], a[156:159], v[92:95], v[204:207]
    v_mfma_f32_16x16x32_bf16 v[192:195], a[160:163], v[96:99], v[192:195]
    v_mfma_f32_16x16x32_bf16 v[196:199], a[164:167], v[96:99], v[196:199]
    v_mfma_f32_16x16x32_bf16 v[200:203], a[160:163], v[100:103], v[200:203]
    v_mfma_f32_16x16x32_bf16 v[204:207], a[164:167], v[100:103], v[204:207]
    v_mfma_f32_16x16x32_bf16 v[192:195], a[168:171], v[104:107], v[192:195]
    v_mfma_f32_16x16x32_bf16 v[196:199], a[172:175], v[104:107], v[196:199]
    v_mfma_f32_16x16x32_bf16 v[200:203], a[168:171], v[108:111], v[200:203]
    v_mfma_f32_16x16x32_bf16 v[204:207], a[172:175], v[108:111], v[204:207]
    v_mfma_f32_16x16x32_bf16 v[192:195], a[176:179], v[112:115], v[192:195]
    v_mfma_f32_16x16x32_bf16 v[196:199], a[180:183], v[112:115], v[196:199]
    v_mfma_f32_16x16x32_bf16 v[200:203], a[176:179], v[116:119], v[200:203]
    v_mfma_f32_16x16x32_bf16 v[204:207], a[180:183], v[116:119], v[204:207]
    v_mfma_f32_16x16x32_bf16 v[192:195], a[184:187], v[120:123], v[192:195]
    buffer_load_dwordx4 v[12:15], v7, s[8:11], 0 offen sc1
    v_mfma_f32_16x16x32_bf16 v[196:199], a[188:191], v[120:123], v[196:199]
    v_mfma_f32_16x16x32_bf16 v[200:203], a[184:187], v[124:127], v[200:203]
    v_mfma_f32_16x16x32_bf16 v[204:207], a[188:191], v[124:127], v[204:207]
    s_waitcnt lgkmcnt(12)
    v_mfma_f32_16x16x32_bf16 v[192:195], a[192:195], v[128:131], v[192:195]
    v_mfma_f32_16x16x32_bf16 v[196:199], a[196:199], v[128:131], v[196:199]
    v_mfma_f32_16x16x32_bf16 v[200:203], a[192:195], v[132:135], v[200:203]
    v_mfma_f32_16x16x32_bf16 v[204:207], a[196:199], v[132:135], v[204:207]
    v_mfma_f32_16x16x32_bf16 v[192:195], a[200:203], v[136:139], v[192:195]
    v_mfma_f32_16x16x32_bf16 v[196:199], a[204:207], v[136:139], v[196:199]
    v_mfma_f32_16x16x32_bf16 v[200:203], a[200:203], v[140:143], v[200:203]
    v_mfma_f32_16x16x32_bf16 v[204:207], a[204:207], v[140:143], v[204:207]
    s_waitcnt lgkmcnt(8)
    v_mfma_f32_16x16x32_bf16 v[192:195], a[208:211], v[144:147], v[192:195]
    v_mfma_f32_16x16x32_bf16 v[196:199], a[212:215], v[144:147], v[196:199]
    v_mfma_f32_16x16x32_bf16 v[200:203], a[208:211], v[148:151], v[200:203]
    v_mfma_f32_16x16x32_bf16 v[204:207], a[212:215], v[148:151], v[204:207]
    v_mfma_f32_16x16x32_bf16 v[192:195], a[216:219], v[152:155], v[192:195]
    v_mfma_f32_16x16x32_bf16 v[196:199], a[220:223], v[152:155], v[196:199]
    v_mfma_f32_16x16x32_bf16 v[200:203], a[216:219], v[156:159], v[200:203]
    v_mfma_f32_16x16x32_bf16 v[204:207], a[220:223], v[156:159], v[204:207]
    s_waitcnt lgkmcnt(4)
    v_mfma_f32_16x16x32_bf16 v[192:195], a[224:227], v[160:163], v[192:195]
    v_mfma_f32_16x16x32_bf16 v[196:199], a[228:231], v[160:163], v[196:199]
    v_mfma_f32_16x16x32_bf16 v[200:203], a[224:227], v[164:167], v[200:203]
    v_mfma_f32_16x16x32_bf16 v[204:207], a[228:231], v[164:167], v[204:207]
    v_mfma_f32_16x16x32_bf16 v[192:195], a[232:235], v[168:171], v[192:195]
    v_mfma_f32_16x16x32_bf16 v[196:199], a[236:239], v[168:171], v[196:199]
    v_mfma_f32_16x16x32_bf16 v[200:203], a[232:235], v[172:175], v[200:203]
    s_waitcnt vmcnt(0)
    v_min3_u32 v4, v12, v13, v14
    v_min_u32 v4, v4, v15
    v_mfma_f32_16x16x32_bf16 v[204:207], a[236:239], v[172:175], v[204:207]
    s_waitcnt lgkmcnt(0)
    v_mfma_f32_16x16x32_bf16 v[192:195], a[240:243], v[176:179], v[192:195]
    v_min_u32_dpp v4, v4, v4 quad_perm:[1,0,3,2] row_mask:0xf bank_mask:0xf
    v_mfma_f32_16x16x32_bf16 v[196:199], a[244:247], v[176:179], v[196:199]
    v_mfma_f32_16x16x32_bf16 v[200:203], a[240:243], v[180:183], v[200:203]
    v_min_u32_dpp v4, v4, v4 quad_perm:[2,3,0,1] row_mask:0xf bank_mask:0xf
    v_mfma_f32_16x16x32_bf16 v[204:207], a[244:247], v[180:183], v[204:207]
    v_mfma_f32_16x16x32_bf16 v[192:195], a[248:251], v[184:187], v[192:195]
    v_min_u32_dpp v4, v4, v4 row_half_mirror row_mask:0xf bank_mask:0xf
    v_mfma_f32_16x16x32_bf16 v[196:199], a[252:255], v[184:187], v[196:199]
    v_mfma_f32_16x16x32_bf16 v[200:203], a[248:251], v[188:191], v[200:203]
    v_readfirstlane_b32 s33, v4
    v_mfma_f32_16x16x32_bf16 v[204:207], a[252:255], v[188:191], v[204:207]
    s_cmp_gt_u32 s33, s28
    s_cbranch_scc1 .gx_527
    s_cmp_ge_u32 s28, 64
    s_cbranch_scc1 .last_531
    s_mov_b32 s39, 1
    s_nop 2
    v_cvt_pk_bf16_f32 v208, v192, v193
    v_cvt_pk_bf16_f32 v209, v194, v195
    v_cvt_pk_bf16_f32 v210, v196, v197
    v_cvt_pk_bf16_f32 v211, v198, v199
    v_cvt_pk_bf16_f32 v212, v200, v201
    v_cvt_pk_bf16_f32 v213, v202, v203
    v_cvt_pk_bf16_f32 v214, v204, v205
    v_cvt_pk_bf16_f32 v215, v206, v207
    s_branch .cold_522
.last_531:
    s_nop 3
    v_cvt_pk_bf16_f32 v208, v192, v193
    v_cvt_pk_bf16_f32 v209, v194, v195
    v_cvt_pk_bf16_f32 v210, v196, v197
    v_cvt_pk_bf16_f32 v211, v198, v199
    v_cvt_pk_bf16_f32 v212, v200, v201
    v_cvt_pk_bf16_f32 v213, v202, v203
    v_cvt_pk_bf16_f32 v214, v204, v205
    v_cvt_pk_bf16_f32 v215, v206, v207
    buffer_store_dwordx4 v[208:211], v2, s[8:11], s30 offen offset:0 sc1
    buffer_store_dwordx4 v[212:215], v2, s[8:11], s30 offen offset:1024 sc1
    s_mov_b32 s39, 0
    s_waitcnt vmcnt(0)
    v_mov_b32 v27, s28
    s_mov_b64 exec, 1
    buffer_store_dword v27, v26, s[8:11], s94 offen sc1
    s_mov_b64 exec, -1
    s_cmp_lt_u32 s28, 64
    s_cbranch_scc1 .cold_522
    s_endpgm
.gx_527:
    s_add_u32 m0, s36, 0
    s_add_u32 s31, s29, 0
    buffer_load_dwordx4 v9, s[8:11], s31 offen offset:0 sc1 lds
    buffer_load_dwordx4 v9, s[8:11], s31 offen offset:1024 sc1 lds
    buffer_load_dwordx4 v9, s[8:11], s31 offen offset:2048 sc1 lds
    buffer_load_dwordx4 v9, s[8:11], s31 offen offset:3072 sc1 lds
    s_add_u32 m0, s36, 16384
    s_add_u32 s31, s29, 16384
    buffer_load_dwordx4 v9, s[8:11], s31 offen offset:0 sc1 lds
    buffer_load_dwordx4 v9, s[8:11], s31 offen offset:1024 sc1 lds
    buffer_load_dwordx4 v9, s[8:11], s31 offen offset:2048 sc1 lds
    buffer_load_dwordx4 v9, s[8:11], s31 offen offset:3072 sc1 lds
    s_branch .cpy_530
.hot_525:
    v_mfma_f32_16x16x32_bf16 v[200:203], a[128:131], v[68:71], v[200:203]
    s_add_u32 m0, s36, 0
    s_add_u32 s31, s29, 0
    v_mfma_f32_16x16x32_bf16 v[204:207], a[132:135], v[68:71], v[204:207]
    buffer_load_dwordx4 v9, s[8:11], s31 offen offset:0 sc1 lds
    v_mfma_f32_16x16x32_bf16 v[192:195], a[136:139], v[72:75], v[192:195]
    ds_read_b128 v[144:147], v8 offset:51200
    ds_read_b128 v[148:151], v8 offset:55296
    v_mfma_f32_16x16x32_bf16 v[196:199], a[140:143], v[72:75], v[196:199]
    ds_read_b128 v[152:155], v8 offset:52224
    ds_read_b128 v[156:159], v8 offset:56320
    v_mfma_f32_16x16x32_bf16 v[200:203], a[136:139], v[76:79], v[200:203]
    ds_read_b128 v[160:163], v8 offset:57344
    ds_read_b128 v[164:167], v8 offset:61440
    v_mfma_f32_16x16x32_bf16 v[204:207], a[140:143], v[76:79], v[204:207]
    ds_read_b128 v[168:171], v8 offset:58368
    s_waitcnt lgkmcnt(15)
    v_mfma_f32_16x16x32_bf16 v[192:195], a[144:147], v[80:83], v[192:195]
    buffer_load_dwordx4 v9, s[8:11], s31 offen offset:1024 sc1 lds
    v_mfma_f32_16x16x32_bf16 v[196:199], a[148:151], v[80:83], v[196:199]
    ds_read_b128 v[172:175], v8 offset:62464
    ds_read_b128 v[176:179], v8 offset:59392
    v_mfma_f32_16x16x32_bf16 v[200:203], a[144:147], v[84:87], v[200:203]
    ds_read_b128 v[180:183], v8 offset:63488
    ds_read_b128 v[184:187], v8 offset:60416
    v_mfma_f32_16x16x32_bf16 v[204:207], a[148:151], v[84:87], v[204:207]
    ds_read_b128 v[188:191], v8 offset:64512
    v_xor_b32 v8, 0x10000, v8
    v_mfma_f32_16x16x32_bf16 v[192:195], a[152:155], v[88:91], v[192:195]
    v_mfma_f32_16x16x32_bf16 v[196:199], a[156:159], v[88:91], v[196:199]
    buffer_load_dwordx4 v9, s[8:11], s31 offen offset:2048 sc1 lds
    v_mfma_f32_16x16x32_bf16 v[200:203], a[152:155], v[92:95], v[200:203]
    v_mfma_f32_16x16x32_bf16 v[204:207], a[156:159], v[92:95], v[204:207]
    v_mfma_f32_16x16x32_bf16 v[192:195], a[160:163], v[96:99], v[192:195]
    v_mfma_f32_16x16x32_bf16 v[196:199], a[164:167], v[96:99], v[196:199]
    v_mfma_f32_16x16x32_bf16 v[200:203], a[160:163], v[100:103], v[200:203]
    buffer_load_dwordx4 v9, s[8:11], s31 offen offset:3072 sc1 lds
    v_mfma_f32_16x16x32_bf16 v[204:207], a[164:167], v[100:103], v[204:207]
    v_mfma_f32_16x16x32_bf16 v[192:195], a[168:171], v[104:107], v[192:195]
    v_mfma_f32_16x16x32_bf16 v[196:199], a[172:175], v[104:107], v[196:199]
    v_mfma_f32_16x16x32_bf16 v[200:203], a[168:171], v[108:111], v[200:203]
    v_mfma_f32_16x16x32_bf16 v[204:207], a[172:175], v[108:111], v[204:207]
    s_waitcnt lgkmcnt(15)
    v_mfma_f32_16x16x32_bf16 v[192:195], a[176:179], v[112:115], v[192:195]
    s_add_u32 m0, s36, 16384
    s_add_u32 s31, s29, 16384
    v_mfma_f32_16x16x32_bf16 v[196:199], a[180:183], v[112:115], v[196:199]
    buffer_load_dwordx4 v9, s[8:11], s31 offen offset:0 sc1 lds
    v_mfma_f32_16x16x32_bf16 v[200:203], a[176:179], v[116:119], v[200:203]
    v_mfma_f32_16x16x32_bf16 v[204:207], a[180:183], v[116:119], v[204:207]
    v_mfma_f32_16x16x32_bf16 v[192:195], a[184:187], v[120:123], v[192:195]
    v_mfma_f32_16x16x32_bf16 v[196:199], a[188:191], v[120:123], v[196:199]
    v_mfma_f32_16x16x32_bf16 v[200:203], a[184:187], v[124:127], v[200:203]
    buffer_load_dwordx4 v9, s[8:11], s31 offen offset:1024 sc1 lds
    v_mfma_f32_16x16x32_bf16 v[204:207], a[188:191], v[124:127], v[204:207]
    s_waitcnt lgkmcnt(12)
    v_mfma_f32_16x16x32_bf16 v[192:195], a[192:195], v[128:131], v[192:195]
    v_mfma_f32_16x16x32_bf16 v[196:199], a[196:199], v[128:131], v[196:199]
    v_mfma_f32_16x16x32_bf16 v[200:203], a[192:195], v[132:135], v[200:203]
    v_mfma_f32_16x16x32_bf16 v[204:207], a[196:199], v[132:135], v[204:207]
    buffer_load_dwordx4 v9, s[8:11], s31 offen offset:2048 sc1 lds
    v_mfma_f32_16x16x32_bf16 v[192:195], a[200:203], v[136:139], v[192:195]
    v_mfma_f32_16x16x32_bf16 v[196:199], a[204:207], v[136:139], v[196:199]
    v_mfma_f32_16x16x32_bf16 v[200:203], a[200:203], v[140:143], v[200:203]
    v_mfma_f32_16x16x32_bf16 v[204:207], a[204:207], v[140:143], v[204:207]
    s_waitcnt lgkmcnt(8)
    v_mfma_f32_16x16x32_bf16 v[192:195], a[208:211], v[144:147], v[192:195]
    buffer_load_dwordx4 v9, s[8:11], s31 offen offset:3072 sc1 lds
    v_mfma_f32_16x16x32_bf16 v[196:199], a[212:215], v[144:147], v[196:199]
    v_mfma_f32_16x16x32_bf16 v[200:203], a[208:211], v[148:151], v[200:203]
    v_mfma_f32_16x16x32_bf16 v[204:207], a[212:215], v[148:151], v[204:207]
    v_mfma_f32_16x16x32_bf16 v[192:195], a[216:219], v[152:155], v[192:195]
    v_mfma_f32_16x16x32_bf16 v[196:199], a[220:223], v[152:155], v[196:199]
    v_mfma_f32_16x16x32_bf16 v[200:203], a[216:219], v[156:159], v[200:203]
    v_mfma_f32_16x16x32_bf16 v[204:207], a[220:223], v[156:159], v[204:207]
    s_waitcnt lgkmcnt(4)
    v_mfma_f32_16x16x32_bf16 v[192:195], a[224:227], v[160:163], v[192:195]
    v_mfma_f32_16x16x32_bf16 v[196:199], a[228:231], v[160:163], v[196:199]
    v_mfma_f32_16x16x32_bf16 v[200:203], a[224:227], v[164:167], v[200:203]
    v_mfma_f32_16x16x32_bf16 v[204:207], a[228:231], v[164:167], v[204:207]
    v_mfma_f32_16x16x32_bf16 v[192:195], a[232:235], v[168:171], v[192:195]
    v_mfma_f32_16x16x32_bf16 v[196:199], a[236:239], v[168:171], v[196:199]
    v_mfma_f32_16x16x32_bf16 v[200:203], a[232:235], v[172:175], v[200:203]
    v_mfma_f32_16x16x32_bf16 v[204:207], a[236:239], v[172:175], v[204:207]
    s_waitcnt lgkmcnt(0)
    v_mfma_f32_16x16x32_bf16 v[192:195], a[240:243], v[176:179], v[192:195]
    v_mfma_f32_16x16x32_bf16 v[196:199], a[244:247], v[176:179], v[196:199]
    v_mfma_f32_16x16x32_bf16 v[200:203], a[240:243], v[180:183], v[200:203]
    v_mfma_f32_16x16x32_bf16 v[204:207], a[244:247], v[180:183], v[204:207]
    v_mfma_f32_16x16x32_bf16 v[192:195], a[248:251], v[184:187], v[192:195]
    v_mfma_f32_16x16x32_bf16 v[196:199], a[252:255], v[184:187], v[196:199]
    v_mfma_f32_16x16x32_bf16 v[200:203], a[248:251], v[188:191], v[200:203]
    v_mfma_f32_16x16x32_bf16 v[204:207], a[252:255], v[188:191], v[204:207]
.cpy_530:
    s_mov_b32 s39, 1
    s_nop 2
    v_cvt_pk_bf16_f32 v208, v192, v193
    v_cvt_pk_bf16_f32 v209, v194, v195
    v_cvt_pk_bf16_f32 v210, v196, v197
    v_cvt_pk_bf16_f32 v211, v198, v199
    v_cvt_pk_bf16_f32 v212, v200, v201
    v_cvt_pk_bf16_f32 v213, v202, v203
    v_cvt_pk_bf16_f32 v214, v204, v205
    v_cvt_pk_bf16_f32 v215, v206, v207
    s_branch .body_524
.pd_528:
.fin_419:
    s_load_dwordx2 s[44:45], s[0:1], 112
    s_sub_u32 s34, s98, 1
    s_lshl_b32 s4, s34, 10
    s_lshr_b32 s5, s99, 2
    s_lshl_b32 s5, s5, 22
    s_add_u32 s4, s4, s5
    s_and_b32 s5, s99, 3
    s_lshl_b32 s5, s5, 18
    s_add_u32 s4, s4, s5
    s_lshl_b32 s38, s99, 1
    v_lshlrev_b32 v2, 4, v1
    v_add_u32 v2, s4, v2
    s_lshl_b32 s4, s34, 15
    s_lshl_b32 s5, s99, 6
    s_add_u32 s4, s4, s5
    v_bfe_u32 v254, v1, 0, 4
    v_mul_u32_u24 v13, 2048, v254
    v_bfe_u32 v254, v1, 4, 2
    v_mul_u32_u24 v254, 16, v254
    v_add_u32 v13, v13, v254
    v_add_u32 v13, s4, v13
    s_lshl_b32 s4, s99, 17
    s_lshl_b32 s5, s34, 10
    s_add_u32 s4, s4, s5
    v_bfe_u32 v254, v1, 4, 2
    v_mul_u32_u24 v14, 32768, v254
    v_bfe_u32 v254, v1, 3, 1
    v_mul_u32_u24 v254, 512, v254
    v_add_u32 v14, v14, v254
    v_bfe_u32 v254, v1, 0, 3
    v_mul_u32_u24 v254, 2, v254
    v_add_u32 v14, v14, v254
    v_add_u32 v14, s4, v14
    v_add_u32 v15, 4096, v14
    v_add_u32 v16, 8192, v14
    v_add_u32 v17, 12288, v14
    v_add_u32 v18, 16384, v14
    v_add_u32 v19, 20480, v14
    v_add_u32 v20, 24576, v14
    v_add_u32 v21, 28672, v14
    s_lshl_b32 s4, s34, 6
    v_bfe_u32 v254, v1, 0, 4
    v_mul_u32_u24 v22, 4, v254
    v_add_u32 v22, s4, v22
    s_lshl_b32 s4, s99, 9
    s_add_u32 s4, s4, 92323840
    v_bfe_u32 v254, v1, 0, 2
    v_mul_u32_u24 v7, 128, v254
    v_add_u32 v7, s4, v7
    s_mov_b32 s28, s24
    s_mov_b32 s33, 0
    s_waitcnt lgkmcnt(0)
    s_mov_b32 s84, s44
    s_and_b32 s85, s45, 0xffff
    s_mov_b32 s86, 0x400000
    s_mov_b32 s87, 0x00020000
    s_xor_b32 s5, s94, 49152
    s_mov_b32 s62, 0
.pw_532:
    buffer_load_dword v4, v5, s[8:11], s5 offen offset:4 sc1
    s_add_u32 s62, s62, 1
    s_cmp_gt_u32 s62, 0x200000
    s_cbranch_scc1 .mg_end_1
    s_waitcnt vmcnt(0)
    v_readfirstlane_b32 s4, v4
    s_cmp_lg_u32 s4, 0
    s_cbranch_scc1 .pw_533
    s_sleep 8
    s_branch .pw_532
.pw_533:
    s_mov_b32 s62, 0
    v_mov_b32 v5, 0
.wc_534:
    buffer_load_dword v4, v5, s[20:23], 0 offen offset:192 sc1
    s_add_u32 s62, s62, 1
    s_cmp_gt_u32 s62, 0x200000
    s_cbranch_scc1 .mg_end_1
    s_waitcnt vmcnt(0)
    v_readfirstlane_b32 s4, v4
    s_cmp_ge_u32 s4, 64
    s_cbranch_scc1 .wd_535
    s_sleep 64
    s_branch .wc_534
.wd_535:
.fl_536:
    s_lshl_b32 s57, s28, 16
    s_and_b32 s4, s28, 31
    s_lshl_b32 s4, s4, 4
    s_lshr_b32 s5, s28, 5
    s_lshl_b32 s5, s5, 11
    s_add_u32 s58, s4, s5
    s_add_u32 s58, s58, 130023424
    s_lshl_b32 s59, s28, 7
    s_add_u32 s59, s59, 121634816
    buffer_load_dwordx4 v[32:35], v13, s[12:15], s57 offen
    buffer_load_dword v44, v22, s[8:11], s59 offen
    buffer_load_ushort v36, v14, s[8:11], s58 offen
    buffer_load_ushort v37, v15, s[8:11], s58 offen
    buffer_load_ushort v38, v16, s[8:11], s58 offen
    buffer_load_ushort v39, v17, s[8:11], s58 offen
    buffer_load_ushort v40, v18, s[8:11], s58 offen
    buffer_load_ushort v41, v19, s[8:11], s58 offen
    buffer_load_ushort v42, v20, s[8:11], s58 offen
    buffer_load_ushort v43, v21, s[8:11], s58 offen
    s_xor_b32 s48, s28, s38
    s_lshl_b32 s48, s48, 11
    s_add_u32 s48, s48, 150994944
    s_xor_b32 s49, s48, 1050624
    s_add_u32 s50, s48, 0x200000
    s_add_u32 s51, s49, 0x200000
    s_cmp_gt_u32 s33, s28
    s_cbranch_scc1 .fd_538
    s_mov_b32 s62, 0
.fp_537:
    buffer_load_dword v4, v7, s[8:11], 0 offen sc1
    s_add_u32 s62, s62, 1
    s_cmp_gt_u32 s62, 0x200000
    s_cbranch_scc1 .mg_end_1
    s_waitcnt vmcnt(0)
    v_min_u32_dpp v4, v4, v4 quad_perm:[1,0,3,2] row_mask:0xf bank_mask:0xf
    s_nop 1
    v_min_u32_dpp v4, v4, v4 quad_perm:[2,3,0,1] row_mask:0xf bank_mask:0xf
    s_nop 1
    v_readfirstlane_b32 s33, v4
    s_cmp_gt_u32 s33, s28
    s_cbranch_scc1 .fd_538
    s_sleep 2
    s_add_u32 s4, s33, 1
    s_cmp_ge_u32 s4, s28
    s_cbranch_scc1 .fp_537
    s_sleep 12
    s_branch .fp_537
.fd_538:
    buffer_load_dwordx4 v[96:99], v2, s[8:11], s48 offen
    buffer_load_dwordx4 v[100:103], v2, s[8:11], s49 offen
    buffer_load_dwordx4 v[104:107], v2, s[8:11], s50 offen
    buffer_load_dwordx4 v[108:111], v2, s[8:11], s51 offen
    s_waitcnt vmcnt(4)
    v_lshlrev_b32 v48, 16, v32
    v_lshlrev_b32 v36, 16, v36
    v_and_b32 v49, 0xffff0000, v32
    v_lshlrev_b32 v37, 16, v37
    v_lshlrev_b32 v50, 16, v33
    v_lshlrev_b32 v38, 16, v38
    v_and_b32 v51, 0xffff0000, v33
    v_lshlrev_b32 v39, 16, v39
    v_lshlrev_b32 v52, 16, v34
    v_lshlrev_b32 v40, 16, v40
    v_and_b32 v53, 0xffff0000, v34
    v_lshlrev_b32 v41, 16, v41
    v_lshlrev_b32 v54, 16, v35
    v_lshlrev_b32 v42, 16, v42
    v_and_b32 v55, 0xffff0000, v35
    v_lshlrev_b32 v43, 16, v43
    v_mul_f32 v48, v48, v36
    v_mul_f32 v49, v49, v37
    v_mul_f32 v50, v50, v38
    v_mul_f32 v51, v51, v39
    v_mul_f32 v52, v52, v40
    v_mul_f32 v53, v53, v41
    v_mul_f32 v54, v54, v42
    v_mul_f32 v55, v55, v43
    v_mul_f32 v48, v48, v44
    v_mul_f32 v49, v49, v44
    v_mul_f32 v50, v50, v44
    v_mul_f32 v51, v51, v44
    v_mul_f32 v52, v52, v44
    v_mul_f32 v53, v53, v44
    v_mul_f32 v54, v54, v44
    v_mul_f32 v55, v55, v44
    v_sub_f32 v44, 1.0, v44
    s_waitcnt vmcnt(3)
    v_lshlrev_b32 v64, 16, v96
    v_and_b32 v65, 0xffff0000, v96
    v_lshlrev_b32 v66, 16, v97
    v_and_b32 v67, 0xffff0000, v97
    v_lshlrev_b32 v68, 16, v98
    v_and_b32 v69, 0xffff0000, v98
    v_lshlrev_b32 v70, 16, v99
    v_and_b32 v71, 0xffff0000, v99
    s_waitcnt vmcnt(2)
    v_lshlrev_b32 v72, 16, v100
    v_and_b32 v73, 0xffff0000, v100
    v_lshlrev_b32 v74, 16, v101
    v_and_b32 v75, 0xffff0000, v101
    v_lshlrev_b32 v76, 16, v102
    v_and_b32 v77, 0xffff0000, v102
    v_lshlrev_b32 v78, 16, v103
    v_and_b32 v79, 0xffff0000, v103
    v_pk_add_f32 v[64:65], v[64:65], v[72:73]
    v_pk_add_f32 v[66:67], v[66:67], v[74:75]
    v_pk_add_f32 v[68:69], v[68:69], v[76:77]
    v_pk_add_f32 v[70:71], v[70:71], v[78:79]
    s_waitcnt vmcnt(1)
    v_lshlrev_b32 v80, 16, v104
    v_and_b32 v81, 0xffff0000, v104
    v_lshlrev_b32 v82, 16, v105
    v_and_b32 v83, 0xffff0000, v105
    v_lshlrev_b32 v84, 16, v106
    v_and_b32 v85, 0xffff0000, v106
    v_lshlrev_b32 v86, 16, v107
    v_and_b32 v87, 0xffff0000, v107
    v_pk_add_f32 v[64:65], v[64:65], v[80:81]
    v_pk_add_f32 v[66:67], v[66:67], v[82:83]
    v_pk_add_f32 v[68:69], v[68:69], v[84:85]
    v_pk_add_f32 v[70:71], v[70:71], v[86:87]
    s_waitcnt vmcnt(0)
    v_lshlrev_b32 v88, 16, v108
    v_and_b32 v89, 0xffff0000, v108
    v_lshlrev_b32 v90, 16, v109
    v_and_b32 v91, 0xffff0000, v109
    v_lshlrev_b32 v92, 16, v110
    v_and_b32 v93, 0xffff0000, v110
    v_lshlrev_b32 v94, 16, v111
    v_and_b32 v95, 0xffff0000, v111
    v_pk_add_f32 v[64:65], v[64:65], v[88:89]
    v_pk_add_f32 v[66:67], v[66:67], v[90:91]
    v_pk_add_f32 v[68:69], v[68:69], v[92:93]
    v_pk_add_f32 v[70:71], v[70:71], v[94:95]
    v_fma_f32 v64, v64, v44, v48
    v_fma_f32 v65, v65, v44, v49
    v_fma_f32 v66, v66, v44, v50
    v_fma_f32 v67, v67, v44, v51
    v_fma_f32 v68, v68, v44, v52
    v_fma_f32 v69, v69, v44, v53
    v_fma_f32 v70, v70, v44, v54
    v_fma_f32 v71, v71, v44, v55
    v_cvt_pk_bf16_f32 v56, v64, v65
    v_cvt_pk_bf16_f32 v57, v66, v67
    v_cvt_pk_bf16_f32 v58, v68, v69
    v_cvt_pk_bf16_f32 v59, v70, v71
    buffer_store_dwordx4 v[56:59], v13, s[84:87], s57 offen
    s_add_u32 s28, s28, 4
    s_cmp_lt_u32 s28, 64
    s_cbranch_scc1 .fl_536
    s_endpgm
.mg_end_1:
    s_endpgm
.section .rodata,"a"
.p2align 6
.amdhsa_kernel mega_kernel
  .amdhsa_next_free_vgpr 512
  .amdhsa_next_free_sgpr 102
  .amdhsa_accum_offset 256
  .amdhsa_group_segment_fixed_size 0
  .amdhsa_kernarg_size 136
  .amdhsa_user_sgpr_count 2
  .amdhsa_user_sgpr_kernarg_segment_ptr 1
  .amdhsa_system_sgpr_workgroup_id_x 1
.end_amdhsa_kernel
```
